```python
import torch

def _softmax(x, axis=-1):
    return torch.softmax(x, dim=axis)
def _gelu(x):
    return torch.nn.functional.gelu(x, approximate="tanh")
def _silu(x):
    return torch.nn.functional.silu(x)
def _sigmoid(x):
    return torch.sigmoid(x)
def _layernorm(x, axis=-1, eps=1e-5):
    m = x.mean(dim=axis, keepdim=True)
    v = x.var(dim=axis, keepdim=True, unbiased=False)
    return (x - m) / torch.sqrt(v + eps)
def _scatter_add(tgt, idx, src, axis=0):
    return tgt.clone().index_add_(axis, idx, src)
def _segment_sum(src, seg, n):
    out = torch.zeros((n,) + src.shape[1:], dtype=src.dtype)
    return out.index_add_(0, seg, src)
def _pad(x, pw):
    flat = tuple(v for pair in reversed(pw) for v in pair)
    return torch.nn.functional.pad(x, flat)

kernel_name = 'concat_heads__mha_block_cached__gqa_block_cached__near_ridge'

def setup_inputs():

    _w = (lambda a: (lambda t: t.to(torch.bfloat16) if t.is_floating_point() else t)(torch.as_tensor(a)))
    def _A_setup():
        B, Sq, D = 16, 192, 512
        H, Sk, Dh = 32, 512, 128
        return {
            "x": _w((lambda *s: torch.randn(*s, dtype=torch.bfloat16) * 0.8)(B, Sq, D)),
            "k_cache": _w((lambda *s: torch.randn(*s, dtype=torch.bfloat16) * 0.8)(B, H, Sk, Dh)),
            "v_cache": _w((lambda *s: torch.randn(*s, dtype=torch.bfloat16) * 0.05)(B, H, Sk, Dh)),
            "wq": _w((lambda *s: torch.randn(*s, dtype=torch.bfloat16) * 0.8)(D, H * Dh) * (D ** -0.5)),
            "wo": _w((lambda *s: torch.randn(*s, dtype=torch.bfloat16) * 0.05)(H * Dh, D) * ((H * Dh) ** -0.5)),
        }
    _A_in = _A_setup()

    def _B_setup():
        B, Sq, D = 16, 192, 512
        Hq, Hkv, Sk, Dh = 32, 32, 512, 128
        assert Hq % Hkv == 0, (Hq, Hkv)
        return {
            "x": _w((lambda *s: torch.randn(*s, dtype=torch.bfloat16) * 0.8)(B, Sq, D)),
            "k_cache": _w((lambda *s: torch.randn(*s, dtype=torch.bfloat16) * 0.8)(B, Hkv, Sk, Dh)),
            "v_cache": _w((lambda *s: torch.randn(*s, dtype=torch.bfloat16) * 0.05)(B, Hkv, Sk, Dh)),
            "wq": _w((lambda *s: torch.randn(*s, dtype=torch.bfloat16) * 0.8)(D, Hq * Dh) * (D ** -0.5)),
            "wo": _w((lambda *s: torch.randn(*s, dtype=torch.bfloat16) * 0.05)(Hq * Dh, D) * ((Hq * Dh) ** -0.5)),
        }
    _B_in = _B_setup()

    return {
        "A_x": _A_in["x"],
        "A_k_cache": _A_in["k_cache"],
        "A_v_cache": _A_in["v_cache"],
        "A_wq": _A_in["wq"],
        "A_wo": _A_in["wo"],
        "B_x": _B_in["x"],
        "B_k_cache": _B_in["k_cache"],
        "B_v_cache": _B_in["v_cache"],
        "B_wq": _B_in["wq"],
        "B_wo": _B_in["wo"],
    }

def reference(A_x, A_k_cache, A_v_cache, A_wq, A_wo, B_x, B_k_cache, B_v_cache, B_wq, B_wo):
    def _A_ref(x, k_cache, v_cache, wq, wo):
        B, Sq, D = x.shape
        H, Dh = 32, 128
        q = (lambda x, *d: x.permute(*d))((x @ wq).reshape(B, Sq, H, Dh), 0, 2, 1, 3)
        scores = torch.einsum("bhqd,bhkd->bhqk", q, k_cache) * (Dh ** -0.5)
        p = _softmax(scores, axis=-1)
        o = torch.einsum("bhqk,bhkd->bhqd", p, v_cache)
        return (lambda x, *d: x.permute(*d))(o, 0, 2, 1, 3).reshape(B, Sq, H * Dh) @ wo

    def _B_ref(x, k_cache, v_cache, wq, wo):
        B, Sq, D = x.shape
        Hq, Dh = 32, 128
        Hkv = k_cache.shape[1]
        rep = Hq // Hkv
        q = (lambda x, *d: x.permute(*d))((x @ wq).reshape(B, Sq, Hq, Dh), 0, 2, 1, 3)
        k = (lambda x, n, axis: torch.repeat_interleave(x, n, dim=axis))(k_cache, rep, axis=1)
        v = (lambda x, n, axis: torch.repeat_interleave(x, n, dim=axis))(v_cache, rep, axis=1)
        scores = torch.einsum("bhqd,bhkd->bhqk", q, k) * (Dh ** -0.5)
        p = _softmax(scores, axis=-1)
        o = torch.einsum("bhqk,bhkd->bhqd", p, v)
        return (lambda x, *d: x.permute(*d))(o, 0, 2, 1, 3).reshape(B, Sq, Hq * Dh) @ wo

    a = _A_ref(A_x, A_k_cache, A_v_cache, A_wq, A_wo)
    b = _B_ref(B_x, B_k_cache, B_v_cache, B_wq, B_wo)
    return torch.concatenate([a, b], axis=-1)
```

```asm
; @launch grid=(256,1,1) block=(256,1,1) lds=163840
.amdgcn_target "amdgcn-amd-amdhsa--gfx950"
.text
.globl concat_heads__mha_block_cached__gqa_block_cached__near_ridge_kernel
.p2align 8
.type concat_heads__mha_block_cached__gqa_block_cached__near_ridge_kernel,@function
concat_heads__mha_block_cached__gqa_block_cached__near_ridge_kernel:
s_cmp_ge_u32 s2, 256
s_cbranch_scc1 L_concat_heads__mha_block_cached__gqa_block_cached__near_ridge_kernel_end
s_and_b32 s58, s2, 7
s_lshr_b32 s59, s2, 3
s_lshr_b32 s69, s58, 2
s_mul_i32 s62, s69, 40
s_add_u32 s64, s0, s62
s_addc_u32 s65, s1, 0
s_load_dwordx8 s[4:11], s[64:65], 0
s_load_dwordx2 s[12:13], s[0:1], 96
s_lshr_b32 s62, s2, 7
s_mul_i32 s62, s62, 40
s_add_u32 s62, s0, s62
s_addc_u32 s63, s1, 0
s_load_dwordx2 s[14:15], s[62:63], 32
s_load_dwordx2 s[84:85], s[64:65], 32
s_load_dwordx4 s[88:91], s[0:1], 80
s_and_b32 s60, s58, 3
s_lshl_b32 s60, s60, 2
s_lshr_b32 s61, s59, 3
s_add_u32 s67, s60, s61
s_and_b32 s68, s59, 7
v_lshrrev_b32 v44, 6, v0
v_and_b32 v1, 63, v0
v_readfirstlane_b32 s3, v44
s_getpc_b64 s[52:53]
L_concat_heads__mha_block_cached__gqa_block_cached__near_ridge_kernel_pc:
s_sub_u32 s52, s52, L_concat_heads__mha_block_cached__gqa_block_cached__near_ridge_kernel_pc-concat_heads__mha_block_cached__gqa_block_cached__near_ridge_kernel
s_subb_u32 s53, s53, 0
s_mov_b32 s54, L_concat_heads__mha_block_cached__gqa_block_cached__near_ridge_kernel_codeend-concat_heads__mha_block_cached__gqa_block_cached__near_ridge_kernel
s_mov_b32 s55, 0x20000
s_lshr_b32 s60, s2, 3
s_lshl_b32 s60, s60, 2
s_add_u32 s60, s60, s3
s_lshl_b32 s101, s60, 7
v_lshlrev_b32 v43, 14, v1
buffer_load_dword v43, v43, s[52:55], s101 offen
v_lshrrev_b32 v44, 2, v1
v_lshlrev_b32 v44, 10, v44
s_and_b32 s58, s3, 1
s_lshr_b32 s59, s3, 1
v_lshrrev_b32 v45, 5, v1
v_lshlrev_b32 v46, 1, v45
v_and_b32 v47, 3, v1
v_xor_b32 v47, v47, v46
v_lshlrev_b32 v47, 4, v47
v_add_u32 v44, v44, v47
s_mul_i32 s60, s3, 49152
v_add_u32 v2, s60, v44
v_add_u32 v3, 15360, v2
v_add_u32 v4, 30720, v2
v_and_b32 v47, 31, v1
v_xor_b32 v47, v47, v46
v_lshlrev_b32 v47, 4, v47
v_lshlrev_b32 v44, 13, v45
v_add_u32 v44, v44, v47
s_lshl_b32 s60, s58, 1
s_lshl_b32 s61, s59, 3
s_add_u32 s60, s60, s61
s_lshl_b32 s60, s60, 13
v_add_u32 v5, s60, v44
v_add_u32 v39, 31744, v5
v_add_u32 v40, 129024, v5
v_add_u32 v41, 160768, v5
s_mul_i32 s56, s3, 3072
s_mul_i32 s57, s3, 4160
s_lshl_b32 s77, s3, 12
s_lshl_b32 s60, s68, 1
s_lshl_b32 s61, s67, 2
s_add_u32 s60, s60, s61
s_add_u32 s60, s60, 15
s_and_b32 s60, s60, 15
s_lshl_b32 s61, s68, 1
s_add_u32 s61, s61, s59
s_add_u32 s61, s61, s67
s_add_u32 s61, s61, 15
s_and_b32 s61, s61, 15
s_lshl_b32 s73, s60, 18
s_lshl_b32 s74, s60, 6
s_lshl_b32 s75, s61, 13
s_lshl_b32 s76, s61, 13
s_waitcnt lgkmcnt(0)
s_mov_b32 s0, s101
s_mul_i32 s60, s67, 196608
s_add_u32 s16, s4, s60
s_addc_u32 s17, s5, 0
s_mov_b32 s18, 196608
s_mov_b32 s19, 0x20000
s_lshl_b32 s60, s68, 9
s_add_u32 s20, s10, s60
s_addc_u32 s21, s11, 0
s_sub_u32 s22, 4194304, s60
s_mov_b32 s23, 0x20000
s_add_u32 s73, s73, 262144
s_add_u32 s74, s74, 64
s_and_b32 s73, s73, 4194303
s_and_b32 s74, s74, 1023
s_add_u32 m0, s57, 131072
s_nop 0
buffer_load_dwordx4 v5, s[20:23], s73 offen lds
buffer_load_dwordx4 v39, s[20:23], s73 offen offset:1024 lds
buffer_load_dwordx4 v40, s[20:23], s73 offen offset:2048 lds
buffer_load_dwordx4 v41, s[20:23], s73 offen offset:3072 lds
s_add_u32 m0, s56, 147712
s_nop 0
buffer_load_dwordx4 v2, s[16:19], s74 offen lds
buffer_load_dwordx4 v3, s[16:19], s74 offen offset:1024 lds
buffer_load_dwordx4 v4, s[16:19], s74 offen offset:2048 lds
s_add_u32 s73, s73, 262144
s_add_u32 s74, s74, 64
s_and_b32 s73, s73, 4194303
s_and_b32 s74, s74, 1023
s_add_u32 m0, s57, 32768
s_nop 0
buffer_load_dwordx4 v5, s[20:23], s73 offen lds
buffer_load_dwordx4 v39, s[20:23], s73 offen offset:1024 lds
buffer_load_dwordx4 v40, s[20:23], s73 offen offset:2048 lds
buffer_load_dwordx4 v41, s[20:23], s73 offen offset:3072 lds
s_and_b32 s58, s3, 1
s_lshr_b32 s59, s3, 1
v_lshrrev_b32 v44, 4, v1
v_and_b32 v45, 15, v1
v_lshlrev_b32 v46, 8, v44
s_lshl_b32 s60, s58, 12
v_add_u32 v46, s60, v46
v_xor_b32 v47, v45, v44
v_xor_b32 v6, 0, v47
v_lshlrev_b32 v6, 4, v6
v_add_u32 v6, v6, v46
v_xor_b32 v7, 4, v47
v_lshlrev_b32 v7, 4, v7
v_add_u32 v7, v7, v46
v_xor_b32 v8, 8, v47
v_lshlrev_b32 v8, 4, v8
v_add_u32 v8, v8, v46
v_xor_b32 v9, 12, v47
v_lshlrev_b32 v9, 4, v9
v_add_u32 v9, v9, v46
v_lshlrev_b32 v47, 1, v44
v_xor_b32 v47, v47, v45
v_lshlrev_b32 v47, 4, v47
v_add_u32 v10, v47, v46
v_xor_b32 v47, 128, v47
v_add_u32 v19, v47, v46
s_mov_b32 s66, 0x3e0293ee
s_mov_b32 s71, 262144
s_mov_b32 s72, 524288
s_mov_b32 s70, 0
v_lshrrev_b32 v48, 4, v1
v_and_b32 v49, 15, v1
v_lshrrev_b32 v50, 2, v49
v_and_b32 v51, 3, v49
v_lshrrev_b32 v44, 1, v50
v_and_b32 v45, 1, v48
v_lshlrev_b32 v45, 1, v45
v_add_u32 v44, v44, v45
v_mul_u32_u24 v44, 4160, v44
v_lshrrev_b32 v45, 1, v48
v_lshlrev_b32 v45, 11, v45
v_add_u32 v44, v44, v45
v_and_b32 v46, 1, v50
v_lshlrev_b32 v45, 9, v46
v_add_u32 v44, v44, v45
v_lshlrev_b32 v45, 3, v51
v_add_u32 v44, v44, v45
s_lshl_b32 s62, s59, 8
v_add_u32 v44, s62, v44
v_lshlrev_b32 v45, 5, v46
v_add_u32 v47, v44, v45
v_sub_u32 v44, v44, v45
v_add_u32 v44, 32, v44
v_add_u32 v11, 131072, v47
v_add_u32 v12, 131072, v44
v_add_u32 v13, 32768, v47
v_add_u32 v14, 32768, v44
v_add_u32 v15, 98304, v47
v_add_u32 v16, 98304, v44
v_lshrrev_b32 v44, 3, v49
v_lshlrev_b32 v44, 1, v44
v_xor_b32 v44, v44, v48
v_lshlrev_b32 v44, 4, v44
v_lshlrev_b32 v45, 6, v49
v_add_u32 v44, v44, v45
s_mul_i32 s62, s58, 6144
v_add_u32 v44, s62, v44
v_add_u32 v17, 49408, v44
v_add_u32 v18, 114944, v44
v_lshrrev_b32 v44, 1, v48
v_xor_b32 v44, v44, v49
v_lshlrev_b32 v44, 4, v44
v_lshlrev_b32 v45, 8, v49
v_and_b32 v46, 1, v48
v_lshlrev_b32 v46, 3, v46
v_add_u32 v45, v45, v46
s_lshl_b32 s62, s59, 13
v_add_u32 v45, s62, v45
v_xor_b32 v20, 0, v44
v_add_u32 v20, v20, v45
v_xor_b32 v21, 32, v44
v_add_u32 v21, v21, v45
v_xor_b32 v22, 64, v44
v_add_u32 v22, v22, v45
v_xor_b32 v23, 96, v44
v_add_u32 v23, v23, v45
v_xor_b32 v24, 128, v44
v_add_u32 v24, v24, v45
v_xor_b32 v25, 160, v44
v_add_u32 v25, v25, v45
v_xor_b32 v26, 192, v44
v_add_u32 v26, v26, v45
v_xor_b32 v27, 224, v44
v_add_u32 v27, v27, v45
v_lshlrev_b32 v44, 2, v48
v_add_u32 v44, v44, v50
v_lshlrev_b32 v45, 8, v44
v_and_b32 v44, 7, v44
v_lshlrev_b32 v44, 5, v44
v_add_u32 v45, v45, v44
v_lshlrev_b32 v44, 3, v51
v_add_u32 v45, v45, v44
s_add_u32 s62, s62, 65536
v_add_u32 v28, s62, v45
v_xor_b32 v29, 32, v28
v_xor_b32 v30, 64, v28
v_xor_b32 v31, 96, v28
v_lshlrev_b32 v38, 4, v1
v_lshlrev_b32 v42, 7, v1
s_add_u32 s58, s68, 0
s_lshl_b32 s60, s58, 1
s_lshr_b32 s61, s3, 1
s_add_u32 s60, s60, s61
s_lshl_b32 s61, s67, 5
s_add_u32 s61, s61, s60
s_lshl_b32 s62, s61, 17
s_lshr_b32 s63, s61, 15
s_add_u32 s24, s6, s62
s_addc_u32 s25, s7, s63
s_mov_b32 s26, 131072
s_mov_b32 s27, 0x20000
s_add_u32 s28, s8, s62
s_addc_u32 s29, s9, s63
s_mov_b32 s30, 131072
s_mov_b32 s31, 0x20000
s_lshl_b32 s61, s69, 4
s_add_u32 s61, s61, s67
s_mul_i32 s61, s61, 12
s_and_b32 s62, s3, 1
s_mul_i32 s62, s62, 6
s_add_u32 s61, s61, s62
s_lshl_b32 s61, s61, 17
s_lshl_b32 s60, s60, 12
s_add_u32 s61, s61, s60
s_add_u32 s32, s12, s61
s_addc_u32 s33, s13, 0
s_mov_b32 s34, 659456
s_mov_b32 s35, 0x20000
s_add_u32 s58, s68, 8
s_lshl_b32 s59, s58, 9
s_add_u32 s44, s10, s59
s_addc_u32 s45, s11, 0
s_sub_u32 s46, 4194304, s59
s_mov_b32 s47, 0x20000
s_lshl_b32 s60, s58, 1
s_lshr_b32 s61, s3, 1
s_add_u32 s60, s60, s61
s_lshl_b32 s61, s67, 5
s_add_u32 s61, s61, s60
s_lshl_b32 s62, s61, 17
s_lshr_b32 s63, s61, 15
s_add_u32 s36, s6, s62
s_addc_u32 s37, s7, s63
s_mov_b32 s38, 131072
s_mov_b32 s39, 0x20000
s_add_u32 s40, s8, s62
s_addc_u32 s41, s9, s63
s_mov_b32 s42, 131072
s_mov_b32 s43, 0x20000
s_lshl_b32 s61, s69, 4
s_add_u32 s61, s61, s67
s_mul_i32 s61, s61, 12
s_and_b32 s62, s3, 1
s_mul_i32 s62, s62, 6
s_add_u32 s61, s61, s62
s_lshl_b32 s61, s61, 17
s_lshl_b32 s60, s60, 12
s_add_u32 s61, s61, s60
s_add_u32 s48, s12, s61
s_addc_u32 s49, s13, 0
s_mov_b32 s50, 659456
s_mov_b32 s51, 0x20000
s_and_b32 s58, s2, 127
s_lshl_b32 s58, s58, 15
s_add_u32 s8, s14, s58
s_addc_u32 s9, s15, 0
s_mov_b32 s10, 32768
s_mov_b32 s11, 0x20000
s_and_b32 s58, s2, 7
s_lshr_b32 s59, s2, 3
s_and_b32 s60, s59, 3
s_lshr_b32 s59, s59, 2
s_lshl_b32 s58, s58, 3
s_add_u32 s58, s58, s59
s_lshr_b32 s59, s58, 5
s_mov_b32 s92, s90
s_mov_b32 s93, s91
s_mov_b32 s94, 256
s_mov_b32 s95, 0x20000
s_lshl_b32 s64, s60, 8
s_add_u32 s84, s84, s64
s_addc_u32 s85, s85, 0
s_sub_u32 s86, 4194304, s64
s_mov_b32 s87, 0x20000
s_and_b32 s61, s58, 31
s_mul_i32 s61, s61, 196608
s_lshl_b32 s62, s59, 10
s_add_u32 s61, s61, s62
s_add_u32 s61, s61, s64
s_add_u32 s88, s88, s61
s_addc_u32 s89, s89, 0
s_mov_b32 s90, 194816
s_mov_b32 s91, 0x20000
s_mul_i32 s61, s58, 786432
s_mul_hi_u32 s62, s58, 786432
s_add_u32 s80, s12, s61
s_addc_u32 s81, s13, s62
s_mov_b32 s82, 786432
s_mov_b32 s83, 0x20000
s_lshr_b32 s58, s58, 1
s_lshl_b32 s14, s58, 3
s_lshl_b32 s58, s69, 4
s_add_u32 s58, s58, s67
s_lshl_b32 s15, s58, 3
s_mul_i32 s78, s3, 33792
s_lshl_b32 s79, s3, 14
s_lshl_b32 s96, s3, 19
s_mov_b32 s70, 15360
s_mov_b32 s4, s92
s_mov_b32 s5, s93
s_cmp_eq_u32 s3, 0
s_cselect_b32 s6, 256, 0
s_mov_b32 s7, 0x20000
s_add_u32 m0, s56, 49408
s_nop 0
buffer_load_dwordx4 v2, s[16:19], s74 offen lds
buffer_load_dwordx4 v3, s[16:19], s74 offen offset:1024 lds
buffer_load_dwordx4 v4, s[16:19], s74 offen offset:2048 lds
s_waitcnt vmcnt(7)
s_barrier
ds_read_b64_tr_b16 a[192:193], v11
ds_read_b64_tr_b16 a[194:195], v11 offset:1024
ds_read_b64_tr_b16 a[196:197], v12
ds_read_b64_tr_b16 a[198:199], v12 offset:1024
ds_read_b64_tr_b16 a[200:201], v11 offset:64
ds_read_b64_tr_b16 a[202:203], v11 offset:1088
ds_read_b64_tr_b16 a[204:205], v12 offset:64
ds_read_b64_tr_b16 a[206:207], v12 offset:1088
ds_read_b64_tr_b16 a[208:209], v11 offset:128
ds_read_b64_tr_b16 a[210:211], v11 offset:1152
ds_read_b64_tr_b16 a[212:213], v12 offset:128
ds_read_b64_tr_b16 a[214:215], v12 offset:1152
ds_read_b64_tr_b16 a[216:217], v11 offset:192
ds_read_b64_tr_b16 a[218:219], v11 offset:1216
ds_read_b64_tr_b16 a[220:221], v12 offset:192
ds_read_b64_tr_b16 a[222:223], v12 offset:1216
ds_read_b128 v[52:55], v18 offset:32768
ds_read_b128 v[56:59], v18 offset:33792
ds_read_b128 v[60:63], v18 offset:34816
s_add_u32 s73, s73, 262144
s_add_u32 s74, s74, 64
s_and_b32 s73, s73, 4194303
s_and_b32 s74, s74, 1023
s_add_u32 m0, s57, 98304
s_nop 0
buffer_load_dwordx4 v5, s[20:23], s73 offen lds
buffer_load_dwordx4 v39, s[20:23], s73 offen offset:1024 lds
buffer_load_dwordx4 v40, s[20:23], s73 offen offset:2048 lds
buffer_load_dwordx4 v41, s[20:23], s73 offen offset:3072 lds
s_add_u32 m0, s56, 114944
s_nop 0
buffer_load_dwordx4 v2, s[16:19], s74 offen lds
buffer_load_dwordx4 v3, s[16:19], s74 offen offset:1024 lds
buffer_load_dwordx4 v4, s[16:19], s74 offen offset:2048 lds
s_waitcnt lgkmcnt(1)
v_mfma_f32_16x16x32_bf16 v[64:67], a[192:195], v[52:55], 0
v_mfma_f32_16x16x32_bf16 v[96:99], a[192:195], v[56:59], 0
ds_read_b128 a[224:227], v18 offset:35840
s_waitcnt lgkmcnt(1)
v_mfma_f32_16x16x32_bf16 v[128:131], a[192:195], v[60:63], 0
ds_read_b128 a[228:231], v18 offset:36864
v_mfma_f32_16x16x32_bf16 v[68:71], a[196:199], v[52:55], 0
ds_read_b128 a[232:235], v18 offset:37888
v_mfma_f32_16x16x32_bf16 v[100:103], a[196:199], v[56:59], 0
s_add_u32 s73, s73, 262144
v_mfma_f32_16x16x32_bf16 v[132:135], a[196:199], v[60:63], 0
s_add_u32 s74, s74, 64
v_mfma_f32_16x16x32_bf16 v[72:75], a[200:203], v[52:55], 0
s_and_b32 s73, s73, 4194303
v_mfma_f32_16x16x32_bf16 v[104:107], a[200:203], v[56:59], 0
s_and_b32 s74, s74, 1023
v_mfma_f32_16x16x32_bf16 v[136:139], a[200:203], v[60:63], 0
s_waitcnt vmcnt(7) lgkmcnt(0)
s_barrier
v_mfma_f32_16x16x32_bf16 v[76:79], a[204:207], v[52:55], 0
s_add_u32 m0, s57, 131072
v_mfma_f32_16x16x32_bf16 v[108:111], a[204:207], v[56:59], 0
buffer_load_dwordx4 v5, s[20:23], s73 offen lds
v_mfma_f32_16x16x32_bf16 v[140:143], a[204:207], v[60:63], 0
v_mfma_f32_16x16x32_bf16 v[80:83], a[208:211], v[52:55], 0
v_mfma_f32_16x16x32_bf16 v[112:115], a[208:211], v[56:59], 0
v_mfma_f32_16x16x32_bf16 v[144:147], a[208:211], v[60:63], 0
v_mfma_f32_16x16x32_bf16 v[84:87], a[212:215], v[52:55], 0
v_mfma_f32_16x16x32_bf16 v[116:119], a[212:215], v[56:59], 0
buffer_load_dwordx4 v39, s[20:23], s73 offen offset:1024 lds
v_mfma_f32_16x16x32_bf16 v[148:151], a[212:215], v[60:63], 0
v_mfma_f32_16x16x32_bf16 v[88:91], a[216:219], v[52:55], 0
v_mfma_f32_16x16x32_bf16 v[120:123], a[216:219], v[56:59], 0
v_mfma_f32_16x16x32_bf16 v[152:155], a[216:219], v[60:63], 0
v_mfma_f32_16x16x32_bf16 v[92:95], a[220:223], v[52:55], 0
ds_read_b128 v[52:55], v17
v_mfma_f32_16x16x32_bf16 v[124:127], a[220:223], v[56:59], 0
buffer_load_dwordx4 v40, s[20:23], s73 offen offset:2048 lds
ds_read_b128 v[56:59], v17 offset:1024
v_mfma_f32_16x16x32_bf16 v[156:159], a[220:223], v[60:63], 0
ds_read_b128 v[60:63], v17 offset:2048
v_mfma_f32_16x16x32_bf16 v[160:163], a[192:195], a[224:227], 0
v_mfma_f32_16x16x32_bf16 v[192:195], a[192:195], a[228:231], 0
v_mfma_f32_16x16x32_bf16 v[224:227], a[192:195], a[232:235], 0
ds_read_b64_tr_b16 a[192:193], v13
v_mfma_f32_16x16x32_bf16 v[164:167], a[196:199], a[224:227], 0
ds_read_b64_tr_b16 a[194:195], v13 offset:1024
v_mfma_f32_16x16x32_bf16 v[196:199], a[196:199], a[228:231], 0
buffer_load_dwordx4 v41, s[20:23], s73 offen offset:3072 lds
v_mfma_f32_16x16x32_bf16 v[228:231], a[196:199], a[232:235], 0
s_add_u32 m0, s56, 147712
ds_read_b64_tr_b16 a[196:197], v14
v_mfma_f32_16x16x32_bf16 v[168:171], a[200:203], a[224:227], 0
ds_read_b64_tr_b16 a[198:199], v14 offset:1024
v_mfma_f32_16x16x32_bf16 v[200:203], a[200:203], a[228:231], 0
v_mfma_f32_16x16x32_bf16 v[232:235], a[200:203], a[232:235], 0
ds_read_b64_tr_b16 a[200:201], v13 offset:64
v_mfma_f32_16x16x32_bf16 v[172:175], a[204:207], a[224:227], 0
ds_read_b64_tr_b16 a[202:203], v13 offset:1088
v_mfma_f32_16x16x32_bf16 v[204:207], a[204:207], a[228:231], 0
buffer_load_dwordx4 v2, s[16:19], s74 offen lds
v_mfma_f32_16x16x32_bf16 v[236:239], a[204:207], a[232:235], 0
ds_read_b64_tr_b16 a[204:205], v14 offset:64
v_mfma_f32_16x16x32_bf16 v[176:179], a[208:211], a[224:227], 0
ds_read_b64_tr_b16 a[206:207], v14 offset:1088
v_mfma_f32_16x16x32_bf16 v[208:211], a[208:211], a[228:231], 0
v_mfma_f32_16x16x32_bf16 v[240:243], a[208:211], a[232:235], 0
ds_read_b64_tr_b16 a[208:209], v13 offset:128
v_mfma_f32_16x16x32_bf16 v[180:183], a[212:215], a[224:227], 0
ds_read_b64_tr_b16 a[210:211], v13 offset:1152
v_mfma_f32_16x16x32_bf16 v[212:215], a[212:215], a[228:231], 0
buffer_load_dwordx4 v3, s[16:19], s74 offen offset:1024 lds
v_mfma_f32_16x16x32_bf16 v[244:247], a[212:215], a[232:235], 0
ds_read_b64_tr_b16 a[212:213], v14 offset:128
v_mfma_f32_16x16x32_bf16 v[184:187], a[216:219], a[224:227], 0
ds_read_b64_tr_b16 a[214:215], v14 offset:1152
v_mfma_f32_16x16x32_bf16 v[216:219], a[216:219], a[228:231], 0
v_mfma_f32_16x16x32_bf16 v[248:251], a[216:219], a[232:235], 0
ds_read_b64_tr_b16 a[216:217], v13 offset:192
v_mfma_f32_16x16x32_bf16 v[188:191], a[220:223], a[224:227], 0
ds_read_b64_tr_b16 a[218:219], v13 offset:1216
v_mfma_f32_16x16x32_bf16 v[220:223], a[220:223], a[228:231], 0
buffer_load_dwordx4 v4, s[16:19], s74 offen offset:2048 lds
v_mfma_f32_16x16x32_bf16 v[252:255], a[220:223], a[232:235], 0
ds_read_b64_tr_b16 a[220:221], v14 offset:192
s_waitcnt lgkmcnt(5)
v_mfma_f32_16x16x32_bf16 v[64:67], a[192:195], v[52:55], v[64:67]
ds_read_b64_tr_b16 a[222:223], v14 offset:1216
v_mfma_f32_16x16x32_bf16 v[96:99], a[192:195], v[56:59], v[96:99]
ds_read_b128 a[224:227], v17 offset:3072
v_mfma_f32_16x16x32_bf16 v[128:131], a[192:195], v[60:63], v[128:131]
ds_read_b128 a[228:231], v17 offset:4096
v_mfma_f32_16x16x32_bf16 v[68:71], a[196:199], v[52:55], v[68:71]
ds_read_b128 a[232:235], v17 offset:5120
v_mfma_f32_16x16x32_bf16 v[100:103], a[196:199], v[56:59], v[100:103]
s_add_u32 s73, s73, 262144
v_mfma_f32_16x16x32_bf16 v[132:135], a[196:199], v[60:63], v[132:135]
s_add_u32 s74, s74, 64
v_mfma_f32_16x16x32_bf16 v[72:75], a[200:203], v[52:55], v[72:75]
s_and_b32 s73, s73, 4194303
v_mfma_f32_16x16x32_bf16 v[104:107], a[200:203], v[56:59], v[104:107]
s_and_b32 s74, s74, 1023
v_mfma_f32_16x16x32_bf16 v[136:139], a[200:203], v[60:63], v[136:139]
s_waitcnt vmcnt(7) lgkmcnt(0)
s_barrier
v_mfma_f32_16x16x32_bf16 v[76:79], a[204:207], v[52:55], v[76:79]
s_add_u32 m0, s57, 32768
v_mfma_f32_16x16x32_bf16 v[108:111], a[204:207], v[56:59], v[108:111]
buffer_load_dwordx4 v5, s[20:23], s73 offen lds
v_mfma_f32_16x16x32_bf16 v[140:143], a[204:207], v[60:63], v[140:143]
v_mfma_f32_16x16x32_bf16 v[80:83], a[208:211], v[52:55], v[80:83]
v_mfma_f32_16x16x32_bf16 v[112:115], a[208:211], v[56:59], v[112:115]
buffer_load_dwordx4 v39, s[20:23], s73 offen offset:1024 lds
v_mfma_f32_16x16x32_bf16 v[144:147], a[208:211], v[60:63], v[144:147]
v_mfma_f32_16x16x32_bf16 v[84:87], a[212:215], v[52:55], v[84:87]
v_mfma_f32_16x16x32_bf16 v[116:119], a[212:215], v[56:59], v[116:119]
buffer_load_dwordx4 v40, s[20:23], s73 offen offset:2048 lds
v_mfma_f32_16x16x32_bf16 v[148:151], a[212:215], v[60:63], v[148:151]
v_mfma_f32_16x16x32_bf16 v[88:91], a[216:219], v[52:55], v[88:91]
v_mfma_f32_16x16x32_bf16 v[120:123], a[216:219], v[56:59], v[120:123]
buffer_load_dwordx4 v41, s[20:23], s73 offen offset:3072 lds
v_mfma_f32_16x16x32_bf16 v[152:155], a[216:219], v[60:63], v[152:155]
s_add_u32 m0, s56, 49408
v_mfma_f32_16x16x32_bf16 v[92:95], a[220:223], v[52:55], v[92:95]
ds_read_b128 v[52:55], v18
v_mfma_f32_16x16x32_bf16 v[124:127], a[220:223], v[56:59], v[124:127]
buffer_load_dwordx4 v2, s[16:19], s74 offen lds
ds_read_b128 v[56:59], v18 offset:1024
v_mfma_f32_16x16x32_bf16 v[156:159], a[220:223], v[60:63], v[156:159]
ds_read_b128 v[60:63], v18 offset:2048
v_mfma_f32_16x16x32_bf16 v[160:163], a[192:195], a[224:227], v[160:163]
v_mfma_f32_16x16x32_bf16 v[192:195], a[192:195], a[228:231], v[192:195]
buffer_load_dwordx4 v3, s[16:19], s74 offen offset:1024 lds
v_mfma_f32_16x16x32_bf16 v[224:227], a[192:195], a[232:235], v[224:227]
ds_read_b64_tr_b16 a[192:193], v15
v_mfma_f32_16x16x32_bf16 v[164:167], a[196:199], a[224:227], v[164:167]
ds_read_b64_tr_b16 a[194:195], v15 offset:1024
v_mfma_f32_16x16x32_bf16 v[196:199], a[196:199], a[228:231], v[196:199]
buffer_load_dwordx4 v4, s[16:19], s74 offen offset:2048 lds
v_mfma_f32_16x16x32_bf16 v[228:231], a[196:199], a[232:235], v[228:231]
s_add_u32 s75, s75, 8192
ds_read_b64_tr_b16 a[196:197], v16
v_mfma_f32_16x16x32_bf16 v[168:171], a[200:203], a[224:227], v[168:171]
s_and_b32 s75, s75, 131071
ds_read_b64_tr_b16 a[198:199], v16 offset:1024
v_mfma_f32_16x16x32_bf16 v[200:203], a[200:203], a[228:231], v[200:203]
s_add_u32 m0, s77, 0
v_mfma_f32_16x16x32_bf16 v[232:235], a[200:203], a[232:235], v[232:235]
buffer_load_dwordx4 v6, s[24:27], s75 offen nt lds
ds_read_b64_tr_b16 a[200:201], v15 offset:64
v_mfma_f32_16x16x32_bf16 v[172:175], a[204:207], a[224:227], v[172:175]
ds_read_b64_tr_b16 a[202:203], v15 offset:1088
v_mfma_f32_16x16x32_bf16 v[204:207], a[204:207], a[228:231], v[204:207]
v_mfma_f32_16x16x32_bf16 v[236:239], a[204:207], a[232:235], v[236:239]
buffer_load_dwordx4 v7, s[24:27], s75 offen offset:1024 nt lds
ds_read_b64_tr_b16 a[204:205], v16 offset:64
v_mfma_f32_16x16x32_bf16 v[176:179], a[208:211], a[224:227], v[176:179]
ds_read_b64_tr_b16 a[206:207], v16 offset:1088
v_mfma_f32_16x16x32_bf16 v[208:211], a[208:211], a[228:231], v[208:211]
v_mfma_f32_16x16x32_bf16 v[240:243], a[208:211], a[232:235], v[240:243]
buffer_load_dwordx4 v8, s[24:27], s75 offen offset:2048 nt lds
ds_read_b64_tr_b16 a[208:209], v15 offset:128
v_mfma_f32_16x16x32_bf16 v[180:183], a[212:215], a[224:227], v[180:183]
ds_read_b64_tr_b16 a[210:211], v15 offset:1152
v_mfma_f32_16x16x32_bf16 v[212:215], a[212:215], a[228:231], v[212:215]
v_mfma_f32_16x16x32_bf16 v[244:247], a[212:215], a[232:235], v[244:247]
buffer_load_dwordx4 v9, s[24:27], s75 offen offset:3072 nt lds
ds_read_b64_tr_b16 a[212:213], v16 offset:128
v_mfma_f32_16x16x32_bf16 v[184:187], a[216:219], a[224:227], v[184:187]
ds_read_b64_tr_b16 a[214:215], v16 offset:1152
v_mfma_f32_16x16x32_bf16 v[216:219], a[216:219], a[228:231], v[216:219]
v_mfma_f32_16x16x32_bf16 v[248:251], a[216:219], a[232:235], v[248:251]
ds_read_b64_tr_b16 a[216:217], v15 offset:192
v_mfma_f32_16x16x32_bf16 v[188:191], a[220:223], a[224:227], v[188:191]
ds_read_b64_tr_b16 a[218:219], v15 offset:1216
v_mfma_f32_16x16x32_bf16 v[220:223], a[220:223], a[228:231], v[220:223]
v_mfma_f32_16x16x32_bf16 v[252:255], a[220:223], a[232:235], v[252:255]
ds_read_b64_tr_b16 a[220:221], v16 offset:192
s_waitcnt lgkmcnt(5)
v_mfma_f32_16x16x32_bf16 v[64:67], a[192:195], v[52:55], v[64:67]
ds_read_b64_tr_b16 a[222:223], v16 offset:1216
v_mfma_f32_16x16x32_bf16 v[96:99], a[192:195], v[56:59], v[96:99]
ds_read_b128 a[224:227], v18 offset:3072
v_mfma_f32_16x16x32_bf16 v[128:131], a[192:195], v[60:63], v[128:131]
ds_read_b128 a[228:231], v18 offset:4096
v_mfma_f32_16x16x32_bf16 v[68:71], a[196:199], v[52:55], v[68:71]
ds_read_b128 a[232:235], v18 offset:5120
v_mfma_f32_16x16x32_bf16 v[100:103], a[196:199], v[56:59], v[100:103]
s_add_u32 s73, s73, 262144
v_mfma_f32_16x16x32_bf16 v[132:135], a[196:199], v[60:63], v[132:135]
s_add_u32 s74, s74, 64
v_mfma_f32_16x16x32_bf16 v[72:75], a[200:203], v[52:55], v[72:75]
s_and_b32 s73, s73, 4194303
v_mfma_f32_16x16x32_bf16 v[104:107], a[200:203], v[56:59], v[104:107]
s_and_b32 s74, s74, 1023
v_mfma_f32_16x16x32_bf16 v[136:139], a[200:203], v[60:63], v[136:139]
s_waitcnt vmcnt(11) lgkmcnt(0)
s_barrier
v_mfma_f32_16x16x32_bf16 v[76:79], a[204:207], v[52:55], v[76:79]
s_add_u32 m0, s57, 98304
v_mfma_f32_16x16x32_bf16 v[108:111], a[204:207], v[56:59], v[108:111]
buffer_load_dwordx4 v5, s[20:23], s73 offen lds
v_mfma_f32_16x16x32_bf16 v[140:143], a[204:207], v[60:63], v[140:143]
v_mfma_f32_16x16x32_bf16 v[80:83], a[208:211], v[52:55], v[80:83]
v_mfma_f32_16x16x32_bf16 v[112:115], a[208:211], v[56:59], v[112:115]
v_mfma_f32_16x16x32_bf16 v[144:147], a[208:211], v[60:63], v[144:147]
v_mfma_f32_16x16x32_bf16 v[84:87], a[212:215], v[52:55], v[84:87]
v_mfma_f32_16x16x32_bf16 v[116:119], a[212:215], v[56:59], v[116:119]
buffer_load_dwordx4 v39, s[20:23], s73 offen offset:1024 lds
v_mfma_f32_16x16x32_bf16 v[148:151], a[212:215], v[60:63], v[148:151]
v_mfma_f32_16x16x32_bf16 v[88:91], a[216:219], v[52:55], v[88:91]
v_mfma_f32_16x16x32_bf16 v[120:123], a[216:219], v[56:59], v[120:123]
v_mfma_f32_16x16x32_bf16 v[152:155], a[216:219], v[60:63], v[152:155]
v_mfma_f32_16x16x32_bf16 v[92:95], a[220:223], v[52:55], v[92:95]
ds_read_b128 v[52:55], v18 offset:32768
v_mfma_f32_16x16x32_bf16 v[124:127], a[220:223], v[56:59], v[124:127]
buffer_load_dwordx4 v40, s[20:23], s73 offen offset:2048 lds
ds_read_b128 v[56:59], v18 offset:33792
v_mfma_f32_16x16x32_bf16 v[156:159], a[220:223], v[60:63], v[156:159]
ds_read_b128 v[60:63], v18 offset:34816
v_mfma_f32_16x16x32_bf16 v[160:163], a[192:195], a[224:227], v[160:163]
v_mfma_f32_16x16x32_bf16 v[192:195], a[192:195], a[228:231], v[192:195]
v_mfma_f32_16x16x32_bf16 v[224:227], a[192:195], a[232:235], v[224:227]
ds_read_b64_tr_b16 a[192:193], v11
v_mfma_f32_16x16x32_bf16 v[164:167], a[196:199], a[224:227], v[164:167]
ds_read_b64_tr_b16 a[194:195], v11 offset:1024
v_mfma_f32_16x16x32_bf16 v[196:199], a[196:199], a[228:231], v[196:199]
buffer_load_dwordx4 v41, s[20:23], s73 offen offset:3072 lds
v_mfma_f32_16x16x32_bf16 v[228:231], a[196:199], a[232:235], v[228:231]
s_add_u32 m0, s56, 114944
ds_read_b64_tr_b16 a[196:197], v12
v_mfma_f32_16x16x32_bf16 v[168:171], a[200:203], a[224:227], v[168:171]
ds_read_b64_tr_b16 a[198:199], v12 offset:1024
v_mfma_f32_16x16x32_bf16 v[200:203], a[200:203], a[228:231], v[200:203]
v_mfma_f32_16x16x32_bf16 v[232:235], a[200:203], a[232:235], v[232:235]
ds_read_b64_tr_b16 a[200:201], v11 offset:64
v_mfma_f32_16x16x32_bf16 v[172:175], a[204:207], a[224:227], v[172:175]
ds_read_b64_tr_b16 a[202:203], v11 offset:1088
v_mfma_f32_16x16x32_bf16 v[204:207], a[204:207], a[228:231], v[204:207]
buffer_load_dwordx4 v2, s[16:19], s74 offen lds
v_mfma_f32_16x16x32_bf16 v[236:239], a[204:207], a[232:235], v[236:239]
ds_read_b64_tr_b16 a[204:205], v12 offset:64
v_mfma_f32_16x16x32_bf16 v[176:179], a[208:211], a[224:227], v[176:179]
ds_read_b64_tr_b16 a[206:207], v12 offset:1088
v_mfma_f32_16x16x32_bf16 v[208:211], a[208:211], a[228:231], v[208:211]
v_mfma_f32_16x16x32_bf16 v[240:243], a[208:211], a[232:235], v[240:243]
ds_read_b64_tr_b16 a[208:209], v11 offset:128
v_mfma_f32_16x16x32_bf16 v[180:183], a[212:215], a[224:227], v[180:183]
ds_read_b64_tr_b16 a[210:211], v11 offset:1152
v_mfma_f32_16x16x32_bf16 v[212:215], a[212:215], a[228:231], v[212:215]
buffer_load_dwordx4 v3, s[16:19], s74 offen offset:1024 lds
v_mfma_f32_16x16x32_bf16 v[244:247], a[212:215], a[232:235], v[244:247]
ds_read_b64_tr_b16 a[212:213], v12 offset:128
v_mfma_f32_16x16x32_bf16 v[184:187], a[216:219], a[224:227], v[184:187]
ds_read_b64_tr_b16 a[214:215], v12 offset:1152
v_mfma_f32_16x16x32_bf16 v[216:219], a[216:219], a[228:231], v[216:219]
v_mfma_f32_16x16x32_bf16 v[248:251], a[216:219], a[232:235], v[248:251]
ds_read_b64_tr_b16 a[216:217], v11 offset:192
v_mfma_f32_16x16x32_bf16 v[188:191], a[220:223], a[224:227], v[188:191]
ds_read_b64_tr_b16 a[218:219], v11 offset:1216
v_mfma_f32_16x16x32_bf16 v[220:223], a[220:223], a[228:231], v[220:223]
buffer_load_dwordx4 v4, s[16:19], s74 offen offset:2048 lds
v_mfma_f32_16x16x32_bf16 v[252:255], a[220:223], a[232:235], v[252:255]
ds_read_b64_tr_b16 a[220:221], v12 offset:192
s_waitcnt lgkmcnt(5)
v_mfma_f32_16x16x32_bf16 v[64:67], a[192:195], v[52:55], v[64:67]
ds_read_b64_tr_b16 a[222:223], v12 offset:1216
v_mfma_f32_16x16x32_bf16 v[96:99], a[192:195], v[56:59], v[96:99]
ds_read_b128 a[224:227], v18 offset:35840
v_mfma_f32_16x16x32_bf16 v[128:131], a[192:195], v[60:63], v[128:131]
ds_read_b128 a[228:231], v18 offset:36864
v_mfma_f32_16x16x32_bf16 v[68:71], a[196:199], v[52:55], v[68:71]
ds_read_b128 a[232:235], v18 offset:37888
v_mfma_f32_16x16x32_bf16 v[100:103], a[196:199], v[56:59], v[100:103]
s_add_u32 s73, s73, 262144
v_mfma_f32_16x16x32_bf16 v[132:135], a[196:199], v[60:63], v[132:135]
s_add_u32 s74, s74, 64
v_mfma_f32_16x16x32_bf16 v[72:75], a[200:203], v[52:55], v[72:75]
s_and_b32 s73, s73, 4194303
v_mfma_f32_16x16x32_bf16 v[104:107], a[200:203], v[56:59], v[104:107]
s_and_b32 s74, s74, 1023
v_mfma_f32_16x16x32_bf16 v[136:139], a[200:203], v[60:63], v[136:139]
s_waitcnt vmcnt(11) lgkmcnt(0)
s_barrier
v_mfma_f32_16x16x32_bf16 v[76:79], a[204:207], v[52:55], v[76:79]
s_add_u32 m0, s57, 131072
v_mfma_f32_16x16x32_bf16 v[108:111], a[204:207], v[56:59], v[108:111]
buffer_load_dwordx4 v5, s[20:23], s73 offen lds
v_mfma_f32_16x16x32_bf16 v[140:143], a[204:207], v[60:63], v[140:143]
v_mfma_f32_16x16x32_bf16 v[80:83], a[208:211], v[52:55], v[80:83]
v_mfma_f32_16x16x32_bf16 v[112:115], a[208:211], v[56:59], v[112:115]
buffer_load_dwordx4 v39, s[20:23], s73 offen offset:1024 lds
v_mfma_f32_16x16x32_bf16 v[144:147], a[208:211], v[60:63], v[144:147]
v_mfma_f32_16x16x32_bf16 v[84:87], a[212:215], v[52:55], v[84:87]
v_mfma_f32_16x16x32_bf16 v[116:119], a[212:215], v[56:59], v[116:119]
buffer_load_dwordx4 v40, s[20:23], s73 offen offset:2048 lds
v_mfma_f32_16x16x32_bf16 v[148:151], a[212:215], v[60:63], v[148:151]
v_mfma_f32_16x16x32_bf16 v[88:91], a[216:219], v[52:55], v[88:91]
v_mfma_f32_16x16x32_bf16 v[120:123], a[216:219], v[56:59], v[120:123]
buffer_load_dwordx4 v41, s[20:23], s73 offen offset:3072 lds
v_mfma_f32_16x16x32_bf16 v[152:155], a[216:219], v[60:63], v[152:155]
s_add_u32 m0, s56, 147712
v_mfma_f32_16x16x32_bf16 v[92:95], a[220:223], v[52:55], v[92:95]
ds_read_b128 v[52:55], v17
v_mfma_f32_16x16x32_bf16 v[124:127], a[220:223], v[56:59], v[124:127]
buffer_load_dwordx4 v2, s[16:19], s74 offen lds
ds_read_b128 v[56:59], v17 offset:1024
v_mfma_f32_16x16x32_bf16 v[156:159], a[220:223], v[60:63], v[156:159]
ds_read_b128 v[60:63], v17 offset:2048
v_mfma_f32_16x16x32_bf16 v[160:163], a[192:195], a[224:227], v[160:163]
v_mfma_f32_16x16x32_bf16 v[192:195], a[192:195], a[228:231], v[192:195]
buffer_load_dwordx4 v3, s[16:19], s74 offen offset:1024 lds
v_mfma_f32_16x16x32_bf16 v[224:227], a[192:195], a[232:235], v[224:227]
ds_read_b64_tr_b16 a[192:193], v13
v_mfma_f32_16x16x32_bf16 v[164:167], a[196:199], a[224:227], v[164:167]
ds_read_b64_tr_b16 a[194:195], v13 offset:1024
v_mfma_f32_16x16x32_bf16 v[196:199], a[196:199], a[228:231], v[196:199]
buffer_load_dwordx4 v4, s[16:19], s74 offen offset:2048 lds
v_mfma_f32_16x16x32_bf16 v[228:231], a[196:199], a[232:235], v[228:231]
s_add_u32 s76, s76, 8192
ds_read_b64_tr_b16 a[196:197], v14
v_mfma_f32_16x16x32_bf16 v[168:171], a[200:203], a[224:227], v[168:171]
s_and_b32 s76, s76, 131071
ds_read_b64_tr_b16 a[198:199], v14 offset:1024
v_mfma_f32_16x16x32_bf16 v[200:203], a[200:203], a[228:231], v[200:203]
s_add_u32 m0, s77, 65536
v_mfma_f32_16x16x32_bf16 v[232:235], a[200:203], a[232:235], v[232:235]
buffer_load_dwordx4 v10, s[28:31], s76 offen nt lds
ds_read_b64_tr_b16 a[200:201], v13 offset:64
v_mfma_f32_16x16x32_bf16 v[172:175], a[204:207], a[224:227], v[172:175]
ds_read_b64_tr_b16 a[202:203], v13 offset:1088
v_mfma_f32_16x16x32_bf16 v[204:207], a[204:207], a[228:231], v[204:207]
v_mfma_f32_16x16x32_bf16 v[236:239], a[204:207], a[232:235], v[236:239]
buffer_load_dwordx4 v19, s[28:31], s76 offen offset:1024 nt lds
ds_read_b64_tr_b16 a[204:205], v14 offset:64
v_mfma_f32_16x16x32_bf16 v[176:179], a[208:211], a[224:227], v[176:179]
ds_read_b64_tr_b16 a[206:207], v14 offset:1088
v_mfma_f32_16x16x32_bf16 v[208:211], a[208:211], a[228:231], v[208:211]
v_mfma_f32_16x16x32_bf16 v[240:243], a[208:211], a[232:235], v[240:243]
buffer_load_dwordx4 v10, s[28:31], s76 offen offset:2048 nt lds
ds_read_b64_tr_b16 a[208:209], v13 offset:128
v_mfma_f32_16x16x32_bf16 v[180:183], a[212:215], a[224:227], v[180:183]
ds_read_b64_tr_b16 a[210:211], v13 offset:1152
v_mfma_f32_16x16x32_bf16 v[212:215], a[212:215], a[228:231], v[212:215]
v_mfma_f32_16x16x32_bf16 v[244:247], a[212:215], a[232:235], v[244:247]
buffer_load_dwordx4 v19, s[28:31], s76 offen offset:3072 nt lds
ds_read_b64_tr_b16 a[212:213], v14 offset:128
v_mfma_f32_16x16x32_bf16 v[184:187], a[216:219], a[224:227], v[184:187]
ds_read_b64_tr_b16 a[214:215], v14 offset:1152
v_mfma_f32_16x16x32_bf16 v[216:219], a[216:219], a[228:231], v[216:219]
v_mfma_f32_16x16x32_bf16 v[248:251], a[216:219], a[232:235], v[248:251]
ds_read_b64_tr_b16 a[216:217], v13 offset:192
v_mfma_f32_16x16x32_bf16 v[188:191], a[220:223], a[224:227], v[188:191]
ds_read_b64_tr_b16 a[218:219], v13 offset:1216
v_mfma_f32_16x16x32_bf16 v[220:223], a[220:223], a[228:231], v[220:223]
v_mfma_f32_16x16x32_bf16 v[252:255], a[220:223], a[232:235], v[252:255]
ds_read_b64_tr_b16 a[220:221], v14 offset:192
s_waitcnt lgkmcnt(5)
v_mfma_f32_16x16x32_bf16 v[64:67], a[192:195], v[52:55], v[64:67]
ds_read_b64_tr_b16 a[222:223], v14 offset:1216
v_mfma_f32_16x16x32_bf16 v[96:99], a[192:195], v[56:59], v[96:99]
ds_read_b128 a[224:227], v17 offset:3072
v_mfma_f32_16x16x32_bf16 v[128:131], a[192:195], v[60:63], v[128:131]
ds_read_b128 a[228:231], v17 offset:4096
v_mfma_f32_16x16x32_bf16 v[68:71], a[196:199], v[52:55], v[68:71]
ds_read_b128 a[232:235], v17 offset:5120
v_mfma_f32_16x16x32_bf16 v[100:103], a[196:199], v[56:59], v[100:103]
s_add_u32 s73, s73, 262144
v_mfma_f32_16x16x32_bf16 v[132:135], a[196:199], v[60:63], v[132:135]
s_add_u32 s74, s74, 64
v_mfma_f32_16x16x32_bf16 v[72:75], a[200:203], v[52:55], v[72:75]
s_and_b32 s73, s73, 4194303
v_mfma_f32_16x16x32_bf16 v[104:107], a[200:203], v[56:59], v[104:107]
s_and_b32 s74, s74, 1023
v_mfma_f32_16x16x32_bf16 v[136:139], a[200:203], v[60:63], v[136:139]
s_waitcnt vmcnt(11) lgkmcnt(0)
s_barrier
v_mfma_f32_16x16x32_bf16 v[76:79], a[204:207], v[52:55], v[76:79]
s_add_u32 m0, s57, 32768
v_mfma_f32_16x16x32_bf16 v[108:111], a[204:207], v[56:59], v[108:111]
buffer_load_dwordx4 v5, s[20:23], s73 offen lds
v_mfma_f32_16x16x32_bf16 v[140:143], a[204:207], v[60:63], v[140:143]
v_mfma_f32_16x16x32_bf16 v[80:83], a[208:211], v[52:55], v[80:83]
v_mfma_f32_16x16x32_bf16 v[112:115], a[208:211], v[56:59], v[112:115]
v_mfma_f32_16x16x32_bf16 v[144:147], a[208:211], v[60:63], v[144:147]
v_mfma_f32_16x16x32_bf16 v[84:87], a[212:215], v[52:55], v[84:87]
v_mfma_f32_16x16x32_bf16 v[116:119], a[212:215], v[56:59], v[116:119]
buffer_load_dwordx4 v39, s[20:23], s73 offen offset:1024 lds
v_mfma_f32_16x16x32_bf16 v[148:151], a[212:215], v[60:63], v[148:151]
v_mfma_f32_16x16x32_bf16 v[88:91], a[216:219], v[52:55], v[88:91]
v_mfma_f32_16x16x32_bf16 v[120:123], a[216:219], v[56:59], v[120:123]
v_mfma_f32_16x16x32_bf16 v[152:155], a[216:219], v[60:63], v[152:155]
v_mfma_f32_16x16x32_bf16 v[92:95], a[220:223], v[52:55], v[92:95]
ds_read_b128 v[52:55], v18
v_mfma_f32_16x16x32_bf16 v[124:127], a[220:223], v[56:59], v[124:127]
buffer_load_dwordx4 v40, s[20:23], s73 offen offset:2048 lds
ds_read_b128 v[56:59], v18 offset:1024
v_mfma_f32_16x16x32_bf16 v[156:159], a[220:223], v[60:63], v[156:159]
ds_read_b128 v[60:63], v18 offset:2048
v_mfma_f32_16x16x32_bf16 v[160:163], a[192:195], a[224:227], v[160:163]
v_mfma_f32_16x16x32_bf16 v[192:195], a[192:195], a[228:231], v[192:195]
v_mfma_f32_16x16x32_bf16 v[224:227], a[192:195], a[232:235], v[224:227]
ds_read_b64_tr_b16 a[192:193], v15
v_mfma_f32_16x16x32_bf16 v[164:167], a[196:199], a[224:227], v[164:167]
ds_read_b64_tr_b16 a[194:195], v15 offset:1024
v_mfma_f32_16x16x32_bf16 v[196:199], a[196:199], a[228:231], v[196:199]
buffer_load_dwordx4 v41, s[20:23], s73 offen offset:3072 lds
v_mfma_f32_16x16x32_bf16 v[228:231], a[196:199], a[232:235], v[228:231]
s_add_u32 m0, s56, 49408
ds_read_b64_tr_b16 a[196:197], v16
v_mfma_f32_16x16x32_bf16 v[168:171], a[200:203], a[224:227], v[168:171]
ds_read_b64_tr_b16 a[198:199], v16 offset:1024
v_mfma_f32_16x16x32_bf16 v[200:203], a[200:203], a[228:231], v[200:203]
v_mfma_f32_16x16x32_bf16 v[232:235], a[200:203], a[232:235], v[232:235]
ds_read_b64_tr_b16 a[200:201], v15 offset:64
v_mfma_f32_16x16x32_bf16 v[172:175], a[204:207], a[224:227], v[172:175]
ds_read_b64_tr_b16 a[202:203], v15 offset:1088
v_mfma_f32_16x16x32_bf16 v[204:207], a[204:207], a[228:231], v[204:207]
buffer_load_dwordx4 v2, s[16:19], s74 offen lds
v_mfma_f32_16x16x32_bf16 v[236:239], a[204:207], a[232:235], v[236:239]
ds_read_b64_tr_b16 a[204:205], v16 offset:64
v_mfma_f32_16x16x32_bf16 v[176:179], a[208:211], a[224:227], v[176:179]
ds_read_b64_tr_b16 a[206:207], v16 offset:1088
v_mfma_f32_16x16x32_bf16 v[208:211], a[208:211], a[228:231], v[208:211]
v_mfma_f32_16x16x32_bf16 v[240:243], a[208:211], a[232:235], v[240:243]
ds_read_b64_tr_b16 a[208:209], v15 offset:128
v_mfma_f32_16x16x32_bf16 v[180:183], a[212:215], a[224:227], v[180:183]
ds_read_b64_tr_b16 a[210:211], v15 offset:1152
v_mfma_f32_16x16x32_bf16 v[212:215], a[212:215], a[228:231], v[212:215]
buffer_load_dwordx4 v3, s[16:19], s74 offen offset:1024 lds
v_mfma_f32_16x16x32_bf16 v[244:247], a[212:215], a[232:235], v[244:247]
ds_read_b64_tr_b16 a[212:213], v16 offset:128
v_mfma_f32_16x16x32_bf16 v[184:187], a[216:219], a[224:227], v[184:187]
ds_read_b64_tr_b16 a[214:215], v16 offset:1152
v_mfma_f32_16x16x32_bf16 v[216:219], a[216:219], a[228:231], v[216:219]
v_mfma_f32_16x16x32_bf16 v[248:251], a[216:219], a[232:235], v[248:251]
ds_read_b64_tr_b16 a[216:217], v15 offset:192
v_mfma_f32_16x16x32_bf16 v[188:191], a[220:223], a[224:227], v[188:191]
ds_read_b64_tr_b16 a[218:219], v15 offset:1216
v_mfma_f32_16x16x32_bf16 v[220:223], a[220:223], a[228:231], v[220:223]
buffer_load_dwordx4 v4, s[16:19], s74 offen offset:2048 lds
v_mfma_f32_16x16x32_bf16 v[252:255], a[220:223], a[232:235], v[252:255]
ds_read_b64_tr_b16 a[220:221], v16 offset:192
s_waitcnt lgkmcnt(5)
v_mfma_f32_16x16x32_bf16 v[64:67], a[192:195], v[52:55], v[64:67]
ds_read_b64_tr_b16 a[222:223], v16 offset:1216
v_mfma_f32_16x16x32_bf16 v[96:99], a[192:195], v[56:59], v[96:99]
ds_read_b128 a[224:227], v18 offset:3072
v_mfma_f32_16x16x32_bf16 v[128:131], a[192:195], v[60:63], v[128:131]
ds_read_b128 a[228:231], v18 offset:4096
v_mfma_f32_16x16x32_bf16 v[68:71], a[196:199], v[52:55], v[68:71]
ds_read_b128 a[232:235], v18 offset:5120
v_mfma_f32_16x16x32_bf16 v[100:103], a[196:199], v[56:59], v[100:103]
s_add_u32 s73, s73, 262144
v_mfma_f32_16x16x32_bf16 v[132:135], a[196:199], v[60:63], v[132:135]
s_add_u32 s74, s74, 64
v_mfma_f32_16x16x32_bf16 v[72:75], a[200:203], v[52:55], v[72:75]
s_and_b32 s73, s73, 4194303
v_mfma_f32_16x16x32_bf16 v[104:107], a[200:203], v[56:59], v[104:107]
s_and_b32 s74, s74, 1023
v_mfma_f32_16x16x32_bf16 v[136:139], a[200:203], v[60:63], v[136:139]
s_waitcnt vmcnt(11) lgkmcnt(0)
s_barrier
v_mfma_f32_16x16x32_bf16 v[76:79], a[204:207], v[52:55], v[76:79]
s_add_u32 m0, s57, 98304
v_mfma_f32_16x16x32_bf16 v[108:111], a[204:207], v[56:59], v[108:111]
buffer_load_dwordx4 v5, s[20:23], s73 offen lds
v_mfma_f32_16x16x32_bf16 v[140:143], a[204:207], v[60:63], v[140:143]
v_mfma_f32_16x16x32_bf16 v[80:83], a[208:211], v[52:55], v[80:83]
v_mfma_f32_16x16x32_bf16 v[112:115], a[208:211], v[56:59], v[112:115]
buffer_load_dwordx4 v39, s[20:23], s73 offen offset:1024 lds
v_mfma_f32_16x16x32_bf16 v[144:147], a[208:211], v[60:63], v[144:147]
v_mfma_f32_16x16x32_bf16 v[84:87], a[212:215], v[52:55], v[84:87]
v_mfma_f32_16x16x32_bf16 v[116:119], a[212:215], v[56:59], v[116:119]
buffer_load_dwordx4 v40, s[20:23], s73 offen offset:2048 lds
v_mfma_f32_16x16x32_bf16 v[148:151], a[212:215], v[60:63], v[148:151]
v_mfma_f32_16x16x32_bf16 v[88:91], a[216:219], v[52:55], v[88:91]
v_mfma_f32_16x16x32_bf16 v[120:123], a[216:219], v[56:59], v[120:123]
buffer_load_dwordx4 v41, s[20:23], s73 offen offset:3072 lds
v_mfma_f32_16x16x32_bf16 v[152:155], a[216:219], v[60:63], v[152:155]
s_add_u32 m0, s56, 114944
v_mfma_f32_16x16x32_bf16 v[92:95], a[220:223], v[52:55], v[92:95]
ds_read_b128 v[52:55], v18 offset:32768
v_mfma_f32_16x16x32_bf16 v[124:127], a[220:223], v[56:59], v[124:127]
buffer_load_dwordx4 v2, s[16:19], s74 offen lds
ds_read_b128 v[56:59], v18 offset:33792
v_mfma_f32_16x16x32_bf16 v[156:159], a[220:223], v[60:63], v[156:159]
ds_read_b128 v[60:63], v18 offset:34816
v_mfma_f32_16x16x32_bf16 v[160:163], a[192:195], a[224:227], v[160:163]
v_mfma_f32_16x16x32_bf16 v[192:195], a[192:195], a[228:231], v[192:195]
buffer_load_dwordx4 v3, s[16:19], s74 offen offset:1024 lds
v_mfma_f32_16x16x32_bf16 v[224:227], a[192:195], a[232:235], v[224:227]
ds_read_b64_tr_b16 a[192:193], v11
v_mfma_f32_16x16x32_bf16 v[164:167], a[196:199], a[224:227], v[164:167]
ds_read_b64_tr_b16 a[194:195], v11 offset:1024
v_mfma_f32_16x16x32_bf16 v[196:199], a[196:199], a[228:231], v[196:199]
buffer_load_dwordx4 v4, s[16:19], s74 offen offset:2048 lds
v_mfma_f32_16x16x32_bf16 v[228:231], a[196:199], a[232:235], v[228:231]
s_add_u32 s75, s75, 8192
ds_read_b64_tr_b16 a[196:197], v12
v_mfma_f32_16x16x32_bf16 v[168:171], a[200:203], a[224:227], v[168:171]
s_and_b32 s75, s75, 131071
ds_read_b64_tr_b16 a[198:199], v12 offset:1024
v_mfma_f32_16x16x32_bf16 v[200:203], a[200:203], a[228:231], v[200:203]
s_add_u32 m0, s77, 16384
v_mfma_f32_16x16x32_bf16 v[232:235], a[200:203], a[232:235], v[232:235]
buffer_load_dwordx4 v6, s[24:27], s75 offen nt lds
ds_read_b64_tr_b16 a[200:201], v11 offset:64
v_mfma_f32_16x16x32_bf16 v[172:175], a[204:207], a[224:227], v[172:175]
ds_read_b64_tr_b16 a[202:203], v11 offset:1088
v_mfma_f32_16x16x32_bf16 v[204:207], a[204:207], a[228:231], v[204:207]
v_mfma_f32_16x16x32_bf16 v[236:239], a[204:207], a[232:235], v[236:239]
buffer_load_dwordx4 v7, s[24:27], s75 offen offset:1024 nt lds
ds_read_b64_tr_b16 a[204:205], v12 offset:64
v_mfma_f32_16x16x32_bf16 v[176:179], a[208:211], a[224:227], v[176:179]
ds_read_b64_tr_b16 a[206:207], v12 offset:1088
v_mfma_f32_16x16x32_bf16 v[208:211], a[208:211], a[228:231], v[208:211]
v_mfma_f32_16x16x32_bf16 v[240:243], a[208:211], a[232:235], v[240:243]
buffer_load_dwordx4 v8, s[24:27], s75 offen offset:2048 nt lds
ds_read_b64_tr_b16 a[208:209], v11 offset:128
v_mfma_f32_16x16x32_bf16 v[180:183], a[212:215], a[224:227], v[180:183]
ds_read_b64_tr_b16 a[210:211], v11 offset:1152
v_mfma_f32_16x16x32_bf16 v[212:215], a[212:215], a[228:231], v[212:215]
v_mfma_f32_16x16x32_bf16 v[244:247], a[212:215], a[232:235], v[244:247]
buffer_load_dwordx4 v9, s[24:27], s75 offen offset:3072 nt lds
ds_read_b64_tr_b16 a[212:213], v12 offset:128
v_mfma_f32_16x16x32_bf16 v[184:187], a[216:219], a[224:227], v[184:187]
ds_read_b64_tr_b16 a[214:215], v12 offset:1152
v_mfma_f32_16x16x32_bf16 v[216:219], a[216:219], a[228:231], v[216:219]
v_mfma_f32_16x16x32_bf16 v[248:251], a[216:219], a[232:235], v[248:251]
ds_read_b64_tr_b16 a[216:217], v11 offset:192
v_mfma_f32_16x16x32_bf16 v[188:191], a[220:223], a[224:227], v[188:191]
ds_read_b64_tr_b16 a[218:219], v11 offset:1216
v_mfma_f32_16x16x32_bf16 v[220:223], a[220:223], a[228:231], v[220:223]
v_mfma_f32_16x16x32_bf16 v[252:255], a[220:223], a[232:235], v[252:255]
ds_read_b64_tr_b16 a[220:221], v12 offset:192
s_waitcnt lgkmcnt(5)
v_mfma_f32_16x16x32_bf16 v[64:67], a[192:195], v[52:55], v[64:67]
ds_read_b64_tr_b16 a[222:223], v12 offset:1216
v_mfma_f32_16x16x32_bf16 v[96:99], a[192:195], v[56:59], v[96:99]
ds_read_b128 a[224:227], v18 offset:35840
v_mfma_f32_16x16x32_bf16 v[128:131], a[192:195], v[60:63], v[128:131]
ds_read_b128 a[228:231], v18 offset:36864
v_mfma_f32_16x16x32_bf16 v[68:71], a[196:199], v[52:55], v[68:71]
ds_read_b128 a[232:235], v18 offset:37888
v_mfma_f32_16x16x32_bf16 v[100:103], a[196:199], v[56:59], v[100:103]
s_add_u32 s73, s73, 262144
v_mfma_f32_16x16x32_bf16 v[132:135], a[196:199], v[60:63], v[132:135]
s_add_u32 s74, s74, 64
v_mfma_f32_16x16x32_bf16 v[72:75], a[200:203], v[52:55], v[72:75]
s_and_b32 s73, s73, 4194303
v_mfma_f32_16x16x32_bf16 v[104:107], a[200:203], v[56:59], v[104:107]
s_and_b32 s74, s74, 1023
v_mfma_f32_16x16x32_bf16 v[136:139], a[200:203], v[60:63], v[136:139]
s_waitcnt vmcnt(11) lgkmcnt(0)
s_barrier
v_mfma_f32_16x16x32_bf16 v[76:79], a[204:207], v[52:55], v[76:79]
s_add_u32 m0, s57, 131072
v_mfma_f32_16x16x32_bf16 v[108:111], a[204:207], v[56:59], v[108:111]
buffer_load_dwordx4 v5, s[20:23], s73 offen lds
v_mfma_f32_16x16x32_bf16 v[140:143], a[204:207], v[60:63], v[140:143]
v_mfma_f32_16x16x32_bf16 v[80:83], a[208:211], v[52:55], v[80:83]
v_mfma_f32_16x16x32_bf16 v[112:115], a[208:211], v[56:59], v[112:115]
v_mfma_f32_16x16x32_bf16 v[144:147], a[208:211], v[60:63], v[144:147]
v_mfma_f32_16x16x32_bf16 v[84:87], a[212:215], v[52:55], v[84:87]
v_mfma_f32_16x16x32_bf16 v[116:119], a[212:215], v[56:59], v[116:119]
buffer_load_dwordx4 v39, s[20:23], s73 offen offset:1024 lds
v_mfma_f32_16x16x32_bf16 v[148:151], a[212:215], v[60:63], v[148:151]
v_mfma_f32_16x16x32_bf16 v[88:91], a[216:219], v[52:55], v[88:91]
v_mfma_f32_16x16x32_bf16 v[120:123], a[216:219], v[56:59], v[120:123]
v_mfma_f32_16x16x32_bf16 v[152:155], a[216:219], v[60:63], v[152:155]
v_mfma_f32_16x16x32_bf16 v[92:95], a[220:223], v[52:55], v[92:95]
ds_read_b128 v[52:55], v17
v_mfma_f32_16x16x32_bf16 v[124:127], a[220:223], v[56:59], v[124:127]
buffer_load_dwordx4 v40, s[20:23], s73 offen offset:2048 lds
ds_read_b128 v[56:59], v17 offset:1024
v_mfma_f32_16x16x32_bf16 v[156:159], a[220:223], v[60:63], v[156:159]
ds_read_b128 v[60:63], v17 offset:2048
v_mfma_f32_16x16x32_bf16 v[160:163], a[192:195], a[224:227], v[160:163]
v_mfma_f32_16x16x32_bf16 v[192:195], a[192:195], a[228:231], v[192:195]
v_mfma_f32_16x16x32_bf16 v[224:227], a[192:195], a[232:235], v[224:227]
ds_read_b64_tr_b16 a[192:193], v13
v_mfma_f32_16x16x32_bf16 v[164:167], a[196:199], a[224:227], v[164:167]
ds_read_b64_tr_b16 a[194:195], v13 offset:1024
v_mfma_f32_16x16x32_bf16 v[196:199], a[196:199], a[228:231], v[196:199]
buffer_load_dwordx4 v41, s[20:23], s73 offen offset:3072 lds
v_mfma_f32_16x16x32_bf16 v[228:231], a[196:199], a[232:235], v[228:231]
s_add_u32 m0, s56, 147712
ds_read_b64_tr_b16 a[196:197], v14
v_mfma_f32_16x16x32_bf16 v[168:171], a[200:203], a[224:227], v[168:171]
ds_read_b64_tr_b16 a[198:199], v14 offset:1024
v_mfma_f32_16x16x32_bf16 v[200:203], a[200:203], a[228:231], v[200:203]
v_mfma_f32_16x16x32_bf16 v[232:235], a[200:203], a[232:235], v[232:235]
ds_read_b64_tr_b16 a[200:201], v13 offset:64
v_mfma_f32_16x16x32_bf16 v[172:175], a[204:207], a[224:227], v[172:175]
ds_read_b64_tr_b16 a[202:203], v13 offset:1088
v_mfma_f32_16x16x32_bf16 v[204:207], a[204:207], a[228:231], v[204:207]
buffer_load_dwordx4 v2, s[16:19], s74 offen lds
v_mfma_f32_16x16x32_bf16 v[236:239], a[204:207], a[232:235], v[236:239]
ds_read_b64_tr_b16 a[204:205], v14 offset:64
v_mfma_f32_16x16x32_bf16 v[176:179], a[208:211], a[224:227], v[176:179]
ds_read_b64_tr_b16 a[206:207], v14 offset:1088
v_mfma_f32_16x16x32_bf16 v[208:211], a[208:211], a[228:231], v[208:211]
v_mfma_f32_16x16x32_bf16 v[240:243], a[208:211], a[232:235], v[240:243]
ds_read_b64_tr_b16 a[208:209], v13 offset:128
v_mfma_f32_16x16x32_bf16 v[180:183], a[212:215], a[224:227], v[180:183]
ds_read_b64_tr_b16 a[210:211], v13 offset:1152
v_mfma_f32_16x16x32_bf16 v[212:215], a[212:215], a[228:231], v[212:215]
buffer_load_dwordx4 v3, s[16:19], s74 offen offset:1024 lds
v_mfma_f32_16x16x32_bf16 v[244:247], a[212:215], a[232:235], v[244:247]
ds_read_b64_tr_b16 a[212:213], v14 offset:128
v_mfma_f32_16x16x32_bf16 v[184:187], a[216:219], a[224:227], v[184:187]
ds_read_b64_tr_b16 a[214:215], v14 offset:1152
v_mfma_f32_16x16x32_bf16 v[216:219], a[216:219], a[228:231], v[216:219]
v_mfma_f32_16x16x32_bf16 v[248:251], a[216:219], a[232:235], v[248:251]
ds_read_b64_tr_b16 a[216:217], v13 offset:192
v_mfma_f32_16x16x32_bf16 v[188:191], a[220:223], a[224:227], v[188:191]
ds_read_b64_tr_b16 a[218:219], v13 offset:1216
v_mfma_f32_16x16x32_bf16 v[220:223], a[220:223], a[228:231], v[220:223]
buffer_load_dwordx4 v4, s[16:19], s74 offen offset:2048 lds
v_mfma_f32_16x16x32_bf16 v[252:255], a[220:223], a[232:235], v[252:255]
ds_read_b64_tr_b16 a[220:221], v14 offset:192
s_waitcnt lgkmcnt(5)
v_mfma_f32_16x16x32_bf16 v[64:67], a[192:195], v[52:55], v[64:67]
ds_read_b64_tr_b16 a[222:223], v14 offset:1216
v_mfma_f32_16x16x32_bf16 v[96:99], a[192:195], v[56:59], v[96:99]
ds_read_b128 a[224:227], v17 offset:3072
v_mfma_f32_16x16x32_bf16 v[128:131], a[192:195], v[60:63], v[128:131]
ds_read_b128 a[228:231], v17 offset:4096
v_mfma_f32_16x16x32_bf16 v[68:71], a[196:199], v[52:55], v[68:71]
ds_read_b128 a[232:235], v17 offset:5120
v_mfma_f32_16x16x32_bf16 v[100:103], a[196:199], v[56:59], v[100:103]
s_add_u32 s73, s73, 262144
v_mfma_f32_16x16x32_bf16 v[132:135], a[196:199], v[60:63], v[132:135]
s_add_u32 s74, s74, 64
v_mfma_f32_16x16x32_bf16 v[72:75], a[200:203], v[52:55], v[72:75]
s_and_b32 s73, s73, 4194303
v_mfma_f32_16x16x32_bf16 v[104:107], a[200:203], v[56:59], v[104:107]
s_and_b32 s74, s74, 1023
v_mfma_f32_16x16x32_bf16 v[136:139], a[200:203], v[60:63], v[136:139]
s_waitcnt vmcnt(11) lgkmcnt(0)
s_barrier
v_mfma_f32_16x16x32_bf16 v[76:79], a[204:207], v[52:55], v[76:79]
s_add_u32 m0, s57, 32768
v_mfma_f32_16x16x32_bf16 v[108:111], a[204:207], v[56:59], v[108:111]
buffer_load_dwordx4 v5, s[20:23], s73 offen lds
v_mfma_f32_16x16x32_bf16 v[140:143], a[204:207], v[60:63], v[140:143]
v_mfma_f32_16x16x32_bf16 v[80:83], a[208:211], v[52:55], v[80:83]
v_mfma_f32_16x16x32_bf16 v[112:115], a[208:211], v[56:59], v[112:115]
buffer_load_dwordx4 v39, s[20:23], s73 offen offset:1024 lds
v_mfma_f32_16x16x32_bf16 v[144:147], a[208:211], v[60:63], v[144:147]
v_mfma_f32_16x16x32_bf16 v[84:87], a[212:215], v[52:55], v[84:87]
v_mfma_f32_16x16x32_bf16 v[116:119], a[212:215], v[56:59], v[116:119]
buffer_load_dwordx4 v40, s[20:23], s73 offen offset:2048 lds
v_mfma_f32_16x16x32_bf16 v[148:151], a[212:215], v[60:63], v[148:151]
v_mfma_f32_16x16x32_bf16 v[88:91], a[216:219], v[52:55], v[88:91]
v_mfma_f32_16x16x32_bf16 v[120:123], a[216:219], v[56:59], v[120:123]
buffer_load_dwordx4 v41, s[20:23], s73 offen offset:3072 lds
v_mfma_f32_16x16x32_bf16 v[152:155], a[216:219], v[60:63], v[152:155]
s_add_u32 m0, s56, 49408
v_mfma_f32_16x16x32_bf16 v[92:95], a[220:223], v[52:55], v[92:95]
ds_read_b128 v[52:55], v18
v_mfma_f32_16x16x32_bf16 v[124:127], a[220:223], v[56:59], v[124:127]
buffer_load_dwordx4 v2, s[16:19], s74 offen lds
ds_read_b128 v[56:59], v18 offset:1024
v_mfma_f32_16x16x32_bf16 v[156:159], a[220:223], v[60:63], v[156:159]
ds_read_b128 v[60:63], v18 offset:2048
v_mfma_f32_16x16x32_bf16 v[160:163], a[192:195], a[224:227], v[160:163]
v_mfma_f32_16x16x32_bf16 v[192:195], a[192:195], a[228:231], v[192:195]
buffer_load_dwordx4 v3, s[16:19], s74 offen offset:1024 lds
v_mfma_f32_16x16x32_bf16 v[224:227], a[192:195], a[232:235], v[224:227]
ds_read_b64_tr_b16 a[192:193], v15
v_mfma_f32_16x16x32_bf16 v[164:167], a[196:199], a[224:227], v[164:167]
ds_read_b64_tr_b16 a[194:195], v15 offset:1024
v_mfma_f32_16x16x32_bf16 v[196:199], a[196:199], a[228:231], v[196:199]
buffer_load_dwordx4 v4, s[16:19], s74 offen offset:2048 lds
v_mfma_f32_16x16x32_bf16 v[228:231], a[196:199], a[232:235], v[228:231]
s_add_u32 s76, s76, 8192
ds_read_b64_tr_b16 a[196:197], v16
v_mfma_f32_16x16x32_bf16 v[168:171], a[200:203], a[224:227], v[168:171]
s_and_b32 s76, s76, 131071
ds_read_b64_tr_b16 a[198:199], v16 offset:1024
v_mfma_f32_16x16x32_bf16 v[200:203], a[200:203], a[228:231], v[200:203]
s_add_u32 m0, s77, 81920
v_mfma_f32_16x16x32_bf16 v[232:235], a[200:203], a[232:235], v[232:235]
buffer_load_dwordx4 v10, s[28:31], s76 offen nt lds
ds_read_b64_tr_b16 a[200:201], v15 offset:64
v_mfma_f32_16x16x32_bf16 v[172:175], a[204:207], a[224:227], v[172:175]
ds_read_b64_tr_b16 a[202:203], v15 offset:1088
v_mfma_f32_16x16x32_bf16 v[204:207], a[204:207], a[228:231], v[204:207]
v_mfma_f32_16x16x32_bf16 v[236:239], a[204:207], a[232:235], v[236:239]
buffer_load_dwordx4 v19, s[28:31], s76 offen offset:1024 nt lds
ds_read_b64_tr_b16 a[204:205], v16 offset:64
v_mfma_f32_16x16x32_bf16 v[176:179], a[208:211], a[224:227], v[176:179]
ds_read_b64_tr_b16 a[206:207], v16 offset:1088
v_mfma_f32_16x16x32_bf16 v[208:211], a[208:211], a[228:231], v[208:211]
v_mfma_f32_16x16x32_bf16 v[240:243], a[208:211], a[232:235], v[240:243]
buffer_load_dwordx4 v10, s[28:31], s76 offen offset:2048 nt lds
ds_read_b64_tr_b16 a[208:209], v15 offset:128
v_mfma_f32_16x16x32_bf16 v[180:183], a[212:215], a[224:227], v[180:183]
ds_read_b64_tr_b16 a[210:211], v15 offset:1152
v_mfma_f32_16x16x32_bf16 v[212:215], a[212:215], a[228:231], v[212:215]
v_mfma_f32_16x16x32_bf16 v[244:247], a[212:215], a[232:235], v[244:247]
buffer_load_dwordx4 v19, s[28:31], s76 offen offset:3072 nt lds
ds_read_b64_tr_b16 a[212:213], v16 offset:128
v_mfma_f32_16x16x32_bf16 v[184:187], a[216:219], a[224:227], v[184:187]
ds_read_b64_tr_b16 a[214:215], v16 offset:1152
v_mfma_f32_16x16x32_bf16 v[216:219], a[216:219], a[228:231], v[216:219]
v_mfma_f32_16x16x32_bf16 v[248:251], a[216:219], a[232:235], v[248:251]
ds_read_b64_tr_b16 a[216:217], v15 offset:192
v_mfma_f32_16x16x32_bf16 v[188:191], a[220:223], a[224:227], v[188:191]
ds_read_b64_tr_b16 a[218:219], v15 offset:1216
v_mfma_f32_16x16x32_bf16 v[220:223], a[220:223], a[228:231], v[220:223]
v_mfma_f32_16x16x32_bf16 v[252:255], a[220:223], a[232:235], v[252:255]
ds_read_b64_tr_b16 a[220:221], v16 offset:192
s_waitcnt lgkmcnt(5)
v_mfma_f32_16x16x32_bf16 v[64:67], a[192:195], v[52:55], v[64:67]
ds_read_b64_tr_b16 a[222:223], v16 offset:1216
v_mfma_f32_16x16x32_bf16 v[96:99], a[192:195], v[56:59], v[96:99]
ds_read_b128 a[224:227], v18 offset:3072
v_mfma_f32_16x16x32_bf16 v[128:131], a[192:195], v[60:63], v[128:131]
ds_read_b128 a[228:231], v18 offset:4096
v_mfma_f32_16x16x32_bf16 v[68:71], a[196:199], v[52:55], v[68:71]
ds_read_b128 a[232:235], v18 offset:5120
v_mfma_f32_16x16x32_bf16 v[100:103], a[196:199], v[56:59], v[100:103]
s_add_u32 s73, s73, 262144
v_mfma_f32_16x16x32_bf16 v[132:135], a[196:199], v[60:63], v[132:135]
s_add_u32 s74, s74, 64
v_mfma_f32_16x16x32_bf16 v[72:75], a[200:203], v[52:55], v[72:75]
s_and_b32 s73, s73, 4194303
v_mfma_f32_16x16x32_bf16 v[104:107], a[200:203], v[56:59], v[104:107]
s_and_b32 s74, s74, 1023
v_mfma_f32_16x16x32_bf16 v[136:139], a[200:203], v[60:63], v[136:139]
s_waitcnt vmcnt(11) lgkmcnt(0)
s_barrier
v_mfma_f32_16x16x32_bf16 v[76:79], a[204:207], v[52:55], v[76:79]
s_add_u32 m0, s57, 98304
v_mfma_f32_16x16x32_bf16 v[108:111], a[204:207], v[56:59], v[108:111]
buffer_load_dwordx4 v5, s[20:23], s73 offen lds
v_mfma_f32_16x16x32_bf16 v[140:143], a[204:207], v[60:63], v[140:143]
v_mfma_f32_16x16x32_bf16 v[80:83], a[208:211], v[52:55], v[80:83]
v_mfma_f32_16x16x32_bf16 v[112:115], a[208:211], v[56:59], v[112:115]
v_mfma_f32_16x16x32_bf16 v[144:147], a[208:211], v[60:63], v[144:147]
v_mfma_f32_16x16x32_bf16 v[84:87], a[212:215], v[52:55], v[84:87]
v_mfma_f32_16x16x32_bf16 v[116:119], a[212:215], v[56:59], v[116:119]
buffer_load_dwordx4 v39, s[20:23], s73 offen offset:1024 lds
v_mfma_f32_16x16x32_bf16 v[148:151], a[212:215], v[60:63], v[148:151]
v_mfma_f32_16x16x32_bf16 v[88:91], a[216:219], v[52:55], v[88:91]
v_mfma_f32_16x16x32_bf16 v[120:123], a[216:219], v[56:59], v[120:123]
v_mfma_f32_16x16x32_bf16 v[152:155], a[216:219], v[60:63], v[152:155]
v_mfma_f32_16x16x32_bf16 v[92:95], a[220:223], v[52:55], v[92:95]
ds_read_b128 v[52:55], v18 offset:32768
v_mfma_f32_16x16x32_bf16 v[124:127], a[220:223], v[56:59], v[124:127]
buffer_load_dwordx4 v40, s[20:23], s73 offen offset:2048 lds
ds_read_b128 v[56:59], v18 offset:33792
v_mfma_f32_16x16x32_bf16 v[156:159], a[220:223], v[60:63], v[156:159]
ds_read_b128 v[60:63], v18 offset:34816
v_mfma_f32_16x16x32_bf16 v[160:163], a[192:195], a[224:227], v[160:163]
v_mfma_f32_16x16x32_bf16 v[192:195], a[192:195], a[228:231], v[192:195]
v_mfma_f32_16x16x32_bf16 v[224:227], a[192:195], a[232:235], v[224:227]
ds_read_b64_tr_b16 a[192:193], v11
v_mfma_f32_16x16x32_bf16 v[164:167], a[196:199], a[224:227], v[164:167]
ds_read_b64_tr_b16 a[194:195], v11 offset:1024
v_mfma_f32_16x16x32_bf16 v[196:199], a[196:199], a[228:231], v[196:199]
buffer_load_dwordx4 v41, s[20:23], s73 offen offset:3072 lds
v_mfma_f32_16x16x32_bf16 v[228:231], a[196:199], a[232:235], v[228:231]
s_add_u32 m0, s56, 114944
ds_read_b64_tr_b16 a[196:197], v12
v_mfma_f32_16x16x32_bf16 v[168:171], a[200:203], a[224:227], v[168:171]
ds_read_b64_tr_b16 a[198:199], v12 offset:1024
v_mfma_f32_16x16x32_bf16 v[200:203], a[200:203], a[228:231], v[200:203]
v_mfma_f32_16x16x32_bf16 v[232:235], a[200:203], a[232:235], v[232:235]
ds_read_b64_tr_b16 a[200:201], v11 offset:64
v_mfma_f32_16x16x32_bf16 v[172:175], a[204:207], a[224:227], v[172:175]
ds_read_b64_tr_b16 a[202:203], v11 offset:1088
v_mfma_f32_16x16x32_bf16 v[204:207], a[204:207], a[228:231], v[204:207]
buffer_load_dwordx4 v2, s[16:19], s74 offen lds
v_mfma_f32_16x16x32_bf16 v[236:239], a[204:207], a[232:235], v[236:239]
ds_read_b64_tr_b16 a[204:205], v12 offset:64
v_mfma_f32_16x16x32_bf16 v[176:179], a[208:211], a[224:227], v[176:179]
ds_read_b64_tr_b16 a[206:207], v12 offset:1088
v_mfma_f32_16x16x32_bf16 v[208:211], a[208:211], a[228:231], v[208:211]
v_mfma_f32_16x16x32_bf16 v[240:243], a[208:211], a[232:235], v[240:243]
ds_read_b64_tr_b16 a[208:209], v11 offset:128
v_mfma_f32_16x16x32_bf16 v[180:183], a[212:215], a[224:227], v[180:183]
ds_read_b64_tr_b16 a[210:211], v11 offset:1152
v_mfma_f32_16x16x32_bf16 v[212:215], a[212:215], a[228:231], v[212:215]
buffer_load_dwordx4 v3, s[16:19], s74 offen offset:1024 lds
v_mfma_f32_16x16x32_bf16 v[244:247], a[212:215], a[232:235], v[244:247]
ds_read_b64_tr_b16 a[212:213], v12 offset:128
v_mfma_f32_16x16x32_bf16 v[184:187], a[216:219], a[224:227], v[184:187]
ds_read_b64_tr_b16 a[214:215], v12 offset:1152
v_mfma_f32_16x16x32_bf16 v[216:219], a[216:219], a[228:231], v[216:219]
v_mfma_f32_16x16x32_bf16 v[248:251], a[216:219], a[232:235], v[248:251]
ds_read_b64_tr_b16 a[216:217], v11 offset:192
v_mfma_f32_16x16x32_bf16 v[188:191], a[220:223], a[224:227], v[188:191]
ds_read_b64_tr_b16 a[218:219], v11 offset:1216
v_mfma_f32_16x16x32_bf16 v[220:223], a[220:223], a[228:231], v[220:223]
buffer_load_dwordx4 v4, s[16:19], s74 offen offset:2048 lds
v_mfma_f32_16x16x32_bf16 v[252:255], a[220:223], a[232:235], v[252:255]
ds_read_b64_tr_b16 a[220:221], v12 offset:192
s_waitcnt lgkmcnt(5)
v_mfma_f32_16x16x32_bf16 v[64:67], a[192:195], v[52:55], v[64:67]
ds_read_b64_tr_b16 a[222:223], v12 offset:1216
v_mfma_f32_16x16x32_bf16 v[96:99], a[192:195], v[56:59], v[96:99]
ds_read_b128 a[224:227], v18 offset:35840
v_mfma_f32_16x16x32_bf16 v[128:131], a[192:195], v[60:63], v[128:131]
ds_read_b128 a[228:231], v18 offset:36864
v_mfma_f32_16x16x32_bf16 v[68:71], a[196:199], v[52:55], v[68:71]
ds_read_b128 a[232:235], v18 offset:37888
v_mfma_f32_16x16x32_bf16 v[100:103], a[196:199], v[56:59], v[100:103]
s_add_u32 s73, s73, 262144
v_mfma_f32_16x16x32_bf16 v[132:135], a[196:199], v[60:63], v[132:135]
s_add_u32 s74, s74, 64
v_mfma_f32_16x16x32_bf16 v[72:75], a[200:203], v[52:55], v[72:75]
s_and_b32 s73, s73, 4194303
v_mfma_f32_16x16x32_bf16 v[104:107], a[200:203], v[56:59], v[104:107]
s_and_b32 s74, s74, 1023
v_mfma_f32_16x16x32_bf16 v[136:139], a[200:203], v[60:63], v[136:139]
s_waitcnt vmcnt(11) lgkmcnt(0)
s_barrier
v_mfma_f32_16x16x32_bf16 v[76:79], a[204:207], v[52:55], v[76:79]
s_add_u32 m0, s57, 131072
v_mfma_f32_16x16x32_bf16 v[108:111], a[204:207], v[56:59], v[108:111]
buffer_load_dwordx4 v5, s[20:23], s73 offen lds
v_mfma_f32_16x16x32_bf16 v[140:143], a[204:207], v[60:63], v[140:143]
v_mfma_f32_16x16x32_bf16 v[80:83], a[208:211], v[52:55], v[80:83]
v_mfma_f32_16x16x32_bf16 v[112:115], a[208:211], v[56:59], v[112:115]
v_mfma_f32_16x16x32_bf16 v[144:147], a[208:211], v[60:63], v[144:147]
v_mfma_f32_16x16x32_bf16 v[84:87], a[212:215], v[52:55], v[84:87]
v_mfma_f32_16x16x32_bf16 v[116:119], a[212:215], v[56:59], v[116:119]
buffer_load_dwordx4 v39, s[20:23], s73 offen offset:1024 lds
v_mfma_f32_16x16x32_bf16 v[148:151], a[212:215], v[60:63], v[148:151]
v_mfma_f32_16x16x32_bf16 v[88:91], a[216:219], v[52:55], v[88:91]
v_mfma_f32_16x16x32_bf16 v[120:123], a[216:219], v[56:59], v[120:123]
v_mfma_f32_16x16x32_bf16 v[152:155], a[216:219], v[60:63], v[152:155]
v_mfma_f32_16x16x32_bf16 v[92:95], a[220:223], v[52:55], v[92:95]
ds_read_b128 v[52:55], v17
v_mfma_f32_16x16x32_bf16 v[124:127], a[220:223], v[56:59], v[124:127]
buffer_load_dwordx4 v40, s[20:23], s73 offen offset:2048 lds
ds_read_b128 v[56:59], v17 offset:1024
v_mfma_f32_16x16x32_bf16 v[156:159], a[220:223], v[60:63], v[156:159]
ds_read_b128 v[60:63], v17 offset:2048
v_mfma_f32_16x16x32_bf16 v[160:163], a[192:195], a[224:227], v[160:163]
v_mfma_f32_16x16x32_bf16 v[192:195], a[192:195], a[228:231], v[192:195]
v_mfma_f32_16x16x32_bf16 v[224:227], a[192:195], a[232:235], v[224:227]
ds_read_b64_tr_b16 a[192:193], v13
v_mfma_f32_16x16x32_bf16 v[164:167], a[196:199], a[224:227], v[164:167]
ds_read_b64_tr_b16 a[194:195], v13 offset:1024
v_mfma_f32_16x16x32_bf16 v[196:199], a[196:199], a[228:231], v[196:199]
buffer_load_dwordx4 v41, s[20:23], s73 offen offset:3072 lds
v_mfma_f32_16x16x32_bf16 v[228:231], a[196:199], a[232:235], v[228:231]
s_add_u32 m0, s56, 147712
ds_read_b64_tr_b16 a[196:197], v14
v_mfma_f32_16x16x32_bf16 v[168:171], a[200:203], a[224:227], v[168:171]
ds_read_b64_tr_b16 a[198:199], v14 offset:1024
v_mfma_f32_16x16x32_bf16 v[200:203], a[200:203], a[228:231], v[200:203]
v_mfma_f32_16x16x32_bf16 v[232:235], a[200:203], a[232:235], v[232:235]
ds_read_b64_tr_b16 a[200:201], v13 offset:64
v_mfma_f32_16x16x32_bf16 v[172:175], a[204:207], a[224:227], v[172:175]
ds_read_b64_tr_b16 a[202:203], v13 offset:1088
v_mfma_f32_16x16x32_bf16 v[204:207], a[204:207], a[228:231], v[204:207]
buffer_load_dwordx4 v2, s[16:19], s74 offen lds
v_mfma_f32_16x16x32_bf16 v[236:239], a[204:207], a[232:235], v[236:239]
ds_read_b64_tr_b16 a[204:205], v14 offset:64
v_mfma_f32_16x16x32_bf16 v[176:179], a[208:211], a[224:227], v[176:179]
ds_read_b64_tr_b16 a[206:207], v14 offset:1088
v_mfma_f32_16x16x32_bf16 v[208:211], a[208:211], a[228:231], v[208:211]
v_mfma_f32_16x16x32_bf16 v[240:243], a[208:211], a[232:235], v[240:243]
ds_read_b64_tr_b16 a[208:209], v13 offset:128
v_mfma_f32_16x16x32_bf16 v[180:183], a[212:215], a[224:227], v[180:183]
ds_read_b64_tr_b16 a[210:211], v13 offset:1152
v_mfma_f32_16x16x32_bf16 v[212:215], a[212:215], a[228:231], v[212:215]
buffer_load_dwordx4 v3, s[16:19], s74 offen offset:1024 lds
v_mfma_f32_16x16x32_bf16 v[244:247], a[212:215], a[232:235], v[244:247]
ds_read_b64_tr_b16 a[212:213], v14 offset:128
v_mfma_f32_16x16x32_bf16 v[184:187], a[216:219], a[224:227], v[184:187]
ds_read_b64_tr_b16 a[214:215], v14 offset:1152
v_mfma_f32_16x16x32_bf16 v[216:219], a[216:219], a[228:231], v[216:219]
v_mfma_f32_16x16x32_bf16 v[248:251], a[216:219], a[232:235], v[248:251]
ds_read_b64_tr_b16 a[216:217], v13 offset:192
v_mfma_f32_16x16x32_bf16 v[188:191], a[220:223], a[224:227], v[188:191]
ds_read_b64_tr_b16 a[218:219], v13 offset:1216
v_mfma_f32_16x16x32_bf16 v[220:223], a[220:223], a[228:231], v[220:223]
buffer_load_dwordx4 v4, s[16:19], s74 offen offset:2048 lds
v_mfma_f32_16x16x32_bf16 v[252:255], a[220:223], a[232:235], v[252:255]
ds_read_b64_tr_b16 a[220:221], v14 offset:192
s_waitcnt lgkmcnt(5)
v_mfma_f32_16x16x32_bf16 v[64:67], a[192:195], v[52:55], v[64:67]
ds_read_b64_tr_b16 a[222:223], v14 offset:1216
v_mfma_f32_16x16x32_bf16 v[96:99], a[192:195], v[56:59], v[96:99]
ds_read_b128 a[224:227], v17 offset:3072
v_mfma_f32_16x16x32_bf16 v[128:131], a[192:195], v[60:63], v[128:131]
ds_read_b128 a[228:231], v17 offset:4096
v_mfma_f32_16x16x32_bf16 v[68:71], a[196:199], v[52:55], v[68:71]
ds_read_b128 a[232:235], v17 offset:5120
v_mfma_f32_16x16x32_bf16 v[100:103], a[196:199], v[56:59], v[100:103]
s_add_u32 s73, s73, 262144
v_mfma_f32_16x16x32_bf16 v[132:135], a[196:199], v[60:63], v[132:135]
s_add_u32 s74, s74, 64
v_mfma_f32_16x16x32_bf16 v[72:75], a[200:203], v[52:55], v[72:75]
s_and_b32 s73, s73, 4194303
v_mfma_f32_16x16x32_bf16 v[104:107], a[200:203], v[56:59], v[104:107]
s_and_b32 s74, s74, 1023
v_mfma_f32_16x16x32_bf16 v[136:139], a[200:203], v[60:63], v[136:139]
s_waitcnt vmcnt(7) lgkmcnt(0)
s_barrier
v_mfma_f32_16x16x32_bf16 v[76:79], a[204:207], v[52:55], v[76:79]
s_add_u32 m0, s57, 32768
v_mfma_f32_16x16x32_bf16 v[108:111], a[204:207], v[56:59], v[108:111]
buffer_load_dwordx4 v5, s[20:23], s73 offen lds
v_mfma_f32_16x16x32_bf16 v[140:143], a[204:207], v[60:63], v[140:143]
v_mfma_f32_16x16x32_bf16 v[80:83], a[208:211], v[52:55], v[80:83]
v_mfma_f32_16x16x32_bf16 v[112:115], a[208:211], v[56:59], v[112:115]
v_mfma_f32_16x16x32_bf16 v[144:147], a[208:211], v[60:63], v[144:147]
v_mfma_f32_16x16x32_bf16 v[84:87], a[212:215], v[52:55], v[84:87]
v_mfma_f32_16x16x32_bf16 v[116:119], a[212:215], v[56:59], v[116:119]
buffer_load_dwordx4 v39, s[20:23], s73 offen offset:1024 lds
v_mfma_f32_16x16x32_bf16 v[148:151], a[212:215], v[60:63], v[148:151]
v_mfma_f32_16x16x32_bf16 v[88:91], a[216:219], v[52:55], v[88:91]
v_mfma_f32_16x16x32_bf16 v[120:123], a[216:219], v[56:59], v[120:123]
v_mfma_f32_16x16x32_bf16 v[152:155], a[216:219], v[60:63], v[152:155]
v_mfma_f32_16x16x32_bf16 v[92:95], a[220:223], v[52:55], v[92:95]
ds_read_b128 v[52:55], v18
v_mfma_f32_16x16x32_bf16 v[124:127], a[220:223], v[56:59], v[124:127]
buffer_load_dwordx4 v40, s[20:23], s73 offen offset:2048 lds
ds_read_b128 v[56:59], v18 offset:1024
v_mfma_f32_16x16x32_bf16 v[156:159], a[220:223], v[60:63], v[156:159]
ds_read_b128 v[60:63], v18 offset:2048
v_mfma_f32_16x16x32_bf16 v[160:163], a[192:195], a[224:227], v[160:163]
v_mfma_f32_16x16x32_bf16 v[192:195], a[192:195], a[228:231], v[192:195]
v_mfma_f32_16x16x32_bf16 v[224:227], a[192:195], a[232:235], v[224:227]
ds_read_b64_tr_b16 a[192:193], v15
v_mfma_f32_16x16x32_bf16 v[164:167], a[196:199], a[224:227], v[164:167]
ds_read_b64_tr_b16 a[194:195], v15 offset:1024
v_mfma_f32_16x16x32_bf16 v[196:199], a[196:199], a[228:231], v[196:199]
buffer_load_dwordx4 v41, s[20:23], s73 offen offset:3072 lds
v_mfma_f32_16x16x32_bf16 v[228:231], a[196:199], a[232:235], v[228:231]
s_add_u32 m0, s56, 49408
ds_read_b64_tr_b16 a[196:197], v16
v_mfma_f32_16x16x32_bf16 v[168:171], a[200:203], a[224:227], v[168:171]
ds_read_b64_tr_b16 a[198:199], v16 offset:1024
v_mfma_f32_16x16x32_bf16 v[200:203], a[200:203], a[228:231], v[200:203]
v_mfma_f32_16x16x32_bf16 v[232:235], a[200:203], a[232:235], v[232:235]
ds_read_b64_tr_b16 a[200:201], v15 offset:64
v_mfma_f32_16x16x32_bf16 v[172:175], a[204:207], a[224:227], v[172:175]
ds_read_b64_tr_b16 a[202:203], v15 offset:1088
v_mfma_f32_16x16x32_bf16 v[204:207], a[204:207], a[228:231], v[204:207]
buffer_load_dwordx4 v2, s[16:19], s74 offen lds
v_mfma_f32_16x16x32_bf16 v[236:239], a[204:207], a[232:235], v[236:239]
ds_read_b64_tr_b16 a[204:205], v16 offset:64
v_mfma_f32_16x16x32_bf16 v[176:179], a[208:211], a[224:227], v[176:179]
ds_read_b64_tr_b16 a[206:207], v16 offset:1088
v_mfma_f32_16x16x32_bf16 v[208:211], a[208:211], a[228:231], v[208:211]
v_mfma_f32_16x16x32_bf16 v[240:243], a[208:211], a[232:235], v[240:243]
ds_read_b64_tr_b16 a[208:209], v15 offset:128
v_mfma_f32_16x16x32_bf16 v[180:183], a[212:215], a[224:227], v[180:183]
ds_read_b64_tr_b16 a[210:211], v15 offset:1152
v_mfma_f32_16x16x32_bf16 v[212:215], a[212:215], a[228:231], v[212:215]
buffer_load_dwordx4 v3, s[16:19], s74 offen offset:1024 lds
v_mfma_f32_16x16x32_bf16 v[244:247], a[212:215], a[232:235], v[244:247]
ds_read_b64_tr_b16 a[212:213], v16 offset:128
v_mfma_f32_16x16x32_bf16 v[184:187], a[216:219], a[224:227], v[184:187]
ds_read_b64_tr_b16 a[214:215], v16 offset:1152
v_mfma_f32_16x16x32_bf16 v[216:219], a[216:219], a[228:231], v[216:219]
v_mfma_f32_16x16x32_bf16 v[248:251], a[216:219], a[232:235], v[248:251]
ds_read_b64_tr_b16 a[216:217], v15 offset:192
v_mfma_f32_16x16x32_bf16 v[188:191], a[220:223], a[224:227], v[188:191]
ds_read_b64_tr_b16 a[218:219], v15 offset:1216
v_mfma_f32_16x16x32_bf16 v[220:223], a[220:223], a[228:231], v[220:223]
buffer_load_dwordx4 v4, s[16:19], s74 offen offset:2048 lds
v_mfma_f32_16x16x32_bf16 v[252:255], a[220:223], a[232:235], v[252:255]
ds_read_b64_tr_b16 a[220:221], v16 offset:192
s_waitcnt lgkmcnt(5)
v_mfma_f32_16x16x32_bf16 v[64:67], a[192:195], v[52:55], v[64:67]
ds_read_b64_tr_b16 a[222:223], v16 offset:1216
v_mfma_f32_16x16x32_bf16 v[96:99], a[192:195], v[56:59], v[96:99]
ds_read_b128 a[224:227], v18 offset:3072
v_mfma_f32_16x16x32_bf16 v[128:131], a[192:195], v[60:63], v[128:131]
ds_read_b128 a[228:231], v18 offset:4096
v_mfma_f32_16x16x32_bf16 v[68:71], a[196:199], v[52:55], v[68:71]
ds_read_b128 a[232:235], v18 offset:5120
v_mfma_f32_16x16x32_bf16 v[100:103], a[196:199], v[56:59], v[100:103]
s_add_u32 s73, s73, 262144
v_mfma_f32_16x16x32_bf16 v[132:135], a[196:199], v[60:63], v[132:135]
s_add_u32 s74, s74, 64
v_mfma_f32_16x16x32_bf16 v[72:75], a[200:203], v[52:55], v[72:75]
s_and_b32 s73, s73, 4194303
v_mfma_f32_16x16x32_bf16 v[104:107], a[200:203], v[56:59], v[104:107]
s_and_b32 s74, s74, 1023
v_mfma_f32_16x16x32_bf16 v[136:139], a[200:203], v[60:63], v[136:139]
s_waitcnt vmcnt(7) lgkmcnt(0)
s_barrier
v_mfma_f32_16x16x32_bf16 v[76:79], a[204:207], v[52:55], v[76:79]
s_add_u32 m0, s57, 98304
v_mfma_f32_16x16x32_bf16 v[108:111], a[204:207], v[56:59], v[108:111]
buffer_load_dwordx4 v5, s[20:23], s73 offen lds
v_mfma_f32_16x16x32_bf16 v[140:143], a[204:207], v[60:63], v[140:143]
v_mfma_f32_16x16x32_bf16 v[80:83], a[208:211], v[52:55], v[80:83]
v_mfma_f32_16x16x32_bf16 v[112:115], a[208:211], v[56:59], v[112:115]
v_mfma_f32_16x16x32_bf16 v[144:147], a[208:211], v[60:63], v[144:147]
v_mfma_f32_16x16x32_bf16 v[84:87], a[212:215], v[52:55], v[84:87]
v_mfma_f32_16x16x32_bf16 v[116:119], a[212:215], v[56:59], v[116:119]
buffer_load_dwordx4 v39, s[20:23], s73 offen offset:1024 lds
v_mfma_f32_16x16x32_bf16 v[148:151], a[212:215], v[60:63], v[148:151]
v_mfma_f32_16x16x32_bf16 v[88:91], a[216:219], v[52:55], v[88:91]
v_mfma_f32_16x16x32_bf16 v[120:123], a[216:219], v[56:59], v[120:123]
v_mfma_f32_16x16x32_bf16 v[152:155], a[216:219], v[60:63], v[152:155]
v_mfma_f32_16x16x32_bf16 v[92:95], a[220:223], v[52:55], v[92:95]
ds_read_b128 v[52:55], v18 offset:32768
v_mfma_f32_16x16x32_bf16 v[124:127], a[220:223], v[56:59], v[124:127]
buffer_load_dwordx4 v40, s[20:23], s73 offen offset:2048 lds
ds_read_b128 v[56:59], v18 offset:33792
v_mfma_f32_16x16x32_bf16 v[156:159], a[220:223], v[60:63], v[156:159]
ds_read_b128 v[60:63], v18 offset:34816
v_mfma_f32_16x16x32_bf16 v[160:163], a[192:195], a[224:227], v[160:163]
v_mfma_f32_16x16x32_bf16 v[192:195], a[192:195], a[228:231], v[192:195]
v_mfma_f32_16x16x32_bf16 v[224:227], a[192:195], a[232:235], v[224:227]
ds_read_b64_tr_b16 a[192:193], v11
v_mfma_f32_16x16x32_bf16 v[164:167], a[196:199], a[224:227], v[164:167]
ds_read_b64_tr_b16 a[194:195], v11 offset:1024
v_mfma_f32_16x16x32_bf16 v[196:199], a[196:199], a[228:231], v[196:199]
buffer_load_dwordx4 v41, s[20:23], s73 offen offset:3072 lds
v_mfma_f32_16x16x32_bf16 v[228:231], a[196:199], a[232:235], v[228:231]
s_add_u32 m0, s56, 114944
ds_read_b64_tr_b16 a[196:197], v12
v_mfma_f32_16x16x32_bf16 v[168:171], a[200:203], a[224:227], v[168:171]
ds_read_b64_tr_b16 a[198:199], v12 offset:1024
v_mfma_f32_16x16x32_bf16 v[200:203], a[200:203], a[228:231], v[200:203]
v_mfma_f32_16x16x32_bf16 v[232:235], a[200:203], a[232:235], v[232:235]
ds_read_b64_tr_b16 a[200:201], v11 offset:64
v_mfma_f32_16x16x32_bf16 v[172:175], a[204:207], a[224:227], v[172:175]
ds_read_b64_tr_b16 a[202:203], v11 offset:1088
v_mfma_f32_16x16x32_bf16 v[204:207], a[204:207], a[228:231], v[204:207]
buffer_load_dwordx4 v2, s[16:19], s74 offen lds
v_mfma_f32_16x16x32_bf16 v[236:239], a[204:207], a[232:235], v[236:239]
ds_read_b64_tr_b16 a[204:205], v12 offset:64
v_mfma_f32_16x16x32_bf16 v[176:179], a[208:211], a[224:227], v[176:179]
ds_read_b64_tr_b16 a[206:207], v12 offset:1088
v_mfma_f32_16x16x32_bf16 v[208:211], a[208:211], a[228:231], v[208:211]
v_mfma_f32_16x16x32_bf16 v[240:243], a[208:211], a[232:235], v[240:243]
ds_read_b64_tr_b16 a[208:209], v11 offset:128
v_mfma_f32_16x16x32_bf16 v[180:183], a[212:215], a[224:227], v[180:183]
ds_read_b64_tr_b16 a[210:211], v11 offset:1152
v_mfma_f32_16x16x32_bf16 v[212:215], a[212:215], a[228:231], v[212:215]
buffer_load_dwordx4 v3, s[16:19], s74 offen offset:1024 lds
v_mfma_f32_16x16x32_bf16 v[244:247], a[212:215], a[232:235], v[244:247]
ds_read_b64_tr_b16 a[212:213], v12 offset:128
v_mfma_f32_16x16x32_bf16 v[184:187], a[216:219], a[224:227], v[184:187]
ds_read_b64_tr_b16 a[214:215], v12 offset:1152
v_mfma_f32_16x16x32_bf16 v[216:219], a[216:219], a[228:231], v[216:219]
v_mfma_f32_16x16x32_bf16 v[248:251], a[216:219], a[232:235], v[248:251]
ds_read_b64_tr_b16 a[216:217], v11 offset:192
v_mfma_f32_16x16x32_bf16 v[188:191], a[220:223], a[224:227], v[188:191]
ds_read_b64_tr_b16 a[218:219], v11 offset:1216
v_mfma_f32_16x16x32_bf16 v[220:223], a[220:223], a[228:231], v[220:223]
buffer_load_dwordx4 v4, s[16:19], s74 offen offset:2048 lds
v_mfma_f32_16x16x32_bf16 v[252:255], a[220:223], a[232:235], v[252:255]
ds_read_b64_tr_b16 a[220:221], v12 offset:192
s_waitcnt lgkmcnt(5)
v_mfma_f32_16x16x32_bf16 v[64:67], a[192:195], v[52:55], v[64:67]
ds_read_b64_tr_b16 a[222:223], v12 offset:1216
v_mfma_f32_16x16x32_bf16 v[96:99], a[192:195], v[56:59], v[96:99]
ds_read_b128 a[224:227], v18 offset:35840
v_mfma_f32_16x16x32_bf16 v[128:131], a[192:195], v[60:63], v[128:131]
ds_read_b128 a[228:231], v18 offset:36864
v_mfma_f32_16x16x32_bf16 v[68:71], a[196:199], v[52:55], v[68:71]
ds_read_b128 a[232:235], v18 offset:37888
v_mfma_f32_16x16x32_bf16 v[100:103], a[196:199], v[56:59], v[100:103]
s_add_u32 s73, s73, 262144
v_mfma_f32_16x16x32_bf16 v[132:135], a[196:199], v[60:63], v[132:135]
s_add_u32 s74, s74, 64
v_mfma_f32_16x16x32_bf16 v[72:75], a[200:203], v[52:55], v[72:75]
s_and_b32 s73, s73, 4194303
v_mfma_f32_16x16x32_bf16 v[104:107], a[200:203], v[56:59], v[104:107]
s_and_b32 s74, s74, 1023
v_mfma_f32_16x16x32_bf16 v[136:139], a[200:203], v[60:63], v[136:139]
s_waitcnt vmcnt(7) lgkmcnt(0)
s_barrier
v_mfma_f32_16x16x32_bf16 v[76:79], a[204:207], v[52:55], v[76:79]
s_add_u32 m0, s57, 131072
v_mfma_f32_16x16x32_bf16 v[108:111], a[204:207], v[56:59], v[108:111]
buffer_load_dwordx4 v5, s[20:23], s73 offen lds
v_mfma_f32_16x16x32_bf16 v[140:143], a[204:207], v[60:63], v[140:143]
v_mfma_f32_16x16x32_bf16 v[80:83], a[208:211], v[52:55], v[80:83]
v_mfma_f32_16x16x32_bf16 v[112:115], a[208:211], v[56:59], v[112:115]
v_mfma_f32_16x16x32_bf16 v[144:147], a[208:211], v[60:63], v[144:147]
v_mfma_f32_16x16x32_bf16 v[84:87], a[212:215], v[52:55], v[84:87]
v_mfma_f32_16x16x32_bf16 v[116:119], a[212:215], v[56:59], v[116:119]
buffer_load_dwordx4 v39, s[20:23], s73 offen offset:1024 lds
v_mfma_f32_16x16x32_bf16 v[148:151], a[212:215], v[60:63], v[148:151]
v_mfma_f32_16x16x32_bf16 v[88:91], a[216:219], v[52:55], v[88:91]
v_mfma_f32_16x16x32_bf16 v[120:123], a[216:219], v[56:59], v[120:123]
v_mfma_f32_16x16x32_bf16 v[152:155], a[216:219], v[60:63], v[152:155]
v_mfma_f32_16x16x32_bf16 v[92:95], a[220:223], v[52:55], v[92:95]
ds_read_b128 v[52:55], v17
v_mfma_f32_16x16x32_bf16 v[124:127], a[220:223], v[56:59], v[124:127]
buffer_load_dwordx4 v40, s[20:23], s73 offen offset:2048 lds
ds_read_b128 v[56:59], v17 offset:1024
v_mfma_f32_16x16x32_bf16 v[156:159], a[220:223], v[60:63], v[156:159]
ds_read_b128 v[60:63], v17 offset:2048
v_mfma_f32_16x16x32_bf16 v[160:163], a[192:195], a[224:227], v[160:163]
v_mfma_f32_16x16x32_bf16 v[192:195], a[192:195], a[228:231], v[192:195]
v_mfma_f32_16x16x32_bf16 v[224:227], a[192:195], a[232:235], v[224:227]
ds_read_b64_tr_b16 a[192:193], v13
v_mfma_f32_16x16x32_bf16 v[164:167], a[196:199], a[224:227], v[164:167]
ds_read_b64_tr_b16 a[194:195], v13 offset:1024
v_mfma_f32_16x16x32_bf16 v[196:199], a[196:199], a[228:231], v[196:199]
buffer_load_dwordx4 v41, s[20:23], s73 offen offset:3072 lds
v_mfma_f32_16x16x32_bf16 v[228:231], a[196:199], a[232:235], v[228:231]
s_add_u32 m0, s56, 147712
ds_read_b64_tr_b16 a[196:197], v14
v_mfma_f32_16x16x32_bf16 v[168:171], a[200:203], a[224:227], v[168:171]
ds_read_b64_tr_b16 a[198:199], v14 offset:1024
v_mfma_f32_16x16x32_bf16 v[200:203], a[200:203], a[228:231], v[200:203]
v_mfma_f32_16x16x32_bf16 v[232:235], a[200:203], a[232:235], v[232:235]
ds_read_b64_tr_b16 a[200:201], v13 offset:64
v_mfma_f32_16x16x32_bf16 v[172:175], a[204:207], a[224:227], v[172:175]
ds_read_b64_tr_b16 a[202:203], v13 offset:1088
v_mfma_f32_16x16x32_bf16 v[204:207], a[204:207], a[228:231], v[204:207]
buffer_load_dwordx4 v2, s[16:19], s74 offen lds
v_mfma_f32_16x16x32_bf16 v[236:239], a[204:207], a[232:235], v[236:239]
ds_read_b64_tr_b16 a[204:205], v14 offset:64
v_mfma_f32_16x16x32_bf16 v[176:179], a[208:211], a[224:227], v[176:179]
ds_read_b64_tr_b16 a[206:207], v14 offset:1088
v_mfma_f32_16x16x32_bf16 v[208:211], a[208:211], a[228:231], v[208:211]
v_mfma_f32_16x16x32_bf16 v[240:243], a[208:211], a[232:235], v[240:243]
ds_read_b64_tr_b16 a[208:209], v13 offset:128
v_mfma_f32_16x16x32_bf16 v[180:183], a[212:215], a[224:227], v[180:183]
ds_read_b64_tr_b16 a[210:211], v13 offset:1152
v_mfma_f32_16x16x32_bf16 v[212:215], a[212:215], a[228:231], v[212:215]
buffer_load_dwordx4 v3, s[16:19], s74 offen offset:1024 lds
v_mfma_f32_16x16x32_bf16 v[244:247], a[212:215], a[232:235], v[244:247]
ds_read_b64_tr_b16 a[212:213], v14 offset:128
v_mfma_f32_16x16x32_bf16 v[184:187], a[216:219], a[224:227], v[184:187]
ds_read_b64_tr_b16 a[214:215], v14 offset:1152
v_mfma_f32_16x16x32_bf16 v[216:219], a[216:219], a[228:231], v[216:219]
v_mfma_f32_16x16x32_bf16 v[248:251], a[216:219], a[232:235], v[248:251]
ds_read_b64_tr_b16 a[216:217], v13 offset:192
v_mfma_f32_16x16x32_bf16 v[188:191], a[220:223], a[224:227], v[188:191]
ds_read_b64_tr_b16 a[218:219], v13 offset:1216
v_mfma_f32_16x16x32_bf16 v[220:223], a[220:223], a[228:231], v[220:223]
buffer_load_dwordx4 v4, s[16:19], s74 offen offset:2048 lds
v_mfma_f32_16x16x32_bf16 v[252:255], a[220:223], a[232:235], v[252:255]
ds_read_b64_tr_b16 a[220:221], v14 offset:192
s_waitcnt lgkmcnt(5)
v_mfma_f32_16x16x32_bf16 v[64:67], a[192:195], v[52:55], v[64:67]
ds_read_b64_tr_b16 a[222:223], v14 offset:1216
v_mfma_f32_16x16x32_bf16 v[96:99], a[192:195], v[56:59], v[96:99]
ds_read_b128 a[224:227], v17 offset:3072
v_mfma_f32_16x16x32_bf16 v[128:131], a[192:195], v[60:63], v[128:131]
ds_read_b128 a[228:231], v17 offset:4096
v_mfma_f32_16x16x32_bf16 v[68:71], a[196:199], v[52:55], v[68:71]
ds_read_b128 a[232:235], v17 offset:5120
v_mfma_f32_16x16x32_bf16 v[100:103], a[196:199], v[56:59], v[100:103]
s_add_u32 s75, s75, 8192
v_mfma_f32_16x16x32_bf16 v[132:135], a[196:199], v[60:63], v[132:135]
s_and_b32 s75, s75, 131071
v_mfma_f32_16x16x32_bf16 v[72:75], a[200:203], v[52:55], v[72:75]
v_mfma_f32_16x16x32_bf16 v[104:107], a[200:203], v[56:59], v[104:107]
v_mfma_f32_16x16x32_bf16 v[136:139], a[200:203], v[60:63], v[136:139]
s_waitcnt vmcnt(7) lgkmcnt(0)
s_barrier
v_mfma_f32_16x16x32_bf16 v[76:79], a[204:207], v[52:55], v[76:79]
s_add_u32 m0, s77, 32768
v_mfma_f32_16x16x32_bf16 v[108:111], a[204:207], v[56:59], v[108:111]
buffer_load_dwordx4 v6, s[24:27], s75 offen nt lds
v_mfma_f32_16x16x32_bf16 v[140:143], a[204:207], v[60:63], v[140:143]
v_mfma_f32_16x16x32_bf16 v[80:83], a[208:211], v[52:55], v[80:83]
v_mfma_f32_16x16x32_bf16 v[112:115], a[208:211], v[56:59], v[112:115]
buffer_load_dwordx4 v7, s[24:27], s75 offen offset:1024 nt lds
v_mfma_f32_16x16x32_bf16 v[144:147], a[208:211], v[60:63], v[144:147]
v_mfma_f32_16x16x32_bf16 v[84:87], a[212:215], v[52:55], v[84:87]
v_mfma_f32_16x16x32_bf16 v[116:119], a[212:215], v[56:59], v[116:119]
buffer_load_dwordx4 v8, s[24:27], s75 offen offset:2048 nt lds
v_mfma_f32_16x16x32_bf16 v[148:151], a[212:215], v[60:63], v[148:151]
v_mfma_f32_16x16x32_bf16 v[88:91], a[216:219], v[52:55], v[88:91]
v_mfma_f32_16x16x32_bf16 v[120:123], a[216:219], v[56:59], v[120:123]
buffer_load_dwordx4 v9, s[24:27], s75 offen offset:3072 nt lds
v_mfma_f32_16x16x32_bf16 v[152:155], a[216:219], v[60:63], v[152:155]
s_add_u32 s75, s75, 8192
v_mfma_f32_16x16x32_bf16 v[92:95], a[220:223], v[52:55], v[92:95]
s_and_b32 s75, s75, 131071
ds_read_b128 v[52:55], v18
v_mfma_f32_16x16x32_bf16 v[124:127], a[220:223], v[56:59], v[124:127]
s_add_u32 m0, s77, 49152
ds_read_b128 v[56:59], v18 offset:1024
v_mfma_f32_16x16x32_bf16 v[156:159], a[220:223], v[60:63], v[156:159]
buffer_load_dwordx4 v6, s[24:27], s75 offen nt lds
ds_read_b128 v[60:63], v18 offset:2048
v_mfma_f32_16x16x32_bf16 v[160:163], a[192:195], a[224:227], v[160:163]
v_mfma_f32_16x16x32_bf16 v[192:195], a[192:195], a[228:231], v[192:195]
v_mfma_f32_16x16x32_bf16 v[224:227], a[192:195], a[232:235], v[224:227]
buffer_load_dwordx4 v7, s[24:27], s75 offen offset:1024 nt lds
ds_read_b64_tr_b16 a[192:193], v15
v_mfma_f32_16x16x32_bf16 v[164:167], a[196:199], a[224:227], v[164:167]
ds_read_b64_tr_b16 a[194:195], v15 offset:1024
v_mfma_f32_16x16x32_bf16 v[196:199], a[196:199], a[228:231], v[196:199]
v_mfma_f32_16x16x32_bf16 v[228:231], a[196:199], a[232:235], v[228:231]
buffer_load_dwordx4 v8, s[24:27], s75 offen offset:2048 nt lds
ds_read_b64_tr_b16 a[196:197], v16
v_mfma_f32_16x16x32_bf16 v[168:171], a[200:203], a[224:227], v[168:171]
ds_read_b64_tr_b16 a[198:199], v16 offset:1024
v_mfma_f32_16x16x32_bf16 v[200:203], a[200:203], a[228:231], v[200:203]
v_mfma_f32_16x16x32_bf16 v[232:235], a[200:203], a[232:235], v[232:235]
buffer_load_dwordx4 v9, s[24:27], s75 offen offset:3072 nt lds
ds_read_b64_tr_b16 a[200:201], v15 offset:64
v_mfma_f32_16x16x32_bf16 v[172:175], a[204:207], a[224:227], v[172:175]
ds_read_b64_tr_b16 a[202:203], v15 offset:1088
v_mfma_f32_16x16x32_bf16 v[204:207], a[204:207], a[228:231], v[204:207]
v_mfma_f32_16x16x32_bf16 v[236:239], a[204:207], a[232:235], v[236:239]
ds_read_b64_tr_b16 a[204:205], v16 offset:64
v_mfma_f32_16x16x32_bf16 v[176:179], a[208:211], a[224:227], v[176:179]
ds_read_b64_tr_b16 a[206:207], v16 offset:1088
v_mfma_f32_16x16x32_bf16 v[208:211], a[208:211], a[228:231], v[208:211]
v_mfma_f32_16x16x32_bf16 v[240:243], a[208:211], a[232:235], v[240:243]
ds_read_b64_tr_b16 a[208:209], v15 offset:128
v_mfma_f32_16x16x32_bf16 v[180:183], a[212:215], a[224:227], v[180:183]
ds_read_b64_tr_b16 a[210:211], v15 offset:1152
v_mfma_f32_16x16x32_bf16 v[212:215], a[212:215], a[228:231], v[212:215]
v_mfma_f32_16x16x32_bf16 v[244:247], a[212:215], a[232:235], v[244:247]
ds_read_b64_tr_b16 a[212:213], v16 offset:128
v_mfma_f32_16x16x32_bf16 v[184:187], a[216:219], a[224:227], v[184:187]
ds_read_b64_tr_b16 a[214:215], v16 offset:1152
v_mfma_f32_16x16x32_bf16 v[216:219], a[216:219], a[228:231], v[216:219]
v_mfma_f32_16x16x32_bf16 v[248:251], a[216:219], a[232:235], v[248:251]
ds_read_b64_tr_b16 a[216:217], v15 offset:192
v_mfma_f32_16x16x32_bf16 v[188:191], a[220:223], a[224:227], v[188:191]
ds_read_b64_tr_b16 a[218:219], v15 offset:1216
v_mfma_f32_16x16x32_bf16 v[220:223], a[220:223], a[228:231], v[220:223]
v_mfma_f32_16x16x32_bf16 v[252:255], a[220:223], a[232:235], v[252:255]
ds_read_b64_tr_b16 a[220:221], v16 offset:192
s_waitcnt lgkmcnt(6)
v_mfma_f32_16x16x32_bf16 v[64:67], a[192:195], v[52:55], v[64:67]
ds_read_b64_tr_b16 a[222:223], v16 offset:1216
v_mfma_f32_16x16x32_bf16 v[96:99], a[192:195], v[56:59], v[96:99]
ds_read_b128 a[224:227], v18 offset:3072
v_mfma_f32_16x16x32_bf16 v[128:131], a[192:195], v[60:63], v[128:131]
ds_read_b128 a[228:231], v18 offset:4096
v_mfma_f32_16x16x32_bf16 v[68:71], a[196:199], v[52:55], v[68:71]
ds_read_b128 a[232:235], v18 offset:5120
v_mfma_f32_16x16x32_bf16 v[100:103], a[196:199], v[56:59], v[100:103]
s_add_u32 s76, s76, 8192
v_mfma_f32_16x16x32_bf16 v[132:135], a[196:199], v[60:63], v[132:135]
s_and_b32 s76, s76, 131071
v_mfma_f32_16x16x32_bf16 v[72:75], a[200:203], v[52:55], v[72:75]
v_mfma_f32_16x16x32_bf16 v[104:107], a[200:203], v[56:59], v[104:107]
v_mfma_f32_16x16x32_bf16 v[136:139], a[200:203], v[60:63], v[136:139]
s_waitcnt vmcnt(8) lgkmcnt(0)
s_barrier
v_mfma_f32_16x16x32_bf16 v[76:79], a[204:207], v[52:55], v[76:79]
s_add_u32 m0, s77, 98304
v_mfma_f32_16x16x32_bf16 v[108:111], a[204:207], v[56:59], v[108:111]
buffer_load_dwordx4 v10, s[28:31], s76 offen nt lds
v_mfma_f32_16x16x32_bf16 v[140:143], a[204:207], v[60:63], v[140:143]
v_mfma_f32_16x16x32_bf16 v[80:83], a[208:211], v[52:55], v[80:83]
v_mfma_f32_16x16x32_bf16 v[112:115], a[208:211], v[56:59], v[112:115]
buffer_load_dwordx4 v19, s[28:31], s76 offen offset:1024 nt lds
v_mfma_f32_16x16x32_bf16 v[144:147], a[208:211], v[60:63], v[144:147]
v_mfma_f32_16x16x32_bf16 v[84:87], a[212:215], v[52:55], v[84:87]
v_mfma_f32_16x16x32_bf16 v[116:119], a[212:215], v[56:59], v[116:119]
buffer_load_dwordx4 v10, s[28:31], s76 offen offset:2048 nt lds
v_mfma_f32_16x16x32_bf16 v[148:151], a[212:215], v[60:63], v[148:151]
v_mfma_f32_16x16x32_bf16 v[88:91], a[216:219], v[52:55], v[88:91]
v_mfma_f32_16x16x32_bf16 v[120:123], a[216:219], v[56:59], v[120:123]
buffer_load_dwordx4 v19, s[28:31], s76 offen offset:3072 nt lds
v_mfma_f32_16x16x32_bf16 v[152:155], a[216:219], v[60:63], v[152:155]
s_add_u32 s76, s76, 8192
v_mfma_f32_16x16x32_bf16 v[92:95], a[220:223], v[52:55], v[92:95]
s_and_b32 s76, s76, 131071
ds_read_b128 v[52:55], v18 offset:32768
v_mfma_f32_16x16x32_bf16 v[124:127], a[220:223], v[56:59], v[124:127]
s_add_u32 m0, s77, 114688
ds_read_b128 v[56:59], v18 offset:33792
v_mfma_f32_16x16x32_bf16 v[156:159], a[220:223], v[60:63], v[156:159]
buffer_load_dwordx4 v10, s[28:31], s76 offen nt lds
ds_read_b128 v[60:63], v18 offset:34816
v_mfma_f32_16x16x32_bf16 v[160:163], a[192:195], a[224:227], v[160:163]
v_mfma_f32_16x16x32_bf16 v[192:195], a[192:195], a[228:231], v[192:195]
v_mfma_f32_16x16x32_bf16 v[224:227], a[192:195], a[232:235], v[224:227]
buffer_load_dwordx4 v19, s[28:31], s76 offen offset:1024 nt lds
ds_read_b64_tr_b16 a[192:193], v11
v_mfma_f32_16x16x32_bf16 v[164:167], a[196:199], a[224:227], v[164:167]
ds_read_b64_tr_b16 a[194:195], v11 offset:1024
v_mfma_f32_16x16x32_bf16 v[196:199], a[196:199], a[228:231], v[196:199]
v_mfma_f32_16x16x32_bf16 v[228:231], a[196:199], a[232:235], v[228:231]
buffer_load_dwordx4 v10, s[28:31], s76 offen offset:2048 nt lds
ds_read_b64_tr_b16 a[196:197], v12
v_mfma_f32_16x16x32_bf16 v[168:171], a[200:203], a[224:227], v[168:171]
ds_read_b64_tr_b16 a[198:199], v12 offset:1024
v_mfma_f32_16x16x32_bf16 v[200:203], a[200:203], a[228:231], v[200:203]
v_mfma_f32_16x16x32_bf16 v[232:235], a[200:203], a[232:235], v[232:235]
buffer_load_dwordx4 v19, s[28:31], s76 offen offset:3072 nt lds
ds_read_b64_tr_b16 a[200:201], v11 offset:64
v_mfma_f32_16x16x32_bf16 v[172:175], a[204:207], a[224:227], v[172:175]
ds_read_b64_tr_b16 a[202:203], v11 offset:1088
v_mfma_f32_16x16x32_bf16 v[204:207], a[204:207], a[228:231], v[204:207]
v_mfma_f32_16x16x32_bf16 v[236:239], a[204:207], a[232:235], v[236:239]
ds_read_b64_tr_b16 a[204:205], v12 offset:64
v_mfma_f32_16x16x32_bf16 v[176:179], a[208:211], a[224:227], v[176:179]
ds_read_b64_tr_b16 a[206:207], v12 offset:1088
v_mfma_f32_16x16x32_bf16 v[208:211], a[208:211], a[228:231], v[208:211]
v_mfma_f32_16x16x32_bf16 v[240:243], a[208:211], a[232:235], v[240:243]
ds_read_b64_tr_b16 a[208:209], v11 offset:128
v_mfma_f32_16x16x32_bf16 v[180:183], a[212:215], a[224:227], v[180:183]
ds_read_b64_tr_b16 a[210:211], v11 offset:1152
v_mfma_f32_16x16x32_bf16 v[212:215], a[212:215], a[228:231], v[212:215]
v_mfma_f32_16x16x32_bf16 v[244:247], a[212:215], a[232:235], v[244:247]
ds_read_b64_tr_b16 a[212:213], v12 offset:128
v_mfma_f32_16x16x32_bf16 v[184:187], a[216:219], a[224:227], v[184:187]
ds_read_b64_tr_b16 a[214:215], v12 offset:1152
v_mfma_f32_16x16x32_bf16 v[216:219], a[216:219], a[228:231], v[216:219]
v_mfma_f32_16x16x32_bf16 v[248:251], a[216:219], a[232:235], v[248:251]
ds_read_b64_tr_b16 a[216:217], v11 offset:192
v_mfma_f32_16x16x32_bf16 v[188:191], a[220:223], a[224:227], v[188:191]
ds_read_b64_tr_b16 a[218:219], v11 offset:1216
v_mfma_f32_16x16x32_bf16 v[220:223], a[220:223], a[228:231], v[220:223]
v_mfma_f32_16x16x32_bf16 v[252:255], a[220:223], a[232:235], v[252:255]
ds_read_b64_tr_b16 a[220:221], v12 offset:192
s_waitcnt lgkmcnt(6)
v_mfma_f32_16x16x32_bf16 v[64:67], a[192:195], v[52:55], v[64:67]
ds_read_b64_tr_b16 a[222:223], v12 offset:1216
v_mfma_f32_16x16x32_bf16 v[68:71], a[196:199], v[52:55], v[68:71]
ds_read_b128 a[224:227], v18 offset:35840
v_mfma_f32_16x16x32_bf16 v[72:75], a[200:203], v[52:55], v[72:75]
ds_read_b128 a[228:231], v18 offset:36864
v_mfma_f32_16x16x32_bf16 v[76:79], a[204:207], v[52:55], v[76:79]
ds_read_b128 a[232:235], v18 offset:37888
s_waitcnt lgkmcnt(6)
v_mfma_f32_16x16x32_bf16 v[80:83], a[208:211], v[52:55], v[80:83]
v_xor_b32 v44, 128, v28
v_mfma_f32_16x16x32_bf16 v[84:87], a[212:215], v[52:55], v[84:87]
v_xor_b32 v45, 160, v28
s_waitcnt lgkmcnt(4)
v_mfma_f32_16x16x32_bf16 v[88:91], a[216:219], v[52:55], v[88:91]
v_xor_b32 v46, 192, v28
s_waitcnt lgkmcnt(3)
v_mfma_f32_16x16x32_bf16 v[92:95], a[220:223], v[52:55], v[92:95]
v_xor_b32 v47, 224, v28
v_mfma_f32_16x16x32_bf16 v[96:99], a[192:195], v[56:59], v[96:99]
s_waitcnt lgkmcnt(0)
s_barrier
v_mov_b32 v48, 0x3f803f80
v_mfma_f32_16x16x32_bf16 v[100:103], a[196:199], v[56:59], v[100:103]
v_mov_b32 v49, 0x3f803f80
v_mfma_f32_16x16x32_bf16 v[104:107], a[200:203], v[56:59], v[104:107]
v_mov_b32 v50, 0x3f803f80
v_mfma_f32_16x16x32_bf16 v[108:111], a[204:207], v[56:59], v[108:111]
v_mov_b32 v51, 0x3f803f80
v_mfma_f32_16x16x32_bf16 v[112:115], a[208:211], v[56:59], v[112:115]
v_mul_f32 v64, s66, v64
v_mul_f32 v65, s66, v65
v_mul_f32 v66, s66, v66
v_mfma_f32_16x16x32_bf16 v[116:119], a[212:215], v[56:59], v[116:119]
v_mul_f32 v67, s66, v67
v_mul_f32 v68, s66, v68
v_mul_f32 v69, s66, v69
v_mfma_f32_16x16x32_bf16 v[120:123], a[216:219], v[56:59], v[120:123]
v_mul_f32 v70, s66, v70
v_mul_f32 v71, s66, v71
v_cvt_pk_bf16_f32 v64, v64, v65
v_mfma_f32_16x16x32_bf16 v[124:127], a[220:223], v[56:59], v[124:127]
v_cvt_pk_bf16_f32 v65, v66, v67
v_cvt_pk_bf16_f32 v66, v68, v69
v_cvt_pk_bf16_f32 v67, v70, v71
v_mfma_f32_16x16x32_bf16 v[128:131], a[192:195], v[60:63], v[128:131]
v_mul_f32 v72, s66, v72
v_mul_f32 v73, s66, v73
v_mul_f32 v74, s66, v74
v_mfma_f32_16x16x32_bf16 v[132:135], a[196:199], v[60:63], v[132:135]
v_mul_f32 v75, s66, v75
v_mul_f32 v76, s66, v76
v_mul_f32 v77, s66, v77
v_mfma_f32_16x16x32_bf16 v[136:139], a[200:203], v[60:63], v[136:139]
v_mul_f32 v78, s66, v78
v_mul_f32 v79, s66, v79
v_cvt_pk_bf16_f32 v68, v72, v73
v_mfma_f32_16x16x32_bf16 v[140:143], a[204:207], v[60:63], v[140:143]
v_cvt_pk_bf16_f32 v69, v74, v75
v_cvt_pk_bf16_f32 v70, v76, v77
v_cvt_pk_bf16_f32 v71, v78, v79
v_mfma_f32_16x16x32_bf16 v[144:147], a[208:211], v[60:63], v[144:147]
v_mul_f32 v80, s66, v80
v_mul_f32 v81, s66, v81
v_mul_f32 v82, s66, v82
v_mfma_f32_16x16x32_bf16 v[148:151], a[212:215], v[60:63], v[148:151]
v_mul_f32 v83, s66, v83
v_mul_f32 v84, s66, v84
v_mul_f32 v85, s66, v85
v_mfma_f32_16x16x32_bf16 v[152:155], a[216:219], v[60:63], v[152:155]
v_mul_f32 v86, s66, v86
v_mul_f32 v87, s66, v87
v_cvt_pk_bf16_f32 v72, v80, v81
v_mfma_f32_16x16x32_bf16 v[156:159], a[220:223], v[60:63], v[156:159]
v_cvt_pk_bf16_f32 v73, v82, v83
v_cvt_pk_bf16_f32 v74, v84, v85
v_cvt_pk_bf16_f32 v75, v86, v87
v_mfma_f32_16x16x32_bf16 v[160:163], a[192:195], a[224:227], v[160:163]
v_mul_f32 v88, s66, v88
v_mul_f32 v89, s66, v89
v_mul_f32 v90, s66, v90
v_mfma_f32_16x16x32_bf16 v[164:167], a[196:199], a[224:227], v[164:167]
v_mul_f32 v91, s66, v91
v_mul_f32 v92, s66, v92
v_mul_f32 v93, s66, v93
v_mfma_f32_16x16x32_bf16 v[168:171], a[200:203], a[224:227], v[168:171]
v_mul_f32 v94, s66, v94
v_mul_f32 v95, s66, v95
v_cvt_pk_bf16_f32 v76, v88, v89
v_mfma_f32_16x16x32_bf16 v[172:175], a[204:207], a[224:227], v[172:175]
v_cvt_pk_bf16_f32 v77, v90, v91
v_cvt_pk_bf16_f32 v78, v92, v93
v_cvt_pk_bf16_f32 v79, v94, v95
v_mfma_f32_16x16x32_bf16 v[176:179], a[208:211], a[224:227], v[176:179]
v_mul_f32 v96, s66, v96
v_mul_f32 v97, s66, v97
v_mul_f32 v98, s66, v98
v_mfma_f32_16x16x32_bf16 v[180:183], a[212:215], a[224:227], v[180:183]
v_mul_f32 v99, s66, v99
v_mul_f32 v100, s66, v100
v_mul_f32 v101, s66, v101
v_mfma_f32_16x16x32_bf16 v[184:187], a[216:219], a[224:227], v[184:187]
v_mul_f32 v102, s66, v102
v_mul_f32 v103, s66, v103
v_cvt_pk_bf16_f32 v96, v96, v97
v_mfma_f32_16x16x32_bf16 v[188:191], a[220:223], a[224:227], v[188:191]
v_cvt_pk_bf16_f32 v97, v98, v99
v_cvt_pk_bf16_f32 v98, v100, v101
v_cvt_pk_bf16_f32 v99, v102, v103
v_mfma_f32_16x16x32_bf16 v[192:195], a[192:195], a[228:231], v[192:195]
v_mul_f32 v104, s66, v104
v_mul_f32 v105, s66, v105
v_mul_f32 v106, s66, v106
v_mfma_f32_16x16x32_bf16 v[196:199], a[196:199], a[228:231], v[196:199]
v_mul_f32 v107, s66, v107
v_mul_f32 v108, s66, v108
v_mul_f32 v109, s66, v109
v_mfma_f32_16x16x32_bf16 v[200:203], a[200:203], a[228:231], v[200:203]
v_mul_f32 v110, s66, v110
v_mul_f32 v111, s66, v111
v_cvt_pk_bf16_f32 v100, v104, v105
v_mfma_f32_16x16x32_bf16 v[204:207], a[204:207], a[228:231], v[204:207]
v_cvt_pk_bf16_f32 v101, v106, v107
v_cvt_pk_bf16_f32 v102, v108, v109
v_cvt_pk_bf16_f32 v103, v110, v111
v_mfma_f32_16x16x32_bf16 v[208:211], a[208:211], a[228:231], v[208:211]
v_mul_f32 v112, s66, v112
v_mul_f32 v113, s66, v113
v_mul_f32 v114, s66, v114
v_mfma_f32_16x16x32_bf16 v[212:215], a[212:215], a[228:231], v[212:215]
v_mul_f32 v115, s66, v115
v_mul_f32 v116, s66, v116
v_mul_f32 v117, s66, v117
v_mfma_f32_16x16x32_bf16 v[216:219], a[216:219], a[228:231], v[216:219]
v_mul_f32 v118, s66, v118
v_mul_f32 v119, s66, v119
v_cvt_pk_bf16_f32 v104, v112, v113
v_mfma_f32_16x16x32_bf16 v[220:223], a[220:223], a[228:231], v[220:223]
v_cvt_pk_bf16_f32 v105, v114, v115
v_cvt_pk_bf16_f32 v106, v116, v117
v_cvt_pk_bf16_f32 v107, v118, v119
v_mfma_f32_16x16x32_bf16 v[224:227], a[192:195], a[232:235], v[224:227]
ds_read_b64 a[192:193], v20
ds_read_b64 a[194:195], v21
v_mul_f32 v120, s66, v120
v_mul_f32 v121, s66, v121
v_mul_f32 v122, s66, v122
v_mfma_f32_16x16x32_bf16 v[228:231], a[196:199], a[232:235], v[228:231]
ds_read_b64 a[196:197], v22
ds_read_b64 a[198:199], v23
v_mul_f32 v123, s66, v123
v_mul_f32 v124, s66, v124
v_mul_f32 v125, s66, v125
v_mfma_f32_16x16x32_bf16 v[232:235], a[200:203], a[232:235], v[232:235]
ds_read_b64 a[200:201], v24
ds_read_b64 a[202:203], v25
v_mul_f32 v126, s66, v126
v_mul_f32 v127, s66, v127
v_cvt_pk_bf16_f32 v108, v120, v121
v_mfma_f32_16x16x32_bf16 v[236:239], a[204:207], a[232:235], v[236:239]
ds_read_b64 a[204:205], v26
ds_read_b64 a[206:207], v27
v_cvt_pk_bf16_f32 v109, v122, v123
v_cvt_pk_bf16_f32 v110, v124, v125
v_cvt_pk_bf16_f32 v111, v126, v127
v_mfma_f32_16x16x32_bf16 v[240:243], a[208:211], a[232:235], v[240:243]
ds_read_b64 a[208:209], v20 offset:4096
ds_read_b64 a[210:211], v21 offset:4096
v_mul_f32 v128, s66, v128
v_mul_f32 v129, s66, v129
v_mul_f32 v130, s66, v130
v_mul_f32 v131, s66, v131
v_mfma_f32_16x16x32_bf16 v[244:247], a[212:215], a[232:235], v[244:247]
ds_read_b64 a[212:213], v22 offset:4096
ds_read_b64 a[214:215], v23 offset:4096
v_mul_f32 v132, s66, v132
v_mul_f32 v133, s66, v133
v_mul_f32 v134, s66, v134
v_mul_f32 v135, s66, v135
v_mfma_f32_16x16x32_bf16 v[248:251], a[216:219], a[232:235], v[248:251]
ds_read_b64 a[216:217], v24 offset:4096
ds_read_b64 a[218:219], v25 offset:4096
v_cvt_pk_bf16_f32 v128, v128, v129
v_cvt_pk_bf16_f32 v129, v130, v131
v_cvt_pk_bf16_f32 v130, v132, v133
v_cvt_pk_bf16_f32 v131, v134, v135
v_mfma_f32_16x16x32_bf16 v[252:255], a[220:223], a[232:235], v[252:255]
ds_read_b64 a[220:221], v26 offset:4096
ds_read_b64 a[222:223], v27 offset:4096
v_mul_f32 v136, s66, v136
v_mul_f32 v137, s66, v137
v_mul_f32 v138, s66, v138
v_mul_f32 v139, s66, v139
s_waitcnt lgkmcnt(4)
v_mfma_f32_16x16x32_bf16 v[80:83], a[192:195], v[64:67], 0
v_mul_f32 v140, s66, v140
v_mul_f32 v141, s66, v141
v_mul_f32 v142, s66, v142
v_mul_f32 v143, s66, v143
v_mfma_f32_16x16x32_bf16 v[84:87], a[208:211], v[64:67], 0
v_cvt_pk_bf16_f32 v132, v136, v137
v_cvt_pk_bf16_f32 v133, v138, v139
v_cvt_pk_bf16_f32 v134, v140, v141
v_cvt_pk_bf16_f32 v135, v142, v143
v_mfma_f32_16x16x32_bf16 v[80:83], a[196:199], v[68:71], v[80:83]
v_mul_f32 v144, s66, v144
v_mul_f32 v145, s66, v145
v_mul_f32 v146, s66, v146
v_mul_f32 v147, s66, v147
v_mfma_f32_16x16x32_bf16 v[84:87], a[212:215], v[68:71], v[84:87]
v_mul_f32 v148, s66, v148
v_mul_f32 v149, s66, v149
v_mul_f32 v150, s66, v150
v_mul_f32 v151, s66, v151
v_mfma_f32_16x16x32_bf16 v[80:83], a[200:203], v[72:75], v[80:83]
v_cvt_pk_bf16_f32 v136, v144, v145
v_cvt_pk_bf16_f32 v137, v146, v147
v_cvt_pk_bf16_f32 v138, v148, v149
v_cvt_pk_bf16_f32 v139, v150, v151
s_waitcnt lgkmcnt(0)
v_mfma_f32_16x16x32_bf16 v[84:87], a[216:219], v[72:75], v[84:87]
v_mul_f32 v152, s66, v152
v_mul_f32 v153, s66, v153
v_mul_f32 v154, s66, v154
v_mul_f32 v155, s66, v155
v_mfma_f32_16x16x32_bf16 v[80:83], a[204:207], v[76:79], v[80:83]
v_mul_f32 v156, s66, v156
v_mul_f32 v157, s66, v157
v_mul_f32 v158, s66, v158
v_mul_f32 v159, s66, v159
v_mfma_f32_16x16x32_bf16 v[84:87], a[220:223], v[76:79], v[84:87]
v_cvt_pk_bf16_f32 v140, v152, v153
v_cvt_pk_bf16_f32 v141, v154, v155
v_cvt_pk_bf16_f32 v142, v156, v157
v_cvt_pk_bf16_f32 v143, v158, v159
v_mfma_f32_16x16x32_bf16 v[112:115], a[192:195], v[96:99], 0
v_mul_f32 v160, s66, v160
v_mul_f32 v161, s66, v161
ds_read_b64_tr_b16 a[224:225], v28
ds_read_b64_tr_b16 a[226:227], v28 offset:4096
v_mfma_f32_16x16x32_bf16 v[116:119], a[208:211], v[96:99], 0
v_mul_f32 v162, s66, v162
v_mul_f32 v163, s66, v163
ds_read_b64_tr_b16 a[228:229], v29
ds_read_b64_tr_b16 a[230:231], v29 offset:4096
v_mfma_f32_16x16x32_bf16 v[112:115], a[196:199], v[100:103], v[112:115]
v_mul_f32 v164, s66, v164
v_mul_f32 v165, s66, v165
ds_read_b64_tr_b16 a[232:233], v30
ds_read_b64_tr_b16 a[234:235], v30 offset:4096
v_mfma_f32_16x16x32_bf16 v[116:119], a[212:215], v[100:103], v[116:119]
v_mul_f32 v166, s66, v166
v_mul_f32 v167, s66, v167
ds_read_b64_tr_b16 a[236:237], v31
ds_read_b64_tr_b16 a[238:239], v31 offset:4096
v_mfma_f32_16x16x32_bf16 v[112:115], a[200:203], v[104:107], v[112:115]
v_cvt_pk_bf16_f32 v160, v160, v161
v_cvt_pk_bf16_f32 v161, v162, v163
ds_read_b64_tr_b16 a[240:241], v44
ds_read_b64_tr_b16 a[242:243], v44 offset:4096
v_mfma_f32_16x16x32_bf16 v[116:119], a[216:219], v[104:107], v[116:119]
v_cvt_pk_bf16_f32 v162, v164, v165
v_cvt_pk_bf16_f32 v163, v166, v167
ds_read_b64_tr_b16 a[244:245], v45
ds_read_b64_tr_b16 a[246:247], v45 offset:4096
v_mfma_f32_16x16x32_bf16 v[112:115], a[204:207], v[108:111], v[112:115]
v_mul_f32 v168, s66, v168
v_mul_f32 v169, s66, v169
ds_read_b64_tr_b16 a[248:249], v46
ds_read_b64_tr_b16 a[250:251], v46 offset:4096
v_mfma_f32_16x16x32_bf16 v[116:119], a[220:223], v[108:111], v[116:119]
v_mul_f32 v170, s66, v170
v_mul_f32 v171, s66, v171
ds_read_b64_tr_b16 a[252:253], v47
ds_read_b64_tr_b16 a[254:255], v47 offset:4096
v_mfma_f32_16x16x32_bf16 v[144:147], a[192:195], v[128:131], 0
v_mul_f32 v172, s66, v172
v_mul_f32 v173, s66, v173
v_mfma_f32_16x16x32_bf16 v[148:151], a[208:211], v[128:131], 0
v_mul_f32 v174, s66, v174
v_mul_f32 v175, s66, v175
v_mfma_f32_16x16x32_bf16 v[144:147], a[196:199], v[132:135], v[144:147]
v_cvt_pk_bf16_f32 v164, v168, v169
v_cvt_pk_bf16_f32 v165, v170, v171
v_mfma_f32_16x16x32_bf16 v[148:151], a[212:215], v[132:135], v[148:151]
v_cvt_pk_bf16_f32 v166, v172, v173
v_cvt_pk_bf16_f32 v167, v174, v175
v_mfma_f32_16x16x32_bf16 v[144:147], a[200:203], v[136:139], v[144:147]
v_mul_f32 v176, s66, v176
v_mul_f32 v177, s66, v177
v_mfma_f32_16x16x32_bf16 v[148:151], a[216:219], v[136:139], v[148:151]
v_mul_f32 v178, s66, v178
v_mul_f32 v179, s66, v179
v_exp_f32 v80, v80
v_exp_f32 v81, v81
v_exp_f32 v82, v82
v_cvt_pk_bf16_f32 v80, v80, v81
v_exp_f32 v83, v83
v_exp_f32 v84, v84
v_cvt_pk_bf16_f32 v81, v82, v83
v_exp_f32 v85, v85
v_exp_f32 v86, v86
v_cvt_pk_bf16_f32 v82, v84, v85
v_exp_f32 v87, v87
s_nop 0
v_cvt_pk_bf16_f32 v83, v86, v87
v_mfma_f32_16x16x32_bf16 v[144:147], a[204:207], v[140:143], v[144:147]
v_mul_f32 v180, s66, v180
v_mul_f32 v181, s66, v181
v_mfma_f32_16x16x32_bf16 v[148:151], a[220:223], v[140:143], v[148:151]
v_mul_f32 v182, s66, v182
v_mul_f32 v183, s66, v183
s_waitcnt lgkmcnt(0)
v_mfma_f32_16x16x32_bf16 a[0:3], a[224:227], v[80:83], 0
v_cvt_pk_bf16_f32 v168, v176, v177
v_cvt_pk_bf16_f32 v169, v178, v179
v_mfma_f32_16x16x32_bf16 a[4:7], a[228:231], v[80:83], 0
v_cvt_pk_bf16_f32 v170, v180, v181
v_cvt_pk_bf16_f32 v171, v182, v183
v_mfma_f32_16x16x32_bf16 a[8:11], a[232:235], v[80:83], 0
v_mul_f32 v184, s66, v184
v_mul_f32 v185, s66, v185
v_mfma_f32_16x16x32_bf16 a[12:15], a[236:239], v[80:83], 0
v_mul_f32 v186, s66, v186
v_mul_f32 v187, s66, v187
v_mfma_f32_16x16x32_bf16 a[16:19], a[240:243], v[80:83], 0
v_mul_f32 v188, s66, v188
v_mul_f32 v189, s66, v189
v_mfma_f32_16x16x32_bf16 a[20:23], a[244:247], v[80:83], 0
v_mul_f32 v190, s66, v190
v_mul_f32 v191, s66, v191
v_mfma_f32_16x16x32_bf16 a[24:27], a[248:251], v[80:83], 0
v_cvt_pk_bf16_f32 v172, v184, v185
v_cvt_pk_bf16_f32 v173, v186, v187
v_mfma_f32_16x16x32_bf16 a[28:31], a[252:255], v[80:83], 0
v_cvt_pk_bf16_f32 v174, v188, v189
v_cvt_pk_bf16_f32 v175, v190, v191
v_mfma_f32_16x16x32_bf16 v[88:91], v[48:51], v[80:83], 0
v_exp_f32 v112, v112
v_mfma_f32_16x16x32_bf16 v[80:83], a[192:195], v[160:163], 0
v_mul_f32 v192, s66, v192
v_mul_f32 v193, s66, v193
v_mul_f32 v194, s66, v194
v_mfma_f32_16x16x32_bf16 v[84:87], a[208:211], v[160:163], 0
v_mul_f32 v195, s66, v195
v_mul_f32 v196, s66, v196
v_mul_f32 v197, s66, v197
v_mfma_f32_16x16x32_bf16 v[80:83], a[196:199], v[164:167], v[80:83]
v_mul_f32 v198, s66, v198
v_mul_f32 v199, s66, v199
v_cvt_pk_bf16_f32 v192, v192, v193
v_mfma_f32_16x16x32_bf16 v[84:87], a[212:215], v[164:167], v[84:87]
v_cvt_pk_bf16_f32 v193, v194, v195
v_cvt_pk_bf16_f32 v194, v196, v197
v_cvt_pk_bf16_f32 v195, v198, v199
v_mfma_f32_16x16x32_bf16 v[80:83], a[200:203], v[168:171], v[80:83]
v_mul_f32 v200, s66, v200
v_mul_f32 v201, s66, v201
v_mul_f32 v202, s66, v202
v_mfma_f32_16x16x32_bf16 v[84:87], a[216:219], v[168:171], v[84:87]
v_mul_f32 v203, s66, v203
v_mul_f32 v204, s66, v204
v_mul_f32 v205, s66, v205
v_exp_f32 v113, v113
v_exp_f32 v114, v114
v_cvt_pk_bf16_f32 v112, v112, v113
v_exp_f32 v115, v115
v_exp_f32 v116, v116
v_cvt_pk_bf16_f32 v113, v114, v115
v_exp_f32 v117, v117
v_exp_f32 v118, v118
v_cvt_pk_bf16_f32 v114, v116, v117
v_exp_f32 v119, v119
s_nop 0
v_cvt_pk_bf16_f32 v115, v118, v119
v_mfma_f32_16x16x32_bf16 v[80:83], a[204:207], v[172:175], v[80:83]
v_mul_f32 v206, s66, v206
v_mul_f32 v207, s66, v207
v_cvt_pk_bf16_f32 v196, v200, v201
v_mfma_f32_16x16x32_bf16 v[84:87], a[220:223], v[172:175], v[84:87]
v_cvt_pk_bf16_f32 v197, v202, v203
v_cvt_pk_bf16_f32 v198, v204, v205
v_cvt_pk_bf16_f32 v199, v206, v207
v_mfma_f32_16x16x32_bf16 a[32:35], a[224:227], v[112:115], 0
v_mul_f32 v208, s66, v208
v_mul_f32 v209, s66, v209
v_mul_f32 v210, s66, v210
v_mfma_f32_16x16x32_bf16 a[36:39], a[228:231], v[112:115], 0
v_mul_f32 v211, s66, v211
v_mul_f32 v212, s66, v212
v_mul_f32 v213, s66, v213
v_mfma_f32_16x16x32_bf16 a[40:43], a[232:235], v[112:115], 0
v_mul_f32 v214, s66, v214
v_mul_f32 v215, s66, v215
v_cvt_pk_bf16_f32 v200, v208, v209
v_mfma_f32_16x16x32_bf16 a[44:47], a[236:239], v[112:115], 0
v_cvt_pk_bf16_f32 v201, v210, v211
v_cvt_pk_bf16_f32 v202, v212, v213
v_cvt_pk_bf16_f32 v203, v214, v215
v_mfma_f32_16x16x32_bf16 a[48:51], a[240:243], v[112:115], 0
v_mul_f32 v216, s66, v216
v_mul_f32 v217, s66, v217
v_mul_f32 v218, s66, v218
v_mfma_f32_16x16x32_bf16 a[52:55], a[244:247], v[112:115], 0
v_mul_f32 v219, s66, v219
v_mul_f32 v220, s66, v220
v_mul_f32 v221, s66, v221
v_mfma_f32_16x16x32_bf16 a[56:59], a[248:251], v[112:115], 0
v_mul_f32 v222, s66, v222
v_mul_f32 v223, s66, v223
v_cvt_pk_bf16_f32 v204, v216, v217
v_mfma_f32_16x16x32_bf16 a[60:63], a[252:255], v[112:115], 0
v_cvt_pk_bf16_f32 v205, v218, v219
v_cvt_pk_bf16_f32 v206, v220, v221
v_cvt_pk_bf16_f32 v207, v222, v223
v_mfma_f32_16x16x32_bf16 v[92:95], v[48:51], v[112:115], 0
v_exp_f32 v144, v144
v_mfma_f32_16x16x32_bf16 v[112:115], a[192:195], v[192:195], 0
v_mul_f32 v224, s66, v224
v_mul_f32 v225, s66, v225
v_mul_f32 v226, s66, v226
v_mfma_f32_16x16x32_bf16 v[116:119], a[208:211], v[192:195], 0
v_mul_f32 v227, s66, v227
v_mul_f32 v228, s66, v228
v_mul_f32 v229, s66, v229
v_mfma_f32_16x16x32_bf16 v[112:115], a[196:199], v[196:199], v[112:115]
v_mul_f32 v230, s66, v230
v_mul_f32 v231, s66, v231
v_cvt_pk_bf16_f32 v224, v224, v225
v_mfma_f32_16x16x32_bf16 v[116:119], a[212:215], v[196:199], v[116:119]
v_cvt_pk_bf16_f32 v225, v226, v227
v_cvt_pk_bf16_f32 v226, v228, v229
v_cvt_pk_bf16_f32 v227, v230, v231
v_mfma_f32_16x16x32_bf16 v[112:115], a[200:203], v[200:203], v[112:115]
v_mul_f32 v232, s66, v232
v_mul_f32 v233, s66, v233
v_mul_f32 v234, s66, v234
v_mfma_f32_16x16x32_bf16 v[116:119], a[216:219], v[200:203], v[116:119]
v_mul_f32 v235, s66, v235
v_mul_f32 v236, s66, v236
v_mul_f32 v237, s66, v237
v_exp_f32 v145, v145
v_exp_f32 v146, v146
v_cvt_pk_bf16_f32 v144, v144, v145
v_exp_f32 v147, v147
v_exp_f32 v148, v148
v_cvt_pk_bf16_f32 v145, v146, v147
v_exp_f32 v149, v149
v_exp_f32 v150, v150
v_cvt_pk_bf16_f32 v146, v148, v149
v_exp_f32 v151, v151
s_nop 0
v_cvt_pk_bf16_f32 v147, v150, v151
v_mfma_f32_16x16x32_bf16 v[112:115], a[204:207], v[204:207], v[112:115]
v_mul_f32 v238, s66, v238
v_mul_f32 v239, s66, v239
v_cvt_pk_bf16_f32 v228, v232, v233
v_mfma_f32_16x16x32_bf16 v[116:119], a[220:223], v[204:207], v[116:119]
v_cvt_pk_bf16_f32 v229, v234, v235
v_cvt_pk_bf16_f32 v230, v236, v237
v_cvt_pk_bf16_f32 v231, v238, v239
v_mfma_f32_16x16x32_bf16 a[64:67], a[224:227], v[144:147], 0
v_mul_f32 v240, s66, v240
v_mul_f32 v241, s66, v241
v_mul_f32 v242, s66, v242
s_barrier
v_mfma_f32_16x16x32_bf16 a[68:71], a[228:231], v[144:147], 0
v_mul_f32 v243, s66, v243
v_mul_f32 v244, s66, v244
v_mul_f32 v245, s66, v245
s_add_u32 s75, s75, 8192
v_mfma_f32_16x16x32_bf16 a[72:75], a[232:235], v[144:147], 0
v_mul_f32 v246, s66, v246
v_mul_f32 v247, s66, v247
v_cvt_pk_bf16_f32 v232, v240, v241
s_and_b32 s75, s75, 131071
v_mfma_f32_16x16x32_bf16 a[76:79], a[236:239], v[144:147], 0
s_add_u32 m0, s77, 0
v_cvt_pk_bf16_f32 v233, v242, v243
v_cvt_pk_bf16_f32 v234, v244, v245
v_cvt_pk_bf16_f32 v235, v246, v247
v_mfma_f32_16x16x32_bf16 a[80:83], a[240:243], v[144:147], 0
buffer_load_dwordx4 v6, s[24:27], s75 offen nt lds
v_mul_f32 v248, s66, v248
v_mul_f32 v249, s66, v249
v_mul_f32 v250, s66, v250
v_mfma_f32_16x16x32_bf16 a[84:87], a[244:247], v[144:147], 0
v_mul_f32 v251, s66, v251
v_mul_f32 v252, s66, v252
v_mul_f32 v253, s66, v253
v_mfma_f32_16x16x32_bf16 a[88:91], a[248:251], v[144:147], 0
v_mul_f32 v254, s66, v254
v_mul_f32 v255, s66, v255
v_cvt_pk_bf16_f32 v236, v248, v249
v_mfma_f32_16x16x32_bf16 a[92:95], a[252:255], v[144:147], 0
v_cvt_pk_bf16_f32 v237, v250, v251
v_cvt_pk_bf16_f32 v238, v252, v253
v_cvt_pk_bf16_f32 v239, v254, v255
v_mfma_f32_16x16x32_bf16 v[120:123], v[48:51], v[144:147], 0
v_exp_f32 v80, v80
v_mfma_f32_16x16x32_bf16 v[144:147], a[192:195], v[224:227], 0
buffer_load_dwordx4 v7, s[24:27], s75 offen offset:1024 nt lds
ds_read_b64 a[192:193], v20 offset:16384
ds_read_b64 a[194:195], v21 offset:16384
v_mfma_f32_16x16x32_bf16 v[148:151], a[208:211], v[224:227], 0
v_exp_f32 v81, v81
v_mfma_f32_16x16x32_bf16 v[144:147], a[196:199], v[228:231], v[144:147]
ds_read_b64 a[208:209], v20 offset:20480
ds_read_b64 a[210:211], v21 offset:20480
v_mfma_f32_16x16x32_bf16 v[148:151], a[212:215], v[228:231], v[148:151]
v_exp_f32 v82, v82
v_cvt_pk_bf16_f32 v80, v80, v81
v_mfma_f32_16x16x32_bf16 v[144:147], a[200:203], v[232:235], v[144:147]
ds_read_b64 a[196:197], v22 offset:16384
ds_read_b64 a[198:199], v23 offset:16384
v_mfma_f32_16x16x32_bf16 v[148:151], a[216:219], v[232:235], v[148:151]
buffer_load_dwordx4 v8, s[24:27], s75 offen offset:2048 nt lds
v_exp_f32 v83, v83
v_exp_f32 v84, v84
v_cvt_pk_bf16_f32 v81, v82, v83
v_exp_f32 v85, v85
v_exp_f32 v86, v86
v_cvt_pk_bf16_f32 v82, v84, v85
v_exp_f32 v87, v87
s_nop 0
v_cvt_pk_bf16_f32 v83, v86, v87
v_mfma_f32_16x16x32_bf16 v[144:147], a[204:207], v[236:239], v[144:147]
ds_read_b64 a[212:213], v22 offset:20480
ds_read_b64 a[214:215], v23 offset:20480
v_mfma_f32_16x16x32_bf16 v[148:151], a[220:223], v[236:239], v[148:151]
v_exp_f32 v112, v112
v_mfma_f32_16x16x32_bf16 a[96:99], a[224:227], v[80:83], 0
ds_read_b64 a[200:201], v24 offset:16384
ds_read_b64 a[202:203], v25 offset:16384
v_mfma_f32_16x16x32_bf16 a[100:103], a[228:231], v[80:83], 0
v_exp_f32 v113, v113
v_mfma_f32_16x16x32_bf16 a[104:107], a[232:235], v[80:83], 0
buffer_load_dwordx4 v9, s[24:27], s75 offen offset:3072 nt lds
ds_read_b64 a[216:217], v24 offset:20480
ds_read_b64 a[218:219], v25 offset:20480
v_mfma_f32_16x16x32_bf16 a[108:111], a[236:239], v[80:83], 0
s_add_u32 s76, s76, 8192
v_exp_f32 v114, v114
v_cvt_pk_bf16_f32 v112, v112, v113
v_mfma_f32_16x16x32_bf16 a[112:115], a[240:243], v[80:83], 0
ds_read_b64 a[204:205], v26 offset:16384
ds_read_b64 a[206:207], v27 offset:16384
s_and_b32 s76, s76, 131071
v_mfma_f32_16x16x32_bf16 a[116:119], a[244:247], v[80:83], 0
s_add_u32 m0, s77, 65536
v_exp_f32 v115, v115
v_mfma_f32_16x16x32_bf16 a[120:123], a[248:251], v[80:83], 0
ds_read_b64 a[220:221], v26 offset:20480
ds_read_b64 a[222:223], v27 offset:20480
v_mfma_f32_16x16x32_bf16 a[124:127], a[252:255], v[80:83], 0
buffer_load_dwordx4 v10, s[28:31], s76 offen nt lds
v_exp_f32 v116, v116
v_mfma_f32_16x16x32_bf16 v[124:127], v[48:51], v[80:83], 0
v_cvt_pk_bf16_f32 v113, v114, v115
v_exp_f32 v117, v117
s_waitcnt lgkmcnt(3)
v_mfma_f32_16x16x32_bf16 v[80:83], a[192:195], v[64:67], 0
v_exp_f32 v118, v118
v_cvt_pk_bf16_f32 v114, v116, v117
v_mfma_f32_16x16x32_bf16 v[84:87], a[208:211], v[64:67], 0
v_exp_f32 v144, v144
v_mfma_f32_16x16x32_bf16 v[80:83], a[196:199], v[68:71], v[80:83]
v_exp_f32 v119, v119
v_mfma_f32_16x16x32_bf16 v[84:87], a[212:215], v[68:71], v[84:87]
buffer_load_dwordx4 v19, s[28:31], s76 offen offset:1024 nt lds
v_exp_f32 v145, v145
v_mfma_f32_16x16x32_bf16 v[80:83], a[200:203], v[72:75], v[80:83]
v_cvt_pk_bf16_f32 v115, v118, v119
v_exp_f32 v146, v146
v_mfma_f32_16x16x32_bf16 v[84:87], a[216:219], v[72:75], v[84:87]
v_cvt_pk_bf16_f32 v144, v144, v145
s_waitcnt lgkmcnt(0)
v_mfma_f32_16x16x32_bf16 v[80:83], a[204:207], v[76:79], v[80:83]
v_mfma_f32_16x16x32_bf16 v[84:87], a[220:223], v[76:79], v[84:87]
v_exp_f32 v147, v147
v_mfma_f32_16x16x32_bf16 a[128:131], a[224:227], v[112:115], 0
buffer_load_dwordx4 v10, s[28:31], s76 offen offset:2048 nt lds
v_mfma_f32_16x16x32_bf16 a[132:135], a[228:231], v[112:115], 0
v_exp_f32 v148, v148
v_mfma_f32_16x16x32_bf16 a[136:139], a[232:235], v[112:115], 0
s_barrier
v_mfma_f32_16x16x32_bf16 a[140:143], a[236:239], v[112:115], 0
v_cvt_pk_bf16_f32 v145, v146, v147
v_mfma_f32_16x16x32_bf16 a[144:147], a[240:243], v[112:115], 0
v_mfma_f32_16x16x32_bf16 a[148:151], a[244:247], v[112:115], 0
buffer_load_dwordx4 v19, s[28:31], s76 offen offset:3072 nt lds
v_exp_f32 v149, v149
v_mfma_f32_16x16x32_bf16 a[152:155], a[248:251], v[112:115], 0
v_mfma_f32_16x16x32_bf16 a[156:159], a[252:255], v[112:115], 0
v_exp_f32 v150, v150
v_mfma_f32_16x16x32_bf16 v[152:155], v[48:51], v[112:115], 0
v_mfma_f32_16x16x32_bf16 v[112:115], a[192:195], v[96:99], 0
v_cvt_pk_bf16_f32 v146, v148, v149
v_exp_f32 v80, v80
v_mfma_f32_16x16x32_bf16 v[116:119], a[208:211], v[96:99], 0
v_exp_f32 v81, v81
v_mfma_f32_16x16x32_bf16 v[112:115], a[196:199], v[100:103], v[112:115]
v_exp_f32 v151, v151
v_mfma_f32_16x16x32_bf16 v[116:119], a[212:215], v[100:103], v[116:119]
v_exp_f32 v82, v82
v_mfma_f32_16x16x32_bf16 v[112:115], a[200:203], v[104:107], v[112:115]
v_cvt_pk_bf16_f32 v147, v150, v151
v_mfma_f32_16x16x32_bf16 v[116:119], a[216:219], v[104:107], v[116:119]
s_add_u32 s75, s75, 8192
v_cvt_pk_bf16_f32 v80, v80, v81
v_mfma_f32_16x16x32_bf16 v[112:115], a[204:207], v[108:111], v[112:115]
s_and_b32 s75, s75, 131071
v_mfma_f32_16x16x32_bf16 v[116:119], a[220:223], v[108:111], v[116:119]
s_add_u32 m0, s77, 16384
v_exp_f32 v83, v83
v_mfma_f32_16x16x32_bf16 a[160:163], a[224:227], v[144:147], 0
buffer_load_dwordx4 v6, s[24:27], s75 offen nt lds
ds_read_b64_tr_b16 a[224:225], v28 offset:16384
ds_read_b64_tr_b16 a[226:227], v28 offset:20480
v_mfma_f32_16x16x32_bf16 a[164:167], a[228:231], v[144:147], 0
v_exp_f32 v84, v84
v_mfma_f32_16x16x32_bf16 a[168:171], a[232:235], v[144:147], 0
ds_read_b64_tr_b16 a[228:229], v29 offset:16384
ds_read_b64_tr_b16 a[230:231], v29 offset:20480
v_mfma_f32_16x16x32_bf16 a[172:175], a[236:239], v[144:147], 0
v_cvt_pk_bf16_f32 v81, v82, v83
v_mfma_f32_16x16x32_bf16 a[176:179], a[240:243], v[144:147], 0
ds_read_b64_tr_b16 a[232:233], v30 offset:16384
ds_read_b64_tr_b16 a[234:235], v30 offset:20480
v_lshlrev_b32 v178, 7, v42
v_mfma_f32_16x16x32_bf16 a[180:183], a[244:247], v[144:147], 0
v_exp_f32 v85, v85
v_mfma_f32_16x16x32_bf16 a[184:187], a[248:251], v[144:147], 0
buffer_load_dword v178, v178, s[52:55], s0 offen
ds_read_b64_tr_b16 a[236:237], v31 offset:16384
ds_read_b64_tr_b16 a[238:239], v31 offset:20480
v_mfma_f32_16x16x32_bf16 a[188:191], a[252:255], v[144:147], 0
v_exp_f32 v86, v86
v_mfma_f32_16x16x32_bf16 v[156:159], v[48:51], v[144:147], 0
buffer_load_dwordx4 v7, s[24:27], s75 offen offset:1024 nt lds
ds_read_b64_tr_b16 a[240:241], v44 offset:16384
ds_read_b64_tr_b16 a[242:243], v44 offset:20480
v_mfma_f32_16x16x32_bf16 v[144:147], a[192:195], v[128:131], 0
v_cvt_pk_bf16_f32 v82, v84, v85
v_exp_f32 v112, v112
v_mfma_f32_16x16x32_bf16 v[148:151], a[208:211], v[128:131], 0
ds_read_b64_tr_b16 a[244:245], v45 offset:16384
ds_read_b64_tr_b16 a[246:247], v45 offset:20480
v_mfma_f32_16x16x32_bf16 v[144:147], a[196:199], v[132:135], v[144:147]
v_exp_f32 v87, v87
v_mfma_f32_16x16x32_bf16 v[148:151], a[212:215], v[132:135], v[148:151]
ds_read_b64_tr_b16 a[248:249], v46 offset:16384
ds_read_b64_tr_b16 a[250:251], v46 offset:20480
v_mfma_f32_16x16x32_bf16 v[144:147], a[200:203], v[136:139], v[144:147]
v_cvt_pk_bf16_f32 v83, v86, v87
v_exp_f32 v113, v113
v_mfma_f32_16x16x32_bf16 v[148:151], a[216:219], v[136:139], v[148:151]
ds_read_b64_tr_b16 a[252:253], v47 offset:16384
ds_read_b64_tr_b16 a[254:255], v47 offset:20480
v_mfma_f32_16x16x32_bf16 v[144:147], a[204:207], v[140:143], v[144:147]
v_exp_f32 v114, v114
v_cvt_pk_bf16_f32 v112, v112, v113
v_mfma_f32_16x16x32_bf16 v[148:151], a[220:223], v[140:143], v[148:151]
buffer_load_dwordx4 v8, s[24:27], s75 offen offset:2048 nt lds
v_exp_f32 v115, v115
s_waitcnt lgkmcnt(4)
v_mfma_f32_16x16x32_bf16 a[0:3], a[224:227], v[80:83], a[0:3]
v_mfma_f32_16x16x32_bf16 a[4:7], a[228:231], v[80:83], a[4:7]
v_exp_f32 v116, v116
v_mfma_f32_16x16x32_bf16 a[8:11], a[232:235], v[80:83], a[8:11]
v_mfma_f32_16x16x32_bf16 a[12:15], a[236:239], v[80:83], a[12:15]
v_cvt_pk_bf16_f32 v113, v114, v115
v_mfma_f32_16x16x32_bf16 a[16:19], a[240:243], v[80:83], a[16:19]
v_mfma_f32_16x16x32_bf16 a[20:23], a[244:247], v[80:83], a[20:23]
v_exp_f32 v117, v117
s_waitcnt lgkmcnt(0)
v_mfma_f32_16x16x32_bf16 a[24:27], a[248:251], v[80:83], a[24:27]
v_mfma_f32_16x16x32_bf16 a[28:31], a[252:255], v[80:83], a[28:31]
buffer_load_dwordx4 v9, s[24:27], s75 offen offset:3072 nt lds
v_exp_f32 v118, v118
v_mfma_f32_16x16x32_bf16 v[88:91], v[48:51], v[80:83], v[88:91]
v_mfma_f32_16x16x32_bf16 v[80:83], a[192:195], v[160:163], 0
v_cvt_pk_bf16_f32 v114, v116, v117
v_exp_f32 v144, v144
v_mfma_f32_16x16x32_bf16 v[84:87], a[208:211], v[160:163], 0
v_exp_f32 v145, v145
v_mfma_f32_16x16x32_bf16 v[80:83], a[196:199], v[164:167], v[80:83]
v_exp_f32 v119, v119
v_mfma_f32_16x16x32_bf16 v[84:87], a[212:215], v[164:167], v[84:87]
v_exp_f32 v146, v146
v_mfma_f32_16x16x32_bf16 v[80:83], a[200:203], v[168:171], v[80:83]
v_cvt_pk_bf16_f32 v115, v118, v119
v_mfma_f32_16x16x32_bf16 v[84:87], a[216:219], v[168:171], v[84:87]
v_cvt_pk_bf16_f32 v144, v144, v145
v_mfma_f32_16x16x32_bf16 v[80:83], a[204:207], v[172:175], v[80:83]
v_mfma_f32_16x16x32_bf16 v[84:87], a[220:223], v[172:175], v[84:87]
v_exp_f32 v147, v147
v_mfma_f32_16x16x32_bf16 a[32:35], a[224:227], v[112:115], a[32:35]
v_mfma_f32_16x16x32_bf16 a[36:39], a[228:231], v[112:115], a[36:39]
v_exp_f32 v148, v148
v_mfma_f32_16x16x32_bf16 a[40:43], a[232:235], v[112:115], a[40:43]
v_mfma_f32_16x16x32_bf16 a[44:47], a[236:239], v[112:115], a[44:47]
v_cvt_pk_bf16_f32 v145, v146, v147
v_mfma_f32_16x16x32_bf16 a[48:51], a[240:243], v[112:115], a[48:51]
v_mfma_f32_16x16x32_bf16 a[52:55], a[244:247], v[112:115], a[52:55]
v_exp_f32 v149, v149
v_mfma_f32_16x16x32_bf16 a[56:59], a[248:251], v[112:115], a[56:59]
v_mfma_f32_16x16x32_bf16 a[60:63], a[252:255], v[112:115], a[60:63]
v_exp_f32 v150, v150
v_mfma_f32_16x16x32_bf16 v[92:95], v[48:51], v[112:115], v[92:95]
v_mfma_f32_16x16x32_bf16 v[112:115], a[192:195], v[192:195], 0
v_cvt_pk_bf16_f32 v146, v148, v149
v_exp_f32 v80, v80
v_mfma_f32_16x16x32_bf16 v[116:119], a[208:211], v[192:195], 0
v_exp_f32 v81, v81
v_mfma_f32_16x16x32_bf16 v[112:115], a[196:199], v[196:199], v[112:115]
v_exp_f32 v151, v151
v_mfma_f32_16x16x32_bf16 v[116:119], a[212:215], v[196:199], v[116:119]
v_exp_f32 v82, v82
v_mfma_f32_16x16x32_bf16 v[112:115], a[200:203], v[200:203], v[112:115]
v_cvt_pk_bf16_f32 v147, v150, v151
v_mfma_f32_16x16x32_bf16 v[116:119], a[216:219], v[200:203], v[116:119]
v_cvt_pk_bf16_f32 v80, v80, v81
v_mfma_f32_16x16x32_bf16 v[112:115], a[204:207], v[204:207], v[112:115]
v_mfma_f32_16x16x32_bf16 v[116:119], a[220:223], v[204:207], v[116:119]
v_exp_f32 v83, v83
v_mfma_f32_16x16x32_bf16 a[64:67], a[224:227], v[144:147], a[64:67]
s_waitcnt vmcnt(25)
s_barrier
v_mfma_f32_16x16x32_bf16 a[68:71], a[228:231], v[144:147], a[68:71]
s_add_u32 s76, s76, 8192
v_exp_f32 v84, v84
v_mfma_f32_16x16x32_bf16 a[72:75], a[232:235], v[144:147], a[72:75]
s_and_b32 s76, s76, 131071
v_mfma_f32_16x16x32_bf16 a[76:79], a[236:239], v[144:147], a[76:79]
s_add_u32 m0, s77, 81920
v_cvt_pk_bf16_f32 v81, v82, v83
v_mfma_f32_16x16x32_bf16 a[80:83], a[240:243], v[144:147], a[80:83]
buffer_load_dwordx4 v10, s[28:31], s76 offen nt lds
v_mfma_f32_16x16x32_bf16 a[84:87], a[244:247], v[144:147], a[84:87]
v_exp_f32 v85, v85
v_mfma_f32_16x16x32_bf16 a[88:91], a[248:251], v[144:147], a[88:91]
v_mfma_f32_16x16x32_bf16 a[92:95], a[252:255], v[144:147], a[92:95]
v_exp_f32 v86, v86
v_mfma_f32_16x16x32_bf16 v[120:123], v[48:51], v[144:147], v[120:123]
v_mfma_f32_16x16x32_bf16 v[144:147], a[192:195], v[224:227], 0
ds_read_b64 a[192:193], v20 offset:32768
ds_read_b64 a[194:195], v21 offset:32768
v_cvt_pk_bf16_f32 v82, v84, v85
v_mfma_f32_16x16x32_bf16 v[148:151], a[208:211], v[224:227], 0
v_exp_f32 v112, v112
v_mfma_f32_16x16x32_bf16 v[144:147], a[196:199], v[228:231], v[144:147]
ds_read_b64 a[208:209], v20 offset:36864
ds_read_b64 a[210:211], v21 offset:36864
v_mfma_f32_16x16x32_bf16 v[148:151], a[212:215], v[228:231], v[148:151]
buffer_load_dwordx4 v19, s[28:31], s76 offen offset:1024 nt lds
v_exp_f32 v87, v87
v_mfma_f32_16x16x32_bf16 v[144:147], a[200:203], v[232:235], v[144:147]
ds_read_b64 a[196:197], v22 offset:32768
ds_read_b64 a[198:199], v23 offset:32768
v_cvt_pk_bf16_f32 v83, v86, v87
v_mfma_f32_16x16x32_bf16 v[148:151], a[216:219], v[232:235], v[148:151]
v_exp_f32 v113, v113
v_mfma_f32_16x16x32_bf16 v[144:147], a[204:207], v[236:239], v[144:147]
ds_read_b64 a[212:213], v22 offset:36864
ds_read_b64 a[214:215], v23 offset:36864
v_mfma_f32_16x16x32_bf16 v[148:151], a[220:223], v[236:239], v[148:151]
v_exp_f32 v114, v114
v_cvt_pk_bf16_f32 v112, v112, v113
v_mfma_f32_16x16x32_bf16 a[96:99], a[224:227], v[80:83], a[96:99]
ds_read_b64 a[200:201], v24 offset:32768
ds_read_b64 a[202:203], v25 offset:32768
v_mfma_f32_16x16x32_bf16 a[100:103], a[228:231], v[80:83], a[100:103]
v_exp_f32 v115, v115
v_mfma_f32_16x16x32_bf16 a[104:107], a[232:235], v[80:83], a[104:107]
ds_read_b64 a[216:217], v24 offset:36864
ds_read_b64 a[218:219], v25 offset:36864
v_mfma_f32_16x16x32_bf16 a[108:111], a[236:239], v[80:83], a[108:111]
buffer_load_dwordx4 v10, s[28:31], s76 offen offset:2048 nt lds
v_exp_f32 v116, v116
v_mfma_f32_16x16x32_bf16 a[112:115], a[240:243], v[80:83], a[112:115]
ds_read_b64 a[204:205], v26 offset:32768
ds_read_b64 a[206:207], v27 offset:32768
v_cvt_pk_bf16_f32 v113, v114, v115
v_mfma_f32_16x16x32_bf16 a[116:119], a[244:247], v[80:83], a[116:119]
v_exp_f32 v117, v117
v_mfma_f32_16x16x32_bf16 a[120:123], a[248:251], v[80:83], a[120:123]
ds_read_b64 a[220:221], v26 offset:36864
ds_read_b64 a[222:223], v27 offset:36864
v_mfma_f32_16x16x32_bf16 a[124:127], a[252:255], v[80:83], a[124:127]
v_exp_f32 v118, v118
v_mfma_f32_16x16x32_bf16 v[124:127], v[48:51], v[80:83], v[124:127]
s_waitcnt lgkmcnt(4)
v_mfma_f32_16x16x32_bf16 v[80:83], a[192:195], v[64:67], 0
v_cvt_pk_bf16_f32 v114, v116, v117
v_exp_f32 v144, v144
v_mfma_f32_16x16x32_bf16 v[84:87], a[208:211], v[64:67], 0
v_exp_f32 v145, v145
v_mfma_f32_16x16x32_bf16 v[80:83], a[196:199], v[68:71], v[80:83]
buffer_load_dwordx4 v19, s[28:31], s76 offen offset:3072 nt lds
v_exp_f32 v119, v119
v_mfma_f32_16x16x32_bf16 v[84:87], a[212:215], v[68:71], v[84:87]
v_exp_f32 v146, v146
v_mfma_f32_16x16x32_bf16 v[80:83], a[200:203], v[72:75], v[80:83]
v_cvt_pk_bf16_f32 v115, v118, v119
v_mfma_f32_16x16x32_bf16 v[84:87], a[216:219], v[72:75], v[84:87]
v_cvt_pk_bf16_f32 v144, v144, v145
s_waitcnt lgkmcnt(0)
v_mfma_f32_16x16x32_bf16 v[80:83], a[204:207], v[76:79], v[80:83]
v_mfma_f32_16x16x32_bf16 v[84:87], a[220:223], v[76:79], v[84:87]
v_exp_f32 v147, v147
v_mfma_f32_16x16x32_bf16 a[128:131], a[224:227], v[112:115], a[128:131]
v_mfma_f32_16x16x32_bf16 a[132:135], a[228:231], v[112:115], a[132:135]
v_exp_f32 v148, v148
v_mfma_f32_16x16x32_bf16 a[136:139], a[232:235], v[112:115], a[136:139]
s_waitcnt vmcnt(21)
s_barrier
v_mfma_f32_16x16x32_bf16 a[140:143], a[236:239], v[112:115], a[140:143]
s_add_u32 s75, s75, 8192
v_cvt_pk_bf16_f32 v145, v146, v147
v_mfma_f32_16x16x32_bf16 a[144:147], a[240:243], v[112:115], a[144:147]
s_and_b32 s75, s75, 131071
v_mfma_f32_16x16x32_bf16 a[148:151], a[244:247], v[112:115], a[148:151]
s_add_u32 m0, s77, 32768
v_exp_f32 v149, v149
v_mfma_f32_16x16x32_bf16 a[152:155], a[248:251], v[112:115], a[152:155]
buffer_load_dwordx4 v6, s[24:27], s75 offen nt lds
v_mfma_f32_16x16x32_bf16 a[156:159], a[252:255], v[112:115], a[156:159]
v_exp_f32 v150, v150
v_mfma_f32_16x16x32_bf16 v[152:155], v[48:51], v[112:115], v[152:155]
v_mfma_f32_16x16x32_bf16 v[112:115], a[192:195], v[96:99], 0
v_cvt_pk_bf16_f32 v146, v148, v149
v_exp_f32 v80, v80
v_mfma_f32_16x16x32_bf16 v[116:119], a[208:211], v[96:99], 0
v_exp_f32 v81, v81
v_mfma_f32_16x16x32_bf16 v[112:115], a[196:199], v[100:103], v[112:115]
v_exp_f32 v151, v151
v_mfma_f32_16x16x32_bf16 v[116:119], a[212:215], v[100:103], v[116:119]
v_exp_f32 v82, v82
v_mfma_f32_16x16x32_bf16 v[112:115], a[200:203], v[104:107], v[112:115]
v_cvt_pk_bf16_f32 v147, v150, v151
v_mfma_f32_16x16x32_bf16 v[116:119], a[216:219], v[104:107], v[116:119]
v_cvt_pk_bf16_f32 v80, v80, v81
v_mfma_f32_16x16x32_bf16 v[112:115], a[204:207], v[108:111], v[112:115]
v_mfma_f32_16x16x32_bf16 v[116:119], a[220:223], v[108:111], v[116:119]
v_exp_f32 v83, v83
v_mfma_f32_16x16x32_bf16 a[160:163], a[224:227], v[144:147], a[160:163]
ds_read_b64_tr_b16 a[224:225], v28 offset:32768
ds_read_b64_tr_b16 a[226:227], v28 offset:36864
v_mfma_f32_16x16x32_bf16 a[164:167], a[228:231], v[144:147], a[164:167]
buffer_load_dwordx4 v7, s[24:27], s75 offen offset:1024 nt lds
v_exp_f32 v84, v84
v_mfma_f32_16x16x32_bf16 a[168:171], a[232:235], v[144:147], a[168:171]
ds_read_b64_tr_b16 a[228:229], v29 offset:32768
ds_read_b64_tr_b16 a[230:231], v29 offset:36864
v_mfma_f32_16x16x32_bf16 a[172:175], a[236:239], v[144:147], a[172:175]
v_cvt_pk_bf16_f32 v81, v82, v83
v_mfma_f32_16x16x32_bf16 a[176:179], a[240:243], v[144:147], a[176:179]
ds_read_b64_tr_b16 a[232:233], v30 offset:32768
ds_read_b64_tr_b16 a[234:235], v30 offset:36864
v_mfma_f32_16x16x32_bf16 a[180:183], a[244:247], v[144:147], a[180:183]
v_exp_f32 v85, v85
v_mfma_f32_16x16x32_bf16 a[184:187], a[248:251], v[144:147], a[184:187]
ds_read_b64_tr_b16 a[236:237], v31 offset:32768
ds_read_b64_tr_b16 a[238:239], v31 offset:36864
v_mfma_f32_16x16x32_bf16 a[188:191], a[252:255], v[144:147], a[188:191]
v_exp_f32 v86, v86
v_mfma_f32_16x16x32_bf16 v[156:159], v[48:51], v[144:147], v[156:159]
ds_read_b64_tr_b16 a[240:241], v44 offset:32768
ds_read_b64_tr_b16 a[242:243], v44 offset:36864
v_mfma_f32_16x16x32_bf16 v[144:147], a[192:195], v[128:131], 0
v_cvt_pk_bf16_f32 v82, v84, v85
v_exp_f32 v112, v112
v_mfma_f32_16x16x32_bf16 v[148:151], a[208:211], v[128:131], 0
ds_read_b64_tr_b16 a[244:245], v45 offset:32768
ds_read_b64_tr_b16 a[246:247], v45 offset:36864
v_mfma_f32_16x16x32_bf16 v[144:147], a[196:199], v[132:135], v[144:147]
v_exp_f32 v87, v87
v_mfma_f32_16x16x32_bf16 v[148:151], a[212:215], v[132:135], v[148:151]
ds_read_b64_tr_b16 a[248:249], v46 offset:32768
ds_read_b64_tr_b16 a[250:251], v46 offset:36864
v_mfma_f32_16x16x32_bf16 v[144:147], a[200:203], v[136:139], v[144:147]
buffer_load_dwordx4 v8, s[24:27], s75 offen offset:2048 nt lds
v_cvt_pk_bf16_f32 v83, v86, v87
v_mfma_f32_16x16x32_bf16 v[148:151], a[216:219], v[136:139], v[148:151]
ds_read_b64_tr_b16 a[252:253], v47 offset:32768
ds_read_b64_tr_b16 a[254:255], v47 offset:36864
v_mfma_f32_16x16x32_bf16 v[144:147], a[204:207], v[140:143], v[144:147]
v_exp_f32 v113, v113
v_mfma_f32_16x16x32_bf16 v[148:151], a[220:223], v[140:143], v[148:151]
v_exp_f32 v114, v114
v_cvt_pk_bf16_f32 v112, v112, v113
s_waitcnt lgkmcnt(4)
v_mfma_f32_16x16x32_bf16 a[0:3], a[224:227], v[80:83], a[0:3]
v_exp_f32 v115, v115
v_mfma_f32_16x16x32_bf16 a[4:7], a[228:231], v[80:83], a[4:7]
v_exp_f32 v116, v116
v_mfma_f32_16x16x32_bf16 a[8:11], a[232:235], v[80:83], a[8:11]
v_mfma_f32_16x16x32_bf16 a[12:15], a[236:239], v[80:83], a[12:15]
v_cvt_pk_bf16_f32 v113, v114, v115
v_mfma_f32_16x16x32_bf16 a[16:19], a[240:243], v[80:83], a[16:19]
v_mfma_f32_16x16x32_bf16 a[20:23], a[244:247], v[80:83], a[20:23]
v_exp_f32 v117, v117
s_waitcnt lgkmcnt(0)
v_mfma_f32_16x16x32_bf16 a[24:27], a[248:251], v[80:83], a[24:27]
v_mfma_f32_16x16x32_bf16 a[28:31], a[252:255], v[80:83], a[28:31]
v_exp_f32 v118, v118
v_mfma_f32_16x16x32_bf16 v[88:91], v[48:51], v[80:83], v[88:91]
buffer_load_dwordx4 v9, s[24:27], s75 offen offset:3072 nt lds
v_mfma_f32_16x16x32_bf16 v[80:83], a[192:195], v[160:163], 0
v_cvt_pk_bf16_f32 v114, v116, v117
v_exp_f32 v144, v144
v_mfma_f32_16x16x32_bf16 v[84:87], a[208:211], v[160:163], 0
v_exp_f32 v145, v145
v_mfma_f32_16x16x32_bf16 v[80:83], a[196:199], v[164:167], v[80:83]
v_exp_f32 v119, v119
v_mfma_f32_16x16x32_bf16 v[84:87], a[212:215], v[164:167], v[84:87]
v_exp_f32 v146, v146
v_mfma_f32_16x16x32_bf16 v[80:83], a[200:203], v[168:171], v[80:83]
v_cvt_pk_bf16_f32 v115, v118, v119
v_mfma_f32_16x16x32_bf16 v[84:87], a[216:219], v[168:171], v[84:87]
v_cvt_pk_bf16_f32 v144, v144, v145
v_mfma_f32_16x16x32_bf16 v[80:83], a[204:207], v[172:175], v[80:83]
v_mfma_f32_16x16x32_bf16 v[84:87], a[220:223], v[172:175], v[84:87]
v_exp_f32 v147, v147
v_mfma_f32_16x16x32_bf16 a[32:35], a[224:227], v[112:115], a[32:35]
v_mfma_f32_16x16x32_bf16 a[36:39], a[228:231], v[112:115], a[36:39]
v_exp_f32 v148, v148
v_mfma_f32_16x16x32_bf16 a[40:43], a[232:235], v[112:115], a[40:43]
v_mfma_f32_16x16x32_bf16 a[44:47], a[236:239], v[112:115], a[44:47]
v_cvt_pk_bf16_f32 v145, v146, v147
v_mfma_f32_16x16x32_bf16 a[48:51], a[240:243], v[112:115], a[48:51]
v_mfma_f32_16x16x32_bf16 a[52:55], a[244:247], v[112:115], a[52:55]
v_exp_f32 v149, v149
v_mfma_f32_16x16x32_bf16 a[56:59], a[248:251], v[112:115], a[56:59]
v_mfma_f32_16x16x32_bf16 a[60:63], a[252:255], v[112:115], a[60:63]
v_exp_f32 v150, v150
v_mfma_f32_16x16x32_bf16 v[92:95], v[48:51], v[112:115], v[92:95]
v_mfma_f32_16x16x32_bf16 v[112:115], a[192:195], v[192:195], 0
v_cvt_pk_bf16_f32 v146, v148, v149
v_exp_f32 v80, v80
v_mfma_f32_16x16x32_bf16 v[116:119], a[208:211], v[192:195], 0
v_exp_f32 v81, v81
v_mfma_f32_16x16x32_bf16 v[112:115], a[196:199], v[196:199], v[112:115]
v_exp_f32 v151, v151
v_mfma_f32_16x16x32_bf16 v[116:119], a[212:215], v[196:199], v[116:119]
v_exp_f32 v82, v82
v_mfma_f32_16x16x32_bf16 v[112:115], a[200:203], v[200:203], v[112:115]
v_cvt_pk_bf16_f32 v147, v150, v151
v_mfma_f32_16x16x32_bf16 v[116:119], a[216:219], v[200:203], v[116:119]
v_cvt_pk_bf16_f32 v80, v80, v81
v_mfma_f32_16x16x32_bf16 v[112:115], a[204:207], v[204:207], v[112:115]
v_mfma_f32_16x16x32_bf16 v[116:119], a[220:223], v[204:207], v[116:119]
v_exp_f32 v83, v83
v_mfma_f32_16x16x32_bf16 a[64:67], a[224:227], v[144:147], a[64:67]
s_barrier
v_mfma_f32_16x16x32_bf16 a[68:71], a[228:231], v[144:147], a[68:71]
s_add_u32 s76, s76, 8192
v_exp_f32 v84, v84
v_mfma_f32_16x16x32_bf16 a[72:75], a[232:235], v[144:147], a[72:75]
s_and_b32 s76, s76, 131071
v_mfma_f32_16x16x32_bf16 a[76:79], a[236:239], v[144:147], a[76:79]
s_add_u32 m0, s77, 98304
v_cvt_pk_bf16_f32 v81, v82, v83
v_mfma_f32_16x16x32_bf16 a[80:83], a[240:243], v[144:147], a[80:83]
buffer_load_dwordx4 v10, s[28:31], s76 offen nt lds
v_mfma_f32_16x16x32_bf16 a[84:87], a[244:247], v[144:147], a[84:87]
v_exp_f32 v85, v85
v_mfma_f32_16x16x32_bf16 a[88:91], a[248:251], v[144:147], a[88:91]
v_mfma_f32_16x16x32_bf16 a[92:95], a[252:255], v[144:147], a[92:95]
v_exp_f32 v86, v86
v_mfma_f32_16x16x32_bf16 v[120:123], v[48:51], v[144:147], v[120:123]
v_mfma_f32_16x16x32_bf16 v[144:147], a[192:195], v[224:227], 0
ds_read_b64 a[192:193], v20 offset:49152
ds_read_b64 a[194:195], v21 offset:49152
v_cvt_pk_bf16_f32 v82, v84, v85
v_mfma_f32_16x16x32_bf16 v[148:151], a[208:211], v[224:227], 0
v_exp_f32 v112, v112
v_mfma_f32_16x16x32_bf16 v[144:147], a[196:199], v[228:231], v[144:147]
ds_read_b64 a[208:209], v20 offset:53248
ds_read_b64 a[210:211], v21 offset:53248
v_mfma_f32_16x16x32_bf16 v[148:151], a[212:215], v[228:231], v[148:151]
buffer_load_dwordx4 v19, s[28:31], s76 offen offset:1024 nt lds
v_exp_f32 v87, v87
v_mfma_f32_16x16x32_bf16 v[144:147], a[200:203], v[232:235], v[144:147]
ds_read_b64 a[196:197], v22 offset:49152
ds_read_b64 a[198:199], v23 offset:49152
v_cvt_pk_bf16_f32 v83, v86, v87
v_mfma_f32_16x16x32_bf16 v[148:151], a[216:219], v[232:235], v[148:151]
v_exp_f32 v113, v113
v_mfma_f32_16x16x32_bf16 v[144:147], a[204:207], v[236:239], v[144:147]
ds_read_b64 a[212:213], v22 offset:53248
ds_read_b64 a[214:215], v23 offset:53248
v_mfma_f32_16x16x32_bf16 v[148:151], a[220:223], v[236:239], v[148:151]
v_exp_f32 v114, v114
v_cvt_pk_bf16_f32 v112, v112, v113
v_mfma_f32_16x16x32_bf16 a[96:99], a[224:227], v[80:83], a[96:99]
ds_read_b64 a[200:201], v24 offset:49152
ds_read_b64 a[202:203], v25 offset:49152
v_mfma_f32_16x16x32_bf16 a[100:103], a[228:231], v[80:83], a[100:103]
v_exp_f32 v115, v115
v_mfma_f32_16x16x32_bf16 a[104:107], a[232:235], v[80:83], a[104:107]
ds_read_b64 a[216:217], v24 offset:53248
ds_read_b64 a[218:219], v25 offset:53248
v_mfma_f32_16x16x32_bf16 a[108:111], a[236:239], v[80:83], a[108:111]
buffer_load_dwordx4 v10, s[28:31], s76 offen offset:2048 nt lds
v_exp_f32 v116, v116
v_mfma_f32_16x16x32_bf16 a[112:115], a[240:243], v[80:83], a[112:115]
ds_read_b64 a[204:205], v26 offset:49152
ds_read_b64 a[206:207], v27 offset:49152
v_cvt_pk_bf16_f32 v113, v114, v115
v_mfma_f32_16x16x32_bf16 a[116:119], a[244:247], v[80:83], a[116:119]
v_exp_f32 v117, v117
v_mfma_f32_16x16x32_bf16 a[120:123], a[248:251], v[80:83], a[120:123]
ds_read_b64 a[220:221], v26 offset:53248
ds_read_b64 a[222:223], v27 offset:53248
v_mfma_f32_16x16x32_bf16 a[124:127], a[252:255], v[80:83], a[124:127]
v_exp_f32 v118, v118
v_mfma_f32_16x16x32_bf16 v[124:127], v[48:51], v[80:83], v[124:127]
s_waitcnt lgkmcnt(4)
v_mfma_f32_16x16x32_bf16 v[80:83], a[192:195], v[64:67], 0
v_cvt_pk_bf16_f32 v114, v116, v117
v_exp_f32 v144, v144
v_mfma_f32_16x16x32_bf16 v[84:87], a[208:211], v[64:67], 0
v_exp_f32 v145, v145
v_mfma_f32_16x16x32_bf16 v[80:83], a[196:199], v[68:71], v[80:83]
buffer_load_dwordx4 v19, s[28:31], s76 offen offset:3072 nt lds
v_exp_f32 v119, v119
v_mfma_f32_16x16x32_bf16 v[84:87], a[212:215], v[68:71], v[84:87]
v_exp_f32 v146, v146
v_mfma_f32_16x16x32_bf16 v[80:83], a[200:203], v[72:75], v[80:83]
v_cvt_pk_bf16_f32 v115, v118, v119
v_mfma_f32_16x16x32_bf16 v[84:87], a[216:219], v[72:75], v[84:87]
v_cvt_pk_bf16_f32 v144, v144, v145
s_waitcnt lgkmcnt(0)
v_mfma_f32_16x16x32_bf16 v[80:83], a[204:207], v[76:79], v[80:83]
v_mfma_f32_16x16x32_bf16 v[84:87], a[220:223], v[76:79], v[84:87]
v_exp_f32 v147, v147
v_mfma_f32_16x16x32_bf16 a[128:131], a[224:227], v[112:115], a[128:131]
v_mfma_f32_16x16x32_bf16 a[132:135], a[228:231], v[112:115], a[132:135]
v_exp_f32 v148, v148
v_mfma_f32_16x16x32_bf16 a[136:139], a[232:235], v[112:115], a[136:139]
s_waitcnt vmcnt(25)
s_barrier
v_mfma_f32_16x16x32_bf16 a[140:143], a[236:239], v[112:115], a[140:143]
s_add_u32 s75, s75, 8192
v_cvt_pk_bf16_f32 v145, v146, v147
v_mfma_f32_16x16x32_bf16 a[144:147], a[240:243], v[112:115], a[144:147]
s_and_b32 s75, s75, 131071
v_mfma_f32_16x16x32_bf16 a[148:151], a[244:247], v[112:115], a[148:151]
s_add_u32 m0, s77, 49152
v_exp_f32 v149, v149
v_mfma_f32_16x16x32_bf16 a[152:155], a[248:251], v[112:115], a[152:155]
buffer_load_dwordx4 v6, s[24:27], s75 offen nt lds
v_mfma_f32_16x16x32_bf16 a[156:159], a[252:255], v[112:115], a[156:159]
v_exp_f32 v150, v150
v_mfma_f32_16x16x32_bf16 v[152:155], v[48:51], v[112:115], v[152:155]
v_mfma_f32_16x16x32_bf16 v[112:115], a[192:195], v[96:99], 0
v_cvt_pk_bf16_f32 v146, v148, v149
v_exp_f32 v80, v80
v_mfma_f32_16x16x32_bf16 v[116:119], a[208:211], v[96:99], 0
v_exp_f32 v81, v81
v_mfma_f32_16x16x32_bf16 v[112:115], a[196:199], v[100:103], v[112:115]
v_exp_f32 v151, v151
v_mfma_f32_16x16x32_bf16 v[116:119], a[212:215], v[100:103], v[116:119]
v_exp_f32 v82, v82
v_mfma_f32_16x16x32_bf16 v[112:115], a[200:203], v[104:107], v[112:115]
v_cvt_pk_bf16_f32 v147, v150, v151
v_mfma_f32_16x16x32_bf16 v[116:119], a[216:219], v[104:107], v[116:119]
v_cvt_pk_bf16_f32 v80, v80, v81
v_mfma_f32_16x16x32_bf16 v[112:115], a[204:207], v[108:111], v[112:115]
v_mfma_f32_16x16x32_bf16 v[116:119], a[220:223], v[108:111], v[116:119]
v_exp_f32 v83, v83
v_mfma_f32_16x16x32_bf16 a[160:163], a[224:227], v[144:147], a[160:163]
ds_read_b64_tr_b16 a[224:225], v28 offset:49152
ds_read_b64_tr_b16 a[226:227], v28 offset:53248
v_mfma_f32_16x16x32_bf16 a[164:167], a[228:231], v[144:147], a[164:167]
buffer_load_dwordx4 v7, s[24:27], s75 offen offset:1024 nt lds
v_exp_f32 v84, v84
v_mfma_f32_16x16x32_bf16 a[168:171], a[232:235], v[144:147], a[168:171]
ds_read_b64_tr_b16 a[228:229], v29 offset:49152
ds_read_b64_tr_b16 a[230:231], v29 offset:53248
v_mfma_f32_16x16x32_bf16 a[172:175], a[236:239], v[144:147], a[172:175]
v_cvt_pk_bf16_f32 v81, v82, v83
v_mfma_f32_16x16x32_bf16 a[176:179], a[240:243], v[144:147], a[176:179]
ds_read_b64_tr_b16 a[232:233], v30 offset:49152
ds_read_b64_tr_b16 a[234:235], v30 offset:53248
v_mfma_f32_16x16x32_bf16 a[180:183], a[244:247], v[144:147], a[180:183]
v_exp_f32 v85, v85
v_mfma_f32_16x16x32_bf16 a[184:187], a[248:251], v[144:147], a[184:187]
ds_read_b64_tr_b16 a[236:237], v31 offset:49152
ds_read_b64_tr_b16 a[238:239], v31 offset:53248
v_mfma_f32_16x16x32_bf16 a[188:191], a[252:255], v[144:147], a[188:191]
v_exp_f32 v86, v86
v_mfma_f32_16x16x32_bf16 v[156:159], v[48:51], v[144:147], v[156:159]
ds_read_b64_tr_b16 a[240:241], v44 offset:49152
ds_read_b64_tr_b16 a[242:243], v44 offset:53248
v_mfma_f32_16x16x32_bf16 v[144:147], a[192:195], v[128:131], 0
v_cvt_pk_bf16_f32 v82, v84, v85
v_exp_f32 v112, v112
v_mfma_f32_16x16x32_bf16 v[148:151], a[208:211], v[128:131], 0
ds_read_b64_tr_b16 a[244:245], v45 offset:49152
ds_read_b64_tr_b16 a[246:247], v45 offset:53248
v_mfma_f32_16x16x32_bf16 v[144:147], a[196:199], v[132:135], v[144:147]
v_exp_f32 v87, v87
v_mfma_f32_16x16x32_bf16 v[148:151], a[212:215], v[132:135], v[148:151]
ds_read_b64_tr_b16 a[248:249], v46 offset:49152
ds_read_b64_tr_b16 a[250:251], v46 offset:53248
v_mfma_f32_16x16x32_bf16 v[144:147], a[200:203], v[136:139], v[144:147]
buffer_load_dwordx4 v8, s[24:27], s75 offen offset:2048 nt lds
v_cvt_pk_bf16_f32 v83, v86, v87
v_mfma_f32_16x16x32_bf16 v[148:151], a[216:219], v[136:139], v[148:151]
ds_read_b64_tr_b16 a[252:253], v47 offset:49152
ds_read_b64_tr_b16 a[254:255], v47 offset:53248
v_mfma_f32_16x16x32_bf16 v[144:147], a[204:207], v[140:143], v[144:147]
v_exp_f32 v113, v113
v_mfma_f32_16x16x32_bf16 v[148:151], a[220:223], v[140:143], v[148:151]
v_exp_f32 v114, v114
v_cvt_pk_bf16_f32 v112, v112, v113
s_waitcnt lgkmcnt(4)
v_mfma_f32_16x16x32_bf16 a[0:3], a[224:227], v[80:83], a[0:3]
v_exp_f32 v115, v115
v_mfma_f32_16x16x32_bf16 a[4:7], a[228:231], v[80:83], a[4:7]
v_exp_f32 v116, v116
v_mfma_f32_16x16x32_bf16 a[8:11], a[232:235], v[80:83], a[8:11]
v_mfma_f32_16x16x32_bf16 a[12:15], a[236:239], v[80:83], a[12:15]
v_cvt_pk_bf16_f32 v113, v114, v115
v_mfma_f32_16x16x32_bf16 a[16:19], a[240:243], v[80:83], a[16:19]
v_mfma_f32_16x16x32_bf16 a[20:23], a[244:247], v[80:83], a[20:23]
v_exp_f32 v117, v117
s_waitcnt lgkmcnt(0)
v_mfma_f32_16x16x32_bf16 a[24:27], a[248:251], v[80:83], a[24:27]
v_mfma_f32_16x16x32_bf16 a[28:31], a[252:255], v[80:83], a[28:31]
v_exp_f32 v118, v118
v_mfma_f32_16x16x32_bf16 v[88:91], v[48:51], v[80:83], v[88:91]
buffer_load_dwordx4 v9, s[24:27], s75 offen offset:3072 nt lds
v_mfma_f32_16x16x32_bf16 v[80:83], a[192:195], v[160:163], 0
v_cvt_pk_bf16_f32 v114, v116, v117
v_exp_f32 v144, v144
v_mfma_f32_16x16x32_bf16 v[84:87], a[208:211], v[160:163], 0
v_exp_f32 v145, v145
v_mfma_f32_16x16x32_bf16 v[80:83], a[196:199], v[164:167], v[80:83]
v_exp_f32 v119, v119
v_mfma_f32_16x16x32_bf16 v[84:87], a[212:215], v[164:167], v[84:87]
v_exp_f32 v146, v146
v_mfma_f32_16x16x32_bf16 v[80:83], a[200:203], v[168:171], v[80:83]
v_cvt_pk_bf16_f32 v115, v118, v119
v_mfma_f32_16x16x32_bf16 v[84:87], a[216:219], v[168:171], v[84:87]
v_cvt_pk_bf16_f32 v144, v144, v145
v_mfma_f32_16x16x32_bf16 v[80:83], a[204:207], v[172:175], v[80:83]
v_mfma_f32_16x16x32_bf16 v[84:87], a[220:223], v[172:175], v[84:87]
v_exp_f32 v147, v147
v_mfma_f32_16x16x32_bf16 a[32:35], a[224:227], v[112:115], a[32:35]
v_mfma_f32_16x16x32_bf16 a[36:39], a[228:231], v[112:115], a[36:39]
v_exp_f32 v148, v148
v_mfma_f32_16x16x32_bf16 a[40:43], a[232:235], v[112:115], a[40:43]
v_mfma_f32_16x16x32_bf16 a[44:47], a[236:239], v[112:115], a[44:47]
v_cvt_pk_bf16_f32 v145, v146, v147
v_mfma_f32_16x16x32_bf16 a[48:51], a[240:243], v[112:115], a[48:51]
v_mfma_f32_16x16x32_bf16 a[52:55], a[244:247], v[112:115], a[52:55]
v_exp_f32 v149, v149
v_mfma_f32_16x16x32_bf16 a[56:59], a[248:251], v[112:115], a[56:59]
v_mfma_f32_16x16x32_bf16 a[60:63], a[252:255], v[112:115], a[60:63]
v_exp_f32 v150, v150
v_mfma_f32_16x16x32_bf16 v[92:95], v[48:51], v[112:115], v[92:95]
v_mfma_f32_16x16x32_bf16 v[112:115], a[192:195], v[192:195], 0
v_cvt_pk_bf16_f32 v146, v148, v149
v_exp_f32 v80, v80
v_mfma_f32_16x16x32_bf16 v[116:119], a[208:211], v[192:195], 0
v_exp_f32 v81, v81
v_mfma_f32_16x16x32_bf16 v[112:115], a[196:199], v[196:199], v[112:115]
v_exp_f32 v151, v151
v_mfma_f32_16x16x32_bf16 v[116:119], a[212:215], v[196:199], v[116:119]
v_exp_f32 v82, v82
v_mfma_f32_16x16x32_bf16 v[112:115], a[200:203], v[200:203], v[112:115]
v_cvt_pk_bf16_f32 v147, v150, v151
v_mfma_f32_16x16x32_bf16 v[116:119], a[216:219], v[200:203], v[116:119]
v_cvt_pk_bf16_f32 v80, v80, v81
v_mfma_f32_16x16x32_bf16 v[112:115], a[204:207], v[204:207], v[112:115]
v_mfma_f32_16x16x32_bf16 v[116:119], a[220:223], v[204:207], v[116:119]
v_exp_f32 v83, v83
v_mfma_f32_16x16x32_bf16 a[64:67], a[224:227], v[144:147], a[64:67]
s_waitcnt vmcnt(25)
s_barrier
v_mfma_f32_16x16x32_bf16 a[68:71], a[228:231], v[144:147], a[68:71]
s_add_u32 s76, s76, 8192
v_exp_f32 v84, v84
v_mfma_f32_16x16x32_bf16 a[72:75], a[232:235], v[144:147], a[72:75]
s_and_b32 s76, s76, 131071
v_mfma_f32_16x16x32_bf16 a[76:79], a[236:239], v[144:147], a[76:79]
s_add_u32 m0, s77, 114688
v_cvt_pk_bf16_f32 v81, v82, v83
v_mfma_f32_16x16x32_bf16 a[80:83], a[240:243], v[144:147], a[80:83]
buffer_load_dwordx4 v10, s[28:31], s76 offen nt lds
v_mfma_f32_16x16x32_bf16 a[84:87], a[244:247], v[144:147], a[84:87]
v_exp_f32 v85, v85
v_mfma_f32_16x16x32_bf16 a[88:91], a[248:251], v[144:147], a[88:91]
v_mfma_f32_16x16x32_bf16 a[92:95], a[252:255], v[144:147], a[92:95]
v_exp_f32 v86, v86
v_mfma_f32_16x16x32_bf16 v[120:123], v[48:51], v[144:147], v[120:123]
v_mfma_f32_16x16x32_bf16 v[144:147], a[192:195], v[224:227], 0
ds_read_b64 a[192:193], v20
ds_read_b64 a[194:195], v21
v_cvt_pk_bf16_f32 v82, v84, v85
v_mfma_f32_16x16x32_bf16 v[148:151], a[208:211], v[224:227], 0
v_exp_f32 v112, v112
v_mfma_f32_16x16x32_bf16 v[144:147], a[196:199], v[228:231], v[144:147]
ds_read_b64 a[208:209], v20 offset:4096
ds_read_b64 a[210:211], v21 offset:4096
v_mfma_f32_16x16x32_bf16 v[148:151], a[212:215], v[228:231], v[148:151]
buffer_load_dwordx4 v19, s[28:31], s76 offen offset:1024 nt lds
v_exp_f32 v87, v87
v_mfma_f32_16x16x32_bf16 v[144:147], a[200:203], v[232:235], v[144:147]
ds_read_b64 a[196:197], v22
ds_read_b64 a[198:199], v23
v_cvt_pk_bf16_f32 v83, v86, v87
v_mfma_f32_16x16x32_bf16 v[148:151], a[216:219], v[232:235], v[148:151]
v_exp_f32 v113, v113
v_mfma_f32_16x16x32_bf16 v[144:147], a[204:207], v[236:239], v[144:147]
ds_read_b64 a[212:213], v22 offset:4096
ds_read_b64 a[214:215], v23 offset:4096
v_mfma_f32_16x16x32_bf16 v[148:151], a[220:223], v[236:239], v[148:151]
v_exp_f32 v114, v114
v_cvt_pk_bf16_f32 v112, v112, v113
v_mfma_f32_16x16x32_bf16 a[96:99], a[224:227], v[80:83], a[96:99]
ds_read_b64 a[200:201], v24
ds_read_b64 a[202:203], v25
v_mfma_f32_16x16x32_bf16 a[100:103], a[228:231], v[80:83], a[100:103]
v_exp_f32 v115, v115
v_mfma_f32_16x16x32_bf16 a[104:107], a[232:235], v[80:83], a[104:107]
ds_read_b64 a[216:217], v24 offset:4096
ds_read_b64 a[218:219], v25 offset:4096
v_mfma_f32_16x16x32_bf16 a[108:111], a[236:239], v[80:83], a[108:111]
buffer_load_dwordx4 v10, s[28:31], s76 offen offset:2048 nt lds
v_exp_f32 v116, v116
v_mfma_f32_16x16x32_bf16 a[112:115], a[240:243], v[80:83], a[112:115]
ds_read_b64 a[204:205], v26
ds_read_b64 a[206:207], v27
v_cvt_pk_bf16_f32 v113, v114, v115
v_mfma_f32_16x16x32_bf16 a[116:119], a[244:247], v[80:83], a[116:119]
v_exp_f32 v117, v117
v_mfma_f32_16x16x32_bf16 a[120:123], a[248:251], v[80:83], a[120:123]
ds_read_b64 a[220:221], v26 offset:4096
ds_read_b64 a[222:223], v27 offset:4096
v_mfma_f32_16x16x32_bf16 a[124:127], a[252:255], v[80:83], a[124:127]
v_exp_f32 v118, v118
v_mfma_f32_16x16x32_bf16 v[124:127], v[48:51], v[80:83], v[124:127]
s_waitcnt lgkmcnt(4)
v_mfma_f32_16x16x32_bf16 v[80:83], a[192:195], v[64:67], 0
v_cvt_pk_bf16_f32 v114, v116, v117
v_exp_f32 v144, v144
v_mfma_f32_16x16x32_bf16 v[84:87], a[208:211], v[64:67], 0
v_exp_f32 v145, v145
v_mfma_f32_16x16x32_bf16 v[80:83], a[196:199], v[68:71], v[80:83]
buffer_load_dwordx4 v19, s[28:31], s76 offen offset:3072 nt lds
v_exp_f32 v119, v119
v_mfma_f32_16x16x32_bf16 v[84:87], a[212:215], v[68:71], v[84:87]
v_exp_f32 v146, v146
v_mfma_f32_16x16x32_bf16 v[80:83], a[200:203], v[72:75], v[80:83]
v_cvt_pk_bf16_f32 v115, v118, v119
v_mfma_f32_16x16x32_bf16 v[84:87], a[216:219], v[72:75], v[84:87]
v_cvt_pk_bf16_f32 v144, v144, v145
s_waitcnt lgkmcnt(0)
v_mfma_f32_16x16x32_bf16 v[80:83], a[204:207], v[76:79], v[80:83]
v_mfma_f32_16x16x32_bf16 v[84:87], a[220:223], v[76:79], v[84:87]
v_exp_f32 v147, v147
v_mfma_f32_16x16x32_bf16 a[128:131], a[224:227], v[112:115], a[128:131]
v_mfma_f32_16x16x32_bf16 a[132:135], a[228:231], v[112:115], a[132:135]
v_exp_f32 v148, v148
v_mfma_f32_16x16x32_bf16 a[136:139], a[232:235], v[112:115], a[136:139]
s_waitcnt vmcnt(25)
s_barrier
v_mfma_f32_16x16x32_bf16 a[140:143], a[236:239], v[112:115], a[140:143]
s_add_u32 s75, s75, 8192
v_cvt_pk_bf16_f32 v145, v146, v147
v_mfma_f32_16x16x32_bf16 a[144:147], a[240:243], v[112:115], a[144:147]
s_and_b32 s75, s75, 131071
v_mfma_f32_16x16x32_bf16 a[148:151], a[244:247], v[112:115], a[148:151]
s_add_u32 m0, s77, 0
v_exp_f32 v149, v149
v_mfma_f32_16x16x32_bf16 a[152:155], a[248:251], v[112:115], a[152:155]
buffer_load_dwordx4 v6, s[24:27], s75 offen nt lds
v_mfma_f32_16x16x32_bf16 a[156:159], a[252:255], v[112:115], a[156:159]
v_exp_f32 v150, v150
v_mfma_f32_16x16x32_bf16 v[152:155], v[48:51], v[112:115], v[152:155]
v_mfma_f32_16x16x32_bf16 v[112:115], a[192:195], v[96:99], 0
v_cvt_pk_bf16_f32 v146, v148, v149
v_exp_f32 v80, v80
v_mfma_f32_16x16x32_bf16 v[116:119], a[208:211], v[96:99], 0
v_exp_f32 v81, v81
v_mfma_f32_16x16x32_bf16 v[112:115], a[196:199], v[100:103], v[112:115]
v_exp_f32 v151, v151
v_mfma_f32_16x16x32_bf16 v[116:119], a[212:215], v[100:103], v[116:119]
v_exp_f32 v82, v82
v_mfma_f32_16x16x32_bf16 v[112:115], a[200:203], v[104:107], v[112:115]
v_cvt_pk_bf16_f32 v147, v150, v151
v_mfma_f32_16x16x32_bf16 v[116:119], a[216:219], v[104:107], v[116:119]
v_cvt_pk_bf16_f32 v80, v80, v81
v_mfma_f32_16x16x32_bf16 v[112:115], a[204:207], v[108:111], v[112:115]
v_mfma_f32_16x16x32_bf16 v[116:119], a[220:223], v[108:111], v[116:119]
v_exp_f32 v83, v83
v_mfma_f32_16x16x32_bf16 a[160:163], a[224:227], v[144:147], a[160:163]
ds_read_b64_tr_b16 a[224:225], v28
ds_read_b64_tr_b16 a[226:227], v28 offset:4096
v_mfma_f32_16x16x32_bf16 a[164:167], a[228:231], v[144:147], a[164:167]
buffer_load_dwordx4 v7, s[24:27], s75 offen offset:1024 nt lds
v_exp_f32 v84, v84
v_mfma_f32_16x16x32_bf16 a[168:171], a[232:235], v[144:147], a[168:171]
ds_read_b64_tr_b16 a[228:229], v29
ds_read_b64_tr_b16 a[230:231], v29 offset:4096
v_mfma_f32_16x16x32_bf16 a[172:175], a[236:239], v[144:147], a[172:175]
v_cvt_pk_bf16_f32 v81, v82, v83
v_mfma_f32_16x16x32_bf16 a[176:179], a[240:243], v[144:147], a[176:179]
ds_read_b64_tr_b16 a[232:233], v30
ds_read_b64_tr_b16 a[234:235], v30 offset:4096
v_mfma_f32_16x16x32_bf16 a[180:183], a[244:247], v[144:147], a[180:183]
v_exp_f32 v85, v85
v_mfma_f32_16x16x32_bf16 a[184:187], a[248:251], v[144:147], a[184:187]
ds_read_b64_tr_b16 a[236:237], v31
ds_read_b64_tr_b16 a[238:239], v31 offset:4096
v_mfma_f32_16x16x32_bf16 a[188:191], a[252:255], v[144:147], a[188:191]
v_exp_f32 v86, v86
v_mfma_f32_16x16x32_bf16 v[156:159], v[48:51], v[144:147], v[156:159]
ds_read_b64_tr_b16 a[240:241], v44
ds_read_b64_tr_b16 a[242:243], v44 offset:4096
v_mfma_f32_16x16x32_bf16 v[144:147], a[192:195], v[128:131], 0
v_cvt_pk_bf16_f32 v82, v84, v85
v_exp_f32 v112, v112
v_mfma_f32_16x16x32_bf16 v[148:151], a[208:211], v[128:131], 0
ds_read_b64_tr_b16 a[244:245], v45
ds_read_b64_tr_b16 a[246:247], v45 offset:4096
v_mfma_f32_16x16x32_bf16 v[144:147], a[196:199], v[132:135], v[144:147]
v_exp_f32 v87, v87
v_mfma_f32_16x16x32_bf16 v[148:151], a[212:215], v[132:135], v[148:151]
ds_read_b64_tr_b16 a[248:249], v46
ds_read_b64_tr_b16 a[250:251], v46 offset:4096
v_mfma_f32_16x16x32_bf16 v[144:147], a[200:203], v[136:139], v[144:147]
buffer_load_dwordx4 v8, s[24:27], s75 offen offset:2048 nt lds
v_cvt_pk_bf16_f32 v83, v86, v87
v_mfma_f32_16x16x32_bf16 v[148:151], a[216:219], v[136:139], v[148:151]
ds_read_b64_tr_b16 a[252:253], v47
ds_read_b64_tr_b16 a[254:255], v47 offset:4096
v_mfma_f32_16x16x32_bf16 v[144:147], a[204:207], v[140:143], v[144:147]
v_exp_f32 v113, v113
v_mfma_f32_16x16x32_bf16 v[148:151], a[220:223], v[140:143], v[148:151]
v_exp_f32 v114, v114
v_cvt_pk_bf16_f32 v112, v112, v113
s_waitcnt lgkmcnt(4)
v_mfma_f32_16x16x32_bf16 a[0:3], a[224:227], v[80:83], a[0:3]
v_exp_f32 v115, v115
v_mfma_f32_16x16x32_bf16 a[4:7], a[228:231], v[80:83], a[4:7]
v_exp_f32 v116, v116
v_mfma_f32_16x16x32_bf16 a[8:11], a[232:235], v[80:83], a[8:11]
v_mfma_f32_16x16x32_bf16 a[12:15], a[236:239], v[80:83], a[12:15]
v_cvt_pk_bf16_f32 v113, v114, v115
v_mfma_f32_16x16x32_bf16 a[16:19], a[240:243], v[80:83], a[16:19]
v_mfma_f32_16x16x32_bf16 a[20:23], a[244:247], v[80:83], a[20:23]
v_exp_f32 v117, v117
s_waitcnt lgkmcnt(0)
v_mfma_f32_16x16x32_bf16 a[24:27], a[248:251], v[80:83], a[24:27]
v_mfma_f32_16x16x32_bf16 a[28:31], a[252:255], v[80:83], a[28:31]
v_exp_f32 v118, v118
v_mfma_f32_16x16x32_bf16 v[88:91], v[48:51], v[80:83], v[88:91]
buffer_load_dwordx4 v9, s[24:27], s75 offen offset:3072 nt lds
v_mfma_f32_16x16x32_bf16 v[80:83], a[192:195], v[160:163], 0
v_cvt_pk_bf16_f32 v114, v116, v117
v_exp_f32 v144, v144
v_mfma_f32_16x16x32_bf16 v[84:87], a[208:211], v[160:163], 0
v_exp_f32 v145, v145
v_mfma_f32_16x16x32_bf16 v[80:83], a[196:199], v[164:167], v[80:83]
v_exp_f32 v119, v119
v_mfma_f32_16x16x32_bf16 v[84:87], a[212:215], v[164:167], v[84:87]
v_exp_f32 v146, v146
v_mfma_f32_16x16x32_bf16 v[80:83], a[200:203], v[168:171], v[80:83]
v_cvt_pk_bf16_f32 v115, v118, v119
v_mfma_f32_16x16x32_bf16 v[84:87], a[216:219], v[168:171], v[84:87]
v_cvt_pk_bf16_f32 v144, v144, v145
v_mfma_f32_16x16x32_bf16 v[80:83], a[204:207], v[172:175], v[80:83]
v_mfma_f32_16x16x32_bf16 v[84:87], a[220:223], v[172:175], v[84:87]
v_exp_f32 v147, v147
v_mfma_f32_16x16x32_bf16 a[32:35], a[224:227], v[112:115], a[32:35]
v_mfma_f32_16x16x32_bf16 a[36:39], a[228:231], v[112:115], a[36:39]
v_exp_f32 v148, v148
v_mfma_f32_16x16x32_bf16 a[40:43], a[232:235], v[112:115], a[40:43]
v_mfma_f32_16x16x32_bf16 a[44:47], a[236:239], v[112:115], a[44:47]
v_cvt_pk_bf16_f32 v145, v146, v147
v_mfma_f32_16x16x32_bf16 a[48:51], a[240:243], v[112:115], a[48:51]
v_mfma_f32_16x16x32_bf16 a[52:55], a[244:247], v[112:115], a[52:55]
v_exp_f32 v149, v149
v_mfma_f32_16x16x32_bf16 a[56:59], a[248:251], v[112:115], a[56:59]
v_mfma_f32_16x16x32_bf16 a[60:63], a[252:255], v[112:115], a[60:63]
v_exp_f32 v150, v150
v_mfma_f32_16x16x32_bf16 v[92:95], v[48:51], v[112:115], v[92:95]
v_mfma_f32_16x16x32_bf16 v[112:115], a[192:195], v[192:195], 0
v_cvt_pk_bf16_f32 v146, v148, v149
v_exp_f32 v80, v80
v_mfma_f32_16x16x32_bf16 v[116:119], a[208:211], v[192:195], 0
v_exp_f32 v81, v81
v_mfma_f32_16x16x32_bf16 v[112:115], a[196:199], v[196:199], v[112:115]
v_exp_f32 v151, v151
v_mfma_f32_16x16x32_bf16 v[116:119], a[212:215], v[196:199], v[116:119]
v_exp_f32 v82, v82
v_mfma_f32_16x16x32_bf16 v[112:115], a[200:203], v[200:203], v[112:115]
v_cvt_pk_bf16_f32 v147, v150, v151
v_mfma_f32_16x16x32_bf16 v[116:119], a[216:219], v[200:203], v[116:119]
v_cvt_pk_bf16_f32 v80, v80, v81
v_mfma_f32_16x16x32_bf16 v[112:115], a[204:207], v[204:207], v[112:115]
v_mfma_f32_16x16x32_bf16 v[116:119], a[220:223], v[204:207], v[116:119]
v_exp_f32 v83, v83
v_mfma_f32_16x16x32_bf16 a[64:67], a[224:227], v[144:147], a[64:67]
s_waitcnt vmcnt(24)
s_barrier
v_mfma_f32_16x16x32_bf16 a[68:71], a[228:231], v[144:147], a[68:71]
s_add_u32 s76, s76, 8192
v_exp_f32 v84, v84
v_mfma_f32_16x16x32_bf16 a[72:75], a[232:235], v[144:147], a[72:75]
s_and_b32 s76, s76, 131071
v_mfma_f32_16x16x32_bf16 a[76:79], a[236:239], v[144:147], a[76:79]
s_add_u32 m0, s77, 65536
v_cvt_pk_bf16_f32 v81, v82, v83
v_mfma_f32_16x16x32_bf16 a[80:83], a[240:243], v[144:147], a[80:83]
buffer_load_dwordx4 v10, s[28:31], s76 offen nt lds
v_mfma_f32_16x16x32_bf16 a[84:87], a[244:247], v[144:147], a[84:87]
v_exp_f32 v85, v85
v_mfma_f32_16x16x32_bf16 a[88:91], a[248:251], v[144:147], a[88:91]
v_mfma_f32_16x16x32_bf16 a[92:95], a[252:255], v[144:147], a[92:95]
v_exp_f32 v86, v86
v_mfma_f32_16x16x32_bf16 v[120:123], v[48:51], v[144:147], v[120:123]
v_mfma_f32_16x16x32_bf16 v[144:147], a[192:195], v[224:227], 0
ds_read_b64 a[192:193], v20 offset:16384
ds_read_b64 a[194:195], v21 offset:16384
v_cvt_pk_bf16_f32 v82, v84, v85
v_mfma_f32_16x16x32_bf16 v[148:151], a[208:211], v[224:227], 0
v_exp_f32 v112, v112
v_mfma_f32_16x16x32_bf16 v[144:147], a[196:199], v[228:231], v[144:147]
ds_read_b64 a[208:209], v20 offset:20480
ds_read_b64 a[210:211], v21 offset:20480
v_mfma_f32_16x16x32_bf16 v[148:151], a[212:215], v[228:231], v[148:151]
buffer_load_dwordx4 v19, s[28:31], s76 offen offset:1024 nt lds
v_exp_f32 v87, v87
v_mfma_f32_16x16x32_bf16 v[144:147], a[200:203], v[232:235], v[144:147]
ds_read_b64 a[196:197], v22 offset:16384
ds_read_b64 a[198:199], v23 offset:16384
v_cvt_pk_bf16_f32 v83, v86, v87
v_mfma_f32_16x16x32_bf16 v[148:151], a[216:219], v[232:235], v[148:151]
v_exp_f32 v113, v113
v_mfma_f32_16x16x32_bf16 v[144:147], a[204:207], v[236:239], v[144:147]
ds_read_b64 a[212:213], v22 offset:20480
ds_read_b64 a[214:215], v23 offset:20480
v_mfma_f32_16x16x32_bf16 v[148:151], a[220:223], v[236:239], v[148:151]
v_exp_f32 v114, v114
v_cvt_pk_bf16_f32 v112, v112, v113
v_mfma_f32_16x16x32_bf16 a[96:99], a[224:227], v[80:83], a[96:99]
ds_read_b64 a[200:201], v24 offset:16384
ds_read_b64 a[202:203], v25 offset:16384
v_mfma_f32_16x16x32_bf16 a[100:103], a[228:231], v[80:83], a[100:103]
v_exp_f32 v115, v115
v_mfma_f32_16x16x32_bf16 a[104:107], a[232:235], v[80:83], a[104:107]
ds_read_b64 a[216:217], v24 offset:20480
ds_read_b64 a[218:219], v25 offset:20480
v_mfma_f32_16x16x32_bf16 a[108:111], a[236:239], v[80:83], a[108:111]
buffer_load_dwordx4 v10, s[28:31], s76 offen offset:2048 nt lds
v_exp_f32 v116, v116
v_mfma_f32_16x16x32_bf16 a[112:115], a[240:243], v[80:83], a[112:115]
ds_read_b64 a[204:205], v26 offset:16384
ds_read_b64 a[206:207], v27 offset:16384
v_cvt_pk_bf16_f32 v113, v114, v115
v_mfma_f32_16x16x32_bf16 a[116:119], a[244:247], v[80:83], a[116:119]
v_exp_f32 v117, v117
v_mfma_f32_16x16x32_bf16 a[120:123], a[248:251], v[80:83], a[120:123]
ds_read_b64 a[220:221], v26 offset:20480
ds_read_b64 a[222:223], v27 offset:20480
v_mfma_f32_16x16x32_bf16 a[124:127], a[252:255], v[80:83], a[124:127]
v_exp_f32 v118, v118
v_mfma_f32_16x16x32_bf16 v[124:127], v[48:51], v[80:83], v[124:127]
s_waitcnt lgkmcnt(4)
v_mfma_f32_16x16x32_bf16 v[80:83], a[192:195], v[64:67], 0
v_cvt_pk_bf16_f32 v114, v116, v117
v_exp_f32 v144, v144
v_mfma_f32_16x16x32_bf16 v[84:87], a[208:211], v[64:67], 0
v_exp_f32 v145, v145
v_mfma_f32_16x16x32_bf16 v[80:83], a[196:199], v[68:71], v[80:83]
buffer_load_dwordx4 v19, s[28:31], s76 offen offset:3072 nt lds
v_exp_f32 v119, v119
v_mfma_f32_16x16x32_bf16 v[84:87], a[212:215], v[68:71], v[84:87]
v_exp_f32 v146, v146
v_mfma_f32_16x16x32_bf16 v[80:83], a[200:203], v[72:75], v[80:83]
v_cvt_pk_bf16_f32 v115, v118, v119
v_mfma_f32_16x16x32_bf16 v[84:87], a[216:219], v[72:75], v[84:87]
v_cvt_pk_bf16_f32 v144, v144, v145
s_waitcnt lgkmcnt(0)
v_mfma_f32_16x16x32_bf16 v[80:83], a[204:207], v[76:79], v[80:83]
v_mfma_f32_16x16x32_bf16 v[84:87], a[220:223], v[76:79], v[84:87]
v_exp_f32 v147, v147
v_mfma_f32_16x16x32_bf16 a[128:131], a[224:227], v[112:115], a[128:131]
v_mfma_f32_16x16x32_bf16 a[132:135], a[228:231], v[112:115], a[132:135]
v_exp_f32 v148, v148
v_mfma_f32_16x16x32_bf16 a[136:139], a[232:235], v[112:115], a[136:139]
s_waitcnt vmcnt(24)
s_barrier
v_mfma_f32_16x16x32_bf16 a[140:143], a[236:239], v[112:115], a[140:143]
s_add_u32 s75, s75, 8192
v_cvt_pk_bf16_f32 v145, v146, v147
v_mfma_f32_16x16x32_bf16 a[144:147], a[240:243], v[112:115], a[144:147]
s_and_b32 s75, s75, 131071
v_mfma_f32_16x16x32_bf16 a[148:151], a[244:247], v[112:115], a[148:151]
s_add_u32 m0, s77, 16384
v_exp_f32 v149, v149
v_mfma_f32_16x16x32_bf16 a[152:155], a[248:251], v[112:115], a[152:155]
buffer_load_dwordx4 v6, s[24:27], s75 offen nt lds
v_mfma_f32_16x16x32_bf16 a[156:159], a[252:255], v[112:115], a[156:159]
v_exp_f32 v150, v150
v_mfma_f32_16x16x32_bf16 v[152:155], v[48:51], v[112:115], v[152:155]
v_mfma_f32_16x16x32_bf16 v[112:115], a[192:195], v[96:99], 0
v_cvt_pk_bf16_f32 v146, v148, v149
v_exp_f32 v80, v80
v_mfma_f32_16x16x32_bf16 v[116:119], a[208:211], v[96:99], 0
v_exp_f32 v81, v81
v_mfma_f32_16x16x32_bf16 v[112:115], a[196:199], v[100:103], v[112:115]
v_exp_f32 v151, v151
v_mfma_f32_16x16x32_bf16 v[116:119], a[212:215], v[100:103], v[116:119]
v_exp_f32 v82, v82
v_mfma_f32_16x16x32_bf16 v[112:115], a[200:203], v[104:107], v[112:115]
v_cvt_pk_bf16_f32 v147, v150, v151
v_mfma_f32_16x16x32_bf16 v[116:119], a[216:219], v[104:107], v[116:119]
v_cvt_pk_bf16_f32 v80, v80, v81
v_mfma_f32_16x16x32_bf16 v[112:115], a[204:207], v[108:111], v[112:115]
v_mfma_f32_16x16x32_bf16 v[116:119], a[220:223], v[108:111], v[116:119]
v_exp_f32 v83, v83
v_mfma_f32_16x16x32_bf16 a[160:163], a[224:227], v[144:147], a[160:163]
ds_read_b64_tr_b16 a[224:225], v28 offset:16384
ds_read_b64_tr_b16 a[226:227], v28 offset:20480
v_mfma_f32_16x16x32_bf16 a[164:167], a[228:231], v[144:147], a[164:167]
buffer_load_dwordx4 v7, s[24:27], s75 offen offset:1024 nt lds
v_exp_f32 v84, v84
v_mfma_f32_16x16x32_bf16 a[168:171], a[232:235], v[144:147], a[168:171]
ds_read_b64_tr_b16 a[228:229], v29 offset:16384
ds_read_b64_tr_b16 a[230:231], v29 offset:20480
v_mfma_f32_16x16x32_bf16 a[172:175], a[236:239], v[144:147], a[172:175]
v_cvt_pk_bf16_f32 v81, v82, v83
v_mfma_f32_16x16x32_bf16 a[176:179], a[240:243], v[144:147], a[176:179]
ds_read_b64_tr_b16 a[232:233], v30 offset:16384
ds_read_b64_tr_b16 a[234:235], v30 offset:20480
v_mfma_f32_16x16x32_bf16 a[180:183], a[244:247], v[144:147], a[180:183]
v_exp_f32 v85, v85
v_mfma_f32_16x16x32_bf16 a[184:187], a[248:251], v[144:147], a[184:187]
ds_read_b64_tr_b16 a[236:237], v31 offset:16384
ds_read_b64_tr_b16 a[238:239], v31 offset:20480
v_mfma_f32_16x16x32_bf16 a[188:191], a[252:255], v[144:147], a[188:191]
v_exp_f32 v86, v86
v_mfma_f32_16x16x32_bf16 v[156:159], v[48:51], v[144:147], v[156:159]
ds_read_b64_tr_b16 a[240:241], v44 offset:16384
ds_read_b64_tr_b16 a[242:243], v44 offset:20480
v_mfma_f32_16x16x32_bf16 v[144:147], a[192:195], v[128:131], 0
v_cvt_pk_bf16_f32 v82, v84, v85
v_exp_f32 v112, v112
v_mfma_f32_16x16x32_bf16 v[148:151], a[208:211], v[128:131], 0
ds_read_b64_tr_b16 a[244:245], v45 offset:16384
ds_read_b64_tr_b16 a[246:247], v45 offset:20480
v_mfma_f32_16x16x32_bf16 v[144:147], a[196:199], v[132:135], v[144:147]
v_exp_f32 v87, v87
v_mfma_f32_16x16x32_bf16 v[148:151], a[212:215], v[132:135], v[148:151]
ds_read_b64_tr_b16 a[248:249], v46 offset:16384
ds_read_b64_tr_b16 a[250:251], v46 offset:20480
v_mfma_f32_16x16x32_bf16 v[144:147], a[200:203], v[136:139], v[144:147]
buffer_load_dwordx4 v8, s[24:27], s75 offen offset:2048 nt lds
v_cvt_pk_bf16_f32 v83, v86, v87
v_mfma_f32_16x16x32_bf16 v[148:151], a[216:219], v[136:139], v[148:151]
ds_read_b64_tr_b16 a[252:253], v47 offset:16384
ds_read_b64_tr_b16 a[254:255], v47 offset:20480
v_mfma_f32_16x16x32_bf16 v[144:147], a[204:207], v[140:143], v[144:147]
v_exp_f32 v113, v113
v_mfma_f32_16x16x32_bf16 v[148:151], a[220:223], v[140:143], v[148:151]
v_exp_f32 v114, v114
v_cvt_pk_bf16_f32 v112, v112, v113
s_waitcnt lgkmcnt(4)
v_mfma_f32_16x16x32_bf16 a[0:3], a[224:227], v[80:83], a[0:3]
v_exp_f32 v115, v115
v_mfma_f32_16x16x32_bf16 a[4:7], a[228:231], v[80:83], a[4:7]
v_exp_f32 v116, v116
v_mfma_f32_16x16x32_bf16 a[8:11], a[232:235], v[80:83], a[8:11]
v_mfma_f32_16x16x32_bf16 a[12:15], a[236:239], v[80:83], a[12:15]
v_cvt_pk_bf16_f32 v113, v114, v115
v_mfma_f32_16x16x32_bf16 a[16:19], a[240:243], v[80:83], a[16:19]
v_mfma_f32_16x16x32_bf16 a[20:23], a[244:247], v[80:83], a[20:23]
v_exp_f32 v117, v117
s_waitcnt lgkmcnt(0)
v_mfma_f32_16x16x32_bf16 a[24:27], a[248:251], v[80:83], a[24:27]
v_mfma_f32_16x16x32_bf16 a[28:31], a[252:255], v[80:83], a[28:31]
v_exp_f32 v118, v118
v_mfma_f32_16x16x32_bf16 v[88:91], v[48:51], v[80:83], v[88:91]
buffer_load_dwordx4 v9, s[24:27], s75 offen offset:3072 nt lds
v_mfma_f32_16x16x32_bf16 v[80:83], a[192:195], v[160:163], 0
v_cvt_pk_bf16_f32 v114, v116, v117
v_exp_f32 v144, v144
v_mfma_f32_16x16x32_bf16 v[84:87], a[208:211], v[160:163], 0
v_exp_f32 v145, v145
v_mfma_f32_16x16x32_bf16 v[80:83], a[196:199], v[164:167], v[80:83]
v_exp_f32 v119, v119
v_mfma_f32_16x16x32_bf16 v[84:87], a[212:215], v[164:167], v[84:87]
v_exp_f32 v146, v146
v_mfma_f32_16x16x32_bf16 v[80:83], a[200:203], v[168:171], v[80:83]
v_cvt_pk_bf16_f32 v115, v118, v119
v_mfma_f32_16x16x32_bf16 v[84:87], a[216:219], v[168:171], v[84:87]
v_cvt_pk_bf16_f32 v144, v144, v145
v_mfma_f32_16x16x32_bf16 v[80:83], a[204:207], v[172:175], v[80:83]
v_mfma_f32_16x16x32_bf16 v[84:87], a[220:223], v[172:175], v[84:87]
v_exp_f32 v147, v147
v_mfma_f32_16x16x32_bf16 a[32:35], a[224:227], v[112:115], a[32:35]
v_mfma_f32_16x16x32_bf16 a[36:39], a[228:231], v[112:115], a[36:39]
v_exp_f32 v148, v148
v_mfma_f32_16x16x32_bf16 a[40:43], a[232:235], v[112:115], a[40:43]
v_mfma_f32_16x16x32_bf16 a[44:47], a[236:239], v[112:115], a[44:47]
v_cvt_pk_bf16_f32 v145, v146, v147
v_mfma_f32_16x16x32_bf16 a[48:51], a[240:243], v[112:115], a[48:51]
v_mfma_f32_16x16x32_bf16 a[52:55], a[244:247], v[112:115], a[52:55]
v_exp_f32 v149, v149
v_mfma_f32_16x16x32_bf16 a[56:59], a[248:251], v[112:115], a[56:59]
v_mfma_f32_16x16x32_bf16 a[60:63], a[252:255], v[112:115], a[60:63]
v_exp_f32 v150, v150
v_mfma_f32_16x16x32_bf16 v[92:95], v[48:51], v[112:115], v[92:95]
v_mfma_f32_16x16x32_bf16 v[112:115], a[192:195], v[192:195], 0
v_cvt_pk_bf16_f32 v146, v148, v149
v_exp_f32 v80, v80
v_mfma_f32_16x16x32_bf16 v[116:119], a[208:211], v[192:195], 0
v_exp_f32 v81, v81
v_mfma_f32_16x16x32_bf16 v[112:115], a[196:199], v[196:199], v[112:115]
v_exp_f32 v151, v151
v_mfma_f32_16x16x32_bf16 v[116:119], a[212:215], v[196:199], v[116:119]
v_exp_f32 v82, v82
v_mfma_f32_16x16x32_bf16 v[112:115], a[200:203], v[200:203], v[112:115]
v_cvt_pk_bf16_f32 v147, v150, v151
v_mfma_f32_16x16x32_bf16 v[116:119], a[216:219], v[200:203], v[116:119]
v_cvt_pk_bf16_f32 v80, v80, v81
v_mfma_f32_16x16x32_bf16 v[112:115], a[204:207], v[204:207], v[112:115]
v_mfma_f32_16x16x32_bf16 v[116:119], a[220:223], v[204:207], v[116:119]
v_exp_f32 v83, v83
v_mfma_f32_16x16x32_bf16 a[64:67], a[224:227], v[144:147], a[64:67]
s_waitcnt vmcnt(24)
s_barrier
v_mfma_f32_16x16x32_bf16 a[68:71], a[228:231], v[144:147], a[68:71]
s_add_u32 s76, s76, 8192
v_exp_f32 v84, v84
v_mfma_f32_16x16x32_bf16 a[72:75], a[232:235], v[144:147], a[72:75]
s_and_b32 s76, s76, 131071
v_mfma_f32_16x16x32_bf16 a[76:79], a[236:239], v[144:147], a[76:79]
s_add_u32 m0, s77, 81920
v_cvt_pk_bf16_f32 v81, v82, v83
v_mfma_f32_16x16x32_bf16 a[80:83], a[240:243], v[144:147], a[80:83]
buffer_load_dwordx4 v10, s[28:31], s76 offen nt lds
v_mfma_f32_16x16x32_bf16 a[84:87], a[244:247], v[144:147], a[84:87]
v_exp_f32 v85, v85
v_mfma_f32_16x16x32_bf16 a[88:91], a[248:251], v[144:147], a[88:91]
v_mfma_f32_16x16x32_bf16 a[92:95], a[252:255], v[144:147], a[92:95]
v_exp_f32 v86, v86
v_mfma_f32_16x16x32_bf16 v[120:123], v[48:51], v[144:147], v[120:123]
v_mfma_f32_16x16x32_bf16 v[144:147], a[192:195], v[224:227], 0
ds_read_b64 a[192:193], v20 offset:32768
ds_read_b64 a[194:195], v21 offset:32768
v_cvt_pk_bf16_f32 v82, v84, v85
v_mfma_f32_16x16x32_bf16 v[148:151], a[208:211], v[224:227], 0
v_exp_f32 v112, v112
v_mfma_f32_16x16x32_bf16 v[144:147], a[196:199], v[228:231], v[144:147]
ds_read_b64 a[208:209], v20 offset:36864
ds_read_b64 a[210:211], v21 offset:36864
v_mfma_f32_16x16x32_bf16 v[148:151], a[212:215], v[228:231], v[148:151]
buffer_load_dwordx4 v19, s[28:31], s76 offen offset:1024 nt lds
v_exp_f32 v87, v87
v_mfma_f32_16x16x32_bf16 v[144:147], a[200:203], v[232:235], v[144:147]
ds_read_b64 a[196:197], v22 offset:32768
ds_read_b64 a[198:199], v23 offset:32768
v_cvt_pk_bf16_f32 v83, v86, v87
v_mfma_f32_16x16x32_bf16 v[148:151], a[216:219], v[232:235], v[148:151]
v_exp_f32 v113, v113
v_mfma_f32_16x16x32_bf16 v[144:147], a[204:207], v[236:239], v[144:147]
ds_read_b64 a[212:213], v22 offset:36864
ds_read_b64 a[214:215], v23 offset:36864
v_mfma_f32_16x16x32_bf16 v[148:151], a[220:223], v[236:239], v[148:151]
v_exp_f32 v114, v114
v_cvt_pk_bf16_f32 v112, v112, v113
v_mfma_f32_16x16x32_bf16 a[96:99], a[224:227], v[80:83], a[96:99]
ds_read_b64 a[200:201], v24 offset:32768
ds_read_b64 a[202:203], v25 offset:32768
v_mfma_f32_16x16x32_bf16 a[100:103], a[228:231], v[80:83], a[100:103]
v_exp_f32 v115, v115
v_mfma_f32_16x16x32_bf16 a[104:107], a[232:235], v[80:83], a[104:107]
ds_read_b64 a[216:217], v24 offset:36864
ds_read_b64 a[218:219], v25 offset:36864
v_mfma_f32_16x16x32_bf16 a[108:111], a[236:239], v[80:83], a[108:111]
buffer_load_dwordx4 v10, s[28:31], s76 offen offset:2048 nt lds
v_exp_f32 v116, v116
v_mfma_f32_16x16x32_bf16 a[112:115], a[240:243], v[80:83], a[112:115]
ds_read_b64 a[204:205], v26 offset:32768
ds_read_b64 a[206:207], v27 offset:32768
v_cvt_pk_bf16_f32 v113, v114, v115
v_mfma_f32_16x16x32_bf16 a[116:119], a[244:247], v[80:83], a[116:119]
v_exp_f32 v117, v117
v_mfma_f32_16x16x32_bf16 a[120:123], a[248:251], v[80:83], a[120:123]
ds_read_b64 a[220:221], v26 offset:36864
ds_read_b64 a[222:223], v27 offset:36864
v_mfma_f32_16x16x32_bf16 a[124:127], a[252:255], v[80:83], a[124:127]
v_exp_f32 v118, v118
v_mfma_f32_16x16x32_bf16 v[124:127], v[48:51], v[80:83], v[124:127]
s_waitcnt lgkmcnt(4)
v_mfma_f32_16x16x32_bf16 v[80:83], a[192:195], v[64:67], 0
v_cvt_pk_bf16_f32 v114, v116, v117
v_exp_f32 v144, v144
v_mfma_f32_16x16x32_bf16 v[84:87], a[208:211], v[64:67], 0
v_exp_f32 v145, v145
v_mfma_f32_16x16x32_bf16 v[80:83], a[196:199], v[68:71], v[80:83]
buffer_load_dwordx4 v19, s[28:31], s76 offen offset:3072 nt lds
v_exp_f32 v119, v119
v_mfma_f32_16x16x32_bf16 v[84:87], a[212:215], v[68:71], v[84:87]
v_exp_f32 v146, v146
v_mfma_f32_16x16x32_bf16 v[80:83], a[200:203], v[72:75], v[80:83]
v_cvt_pk_bf16_f32 v115, v118, v119
v_mfma_f32_16x16x32_bf16 v[84:87], a[216:219], v[72:75], v[84:87]
v_cvt_pk_bf16_f32 v144, v144, v145
s_waitcnt lgkmcnt(0)
v_mfma_f32_16x16x32_bf16 v[80:83], a[204:207], v[76:79], v[80:83]
v_mfma_f32_16x16x32_bf16 v[84:87], a[220:223], v[76:79], v[84:87]
v_exp_f32 v147, v147
v_mfma_f32_16x16x32_bf16 a[128:131], a[224:227], v[112:115], a[128:131]
v_mfma_f32_16x16x32_bf16 a[132:135], a[228:231], v[112:115], a[132:135]
v_exp_f32 v148, v148
v_mfma_f32_16x16x32_bf16 a[136:139], a[232:235], v[112:115], a[136:139]
s_waitcnt vmcnt(24)
s_barrier
v_mfma_f32_16x16x32_bf16 a[140:143], a[236:239], v[112:115], a[140:143]
s_add_u32 s75, s75, 8192
v_cvt_pk_bf16_f32 v145, v146, v147
v_mfma_f32_16x16x32_bf16 a[144:147], a[240:243], v[112:115], a[144:147]
s_and_b32 s75, s75, 131071
v_mfma_f32_16x16x32_bf16 a[148:151], a[244:247], v[112:115], a[148:151]
s_add_u32 m0, s77, 32768
v_exp_f32 v149, v149
v_mfma_f32_16x16x32_bf16 a[152:155], a[248:251], v[112:115], a[152:155]
buffer_load_dwordx4 v6, s[24:27], s75 offen nt lds
v_mfma_f32_16x16x32_bf16 a[156:159], a[252:255], v[112:115], a[156:159]
v_exp_f32 v150, v150
v_mfma_f32_16x16x32_bf16 v[152:155], v[48:51], v[112:115], v[152:155]
v_mfma_f32_16x16x32_bf16 v[112:115], a[192:195], v[96:99], 0
v_cvt_pk_bf16_f32 v146, v148, v149
v_exp_f32 v80, v80
v_mfma_f32_16x16x32_bf16 v[116:119], a[208:211], v[96:99], 0
v_exp_f32 v81, v81
v_mfma_f32_16x16x32_bf16 v[112:115], a[196:199], v[100:103], v[112:115]
v_exp_f32 v151, v151
v_mfma_f32_16x16x32_bf16 v[116:119], a[212:215], v[100:103], v[116:119]
v_exp_f32 v82, v82
v_mfma_f32_16x16x32_bf16 v[112:115], a[200:203], v[104:107], v[112:115]
v_cvt_pk_bf16_f32 v147, v150, v151
v_mfma_f32_16x16x32_bf16 v[116:119], a[216:219], v[104:107], v[116:119]
v_cvt_pk_bf16_f32 v80, v80, v81
v_mfma_f32_16x16x32_bf16 v[112:115], a[204:207], v[108:111], v[112:115]
v_mfma_f32_16x16x32_bf16 v[116:119], a[220:223], v[108:111], v[116:119]
v_exp_f32 v83, v83
v_mfma_f32_16x16x32_bf16 a[160:163], a[224:227], v[144:147], a[160:163]
ds_read_b64_tr_b16 a[224:225], v28 offset:32768
ds_read_b64_tr_b16 a[226:227], v28 offset:36864
v_mfma_f32_16x16x32_bf16 a[164:167], a[228:231], v[144:147], a[164:167]
buffer_load_dwordx4 v7, s[24:27], s75 offen offset:1024 nt lds
v_exp_f32 v84, v84
v_mfma_f32_16x16x32_bf16 a[168:171], a[232:235], v[144:147], a[168:171]
ds_read_b64_tr_b16 a[228:229], v29 offset:32768
ds_read_b64_tr_b16 a[230:231], v29 offset:36864
v_mfma_f32_16x16x32_bf16 a[172:175], a[236:239], v[144:147], a[172:175]
v_cvt_pk_bf16_f32 v81, v82, v83
v_mfma_f32_16x16x32_bf16 a[176:179], a[240:243], v[144:147], a[176:179]
ds_read_b64_tr_b16 a[232:233], v30 offset:32768
ds_read_b64_tr_b16 a[234:235], v30 offset:36864
v_mfma_f32_16x16x32_bf16 a[180:183], a[244:247], v[144:147], a[180:183]
v_exp_f32 v85, v85
v_mfma_f32_16x16x32_bf16 a[184:187], a[248:251], v[144:147], a[184:187]
ds_read_b64_tr_b16 a[236:237], v31 offset:32768
ds_read_b64_tr_b16 a[238:239], v31 offset:36864
v_mfma_f32_16x16x32_bf16 a[188:191], a[252:255], v[144:147], a[188:191]
v_exp_f32 v86, v86
v_mfma_f32_16x16x32_bf16 v[156:159], v[48:51], v[144:147], v[156:159]
ds_read_b64_tr_b16 a[240:241], v44 offset:32768
ds_read_b64_tr_b16 a[242:243], v44 offset:36864
v_mfma_f32_16x16x32_bf16 v[144:147], a[192:195], v[128:131], 0
v_cvt_pk_bf16_f32 v82, v84, v85
v_exp_f32 v112, v112
v_mfma_f32_16x16x32_bf16 v[148:151], a[208:211], v[128:131], 0
ds_read_b64_tr_b16 a[244:245], v45 offset:32768
ds_read_b64_tr_b16 a[246:247], v45 offset:36864
v_mfma_f32_16x16x32_bf16 v[144:147], a[196:199], v[132:135], v[144:147]
v_exp_f32 v87, v87
v_mfma_f32_16x16x32_bf16 v[148:151], a[212:215], v[132:135], v[148:151]
ds_read_b64_tr_b16 a[248:249], v46 offset:32768
ds_read_b64_tr_b16 a[250:251], v46 offset:36864
v_mfma_f32_16x16x32_bf16 v[144:147], a[200:203], v[136:139], v[144:147]
buffer_load_dwordx4 v8, s[24:27], s75 offen offset:2048 nt lds
v_cvt_pk_bf16_f32 v83, v86, v87
v_mfma_f32_16x16x32_bf16 v[148:151], a[216:219], v[136:139], v[148:151]
ds_read_b64_tr_b16 a[252:253], v47 offset:32768
ds_read_b64_tr_b16 a[254:255], v47 offset:36864
v_mfma_f32_16x16x32_bf16 v[144:147], a[204:207], v[140:143], v[144:147]
v_exp_f32 v113, v113
v_mfma_f32_16x16x32_bf16 v[148:151], a[220:223], v[140:143], v[148:151]
v_exp_f32 v114, v114
v_cvt_pk_bf16_f32 v112, v112, v113
s_waitcnt lgkmcnt(4)
v_mfma_f32_16x16x32_bf16 a[0:3], a[224:227], v[80:83], a[0:3]
v_exp_f32 v115, v115
v_mfma_f32_16x16x32_bf16 a[4:7], a[228:231], v[80:83], a[4:7]
v_exp_f32 v116, v116
v_mfma_f32_16x16x32_bf16 a[8:11], a[232:235], v[80:83], a[8:11]
v_mfma_f32_16x16x32_bf16 a[12:15], a[236:239], v[80:83], a[12:15]
v_cvt_pk_bf16_f32 v113, v114, v115
v_mfma_f32_16x16x32_bf16 a[16:19], a[240:243], v[80:83], a[16:19]
v_mfma_f32_16x16x32_bf16 a[20:23], a[244:247], v[80:83], a[20:23]
v_exp_f32 v117, v117
s_waitcnt lgkmcnt(0)
v_mfma_f32_16x16x32_bf16 a[24:27], a[248:251], v[80:83], a[24:27]
v_mfma_f32_16x16x32_bf16 a[28:31], a[252:255], v[80:83], a[28:31]
v_exp_f32 v118, v118
v_mfma_f32_16x16x32_bf16 v[88:91], v[48:51], v[80:83], v[88:91]
buffer_load_dwordx4 v9, s[24:27], s75 offen offset:3072 nt lds
v_mfma_f32_16x16x32_bf16 v[80:83], a[192:195], v[160:163], 0
v_cvt_pk_bf16_f32 v114, v116, v117
v_exp_f32 v144, v144
v_mfma_f32_16x16x32_bf16 v[84:87], a[208:211], v[160:163], 0
v_exp_f32 v145, v145
v_mfma_f32_16x16x32_bf16 v[80:83], a[196:199], v[164:167], v[80:83]
v_exp_f32 v119, v119
v_mfma_f32_16x16x32_bf16 v[84:87], a[212:215], v[164:167], v[84:87]
v_exp_f32 v146, v146
v_mfma_f32_16x16x32_bf16 v[80:83], a[200:203], v[168:171], v[80:83]
v_cvt_pk_bf16_f32 v115, v118, v119
v_mfma_f32_16x16x32_bf16 v[84:87], a[216:219], v[168:171], v[84:87]
v_cvt_pk_bf16_f32 v144, v144, v145
v_mfma_f32_16x16x32_bf16 v[80:83], a[204:207], v[172:175], v[80:83]
v_mfma_f32_16x16x32_bf16 v[84:87], a[220:223], v[172:175], v[84:87]
v_exp_f32 v147, v147
v_mfma_f32_16x16x32_bf16 a[32:35], a[224:227], v[112:115], a[32:35]
v_mfma_f32_16x16x32_bf16 a[36:39], a[228:231], v[112:115], a[36:39]
v_exp_f32 v148, v148
v_mfma_f32_16x16x32_bf16 a[40:43], a[232:235], v[112:115], a[40:43]
v_mfma_f32_16x16x32_bf16 a[44:47], a[236:239], v[112:115], a[44:47]
v_cvt_pk_bf16_f32 v145, v146, v147
v_mfma_f32_16x16x32_bf16 a[48:51], a[240:243], v[112:115], a[48:51]
v_mfma_f32_16x16x32_bf16 a[52:55], a[244:247], v[112:115], a[52:55]
v_exp_f32 v149, v149
v_mfma_f32_16x16x32_bf16 a[56:59], a[248:251], v[112:115], a[56:59]
v_mfma_f32_16x16x32_bf16 a[60:63], a[252:255], v[112:115], a[60:63]
v_exp_f32 v150, v150
v_mfma_f32_16x16x32_bf16 v[92:95], v[48:51], v[112:115], v[92:95]
v_mfma_f32_16x16x32_bf16 v[112:115], a[192:195], v[192:195], 0
v_cvt_pk_bf16_f32 v146, v148, v149
v_exp_f32 v80, v80
v_mfma_f32_16x16x32_bf16 v[116:119], a[208:211], v[192:195], 0
v_exp_f32 v81, v81
v_mfma_f32_16x16x32_bf16 v[112:115], a[196:199], v[196:199], v[112:115]
v_exp_f32 v151, v151
v_mfma_f32_16x16x32_bf16 v[116:119], a[212:215], v[196:199], v[116:119]
v_exp_f32 v82, v82
v_mfma_f32_16x16x32_bf16 v[112:115], a[200:203], v[200:203], v[112:115]
v_cvt_pk_bf16_f32 v147, v150, v151
v_mfma_f32_16x16x32_bf16 v[116:119], a[216:219], v[200:203], v[116:119]
v_cvt_pk_bf16_f32 v80, v80, v81
v_mfma_f32_16x16x32_bf16 v[112:115], a[204:207], v[204:207], v[112:115]
v_mfma_f32_16x16x32_bf16 v[116:119], a[220:223], v[204:207], v[116:119]
v_exp_f32 v83, v83
v_mfma_f32_16x16x32_bf16 a[64:67], a[224:227], v[144:147], a[64:67]
s_waitcnt vmcnt(24)
s_barrier
v_mfma_f32_16x16x32_bf16 a[68:71], a[228:231], v[144:147], a[68:71]
s_add_u32 s76, s76, 8192
v_exp_f32 v84, v84
v_mfma_f32_16x16x32_bf16 a[72:75], a[232:235], v[144:147], a[72:75]
s_and_b32 s76, s76, 131071
v_mfma_f32_16x16x32_bf16 a[76:79], a[236:239], v[144:147], a[76:79]
s_add_u32 m0, s77, 98304
v_cvt_pk_bf16_f32 v81, v82, v83
v_mfma_f32_16x16x32_bf16 a[80:83], a[240:243], v[144:147], a[80:83]
buffer_load_dwordx4 v10, s[28:31], s76 offen nt lds
v_mfma_f32_16x16x32_bf16 a[84:87], a[244:247], v[144:147], a[84:87]
v_exp_f32 v85, v85
v_mfma_f32_16x16x32_bf16 a[88:91], a[248:251], v[144:147], a[88:91]
v_mfma_f32_16x16x32_bf16 a[92:95], a[252:255], v[144:147], a[92:95]
v_exp_f32 v86, v86
v_mfma_f32_16x16x32_bf16 v[120:123], v[48:51], v[144:147], v[120:123]
v_mfma_f32_16x16x32_bf16 v[144:147], a[192:195], v[224:227], 0
ds_read_b64 a[192:193], v20 offset:49152
ds_read_b64 a[194:195], v21 offset:49152
v_cvt_pk_bf16_f32 v82, v84, v85
v_mfma_f32_16x16x32_bf16 v[148:151], a[208:211], v[224:227], 0
v_exp_f32 v112, v112
v_mfma_f32_16x16x32_bf16 v[144:147], a[196:199], v[228:231], v[144:147]
ds_read_b64 a[208:209], v20 offset:53248
ds_read_b64 a[210:211], v21 offset:53248
v_mfma_f32_16x16x32_bf16 v[148:151], a[212:215], v[228:231], v[148:151]
buffer_load_dwordx4 v19, s[28:31], s76 offen offset:1024 nt lds
v_exp_f32 v87, v87
v_mfma_f32_16x16x32_bf16 v[144:147], a[200:203], v[232:235], v[144:147]
ds_read_b64 a[196:197], v22 offset:49152
ds_read_b64 a[198:199], v23 offset:49152
v_cvt_pk_bf16_f32 v83, v86, v87
v_mfma_f32_16x16x32_bf16 v[148:151], a[216:219], v[232:235], v[148:151]
v_exp_f32 v113, v113
v_mfma_f32_16x16x32_bf16 v[144:147], a[204:207], v[236:239], v[144:147]
ds_read_b64 a[212:213], v22 offset:53248
ds_read_b64 a[214:215], v23 offset:53248
v_mfma_f32_16x16x32_bf16 v[148:151], a[220:223], v[236:239], v[148:151]
v_exp_f32 v114, v114
v_cvt_pk_bf16_f32 v112, v112, v113
v_mfma_f32_16x16x32_bf16 a[96:99], a[224:227], v[80:83], a[96:99]
ds_read_b64 a[200:201], v24 offset:49152
ds_read_b64 a[202:203], v25 offset:49152
v_mfma_f32_16x16x32_bf16 a[100:103], a[228:231], v[80:83], a[100:103]
v_exp_f32 v115, v115
v_mfma_f32_16x16x32_bf16 a[104:107], a[232:235], v[80:83], a[104:107]
ds_read_b64 a[216:217], v24 offset:53248
ds_read_b64 a[218:219], v25 offset:53248
v_mfma_f32_16x16x32_bf16 a[108:111], a[236:239], v[80:83], a[108:111]
buffer_load_dwordx4 v10, s[28:31], s76 offen offset:2048 nt lds
v_exp_f32 v116, v116
v_mfma_f32_16x16x32_bf16 a[112:115], a[240:243], v[80:83], a[112:115]
ds_read_b64 a[204:205], v26 offset:49152
ds_read_b64 a[206:207], v27 offset:49152
v_cvt_pk_bf16_f32 v113, v114, v115
v_mfma_f32_16x16x32_bf16 a[116:119], a[244:247], v[80:83], a[116:119]
v_exp_f32 v117, v117
v_mfma_f32_16x16x32_bf16 a[120:123], a[248:251], v[80:83], a[120:123]
ds_read_b64 a[220:221], v26 offset:53248
ds_read_b64 a[222:223], v27 offset:53248
v_mfma_f32_16x16x32_bf16 a[124:127], a[252:255], v[80:83], a[124:127]
v_exp_f32 v118, v118
v_mfma_f32_16x16x32_bf16 v[124:127], v[48:51], v[80:83], v[124:127]
s_waitcnt lgkmcnt(4)
v_mfma_f32_16x16x32_bf16 v[80:83], a[192:195], v[64:67], 0
v_cvt_pk_bf16_f32 v114, v116, v117
v_exp_f32 v144, v144
v_mfma_f32_16x16x32_bf16 v[84:87], a[208:211], v[64:67], 0
v_exp_f32 v145, v145
v_mfma_f32_16x16x32_bf16 v[80:83], a[196:199], v[68:71], v[80:83]
buffer_load_dwordx4 v19, s[28:31], s76 offen offset:3072 nt lds
v_exp_f32 v119, v119
v_mfma_f32_16x16x32_bf16 v[84:87], a[212:215], v[68:71], v[84:87]
v_exp_f32 v146, v146
v_mfma_f32_16x16x32_bf16 v[80:83], a[200:203], v[72:75], v[80:83]
v_cvt_pk_bf16_f32 v115, v118, v119
v_mfma_f32_16x16x32_bf16 v[84:87], a[216:219], v[72:75], v[84:87]
v_cvt_pk_bf16_f32 v144, v144, v145
s_waitcnt lgkmcnt(0)
v_mfma_f32_16x16x32_bf16 v[80:83], a[204:207], v[76:79], v[80:83]
v_mfma_f32_16x16x32_bf16 v[84:87], a[220:223], v[76:79], v[84:87]
v_exp_f32 v147, v147
v_mfma_f32_16x16x32_bf16 a[128:131], a[224:227], v[112:115], a[128:131]
v_mfma_f32_16x16x32_bf16 a[132:135], a[228:231], v[112:115], a[132:135]
v_exp_f32 v148, v148
v_mfma_f32_16x16x32_bf16 a[136:139], a[232:235], v[112:115], a[136:139]
s_waitcnt vmcnt(24)
s_barrier
v_mfma_f32_16x16x32_bf16 a[140:143], a[236:239], v[112:115], a[140:143]
s_add_u32 s75, s75, 8192
v_cvt_pk_bf16_f32 v145, v146, v147
v_mfma_f32_16x16x32_bf16 a[144:147], a[240:243], v[112:115], a[144:147]
s_and_b32 s75, s75, 131071
v_mfma_f32_16x16x32_bf16 a[148:151], a[244:247], v[112:115], a[148:151]
s_add_u32 m0, s77, 49152
v_exp_f32 v149, v149
v_mfma_f32_16x16x32_bf16 a[152:155], a[248:251], v[112:115], a[152:155]
buffer_load_dwordx4 v6, s[24:27], s75 offen nt lds
v_mfma_f32_16x16x32_bf16 a[156:159], a[252:255], v[112:115], a[156:159]
v_exp_f32 v150, v150
v_mfma_f32_16x16x32_bf16 v[152:155], v[48:51], v[112:115], v[152:155]
v_mfma_f32_16x16x32_bf16 v[112:115], a[192:195], v[96:99], 0
v_cvt_pk_bf16_f32 v146, v148, v149
v_exp_f32 v80, v80
v_mfma_f32_16x16x32_bf16 v[116:119], a[208:211], v[96:99], 0
v_exp_f32 v81, v81
v_mfma_f32_16x16x32_bf16 v[112:115], a[196:199], v[100:103], v[112:115]
v_exp_f32 v151, v151
v_mfma_f32_16x16x32_bf16 v[116:119], a[212:215], v[100:103], v[116:119]
v_exp_f32 v82, v82
v_mfma_f32_16x16x32_bf16 v[112:115], a[200:203], v[104:107], v[112:115]
v_cvt_pk_bf16_f32 v147, v150, v151
v_mfma_f32_16x16x32_bf16 v[116:119], a[216:219], v[104:107], v[116:119]
v_cvt_pk_bf16_f32 v80, v80, v81
v_mfma_f32_16x16x32_bf16 v[112:115], a[204:207], v[108:111], v[112:115]
v_mfma_f32_16x16x32_bf16 v[116:119], a[220:223], v[108:111], v[116:119]
v_exp_f32 v83, v83
v_mfma_f32_16x16x32_bf16 a[160:163], a[224:227], v[144:147], a[160:163]
ds_read_b64_tr_b16 a[224:225], v28 offset:49152
ds_read_b64_tr_b16 a[226:227], v28 offset:53248
v_mfma_f32_16x16x32_bf16 a[164:167], a[228:231], v[144:147], a[164:167]
buffer_load_dwordx4 v7, s[24:27], s75 offen offset:1024 nt lds
v_exp_f32 v84, v84
v_mfma_f32_16x16x32_bf16 a[168:171], a[232:235], v[144:147], a[168:171]
ds_read_b64_tr_b16 a[228:229], v29 offset:49152
ds_read_b64_tr_b16 a[230:231], v29 offset:53248
v_mfma_f32_16x16x32_bf16 a[172:175], a[236:239], v[144:147], a[172:175]
v_cvt_pk_bf16_f32 v81, v82, v83
v_mfma_f32_16x16x32_bf16 a[176:179], a[240:243], v[144:147], a[176:179]
ds_read_b64_tr_b16 a[232:233], v30 offset:49152
ds_read_b64_tr_b16 a[234:235], v30 offset:53248
v_mfma_f32_16x16x32_bf16 a[180:183], a[244:247], v[144:147], a[180:183]
v_exp_f32 v85, v85
v_mfma_f32_16x16x32_bf16 a[184:187], a[248:251], v[144:147], a[184:187]
ds_read_b64_tr_b16 a[236:237], v31 offset:49152
ds_read_b64_tr_b16 a[238:239], v31 offset:53248
v_mfma_f32_16x16x32_bf16 a[188:191], a[252:255], v[144:147], a[188:191]
v_exp_f32 v86, v86
v_mfma_f32_16x16x32_bf16 v[156:159], v[48:51], v[144:147], v[156:159]
ds_read_b64_tr_b16 a[240:241], v44 offset:49152
ds_read_b64_tr_b16 a[242:243], v44 offset:53248
v_mfma_f32_16x16x32_bf16 v[144:147], a[192:195], v[128:131], 0
v_cvt_pk_bf16_f32 v82, v84, v85
v_exp_f32 v112, v112
v_mfma_f32_16x16x32_bf16 v[148:151], a[208:211], v[128:131], 0
ds_read_b64_tr_b16 a[244:245], v45 offset:49152
ds_read_b64_tr_b16 a[246:247], v45 offset:53248
v_mfma_f32_16x16x32_bf16 v[144:147], a[196:199], v[132:135], v[144:147]
v_exp_f32 v87, v87
v_mfma_f32_16x16x32_bf16 v[148:151], a[212:215], v[132:135], v[148:151]
ds_read_b64_tr_b16 a[248:249], v46 offset:49152
ds_read_b64_tr_b16 a[250:251], v46 offset:53248
v_mfma_f32_16x16x32_bf16 v[144:147], a[200:203], v[136:139], v[144:147]
buffer_load_dwordx4 v8, s[24:27], s75 offen offset:2048 nt lds
v_cvt_pk_bf16_f32 v83, v86, v87
v_mfma_f32_16x16x32_bf16 v[148:151], a[216:219], v[136:139], v[148:151]
ds_read_b64_tr_b16 a[252:253], v47 offset:49152
ds_read_b64_tr_b16 a[254:255], v47 offset:53248
v_mfma_f32_16x16x32_bf16 v[144:147], a[204:207], v[140:143], v[144:147]
v_exp_f32 v113, v113
v_mfma_f32_16x16x32_bf16 v[148:151], a[220:223], v[140:143], v[148:151]
v_exp_f32 v114, v114
v_cvt_pk_bf16_f32 v112, v112, v113
s_waitcnt lgkmcnt(4)
v_mfma_f32_16x16x32_bf16 a[0:3], a[224:227], v[80:83], a[0:3]
v_exp_f32 v115, v115
v_mfma_f32_16x16x32_bf16 a[4:7], a[228:231], v[80:83], a[4:7]
v_exp_f32 v116, v116
v_mfma_f32_16x16x32_bf16 a[8:11], a[232:235], v[80:83], a[8:11]
v_mfma_f32_16x16x32_bf16 a[12:15], a[236:239], v[80:83], a[12:15]
v_cvt_pk_bf16_f32 v113, v114, v115
v_mfma_f32_16x16x32_bf16 a[16:19], a[240:243], v[80:83], a[16:19]
v_mfma_f32_16x16x32_bf16 a[20:23], a[244:247], v[80:83], a[20:23]
v_exp_f32 v117, v117
s_waitcnt lgkmcnt(0)
v_mfma_f32_16x16x32_bf16 a[24:27], a[248:251], v[80:83], a[24:27]
v_mfma_f32_16x16x32_bf16 a[28:31], a[252:255], v[80:83], a[28:31]
v_exp_f32 v118, v118
v_mfma_f32_16x16x32_bf16 v[88:91], v[48:51], v[80:83], v[88:91]
buffer_load_dwordx4 v9, s[24:27], s75 offen offset:3072 nt lds
v_mfma_f32_16x16x32_bf16 v[80:83], a[192:195], v[160:163], 0
v_cvt_pk_bf16_f32 v114, v116, v117
v_exp_f32 v144, v144
v_mfma_f32_16x16x32_bf16 v[84:87], a[208:211], v[160:163], 0
v_exp_f32 v145, v145
v_mfma_f32_16x16x32_bf16 v[80:83], a[196:199], v[164:167], v[80:83]
v_exp_f32 v119, v119
v_mfma_f32_16x16x32_bf16 v[84:87], a[212:215], v[164:167], v[84:87]
v_exp_f32 v146, v146
v_mfma_f32_16x16x32_bf16 v[80:83], a[200:203], v[168:171], v[80:83]
v_cvt_pk_bf16_f32 v115, v118, v119
v_mfma_f32_16x16x32_bf16 v[84:87], a[216:219], v[168:171], v[84:87]
v_cvt_pk_bf16_f32 v144, v144, v145
v_mfma_f32_16x16x32_bf16 v[80:83], a[204:207], v[172:175], v[80:83]
v_mfma_f32_16x16x32_bf16 v[84:87], a[220:223], v[172:175], v[84:87]
v_exp_f32 v147, v147
v_mfma_f32_16x16x32_bf16 a[32:35], a[224:227], v[112:115], a[32:35]
v_mfma_f32_16x16x32_bf16 a[36:39], a[228:231], v[112:115], a[36:39]
v_exp_f32 v148, v148
v_mfma_f32_16x16x32_bf16 a[40:43], a[232:235], v[112:115], a[40:43]
v_mfma_f32_16x16x32_bf16 a[44:47], a[236:239], v[112:115], a[44:47]
v_cvt_pk_bf16_f32 v145, v146, v147
v_mfma_f32_16x16x32_bf16 a[48:51], a[240:243], v[112:115], a[48:51]
v_mfma_f32_16x16x32_bf16 a[52:55], a[244:247], v[112:115], a[52:55]
v_exp_f32 v149, v149
v_mfma_f32_16x16x32_bf16 a[56:59], a[248:251], v[112:115], a[56:59]
v_mfma_f32_16x16x32_bf16 a[60:63], a[252:255], v[112:115], a[60:63]
v_exp_f32 v150, v150
v_mfma_f32_16x16x32_bf16 v[92:95], v[48:51], v[112:115], v[92:95]
v_mfma_f32_16x16x32_bf16 v[112:115], a[192:195], v[192:195], 0
v_cvt_pk_bf16_f32 v146, v148, v149
v_exp_f32 v80, v80
v_mfma_f32_16x16x32_bf16 v[116:119], a[208:211], v[192:195], 0
v_exp_f32 v81, v81
v_mfma_f32_16x16x32_bf16 v[112:115], a[196:199], v[196:199], v[112:115]
v_exp_f32 v151, v151
v_mfma_f32_16x16x32_bf16 v[116:119], a[212:215], v[196:199], v[116:119]
v_exp_f32 v82, v82
v_mfma_f32_16x16x32_bf16 v[112:115], a[200:203], v[200:203], v[112:115]
v_cvt_pk_bf16_f32 v147, v150, v151
v_mfma_f32_16x16x32_bf16 v[116:119], a[216:219], v[200:203], v[116:119]
v_cvt_pk_bf16_f32 v80, v80, v81
v_mfma_f32_16x16x32_bf16 v[112:115], a[204:207], v[204:207], v[112:115]
v_mfma_f32_16x16x32_bf16 v[116:119], a[220:223], v[204:207], v[116:119]
v_exp_f32 v83, v83
v_mfma_f32_16x16x32_bf16 a[64:67], a[224:227], v[144:147], a[64:67]
s_waitcnt vmcnt(24)
s_barrier
v_mfma_f32_16x16x32_bf16 a[68:71], a[228:231], v[144:147], a[68:71]
s_add_u32 s76, s76, 8192
v_exp_f32 v84, v84
v_mfma_f32_16x16x32_bf16 a[72:75], a[232:235], v[144:147], a[72:75]
s_and_b32 s76, s76, 131071
v_mfma_f32_16x16x32_bf16 a[76:79], a[236:239], v[144:147], a[76:79]
s_add_u32 m0, s77, 114688
v_cvt_pk_bf16_f32 v81, v82, v83
v_mfma_f32_16x16x32_bf16 a[80:83], a[240:243], v[144:147], a[80:83]
buffer_load_dwordx4 v10, s[28:31], s76 offen nt lds
v_mfma_f32_16x16x32_bf16 a[84:87], a[244:247], v[144:147], a[84:87]
v_exp_f32 v85, v85
v_mfma_f32_16x16x32_bf16 a[88:91], a[248:251], v[144:147], a[88:91]
v_mfma_f32_16x16x32_bf16 a[92:95], a[252:255], v[144:147], a[92:95]
v_exp_f32 v86, v86
v_mfma_f32_16x16x32_bf16 v[120:123], v[48:51], v[144:147], v[120:123]
v_mfma_f32_16x16x32_bf16 v[144:147], a[192:195], v[224:227], 0
ds_read_b64 a[192:193], v20
ds_read_b64 a[194:195], v21
v_cvt_pk_bf16_f32 v82, v84, v85
v_mfma_f32_16x16x32_bf16 v[148:151], a[208:211], v[224:227], 0
v_exp_f32 v112, v112
v_mfma_f32_16x16x32_bf16 v[144:147], a[196:199], v[228:231], v[144:147]
ds_read_b64 a[208:209], v20 offset:4096
ds_read_b64 a[210:211], v21 offset:4096
v_mfma_f32_16x16x32_bf16 v[148:151], a[212:215], v[228:231], v[148:151]
buffer_load_dwordx4 v19, s[28:31], s76 offen offset:1024 nt lds
v_exp_f32 v87, v87
v_mfma_f32_16x16x32_bf16 v[144:147], a[200:203], v[232:235], v[144:147]
ds_read_b64 a[196:197], v22
ds_read_b64 a[198:199], v23
v_cvt_pk_bf16_f32 v83, v86, v87
v_mfma_f32_16x16x32_bf16 v[148:151], a[216:219], v[232:235], v[148:151]
v_exp_f32 v113, v113
v_mfma_f32_16x16x32_bf16 v[144:147], a[204:207], v[236:239], v[144:147]
ds_read_b64 a[212:213], v22 offset:4096
ds_read_b64 a[214:215], v23 offset:4096
v_mfma_f32_16x16x32_bf16 v[148:151], a[220:223], v[236:239], v[148:151]
v_exp_f32 v114, v114
v_cvt_pk_bf16_f32 v112, v112, v113
v_mfma_f32_16x16x32_bf16 a[96:99], a[224:227], v[80:83], a[96:99]
ds_read_b64 a[200:201], v24
ds_read_b64 a[202:203], v25
v_mfma_f32_16x16x32_bf16 a[100:103], a[228:231], v[80:83], a[100:103]
v_exp_f32 v115, v115
v_mfma_f32_16x16x32_bf16 a[104:107], a[232:235], v[80:83], a[104:107]
ds_read_b64 a[216:217], v24 offset:4096
ds_read_b64 a[218:219], v25 offset:4096
v_mfma_f32_16x16x32_bf16 a[108:111], a[236:239], v[80:83], a[108:111]
buffer_load_dwordx4 v10, s[28:31], s76 offen offset:2048 nt lds
v_exp_f32 v116, v116
v_mfma_f32_16x16x32_bf16 a[112:115], a[240:243], v[80:83], a[112:115]
ds_read_b64 a[204:205], v26
ds_read_b64 a[206:207], v27
v_cvt_pk_bf16_f32 v113, v114, v115
v_mfma_f32_16x16x32_bf16 a[116:119], a[244:247], v[80:83], a[116:119]
v_exp_f32 v117, v117
v_mfma_f32_16x16x32_bf16 a[120:123], a[248:251], v[80:83], a[120:123]
ds_read_b64 a[220:221], v26 offset:4096
ds_read_b64 a[222:223], v27 offset:4096
v_mfma_f32_16x16x32_bf16 a[124:127], a[252:255], v[80:83], a[124:127]
v_exp_f32 v118, v118
v_mfma_f32_16x16x32_bf16 v[124:127], v[48:51], v[80:83], v[124:127]
s_waitcnt lgkmcnt(4)
v_mfma_f32_16x16x32_bf16 v[80:83], a[192:195], v[64:67], 0
v_cvt_pk_bf16_f32 v114, v116, v117
v_exp_f32 v144, v144
v_mfma_f32_16x16x32_bf16 v[84:87], a[208:211], v[64:67], 0
v_exp_f32 v145, v145
v_mfma_f32_16x16x32_bf16 v[80:83], a[196:199], v[68:71], v[80:83]
buffer_load_dwordx4 v19, s[28:31], s76 offen offset:3072 nt lds
v_exp_f32 v119, v119
v_mfma_f32_16x16x32_bf16 v[84:87], a[212:215], v[68:71], v[84:87]
v_exp_f32 v146, v146
v_mfma_f32_16x16x32_bf16 v[80:83], a[200:203], v[72:75], v[80:83]
v_cvt_pk_bf16_f32 v115, v118, v119
v_mfma_f32_16x16x32_bf16 v[84:87], a[216:219], v[72:75], v[84:87]
v_cvt_pk_bf16_f32 v144, v144, v145
s_waitcnt lgkmcnt(0)
v_mfma_f32_16x16x32_bf16 v[80:83], a[204:207], v[76:79], v[80:83]
v_mfma_f32_16x16x32_bf16 v[84:87], a[220:223], v[76:79], v[84:87]
v_exp_f32 v147, v147
v_mfma_f32_16x16x32_bf16 a[128:131], a[224:227], v[112:115], a[128:131]
v_mfma_f32_16x16x32_bf16 a[132:135], a[228:231], v[112:115], a[132:135]
v_exp_f32 v148, v148
v_mfma_f32_16x16x32_bf16 a[136:139], a[232:235], v[112:115], a[136:139]
s_waitcnt vmcnt(24)
s_barrier
v_mfma_f32_16x16x32_bf16 a[140:143], a[236:239], v[112:115], a[140:143]
s_add_u32 s75, s75, 8192
v_cvt_pk_bf16_f32 v145, v146, v147
v_mfma_f32_16x16x32_bf16 a[144:147], a[240:243], v[112:115], a[144:147]
s_and_b32 s75, s75, 131071
v_mfma_f32_16x16x32_bf16 a[148:151], a[244:247], v[112:115], a[148:151]
s_add_u32 m0, s77, 0
v_exp_f32 v149, v149
v_mfma_f32_16x16x32_bf16 a[152:155], a[248:251], v[112:115], a[152:155]
buffer_load_dwordx4 v6, s[24:27], s75 offen nt lds
v_mfma_f32_16x16x32_bf16 a[156:159], a[252:255], v[112:115], a[156:159]
v_exp_f32 v150, v150
v_mfma_f32_16x16x32_bf16 v[152:155], v[48:51], v[112:115], v[152:155]
v_mfma_f32_16x16x32_bf16 v[112:115], a[192:195], v[96:99], 0
v_cvt_pk_bf16_f32 v146, v148, v149
v_exp_f32 v80, v80
v_mfma_f32_16x16x32_bf16 v[116:119], a[208:211], v[96:99], 0
v_exp_f32 v81, v81
v_mfma_f32_16x16x32_bf16 v[112:115], a[196:199], v[100:103], v[112:115]
v_exp_f32 v151, v151
v_mfma_f32_16x16x32_bf16 v[116:119], a[212:215], v[100:103], v[116:119]
v_exp_f32 v82, v82
v_mfma_f32_16x16x32_bf16 v[112:115], a[200:203], v[104:107], v[112:115]
v_cvt_pk_bf16_f32 v147, v150, v151
v_mfma_f32_16x16x32_bf16 v[116:119], a[216:219], v[104:107], v[116:119]
v_cvt_pk_bf16_f32 v80, v80, v81
v_mfma_f32_16x16x32_bf16 v[112:115], a[204:207], v[108:111], v[112:115]
v_mfma_f32_16x16x32_bf16 v[116:119], a[220:223], v[108:111], v[116:119]
v_exp_f32 v83, v83
v_mfma_f32_16x16x32_bf16 a[160:163], a[224:227], v[144:147], a[160:163]
ds_read_b64_tr_b16 a[224:225], v28
ds_read_b64_tr_b16 a[226:227], v28 offset:4096
v_mfma_f32_16x16x32_bf16 a[164:167], a[228:231], v[144:147], a[164:167]
buffer_load_dwordx4 v7, s[24:27], s75 offen offset:1024 nt lds
v_exp_f32 v84, v84
v_mfma_f32_16x16x32_bf16 a[168:171], a[232:235], v[144:147], a[168:171]
ds_read_b64_tr_b16 a[228:229], v29
ds_read_b64_tr_b16 a[230:231], v29 offset:4096
v_mfma_f32_16x16x32_bf16 a[172:175], a[236:239], v[144:147], a[172:175]
v_cvt_pk_bf16_f32 v81, v82, v83
v_mfma_f32_16x16x32_bf16 a[176:179], a[240:243], v[144:147], a[176:179]
ds_read_b64_tr_b16 a[232:233], v30
ds_read_b64_tr_b16 a[234:235], v30 offset:4096
v_mfma_f32_16x16x32_bf16 a[180:183], a[244:247], v[144:147], a[180:183]
v_exp_f32 v85, v85
v_mfma_f32_16x16x32_bf16 a[184:187], a[248:251], v[144:147], a[184:187]
ds_read_b64_tr_b16 a[236:237], v31
ds_read_b64_tr_b16 a[238:239], v31 offset:4096
v_mfma_f32_16x16x32_bf16 a[188:191], a[252:255], v[144:147], a[188:191]
v_exp_f32 v86, v86
v_mfma_f32_16x16x32_bf16 v[156:159], v[48:51], v[144:147], v[156:159]
ds_read_b64_tr_b16 a[240:241], v44
ds_read_b64_tr_b16 a[242:243], v44 offset:4096
v_mfma_f32_16x16x32_bf16 v[144:147], a[192:195], v[128:131], 0
v_cvt_pk_bf16_f32 v82, v84, v85
v_exp_f32 v112, v112
v_mfma_f32_16x16x32_bf16 v[148:151], a[208:211], v[128:131], 0
ds_read_b64_tr_b16 a[244:245], v45
ds_read_b64_tr_b16 a[246:247], v45 offset:4096
v_mfma_f32_16x16x32_bf16 v[144:147], a[196:199], v[132:135], v[144:147]
v_exp_f32 v87, v87
v_mfma_f32_16x16x32_bf16 v[148:151], a[212:215], v[132:135], v[148:151]
ds_read_b64_tr_b16 a[248:249], v46
ds_read_b64_tr_b16 a[250:251], v46 offset:4096
v_mfma_f32_16x16x32_bf16 v[144:147], a[200:203], v[136:139], v[144:147]
buffer_load_dwordx4 v8, s[24:27], s75 offen offset:2048 nt lds
v_cvt_pk_bf16_f32 v83, v86, v87
v_mfma_f32_16x16x32_bf16 v[148:151], a[216:219], v[136:139], v[148:151]
ds_read_b64_tr_b16 a[252:253], v47
ds_read_b64_tr_b16 a[254:255], v47 offset:4096
v_mfma_f32_16x16x32_bf16 v[144:147], a[204:207], v[140:143], v[144:147]
v_exp_f32 v113, v113
v_mfma_f32_16x16x32_bf16 v[148:151], a[220:223], v[140:143], v[148:151]
v_exp_f32 v114, v114
v_cvt_pk_bf16_f32 v112, v112, v113
s_waitcnt lgkmcnt(4)
v_mfma_f32_16x16x32_bf16 a[0:3], a[224:227], v[80:83], a[0:3]
v_exp_f32 v115, v115
v_mfma_f32_16x16x32_bf16 a[4:7], a[228:231], v[80:83], a[4:7]
v_exp_f32 v116, v116
v_mfma_f32_16x16x32_bf16 a[8:11], a[232:235], v[80:83], a[8:11]
v_mfma_f32_16x16x32_bf16 a[12:15], a[236:239], v[80:83], a[12:15]
v_cvt_pk_bf16_f32 v113, v114, v115
v_mfma_f32_16x16x32_bf16 a[16:19], a[240:243], v[80:83], a[16:19]
v_mfma_f32_16x16x32_bf16 a[20:23], a[244:247], v[80:83], a[20:23]
v_exp_f32 v117, v117
s_waitcnt lgkmcnt(0)
v_mfma_f32_16x16x32_bf16 a[24:27], a[248:251], v[80:83], a[24:27]
v_mfma_f32_16x16x32_bf16 a[28:31], a[252:255], v[80:83], a[28:31]
v_exp_f32 v118, v118
v_mfma_f32_16x16x32_bf16 v[88:91], v[48:51], v[80:83], v[88:91]
buffer_load_dwordx4 v9, s[24:27], s75 offen offset:3072 nt lds
v_mfma_f32_16x16x32_bf16 v[80:83], a[192:195], v[160:163], 0
v_cvt_pk_bf16_f32 v114, v116, v117
v_exp_f32 v144, v144
v_mfma_f32_16x16x32_bf16 v[84:87], a[208:211], v[160:163], 0
v_exp_f32 v145, v145
v_mfma_f32_16x16x32_bf16 v[80:83], a[196:199], v[164:167], v[80:83]
v_exp_f32 v119, v119
v_mfma_f32_16x16x32_bf16 v[84:87], a[212:215], v[164:167], v[84:87]
v_exp_f32 v146, v146
v_mfma_f32_16x16x32_bf16 v[80:83], a[200:203], v[168:171], v[80:83]
v_cvt_pk_bf16_f32 v115, v118, v119
v_mfma_f32_16x16x32_bf16 v[84:87], a[216:219], v[168:171], v[84:87]
v_cvt_pk_bf16_f32 v144, v144, v145
v_mfma_f32_16x16x32_bf16 v[80:83], a[204:207], v[172:175], v[80:83]
v_mfma_f32_16x16x32_bf16 v[84:87], a[220:223], v[172:175], v[84:87]
v_exp_f32 v147, v147
v_mfma_f32_16x16x32_bf16 a[32:35], a[224:227], v[112:115], a[32:35]
v_mfma_f32_16x16x32_bf16 a[36:39], a[228:231], v[112:115], a[36:39]
v_exp_f32 v148, v148
v_mfma_f32_16x16x32_bf16 a[40:43], a[232:235], v[112:115], a[40:43]
v_mfma_f32_16x16x32_bf16 a[44:47], a[236:239], v[112:115], a[44:47]
v_cvt_pk_bf16_f32 v145, v146, v147
v_mfma_f32_16x16x32_bf16 a[48:51], a[240:243], v[112:115], a[48:51]
v_mfma_f32_16x16x32_bf16 a[52:55], a[244:247], v[112:115], a[52:55]
v_exp_f32 v149, v149
v_mfma_f32_16x16x32_bf16 a[56:59], a[248:251], v[112:115], a[56:59]
v_mfma_f32_16x16x32_bf16 a[60:63], a[252:255], v[112:115], a[60:63]
v_exp_f32 v150, v150
v_mfma_f32_16x16x32_bf16 v[92:95], v[48:51], v[112:115], v[92:95]
v_mfma_f32_16x16x32_bf16 v[112:115], a[192:195], v[192:195], 0
v_cvt_pk_bf16_f32 v146, v148, v149
v_exp_f32 v80, v80
v_mfma_f32_16x16x32_bf16 v[116:119], a[208:211], v[192:195], 0
v_exp_f32 v81, v81
v_mfma_f32_16x16x32_bf16 v[112:115], a[196:199], v[196:199], v[112:115]
v_exp_f32 v151, v151
v_mfma_f32_16x16x32_bf16 v[116:119], a[212:215], v[196:199], v[116:119]
v_exp_f32 v82, v82
v_mfma_f32_16x16x32_bf16 v[112:115], a[200:203], v[200:203], v[112:115]
v_cvt_pk_bf16_f32 v147, v150, v151
v_mfma_f32_16x16x32_bf16 v[116:119], a[216:219], v[200:203], v[116:119]
v_cvt_pk_bf16_f32 v80, v80, v81
v_mfma_f32_16x16x32_bf16 v[112:115], a[204:207], v[204:207], v[112:115]
v_mfma_f32_16x16x32_bf16 v[116:119], a[220:223], v[204:207], v[116:119]
v_exp_f32 v83, v83
v_mfma_f32_16x16x32_bf16 a[64:67], a[224:227], v[144:147], a[64:67]
s_waitcnt vmcnt(24)
s_barrier
v_mfma_f32_16x16x32_bf16 a[68:71], a[228:231], v[144:147], a[68:71]
s_add_u32 s76, s76, 8192
v_exp_f32 v84, v84
v_mfma_f32_16x16x32_bf16 a[72:75], a[232:235], v[144:147], a[72:75]
s_and_b32 s76, s76, 131071
v_mfma_f32_16x16x32_bf16 a[76:79], a[236:239], v[144:147], a[76:79]
s_add_u32 m0, s77, 65536
v_cvt_pk_bf16_f32 v81, v82, v83
v_mfma_f32_16x16x32_bf16 a[80:83], a[240:243], v[144:147], a[80:83]
buffer_load_dwordx4 v10, s[28:31], s76 offen nt lds
v_mfma_f32_16x16x32_bf16 a[84:87], a[244:247], v[144:147], a[84:87]
v_exp_f32 v85, v85
v_mfma_f32_16x16x32_bf16 a[88:91], a[248:251], v[144:147], a[88:91]
v_mfma_f32_16x16x32_bf16 a[92:95], a[252:255], v[144:147], a[92:95]
v_exp_f32 v86, v86
v_mfma_f32_16x16x32_bf16 v[120:123], v[48:51], v[144:147], v[120:123]
v_mfma_f32_16x16x32_bf16 v[144:147], a[192:195], v[224:227], 0
ds_read_b64 a[192:193], v20 offset:16384
ds_read_b64 a[194:195], v21 offset:16384
v_cvt_pk_bf16_f32 v82, v84, v85
v_mfma_f32_16x16x32_bf16 v[148:151], a[208:211], v[224:227], 0
v_exp_f32 v112, v112
v_mfma_f32_16x16x32_bf16 v[144:147], a[196:199], v[228:231], v[144:147]
ds_read_b64 a[208:209], v20 offset:20480
ds_read_b64 a[210:211], v21 offset:20480
v_mfma_f32_16x16x32_bf16 v[148:151], a[212:215], v[228:231], v[148:151]
buffer_load_dwordx4 v19, s[28:31], s76 offen offset:1024 nt lds
v_exp_f32 v87, v87
v_mfma_f32_16x16x32_bf16 v[144:147], a[200:203], v[232:235], v[144:147]
ds_read_b64 a[196:197], v22 offset:16384
ds_read_b64 a[198:199], v23 offset:16384
v_cvt_pk_bf16_f32 v83, v86, v87
v_mfma_f32_16x16x32_bf16 v[148:151], a[216:219], v[232:235], v[148:151]
v_exp_f32 v113, v113
v_mfma_f32_16x16x32_bf16 v[144:147], a[204:207], v[236:239], v[144:147]
ds_read_b64 a[212:213], v22 offset:20480
ds_read_b64 a[214:215], v23 offset:20480
v_mfma_f32_16x16x32_bf16 v[148:151], a[220:223], v[236:239], v[148:151]
v_exp_f32 v114, v114
v_cvt_pk_bf16_f32 v112, v112, v113
v_mfma_f32_16x16x32_bf16 a[96:99], a[224:227], v[80:83], a[96:99]
ds_read_b64 a[200:201], v24 offset:16384
ds_read_b64 a[202:203], v25 offset:16384
v_mfma_f32_16x16x32_bf16 a[100:103], a[228:231], v[80:83], a[100:103]
v_exp_f32 v115, v115
v_mfma_f32_16x16x32_bf16 a[104:107], a[232:235], v[80:83], a[104:107]
ds_read_b64 a[216:217], v24 offset:20480
ds_read_b64 a[218:219], v25 offset:20480
v_mfma_f32_16x16x32_bf16 a[108:111], a[236:239], v[80:83], a[108:111]
buffer_load_dwordx4 v10, s[28:31], s76 offen offset:2048 nt lds
v_exp_f32 v116, v116
v_mfma_f32_16x16x32_bf16 a[112:115], a[240:243], v[80:83], a[112:115]
ds_read_b64 a[204:205], v26 offset:16384
ds_read_b64 a[206:207], v27 offset:16384
v_cvt_pk_bf16_f32 v113, v114, v115
v_mfma_f32_16x16x32_bf16 a[116:119], a[244:247], v[80:83], a[116:119]
v_exp_f32 v117, v117
v_mfma_f32_16x16x32_bf16 a[120:123], a[248:251], v[80:83], a[120:123]
ds_read_b64 a[220:221], v26 offset:20480
ds_read_b64 a[222:223], v27 offset:20480
v_mfma_f32_16x16x32_bf16 a[124:127], a[252:255], v[80:83], a[124:127]
v_exp_f32 v118, v118
v_mfma_f32_16x16x32_bf16 v[124:127], v[48:51], v[80:83], v[124:127]
s_waitcnt lgkmcnt(4)
v_mfma_f32_16x16x32_bf16 v[80:83], a[192:195], v[64:67], 0
v_cvt_pk_bf16_f32 v114, v116, v117
v_exp_f32 v144, v144
v_mfma_f32_16x16x32_bf16 v[84:87], a[208:211], v[64:67], 0
v_exp_f32 v145, v145
v_mfma_f32_16x16x32_bf16 v[80:83], a[196:199], v[68:71], v[80:83]
buffer_load_dwordx4 v19, s[28:31], s76 offen offset:3072 nt lds
v_exp_f32 v119, v119
v_mfma_f32_16x16x32_bf16 v[84:87], a[212:215], v[68:71], v[84:87]
v_exp_f32 v146, v146
v_mfma_f32_16x16x32_bf16 v[80:83], a[200:203], v[72:75], v[80:83]
v_cvt_pk_bf16_f32 v115, v118, v119
v_mfma_f32_16x16x32_bf16 v[84:87], a[216:219], v[72:75], v[84:87]
v_cvt_pk_bf16_f32 v144, v144, v145
s_waitcnt lgkmcnt(0)
v_mfma_f32_16x16x32_bf16 v[80:83], a[204:207], v[76:79], v[80:83]
v_mfma_f32_16x16x32_bf16 v[84:87], a[220:223], v[76:79], v[84:87]
v_exp_f32 v147, v147
v_mfma_f32_16x16x32_bf16 a[128:131], a[224:227], v[112:115], a[128:131]
v_mfma_f32_16x16x32_bf16 a[132:135], a[228:231], v[112:115], a[132:135]
v_exp_f32 v148, v148
v_mfma_f32_16x16x32_bf16 a[136:139], a[232:235], v[112:115], a[136:139]
s_waitcnt vmcnt(24)
s_barrier
v_mfma_f32_16x16x32_bf16 a[140:143], a[236:239], v[112:115], a[140:143]
s_add_u32 s75, s75, 8192
v_cvt_pk_bf16_f32 v145, v146, v147
v_mfma_f32_16x16x32_bf16 a[144:147], a[240:243], v[112:115], a[144:147]
s_and_b32 s75, s75, 131071
v_mfma_f32_16x16x32_bf16 a[148:151], a[244:247], v[112:115], a[148:151]
s_add_u32 m0, s77, 16384
v_exp_f32 v149, v149
v_mfma_f32_16x16x32_bf16 a[152:155], a[248:251], v[112:115], a[152:155]
buffer_load_dwordx4 v6, s[24:27], s75 offen nt lds
v_mfma_f32_16x16x32_bf16 a[156:159], a[252:255], v[112:115], a[156:159]
v_exp_f32 v150, v150
v_mfma_f32_16x16x32_bf16 v[152:155], v[48:51], v[112:115], v[152:155]
v_mfma_f32_16x16x32_bf16 v[112:115], a[192:195], v[96:99], 0
v_cvt_pk_bf16_f32 v146, v148, v149
v_exp_f32 v80, v80
v_mfma_f32_16x16x32_bf16 v[116:119], a[208:211], v[96:99], 0
v_exp_f32 v81, v81
v_mfma_f32_16x16x32_bf16 v[112:115], a[196:199], v[100:103], v[112:115]
v_exp_f32 v151, v151
v_mfma_f32_16x16x32_bf16 v[116:119], a[212:215], v[100:103], v[116:119]
v_exp_f32 v82, v82
v_mfma_f32_16x16x32_bf16 v[112:115], a[200:203], v[104:107], v[112:115]
v_cvt_pk_bf16_f32 v147, v150, v151
v_mfma_f32_16x16x32_bf16 v[116:119], a[216:219], v[104:107], v[116:119]
v_cvt_pk_bf16_f32 v80, v80, v81
v_mfma_f32_16x16x32_bf16 v[112:115], a[204:207], v[108:111], v[112:115]
v_mfma_f32_16x16x32_bf16 v[116:119], a[220:223], v[108:111], v[116:119]
v_exp_f32 v83, v83
v_mfma_f32_16x16x32_bf16 a[160:163], a[224:227], v[144:147], a[160:163]
ds_read_b64_tr_b16 a[224:225], v28 offset:16384
ds_read_b64_tr_b16 a[226:227], v28 offset:20480
v_mfma_f32_16x16x32_bf16 a[164:167], a[228:231], v[144:147], a[164:167]
buffer_load_dwordx4 v7, s[24:27], s75 offen offset:1024 nt lds
v_exp_f32 v84, v84
v_mfma_f32_16x16x32_bf16 a[168:171], a[232:235], v[144:147], a[168:171]
ds_read_b64_tr_b16 a[228:229], v29 offset:16384
ds_read_b64_tr_b16 a[230:231], v29 offset:20480
v_mfma_f32_16x16x32_bf16 a[172:175], a[236:239], v[144:147], a[172:175]
v_cvt_pk_bf16_f32 v81, v82, v83
v_mfma_f32_16x16x32_bf16 a[176:179], a[240:243], v[144:147], a[176:179]
ds_read_b64_tr_b16 a[232:233], v30 offset:16384
ds_read_b64_tr_b16 a[234:235], v30 offset:20480
v_mfma_f32_16x16x32_bf16 a[180:183], a[244:247], v[144:147], a[180:183]
v_exp_f32 v85, v85
v_mfma_f32_16x16x32_bf16 a[184:187], a[248:251], v[144:147], a[184:187]
ds_read_b64_tr_b16 a[236:237], v31 offset:16384
ds_read_b64_tr_b16 a[238:239], v31 offset:20480
v_mfma_f32_16x16x32_bf16 a[188:191], a[252:255], v[144:147], a[188:191]
v_exp_f32 v86, v86
v_mfma_f32_16x16x32_bf16 v[156:159], v[48:51], v[144:147], v[156:159]
ds_read_b64_tr_b16 a[240:241], v44 offset:16384
ds_read_b64_tr_b16 a[242:243], v44 offset:20480
v_mfma_f32_16x16x32_bf16 v[144:147], a[192:195], v[128:131], 0
v_cvt_pk_bf16_f32 v82, v84, v85
v_exp_f32 v112, v112
v_mfma_f32_16x16x32_bf16 v[148:151], a[208:211], v[128:131], 0
ds_read_b64_tr_b16 a[244:245], v45 offset:16384
ds_read_b64_tr_b16 a[246:247], v45 offset:20480
v_mfma_f32_16x16x32_bf16 v[144:147], a[196:199], v[132:135], v[144:147]
v_exp_f32 v87, v87
v_mfma_f32_16x16x32_bf16 v[148:151], a[212:215], v[132:135], v[148:151]
ds_read_b64_tr_b16 a[248:249], v46 offset:16384
ds_read_b64_tr_b16 a[250:251], v46 offset:20480
v_mfma_f32_16x16x32_bf16 v[144:147], a[200:203], v[136:139], v[144:147]
buffer_load_dwordx4 v8, s[24:27], s75 offen offset:2048 nt lds
v_cvt_pk_bf16_f32 v83, v86, v87
v_mfma_f32_16x16x32_bf16 v[148:151], a[216:219], v[136:139], v[148:151]
ds_read_b64_tr_b16 a[252:253], v47 offset:16384
ds_read_b64_tr_b16 a[254:255], v47 offset:20480
v_mfma_f32_16x16x32_bf16 v[144:147], a[204:207], v[140:143], v[144:147]
v_exp_f32 v113, v113
v_mfma_f32_16x16x32_bf16 v[148:151], a[220:223], v[140:143], v[148:151]
v_exp_f32 v114, v114
v_cvt_pk_bf16_f32 v112, v112, v113
s_waitcnt lgkmcnt(4)
v_mfma_f32_16x16x32_bf16 a[0:3], a[224:227], v[80:83], a[0:3]
v_exp_f32 v115, v115
v_mfma_f32_16x16x32_bf16 a[4:7], a[228:231], v[80:83], a[4:7]
v_exp_f32 v116, v116
v_mfma_f32_16x16x32_bf16 a[8:11], a[232:235], v[80:83], a[8:11]
v_mfma_f32_16x16x32_bf16 a[12:15], a[236:239], v[80:83], a[12:15]
v_cvt_pk_bf16_f32 v113, v114, v115
v_mfma_f32_16x16x32_bf16 a[16:19], a[240:243], v[80:83], a[16:19]
v_mfma_f32_16x16x32_bf16 a[20:23], a[244:247], v[80:83], a[20:23]
v_exp_f32 v117, v117
s_waitcnt lgkmcnt(0)
v_mfma_f32_16x16x32_bf16 a[24:27], a[248:251], v[80:83], a[24:27]
v_mfma_f32_16x16x32_bf16 a[28:31], a[252:255], v[80:83], a[28:31]
v_exp_f32 v118, v118
v_mfma_f32_16x16x32_bf16 v[88:91], v[48:51], v[80:83], v[88:91]
buffer_load_dwordx4 v9, s[24:27], s75 offen offset:3072 nt lds
v_mfma_f32_16x16x32_bf16 v[80:83], a[192:195], v[160:163], 0
v_cvt_pk_bf16_f32 v114, v116, v117
v_exp_f32 v144, v144
v_mfma_f32_16x16x32_bf16 v[84:87], a[208:211], v[160:163], 0
v_exp_f32 v145, v145
v_mfma_f32_16x16x32_bf16 v[80:83], a[196:199], v[164:167], v[80:83]
v_exp_f32 v119, v119
v_mfma_f32_16x16x32_bf16 v[84:87], a[212:215], v[164:167], v[84:87]
v_exp_f32 v146, v146
v_mfma_f32_16x16x32_bf16 v[80:83], a[200:203], v[168:171], v[80:83]
v_cvt_pk_bf16_f32 v115, v118, v119
v_mfma_f32_16x16x32_bf16 v[84:87], a[216:219], v[168:171], v[84:87]
v_cvt_pk_bf16_f32 v144, v144, v145
v_mfma_f32_16x16x32_bf16 v[80:83], a[204:207], v[172:175], v[80:83]
v_mfma_f32_16x16x32_bf16 v[84:87], a[220:223], v[172:175], v[84:87]
v_exp_f32 v147, v147
v_mfma_f32_16x16x32_bf16 a[32:35], a[224:227], v[112:115], a[32:35]
v_mfma_f32_16x16x32_bf16 a[36:39], a[228:231], v[112:115], a[36:39]
v_exp_f32 v148, v148
v_mfma_f32_16x16x32_bf16 a[40:43], a[232:235], v[112:115], a[40:43]
v_mfma_f32_16x16x32_bf16 a[44:47], a[236:239], v[112:115], a[44:47]
v_cvt_pk_bf16_f32 v145, v146, v147
v_mfma_f32_16x16x32_bf16 a[48:51], a[240:243], v[112:115], a[48:51]
v_mfma_f32_16x16x32_bf16 a[52:55], a[244:247], v[112:115], a[52:55]
v_exp_f32 v149, v149
v_mfma_f32_16x16x32_bf16 a[56:59], a[248:251], v[112:115], a[56:59]
v_mfma_f32_16x16x32_bf16 a[60:63], a[252:255], v[112:115], a[60:63]
v_exp_f32 v150, v150
v_mfma_f32_16x16x32_bf16 v[92:95], v[48:51], v[112:115], v[92:95]
v_mfma_f32_16x16x32_bf16 v[112:115], a[192:195], v[192:195], 0
v_cvt_pk_bf16_f32 v146, v148, v149
v_exp_f32 v80, v80
v_mfma_f32_16x16x32_bf16 v[116:119], a[208:211], v[192:195], 0
v_exp_f32 v81, v81
v_mfma_f32_16x16x32_bf16 v[112:115], a[196:199], v[196:199], v[112:115]
v_exp_f32 v151, v151
v_mfma_f32_16x16x32_bf16 v[116:119], a[212:215], v[196:199], v[116:119]
v_exp_f32 v82, v82
v_mfma_f32_16x16x32_bf16 v[112:115], a[200:203], v[200:203], v[112:115]
v_cvt_pk_bf16_f32 v147, v150, v151
v_mfma_f32_16x16x32_bf16 v[116:119], a[216:219], v[200:203], v[116:119]
v_cvt_pk_bf16_f32 v80, v80, v81
v_mfma_f32_16x16x32_bf16 v[112:115], a[204:207], v[204:207], v[112:115]
v_mfma_f32_16x16x32_bf16 v[116:119], a[220:223], v[204:207], v[116:119]
v_exp_f32 v83, v83
v_mfma_f32_16x16x32_bf16 a[64:67], a[224:227], v[144:147], a[64:67]
s_waitcnt vmcnt(24)
s_barrier
v_mfma_f32_16x16x32_bf16 a[68:71], a[228:231], v[144:147], a[68:71]
s_add_u32 s76, s76, 8192
v_exp_f32 v84, v84
v_mfma_f32_16x16x32_bf16 a[72:75], a[232:235], v[144:147], a[72:75]
s_and_b32 s76, s76, 131071
v_mfma_f32_16x16x32_bf16 a[76:79], a[236:239], v[144:147], a[76:79]
s_add_u32 m0, s77, 81920
v_cvt_pk_bf16_f32 v81, v82, v83
v_mfma_f32_16x16x32_bf16 a[80:83], a[240:243], v[144:147], a[80:83]
buffer_load_dwordx4 v10, s[28:31], s76 offen nt lds
v_mfma_f32_16x16x32_bf16 a[84:87], a[244:247], v[144:147], a[84:87]
v_exp_f32 v85, v85
v_mfma_f32_16x16x32_bf16 a[88:91], a[248:251], v[144:147], a[88:91]
v_mfma_f32_16x16x32_bf16 a[92:95], a[252:255], v[144:147], a[92:95]
v_exp_f32 v86, v86
v_mfma_f32_16x16x32_bf16 v[120:123], v[48:51], v[144:147], v[120:123]
v_mfma_f32_16x16x32_bf16 v[144:147], a[192:195], v[224:227], 0
ds_read_b64 a[192:193], v20 offset:32768
ds_read_b64 a[194:195], v21 offset:32768
v_cvt_pk_bf16_f32 v82, v84, v85
v_mfma_f32_16x16x32_bf16 v[148:151], a[208:211], v[224:227], 0
v_exp_f32 v112, v112
v_mfma_f32_16x16x32_bf16 v[144:147], a[196:199], v[228:231], v[144:147]
ds_read_b64 a[208:209], v20 offset:36864
ds_read_b64 a[210:211], v21 offset:36864
v_mfma_f32_16x16x32_bf16 v[148:151], a[212:215], v[228:231], v[148:151]
buffer_load_dwordx4 v19, s[28:31], s76 offen offset:1024 nt lds
v_exp_f32 v87, v87
v_mfma_f32_16x16x32_bf16 v[144:147], a[200:203], v[232:235], v[144:147]
ds_read_b64 a[196:197], v22 offset:32768
ds_read_b64 a[198:199], v23 offset:32768
v_cvt_pk_bf16_f32 v83, v86, v87
v_mfma_f32_16x16x32_bf16 v[148:151], a[216:219], v[232:235], v[148:151]
v_exp_f32 v113, v113
v_mfma_f32_16x16x32_bf16 v[144:147], a[204:207], v[236:239], v[144:147]
ds_read_b64 a[212:213], v22 offset:36864
ds_read_b64 a[214:215], v23 offset:36864
v_mfma_f32_16x16x32_bf16 v[148:151], a[220:223], v[236:239], v[148:151]
v_exp_f32 v114, v114
v_cvt_pk_bf16_f32 v112, v112, v113
v_mfma_f32_16x16x32_bf16 a[96:99], a[224:227], v[80:83], a[96:99]
ds_read_b64 a[200:201], v24 offset:32768
ds_read_b64 a[202:203], v25 offset:32768
v_mfma_f32_16x16x32_bf16 a[100:103], a[228:231], v[80:83], a[100:103]
v_exp_f32 v115, v115
v_mfma_f32_16x16x32_bf16 a[104:107], a[232:235], v[80:83], a[104:107]
ds_read_b64 a[216:217], v24 offset:36864
ds_read_b64 a[218:219], v25 offset:36864
v_mfma_f32_16x16x32_bf16 a[108:111], a[236:239], v[80:83], a[108:111]
buffer_load_dwordx4 v10, s[28:31], s76 offen offset:2048 nt lds
v_exp_f32 v116, v116
v_mfma_f32_16x16x32_bf16 a[112:115], a[240:243], v[80:83], a[112:115]
ds_read_b64 a[204:205], v26 offset:32768
ds_read_b64 a[206:207], v27 offset:32768
v_cvt_pk_bf16_f32 v113, v114, v115
v_mfma_f32_16x16x32_bf16 a[116:119], a[244:247], v[80:83], a[116:119]
v_exp_f32 v117, v117
v_mfma_f32_16x16x32_bf16 a[120:123], a[248:251], v[80:83], a[120:123]
ds_read_b64 a[220:221], v26 offset:36864
ds_read_b64 a[222:223], v27 offset:36864
v_mfma_f32_16x16x32_bf16 a[124:127], a[252:255], v[80:83], a[124:127]
v_exp_f32 v118, v118
v_mfma_f32_16x16x32_bf16 v[124:127], v[48:51], v[80:83], v[124:127]
s_waitcnt lgkmcnt(4)
v_mfma_f32_16x16x32_bf16 v[80:83], a[192:195], v[64:67], 0
v_cvt_pk_bf16_f32 v114, v116, v117
v_exp_f32 v144, v144
v_mfma_f32_16x16x32_bf16 v[84:87], a[208:211], v[64:67], 0
v_exp_f32 v145, v145
v_mfma_f32_16x16x32_bf16 v[80:83], a[196:199], v[68:71], v[80:83]
buffer_load_dwordx4 v19, s[28:31], s76 offen offset:3072 nt lds
v_exp_f32 v119, v119
v_mfma_f32_16x16x32_bf16 v[84:87], a[212:215], v[68:71], v[84:87]
v_exp_f32 v146, v146
v_mfma_f32_16x16x32_bf16 v[80:83], a[200:203], v[72:75], v[80:83]
v_cvt_pk_bf16_f32 v115, v118, v119
v_mfma_f32_16x16x32_bf16 v[84:87], a[216:219], v[72:75], v[84:87]
v_cvt_pk_bf16_f32 v144, v144, v145
s_waitcnt lgkmcnt(0)
v_mfma_f32_16x16x32_bf16 v[80:83], a[204:207], v[76:79], v[80:83]
v_mfma_f32_16x16x32_bf16 v[84:87], a[220:223], v[76:79], v[84:87]
v_exp_f32 v147, v147
v_mfma_f32_16x16x32_bf16 a[128:131], a[224:227], v[112:115], a[128:131]
v_mfma_f32_16x16x32_bf16 a[132:135], a[228:231], v[112:115], a[132:135]
v_exp_f32 v148, v148
v_mfma_f32_16x16x32_bf16 a[136:139], a[232:235], v[112:115], a[136:139]
s_waitcnt vmcnt(24)
s_barrier
v_mfma_f32_16x16x32_bf16 a[140:143], a[236:239], v[112:115], a[140:143]
s_add_u32 s75, s75, 8192
v_cvt_pk_bf16_f32 v145, v146, v147
v_mfma_f32_16x16x32_bf16 a[144:147], a[240:243], v[112:115], a[144:147]
s_and_b32 s75, s75, 131071
v_mfma_f32_16x16x32_bf16 a[148:151], a[244:247], v[112:115], a[148:151]
s_add_u32 m0, s77, 32768
v_exp_f32 v149, v149
v_mfma_f32_16x16x32_bf16 a[152:155], a[248:251], v[112:115], a[152:155]
buffer_load_dwordx4 v6, s[24:27], s75 offen nt lds
v_mfma_f32_16x16x32_bf16 a[156:159], a[252:255], v[112:115], a[156:159]
v_exp_f32 v150, v150
v_mfma_f32_16x16x32_bf16 v[152:155], v[48:51], v[112:115], v[152:155]
v_mfma_f32_16x16x32_bf16 v[112:115], a[192:195], v[96:99], 0
v_cvt_pk_bf16_f32 v146, v148, v149
v_exp_f32 v80, v80
v_mfma_f32_16x16x32_bf16 v[116:119], a[208:211], v[96:99], 0
v_exp_f32 v81, v81
v_mfma_f32_16x16x32_bf16 v[112:115], a[196:199], v[100:103], v[112:115]
v_exp_f32 v151, v151
v_mfma_f32_16x16x32_bf16 v[116:119], a[212:215], v[100:103], v[116:119]
v_exp_f32 v82, v82
v_mfma_f32_16x16x32_bf16 v[112:115], a[200:203], v[104:107], v[112:115]
v_cvt_pk_bf16_f32 v147, v150, v151
v_mfma_f32_16x16x32_bf16 v[116:119], a[216:219], v[104:107], v[116:119]
v_cvt_pk_bf16_f32 v80, v80, v81
v_mfma_f32_16x16x32_bf16 v[112:115], a[204:207], v[108:111], v[112:115]
v_mfma_f32_16x16x32_bf16 v[116:119], a[220:223], v[108:111], v[116:119]
v_exp_f32 v83, v83
v_mfma_f32_16x16x32_bf16 a[160:163], a[224:227], v[144:147], a[160:163]
ds_read_b64_tr_b16 a[224:225], v28 offset:32768
ds_read_b64_tr_b16 a[226:227], v28 offset:36864
v_mfma_f32_16x16x32_bf16 a[164:167], a[228:231], v[144:147], a[164:167]
buffer_load_dwordx4 v7, s[24:27], s75 offen offset:1024 nt lds
v_exp_f32 v84, v84
v_mfma_f32_16x16x32_bf16 a[168:171], a[232:235], v[144:147], a[168:171]
ds_read_b64_tr_b16 a[228:229], v29 offset:32768
ds_read_b64_tr_b16 a[230:231], v29 offset:36864
v_mfma_f32_16x16x32_bf16 a[172:175], a[236:239], v[144:147], a[172:175]
v_cvt_pk_bf16_f32 v81, v82, v83
v_mfma_f32_16x16x32_bf16 a[176:179], a[240:243], v[144:147], a[176:179]
ds_read_b64_tr_b16 a[232:233], v30 offset:32768
ds_read_b64_tr_b16 a[234:235], v30 offset:36864
v_lshlrev_b32 v179, 7, v42
v_mfma_f32_16x16x32_bf16 a[180:183], a[244:247], v[144:147], a[180:183]
v_exp_f32 v85, v85
v_mfma_f32_16x16x32_bf16 a[184:187], a[248:251], v[144:147], a[184:187]
buffer_load_dword v179, v179, s[52:55], s0 offen
ds_read_b64_tr_b16 a[236:237], v31 offset:32768
ds_read_b64_tr_b16 a[238:239], v31 offset:36864
v_mfma_f32_16x16x32_bf16 a[188:191], a[252:255], v[144:147], a[188:191]
v_exp_f32 v86, v86
v_mfma_f32_16x16x32_bf16 v[156:159], v[48:51], v[144:147], v[156:159]
ds_read_b64_tr_b16 a[240:241], v44 offset:32768
ds_read_b64_tr_b16 a[242:243], v44 offset:36864
v_mfma_f32_16x16x32_bf16 v[144:147], a[192:195], v[128:131], 0
v_cvt_pk_bf16_f32 v82, v84, v85
v_exp_f32 v112, v112
v_mfma_f32_16x16x32_bf16 v[148:151], a[208:211], v[128:131], 0
ds_read_b64_tr_b16 a[244:245], v45 offset:32768
ds_read_b64_tr_b16 a[246:247], v45 offset:36864
v_mfma_f32_16x16x32_bf16 v[144:147], a[196:199], v[132:135], v[144:147]
v_exp_f32 v87, v87
v_mfma_f32_16x16x32_bf16 v[148:151], a[212:215], v[132:135], v[148:151]
ds_read_b64_tr_b16 a[248:249], v46 offset:32768
ds_read_b64_tr_b16 a[250:251], v46 offset:36864
v_mfma_f32_16x16x32_bf16 v[144:147], a[200:203], v[136:139], v[144:147]
buffer_load_dwordx4 v8, s[24:27], s75 offen offset:2048 nt lds
v_cvt_pk_bf16_f32 v83, v86, v87
v_mfma_f32_16x16x32_bf16 v[148:151], a[216:219], v[136:139], v[148:151]
ds_read_b64_tr_b16 a[252:253], v47 offset:32768
ds_read_b64_tr_b16 a[254:255], v47 offset:36864
v_mfma_f32_16x16x32_bf16 v[144:147], a[204:207], v[140:143], v[144:147]
v_exp_f32 v113, v113
v_mfma_f32_16x16x32_bf16 v[148:151], a[220:223], v[140:143], v[148:151]
v_exp_f32 v114, v114
v_cvt_pk_bf16_f32 v112, v112, v113
s_waitcnt lgkmcnt(4)
v_mfma_f32_16x16x32_bf16 a[0:3], a[224:227], v[80:83], a[0:3]
v_exp_f32 v115, v115
v_mfma_f32_16x16x32_bf16 a[4:7], a[228:231], v[80:83], a[4:7]
v_exp_f32 v116, v116
v_mfma_f32_16x16x32_bf16 a[8:11], a[232:235], v[80:83], a[8:11]
v_mfma_f32_16x16x32_bf16 a[12:15], a[236:239], v[80:83], a[12:15]
v_cvt_pk_bf16_f32 v113, v114, v115
v_mfma_f32_16x16x32_bf16 a[16:19], a[240:243], v[80:83], a[16:19]
v_mfma_f32_16x16x32_bf16 a[20:23], a[244:247], v[80:83], a[20:23]
v_exp_f32 v117, v117
s_waitcnt lgkmcnt(0)
v_mfma_f32_16x16x32_bf16 a[24:27], a[248:251], v[80:83], a[24:27]
v_mfma_f32_16x16x32_bf16 a[28:31], a[252:255], v[80:83], a[28:31]
v_exp_f32 v118, v118
v_mfma_f32_16x16x32_bf16 v[88:91], v[48:51], v[80:83], v[88:91]
buffer_load_dwordx4 v9, s[24:27], s75 offen offset:3072 nt lds
v_mfma_f32_16x16x32_bf16 v[80:83], a[192:195], v[160:163], 0
v_cvt_pk_bf16_f32 v114, v116, v117
v_exp_f32 v144, v144
v_mfma_f32_16x16x32_bf16 v[84:87], a[208:211], v[160:163], 0
v_exp_f32 v145, v145
v_mfma_f32_16x16x32_bf16 v[80:83], a[196:199], v[164:167], v[80:83]
v_exp_f32 v119, v119
v_mfma_f32_16x16x32_bf16 v[84:87], a[212:215], v[164:167], v[84:87]
v_exp_f32 v146, v146
v_mfma_f32_16x16x32_bf16 v[80:83], a[200:203], v[168:171], v[80:83]
v_cvt_pk_bf16_f32 v115, v118, v119
v_mfma_f32_16x16x32_bf16 v[84:87], a[216:219], v[168:171], v[84:87]
v_cvt_pk_bf16_f32 v144, v144, v145
v_mfma_f32_16x16x32_bf16 v[80:83], a[204:207], v[172:175], v[80:83]
v_mfma_f32_16x16x32_bf16 v[84:87], a[220:223], v[172:175], v[84:87]
v_exp_f32 v147, v147
v_mfma_f32_16x16x32_bf16 a[32:35], a[224:227], v[112:115], a[32:35]
v_mfma_f32_16x16x32_bf16 a[36:39], a[228:231], v[112:115], a[36:39]
v_exp_f32 v148, v148
v_mfma_f32_16x16x32_bf16 a[40:43], a[232:235], v[112:115], a[40:43]
v_mfma_f32_16x16x32_bf16 a[44:47], a[236:239], v[112:115], a[44:47]
v_cvt_pk_bf16_f32 v145, v146, v147
v_mfma_f32_16x16x32_bf16 a[48:51], a[240:243], v[112:115], a[48:51]
v_mfma_f32_16x16x32_bf16 a[52:55], a[244:247], v[112:115], a[52:55]
v_exp_f32 v149, v149
v_mfma_f32_16x16x32_bf16 a[56:59], a[248:251], v[112:115], a[56:59]
v_mfma_f32_16x16x32_bf16 a[60:63], a[252:255], v[112:115], a[60:63]
v_exp_f32 v150, v150
v_mfma_f32_16x16x32_bf16 v[92:95], v[48:51], v[112:115], v[92:95]
v_mfma_f32_16x16x32_bf16 v[112:115], a[192:195], v[192:195], 0
v_cvt_pk_bf16_f32 v146, v148, v149
v_exp_f32 v80, v80
v_mfma_f32_16x16x32_bf16 v[116:119], a[208:211], v[192:195], 0
v_exp_f32 v81, v81
v_mfma_f32_16x16x32_bf16 v[112:115], a[196:199], v[196:199], v[112:115]
v_exp_f32 v151, v151
v_mfma_f32_16x16x32_bf16 v[116:119], a[212:215], v[196:199], v[116:119]
v_exp_f32 v82, v82
v_mfma_f32_16x16x32_bf16 v[112:115], a[200:203], v[200:203], v[112:115]
v_cvt_pk_bf16_f32 v147, v150, v151
v_mfma_f32_16x16x32_bf16 v[116:119], a[216:219], v[200:203], v[116:119]
v_cvt_pk_bf16_f32 v80, v80, v81
v_mfma_f32_16x16x32_bf16 v[112:115], a[204:207], v[204:207], v[112:115]
v_mfma_f32_16x16x32_bf16 v[116:119], a[220:223], v[204:207], v[116:119]
v_exp_f32 v83, v83
v_mfma_f32_16x16x32_bf16 a[64:67], a[224:227], v[144:147], a[64:67]
s_waitcnt vmcnt(25)
s_barrier
v_mfma_f32_16x16x32_bf16 a[68:71], a[228:231], v[144:147], a[68:71]
s_add_u32 s76, s76, 8192
v_exp_f32 v84, v84
v_mfma_f32_16x16x32_bf16 a[72:75], a[232:235], v[144:147], a[72:75]
s_and_b32 s76, s76, 131071
v_mfma_f32_16x16x32_bf16 a[76:79], a[236:239], v[144:147], a[76:79]
s_add_u32 m0, s77, 98304
v_cvt_pk_bf16_f32 v81, v82, v83
v_mfma_f32_16x16x32_bf16 a[80:83], a[240:243], v[144:147], a[80:83]
buffer_load_dwordx4 v10, s[28:31], s76 offen nt lds
v_mfma_f32_16x16x32_bf16 a[84:87], a[244:247], v[144:147], a[84:87]
v_exp_f32 v85, v85
v_mfma_f32_16x16x32_bf16 a[88:91], a[248:251], v[144:147], a[88:91]
v_mfma_f32_16x16x32_bf16 a[92:95], a[252:255], v[144:147], a[92:95]
v_exp_f32 v86, v86
v_mfma_f32_16x16x32_bf16 v[120:123], v[48:51], v[144:147], v[120:123]
v_mfma_f32_16x16x32_bf16 v[144:147], a[192:195], v[224:227], 0
ds_read_b64 a[192:193], v20 offset:49152
ds_read_b64 a[194:195], v21 offset:49152
v_cvt_pk_bf16_f32 v82, v84, v85
v_mfma_f32_16x16x32_bf16 v[148:151], a[208:211], v[224:227], 0
v_exp_f32 v112, v112
v_mfma_f32_16x16x32_bf16 v[144:147], a[196:199], v[228:231], v[144:147]
ds_read_b64 a[208:209], v20 offset:53248
ds_read_b64 a[210:211], v21 offset:53248
v_mfma_f32_16x16x32_bf16 v[148:151], a[212:215], v[228:231], v[148:151]
buffer_load_dwordx4 v19, s[28:31], s76 offen offset:1024 nt lds
v_exp_f32 v87, v87
v_mfma_f32_16x16x32_bf16 v[144:147], a[200:203], v[232:235], v[144:147]
ds_read_b64 a[196:197], v22 offset:49152
ds_read_b64 a[198:199], v23 offset:49152
v_cvt_pk_bf16_f32 v83, v86, v87
v_mfma_f32_16x16x32_bf16 v[148:151], a[216:219], v[232:235], v[148:151]
v_exp_f32 v113, v113
v_mfma_f32_16x16x32_bf16 v[144:147], a[204:207], v[236:239], v[144:147]
ds_read_b64 a[212:213], v22 offset:53248
ds_read_b64 a[214:215], v23 offset:53248
v_mfma_f32_16x16x32_bf16 v[148:151], a[220:223], v[236:239], v[148:151]
v_exp_f32 v114, v114
v_cvt_pk_bf16_f32 v112, v112, v113
v_mfma_f32_16x16x32_bf16 a[96:99], a[224:227], v[80:83], a[96:99]
ds_read_b64 a[200:201], v24 offset:49152
ds_read_b64 a[202:203], v25 offset:49152
v_mfma_f32_16x16x32_bf16 a[100:103], a[228:231], v[80:83], a[100:103]
v_exp_f32 v115, v115
v_mfma_f32_16x16x32_bf16 a[104:107], a[232:235], v[80:83], a[104:107]
ds_read_b64 a[216:217], v24 offset:53248
ds_read_b64 a[218:219], v25 offset:53248
v_mfma_f32_16x16x32_bf16 a[108:111], a[236:239], v[80:83], a[108:111]
buffer_load_dwordx4 v10, s[28:31], s76 offen offset:2048 nt lds
v_exp_f32 v116, v116
v_mfma_f32_16x16x32_bf16 a[112:115], a[240:243], v[80:83], a[112:115]
ds_read_b64 a[204:205], v26 offset:49152
ds_read_b64 a[206:207], v27 offset:49152
v_cvt_pk_bf16_f32 v113, v114, v115
v_mfma_f32_16x16x32_bf16 a[116:119], a[244:247], v[80:83], a[116:119]
v_exp_f32 v117, v117
v_mfma_f32_16x16x32_bf16 a[120:123], a[248:251], v[80:83], a[120:123]
ds_read_b64 a[220:221], v26 offset:53248
ds_read_b64 a[222:223], v27 offset:53248
v_mfma_f32_16x16x32_bf16 a[124:127], a[252:255], v[80:83], a[124:127]
v_exp_f32 v118, v118
v_mfma_f32_16x16x32_bf16 v[124:127], v[48:51], v[80:83], v[124:127]
s_waitcnt lgkmcnt(4)
v_mfma_f32_16x16x32_bf16 v[80:83], a[192:195], v[64:67], 0
v_cvt_pk_bf16_f32 v114, v116, v117
v_exp_f32 v144, v144
v_mfma_f32_16x16x32_bf16 v[84:87], a[208:211], v[64:67], 0
v_exp_f32 v145, v145
v_mfma_f32_16x16x32_bf16 v[80:83], a[196:199], v[68:71], v[80:83]
buffer_load_dwordx4 v19, s[28:31], s76 offen offset:3072 nt lds
v_exp_f32 v119, v119
v_mfma_f32_16x16x32_bf16 v[84:87], a[212:215], v[68:71], v[84:87]
v_exp_f32 v146, v146
v_mfma_f32_16x16x32_bf16 v[80:83], a[200:203], v[72:75], v[80:83]
v_cvt_pk_bf16_f32 v115, v118, v119
v_mfma_f32_16x16x32_bf16 v[84:87], a[216:219], v[72:75], v[84:87]
v_cvt_pk_bf16_f32 v144, v144, v145
s_waitcnt lgkmcnt(0)
v_mfma_f32_16x16x32_bf16 v[80:83], a[204:207], v[76:79], v[80:83]
v_mfma_f32_16x16x32_bf16 v[84:87], a[220:223], v[76:79], v[84:87]
v_exp_f32 v147, v147
v_mfma_f32_16x16x32_bf16 a[128:131], a[224:227], v[112:115], a[128:131]
v_mfma_f32_16x16x32_bf16 a[132:135], a[228:231], v[112:115], a[132:135]
v_exp_f32 v148, v148
v_mfma_f32_16x16x32_bf16 a[136:139], a[232:235], v[112:115], a[136:139]
s_waitcnt vmcnt(25)
s_barrier
v_mfma_f32_16x16x32_bf16 a[140:143], a[236:239], v[112:115], a[140:143]
s_add_u32 s75, s75, 8192
v_cvt_pk_bf16_f32 v145, v146, v147
v_mfma_f32_16x16x32_bf16 a[144:147], a[240:243], v[112:115], a[144:147]
s_and_b32 s75, s75, 131071
v_mfma_f32_16x16x32_bf16 a[148:151], a[244:247], v[112:115], a[148:151]
s_add_u32 m0, s77, 49152
v_exp_f32 v149, v149
v_mfma_f32_16x16x32_bf16 a[152:155], a[248:251], v[112:115], a[152:155]
buffer_load_dwordx4 v6, s[24:27], s75 offen nt lds
v_mfma_f32_16x16x32_bf16 a[156:159], a[252:255], v[112:115], a[156:159]
v_exp_f32 v150, v150
v_mfma_f32_16x16x32_bf16 v[152:155], v[48:51], v[112:115], v[152:155]
v_mfma_f32_16x16x32_bf16 v[112:115], a[192:195], v[96:99], 0
v_cvt_pk_bf16_f32 v146, v148, v149
v_exp_f32 v80, v80
v_mfma_f32_16x16x32_bf16 v[116:119], a[208:211], v[96:99], 0
v_exp_f32 v81, v81
v_mfma_f32_16x16x32_bf16 v[112:115], a[196:199], v[100:103], v[112:115]
v_exp_f32 v151, v151
v_mfma_f32_16x16x32_bf16 v[116:119], a[212:215], v[100:103], v[116:119]
v_exp_f32 v82, v82
v_mfma_f32_16x16x32_bf16 v[112:115], a[200:203], v[104:107], v[112:115]
v_cvt_pk_bf16_f32 v147, v150, v151
v_mfma_f32_16x16x32_bf16 v[116:119], a[216:219], v[104:107], v[116:119]
v_cvt_pk_bf16_f32 v80, v80, v81
v_mfma_f32_16x16x32_bf16 v[112:115], a[204:207], v[108:111], v[112:115]
v_mfma_f32_16x16x32_bf16 v[116:119], a[220:223], v[108:111], v[116:119]
v_exp_f32 v83, v83
v_mfma_f32_16x16x32_bf16 a[160:163], a[224:227], v[144:147], a[160:163]
ds_read_b64_tr_b16 a[224:225], v28 offset:49152
ds_read_b64_tr_b16 a[226:227], v28 offset:53248
v_mfma_f32_16x16x32_bf16 a[164:167], a[228:231], v[144:147], a[164:167]
buffer_load_dwordx4 v7, s[24:27], s75 offen offset:1024 nt lds
v_exp_f32 v84, v84
v_mfma_f32_16x16x32_bf16 a[168:171], a[232:235], v[144:147], a[168:171]
ds_read_b64_tr_b16 a[228:229], v29 offset:49152
ds_read_b64_tr_b16 a[230:231], v29 offset:53248
v_mfma_f32_16x16x32_bf16 a[172:175], a[236:239], v[144:147], a[172:175]
v_cvt_pk_bf16_f32 v81, v82, v83
v_mfma_f32_16x16x32_bf16 a[176:179], a[240:243], v[144:147], a[176:179]
ds_read_b64_tr_b16 a[232:233], v30 offset:49152
ds_read_b64_tr_b16 a[234:235], v30 offset:53248
v_mfma_f32_16x16x32_bf16 a[180:183], a[244:247], v[144:147], a[180:183]
v_exp_f32 v85, v85
v_mfma_f32_16x16x32_bf16 a[184:187], a[248:251], v[144:147], a[184:187]
ds_read_b64_tr_b16 a[236:237], v31 offset:49152
ds_read_b64_tr_b16 a[238:239], v31 offset:53248
v_mfma_f32_16x16x32_bf16 a[188:191], a[252:255], v[144:147], a[188:191]
v_exp_f32 v86, v86
v_mfma_f32_16x16x32_bf16 v[156:159], v[48:51], v[144:147], v[156:159]
ds_read_b64_tr_b16 a[240:241], v44 offset:49152
ds_read_b64_tr_b16 a[242:243], v44 offset:53248
v_mfma_f32_16x16x32_bf16 v[144:147], a[192:195], v[128:131], 0
v_cvt_pk_bf16_f32 v82, v84, v85
v_exp_f32 v112, v112
v_mfma_f32_16x16x32_bf16 v[148:151], a[208:211], v[128:131], 0
ds_read_b64_tr_b16 a[244:245], v45 offset:49152
ds_read_b64_tr_b16 a[246:247], v45 offset:53248
v_mfma_f32_16x16x32_bf16 v[144:147], a[196:199], v[132:135], v[144:147]
v_exp_f32 v87, v87
v_mfma_f32_16x16x32_bf16 v[148:151], a[212:215], v[132:135], v[148:151]
ds_read_b64_tr_b16 a[248:249], v46 offset:49152
ds_read_b64_tr_b16 a[250:251], v46 offset:53248
v_mfma_f32_16x16x32_bf16 v[144:147], a[200:203], v[136:139], v[144:147]
buffer_load_dwordx4 v8, s[24:27], s75 offen offset:2048 nt lds
v_cvt_pk_bf16_f32 v83, v86, v87
v_mfma_f32_16x16x32_bf16 v[148:151], a[216:219], v[136:139], v[148:151]
ds_read_b64_tr_b16 a[252:253], v47 offset:49152
ds_read_b64_tr_b16 a[254:255], v47 offset:53248
v_mfma_f32_16x16x32_bf16 v[144:147], a[204:207], v[140:143], v[144:147]
v_exp_f32 v113, v113
v_mfma_f32_16x16x32_bf16 v[148:151], a[220:223], v[140:143], v[148:151]
v_exp_f32 v114, v114
v_cvt_pk_bf16_f32 v112, v112, v113
s_waitcnt lgkmcnt(4)
v_mfma_f32_16x16x32_bf16 a[0:3], a[224:227], v[80:83], a[0:3]
v_exp_f32 v115, v115
v_mfma_f32_16x16x32_bf16 a[4:7], a[228:231], v[80:83], a[4:7]
v_exp_f32 v116, v116
v_mfma_f32_16x16x32_bf16 a[8:11], a[232:235], v[80:83], a[8:11]
v_mfma_f32_16x16x32_bf16 a[12:15], a[236:239], v[80:83], a[12:15]
v_cvt_pk_bf16_f32 v113, v114, v115
v_mfma_f32_16x16x32_bf16 a[16:19], a[240:243], v[80:83], a[16:19]
v_mfma_f32_16x16x32_bf16 a[20:23], a[244:247], v[80:83], a[20:23]
v_exp_f32 v117, v117
s_waitcnt lgkmcnt(0)
v_mfma_f32_16x16x32_bf16 a[24:27], a[248:251], v[80:83], a[24:27]
v_mfma_f32_16x16x32_bf16 a[28:31], a[252:255], v[80:83], a[28:31]
v_exp_f32 v118, v118
v_mfma_f32_16x16x32_bf16 v[88:91], v[48:51], v[80:83], v[88:91]
buffer_load_dwordx4 v9, s[24:27], s75 offen offset:3072 nt lds
v_mfma_f32_16x16x32_bf16 v[80:83], a[192:195], v[160:163], 0
v_cvt_pk_bf16_f32 v114, v116, v117
v_exp_f32 v144, v144
v_mfma_f32_16x16x32_bf16 v[84:87], a[208:211], v[160:163], 0
v_exp_f32 v145, v145
v_mfma_f32_16x16x32_bf16 v[80:83], a[196:199], v[164:167], v[80:83]
v_exp_f32 v119, v119
v_mfma_f32_16x16x32_bf16 v[84:87], a[212:215], v[164:167], v[84:87]
v_exp_f32 v146, v146
v_mfma_f32_16x16x32_bf16 v[80:83], a[200:203], v[168:171], v[80:83]
v_cvt_pk_bf16_f32 v115, v118, v119
v_mfma_f32_16x16x32_bf16 v[84:87], a[216:219], v[168:171], v[84:87]
v_cvt_pk_bf16_f32 v144, v144, v145
v_mfma_f32_16x16x32_bf16 v[80:83], a[204:207], v[172:175], v[80:83]
v_mfma_f32_16x16x32_bf16 v[84:87], a[220:223], v[172:175], v[84:87]
v_exp_f32 v147, v147
v_mfma_f32_16x16x32_bf16 a[32:35], a[224:227], v[112:115], a[32:35]
v_mfma_f32_16x16x32_bf16 a[36:39], a[228:231], v[112:115], a[36:39]
v_exp_f32 v148, v148
v_mfma_f32_16x16x32_bf16 a[40:43], a[232:235], v[112:115], a[40:43]
v_mfma_f32_16x16x32_bf16 a[44:47], a[236:239], v[112:115], a[44:47]
v_cvt_pk_bf16_f32 v145, v146, v147
v_mfma_f32_16x16x32_bf16 a[48:51], a[240:243], v[112:115], a[48:51]
v_mfma_f32_16x16x32_bf16 a[52:55], a[244:247], v[112:115], a[52:55]
v_exp_f32 v149, v149
v_mfma_f32_16x16x32_bf16 a[56:59], a[248:251], v[112:115], a[56:59]
v_mfma_f32_16x16x32_bf16 a[60:63], a[252:255], v[112:115], a[60:63]
v_exp_f32 v150, v150
v_mfma_f32_16x16x32_bf16 v[92:95], v[48:51], v[112:115], v[92:95]
v_mfma_f32_16x16x32_bf16 v[112:115], a[192:195], v[192:195], 0
v_cvt_pk_bf16_f32 v146, v148, v149
v_exp_f32 v80, v80
v_mfma_f32_16x16x32_bf16 v[116:119], a[208:211], v[192:195], 0
v_exp_f32 v81, v81
v_mfma_f32_16x16x32_bf16 v[112:115], a[196:199], v[196:199], v[112:115]
v_exp_f32 v151, v151
v_mfma_f32_16x16x32_bf16 v[116:119], a[212:215], v[196:199], v[116:119]
v_exp_f32 v82, v82
v_mfma_f32_16x16x32_bf16 v[112:115], a[200:203], v[200:203], v[112:115]
v_cvt_pk_bf16_f32 v147, v150, v151
v_mfma_f32_16x16x32_bf16 v[116:119], a[216:219], v[200:203], v[116:119]
v_cvt_pk_bf16_f32 v80, v80, v81
v_mfma_f32_16x16x32_bf16 v[112:115], a[204:207], v[204:207], v[112:115]
v_mfma_f32_16x16x32_bf16 v[116:119], a[220:223], v[204:207], v[116:119]
v_exp_f32 v83, v83
v_mfma_f32_16x16x32_bf16 a[64:67], a[224:227], v[144:147], a[64:67]
s_waitcnt vmcnt(25)
s_barrier
v_mfma_f32_16x16x32_bf16 a[68:71], a[228:231], v[144:147], a[68:71]
s_add_u32 s76, s76, 8192
v_exp_f32 v84, v84
v_mfma_f32_16x16x32_bf16 a[72:75], a[232:235], v[144:147], a[72:75]
s_and_b32 s76, s76, 131071
v_mfma_f32_16x16x32_bf16 a[76:79], a[236:239], v[144:147], a[76:79]
s_add_u32 m0, s77, 114688
v_cvt_pk_bf16_f32 v81, v82, v83
v_mfma_f32_16x16x32_bf16 a[80:83], a[240:243], v[144:147], a[80:83]
buffer_load_dwordx4 v10, s[28:31], s76 offen nt lds
v_mfma_f32_16x16x32_bf16 a[84:87], a[244:247], v[144:147], a[84:87]
v_exp_f32 v85, v85
v_mfma_f32_16x16x32_bf16 a[88:91], a[248:251], v[144:147], a[88:91]
v_mfma_f32_16x16x32_bf16 a[92:95], a[252:255], v[144:147], a[92:95]
v_exp_f32 v86, v86
v_mfma_f32_16x16x32_bf16 v[120:123], v[48:51], v[144:147], v[120:123]
v_mfma_f32_16x16x32_bf16 v[144:147], a[192:195], v[224:227], 0
ds_read_b64 a[192:193], v20
ds_read_b64 a[194:195], v21
v_cvt_pk_bf16_f32 v82, v84, v85
v_mfma_f32_16x16x32_bf16 v[148:151], a[208:211], v[224:227], 0
v_exp_f32 v112, v112
v_mfma_f32_16x16x32_bf16 v[144:147], a[196:199], v[228:231], v[144:147]
ds_read_b64 a[208:209], v20 offset:4096
ds_read_b64 a[210:211], v21 offset:4096
v_mfma_f32_16x16x32_bf16 v[148:151], a[212:215], v[228:231], v[148:151]
buffer_load_dwordx4 v19, s[28:31], s76 offen offset:1024 nt lds
v_exp_f32 v87, v87
v_mfma_f32_16x16x32_bf16 v[144:147], a[200:203], v[232:235], v[144:147]
ds_read_b64 a[196:197], v22
ds_read_b64 a[198:199], v23
v_cvt_pk_bf16_f32 v83, v86, v87
v_mfma_f32_16x16x32_bf16 v[148:151], a[216:219], v[232:235], v[148:151]
v_exp_f32 v113, v113
v_mfma_f32_16x16x32_bf16 v[144:147], a[204:207], v[236:239], v[144:147]
ds_read_b64 a[212:213], v22 offset:4096
ds_read_b64 a[214:215], v23 offset:4096
v_mfma_f32_16x16x32_bf16 v[148:151], a[220:223], v[236:239], v[148:151]
v_exp_f32 v114, v114
v_cvt_pk_bf16_f32 v112, v112, v113
v_mfma_f32_16x16x32_bf16 a[96:99], a[224:227], v[80:83], a[96:99]
ds_read_b64 a[200:201], v24
ds_read_b64 a[202:203], v25
v_mfma_f32_16x16x32_bf16 a[100:103], a[228:231], v[80:83], a[100:103]
v_exp_f32 v115, v115
v_mfma_f32_16x16x32_bf16 a[104:107], a[232:235], v[80:83], a[104:107]
ds_read_b64 a[216:217], v24 offset:4096
ds_read_b64 a[218:219], v25 offset:4096
v_mfma_f32_16x16x32_bf16 a[108:111], a[236:239], v[80:83], a[108:111]
buffer_load_dwordx4 v10, s[28:31], s76 offen offset:2048 nt lds
v_exp_f32 v116, v116
v_mfma_f32_16x16x32_bf16 a[112:115], a[240:243], v[80:83], a[112:115]
ds_read_b64 a[204:205], v26
ds_read_b64 a[206:207], v27
v_cvt_pk_bf16_f32 v113, v114, v115
v_mfma_f32_16x16x32_bf16 a[116:119], a[244:247], v[80:83], a[116:119]
v_exp_f32 v117, v117
v_mfma_f32_16x16x32_bf16 a[120:123], a[248:251], v[80:83], a[120:123]
ds_read_b64 a[220:221], v26 offset:4096
ds_read_b64 a[222:223], v27 offset:4096
v_mfma_f32_16x16x32_bf16 a[124:127], a[252:255], v[80:83], a[124:127]
v_exp_f32 v118, v118
v_mfma_f32_16x16x32_bf16 v[124:127], v[48:51], v[80:83], v[124:127]
s_waitcnt lgkmcnt(4)
v_mfma_f32_16x16x32_bf16 v[80:83], a[192:195], v[64:67], 0
v_cvt_pk_bf16_f32 v114, v116, v117
v_exp_f32 v144, v144
v_mfma_f32_16x16x32_bf16 v[84:87], a[208:211], v[64:67], 0
v_exp_f32 v145, v145
v_mfma_f32_16x16x32_bf16 v[80:83], a[196:199], v[68:71], v[80:83]
buffer_load_dwordx4 v19, s[28:31], s76 offen offset:3072 nt lds
v_exp_f32 v119, v119
v_mfma_f32_16x16x32_bf16 v[84:87], a[212:215], v[68:71], v[84:87]
v_exp_f32 v146, v146
v_mfma_f32_16x16x32_bf16 v[80:83], a[200:203], v[72:75], v[80:83]
v_cvt_pk_bf16_f32 v115, v118, v119
v_mfma_f32_16x16x32_bf16 v[84:87], a[216:219], v[72:75], v[84:87]
v_cvt_pk_bf16_f32 v144, v144, v145
s_waitcnt lgkmcnt(0)
v_mfma_f32_16x16x32_bf16 v[80:83], a[204:207], v[76:79], v[80:83]
v_mfma_f32_16x16x32_bf16 v[84:87], a[220:223], v[76:79], v[84:87]
v_exp_f32 v147, v147
v_mfma_f32_16x16x32_bf16 a[128:131], a[224:227], v[112:115], a[128:131]
v_mfma_f32_16x16x32_bf16 a[132:135], a[228:231], v[112:115], a[132:135]
v_exp_f32 v148, v148
v_mfma_f32_16x16x32_bf16 a[136:139], a[232:235], v[112:115], a[136:139]
s_waitcnt vmcnt(25)
s_barrier
v_mfma_f32_16x16x32_bf16 a[140:143], a[236:239], v[112:115], a[140:143]
s_add_u32 s75, s75, 8192
v_cvt_pk_bf16_f32 v145, v146, v147
v_mfma_f32_16x16x32_bf16 a[144:147], a[240:243], v[112:115], a[144:147]
s_and_b32 s75, s75, 131071
v_mfma_f32_16x16x32_bf16 a[148:151], a[244:247], v[112:115], a[148:151]
s_add_u32 m0, s77, 0
v_exp_f32 v149, v149
v_mfma_f32_16x16x32_bf16 a[152:155], a[248:251], v[112:115], a[152:155]
buffer_load_dwordx4 v6, s[36:39], s75 offen nt lds
v_mfma_f32_16x16x32_bf16 a[156:159], a[252:255], v[112:115], a[156:159]
v_exp_f32 v150, v150
v_mfma_f32_16x16x32_bf16 v[152:155], v[48:51], v[112:115], v[152:155]
v_mfma_f32_16x16x32_bf16 v[112:115], a[192:195], v[96:99], 0
v_cvt_pk_bf16_f32 v146, v148, v149
v_exp_f32 v80, v80
v_mfma_f32_16x16x32_bf16 v[116:119], a[208:211], v[96:99], 0
v_exp_f32 v81, v81
v_mfma_f32_16x16x32_bf16 v[112:115], a[196:199], v[100:103], v[112:115]
v_exp_f32 v151, v151
v_mfma_f32_16x16x32_bf16 v[116:119], a[212:215], v[100:103], v[116:119]
v_exp_f32 v82, v82
v_mfma_f32_16x16x32_bf16 v[112:115], a[200:203], v[104:107], v[112:115]
v_cvt_pk_bf16_f32 v147, v150, v151
v_mfma_f32_16x16x32_bf16 v[116:119], a[216:219], v[104:107], v[116:119]
v_cvt_pk_bf16_f32 v80, v80, v81
v_mfma_f32_16x16x32_bf16 v[112:115], a[204:207], v[108:111], v[112:115]
v_mfma_f32_16x16x32_bf16 v[116:119], a[220:223], v[108:111], v[116:119]
v_exp_f32 v83, v83
v_mfma_f32_16x16x32_bf16 a[160:163], a[224:227], v[144:147], a[160:163]
ds_read_b64_tr_b16 a[224:225], v28
ds_read_b64_tr_b16 a[226:227], v28 offset:4096
v_mfma_f32_16x16x32_bf16 a[164:167], a[228:231], v[144:147], a[164:167]
buffer_load_dwordx4 v7, s[36:39], s75 offen offset:1024 nt lds
v_exp_f32 v84, v84
v_mfma_f32_16x16x32_bf16 a[168:171], a[232:235], v[144:147], a[168:171]
ds_read_b64_tr_b16 a[228:229], v29
ds_read_b64_tr_b16 a[230:231], v29 offset:4096
v_mfma_f32_16x16x32_bf16 a[172:175], a[236:239], v[144:147], a[172:175]
v_cvt_pk_bf16_f32 v81, v82, v83
v_mfma_f32_16x16x32_bf16 a[176:179], a[240:243], v[144:147], a[176:179]
ds_read_b64_tr_b16 a[232:233], v30
ds_read_b64_tr_b16 a[234:235], v30 offset:4096
v_mfma_f32_16x16x32_bf16 a[180:183], a[244:247], v[144:147], a[180:183]
v_exp_f32 v85, v85
v_mfma_f32_16x16x32_bf16 a[184:187], a[248:251], v[144:147], a[184:187]
ds_read_b64_tr_b16 a[236:237], v31
ds_read_b64_tr_b16 a[238:239], v31 offset:4096
v_mfma_f32_16x16x32_bf16 a[188:191], a[252:255], v[144:147], a[188:191]
v_exp_f32 v86, v86
v_mfma_f32_16x16x32_bf16 v[156:159], v[48:51], v[144:147], v[156:159]
ds_read_b64_tr_b16 a[240:241], v44
ds_read_b64_tr_b16 a[242:243], v44 offset:4096
v_mfma_f32_16x16x32_bf16 v[144:147], a[192:195], v[128:131], 0
v_cvt_pk_bf16_f32 v82, v84, v85
v_exp_f32 v112, v112
v_mfma_f32_16x16x32_bf16 v[148:151], a[208:211], v[128:131], 0
ds_read_b64_tr_b16 a[244:245], v45
ds_read_b64_tr_b16 a[246:247], v45 offset:4096
v_mfma_f32_16x16x32_bf16 v[144:147], a[196:199], v[132:135], v[144:147]
v_exp_f32 v87, v87
v_mfma_f32_16x16x32_bf16 v[148:151], a[212:215], v[132:135], v[148:151]
ds_read_b64_tr_b16 a[248:249], v46
ds_read_b64_tr_b16 a[250:251], v46 offset:4096
v_mfma_f32_16x16x32_bf16 v[144:147], a[200:203], v[136:139], v[144:147]
buffer_load_dwordx4 v8, s[36:39], s75 offen offset:2048 nt lds
v_cvt_pk_bf16_f32 v83, v86, v87
v_mfma_f32_16x16x32_bf16 v[148:151], a[216:219], v[136:139], v[148:151]
ds_read_b64_tr_b16 a[252:253], v47
ds_read_b64_tr_b16 a[254:255], v47 offset:4096
v_mfma_f32_16x16x32_bf16 v[144:147], a[204:207], v[140:143], v[144:147]
v_exp_f32 v113, v113
v_mfma_f32_16x16x32_bf16 v[148:151], a[220:223], v[140:143], v[148:151]
v_exp_f32 v114, v114
v_cvt_pk_bf16_f32 v112, v112, v113
s_waitcnt lgkmcnt(4)
v_mfma_f32_16x16x32_bf16 a[0:3], a[224:227], v[80:83], a[0:3]
v_exp_f32 v115, v115
v_mfma_f32_16x16x32_bf16 a[4:7], a[228:231], v[80:83], a[4:7]
v_exp_f32 v116, v116
v_mfma_f32_16x16x32_bf16 a[8:11], a[232:235], v[80:83], a[8:11]
v_mfma_f32_16x16x32_bf16 a[12:15], a[236:239], v[80:83], a[12:15]
v_cvt_pk_bf16_f32 v113, v114, v115
v_mfma_f32_16x16x32_bf16 a[16:19], a[240:243], v[80:83], a[16:19]
v_mfma_f32_16x16x32_bf16 a[20:23], a[244:247], v[80:83], a[20:23]
v_exp_f32 v117, v117
s_waitcnt lgkmcnt(0)
v_mfma_f32_16x16x32_bf16 a[24:27], a[248:251], v[80:83], a[24:27]
v_mfma_f32_16x16x32_bf16 a[28:31], a[252:255], v[80:83], a[28:31]
v_exp_f32 v118, v118
v_mfma_f32_16x16x32_bf16 v[88:91], v[48:51], v[80:83], v[88:91]
buffer_load_dwordx4 v9, s[36:39], s75 offen offset:3072 nt lds
v_mfma_f32_16x16x32_bf16 v[80:83], a[192:195], v[160:163], 0
v_cvt_pk_bf16_f32 v114, v116, v117
v_exp_f32 v144, v144
v_mfma_f32_16x16x32_bf16 v[84:87], a[208:211], v[160:163], 0
v_exp_f32 v145, v145
v_mfma_f32_16x16x32_bf16 v[80:83], a[196:199], v[164:167], v[80:83]
v_exp_f32 v119, v119
v_mfma_f32_16x16x32_bf16 v[84:87], a[212:215], v[164:167], v[84:87]
v_exp_f32 v146, v146
v_mfma_f32_16x16x32_bf16 v[80:83], a[200:203], v[168:171], v[80:83]
v_cvt_pk_bf16_f32 v115, v118, v119
v_mfma_f32_16x16x32_bf16 v[84:87], a[216:219], v[168:171], v[84:87]
v_cvt_pk_bf16_f32 v144, v144, v145
v_mfma_f32_16x16x32_bf16 v[80:83], a[204:207], v[172:175], v[80:83]
v_mfma_f32_16x16x32_bf16 v[84:87], a[220:223], v[172:175], v[84:87]
v_exp_f32 v147, v147
v_mfma_f32_16x16x32_bf16 a[32:35], a[224:227], v[112:115], a[32:35]
v_mfma_f32_16x16x32_bf16 a[36:39], a[228:231], v[112:115], a[36:39]
v_exp_f32 v148, v148
v_mfma_f32_16x16x32_bf16 a[40:43], a[232:235], v[112:115], a[40:43]
v_mfma_f32_16x16x32_bf16 a[44:47], a[236:239], v[112:115], a[44:47]
v_cvt_pk_bf16_f32 v145, v146, v147
v_mfma_f32_16x16x32_bf16 a[48:51], a[240:243], v[112:115], a[48:51]
v_mfma_f32_16x16x32_bf16 a[52:55], a[244:247], v[112:115], a[52:55]
v_exp_f32 v149, v149
v_mfma_f32_16x16x32_bf16 a[56:59], a[248:251], v[112:115], a[56:59]
v_mfma_f32_16x16x32_bf16 a[60:63], a[252:255], v[112:115], a[60:63]
v_exp_f32 v150, v150
v_mfma_f32_16x16x32_bf16 v[92:95], v[48:51], v[112:115], v[92:95]
v_mfma_f32_16x16x32_bf16 v[112:115], a[192:195], v[192:195], 0
v_cvt_pk_bf16_f32 v146, v148, v149
v_exp_f32 v80, v80
v_mfma_f32_16x16x32_bf16 v[116:119], a[208:211], v[192:195], 0
v_exp_f32 v81, v81
v_mfma_f32_16x16x32_bf16 v[112:115], a[196:199], v[196:199], v[112:115]
v_exp_f32 v151, v151
v_mfma_f32_16x16x32_bf16 v[116:119], a[212:215], v[196:199], v[116:119]
v_exp_f32 v82, v82
v_mfma_f32_16x16x32_bf16 v[112:115], a[200:203], v[200:203], v[112:115]
v_cvt_pk_bf16_f32 v147, v150, v151
v_mfma_f32_16x16x32_bf16 v[116:119], a[216:219], v[200:203], v[116:119]
v_cvt_pk_bf16_f32 v80, v80, v81
v_mfma_f32_16x16x32_bf16 v[112:115], a[204:207], v[204:207], v[112:115]
v_mfma_f32_16x16x32_bf16 v[116:119], a[220:223], v[204:207], v[116:119]
v_exp_f32 v83, v83
v_mfma_f32_16x16x32_bf16 a[64:67], a[224:227], v[144:147], a[64:67]
s_waitcnt vmcnt(25)
s_barrier
v_mfma_f32_16x16x32_bf16 a[68:71], a[228:231], v[144:147], a[68:71]
s_add_u32 s76, s76, 8192
v_exp_f32 v84, v84
v_mfma_f32_16x16x32_bf16 a[72:75], a[232:235], v[144:147], a[72:75]
s_and_b32 s76, s76, 131071
v_mfma_f32_16x16x32_bf16 a[76:79], a[236:239], v[144:147], a[76:79]
s_add_u32 m0, s77, 65536
v_cvt_pk_bf16_f32 v81, v82, v83
v_mfma_f32_16x16x32_bf16 a[80:83], a[240:243], v[144:147], a[80:83]
buffer_load_dwordx4 v10, s[40:43], s76 offen nt lds
v_mfma_f32_16x16x32_bf16 a[84:87], a[244:247], v[144:147], a[84:87]
v_exp_f32 v85, v85
v_mfma_f32_16x16x32_bf16 a[88:91], a[248:251], v[144:147], a[88:91]
v_mfma_f32_16x16x32_bf16 a[92:95], a[252:255], v[144:147], a[92:95]
v_exp_f32 v86, v86
v_mfma_f32_16x16x32_bf16 v[120:123], v[48:51], v[144:147], v[120:123]
v_mfma_f32_16x16x32_bf16 v[144:147], a[192:195], v[224:227], 0
ds_read_b64 a[192:193], v20 offset:16384
ds_read_b64 a[194:195], v21 offset:16384
v_cvt_pk_bf16_f32 v82, v84, v85
v_mfma_f32_16x16x32_bf16 v[148:151], a[208:211], v[224:227], 0
v_exp_f32 v112, v112
v_mfma_f32_16x16x32_bf16 v[144:147], a[196:199], v[228:231], v[144:147]
ds_read_b64 a[208:209], v20 offset:20480
ds_read_b64 a[210:211], v21 offset:20480
v_mfma_f32_16x16x32_bf16 v[148:151], a[212:215], v[228:231], v[148:151]
buffer_load_dwordx4 v19, s[40:43], s76 offen offset:1024 nt lds
v_exp_f32 v87, v87
v_mfma_f32_16x16x32_bf16 v[144:147], a[200:203], v[232:235], v[144:147]
ds_read_b64 a[196:197], v22 offset:16384
ds_read_b64 a[198:199], v23 offset:16384
v_cvt_pk_bf16_f32 v83, v86, v87
v_mfma_f32_16x16x32_bf16 v[148:151], a[216:219], v[232:235], v[148:151]
v_exp_f32 v113, v113
v_mfma_f32_16x16x32_bf16 v[144:147], a[204:207], v[236:239], v[144:147]
ds_read_b64 a[212:213], v22 offset:20480
ds_read_b64 a[214:215], v23 offset:20480
v_mfma_f32_16x16x32_bf16 v[148:151], a[220:223], v[236:239], v[148:151]
v_exp_f32 v114, v114
v_cvt_pk_bf16_f32 v112, v112, v113
v_mfma_f32_16x16x32_bf16 a[96:99], a[224:227], v[80:83], a[96:99]
ds_read_b64 a[200:201], v24 offset:16384
ds_read_b64 a[202:203], v25 offset:16384
v_mfma_f32_16x16x32_bf16 a[100:103], a[228:231], v[80:83], a[100:103]
v_exp_f32 v115, v115
v_mfma_f32_16x16x32_bf16 a[104:107], a[232:235], v[80:83], a[104:107]
ds_read_b64 a[216:217], v24 offset:20480
ds_read_b64 a[218:219], v25 offset:20480
v_mfma_f32_16x16x32_bf16 a[108:111], a[236:239], v[80:83], a[108:111]
buffer_load_dwordx4 v10, s[40:43], s76 offen offset:2048 nt lds
v_exp_f32 v116, v116
v_mfma_f32_16x16x32_bf16 a[112:115], a[240:243], v[80:83], a[112:115]
ds_read_b64 a[204:205], v26 offset:16384
ds_read_b64 a[206:207], v27 offset:16384
v_cvt_pk_bf16_f32 v113, v114, v115
v_mfma_f32_16x16x32_bf16 a[116:119], a[244:247], v[80:83], a[116:119]
v_exp_f32 v117, v117
v_mfma_f32_16x16x32_bf16 a[120:123], a[248:251], v[80:83], a[120:123]
ds_read_b64 a[220:221], v26 offset:20480
ds_read_b64 a[222:223], v27 offset:20480
v_mfma_f32_16x16x32_bf16 a[124:127], a[252:255], v[80:83], a[124:127]
v_exp_f32 v118, v118
v_mfma_f32_16x16x32_bf16 v[124:127], v[48:51], v[80:83], v[124:127]
s_waitcnt lgkmcnt(4)
v_mfma_f32_16x16x32_bf16 v[80:83], a[192:195], v[64:67], 0
v_cvt_pk_bf16_f32 v114, v116, v117
v_exp_f32 v144, v144
v_mfma_f32_16x16x32_bf16 v[84:87], a[208:211], v[64:67], 0
v_exp_f32 v145, v145
v_mfma_f32_16x16x32_bf16 v[80:83], a[196:199], v[68:71], v[80:83]
buffer_load_dwordx4 v19, s[40:43], s76 offen offset:3072 nt lds
v_exp_f32 v119, v119
v_mfma_f32_16x16x32_bf16 v[84:87], a[212:215], v[68:71], v[84:87]
v_exp_f32 v146, v146
v_mfma_f32_16x16x32_bf16 v[80:83], a[200:203], v[72:75], v[80:83]
v_cvt_pk_bf16_f32 v115, v118, v119
v_mfma_f32_16x16x32_bf16 v[84:87], a[216:219], v[72:75], v[84:87]
v_cvt_pk_bf16_f32 v144, v144, v145
s_waitcnt lgkmcnt(0)
v_mfma_f32_16x16x32_bf16 v[80:83], a[204:207], v[76:79], v[80:83]
v_mfma_f32_16x16x32_bf16 v[84:87], a[220:223], v[76:79], v[84:87]
v_exp_f32 v147, v147
v_mfma_f32_16x16x32_bf16 a[128:131], a[224:227], v[112:115], a[128:131]
v_mfma_f32_16x16x32_bf16 a[132:135], a[228:231], v[112:115], a[132:135]
v_exp_f32 v148, v148
v_mfma_f32_16x16x32_bf16 a[136:139], a[232:235], v[112:115], a[136:139]
s_waitcnt vmcnt(25)
s_barrier
v_mfma_f32_16x16x32_bf16 a[140:143], a[236:239], v[112:115], a[140:143]
s_add_u32 s75, s75, 8192
v_cvt_pk_bf16_f32 v145, v146, v147
v_mfma_f32_16x16x32_bf16 a[144:147], a[240:243], v[112:115], a[144:147]
s_and_b32 s75, s75, 131071
v_mfma_f32_16x16x32_bf16 a[148:151], a[244:247], v[112:115], a[148:151]
s_add_u32 m0, s77, 16384
v_exp_f32 v149, v149
v_mfma_f32_16x16x32_bf16 a[152:155], a[248:251], v[112:115], a[152:155]
buffer_load_dwordx4 v6, s[36:39], s75 offen nt lds
v_mfma_f32_16x16x32_bf16 a[156:159], a[252:255], v[112:115], a[156:159]
v_exp_f32 v150, v150
v_mfma_f32_16x16x32_bf16 v[152:155], v[48:51], v[112:115], v[152:155]
v_mfma_f32_16x16x32_bf16 v[112:115], a[192:195], v[96:99], 0
v_cvt_pk_bf16_f32 v146, v148, v149
v_exp_f32 v80, v80
v_mfma_f32_16x16x32_bf16 v[116:119], a[208:211], v[96:99], 0
v_exp_f32 v81, v81
v_mfma_f32_16x16x32_bf16 v[112:115], a[196:199], v[100:103], v[112:115]
v_exp_f32 v151, v151
v_mfma_f32_16x16x32_bf16 v[116:119], a[212:215], v[100:103], v[116:119]
v_exp_f32 v82, v82
v_mfma_f32_16x16x32_bf16 v[112:115], a[200:203], v[104:107], v[112:115]
v_cvt_pk_bf16_f32 v147, v150, v151
v_mfma_f32_16x16x32_bf16 v[116:119], a[216:219], v[104:107], v[116:119]
v_cvt_pk_bf16_f32 v80, v80, v81
v_mfma_f32_16x16x32_bf16 v[112:115], a[204:207], v[108:111], v[112:115]
v_mfma_f32_16x16x32_bf16 v[116:119], a[220:223], v[108:111], v[116:119]
v_exp_f32 v83, v83
v_mfma_f32_16x16x32_bf16 a[160:163], a[224:227], v[144:147], a[160:163]
ds_read_b64_tr_b16 a[224:225], v28 offset:16384
ds_read_b64_tr_b16 a[226:227], v28 offset:20480
v_mfma_f32_16x16x32_bf16 a[164:167], a[228:231], v[144:147], a[164:167]
buffer_load_dwordx4 v7, s[36:39], s75 offen offset:1024 nt lds
v_exp_f32 v84, v84
v_mfma_f32_16x16x32_bf16 a[168:171], a[232:235], v[144:147], a[168:171]
ds_read_b64_tr_b16 a[228:229], v29 offset:16384
ds_read_b64_tr_b16 a[230:231], v29 offset:20480
v_mfma_f32_16x16x32_bf16 a[172:175], a[236:239], v[144:147], a[172:175]
v_cvt_pk_bf16_f32 v81, v82, v83
v_mfma_f32_16x16x32_bf16 a[176:179], a[240:243], v[144:147], a[176:179]
ds_read_b64_tr_b16 a[232:233], v30 offset:16384
ds_read_b64_tr_b16 a[234:235], v30 offset:20480
v_mfma_f32_16x16x32_bf16 a[180:183], a[244:247], v[144:147], a[180:183]
v_exp_f32 v85, v85
v_mfma_f32_16x16x32_bf16 a[184:187], a[248:251], v[144:147], a[184:187]
ds_read_b64_tr_b16 a[236:237], v31 offset:16384
ds_read_b64_tr_b16 a[238:239], v31 offset:20480
v_mfma_f32_16x16x32_bf16 a[188:191], a[252:255], v[144:147], a[188:191]
v_exp_f32 v86, v86
v_mfma_f32_16x16x32_bf16 v[156:159], v[48:51], v[144:147], v[156:159]
ds_read_b64_tr_b16 a[240:241], v44 offset:16384
ds_read_b64_tr_b16 a[242:243], v44 offset:20480
v_mfma_f32_16x16x32_bf16 v[144:147], a[192:195], v[128:131], 0
v_cvt_pk_bf16_f32 v82, v84, v85
v_exp_f32 v112, v112
v_mfma_f32_16x16x32_bf16 v[148:151], a[208:211], v[128:131], 0
ds_read_b64_tr_b16 a[244:245], v45 offset:16384
ds_read_b64_tr_b16 a[246:247], v45 offset:20480
v_mfma_f32_16x16x32_bf16 v[144:147], a[196:199], v[132:135], v[144:147]
v_exp_f32 v87, v87
v_mfma_f32_16x16x32_bf16 v[148:151], a[212:215], v[132:135], v[148:151]
ds_read_b64_tr_b16 a[248:249], v46 offset:16384
ds_read_b64_tr_b16 a[250:251], v46 offset:20480
v_mfma_f32_16x16x32_bf16 v[144:147], a[200:203], v[136:139], v[144:147]
buffer_load_dwordx4 v8, s[36:39], s75 offen offset:2048 nt lds
v_cvt_pk_bf16_f32 v83, v86, v87
v_mfma_f32_16x16x32_bf16 v[148:151], a[216:219], v[136:139], v[148:151]
ds_read_b64_tr_b16 a[252:253], v47 offset:16384
ds_read_b64_tr_b16 a[254:255], v47 offset:20480
v_mfma_f32_16x16x32_bf16 v[144:147], a[204:207], v[140:143], v[144:147]
v_exp_f32 v113, v113
v_mfma_f32_16x16x32_bf16 v[148:151], a[220:223], v[140:143], v[148:151]
v_exp_f32 v114, v114
v_cvt_pk_bf16_f32 v112, v112, v113
s_waitcnt lgkmcnt(4)
v_mfma_f32_16x16x32_bf16 a[0:3], a[224:227], v[80:83], a[0:3]
v_exp_f32 v115, v115
v_mfma_f32_16x16x32_bf16 a[4:7], a[228:231], v[80:83], a[4:7]
v_exp_f32 v116, v116
v_mfma_f32_16x16x32_bf16 a[8:11], a[232:235], v[80:83], a[8:11]
v_mfma_f32_16x16x32_bf16 a[12:15], a[236:239], v[80:83], a[12:15]
v_cvt_pk_bf16_f32 v113, v114, v115
v_mfma_f32_16x16x32_bf16 a[16:19], a[240:243], v[80:83], a[16:19]
v_mfma_f32_16x16x32_bf16 a[20:23], a[244:247], v[80:83], a[20:23]
v_exp_f32 v117, v117
s_waitcnt lgkmcnt(0)
v_mfma_f32_16x16x32_bf16 a[24:27], a[248:251], v[80:83], a[24:27]
v_mfma_f32_16x16x32_bf16 a[28:31], a[252:255], v[80:83], a[28:31]
v_exp_f32 v118, v118
v_mfma_f32_16x16x32_bf16 v[88:91], v[48:51], v[80:83], v[88:91]
buffer_load_dwordx4 v9, s[36:39], s75 offen offset:3072 nt lds
v_mfma_f32_16x16x32_bf16 v[80:83], a[192:195], v[160:163], 0
v_cvt_pk_bf16_f32 v114, v116, v117
v_exp_f32 v144, v144
v_mfma_f32_16x16x32_bf16 v[84:87], a[208:211], v[160:163], 0
v_exp_f32 v145, v145
v_mfma_f32_16x16x32_bf16 v[80:83], a[196:199], v[164:167], v[80:83]
v_exp_f32 v119, v119
v_mfma_f32_16x16x32_bf16 v[84:87], a[212:215], v[164:167], v[84:87]
v_exp_f32 v146, v146
v_mfma_f32_16x16x32_bf16 v[80:83], a[200:203], v[168:171], v[80:83]
v_cvt_pk_bf16_f32 v115, v118, v119
v_mfma_f32_16x16x32_bf16 v[84:87], a[216:219], v[168:171], v[84:87]
v_cvt_pk_bf16_f32 v144, v144, v145
v_mfma_f32_16x16x32_bf16 v[80:83], a[204:207], v[172:175], v[80:83]
v_mfma_f32_16x16x32_bf16 v[84:87], a[220:223], v[172:175], v[84:87]
v_exp_f32 v147, v147
v_mfma_f32_16x16x32_bf16 a[32:35], a[224:227], v[112:115], a[32:35]
v_mfma_f32_16x16x32_bf16 a[36:39], a[228:231], v[112:115], a[36:39]
v_exp_f32 v148, v148
v_mfma_f32_16x16x32_bf16 a[40:43], a[232:235], v[112:115], a[40:43]
v_mfma_f32_16x16x32_bf16 a[44:47], a[236:239], v[112:115], a[44:47]
v_cvt_pk_bf16_f32 v145, v146, v147
v_mfma_f32_16x16x32_bf16 a[48:51], a[240:243], v[112:115], a[48:51]
v_mfma_f32_16x16x32_bf16 a[52:55], a[244:247], v[112:115], a[52:55]
v_exp_f32 v149, v149
v_mfma_f32_16x16x32_bf16 a[56:59], a[248:251], v[112:115], a[56:59]
v_mfma_f32_16x16x32_bf16 a[60:63], a[252:255], v[112:115], a[60:63]
v_exp_f32 v150, v150
v_mfma_f32_16x16x32_bf16 v[92:95], v[48:51], v[112:115], v[92:95]
v_mfma_f32_16x16x32_bf16 v[112:115], a[192:195], v[192:195], 0
v_cvt_pk_bf16_f32 v146, v148, v149
v_exp_f32 v80, v80
v_mfma_f32_16x16x32_bf16 v[116:119], a[208:211], v[192:195], 0
v_exp_f32 v81, v81
v_mfma_f32_16x16x32_bf16 v[112:115], a[196:199], v[196:199], v[112:115]
v_exp_f32 v151, v151
v_mfma_f32_16x16x32_bf16 v[116:119], a[212:215], v[196:199], v[116:119]
v_exp_f32 v82, v82
v_mfma_f32_16x16x32_bf16 v[112:115], a[200:203], v[200:203], v[112:115]
v_cvt_pk_bf16_f32 v147, v150, v151
v_mfma_f32_16x16x32_bf16 v[116:119], a[216:219], v[200:203], v[116:119]
v_cvt_pk_bf16_f32 v80, v80, v81
v_mfma_f32_16x16x32_bf16 v[112:115], a[204:207], v[204:207], v[112:115]
v_mfma_f32_16x16x32_bf16 v[116:119], a[220:223], v[204:207], v[116:119]
v_exp_f32 v83, v83
v_mfma_f32_16x16x32_bf16 a[64:67], a[224:227], v[144:147], a[64:67]
s_waitcnt vmcnt(24)
s_barrier
v_mfma_f32_16x16x32_bf16 a[68:71], a[228:231], v[144:147], a[68:71]
s_add_u32 s76, s76, 8192
v_exp_f32 v84, v84
v_mfma_f32_16x16x32_bf16 a[72:75], a[232:235], v[144:147], a[72:75]
s_and_b32 s76, s76, 131071
v_mfma_f32_16x16x32_bf16 a[76:79], a[236:239], v[144:147], a[76:79]
s_add_u32 m0, s77, 81920
v_cvt_pk_bf16_f32 v81, v82, v83
v_mfma_f32_16x16x32_bf16 a[80:83], a[240:243], v[144:147], a[80:83]
buffer_load_dwordx4 v10, s[40:43], s76 offen nt lds
v_mfma_f32_16x16x32_bf16 a[84:87], a[244:247], v[144:147], a[84:87]
v_exp_f32 v85, v85
v_mfma_f32_16x16x32_bf16 a[88:91], a[248:251], v[144:147], a[88:91]
v_mfma_f32_16x16x32_bf16 a[92:95], a[252:255], v[144:147], a[92:95]
v_exp_f32 v86, v86
v_mfma_f32_16x16x32_bf16 v[120:123], v[48:51], v[144:147], v[120:123]
v_mfma_f32_16x16x32_bf16 v[144:147], a[192:195], v[224:227], 0
ds_read_b64 a[192:193], v20 offset:32768
ds_read_b64 a[194:195], v21 offset:32768
v_cvt_pk_bf16_f32 v82, v84, v85
v_mfma_f32_16x16x32_bf16 v[148:151], a[208:211], v[224:227], 0
v_exp_f32 v112, v112
v_mfma_f32_16x16x32_bf16 v[144:147], a[196:199], v[228:231], v[144:147]
ds_read_b64 a[208:209], v20 offset:36864
ds_read_b64 a[210:211], v21 offset:36864
v_mfma_f32_16x16x32_bf16 v[148:151], a[212:215], v[228:231], v[148:151]
buffer_load_dwordx4 v19, s[40:43], s76 offen offset:1024 nt lds
v_exp_f32 v87, v87
v_mfma_f32_16x16x32_bf16 v[144:147], a[200:203], v[232:235], v[144:147]
ds_read_b64 a[196:197], v22 offset:32768
ds_read_b64 a[198:199], v23 offset:32768
v_cvt_pk_bf16_f32 v83, v86, v87
v_mfma_f32_16x16x32_bf16 v[148:151], a[216:219], v[232:235], v[148:151]
v_exp_f32 v113, v113
v_mfma_f32_16x16x32_bf16 v[144:147], a[204:207], v[236:239], v[144:147]
ds_read_b64 a[212:213], v22 offset:36864
ds_read_b64 a[214:215], v23 offset:36864
v_mfma_f32_16x16x32_bf16 v[148:151], a[220:223], v[236:239], v[148:151]
v_exp_f32 v114, v114
v_cvt_pk_bf16_f32 v112, v112, v113
v_mfma_f32_16x16x32_bf16 a[96:99], a[224:227], v[80:83], a[96:99]
ds_read_b64 a[200:201], v24 offset:32768
ds_read_b64 a[202:203], v25 offset:32768
v_mfma_f32_16x16x32_bf16 a[100:103], a[228:231], v[80:83], a[100:103]
v_exp_f32 v115, v115
v_mfma_f32_16x16x32_bf16 a[104:107], a[232:235], v[80:83], a[104:107]
ds_read_b64 a[216:217], v24 offset:36864
ds_read_b64 a[218:219], v25 offset:36864
v_mfma_f32_16x16x32_bf16 a[108:111], a[236:239], v[80:83], a[108:111]
buffer_load_dwordx4 v10, s[40:43], s76 offen offset:2048 nt lds
v_exp_f32 v116, v116
v_mfma_f32_16x16x32_bf16 a[112:115], a[240:243], v[80:83], a[112:115]
ds_read_b64 a[204:205], v26 offset:32768
ds_read_b64 a[206:207], v27 offset:32768
v_cvt_pk_bf16_f32 v113, v114, v115
v_mfma_f32_16x16x32_bf16 a[116:119], a[244:247], v[80:83], a[116:119]
v_exp_f32 v117, v117
v_mfma_f32_16x16x32_bf16 a[120:123], a[248:251], v[80:83], a[120:123]
ds_read_b64 a[220:221], v26 offset:36864
ds_read_b64 a[222:223], v27 offset:36864
v_mfma_f32_16x16x32_bf16 a[124:127], a[252:255], v[80:83], a[124:127]
v_exp_f32 v118, v118
v_mfma_f32_16x16x32_bf16 v[124:127], v[48:51], v[80:83], v[124:127]
s_waitcnt lgkmcnt(4)
v_mfma_f32_16x16x32_bf16 v[80:83], a[192:195], v[64:67], 0
v_cvt_pk_bf16_f32 v114, v116, v117
v_exp_f32 v144, v144
v_mfma_f32_16x16x32_bf16 v[84:87], a[208:211], v[64:67], 0
v_exp_f32 v145, v145
v_mfma_f32_16x16x32_bf16 v[80:83], a[196:199], v[68:71], v[80:83]
buffer_load_dwordx4 v19, s[40:43], s76 offen offset:3072 nt lds
v_exp_f32 v119, v119
v_mfma_f32_16x16x32_bf16 v[84:87], a[212:215], v[68:71], v[84:87]
v_exp_f32 v146, v146
v_mfma_f32_16x16x32_bf16 v[80:83], a[200:203], v[72:75], v[80:83]
v_cvt_pk_bf16_f32 v115, v118, v119
v_mfma_f32_16x16x32_bf16 v[84:87], a[216:219], v[72:75], v[84:87]
v_cvt_pk_bf16_f32 v144, v144, v145
s_waitcnt lgkmcnt(0)
v_mfma_f32_16x16x32_bf16 v[80:83], a[204:207], v[76:79], v[80:83]
v_mfma_f32_16x16x32_bf16 v[84:87], a[220:223], v[76:79], v[84:87]
v_exp_f32 v147, v147
v_mfma_f32_16x16x32_bf16 a[128:131], a[224:227], v[112:115], a[128:131]
v_mfma_f32_16x16x32_bf16 a[132:135], a[228:231], v[112:115], a[132:135]
v_exp_f32 v148, v148
v_mfma_f32_16x16x32_bf16 a[136:139], a[232:235], v[112:115], a[136:139]
s_waitcnt vmcnt(24)
s_barrier
v_mfma_f32_16x16x32_bf16 a[140:143], a[236:239], v[112:115], a[140:143]
v_cvt_pk_bf16_f32 v145, v146, v147
v_mfma_f32_16x16x32_bf16 a[144:147], a[240:243], v[112:115], a[144:147]
v_mfma_f32_16x16x32_bf16 a[148:151], a[244:247], v[112:115], a[148:151]
v_exp_f32 v149, v149
v_mfma_f32_16x16x32_bf16 a[152:155], a[248:251], v[112:115], a[152:155]
v_mfma_f32_16x16x32_bf16 a[156:159], a[252:255], v[112:115], a[156:159]
v_exp_f32 v150, v150
v_mfma_f32_16x16x32_bf16 v[152:155], v[48:51], v[112:115], v[152:155]
v_mfma_f32_16x16x32_bf16 v[112:115], a[192:195], v[96:99], 0
v_cvt_pk_bf16_f32 v146, v148, v149
v_exp_f32 v80, v80
v_mfma_f32_16x16x32_bf16 v[116:119], a[208:211], v[96:99], 0
v_exp_f32 v81, v81
v_mfma_f32_16x16x32_bf16 v[112:115], a[196:199], v[100:103], v[112:115]
v_exp_f32 v151, v151
v_mfma_f32_16x16x32_bf16 v[116:119], a[212:215], v[100:103], v[116:119]
v_exp_f32 v82, v82
v_mfma_f32_16x16x32_bf16 v[112:115], a[200:203], v[104:107], v[112:115]
v_cvt_pk_bf16_f32 v147, v150, v151
v_mfma_f32_16x16x32_bf16 v[116:119], a[216:219], v[104:107], v[116:119]
v_cvt_pk_bf16_f32 v80, v80, v81
v_mfma_f32_16x16x32_bf16 v[112:115], a[204:207], v[108:111], v[112:115]
v_mfma_f32_16x16x32_bf16 v[116:119], a[220:223], v[108:111], v[116:119]
v_exp_f32 v83, v83
v_mfma_f32_16x16x32_bf16 a[160:163], a[224:227], v[144:147], a[160:163]
ds_read_b64_tr_b16 a[224:225], v28 offset:32768
ds_read_b64_tr_b16 a[226:227], v28 offset:36864
v_mfma_f32_16x16x32_bf16 a[164:167], a[228:231], v[144:147], a[164:167]
v_exp_f32 v84, v84
v_mfma_f32_16x16x32_bf16 a[168:171], a[232:235], v[144:147], a[168:171]
ds_read_b64_tr_b16 a[228:229], v29 offset:32768
ds_read_b64_tr_b16 a[230:231], v29 offset:36864
v_mfma_f32_16x16x32_bf16 a[172:175], a[236:239], v[144:147], a[172:175]
v_cvt_pk_bf16_f32 v81, v82, v83
v_mfma_f32_16x16x32_bf16 a[176:179], a[240:243], v[144:147], a[176:179]
ds_read_b64_tr_b16 a[232:233], v30 offset:32768
ds_read_b64_tr_b16 a[234:235], v30 offset:36864
v_mfma_f32_16x16x32_bf16 a[180:183], a[244:247], v[144:147], a[180:183]
v_exp_f32 v85, v85
v_mfma_f32_16x16x32_bf16 a[184:187], a[248:251], v[144:147], a[184:187]
ds_read_b64_tr_b16 a[236:237], v31 offset:32768
ds_read_b64_tr_b16 a[238:239], v31 offset:36864
v_mfma_f32_16x16x32_bf16 a[188:191], a[252:255], v[144:147], a[188:191]
v_exp_f32 v86, v86
v_mfma_f32_16x16x32_bf16 v[156:159], v[48:51], v[144:147], v[156:159]
ds_read_b64_tr_b16 a[240:241], v44 offset:32768
ds_read_b64_tr_b16 a[242:243], v44 offset:36864
v_mfma_f32_16x16x32_bf16 v[144:147], a[192:195], v[128:131], 0
v_cvt_pk_bf16_f32 v82, v84, v85
v_exp_f32 v112, v112
v_mfma_f32_16x16x32_bf16 v[148:151], a[208:211], v[128:131], 0
ds_read_b64_tr_b16 a[244:245], v45 offset:32768
ds_read_b64_tr_b16 a[246:247], v45 offset:36864
v_mfma_f32_16x16x32_bf16 v[144:147], a[196:199], v[132:135], v[144:147]
v_exp_f32 v87, v87
v_mfma_f32_16x16x32_bf16 v[148:151], a[212:215], v[132:135], v[148:151]
ds_read_b64_tr_b16 a[248:249], v46 offset:32768
ds_read_b64_tr_b16 a[250:251], v46 offset:36864
v_mfma_f32_16x16x32_bf16 v[144:147], a[200:203], v[136:139], v[144:147]
v_cvt_pk_bf16_f32 v83, v86, v87
v_exp_f32 v113, v113
v_mfma_f32_16x16x32_bf16 v[148:151], a[216:219], v[136:139], v[148:151]
ds_read_b64_tr_b16 a[252:253], v47 offset:32768
ds_read_b64_tr_b16 a[254:255], v47 offset:36864
v_mfma_f32_16x16x32_bf16 v[144:147], a[204:207], v[140:143], v[144:147]
v_exp_f32 v114, v114
v_cvt_pk_bf16_f32 v112, v112, v113
v_mfma_f32_16x16x32_bf16 v[148:151], a[220:223], v[140:143], v[148:151]
v_exp_f32 v115, v115
s_waitcnt lgkmcnt(4)
v_mfma_f32_16x16x32_bf16 a[0:3], a[224:227], v[80:83], a[0:3]
v_mfma_f32_16x16x32_bf16 a[4:7], a[228:231], v[80:83], a[4:7]
v_exp_f32 v116, v116
v_mfma_f32_16x16x32_bf16 a[8:11], a[232:235], v[80:83], a[8:11]
v_mfma_f32_16x16x32_bf16 a[12:15], a[236:239], v[80:83], a[12:15]
v_cvt_pk_bf16_f32 v113, v114, v115
v_mfma_f32_16x16x32_bf16 a[16:19], a[240:243], v[80:83], a[16:19]
v_mfma_f32_16x16x32_bf16 a[20:23], a[244:247], v[80:83], a[20:23]
v_exp_f32 v117, v117
s_waitcnt lgkmcnt(0)
v_mfma_f32_16x16x32_bf16 a[24:27], a[248:251], v[80:83], a[24:27]
v_mfma_f32_16x16x32_bf16 a[28:31], a[252:255], v[80:83], a[28:31]
v_exp_f32 v118, v118
v_mfma_f32_16x16x32_bf16 v[88:91], v[48:51], v[80:83], v[88:91]
v_mfma_f32_16x16x32_bf16 v[80:83], a[192:195], v[160:163], 0
v_cvt_pk_bf16_f32 v114, v116, v117
v_exp_f32 v144, v144
v_mfma_f32_16x16x32_bf16 v[84:87], a[208:211], v[160:163], 0
v_exp_f32 v145, v145
v_mfma_f32_16x16x32_bf16 v[80:83], a[196:199], v[164:167], v[80:83]
v_exp_f32 v119, v119
v_mfma_f32_16x16x32_bf16 v[84:87], a[212:215], v[164:167], v[84:87]
v_exp_f32 v146, v146
v_mfma_f32_16x16x32_bf16 v[80:83], a[200:203], v[168:171], v[80:83]
v_cvt_pk_bf16_f32 v115, v118, v119
v_mfma_f32_16x16x32_bf16 v[84:87], a[216:219], v[168:171], v[84:87]
v_cvt_pk_bf16_f32 v144, v144, v145
v_mfma_f32_16x16x32_bf16 v[80:83], a[204:207], v[172:175], v[80:83]
v_mfma_f32_16x16x32_bf16 v[84:87], a[220:223], v[172:175], v[84:87]
v_exp_f32 v147, v147
v_mfma_f32_16x16x32_bf16 a[32:35], a[224:227], v[112:115], a[32:35]
v_mfma_f32_16x16x32_bf16 a[36:39], a[228:231], v[112:115], a[36:39]
v_exp_f32 v148, v148
v_mfma_f32_16x16x32_bf16 a[40:43], a[232:235], v[112:115], a[40:43]
v_mfma_f32_16x16x32_bf16 a[44:47], a[236:239], v[112:115], a[44:47]
v_cvt_pk_bf16_f32 v145, v146, v147
v_mfma_f32_16x16x32_bf16 a[48:51], a[240:243], v[112:115], a[48:51]
v_mfma_f32_16x16x32_bf16 a[52:55], a[244:247], v[112:115], a[52:55]
v_exp_f32 v149, v149
v_mfma_f32_16x16x32_bf16 a[56:59], a[248:251], v[112:115], a[56:59]
v_mfma_f32_16x16x32_bf16 a[60:63], a[252:255], v[112:115], a[60:63]
v_exp_f32 v150, v150
v_mfma_f32_16x16x32_bf16 v[92:95], v[48:51], v[112:115], v[92:95]
v_mfma_f32_16x16x32_bf16 v[112:115], a[192:195], v[192:195], 0
v_cvt_pk_bf16_f32 v146, v148, v149
v_exp_f32 v80, v80
v_mfma_f32_16x16x32_bf16 v[116:119], a[208:211], v[192:195], 0
v_exp_f32 v81, v81
v_mfma_f32_16x16x32_bf16 v[112:115], a[196:199], v[196:199], v[112:115]
v_exp_f32 v151, v151
v_mfma_f32_16x16x32_bf16 v[116:119], a[212:215], v[196:199], v[116:119]
v_exp_f32 v82, v82
v_mfma_f32_16x16x32_bf16 v[112:115], a[200:203], v[200:203], v[112:115]
v_cvt_pk_bf16_f32 v147, v150, v151
v_mfma_f32_16x16x32_bf16 v[116:119], a[216:219], v[200:203], v[116:119]
v_cvt_pk_bf16_f32 v80, v80, v81
v_mfma_f32_16x16x32_bf16 v[112:115], a[204:207], v[204:207], v[112:115]
v_mfma_f32_16x16x32_bf16 v[116:119], a[220:223], v[204:207], v[116:119]
v_exp_f32 v83, v83
v_mfma_f32_16x16x32_bf16 a[64:67], a[224:227], v[144:147], a[64:67]
s_waitcnt vmcnt(20)
s_barrier
v_mfma_f32_16x16x32_bf16 a[68:71], a[228:231], v[144:147], a[68:71]
s_add_u32 s73, s73, 262144
v_exp_f32 v84, v84
v_mfma_f32_16x16x32_bf16 a[72:75], a[232:235], v[144:147], a[72:75]
s_add_u32 s74, s74, 64
v_mfma_f32_16x16x32_bf16 a[76:79], a[236:239], v[144:147], a[76:79]
s_and_b32 s73, s73, 4194303
v_cvt_pk_bf16_f32 v81, v82, v83
v_mfma_f32_16x16x32_bf16 a[80:83], a[240:243], v[144:147], a[80:83]
s_and_b32 s74, s74, 1023
v_mfma_f32_16x16x32_bf16 a[84:87], a[244:247], v[144:147], a[84:87]
s_add_u32 m0, s57, 131072
v_exp_f32 v85, v85
v_mfma_f32_16x16x32_bf16 a[88:91], a[248:251], v[144:147], a[88:91]
buffer_load_dwordx4 v5, s[44:47], s73 offen lds
v_mfma_f32_16x16x32_bf16 a[92:95], a[252:255], v[144:147], a[92:95]
v_exp_f32 v86, v86
v_mfma_f32_16x16x32_bf16 v[120:123], v[48:51], v[144:147], v[120:123]
v_mfma_f32_16x16x32_bf16 v[144:147], a[192:195], v[224:227], 0
ds_read_b64 a[192:193], v20 offset:49152
ds_read_b64 a[194:195], v21 offset:49152
v_cvt_pk_bf16_f32 v82, v84, v85
v_mfma_f32_16x16x32_bf16 v[148:151], a[208:211], v[224:227], 0
buffer_load_dwordx4 v39, s[44:47], s73 offen offset:1024 lds
v_exp_f32 v112, v112
v_mfma_f32_16x16x32_bf16 v[144:147], a[196:199], v[228:231], v[144:147]
ds_read_b64 a[208:209], v20 offset:53248
ds_read_b64 a[210:211], v21 offset:53248
v_mfma_f32_16x16x32_bf16 v[148:151], a[212:215], v[228:231], v[148:151]
v_exp_f32 v87, v87
v_mfma_f32_16x16x32_bf16 v[144:147], a[200:203], v[232:235], v[144:147]
ds_read_b64 a[196:197], v22 offset:49152
ds_read_b64 a[198:199], v23 offset:49152
v_cvt_pk_bf16_f32 v83, v86, v87
v_mfma_f32_16x16x32_bf16 v[148:151], a[216:219], v[232:235], v[148:151]
buffer_load_dwordx4 v40, s[44:47], s73 offen offset:2048 lds
v_exp_f32 v113, v113
v_mfma_f32_16x16x32_bf16 v[144:147], a[204:207], v[236:239], v[144:147]
ds_read_b64 a[212:213], v22 offset:53248
ds_read_b64 a[214:215], v23 offset:53248
v_mfma_f32_16x16x32_bf16 v[148:151], a[220:223], v[236:239], v[148:151]
v_exp_f32 v114, v114
v_cvt_pk_bf16_f32 v112, v112, v113
v_mfma_f32_16x16x32_bf16 a[96:99], a[224:227], v[80:83], a[96:99]
ds_read_b64 a[200:201], v24 offset:49152
ds_read_b64 a[202:203], v25 offset:49152
v_mfma_f32_16x16x32_bf16 a[100:103], a[228:231], v[80:83], a[100:103]
buffer_load_dwordx4 v41, s[44:47], s73 offen offset:3072 lds
v_exp_f32 v115, v115
v_mfma_f32_16x16x32_bf16 a[104:107], a[232:235], v[80:83], a[104:107]
s_add_u32 m0, s56, 147712
ds_read_b64 a[216:217], v24 offset:53248
ds_read_b64 a[218:219], v25 offset:53248
v_mfma_f32_16x16x32_bf16 a[108:111], a[236:239], v[80:83], a[108:111]
v_exp_f32 v116, v116
v_cvt_pk_bf16_f32 v113, v114, v115
v_mfma_f32_16x16x32_bf16 a[112:115], a[240:243], v[80:83], a[112:115]
ds_read_b64 a[204:205], v26 offset:49152
ds_read_b64 a[206:207], v27 offset:49152
v_mfma_f32_16x16x32_bf16 a[116:119], a[244:247], v[80:83], a[116:119]
buffer_load_dwordx4 v2, s[16:19], s74 offen lds
v_exp_f32 v117, v117
v_mfma_f32_16x16x32_bf16 a[120:123], a[248:251], v[80:83], a[120:123]
ds_read_b64 a[220:221], v26 offset:53248
ds_read_b64 a[222:223], v27 offset:53248
v_mfma_f32_16x16x32_bf16 a[124:127], a[252:255], v[80:83], a[124:127]
v_exp_f32 v118, v118
v_mfma_f32_16x16x32_bf16 v[124:127], v[48:51], v[80:83], v[124:127]
s_waitcnt lgkmcnt(4)
v_mfma_f32_16x16x32_bf16 v[80:83], a[192:195], v[64:67], 0
buffer_load_dwordx4 v3, s[16:19], s74 offen offset:1024 lds
v_cvt_pk_bf16_f32 v114, v116, v117
v_mfma_f32_16x16x32_bf16 v[84:87], a[208:211], v[64:67], 0
v_exp_f32 v144, v144
v_mfma_f32_16x16x32_bf16 v[80:83], a[196:199], v[68:71], v[80:83]
v_exp_f32 v119, v119
v_mfma_f32_16x16x32_bf16 v[84:87], a[212:215], v[68:71], v[84:87]
v_exp_f32 v145, v145
v_mfma_f32_16x16x32_bf16 v[80:83], a[200:203], v[72:75], v[80:83]
buffer_load_dwordx4 v4, s[16:19], s74 offen offset:2048 lds
v_cvt_pk_bf16_f32 v115, v118, v119
v_mfma_f32_16x16x32_bf16 v[84:87], a[216:219], v[72:75], v[84:87]
v_exp_f32 v146, v146
v_cvt_pk_bf16_f32 v144, v144, v145
s_waitcnt lgkmcnt(0)
v_mfma_f32_16x16x32_bf16 v[80:83], a[204:207], v[76:79], v[80:83]
v_mfma_f32_16x16x32_bf16 v[84:87], a[220:223], v[76:79], v[84:87]
v_exp_f32 v147, v147
v_mfma_f32_16x16x32_bf16 a[128:131], a[224:227], v[112:115], a[128:131]
v_mfma_f32_16x16x32_bf16 a[132:135], a[228:231], v[112:115], a[132:135]
v_exp_f32 v148, v148
v_mfma_f32_16x16x32_bf16 a[136:139], a[232:235], v[112:115], a[136:139]
s_waitcnt vmcnt(23)
s_barrier
v_mfma_f32_16x16x32_bf16 a[140:143], a[236:239], v[112:115], a[140:143]
v_cvt_pk_bf16_f32 v145, v146, v147
v_mfma_f32_16x16x32_bf16 a[144:147], a[240:243], v[112:115], a[144:147]
v_mfma_f32_16x16x32_bf16 a[148:151], a[244:247], v[112:115], a[148:151]
v_exp_f32 v149, v149
v_mfma_f32_16x16x32_bf16 a[152:155], a[248:251], v[112:115], a[152:155]
s_add_u32 s73, s73, 262144
v_mfma_f32_16x16x32_bf16 a[156:159], a[252:255], v[112:115], a[156:159]
s_add_u32 s74, s74, 64
v_exp_f32 v150, v150
v_mfma_f32_16x16x32_bf16 v[152:155], v[48:51], v[112:115], v[152:155]
s_and_b32 s73, s73, 4194303
v_mfma_f32_16x16x32_bf16 v[112:115], a[192:195], v[96:99], 0
s_and_b32 s74, s74, 1023
v_cvt_pk_bf16_f32 v146, v148, v149
v_exp_f32 v80, v80
v_mfma_f32_16x16x32_bf16 v[116:119], a[208:211], v[96:99], 0
s_add_u32 m0, s57, 32768
v_exp_f32 v81, v81
v_mfma_f32_16x16x32_bf16 v[112:115], a[196:199], v[100:103], v[112:115]
buffer_load_dwordx4 v5, s[44:47], s73 offen lds
v_exp_f32 v151, v151
v_mfma_f32_16x16x32_bf16 v[116:119], a[212:215], v[100:103], v[116:119]
v_exp_f32 v82, v82
v_mfma_f32_16x16x32_bf16 v[112:115], a[200:203], v[104:107], v[112:115]
v_cvt_pk_bf16_f32 v147, v150, v151
v_mfma_f32_16x16x32_bf16 v[116:119], a[216:219], v[104:107], v[116:119]
v_cvt_pk_bf16_f32 v80, v80, v81
v_mfma_f32_16x16x32_bf16 v[112:115], a[204:207], v[108:111], v[112:115]
buffer_load_dwordx4 v39, s[44:47], s73 offen offset:1024 lds
v_mfma_f32_16x16x32_bf16 v[116:119], a[220:223], v[108:111], v[116:119]
v_exp_f32 v83, v83
v_mfma_f32_16x16x32_bf16 a[160:163], a[224:227], v[144:147], a[160:163]
ds_read_b64_tr_b16 a[224:225], v28 offset:49152
ds_read_b64_tr_b16 a[226:227], v28 offset:53248
v_mfma_f32_16x16x32_bf16 a[164:167], a[228:231], v[144:147], a[164:167]
v_exp_f32 v84, v84
v_mfma_f32_16x16x32_bf16 a[168:171], a[232:235], v[144:147], a[168:171]
buffer_load_dwordx4 v40, s[44:47], s73 offen offset:2048 lds
ds_read_b64_tr_b16 a[228:229], v29 offset:49152
ds_read_b64_tr_b16 a[230:231], v29 offset:53248
v_mfma_f32_16x16x32_bf16 a[172:175], a[236:239], v[144:147], a[172:175]
v_cvt_pk_bf16_f32 v81, v82, v83
v_mfma_f32_16x16x32_bf16 a[176:179], a[240:243], v[144:147], a[176:179]
ds_read_b64_tr_b16 a[232:233], v30 offset:49152
ds_read_b64_tr_b16 a[234:235], v30 offset:53248
v_mfma_f32_16x16x32_bf16 a[180:183], a[244:247], v[144:147], a[180:183]
v_exp_f32 v85, v85
v_mfma_f32_16x16x32_bf16 a[184:187], a[248:251], v[144:147], a[184:187]
buffer_load_dwordx4 v41, s[44:47], s73 offen offset:3072 lds
ds_read_b64_tr_b16 a[236:237], v31 offset:49152
ds_read_b64_tr_b16 a[238:239], v31 offset:53248
v_mfma_f32_16x16x32_bf16 a[188:191], a[252:255], v[144:147], a[188:191]
s_add_u32 m0, s56, 49408
v_exp_f32 v86, v86
v_mfma_f32_16x16x32_bf16 v[156:159], v[48:51], v[144:147], v[156:159]
ds_read_b64_tr_b16 a[240:241], v44 offset:49152
ds_read_b64_tr_b16 a[242:243], v44 offset:53248
v_mfma_f32_16x16x32_bf16 v[144:147], a[192:195], v[128:131], 0
v_cvt_pk_bf16_f32 v82, v84, v85
v_exp_f32 v112, v112
v_mfma_f32_16x16x32_bf16 v[148:151], a[208:211], v[128:131], 0
buffer_load_dwordx4 v2, s[16:19], s74 offen lds
ds_read_b64_tr_b16 a[244:245], v45 offset:49152
ds_read_b64_tr_b16 a[246:247], v45 offset:53248
v_mfma_f32_16x16x32_bf16 v[144:147], a[196:199], v[132:135], v[144:147]
v_exp_f32 v87, v87
v_mfma_f32_16x16x32_bf16 v[148:151], a[212:215], v[132:135], v[148:151]
ds_read_b64_tr_b16 a[248:249], v46 offset:49152
ds_read_b64_tr_b16 a[250:251], v46 offset:53248
v_mfma_f32_16x16x32_bf16 v[144:147], a[200:203], v[136:139], v[144:147]
v_cvt_pk_bf16_f32 v83, v86, v87
v_exp_f32 v113, v113
v_mfma_f32_16x16x32_bf16 v[148:151], a[216:219], v[136:139], v[148:151]
buffer_load_dwordx4 v3, s[16:19], s74 offen offset:1024 lds
ds_read_b64_tr_b16 a[252:253], v47 offset:49152
ds_read_b64_tr_b16 a[254:255], v47 offset:53248
v_mfma_f32_16x16x32_bf16 v[144:147], a[204:207], v[140:143], v[144:147]
v_exp_f32 v114, v114
v_cvt_pk_bf16_f32 v112, v112, v113
v_mfma_f32_16x16x32_bf16 v[148:151], a[220:223], v[140:143], v[148:151]
v_exp_f32 v115, v115
s_waitcnt lgkmcnt(4)
v_mfma_f32_16x16x32_bf16 a[0:3], a[224:227], v[80:83], a[0:3]
v_mfma_f32_16x16x32_bf16 a[4:7], a[228:231], v[80:83], a[4:7]
buffer_load_dwordx4 v4, s[16:19], s74 offen offset:2048 lds
v_exp_f32 v116, v116
v_mfma_f32_16x16x32_bf16 a[8:11], a[232:235], v[80:83], a[8:11]
v_mfma_f32_16x16x32_bf16 a[12:15], a[236:239], v[80:83], a[12:15]
v_cvt_pk_bf16_f32 v113, v114, v115
v_mfma_f32_16x16x32_bf16 a[16:19], a[240:243], v[80:83], a[16:19]
v_mfma_f32_16x16x32_bf16 a[20:23], a[244:247], v[80:83], a[20:23]
v_exp_f32 v117, v117
s_waitcnt lgkmcnt(0)
v_mfma_f32_16x16x32_bf16 a[24:27], a[248:251], v[80:83], a[24:27]
v_mfma_f32_16x16x32_bf16 a[28:31], a[252:255], v[80:83], a[28:31]
v_exp_f32 v118, v118
v_mfma_f32_16x16x32_bf16 v[88:91], v[48:51], v[80:83], v[88:91]
v_mfma_f32_16x16x32_bf16 v[80:83], a[192:195], v[160:163], 0
v_cvt_pk_bf16_f32 v114, v116, v117
v_exp_f32 v144, v144
v_mfma_f32_16x16x32_bf16 v[84:87], a[208:211], v[160:163], 0
v_exp_f32 v145, v145
v_mfma_f32_16x16x32_bf16 v[80:83], a[196:199], v[164:167], v[80:83]
v_exp_f32 v119, v119
v_mfma_f32_16x16x32_bf16 v[84:87], a[212:215], v[164:167], v[84:87]
v_exp_f32 v146, v146
v_mfma_f32_16x16x32_bf16 v[80:83], a[200:203], v[168:171], v[80:83]
v_cvt_pk_bf16_f32 v115, v118, v119
v_mfma_f32_16x16x32_bf16 v[84:87], a[216:219], v[168:171], v[84:87]
v_cvt_pk_bf16_f32 v144, v144, v145
v_mfma_f32_16x16x32_bf16 v[80:83], a[204:207], v[172:175], v[80:83]
v_mfma_f32_16x16x32_bf16 v[84:87], a[220:223], v[172:175], v[84:87]
v_exp_f32 v147, v147
v_mfma_f32_16x16x32_bf16 a[32:35], a[224:227], v[112:115], a[32:35]
v_mfma_f32_16x16x32_bf16 a[36:39], a[228:231], v[112:115], a[36:39]
v_exp_f32 v148, v148
v_mfma_f32_16x16x32_bf16 a[40:43], a[232:235], v[112:115], a[40:43]
v_mfma_f32_16x16x32_bf16 a[44:47], a[236:239], v[112:115], a[44:47]
v_cvt_pk_bf16_f32 v145, v146, v147
v_mfma_f32_16x16x32_bf16 a[48:51], a[240:243], v[112:115], a[48:51]
v_mfma_f32_16x16x32_bf16 a[52:55], a[244:247], v[112:115], a[52:55]
v_exp_f32 v149, v149
v_mfma_f32_16x16x32_bf16 a[56:59], a[248:251], v[112:115], a[56:59]
v_mfma_f32_16x16x32_bf16 a[60:63], a[252:255], v[112:115], a[60:63]
v_exp_f32 v150, v150
v_mfma_f32_16x16x32_bf16 v[92:95], v[48:51], v[112:115], v[92:95]
v_mfma_f32_16x16x32_bf16 v[112:115], a[192:195], v[192:195], 0
v_cvt_pk_bf16_f32 v146, v148, v149
v_exp_f32 v80, v80
v_mfma_f32_16x16x32_bf16 v[116:119], a[208:211], v[192:195], 0
v_exp_f32 v81, v81
v_mfma_f32_16x16x32_bf16 v[112:115], a[196:199], v[196:199], v[112:115]
v_exp_f32 v151, v151
v_mfma_f32_16x16x32_bf16 v[116:119], a[212:215], v[196:199], v[116:119]
v_exp_f32 v82, v82
v_mfma_f32_16x16x32_bf16 v[112:115], a[200:203], v[200:203], v[112:115]
v_cvt_pk_bf16_f32 v147, v150, v151
v_mfma_f32_16x16x32_bf16 v[116:119], a[216:219], v[200:203], v[116:119]
v_cvt_pk_bf16_f32 v80, v80, v81
v_mfma_f32_16x16x32_bf16 v[112:115], a[204:207], v[204:207], v[112:115]
v_mfma_f32_16x16x32_bf16 v[116:119], a[220:223], v[204:207], v[116:119]
v_exp_f32 v83, v83
v_mfma_f32_16x16x32_bf16 a[64:67], a[224:227], v[144:147], a[64:67]
s_waitcnt vmcnt(7)
s_barrier
v_mfma_f32_16x16x32_bf16 a[68:71], a[228:231], v[144:147], a[68:71]
s_add_u32 s73, s73, 262144
v_exp_f32 v84, v84
v_mfma_f32_16x16x32_bf16 a[72:75], a[232:235], v[144:147], a[72:75]
s_add_u32 s74, s74, 64
ds_read_b128 v[52:55], v18 offset:32768
v_mfma_f32_16x16x32_bf16 a[76:79], a[236:239], v[144:147], a[76:79]
s_and_b32 s73, s73, 4194303
ds_read_b128 v[56:59], v18 offset:33792
v_cvt_pk_bf16_f32 v81, v82, v83
v_mfma_f32_16x16x32_bf16 a[80:83], a[240:243], v[144:147], a[80:83]
s_and_b32 s74, s74, 1023
ds_read_b128 v[60:63], v18 offset:34816
v_mfma_f32_16x16x32_bf16 a[84:87], a[244:247], v[144:147], a[84:87]
s_add_u32 m0, s57, 98304
v_exp_f32 v85, v85
v_mfma_f32_16x16x32_bf16 a[88:91], a[248:251], v[144:147], a[88:91]
buffer_load_dwordx4 v5, s[44:47], s73 offen lds
v_mfma_f32_16x16x32_bf16 a[92:95], a[252:255], v[144:147], a[92:95]
v_exp_f32 v86, v86
v_mfma_f32_16x16x32_bf16 v[120:123], v[48:51], v[144:147], v[120:123]
v_mfma_f32_16x16x32_bf16 v[144:147], a[192:195], v[224:227], 0
v_cvt_pk_bf16_f32 v82, v84, v85
v_exp_f32 v112, v112
v_mfma_f32_16x16x32_bf16 v[148:151], a[208:211], v[224:227], 0
buffer_load_dwordx4 v39, s[44:47], s73 offen offset:1024 lds
v_exp_f32 v113, v113
v_mfma_f32_16x16x32_bf16 v[144:147], a[196:199], v[228:231], v[144:147]
v_exp_f32 v87, v87
v_mfma_f32_16x16x32_bf16 v[148:151], a[212:215], v[228:231], v[148:151]
v_exp_f32 v114, v114
v_mfma_f32_16x16x32_bf16 v[144:147], a[200:203], v[232:235], v[144:147]
v_cvt_pk_bf16_f32 v83, v86, v87
v_cvt_pk_bf16_f32 v112, v112, v113
v_mfma_f32_16x16x32_bf16 v[148:151], a[216:219], v[232:235], v[148:151]
buffer_load_dwordx4 v40, s[44:47], s73 offen offset:2048 lds
v_exp_f32 v115, v115
v_mfma_f32_16x16x32_bf16 v[144:147], a[204:207], v[236:239], v[144:147]
v_mfma_f32_16x16x32_bf16 v[148:151], a[220:223], v[236:239], v[148:151]
v_exp_f32 v116, v116
v_mfma_f32_16x16x32_bf16 a[96:99], a[224:227], v[80:83], a[96:99]
ds_read_b64_tr_b16 a[192:193], v11
v_cvt_pk_bf16_f32 v113, v114, v115
v_mfma_f32_16x16x32_bf16 a[100:103], a[228:231], v[80:83], a[100:103]
buffer_load_dwordx4 v41, s[44:47], s73 offen offset:3072 lds
ds_read_b64_tr_b16 a[194:195], v11 offset:1024
v_mfma_f32_16x16x32_bf16 a[104:107], a[232:235], v[80:83], a[104:107]
s_add_u32 m0, s56, 114944
ds_read_b64_tr_b16 a[196:197], v12
v_exp_f32 v117, v117
v_mfma_f32_16x16x32_bf16 a[108:111], a[236:239], v[80:83], a[108:111]
ds_read_b64_tr_b16 a[198:199], v12 offset:1024
v_exp_f32 v118, v118
v_mfma_f32_16x16x32_bf16 a[112:115], a[240:243], v[80:83], a[112:115]
ds_read_b64_tr_b16 a[200:201], v11 offset:64
v_cvt_pk_bf16_f32 v114, v116, v117
v_mfma_f32_16x16x32_bf16 a[116:119], a[244:247], v[80:83], a[116:119]
buffer_load_dwordx4 v2, s[16:19], s74 offen lds
ds_read_b64_tr_b16 a[202:203], v11 offset:1088
v_mfma_f32_16x16x32_bf16 a[120:123], a[248:251], v[80:83], a[120:123]
ds_read_b64_tr_b16 a[204:205], v12 offset:64
v_exp_f32 v119, v119
v_mfma_f32_16x16x32_bf16 a[124:127], a[252:255], v[80:83], a[124:127]
ds_read_b64_tr_b16 a[206:207], v12 offset:1088
v_cvt_pk_bf16_f32 v115, v118, v119
v_mfma_f32_16x16x32_bf16 v[124:127], v[48:51], v[80:83], v[124:127]
ds_read_b64_tr_b16 a[208:209], v11 offset:128
v_exp_f32 v144, v144
v_mfma_f32_16x16x32_bf16 a[128:131], a[224:227], v[112:115], a[128:131]
buffer_load_dwordx4 v3, s[16:19], s74 offen offset:1024 lds
ds_read_b64_tr_b16 a[210:211], v11 offset:1152
v_mfma_f32_16x16x32_bf16 a[132:135], a[228:231], v[112:115], a[132:135]
ds_read_b64_tr_b16 a[212:213], v12 offset:128
v_exp_f32 v145, v145
v_mfma_f32_16x16x32_bf16 a[136:139], a[232:235], v[112:115], a[136:139]
ds_read_b64_tr_b16 a[214:215], v12 offset:1152
v_exp_f32 v146, v146
v_mfma_f32_16x16x32_bf16 a[140:143], a[236:239], v[112:115], a[140:143]
ds_read_b64_tr_b16 a[216:217], v11 offset:192
v_cvt_pk_bf16_f32 v144, v144, v145
v_mfma_f32_16x16x32_bf16 a[144:147], a[240:243], v[112:115], a[144:147]
buffer_load_dwordx4 v4, s[16:19], s74 offen offset:2048 lds
ds_read_b64_tr_b16 a[218:219], v11 offset:1216
v_mfma_f32_16x16x32_bf16 a[148:151], a[244:247], v[112:115], a[148:151]
ds_read_b64_tr_b16 a[220:221], v12 offset:192
v_exp_f32 v147, v147
v_mfma_f32_16x16x32_bf16 a[152:155], a[248:251], v[112:115], a[152:155]
ds_read_b64_tr_b16 a[222:223], v12 offset:1216
v_exp_f32 v148, v148
v_mfma_f32_16x16x32_bf16 a[156:159], a[252:255], v[112:115], a[156:159]
v_cvt_pk_bf16_f32 v145, v146, v147
v_exp_f32 v149, v149
v_mfma_f32_16x16x32_bf16 v[152:155], v[48:51], v[112:115], v[152:155]
v_exp_f32 v150, v150
v_cvt_pk_bf16_f32 v146, v148, v149
v_exp_f32 v151, v151
s_nop 0
v_cvt_pk_bf16_f32 v147, v150, v151
s_nop 1
v_mfma_f32_16x16x32_bf16 a[160:163], a[224:227], v[144:147], a[160:163]
v_mfma_f32_16x16x32_bf16 a[164:167], a[228:231], v[144:147], a[164:167]
v_mfma_f32_16x16x32_bf16 a[168:171], a[232:235], v[144:147], a[168:171]
v_rcp_f32 v32, v88
v_mfma_f32_16x16x32_bf16 a[172:175], a[236:239], v[144:147], a[172:175]
v_rcp_f32 v33, v92
v_mfma_f32_16x16x32_bf16 a[176:179], a[240:243], v[144:147], a[176:179]
v_rcp_f32 v34, v120
v_mfma_f32_16x16x32_bf16 a[180:183], a[244:247], v[144:147], a[180:183]
v_rcp_f32 v35, v124
v_mfma_f32_16x16x32_bf16 a[184:187], a[248:251], v[144:147], a[184:187]
v_rcp_f32 v36, v152
v_mfma_f32_16x16x32_bf16 a[188:191], a[252:255], v[144:147], a[188:191]
v_mfma_f32_16x16x32_bf16 v[156:159], v[48:51], v[144:147], v[156:159]
s_nop 7
v_rcp_f32 v37, v156
v_min3_f32 v240, v88, v92, v120
v_max3_f32 v241, v88, v92, v120
v_add_f32 v242, v88, v92
v_min3_f32 v240, v240, v124, v152
v_max3_f32 v241, v241, v124, v152
v_add_f32 v242, v242, v120
v_min_f32 v240, v240, v156
v_max_f32 v241, v241, v156
v_add_f32 v242, v242, v124
v_add_f32 v242, v242, v152
s_mov_b32 s58, 0x33800000
v_add_f32 v242, v242, v156
s_mov_b32 s59, 0x4e800000
v_cmp_ge_f32 s[60:61], v240, s58
v_cmp_le_f32 s[62:63], v241, s59
v_cmp_o_f32 vcc, v242, v242
s_and_b64 s[60:61], s[60:61], s[62:63]
s_and_b64 s[60:61], s[60:61], vcc
s_cmp_eq_u64 s[60:61], -1
s_cbranch_scc0 L_concat_heads__mha_block_cached__gqa_block_cached__near_ridge_kernel_slow0
L_concat_heads__mha_block_cached__gqa_block_cached__near_ridge_kernel_back0:
s_waitcnt lgkmcnt(0)
v_mfma_f32_16x16x32_bf16 v[64:67], a[192:195], v[52:55], 0
v_mfma_f32_16x16x32_bf16 v[96:99], a[192:195], v[56:59], 0
ds_read_b128 a[224:227], v18 offset:35840
v_mfma_f32_16x16x32_bf16 v[128:131], a[192:195], v[60:63], 0
ds_read_b128 a[228:231], v18 offset:36864
v_mfma_f32_16x16x32_bf16 v[68:71], a[196:199], v[52:55], 0
ds_read_b128 a[232:235], v18 offset:37888
v_mfma_f32_16x16x32_bf16 v[100:103], a[196:199], v[56:59], 0
s_add_u32 s73, s73, 262144
v_accvgpr_read_b32 v44, a0
v_mfma_f32_16x16x32_bf16 v[132:135], a[196:199], v[60:63], 0
s_add_u32 s74, s74, 64
v_accvgpr_read_b32 v45, a1
v_mfma_f32_16x16x32_bf16 v[72:75], a[200:203], v[52:55], 0
s_and_b32 s73, s73, 4194303
v_accvgpr_read_b32 v46, a2
v_mfma_f32_16x16x32_bf16 v[104:107], a[200:203], v[56:59], 0
s_and_b32 s74, s74, 1023
v_mfma_f32_16x16x32_bf16 v[136:139], a[200:203], v[60:63], 0
s_waitcnt vmcnt(7) lgkmcnt(0)
s_barrier
v_accvgpr_read_b32 v47, a3
v_mfma_f32_16x16x32_bf16 v[76:79], a[204:207], v[52:55], 0
s_add_u32 m0, s57, 131072
v_accvgpr_read_b32 v48, a4
v_mfma_f32_16x16x32_bf16 v[108:111], a[204:207], v[56:59], 0
buffer_load_dwordx4 v5, s[44:47], s73 offen lds
v_accvgpr_read_b32 v49, a5
v_mfma_f32_16x16x32_bf16 v[140:143], a[204:207], v[60:63], 0
v_mfma_f32_16x16x32_bf16 v[80:83], a[208:211], v[52:55], 0
v_accvgpr_read_b32 v50, a6
v_mfma_f32_16x16x32_bf16 v[112:115], a[208:211], v[56:59], 0
v_accvgpr_read_b32 v51, a7
v_mfma_f32_16x16x32_bf16 v[144:147], a[208:211], v[60:63], 0
v_mul_f32 v44, v44, v32
v_mfma_f32_16x16x32_bf16 v[84:87], a[212:215], v[52:55], 0
v_mfma_f32_16x16x32_bf16 v[116:119], a[212:215], v[56:59], 0
buffer_load_dwordx4 v39, s[44:47], s73 offen offset:1024 lds
v_mul_f32 v45, v45, v32
v_mfma_f32_16x16x32_bf16 v[148:151], a[212:215], v[60:63], 0
v_mul_f32 v46, v46, v32
v_mfma_f32_16x16x32_bf16 v[88:91], a[216:219], v[52:55], 0
v_mul_f32 v47, v47, v32
v_mfma_f32_16x16x32_bf16 v[120:123], a[216:219], v[56:59], 0
v_mfma_f32_16x16x32_bf16 v[152:155], a[216:219], v[60:63], 0
v_mul_f32 v48, v48, v32
v_mfma_f32_16x16x32_bf16 v[92:95], a[220:223], v[52:55], 0
ds_read_b128 v[52:55], v17
v_mul_f32 v49, v49, v32
v_mfma_f32_16x16x32_bf16 v[124:127], a[220:223], v[56:59], 0
buffer_load_dwordx4 v40, s[44:47], s73 offen offset:2048 lds
ds_read_b128 v[56:59], v17 offset:1024
v_mfma_f32_16x16x32_bf16 v[156:159], a[220:223], v[60:63], 0
ds_read_b128 v[60:63], v17 offset:2048
v_mul_f32 v50, v50, v32
v_mfma_f32_16x16x32_bf16 v[160:163], a[192:195], a[224:227], 0
v_mul_f32 v51, v51, v32
v_mfma_f32_16x16x32_bf16 v[192:195], a[192:195], a[228:231], 0
v_cvt_pk_bf16_f32 v44, v44, v45
v_mfma_f32_16x16x32_bf16 v[224:227], a[192:195], a[232:235], 0
ds_read_b64_tr_b16 a[192:193], v13
v_cvt_pk_bf16_f32 v45, v46, v47
v_mfma_f32_16x16x32_bf16 v[164:167], a[196:199], a[224:227], 0
ds_read_b64_tr_b16 a[194:195], v13 offset:1024
v_mfma_f32_16x16x32_bf16 v[196:199], a[196:199], a[228:231], 0
buffer_load_dwordx4 v41, s[44:47], s73 offen offset:3072 lds
v_cvt_pk_bf16_f32 v46, v48, v49
v_mfma_f32_16x16x32_bf16 v[228:231], a[196:199], a[232:235], 0
s_add_u32 m0, s56, 147712
ds_read_b64_tr_b16 a[196:197], v14
v_mfma_f32_16x16x32_bf16 v[168:171], a[200:203], a[224:227], 0
ds_read_b64_tr_b16 a[198:199], v14 offset:1024
v_cvt_pk_bf16_f32 v47, v50, v51
v_mfma_f32_16x16x32_bf16 v[200:203], a[200:203], a[228:231], 0
s_mov_b32 s71, 0
v_mfma_f32_16x16x32_bf16 v[232:235], a[200:203], a[232:235], 0
buffer_store_dwordx4 v[44:47], v38, s[32:35], s71 offen sc1
ds_read_b64_tr_b16 a[200:201], v13 offset:64
v_mfma_f32_16x16x32_bf16 v[172:175], a[204:207], a[224:227], 0
ds_read_b64_tr_b16 a[202:203], v13 offset:1088
v_accvgpr_read_b32 v44, a8
v_mfma_f32_16x16x32_bf16 v[204:207], a[204:207], a[228:231], 0
buffer_load_dwordx4 v2, s[16:19], s74 offen lds
v_accvgpr_read_b32 v45, a9
v_mfma_f32_16x16x32_bf16 v[236:239], a[204:207], a[232:235], 0
ds_read_b64_tr_b16 a[204:205], v14 offset:64
v_mfma_f32_16x16x32_bf16 v[176:179], a[208:211], a[224:227], 0
ds_read_b64_tr_b16 a[206:207], v14 offset:1088
v_accvgpr_read_b32 v46, a10
v_mfma_f32_16x16x32_bf16 v[208:211], a[208:211], a[228:231], 0
v_accvgpr_read_b32 v47, a11
v_mfma_f32_16x16x32_bf16 v[240:243], a[208:211], a[232:235], 0
ds_read_b64_tr_b16 a[208:209], v13 offset:128
v_accvgpr_read_b32 v48, a12
v_mfma_f32_16x16x32_bf16 v[180:183], a[212:215], a[224:227], 0
ds_read_b64_tr_b16 a[210:211], v13 offset:1152
v_mfma_f32_16x16x32_bf16 v[212:215], a[212:215], a[228:231], 0
buffer_load_dwordx4 v3, s[16:19], s74 offen offset:1024 lds
v_accvgpr_read_b32 v49, a13
v_mfma_f32_16x16x32_bf16 v[244:247], a[212:215], a[232:235], 0
ds_read_b64_tr_b16 a[212:213], v14 offset:128
v_accvgpr_read_b32 v50, a14
v_mfma_f32_16x16x32_bf16 v[184:187], a[216:219], a[224:227], 0
ds_read_b64_tr_b16 a[214:215], v14 offset:1152
v_accvgpr_read_b32 v51, a15
v_mfma_f32_16x16x32_bf16 v[216:219], a[216:219], a[228:231], 0
v_mfma_f32_16x16x32_bf16 v[248:251], a[216:219], a[232:235], 0
ds_read_b64_tr_b16 a[216:217], v13 offset:192
v_mul_f32 v44, v44, v32
v_mfma_f32_16x16x32_bf16 v[188:191], a[220:223], a[224:227], 0
ds_read_b64_tr_b16 a[218:219], v13 offset:1216
v_mul_f32 v45, v45, v32
v_mfma_f32_16x16x32_bf16 v[220:223], a[220:223], a[228:231], 0
buffer_load_dwordx4 v4, s[16:19], s74 offen offset:2048 lds
v_mul_f32 v46, v46, v32
v_mfma_f32_16x16x32_bf16 v[252:255], a[220:223], a[232:235], 0
ds_read_b64_tr_b16 a[220:221], v14 offset:192
s_waitcnt lgkmcnt(4)
v_mfma_f32_16x16x32_bf16 v[64:67], a[192:195], v[52:55], v[64:67]
ds_read_b64_tr_b16 a[222:223], v14 offset:1216
v_mul_f32 v47, v47, v32
v_mfma_f32_16x16x32_bf16 v[96:99], a[192:195], v[56:59], v[96:99]
ds_read_b128 a[224:227], v17 offset:3072
v_mul_f32 v48, v48, v32
v_mfma_f32_16x16x32_bf16 v[128:131], a[192:195], v[60:63], v[128:131]
ds_read_b128 a[228:231], v17 offset:4096
v_mul_f32 v49, v49, v32
v_mfma_f32_16x16x32_bf16 v[68:71], a[196:199], v[52:55], v[68:71]
ds_read_b128 a[232:235], v17 offset:5120
v_mfma_f32_16x16x32_bf16 v[100:103], a[196:199], v[56:59], v[100:103]
s_add_u32 s73, s73, 262144
v_mul_f32 v50, v50, v32
v_mfma_f32_16x16x32_bf16 v[132:135], a[196:199], v[60:63], v[132:135]
s_add_u32 s74, s74, 64
v_mul_f32 v51, v51, v32
v_mfma_f32_16x16x32_bf16 v[72:75], a[200:203], v[52:55], v[72:75]
s_and_b32 s73, s73, 4194303
v_mfma_f32_16x16x32_bf16 v[104:107], a[200:203], v[56:59], v[104:107]
s_and_b32 s74, s74, 1023
v_cvt_pk_bf16_f32 v44, v44, v45
v_mfma_f32_16x16x32_bf16 v[136:139], a[200:203], v[60:63], v[136:139]
s_waitcnt vmcnt(8) lgkmcnt(0)
s_barrier
v_cvt_pk_bf16_f32 v45, v46, v47
v_mfma_f32_16x16x32_bf16 v[76:79], a[204:207], v[52:55], v[76:79]
s_add_u32 m0, s57, 32768
v_cvt_pk_bf16_f32 v46, v48, v49
v_mfma_f32_16x16x32_bf16 v[108:111], a[204:207], v[56:59], v[108:111]
buffer_load_dwordx4 v5, s[44:47], s73 offen lds
v_mfma_f32_16x16x32_bf16 v[140:143], a[204:207], v[60:63], v[140:143]
v_cvt_pk_bf16_f32 v47, v50, v51
v_mfma_f32_16x16x32_bf16 v[80:83], a[208:211], v[52:55], v[80:83]
s_mov_b32 s71, 0
v_mfma_f32_16x16x32_bf16 v[112:115], a[208:211], v[56:59], v[112:115]
buffer_store_dwordx4 v[44:47], v38, s[32:35], s71 offen offset:1024 sc1
v_mfma_f32_16x16x32_bf16 v[144:147], a[208:211], v[60:63], v[144:147]
v_mfma_f32_16x16x32_bf16 v[84:87], a[212:215], v[52:55], v[84:87]
v_accvgpr_read_b32 v44, a16
v_mfma_f32_16x16x32_bf16 v[116:119], a[212:215], v[56:59], v[116:119]
buffer_load_dwordx4 v39, s[44:47], s73 offen offset:1024 lds
v_accvgpr_read_b32 v45, a17
v_mfma_f32_16x16x32_bf16 v[148:151], a[212:215], v[60:63], v[148:151]
v_accvgpr_read_b32 v46, a18
v_mfma_f32_16x16x32_bf16 v[88:91], a[216:219], v[52:55], v[88:91]
v_mfma_f32_16x16x32_bf16 v[120:123], a[216:219], v[56:59], v[120:123]
v_accvgpr_read_b32 v47, a19
v_mfma_f32_16x16x32_bf16 v[152:155], a[216:219], v[60:63], v[152:155]
v_accvgpr_read_b32 v48, a20
v_mfma_f32_16x16x32_bf16 v[92:95], a[220:223], v[52:55], v[92:95]
ds_read_b128 v[52:55], v18
v_accvgpr_read_b32 v49, a21
v_mfma_f32_16x16x32_bf16 v[124:127], a[220:223], v[56:59], v[124:127]
buffer_load_dwordx4 v40, s[44:47], s73 offen offset:2048 lds
ds_read_b128 v[56:59], v18 offset:1024
v_mfma_f32_16x16x32_bf16 v[156:159], a[220:223], v[60:63], v[156:159]
ds_read_b128 v[60:63], v18 offset:2048
v_accvgpr_read_b32 v50, a22
v_mfma_f32_16x16x32_bf16 v[160:163], a[192:195], a[224:227], v[160:163]
v_accvgpr_read_b32 v51, a23
v_mfma_f32_16x16x32_bf16 v[192:195], a[192:195], a[228:231], v[192:195]
v_mul_f32 v44, v44, v32
v_mfma_f32_16x16x32_bf16 v[224:227], a[192:195], a[232:235], v[224:227]
ds_read_b64_tr_b16 a[192:193], v15
v_mfma_f32_16x16x32_bf16 v[164:167], a[196:199], a[224:227], v[164:167]
ds_read_b64_tr_b16 a[194:195], v15 offset:1024
v_mul_f32 v45, v45, v32
v_mfma_f32_16x16x32_bf16 v[196:199], a[196:199], a[228:231], v[196:199]
buffer_load_dwordx4 v41, s[44:47], s73 offen offset:3072 lds
v_mul_f32 v46, v46, v32
v_mfma_f32_16x16x32_bf16 v[228:231], a[196:199], a[232:235], v[228:231]
s_add_u32 m0, s56, 49408
ds_read_b64_tr_b16 a[196:197], v16
v_mfma_f32_16x16x32_bf16 v[168:171], a[200:203], a[224:227], v[168:171]
ds_read_b64_tr_b16 a[198:199], v16 offset:1024
v_mul_f32 v47, v47, v32
v_mfma_f32_16x16x32_bf16 v[200:203], a[200:203], a[228:231], v[200:203]
v_mul_f32 v48, v48, v32
v_mfma_f32_16x16x32_bf16 v[232:235], a[200:203], a[232:235], v[232:235]
ds_read_b64_tr_b16 a[200:201], v15 offset:64
v_mul_f32 v49, v49, v32
v_mfma_f32_16x16x32_bf16 v[172:175], a[204:207], a[224:227], v[172:175]
ds_read_b64_tr_b16 a[202:203], v15 offset:1088
v_mul_f32 v50, v50, v32
v_mfma_f32_16x16x32_bf16 v[204:207], a[204:207], a[228:231], v[204:207]
buffer_load_dwordx4 v2, s[16:19], s74 offen lds
v_mfma_f32_16x16x32_bf16 v[236:239], a[204:207], a[232:235], v[236:239]
ds_read_b64_tr_b16 a[204:205], v16 offset:64
v_mul_f32 v51, v51, v32
v_mfma_f32_16x16x32_bf16 v[176:179], a[208:211], a[224:227], v[176:179]
ds_read_b64_tr_b16 a[206:207], v16 offset:1088
v_cvt_pk_bf16_f32 v44, v44, v45
v_mfma_f32_16x16x32_bf16 v[208:211], a[208:211], a[228:231], v[208:211]
v_cvt_pk_bf16_f32 v45, v46, v47
v_mfma_f32_16x16x32_bf16 v[240:243], a[208:211], a[232:235], v[240:243]
ds_read_b64_tr_b16 a[208:209], v15 offset:128
v_mfma_f32_16x16x32_bf16 v[180:183], a[212:215], a[224:227], v[180:183]
ds_read_b64_tr_b16 a[210:211], v15 offset:1152
v_cvt_pk_bf16_f32 v46, v48, v49
v_mfma_f32_16x16x32_bf16 v[212:215], a[212:215], a[228:231], v[212:215]
buffer_load_dwordx4 v3, s[16:19], s74 offen offset:1024 lds
v_cvt_pk_bf16_f32 v47, v50, v51
v_mfma_f32_16x16x32_bf16 v[244:247], a[212:215], a[232:235], v[244:247]
ds_read_b64_tr_b16 a[212:213], v16 offset:128
s_mov_b32 s71, 0
v_mfma_f32_16x16x32_bf16 v[184:187], a[216:219], a[224:227], v[184:187]
ds_read_b64_tr_b16 a[214:215], v16 offset:1152
v_mfma_f32_16x16x32_bf16 v[216:219], a[216:219], a[228:231], v[216:219]
buffer_store_dwordx4 v[44:47], v38, s[32:35], s71 offen offset:2048 sc1
v_mfma_f32_16x16x32_bf16 v[248:251], a[216:219], a[232:235], v[248:251]
ds_read_b64_tr_b16 a[216:217], v15 offset:192
v_accvgpr_read_b32 v44, a24
v_mfma_f32_16x16x32_bf16 v[188:191], a[220:223], a[224:227], v[188:191]
ds_read_b64_tr_b16 a[218:219], v15 offset:1216
v_accvgpr_read_b32 v45, a25
v_mfma_f32_16x16x32_bf16 v[220:223], a[220:223], a[228:231], v[220:223]
buffer_load_dwordx4 v4, s[16:19], s74 offen offset:2048 lds
v_mfma_f32_16x16x32_bf16 v[252:255], a[220:223], a[232:235], v[252:255]
ds_read_b64_tr_b16 a[220:221], v16 offset:192
v_accvgpr_read_b32 v46, a26
s_waitcnt lgkmcnt(4)
v_mfma_f32_16x16x32_bf16 v[64:67], a[192:195], v[52:55], v[64:67]
ds_read_b64_tr_b16 a[222:223], v16 offset:1216
v_accvgpr_read_b32 v47, a27
v_mfma_f32_16x16x32_bf16 v[96:99], a[192:195], v[56:59], v[96:99]
ds_read_b128 a[224:227], v18 offset:3072
v_accvgpr_read_b32 v48, a28
v_mfma_f32_16x16x32_bf16 v[128:131], a[192:195], v[60:63], v[128:131]
ds_read_b128 a[228:231], v18 offset:4096
v_mfma_f32_16x16x32_bf16 v[68:71], a[196:199], v[52:55], v[68:71]
ds_read_b128 a[232:235], v18 offset:5120
v_accvgpr_read_b32 v49, a29
v_mfma_f32_16x16x32_bf16 v[100:103], a[196:199], v[56:59], v[100:103]
s_add_u32 s73, s73, 262144
v_accvgpr_read_b32 v50, a30
v_mfma_f32_16x16x32_bf16 v[132:135], a[196:199], v[60:63], v[132:135]
s_add_u32 s74, s74, 64
v_mfma_f32_16x16x32_bf16 v[72:75], a[200:203], v[52:55], v[72:75]
s_and_b32 s73, s73, 4194303
v_accvgpr_read_b32 v51, a31
v_mfma_f32_16x16x32_bf16 v[104:107], a[200:203], v[56:59], v[104:107]
s_and_b32 s74, s74, 1023
v_mul_f32 v44, v44, v32
v_mfma_f32_16x16x32_bf16 v[136:139], a[200:203], v[60:63], v[136:139]
s_waitcnt vmcnt(9) lgkmcnt(0)
s_barrier
v_mul_f32 v45, v45, v32
v_mfma_f32_16x16x32_bf16 v[76:79], a[204:207], v[52:55], v[76:79]
s_add_u32 m0, s57, 98304
v_mfma_f32_16x16x32_bf16 v[108:111], a[204:207], v[56:59], v[108:111]
buffer_load_dwordx4 v5, s[44:47], s73 offen lds
v_mul_f32 v46, v46, v32
v_mfma_f32_16x16x32_bf16 v[140:143], a[204:207], v[60:63], v[140:143]
v_mul_f32 v47, v47, v32
v_mfma_f32_16x16x32_bf16 v[80:83], a[208:211], v[52:55], v[80:83]
v_mul_f32 v48, v48, v32
v_mfma_f32_16x16x32_bf16 v[112:115], a[208:211], v[56:59], v[112:115]
v_mfma_f32_16x16x32_bf16 v[144:147], a[208:211], v[60:63], v[144:147]
v_mul_f32 v49, v49, v32
v_mfma_f32_16x16x32_bf16 v[84:87], a[212:215], v[52:55], v[84:87]
v_mul_f32 v50, v50, v32
v_mfma_f32_16x16x32_bf16 v[116:119], a[212:215], v[56:59], v[116:119]
buffer_load_dwordx4 v39, s[44:47], s73 offen offset:1024 lds
v_mul_f32 v51, v51, v32
v_mfma_f32_16x16x32_bf16 v[148:151], a[212:215], v[60:63], v[148:151]
v_mfma_f32_16x16x32_bf16 v[88:91], a[216:219], v[52:55], v[88:91]
v_cvt_pk_bf16_f32 v44, v44, v45
v_mfma_f32_16x16x32_bf16 v[120:123], a[216:219], v[56:59], v[120:123]
v_cvt_pk_bf16_f32 v45, v46, v47
v_mfma_f32_16x16x32_bf16 v[152:155], a[216:219], v[60:63], v[152:155]
v_cvt_pk_bf16_f32 v46, v48, v49
v_mfma_f32_16x16x32_bf16 v[92:95], a[220:223], v[52:55], v[92:95]
ds_read_b128 v[52:55], v18 offset:32768
v_mfma_f32_16x16x32_bf16 v[124:127], a[220:223], v[56:59], v[124:127]
buffer_load_dwordx4 v40, s[44:47], s73 offen offset:2048 lds
ds_read_b128 v[56:59], v18 offset:33792
v_mfma_f32_16x16x32_bf16 v[156:159], a[220:223], v[60:63], v[156:159]
ds_read_b128 v[60:63], v18 offset:34816
v_cvt_pk_bf16_f32 v47, v50, v51
v_mfma_f32_16x16x32_bf16 v[160:163], a[192:195], a[224:227], v[160:163]
s_mov_b32 s71, 0
buffer_store_dwordx4 v[44:47], v38, s[32:35], s71 offen offset:3072 sc1
v_mfma_f32_16x16x32_bf16 v[192:195], a[192:195], a[228:231], v[192:195]
v_mfma_f32_16x16x32_bf16 v[224:227], a[192:195], a[232:235], v[224:227]
ds_read_b64_tr_b16 a[192:193], v11
v_accvgpr_read_b32 v44, a32
v_mfma_f32_16x16x32_bf16 v[164:167], a[196:199], a[224:227], v[164:167]
ds_read_b64_tr_b16 a[194:195], v11 offset:1024
v_accvgpr_read_b32 v45, a33
v_mfma_f32_16x16x32_bf16 v[196:199], a[196:199], a[228:231], v[196:199]
buffer_load_dwordx4 v41, s[44:47], s73 offen offset:3072 lds
v_accvgpr_read_b32 v46, a34
v_mfma_f32_16x16x32_bf16 v[228:231], a[196:199], a[232:235], v[228:231]
s_add_u32 m0, s56, 114944
ds_read_b64_tr_b16 a[196:197], v12
v_mfma_f32_16x16x32_bf16 v[168:171], a[200:203], a[224:227], v[168:171]
ds_read_b64_tr_b16 a[198:199], v12 offset:1024
v_accvgpr_read_b32 v47, a35
v_mfma_f32_16x16x32_bf16 v[200:203], a[200:203], a[228:231], v[200:203]
v_accvgpr_read_b32 v48, a36
v_mfma_f32_16x16x32_bf16 v[232:235], a[200:203], a[232:235], v[232:235]
ds_read_b64_tr_b16 a[200:201], v11 offset:64
v_accvgpr_read_b32 v49, a37
v_mfma_f32_16x16x32_bf16 v[172:175], a[204:207], a[224:227], v[172:175]
ds_read_b64_tr_b16 a[202:203], v11 offset:1088
v_mfma_f32_16x16x32_bf16 v[204:207], a[204:207], a[228:231], v[204:207]
buffer_load_dwordx4 v2, s[16:19], s74 offen lds
v_accvgpr_read_b32 v50, a38
v_mfma_f32_16x16x32_bf16 v[236:239], a[204:207], a[232:235], v[236:239]
ds_read_b64_tr_b16 a[204:205], v12 offset:64
v_accvgpr_read_b32 v51, a39
v_mfma_f32_16x16x32_bf16 v[176:179], a[208:211], a[224:227], v[176:179]
ds_read_b64_tr_b16 a[206:207], v12 offset:1088
v_mul_f32 v44, v44, v33
v_mfma_f32_16x16x32_bf16 v[208:211], a[208:211], a[228:231], v[208:211]
v_mfma_f32_16x16x32_bf16 v[240:243], a[208:211], a[232:235], v[240:243]
ds_read_b64_tr_b16 a[208:209], v11 offset:128
v_mul_f32 v45, v45, v33
v_mfma_f32_16x16x32_bf16 v[180:183], a[212:215], a[224:227], v[180:183]
ds_read_b64_tr_b16 a[210:211], v11 offset:1152
v_mul_f32 v46, v46, v33
v_mfma_f32_16x16x32_bf16 v[212:215], a[212:215], a[228:231], v[212:215]
buffer_load_dwordx4 v3, s[16:19], s74 offen offset:1024 lds
v_mul_f32 v47, v47, v33
v_mfma_f32_16x16x32_bf16 v[244:247], a[212:215], a[232:235], v[244:247]
ds_read_b64_tr_b16 a[212:213], v12 offset:128
v_mfma_f32_16x16x32_bf16 v[184:187], a[216:219], a[224:227], v[184:187]
ds_read_b64_tr_b16 a[214:215], v12 offset:1152
v_mul_f32 v48, v48, v33
v_mfma_f32_16x16x32_bf16 v[216:219], a[216:219], a[228:231], v[216:219]
v_mul_f32 v49, v49, v33
v_mfma_f32_16x16x32_bf16 v[248:251], a[216:219], a[232:235], v[248:251]
ds_read_b64_tr_b16 a[216:217], v11 offset:192
v_mul_f32 v50, v50, v33
v_mfma_f32_16x16x32_bf16 v[188:191], a[220:223], a[224:227], v[188:191]
ds_read_b64_tr_b16 a[218:219], v11 offset:1216
v_mfma_f32_16x16x32_bf16 v[220:223], a[220:223], a[228:231], v[220:223]
buffer_load_dwordx4 v4, s[16:19], s74 offen offset:2048 lds
v_mul_f32 v51, v51, v33
v_mfma_f32_16x16x32_bf16 v[252:255], a[220:223], a[232:235], v[252:255]
ds_read_b64_tr_b16 a[220:221], v12 offset:192
v_cvt_pk_bf16_f32 v44, v44, v45
s_waitcnt lgkmcnt(3)
v_mfma_f32_16x16x32_bf16 v[64:67], a[192:195], v[52:55], v[64:67]
ds_read_b64_tr_b16 a[222:223], v12 offset:1216
v_cvt_pk_bf16_f32 v45, v46, v47
v_mfma_f32_16x16x32_bf16 v[96:99], a[192:195], v[56:59], v[96:99]
ds_read_b128 a[224:227], v18 offset:35840
v_mfma_f32_16x16x32_bf16 v[128:131], a[192:195], v[60:63], v[128:131]
ds_read_b128 a[228:231], v18 offset:36864
v_cvt_pk_bf16_f32 v46, v48, v49
v_mfma_f32_16x16x32_bf16 v[68:71], a[196:199], v[52:55], v[68:71]
ds_read_b128 a[232:235], v18 offset:37888
v_cvt_pk_bf16_f32 v47, v50, v51
v_mfma_f32_16x16x32_bf16 v[100:103], a[196:199], v[56:59], v[100:103]
s_add_u32 s73, s73, 262144
v_mfma_f32_16x16x32_bf16 v[132:135], a[196:199], v[60:63], v[132:135]
s_add_u32 s74, s74, 64
s_mov_b32 s71, 131072
v_mfma_f32_16x16x32_bf16 v[72:75], a[200:203], v[52:55], v[72:75]
buffer_store_dwordx4 v[44:47], v38, s[32:35], s71 offen sc1
s_and_b32 s73, s73, 4194303
v_mfma_f32_16x16x32_bf16 v[104:107], a[200:203], v[56:59], v[104:107]
s_and_b32 s74, s74, 1023
v_accvgpr_read_b32 v44, a40
v_mfma_f32_16x16x32_bf16 v[136:139], a[200:203], v[60:63], v[136:139]
s_waitcnt vmcnt(9) lgkmcnt(0)
s_barrier
v_mfma_f32_16x16x32_bf16 v[76:79], a[204:207], v[52:55], v[76:79]
s_add_u32 m0, s57, 131072
v_accvgpr_read_b32 v45, a41
v_mfma_f32_16x16x32_bf16 v[108:111], a[204:207], v[56:59], v[108:111]
buffer_load_dwordx4 v5, s[44:47], s73 offen lds
v_accvgpr_read_b32 v46, a42
v_mfma_f32_16x16x32_bf16 v[140:143], a[204:207], v[60:63], v[140:143]
v_accvgpr_read_b32 v47, a43
v_mfma_f32_16x16x32_bf16 v[80:83], a[208:211], v[52:55], v[80:83]
v_mfma_f32_16x16x32_bf16 v[112:115], a[208:211], v[56:59], v[112:115]
v_accvgpr_read_b32 v48, a44
v_mfma_f32_16x16x32_bf16 v[144:147], a[208:211], v[60:63], v[144:147]
v_accvgpr_read_b32 v49, a45
v_mfma_f32_16x16x32_bf16 v[84:87], a[212:215], v[52:55], v[84:87]
v_accvgpr_read_b32 v50, a46
v_mfma_f32_16x16x32_bf16 v[116:119], a[212:215], v[56:59], v[116:119]
buffer_load_dwordx4 v39, s[44:47], s73 offen offset:1024 lds
v_mfma_f32_16x16x32_bf16 v[148:151], a[212:215], v[60:63], v[148:151]
v_accvgpr_read_b32 v51, a47
v_mfma_f32_16x16x32_bf16 v[88:91], a[216:219], v[52:55], v[88:91]
v_mul_f32 v44, v44, v33
v_mfma_f32_16x16x32_bf16 v[120:123], a[216:219], v[56:59], v[120:123]
v_mul_f32 v45, v45, v33
v_mfma_f32_16x16x32_bf16 v[152:155], a[216:219], v[60:63], v[152:155]
v_mfma_f32_16x16x32_bf16 v[92:95], a[220:223], v[52:55], v[92:95]
ds_read_b128 v[52:55], v17
v_mul_f32 v46, v46, v33
v_mfma_f32_16x16x32_bf16 v[124:127], a[220:223], v[56:59], v[124:127]
buffer_load_dwordx4 v40, s[44:47], s73 offen offset:2048 lds
ds_read_b128 v[56:59], v17 offset:1024
v_mfma_f32_16x16x32_bf16 v[156:159], a[220:223], v[60:63], v[156:159]
ds_read_b128 v[60:63], v17 offset:2048
v_mul_f32 v47, v47, v33
v_mfma_f32_16x16x32_bf16 v[160:163], a[192:195], a[224:227], v[160:163]
v_mul_f32 v48, v48, v33
v_mfma_f32_16x16x32_bf16 v[192:195], a[192:195], a[228:231], v[192:195]
v_mul_f32 v49, v49, v33
v_mfma_f32_16x16x32_bf16 v[224:227], a[192:195], a[232:235], v[224:227]
ds_read_b64_tr_b16 a[192:193], v13
v_mul_f32 v50, v50, v33
v_mfma_f32_16x16x32_bf16 v[164:167], a[196:199], a[224:227], v[164:167]
ds_read_b64_tr_b16 a[194:195], v13 offset:1024
v_mul_f32 v51, v51, v33
v_mfma_f32_16x16x32_bf16 v[196:199], a[196:199], a[228:231], v[196:199]
buffer_load_dwordx4 v41, s[44:47], s73 offen offset:3072 lds
v_mfma_f32_16x16x32_bf16 v[228:231], a[196:199], a[232:235], v[228:231]
s_add_u32 m0, s56, 147712
ds_read_b64_tr_b16 a[196:197], v14
v_mfma_f32_16x16x32_bf16 v[168:171], a[200:203], a[224:227], v[168:171]
ds_read_b64_tr_b16 a[198:199], v14 offset:1024
v_cvt_pk_bf16_f32 v44, v44, v45
v_mfma_f32_16x16x32_bf16 v[200:203], a[200:203], a[228:231], v[200:203]
v_cvt_pk_bf16_f32 v45, v46, v47
v_mfma_f32_16x16x32_bf16 v[232:235], a[200:203], a[232:235], v[232:235]
ds_read_b64_tr_b16 a[200:201], v13 offset:64
v_cvt_pk_bf16_f32 v46, v48, v49
v_mfma_f32_16x16x32_bf16 v[172:175], a[204:207], a[224:227], v[172:175]
ds_read_b64_tr_b16 a[202:203], v13 offset:1088
v_cvt_pk_bf16_f32 v47, v50, v51
v_mfma_f32_16x16x32_bf16 v[204:207], a[204:207], a[228:231], v[204:207]
buffer_load_dwordx4 v2, s[16:19], s74 offen lds
s_mov_b32 s71, 131072
v_mfma_f32_16x16x32_bf16 v[236:239], a[204:207], a[232:235], v[236:239]
buffer_store_dwordx4 v[44:47], v38, s[32:35], s71 offen offset:1024 sc1
ds_read_b64_tr_b16 a[204:205], v14 offset:64
v_mfma_f32_16x16x32_bf16 v[176:179], a[208:211], a[224:227], v[176:179]
ds_read_b64_tr_b16 a[206:207], v14 offset:1088
v_mfma_f32_16x16x32_bf16 v[208:211], a[208:211], a[228:231], v[208:211]
v_accvgpr_read_b32 v44, a48
v_mfma_f32_16x16x32_bf16 v[240:243], a[208:211], a[232:235], v[240:243]
ds_read_b64_tr_b16 a[208:209], v13 offset:128
v_accvgpr_read_b32 v45, a49
v_mfma_f32_16x16x32_bf16 v[180:183], a[212:215], a[224:227], v[180:183]
ds_read_b64_tr_b16 a[210:211], v13 offset:1152
v_accvgpr_read_b32 v46, a50
v_mfma_f32_16x16x32_bf16 v[212:215], a[212:215], a[228:231], v[212:215]
buffer_load_dwordx4 v3, s[16:19], s74 offen offset:1024 lds
v_mfma_f32_16x16x32_bf16 v[244:247], a[212:215], a[232:235], v[244:247]
ds_read_b64_tr_b16 a[212:213], v14 offset:128
v_accvgpr_read_b32 v47, a51
v_mfma_f32_16x16x32_bf16 v[184:187], a[216:219], a[224:227], v[184:187]
ds_read_b64_tr_b16 a[214:215], v14 offset:1152
v_accvgpr_read_b32 v48, a52
v_mfma_f32_16x16x32_bf16 v[216:219], a[216:219], a[228:231], v[216:219]
v_accvgpr_read_b32 v49, a53
v_mfma_f32_16x16x32_bf16 v[248:251], a[216:219], a[232:235], v[248:251]
ds_read_b64_tr_b16 a[216:217], v13 offset:192
v_mfma_f32_16x16x32_bf16 v[188:191], a[220:223], a[224:227], v[188:191]
ds_read_b64_tr_b16 a[218:219], v13 offset:1216
v_accvgpr_read_b32 v50, a54
v_mfma_f32_16x16x32_bf16 v[220:223], a[220:223], a[228:231], v[220:223]
buffer_load_dwordx4 v4, s[16:19], s74 offen offset:2048 lds
v_accvgpr_read_b32 v51, a55
v_mfma_f32_16x16x32_bf16 v[252:255], a[220:223], a[232:235], v[252:255]
ds_read_b64_tr_b16 a[220:221], v14 offset:192
v_mul_f32 v44, v44, v33
s_waitcnt lgkmcnt(3)
v_mfma_f32_16x16x32_bf16 v[64:67], a[192:195], v[52:55], v[64:67]
ds_read_b64_tr_b16 a[222:223], v14 offset:1216
v_mfma_f32_16x16x32_bf16 v[96:99], a[192:195], v[56:59], v[96:99]
ds_read_b128 a[224:227], v17 offset:3072
v_mul_f32 v45, v45, v33
v_mfma_f32_16x16x32_bf16 v[128:131], a[192:195], v[60:63], v[128:131]
ds_read_b128 a[228:231], v17 offset:4096
v_mul_f32 v46, v46, v33
v_mfma_f32_16x16x32_bf16 v[68:71], a[196:199], v[52:55], v[68:71]
ds_read_b128 a[232:235], v17 offset:5120
v_mfma_f32_16x16x32_bf16 v[100:103], a[196:199], v[56:59], v[100:103]
s_add_u32 s73, s73, 262144
v_mul_f32 v47, v47, v33
v_mfma_f32_16x16x32_bf16 v[132:135], a[196:199], v[60:63], v[132:135]
s_add_u32 s74, s74, 64
v_mul_f32 v48, v48, v33
v_mfma_f32_16x16x32_bf16 v[72:75], a[200:203], v[52:55], v[72:75]
s_and_b32 s73, s73, 4194303
v_mul_f32 v49, v49, v33
v_mfma_f32_16x16x32_bf16 v[104:107], a[200:203], v[56:59], v[104:107]
s_and_b32 s74, s74, 1023
v_mfma_f32_16x16x32_bf16 v[136:139], a[200:203], v[60:63], v[136:139]
s_waitcnt vmcnt(9) lgkmcnt(0)
s_barrier
v_mul_f32 v50, v50, v33
v_mfma_f32_16x16x32_bf16 v[76:79], a[204:207], v[52:55], v[76:79]
s_add_u32 m0, s57, 32768
v_mul_f32 v51, v51, v33
v_mfma_f32_16x16x32_bf16 v[108:111], a[204:207], v[56:59], v[108:111]
buffer_load_dwordx4 v5, s[44:47], s73 offen lds
v_cvt_pk_bf16_f32 v44, v44, v45
v_mfma_f32_16x16x32_bf16 v[140:143], a[204:207], v[60:63], v[140:143]
v_mfma_f32_16x16x32_bf16 v[80:83], a[208:211], v[52:55], v[80:83]
v_cvt_pk_bf16_f32 v45, v46, v47
v_mfma_f32_16x16x32_bf16 v[112:115], a[208:211], v[56:59], v[112:115]
v_cvt_pk_bf16_f32 v46, v48, v49
v_mfma_f32_16x16x32_bf16 v[144:147], a[208:211], v[60:63], v[144:147]
v_cvt_pk_bf16_f32 v47, v50, v51
v_mfma_f32_16x16x32_bf16 v[84:87], a[212:215], v[52:55], v[84:87]
v_mfma_f32_16x16x32_bf16 v[116:119], a[212:215], v[56:59], v[116:119]
buffer_load_dwordx4 v39, s[44:47], s73 offen offset:1024 lds
s_mov_b32 s71, 131072
v_mfma_f32_16x16x32_bf16 v[148:151], a[212:215], v[60:63], v[148:151]
buffer_store_dwordx4 v[44:47], v38, s[32:35], s71 offen offset:2048 sc1
v_mfma_f32_16x16x32_bf16 v[88:91], a[216:219], v[52:55], v[88:91]
s_nop 0
v_accvgpr_read_b32 v44, a56
v_mfma_f32_16x16x32_bf16 v[120:123], a[216:219], v[56:59], v[120:123]
v_mfma_f32_16x16x32_bf16 v[152:155], a[216:219], v[60:63], v[152:155]
v_accvgpr_read_b32 v45, a57
v_mfma_f32_16x16x32_bf16 v[92:95], a[220:223], v[52:55], v[92:95]
ds_read_b128 v[52:55], v18
v_accvgpr_read_b32 v46, a58
v_mfma_f32_16x16x32_bf16 v[124:127], a[220:223], v[56:59], v[124:127]
buffer_load_dwordx4 v40, s[44:47], s73 offen offset:2048 lds
ds_read_b128 v[56:59], v18 offset:1024
v_mfma_f32_16x16x32_bf16 v[156:159], a[220:223], v[60:63], v[156:159]
ds_read_b128 v[60:63], v18 offset:2048
v_accvgpr_read_b32 v47, a59
v_mfma_f32_16x16x32_bf16 v[160:163], a[192:195], a[224:227], v[160:163]
v_accvgpr_read_b32 v48, a60
v_mfma_f32_16x16x32_bf16 v[192:195], a[192:195], a[228:231], v[192:195]
v_accvgpr_read_b32 v49, a61
v_mfma_f32_16x16x32_bf16 v[224:227], a[192:195], a[232:235], v[224:227]
ds_read_b64_tr_b16 a[192:193], v15
v_accvgpr_read_b32 v50, a62
v_mfma_f32_16x16x32_bf16 v[164:167], a[196:199], a[224:227], v[164:167]
ds_read_b64_tr_b16 a[194:195], v15 offset:1024
v_mfma_f32_16x16x32_bf16 v[196:199], a[196:199], a[228:231], v[196:199]
buffer_load_dwordx4 v41, s[44:47], s73 offen offset:3072 lds
v_accvgpr_read_b32 v51, a63
v_mfma_f32_16x16x32_bf16 v[228:231], a[196:199], a[232:235], v[228:231]
s_add_u32 m0, s56, 49408
ds_read_b64_tr_b16 a[196:197], v16
v_mfma_f32_16x16x32_bf16 v[168:171], a[200:203], a[224:227], v[168:171]
ds_read_b64_tr_b16 a[198:199], v16 offset:1024
v_mul_f32 v44, v44, v33
v_mfma_f32_16x16x32_bf16 v[200:203], a[200:203], a[228:231], v[200:203]
v_mul_f32 v45, v45, v33
v_mfma_f32_16x16x32_bf16 v[232:235], a[200:203], a[232:235], v[232:235]
ds_read_b64_tr_b16 a[200:201], v15 offset:64
v_mul_f32 v46, v46, v33
v_mfma_f32_16x16x32_bf16 v[172:175], a[204:207], a[224:227], v[172:175]
ds_read_b64_tr_b16 a[202:203], v15 offset:1088
v_mul_f32 v47, v47, v33
v_mfma_f32_16x16x32_bf16 v[204:207], a[204:207], a[228:231], v[204:207]
buffer_load_dwordx4 v2, s[16:19], s74 offen lds
v_mul_f32 v48, v48, v33
v_mfma_f32_16x16x32_bf16 v[236:239], a[204:207], a[232:235], v[236:239]
ds_read_b64_tr_b16 a[204:205], v16 offset:64
v_mfma_f32_16x16x32_bf16 v[176:179], a[208:211], a[224:227], v[176:179]
ds_read_b64_tr_b16 a[206:207], v16 offset:1088
v_mul_f32 v49, v49, v33
v_mfma_f32_16x16x32_bf16 v[208:211], a[208:211], a[228:231], v[208:211]
v_mul_f32 v50, v50, v33
v_mfma_f32_16x16x32_bf16 v[240:243], a[208:211], a[232:235], v[240:243]
ds_read_b64_tr_b16 a[208:209], v15 offset:128
v_mul_f32 v51, v51, v33
v_mfma_f32_16x16x32_bf16 v[180:183], a[212:215], a[224:227], v[180:183]
ds_read_b64_tr_b16 a[210:211], v15 offset:1152
v_mfma_f32_16x16x32_bf16 v[212:215], a[212:215], a[228:231], v[212:215]
buffer_load_dwordx4 v3, s[16:19], s74 offen offset:1024 lds
v_cvt_pk_bf16_f32 v44, v44, v45
v_mfma_f32_16x16x32_bf16 v[244:247], a[212:215], a[232:235], v[244:247]
ds_read_b64_tr_b16 a[212:213], v16 offset:128
v_cvt_pk_bf16_f32 v45, v46, v47
v_mfma_f32_16x16x32_bf16 v[184:187], a[216:219], a[224:227], v[184:187]
ds_read_b64_tr_b16 a[214:215], v16 offset:1152
v_cvt_pk_bf16_f32 v46, v48, v49
v_mfma_f32_16x16x32_bf16 v[216:219], a[216:219], a[228:231], v[216:219]
v_mfma_f32_16x16x32_bf16 v[248:251], a[216:219], a[232:235], v[248:251]
ds_read_b64_tr_b16 a[216:217], v15 offset:192
v_cvt_pk_bf16_f32 v47, v50, v51
v_mfma_f32_16x16x32_bf16 v[188:191], a[220:223], a[224:227], v[188:191]
ds_read_b64_tr_b16 a[218:219], v15 offset:1216
s_mov_b32 s71, 131072
v_mfma_f32_16x16x32_bf16 v[220:223], a[220:223], a[228:231], v[220:223]
buffer_load_dwordx4 v4, s[16:19], s74 offen offset:2048 lds
buffer_store_dwordx4 v[44:47], v38, s[32:35], s71 offen offset:3072 sc1
v_mfma_f32_16x16x32_bf16 v[252:255], a[220:223], a[232:235], v[252:255]
ds_read_b64_tr_b16 a[220:221], v16 offset:192
s_waitcnt lgkmcnt(4)
v_mfma_f32_16x16x32_bf16 v[64:67], a[192:195], v[52:55], v[64:67]
ds_read_b64_tr_b16 a[222:223], v16 offset:1216
v_accvgpr_read_b32 v44, a64
v_mfma_f32_16x16x32_bf16 v[96:99], a[192:195], v[56:59], v[96:99]
ds_read_b128 a[224:227], v18 offset:3072
v_accvgpr_read_b32 v45, a65
v_mfma_f32_16x16x32_bf16 v[128:131], a[192:195], v[60:63], v[128:131]
ds_read_b128 a[228:231], v18 offset:4096
v_mfma_f32_16x16x32_bf16 v[68:71], a[196:199], v[52:55], v[68:71]
ds_read_b128 a[232:235], v18 offset:5120
v_accvgpr_read_b32 v46, a66
v_mfma_f32_16x16x32_bf16 v[100:103], a[196:199], v[56:59], v[100:103]
s_add_u32 s73, s73, 262144
v_accvgpr_read_b32 v47, a67
v_mfma_f32_16x16x32_bf16 v[132:135], a[196:199], v[60:63], v[132:135]
s_add_u32 s74, s74, 64
v_accvgpr_read_b32 v48, a68
v_mfma_f32_16x16x32_bf16 v[72:75], a[200:203], v[52:55], v[72:75]
s_and_b32 s73, s73, 4194303
v_mfma_f32_16x16x32_bf16 v[104:107], a[200:203], v[56:59], v[104:107]
s_and_b32 s74, s74, 1023
v_accvgpr_read_b32 v49, a69
v_mfma_f32_16x16x32_bf16 v[136:139], a[200:203], v[60:63], v[136:139]
s_waitcnt vmcnt(9) lgkmcnt(0)
s_barrier
v_accvgpr_read_b32 v50, a70
v_mfma_f32_16x16x32_bf16 v[76:79], a[204:207], v[52:55], v[76:79]
s_add_u32 m0, s57, 98304
v_accvgpr_read_b32 v51, a71
v_mfma_f32_16x16x32_bf16 v[108:111], a[204:207], v[56:59], v[108:111]
buffer_load_dwordx4 v5, s[44:47], s73 offen lds
v_mfma_f32_16x16x32_bf16 v[140:143], a[204:207], v[60:63], v[140:143]
v_mul_f32 v44, v44, v34
v_mfma_f32_16x16x32_bf16 v[80:83], a[208:211], v[52:55], v[80:83]
v_mul_f32 v45, v45, v34
v_mfma_f32_16x16x32_bf16 v[112:115], a[208:211], v[56:59], v[112:115]
v_mul_f32 v46, v46, v34
v_mfma_f32_16x16x32_bf16 v[144:147], a[208:211], v[60:63], v[144:147]
v_mfma_f32_16x16x32_bf16 v[84:87], a[212:215], v[52:55], v[84:87]
v_mul_f32 v47, v47, v34
v_mfma_f32_16x16x32_bf16 v[116:119], a[212:215], v[56:59], v[116:119]
buffer_load_dwordx4 v39, s[44:47], s73 offen offset:1024 lds
v_mul_f32 v48, v48, v34
v_mfma_f32_16x16x32_bf16 v[148:151], a[212:215], v[60:63], v[148:151]
v_mul_f32 v49, v49, v34
v_mfma_f32_16x16x32_bf16 v[88:91], a[216:219], v[52:55], v[88:91]
v_mfma_f32_16x16x32_bf16 v[120:123], a[216:219], v[56:59], v[120:123]
v_mul_f32 v50, v50, v34
v_mfma_f32_16x16x32_bf16 v[152:155], a[216:219], v[60:63], v[152:155]
v_mul_f32 v51, v51, v34
v_mfma_f32_16x16x32_bf16 v[92:95], a[220:223], v[52:55], v[92:95]
ds_read_b128 v[52:55], v18 offset:32768
v_cvt_pk_bf16_f32 v44, v44, v45
v_mfma_f32_16x16x32_bf16 v[124:127], a[220:223], v[56:59], v[124:127]
buffer_load_dwordx4 v40, s[44:47], s73 offen offset:2048 lds
ds_read_b128 v[56:59], v18 offset:33792
v_mfma_f32_16x16x32_bf16 v[156:159], a[220:223], v[60:63], v[156:159]
ds_read_b128 v[60:63], v18 offset:34816
v_cvt_pk_bf16_f32 v45, v46, v47
v_mfma_f32_16x16x32_bf16 v[160:163], a[192:195], a[224:227], v[160:163]
v_cvt_pk_bf16_f32 v46, v48, v49
v_mfma_f32_16x16x32_bf16 v[192:195], a[192:195], a[228:231], v[192:195]
v_cvt_pk_bf16_f32 v47, v50, v51
v_mfma_f32_16x16x32_bf16 v[224:227], a[192:195], a[232:235], v[224:227]
ds_read_b64_tr_b16 a[192:193], v11
v_mfma_f32_16x16x32_bf16 v[164:167], a[196:199], a[224:227], v[164:167]
ds_read_b64_tr_b16 a[194:195], v11 offset:1024
s_mov_b32 s71, 262144
v_mfma_f32_16x16x32_bf16 v[196:199], a[196:199], a[228:231], v[196:199]
buffer_load_dwordx4 v41, s[44:47], s73 offen offset:3072 lds
buffer_store_dwordx4 v[44:47], v38, s[32:35], s71 offen sc1
v_mfma_f32_16x16x32_bf16 v[228:231], a[196:199], a[232:235], v[228:231]
s_add_u32 m0, s56, 114944
ds_read_b64_tr_b16 a[196:197], v12
v_mfma_f32_16x16x32_bf16 v[168:171], a[200:203], a[224:227], v[168:171]
ds_read_b64_tr_b16 a[198:199], v12 offset:1024
v_accvgpr_read_b32 v44, a72
v_mfma_f32_16x16x32_bf16 v[200:203], a[200:203], a[228:231], v[200:203]
v_accvgpr_read_b32 v45, a73
v_mfma_f32_16x16x32_bf16 v[232:235], a[200:203], a[232:235], v[232:235]
ds_read_b64_tr_b16 a[200:201], v11 offset:64
v_accvgpr_read_b32 v46, a74
v_mfma_f32_16x16x32_bf16 v[172:175], a[204:207], a[224:227], v[172:175]
ds_read_b64_tr_b16 a[202:203], v11 offset:1088
v_accvgpr_read_b32 v47, a75
v_mfma_f32_16x16x32_bf16 v[204:207], a[204:207], a[228:231], v[204:207]
buffer_load_dwordx4 v2, s[16:19], s74 offen lds
v_mfma_f32_16x16x32_bf16 v[236:239], a[204:207], a[232:235], v[236:239]
ds_read_b64_tr_b16 a[204:205], v12 offset:64
v_accvgpr_read_b32 v48, a76
v_mfma_f32_16x16x32_bf16 v[176:179], a[208:211], a[224:227], v[176:179]
ds_read_b64_tr_b16 a[206:207], v12 offset:1088
v_accvgpr_read_b32 v49, a77
v_mfma_f32_16x16x32_bf16 v[208:211], a[208:211], a[228:231], v[208:211]
v_accvgpr_read_b32 v50, a78
v_mfma_f32_16x16x32_bf16 v[240:243], a[208:211], a[232:235], v[240:243]
ds_read_b64_tr_b16 a[208:209], v11 offset:128
v_mfma_f32_16x16x32_bf16 v[180:183], a[212:215], a[224:227], v[180:183]
ds_read_b64_tr_b16 a[210:211], v11 offset:1152
v_accvgpr_read_b32 v51, a79
v_mfma_f32_16x16x32_bf16 v[212:215], a[212:215], a[228:231], v[212:215]
buffer_load_dwordx4 v3, s[16:19], s74 offen offset:1024 lds
v_mul_f32 v44, v44, v34
v_mfma_f32_16x16x32_bf16 v[244:247], a[212:215], a[232:235], v[244:247]
ds_read_b64_tr_b16 a[212:213], v12 offset:128
v_mul_f32 v45, v45, v34
v_mfma_f32_16x16x32_bf16 v[184:187], a[216:219], a[224:227], v[184:187]
ds_read_b64_tr_b16 a[214:215], v12 offset:1152
v_mfma_f32_16x16x32_bf16 v[216:219], a[216:219], a[228:231], v[216:219]
v_mul_f32 v46, v46, v34
v_mfma_f32_16x16x32_bf16 v[248:251], a[216:219], a[232:235], v[248:251]
ds_read_b64_tr_b16 a[216:217], v11 offset:192
v_mul_f32 v47, v47, v34
v_mfma_f32_16x16x32_bf16 v[188:191], a[220:223], a[224:227], v[188:191]
ds_read_b64_tr_b16 a[218:219], v11 offset:1216
v_mul_f32 v48, v48, v34
v_mfma_f32_16x16x32_bf16 v[220:223], a[220:223], a[228:231], v[220:223]
buffer_load_dwordx4 v4, s[16:19], s74 offen offset:2048 lds
v_mfma_f32_16x16x32_bf16 v[252:255], a[220:223], a[232:235], v[252:255]
ds_read_b64_tr_b16 a[220:221], v12 offset:192
v_mul_f32 v49, v49, v34
s_waitcnt lgkmcnt(4)
v_mfma_f32_16x16x32_bf16 v[64:67], a[192:195], v[52:55], v[64:67]
ds_read_b64_tr_b16 a[222:223], v12 offset:1216
v_mul_f32 v50, v50, v34
v_mfma_f32_16x16x32_bf16 v[96:99], a[192:195], v[56:59], v[96:99]
ds_read_b128 a[224:227], v18 offset:35840
v_mfma_f32_16x16x32_bf16 v[128:131], a[192:195], v[60:63], v[128:131]
ds_read_b128 a[228:231], v18 offset:36864
v_mul_f32 v51, v51, v34
v_mfma_f32_16x16x32_bf16 v[68:71], a[196:199], v[52:55], v[68:71]
ds_read_b128 a[232:235], v18 offset:37888
v_cvt_pk_bf16_f32 v44, v44, v45
v_mfma_f32_16x16x32_bf16 v[100:103], a[196:199], v[56:59], v[100:103]
s_add_u32 s73, s73, 262144
v_cvt_pk_bf16_f32 v45, v46, v47
v_mfma_f32_16x16x32_bf16 v[132:135], a[196:199], v[60:63], v[132:135]
s_add_u32 s74, s74, 64
v_mfma_f32_16x16x32_bf16 v[72:75], a[200:203], v[52:55], v[72:75]
s_and_b32 s73, s73, 4194303
v_cvt_pk_bf16_f32 v46, v48, v49
v_mfma_f32_16x16x32_bf16 v[104:107], a[200:203], v[56:59], v[104:107]
s_and_b32 s74, s74, 1023
v_cvt_pk_bf16_f32 v47, v50, v51
v_mfma_f32_16x16x32_bf16 v[136:139], a[200:203], v[60:63], v[136:139]
s_waitcnt vmcnt(9) lgkmcnt(0)
s_barrier
s_mov_b32 s71, 262144
v_mfma_f32_16x16x32_bf16 v[76:79], a[204:207], v[52:55], v[76:79]
s_add_u32 m0, s57, 131072
v_mfma_f32_16x16x32_bf16 v[108:111], a[204:207], v[56:59], v[108:111]
buffer_load_dwordx4 v5, s[44:47], s73 offen lds
buffer_store_dwordx4 v[44:47], v38, s[32:35], s71 offen offset:1024 sc1
v_mfma_f32_16x16x32_bf16 v[140:143], a[204:207], v[60:63], v[140:143]
s_nop 0
v_accvgpr_read_b32 v44, a80
v_mfma_f32_16x16x32_bf16 v[80:83], a[208:211], v[52:55], v[80:83]
v_accvgpr_read_b32 v45, a81
v_mfma_f32_16x16x32_bf16 v[112:115], a[208:211], v[56:59], v[112:115]
v_mfma_f32_16x16x32_bf16 v[144:147], a[208:211], v[60:63], v[144:147]
v_accvgpr_read_b32 v46, a82
v_mfma_f32_16x16x32_bf16 v[84:87], a[212:215], v[52:55], v[84:87]
v_accvgpr_read_b32 v47, a83
v_mfma_f32_16x16x32_bf16 v[116:119], a[212:215], v[56:59], v[116:119]
buffer_load_dwordx4 v39, s[44:47], s73 offen offset:1024 lds
v_accvgpr_read_b32 v48, a84
v_mfma_f32_16x16x32_bf16 v[148:151], a[212:215], v[60:63], v[148:151]
v_mfma_f32_16x16x32_bf16 v[88:91], a[216:219], v[52:55], v[88:91]
v_accvgpr_read_b32 v49, a85
v_mfma_f32_16x16x32_bf16 v[120:123], a[216:219], v[56:59], v[120:123]
v_accvgpr_read_b32 v50, a86
v_mfma_f32_16x16x32_bf16 v[152:155], a[216:219], v[60:63], v[152:155]
v_accvgpr_read_b32 v51, a87
v_mfma_f32_16x16x32_bf16 v[92:95], a[220:223], v[52:55], v[92:95]
ds_read_b128 v[52:55], v17
v_mfma_f32_16x16x32_bf16 v[124:127], a[220:223], v[56:59], v[124:127]
buffer_load_dwordx4 v40, s[44:47], s73 offen offset:2048 lds
ds_read_b128 v[56:59], v17 offset:1024
v_mfma_f32_16x16x32_bf16 v[156:159], a[220:223], v[60:63], v[156:159]
ds_read_b128 v[60:63], v17 offset:2048
v_mul_f32 v44, v44, v34
v_mfma_f32_16x16x32_bf16 v[160:163], a[192:195], a[224:227], v[160:163]
v_mul_f32 v45, v45, v34
v_mfma_f32_16x16x32_bf16 v[192:195], a[192:195], a[228:231], v[192:195]
v_mul_f32 v46, v46, v34
v_mfma_f32_16x16x32_bf16 v[224:227], a[192:195], a[232:235], v[224:227]
ds_read_b64_tr_b16 a[192:193], v13
v_mul_f32 v47, v47, v34
v_mfma_f32_16x16x32_bf16 v[164:167], a[196:199], a[224:227], v[164:167]
ds_read_b64_tr_b16 a[194:195], v13 offset:1024
v_mul_f32 v48, v48, v34
v_mfma_f32_16x16x32_bf16 v[196:199], a[196:199], a[228:231], v[196:199]
buffer_load_dwordx4 v41, s[44:47], s73 offen offset:3072 lds
v_mul_f32 v49, v49, v34
v_mfma_f32_16x16x32_bf16 v[228:231], a[196:199], a[232:235], v[228:231]
s_add_u32 m0, s56, 147712
ds_read_b64_tr_b16 a[196:197], v14
v_mfma_f32_16x16x32_bf16 v[168:171], a[200:203], a[224:227], v[168:171]
ds_read_b64_tr_b16 a[198:199], v14 offset:1024
v_mul_f32 v50, v50, v34
v_mfma_f32_16x16x32_bf16 v[200:203], a[200:203], a[228:231], v[200:203]
v_mul_f32 v51, v51, v34
v_mfma_f32_16x16x32_bf16 v[232:235], a[200:203], a[232:235], v[232:235]
ds_read_b64_tr_b16 a[200:201], v13 offset:64
v_cvt_pk_bf16_f32 v44, v44, v45
v_mfma_f32_16x16x32_bf16 v[172:175], a[204:207], a[224:227], v[172:175]
ds_read_b64_tr_b16 a[202:203], v13 offset:1088
v_mfma_f32_16x16x32_bf16 v[204:207], a[204:207], a[228:231], v[204:207]
buffer_load_dwordx4 v2, s[16:19], s74 offen lds
v_cvt_pk_bf16_f32 v45, v46, v47
v_mfma_f32_16x16x32_bf16 v[236:239], a[204:207], a[232:235], v[236:239]
ds_read_b64_tr_b16 a[204:205], v14 offset:64
v_cvt_pk_bf16_f32 v46, v48, v49
v_mfma_f32_16x16x32_bf16 v[176:179], a[208:211], a[224:227], v[176:179]
ds_read_b64_tr_b16 a[206:207], v14 offset:1088
v_cvt_pk_bf16_f32 v47, v50, v51
v_mfma_f32_16x16x32_bf16 v[208:211], a[208:211], a[228:231], v[208:211]
v_mfma_f32_16x16x32_bf16 v[240:243], a[208:211], a[232:235], v[240:243]
ds_read_b64_tr_b16 a[208:209], v13 offset:128
s_mov_b32 s71, 262144
v_mfma_f32_16x16x32_bf16 v[180:183], a[212:215], a[224:227], v[180:183]
buffer_store_dwordx4 v[44:47], v38, s[32:35], s71 offen offset:2048 sc1
ds_read_b64_tr_b16 a[210:211], v13 offset:1152
v_mfma_f32_16x16x32_bf16 v[212:215], a[212:215], a[228:231], v[212:215]
buffer_load_dwordx4 v3, s[16:19], s74 offen offset:1024 lds
v_accvgpr_read_b32 v44, a88
v_mfma_f32_16x16x32_bf16 v[244:247], a[212:215], a[232:235], v[244:247]
ds_read_b64_tr_b16 a[212:213], v14 offset:128
v_mfma_f32_16x16x32_bf16 v[184:187], a[216:219], a[224:227], v[184:187]
ds_read_b64_tr_b16 a[214:215], v14 offset:1152
v_accvgpr_read_b32 v45, a89
v_mfma_f32_16x16x32_bf16 v[216:219], a[216:219], a[228:231], v[216:219]
v_accvgpr_read_b32 v46, a90
v_mfma_f32_16x16x32_bf16 v[248:251], a[216:219], a[232:235], v[248:251]
ds_read_b64_tr_b16 a[216:217], v13 offset:192
v_accvgpr_read_b32 v47, a91
v_mfma_f32_16x16x32_bf16 v[188:191], a[220:223], a[224:227], v[188:191]
ds_read_b64_tr_b16 a[218:219], v13 offset:1216
v_mfma_f32_16x16x32_bf16 v[220:223], a[220:223], a[228:231], v[220:223]
buffer_load_dwordx4 v4, s[16:19], s74 offen offset:2048 lds
v_accvgpr_read_b32 v48, a92
v_mfma_f32_16x16x32_bf16 v[252:255], a[220:223], a[232:235], v[252:255]
ds_read_b64_tr_b16 a[220:221], v14 offset:192
v_accvgpr_read_b32 v49, a93
s_waitcnt lgkmcnt(3)
v_mfma_f32_16x16x32_bf16 v[64:67], a[192:195], v[52:55], v[64:67]
ds_read_b64_tr_b16 a[222:223], v14 offset:1216
v_mfma_f32_16x16x32_bf16 v[96:99], a[192:195], v[56:59], v[96:99]
ds_read_b128 a[224:227], v17 offset:3072
v_accvgpr_read_b32 v50, a94
v_mfma_f32_16x16x32_bf16 v[128:131], a[192:195], v[60:63], v[128:131]
ds_read_b128 a[228:231], v17 offset:4096
v_accvgpr_read_b32 v51, a95
v_mfma_f32_16x16x32_bf16 v[68:71], a[196:199], v[52:55], v[68:71]
ds_read_b128 a[232:235], v17 offset:5120
v_mul_f32 v44, v44, v34
v_mfma_f32_16x16x32_bf16 v[100:103], a[196:199], v[56:59], v[100:103]
s_add_u32 s73, s73, 262144
v_mfma_f32_16x16x32_bf16 v[132:135], a[196:199], v[60:63], v[132:135]
s_add_u32 s74, s74, 64
v_mul_f32 v45, v45, v34
v_mfma_f32_16x16x32_bf16 v[72:75], a[200:203], v[52:55], v[72:75]
s_and_b32 s73, s73, 4194303
v_mul_f32 v46, v46, v34
v_mfma_f32_16x16x32_bf16 v[104:107], a[200:203], v[56:59], v[104:107]
s_and_b32 s74, s74, 1023
v_mul_f32 v47, v47, v34
v_mfma_f32_16x16x32_bf16 v[136:139], a[200:203], v[60:63], v[136:139]
s_waitcnt vmcnt(9) lgkmcnt(0)
s_barrier
v_mfma_f32_16x16x32_bf16 v[76:79], a[204:207], v[52:55], v[76:79]
s_add_u32 m0, s57, 32768
v_mul_f32 v48, v48, v34
v_mfma_f32_16x16x32_bf16 v[108:111], a[204:207], v[56:59], v[108:111]
buffer_load_dwordx4 v5, s[44:47], s73 offen lds
v_mul_f32 v49, v49, v34
v_mfma_f32_16x16x32_bf16 v[140:143], a[204:207], v[60:63], v[140:143]
v_mul_f32 v50, v50, v34
v_mfma_f32_16x16x32_bf16 v[80:83], a[208:211], v[52:55], v[80:83]
v_mfma_f32_16x16x32_bf16 v[112:115], a[208:211], v[56:59], v[112:115]
v_mul_f32 v51, v51, v34
v_mfma_f32_16x16x32_bf16 v[144:147], a[208:211], v[60:63], v[144:147]
v_cvt_pk_bf16_f32 v44, v44, v45
v_mfma_f32_16x16x32_bf16 v[84:87], a[212:215], v[52:55], v[84:87]
v_cvt_pk_bf16_f32 v45, v46, v47
v_mfma_f32_16x16x32_bf16 v[116:119], a[212:215], v[56:59], v[116:119]
buffer_load_dwordx4 v39, s[44:47], s73 offen offset:1024 lds
v_mfma_f32_16x16x32_bf16 v[148:151], a[212:215], v[60:63], v[148:151]
v_cvt_pk_bf16_f32 v46, v48, v49
v_mfma_f32_16x16x32_bf16 v[88:91], a[216:219], v[52:55], v[88:91]
v_cvt_pk_bf16_f32 v47, v50, v51
v_mfma_f32_16x16x32_bf16 v[120:123], a[216:219], v[56:59], v[120:123]
s_mov_b32 s71, 262144
v_mfma_f32_16x16x32_bf16 v[152:155], a[216:219], v[60:63], v[152:155]
v_mfma_f32_16x16x32_bf16 v[92:95], a[220:223], v[52:55], v[92:95]
buffer_store_dwordx4 v[44:47], v38, s[32:35], s71 offen offset:3072 sc1
ds_read_b128 v[52:55], v18
v_mfma_f32_16x16x32_bf16 v[124:127], a[220:223], v[56:59], v[124:127]
buffer_load_dwordx4 v40, s[44:47], s73 offen offset:2048 lds
ds_read_b128 v[56:59], v18 offset:1024
v_mfma_f32_16x16x32_bf16 v[156:159], a[220:223], v[60:63], v[156:159]
ds_read_b128 v[60:63], v18 offset:2048
v_accvgpr_read_b32 v44, a96
v_mfma_f32_16x16x32_bf16 v[160:163], a[192:195], a[224:227], v[160:163]
v_accvgpr_read_b32 v45, a97
v_mfma_f32_16x16x32_bf16 v[192:195], a[192:195], a[228:231], v[192:195]
v_accvgpr_read_b32 v46, a98
v_mfma_f32_16x16x32_bf16 v[224:227], a[192:195], a[232:235], v[224:227]
ds_read_b64_tr_b16 a[192:193], v15
v_accvgpr_read_b32 v47, a99
v_mfma_f32_16x16x32_bf16 v[164:167], a[196:199], a[224:227], v[164:167]
ds_read_b64_tr_b16 a[194:195], v15 offset:1024
v_accvgpr_read_b32 v48, a100
v_mfma_f32_16x16x32_bf16 v[196:199], a[196:199], a[228:231], v[196:199]
buffer_load_dwordx4 v41, s[44:47], s73 offen offset:3072 lds
v_mfma_f32_16x16x32_bf16 v[228:231], a[196:199], a[232:235], v[228:231]
s_add_u32 m0, s56, 49408
ds_read_b64_tr_b16 a[196:197], v16
v_mfma_f32_16x16x32_bf16 v[168:171], a[200:203], a[224:227], v[168:171]
ds_read_b64_tr_b16 a[198:199], v16 offset:1024
v_accvgpr_read_b32 v49, a101
v_mfma_f32_16x16x32_bf16 v[200:203], a[200:203], a[228:231], v[200:203]
v_accvgpr_read_b32 v50, a102
v_mfma_f32_16x16x32_bf16 v[232:235], a[200:203], a[232:235], v[232:235]
ds_read_b64_tr_b16 a[200:201], v15 offset:64
v_accvgpr_read_b32 v51, a103
v_mfma_f32_16x16x32_bf16 v[172:175], a[204:207], a[224:227], v[172:175]
ds_read_b64_tr_b16 a[202:203], v15 offset:1088
v_mul_f32 v44, v44, v35
v_mfma_f32_16x16x32_bf16 v[204:207], a[204:207], a[228:231], v[204:207]
buffer_load_dwordx4 v2, s[16:19], s74 offen lds
v_mul_f32 v45, v45, v35
v_mfma_f32_16x16x32_bf16 v[236:239], a[204:207], a[232:235], v[236:239]
ds_read_b64_tr_b16 a[204:205], v16 offset:64
v_mul_f32 v46, v46, v35
v_mfma_f32_16x16x32_bf16 v[176:179], a[208:211], a[224:227], v[176:179]
ds_read_b64_tr_b16 a[206:207], v16 offset:1088
v_mfma_f32_16x16x32_bf16 v[208:211], a[208:211], a[228:231], v[208:211]
v_mul_f32 v47, v47, v35
v_mfma_f32_16x16x32_bf16 v[240:243], a[208:211], a[232:235], v[240:243]
ds_read_b64_tr_b16 a[208:209], v15 offset:128
v_mul_f32 v48, v48, v35
v_mfma_f32_16x16x32_bf16 v[180:183], a[212:215], a[224:227], v[180:183]
ds_read_b64_tr_b16 a[210:211], v15 offset:1152
v_mul_f32 v49, v49, v35
v_mfma_f32_16x16x32_bf16 v[212:215], a[212:215], a[228:231], v[212:215]
buffer_load_dwordx4 v3, s[16:19], s74 offen offset:1024 lds
v_mfma_f32_16x16x32_bf16 v[244:247], a[212:215], a[232:235], v[244:247]
ds_read_b64_tr_b16 a[212:213], v16 offset:128
v_mul_f32 v50, v50, v35
v_mfma_f32_16x16x32_bf16 v[184:187], a[216:219], a[224:227], v[184:187]
ds_read_b64_tr_b16 a[214:215], v16 offset:1152
v_mul_f32 v51, v51, v35
v_mfma_f32_16x16x32_bf16 v[216:219], a[216:219], a[228:231], v[216:219]
v_cvt_pk_bf16_f32 v44, v44, v45
v_mfma_f32_16x16x32_bf16 v[248:251], a[216:219], a[232:235], v[248:251]
ds_read_b64_tr_b16 a[216:217], v15 offset:192
v_mfma_f32_16x16x32_bf16 v[188:191], a[220:223], a[224:227], v[188:191]
ds_read_b64_tr_b16 a[218:219], v15 offset:1216
v_cvt_pk_bf16_f32 v45, v46, v47
v_mfma_f32_16x16x32_bf16 v[220:223], a[220:223], a[228:231], v[220:223]
buffer_load_dwordx4 v4, s[16:19], s74 offen offset:2048 lds
v_cvt_pk_bf16_f32 v46, v48, v49
v_mfma_f32_16x16x32_bf16 v[252:255], a[220:223], a[232:235], v[252:255]
ds_read_b64_tr_b16 a[220:221], v16 offset:192
s_waitcnt lgkmcnt(4)
v_mfma_f32_16x16x32_bf16 v[64:67], a[192:195], v[52:55], v[64:67]
ds_read_b64_tr_b16 a[222:223], v16 offset:1216
v_cvt_pk_bf16_f32 v47, v50, v51
v_mfma_f32_16x16x32_bf16 v[96:99], a[192:195], v[56:59], v[96:99]
ds_read_b128 a[224:227], v18 offset:3072
s_mov_b32 s71, 393216
v_mfma_f32_16x16x32_bf16 v[128:131], a[192:195], v[60:63], v[128:131]
buffer_store_dwordx4 v[44:47], v38, s[32:35], s71 offen sc1
ds_read_b128 a[228:231], v18 offset:4096
v_mfma_f32_16x16x32_bf16 v[68:71], a[196:199], v[52:55], v[68:71]
ds_read_b128 a[232:235], v18 offset:5120
v_mfma_f32_16x16x32_bf16 v[100:103], a[196:199], v[56:59], v[100:103]
s_add_u32 s73, s73, 262144
v_accvgpr_read_b32 v44, a104
v_mfma_f32_16x16x32_bf16 v[132:135], a[196:199], v[60:63], v[132:135]
s_add_u32 s74, s74, 64
v_accvgpr_read_b32 v45, a105
v_mfma_f32_16x16x32_bf16 v[72:75], a[200:203], v[52:55], v[72:75]
s_and_b32 s73, s73, 4194303
v_accvgpr_read_b32 v46, a106
v_mfma_f32_16x16x32_bf16 v[104:107], a[200:203], v[56:59], v[104:107]
s_and_b32 s74, s74, 1023
v_mfma_f32_16x16x32_bf16 v[136:139], a[200:203], v[60:63], v[136:139]
s_waitcnt vmcnt(9) lgkmcnt(0)
s_barrier
v_accvgpr_read_b32 v47, a107
v_mfma_f32_16x16x32_bf16 v[76:79], a[204:207], v[52:55], v[76:79]
s_add_u32 m0, s57, 98304
v_accvgpr_read_b32 v48, a108
v_mfma_f32_16x16x32_bf16 v[108:111], a[204:207], v[56:59], v[108:111]
buffer_load_dwordx4 v5, s[44:47], s73 offen lds
v_accvgpr_read_b32 v49, a109
v_mfma_f32_16x16x32_bf16 v[140:143], a[204:207], v[60:63], v[140:143]
v_mfma_f32_16x16x32_bf16 v[80:83], a[208:211], v[52:55], v[80:83]
v_accvgpr_read_b32 v50, a110
v_mfma_f32_16x16x32_bf16 v[112:115], a[208:211], v[56:59], v[112:115]
v_accvgpr_read_b32 v51, a111
v_mfma_f32_16x16x32_bf16 v[144:147], a[208:211], v[60:63], v[144:147]
v_mul_f32 v44, v44, v35
v_mfma_f32_16x16x32_bf16 v[84:87], a[212:215], v[52:55], v[84:87]
v_mfma_f32_16x16x32_bf16 v[116:119], a[212:215], v[56:59], v[116:119]
buffer_load_dwordx4 v39, s[44:47], s73 offen offset:1024 lds
v_mul_f32 v45, v45, v35
v_mfma_f32_16x16x32_bf16 v[148:151], a[212:215], v[60:63], v[148:151]
v_mul_f32 v46, v46, v35
v_mfma_f32_16x16x32_bf16 v[88:91], a[216:219], v[52:55], v[88:91]
v_mul_f32 v47, v47, v35
v_mfma_f32_16x16x32_bf16 v[120:123], a[216:219], v[56:59], v[120:123]
v_mfma_f32_16x16x32_bf16 v[152:155], a[216:219], v[60:63], v[152:155]
v_mul_f32 v48, v48, v35
v_mfma_f32_16x16x32_bf16 v[92:95], a[220:223], v[52:55], v[92:95]
ds_read_b128 v[52:55], v18 offset:32768
v_mul_f32 v49, v49, v35
v_mfma_f32_16x16x32_bf16 v[124:127], a[220:223], v[56:59], v[124:127]
buffer_load_dwordx4 v40, s[44:47], s73 offen offset:2048 lds
ds_read_b128 v[56:59], v18 offset:33792
v_mfma_f32_16x16x32_bf16 v[156:159], a[220:223], v[60:63], v[156:159]
ds_read_b128 v[60:63], v18 offset:34816
v_mul_f32 v50, v50, v35
v_mfma_f32_16x16x32_bf16 v[160:163], a[192:195], a[224:227], v[160:163]
v_mul_f32 v51, v51, v35
v_mfma_f32_16x16x32_bf16 v[192:195], a[192:195], a[228:231], v[192:195]
v_cvt_pk_bf16_f32 v44, v44, v45
v_mfma_f32_16x16x32_bf16 v[224:227], a[192:195], a[232:235], v[224:227]
ds_read_b64_tr_b16 a[192:193], v11
v_cvt_pk_bf16_f32 v45, v46, v47
v_mfma_f32_16x16x32_bf16 v[164:167], a[196:199], a[224:227], v[164:167]
ds_read_b64_tr_b16 a[194:195], v11 offset:1024
v_mfma_f32_16x16x32_bf16 v[196:199], a[196:199], a[228:231], v[196:199]
buffer_load_dwordx4 v41, s[44:47], s73 offen offset:3072 lds
v_cvt_pk_bf16_f32 v46, v48, v49
v_mfma_f32_16x16x32_bf16 v[228:231], a[196:199], a[232:235], v[228:231]
s_add_u32 m0, s56, 114944
ds_read_b64_tr_b16 a[196:197], v12
v_mfma_f32_16x16x32_bf16 v[168:171], a[200:203], a[224:227], v[168:171]
ds_read_b64_tr_b16 a[198:199], v12 offset:1024
v_cvt_pk_bf16_f32 v47, v50, v51
v_mfma_f32_16x16x32_bf16 v[200:203], a[200:203], a[228:231], v[200:203]
s_mov_b32 s71, 393216
v_mfma_f32_16x16x32_bf16 v[232:235], a[200:203], a[232:235], v[232:235]
buffer_store_dwordx4 v[44:47], v38, s[32:35], s71 offen offset:1024 sc1
ds_read_b64_tr_b16 a[200:201], v11 offset:64
v_mfma_f32_16x16x32_bf16 v[172:175], a[204:207], a[224:227], v[172:175]
ds_read_b64_tr_b16 a[202:203], v11 offset:1088
v_accvgpr_read_b32 v44, a112
v_mfma_f32_16x16x32_bf16 v[204:207], a[204:207], a[228:231], v[204:207]
buffer_load_dwordx4 v2, s[16:19], s74 offen lds
v_accvgpr_read_b32 v45, a113
v_mfma_f32_16x16x32_bf16 v[236:239], a[204:207], a[232:235], v[236:239]
ds_read_b64_tr_b16 a[204:205], v12 offset:64
v_mfma_f32_16x16x32_bf16 v[176:179], a[208:211], a[224:227], v[176:179]
ds_read_b64_tr_b16 a[206:207], v12 offset:1088
v_accvgpr_read_b32 v46, a114
v_mfma_f32_16x16x32_bf16 v[208:211], a[208:211], a[228:231], v[208:211]
v_accvgpr_read_b32 v47, a115
v_mfma_f32_16x16x32_bf16 v[240:243], a[208:211], a[232:235], v[240:243]
ds_read_b64_tr_b16 a[208:209], v11 offset:128
v_accvgpr_read_b32 v48, a116
v_mfma_f32_16x16x32_bf16 v[180:183], a[212:215], a[224:227], v[180:183]
ds_read_b64_tr_b16 a[210:211], v11 offset:1152
v_mfma_f32_16x16x32_bf16 v[212:215], a[212:215], a[228:231], v[212:215]
buffer_load_dwordx4 v3, s[16:19], s74 offen offset:1024 lds
v_accvgpr_read_b32 v49, a117
v_mfma_f32_16x16x32_bf16 v[244:247], a[212:215], a[232:235], v[244:247]
ds_read_b64_tr_b16 a[212:213], v12 offset:128
v_accvgpr_read_b32 v50, a118
v_mfma_f32_16x16x32_bf16 v[184:187], a[216:219], a[224:227], v[184:187]
ds_read_b64_tr_b16 a[214:215], v12 offset:1152
v_accvgpr_read_b32 v51, a119
v_mfma_f32_16x16x32_bf16 v[216:219], a[216:219], a[228:231], v[216:219]
v_mfma_f32_16x16x32_bf16 v[248:251], a[216:219], a[232:235], v[248:251]
ds_read_b64_tr_b16 a[216:217], v11 offset:192
v_mul_f32 v44, v44, v35
v_mfma_f32_16x16x32_bf16 v[188:191], a[220:223], a[224:227], v[188:191]
ds_read_b64_tr_b16 a[218:219], v11 offset:1216
v_mul_f32 v45, v45, v35
v_mfma_f32_16x16x32_bf16 v[220:223], a[220:223], a[228:231], v[220:223]
buffer_load_dwordx4 v4, s[16:19], s74 offen offset:2048 lds
v_mfma_f32_16x16x32_bf16 v[252:255], a[220:223], a[232:235], v[252:255]
ds_read_b64_tr_b16 a[220:221], v12 offset:192
v_mul_f32 v46, v46, v35
s_waitcnt lgkmcnt(4)
v_mfma_f32_16x16x32_bf16 v[64:67], a[192:195], v[52:55], v[64:67]
ds_read_b64_tr_b16 a[222:223], v12 offset:1216
v_mul_f32 v47, v47, v35
v_mfma_f32_16x16x32_bf16 v[96:99], a[192:195], v[56:59], v[96:99]
ds_read_b128 a[224:227], v18 offset:35840
v_mul_f32 v48, v48, v35
v_mfma_f32_16x16x32_bf16 v[128:131], a[192:195], v[60:63], v[128:131]
ds_read_b128 a[228:231], v18 offset:36864
v_mfma_f32_16x16x32_bf16 v[68:71], a[196:199], v[52:55], v[68:71]
ds_read_b128 a[232:235], v18 offset:37888
v_mul_f32 v49, v49, v35
v_mfma_f32_16x16x32_bf16 v[100:103], a[196:199], v[56:59], v[100:103]
s_add_u32 s73, s73, 262144
v_mul_f32 v50, v50, v35
v_mfma_f32_16x16x32_bf16 v[132:135], a[196:199], v[60:63], v[132:135]
s_add_u32 s74, s74, 64
v_mul_f32 v51, v51, v35
v_mfma_f32_16x16x32_bf16 v[72:75], a[200:203], v[52:55], v[72:75]
s_and_b32 s73, s73, 4194303
v_mfma_f32_16x16x32_bf16 v[104:107], a[200:203], v[56:59], v[104:107]
s_and_b32 s74, s74, 1023
v_cvt_pk_bf16_f32 v44, v44, v45
v_mfma_f32_16x16x32_bf16 v[136:139], a[200:203], v[60:63], v[136:139]
s_waitcnt vmcnt(9) lgkmcnt(0)
s_barrier
v_cvt_pk_bf16_f32 v45, v46, v47
v_mfma_f32_16x16x32_bf16 v[76:79], a[204:207], v[52:55], v[76:79]
s_add_u32 m0, s57, 131072
v_cvt_pk_bf16_f32 v46, v48, v49
v_mfma_f32_16x16x32_bf16 v[108:111], a[204:207], v[56:59], v[108:111]
buffer_load_dwordx4 v5, s[44:47], s73 offen lds
v_mfma_f32_16x16x32_bf16 v[140:143], a[204:207], v[60:63], v[140:143]
v_cvt_pk_bf16_f32 v47, v50, v51
v_mfma_f32_16x16x32_bf16 v[80:83], a[208:211], v[52:55], v[80:83]
s_mov_b32 s71, 393216
v_mfma_f32_16x16x32_bf16 v[112:115], a[208:211], v[56:59], v[112:115]
buffer_store_dwordx4 v[44:47], v38, s[32:35], s71 offen offset:2048 sc1
v_mfma_f32_16x16x32_bf16 v[144:147], a[208:211], v[60:63], v[144:147]
v_mfma_f32_16x16x32_bf16 v[84:87], a[212:215], v[52:55], v[84:87]
v_accvgpr_read_b32 v44, a120
v_mfma_f32_16x16x32_bf16 v[116:119], a[212:215], v[56:59], v[116:119]
buffer_load_dwordx4 v39, s[44:47], s73 offen offset:1024 lds
v_accvgpr_read_b32 v45, a121
v_mfma_f32_16x16x32_bf16 v[148:151], a[212:215], v[60:63], v[148:151]
v_accvgpr_read_b32 v46, a122
v_mfma_f32_16x16x32_bf16 v[88:91], a[216:219], v[52:55], v[88:91]
v_mfma_f32_16x16x32_bf16 v[120:123], a[216:219], v[56:59], v[120:123]
v_accvgpr_read_b32 v47, a123
v_mfma_f32_16x16x32_bf16 v[152:155], a[216:219], v[60:63], v[152:155]
v_accvgpr_read_b32 v48, a124
v_mfma_f32_16x16x32_bf16 v[92:95], a[220:223], v[52:55], v[92:95]
ds_read_b128 v[52:55], v17
v_accvgpr_read_b32 v49, a125
v_mfma_f32_16x16x32_bf16 v[124:127], a[220:223], v[56:59], v[124:127]
buffer_load_dwordx4 v40, s[44:47], s73 offen offset:2048 lds
ds_read_b128 v[56:59], v17 offset:1024
v_mfma_f32_16x16x32_bf16 v[156:159], a[220:223], v[60:63], v[156:159]
ds_read_b128 v[60:63], v17 offset:2048
v_accvgpr_read_b32 v50, a126
v_mfma_f32_16x16x32_bf16 v[160:163], a[192:195], a[224:227], v[160:163]
v_accvgpr_read_b32 v51, a127
v_mfma_f32_16x16x32_bf16 v[192:195], a[192:195], a[228:231], v[192:195]
v_mul_f32 v44, v44, v35
v_mfma_f32_16x16x32_bf16 v[224:227], a[192:195], a[232:235], v[224:227]
ds_read_b64_tr_b16 a[192:193], v13
v_mfma_f32_16x16x32_bf16 v[164:167], a[196:199], a[224:227], v[164:167]
ds_read_b64_tr_b16 a[194:195], v13 offset:1024
v_mul_f32 v45, v45, v35
v_mfma_f32_16x16x32_bf16 v[196:199], a[196:199], a[228:231], v[196:199]
buffer_load_dwordx4 v41, s[44:47], s73 offen offset:3072 lds
v_mul_f32 v46, v46, v35
v_mfma_f32_16x16x32_bf16 v[228:231], a[196:199], a[232:235], v[228:231]
s_add_u32 m0, s56, 147712
ds_read_b64_tr_b16 a[196:197], v14
v_mfma_f32_16x16x32_bf16 v[168:171], a[200:203], a[224:227], v[168:171]
ds_read_b64_tr_b16 a[198:199], v14 offset:1024
v_mul_f32 v47, v47, v35
v_mfma_f32_16x16x32_bf16 v[200:203], a[200:203], a[228:231], v[200:203]
v_mul_f32 v48, v48, v35
v_mfma_f32_16x16x32_bf16 v[232:235], a[200:203], a[232:235], v[232:235]
ds_read_b64_tr_b16 a[200:201], v13 offset:64
v_mul_f32 v49, v49, v35
v_mfma_f32_16x16x32_bf16 v[172:175], a[204:207], a[224:227], v[172:175]
ds_read_b64_tr_b16 a[202:203], v13 offset:1088
v_mul_f32 v50, v50, v35
v_mfma_f32_16x16x32_bf16 v[204:207], a[204:207], a[228:231], v[204:207]
buffer_load_dwordx4 v2, s[16:19], s74 offen lds
v_mfma_f32_16x16x32_bf16 v[236:239], a[204:207], a[232:235], v[236:239]
ds_read_b64_tr_b16 a[204:205], v14 offset:64
v_mul_f32 v51, v51, v35
v_mfma_f32_16x16x32_bf16 v[176:179], a[208:211], a[224:227], v[176:179]
ds_read_b64_tr_b16 a[206:207], v14 offset:1088
v_cvt_pk_bf16_f32 v44, v44, v45
v_mfma_f32_16x16x32_bf16 v[208:211], a[208:211], a[228:231], v[208:211]
v_cvt_pk_bf16_f32 v45, v46, v47
v_mfma_f32_16x16x32_bf16 v[240:243], a[208:211], a[232:235], v[240:243]
ds_read_b64_tr_b16 a[208:209], v13 offset:128
v_mfma_f32_16x16x32_bf16 v[180:183], a[212:215], a[224:227], v[180:183]
ds_read_b64_tr_b16 a[210:211], v13 offset:1152
v_cvt_pk_bf16_f32 v46, v48, v49
v_mfma_f32_16x16x32_bf16 v[212:215], a[212:215], a[228:231], v[212:215]
buffer_load_dwordx4 v3, s[16:19], s74 offen offset:1024 lds
v_cvt_pk_bf16_f32 v47, v50, v51
v_mfma_f32_16x16x32_bf16 v[244:247], a[212:215], a[232:235], v[244:247]
ds_read_b64_tr_b16 a[212:213], v14 offset:128
s_mov_b32 s71, 393216
v_mfma_f32_16x16x32_bf16 v[184:187], a[216:219], a[224:227], v[184:187]
ds_read_b64_tr_b16 a[214:215], v14 offset:1152
v_mfma_f32_16x16x32_bf16 v[216:219], a[216:219], a[228:231], v[216:219]
buffer_store_dwordx4 v[44:47], v38, s[32:35], s71 offen offset:3072 sc1
v_mfma_f32_16x16x32_bf16 v[248:251], a[216:219], a[232:235], v[248:251]
ds_read_b64_tr_b16 a[216:217], v13 offset:192
v_accvgpr_read_b32 v44, a128
v_mfma_f32_16x16x32_bf16 v[188:191], a[220:223], a[224:227], v[188:191]
ds_read_b64_tr_b16 a[218:219], v13 offset:1216
v_mfma_f32_16x16x32_bf16 v[220:223], a[220:223], a[228:231], v[220:223]
buffer_load_dwordx4 v4, s[16:19], s74 offen offset:2048 lds
v_accvgpr_read_b32 v45, a129
v_mfma_f32_16x16x32_bf16 v[252:255], a[220:223], a[232:235], v[252:255]
ds_read_b64_tr_b16 a[220:221], v14 offset:192
v_accvgpr_read_b32 v46, a130
s_waitcnt lgkmcnt(4)
v_mfma_f32_16x16x32_bf16 v[64:67], a[192:195], v[52:55], v[64:67]
ds_read_b64_tr_b16 a[222:223], v14 offset:1216
v_accvgpr_read_b32 v47, a131
v_mfma_f32_16x16x32_bf16 v[96:99], a[192:195], v[56:59], v[96:99]
ds_read_b128 a[224:227], v17 offset:3072
v_mfma_f32_16x16x32_bf16 v[128:131], a[192:195], v[60:63], v[128:131]
ds_read_b128 a[228:231], v17 offset:4096
v_accvgpr_read_b32 v48, a132
v_mfma_f32_16x16x32_bf16 v[68:71], a[196:199], v[52:55], v[68:71]
ds_read_b128 a[232:235], v17 offset:5120
v_accvgpr_read_b32 v49, a133
v_mfma_f32_16x16x32_bf16 v[100:103], a[196:199], v[56:59], v[100:103]
s_add_u32 s73, s73, 262144
v_accvgpr_read_b32 v50, a134
v_mfma_f32_16x16x32_bf16 v[132:135], a[196:199], v[60:63], v[132:135]
s_add_u32 s74, s74, 64
v_mfma_f32_16x16x32_bf16 v[72:75], a[200:203], v[52:55], v[72:75]
s_and_b32 s73, s73, 4194303
v_accvgpr_read_b32 v51, a135
v_mfma_f32_16x16x32_bf16 v[104:107], a[200:203], v[56:59], v[104:107]
s_and_b32 s74, s74, 1023
v_mul_f32 v44, v44, v36
v_mfma_f32_16x16x32_bf16 v[136:139], a[200:203], v[60:63], v[136:139]
s_waitcnt vmcnt(9) lgkmcnt(0)
s_barrier
v_mul_f32 v45, v45, v36
v_mfma_f32_16x16x32_bf16 v[76:79], a[204:207], v[52:55], v[76:79]
s_add_u32 m0, s57, 32768
v_mfma_f32_16x16x32_bf16 v[108:111], a[204:207], v[56:59], v[108:111]
buffer_load_dwordx4 v5, s[44:47], s73 offen lds
v_mul_f32 v46, v46, v36
v_mfma_f32_16x16x32_bf16 v[140:143], a[204:207], v[60:63], v[140:143]
v_mul_f32 v47, v47, v36
v_mfma_f32_16x16x32_bf16 v[80:83], a[208:211], v[52:55], v[80:83]
v_mul_f32 v48, v48, v36
v_mfma_f32_16x16x32_bf16 v[112:115], a[208:211], v[56:59], v[112:115]
v_mfma_f32_16x16x32_bf16 v[144:147], a[208:211], v[60:63], v[144:147]
v_mul_f32 v49, v49, v36
v_mfma_f32_16x16x32_bf16 v[84:87], a[212:215], v[52:55], v[84:87]
v_mul_f32 v50, v50, v36
v_mfma_f32_16x16x32_bf16 v[116:119], a[212:215], v[56:59], v[116:119]
buffer_load_dwordx4 v39, s[44:47], s73 offen offset:1024 lds
v_mul_f32 v51, v51, v36
v_mfma_f32_16x16x32_bf16 v[148:151], a[212:215], v[60:63], v[148:151]
v_mfma_f32_16x16x32_bf16 v[88:91], a[216:219], v[52:55], v[88:91]
v_cvt_pk_bf16_f32 v44, v44, v45
v_mfma_f32_16x16x32_bf16 v[120:123], a[216:219], v[56:59], v[120:123]
v_cvt_pk_bf16_f32 v45, v46, v47
v_mfma_f32_16x16x32_bf16 v[152:155], a[216:219], v[60:63], v[152:155]
v_cvt_pk_bf16_f32 v46, v48, v49
v_mfma_f32_16x16x32_bf16 v[92:95], a[220:223], v[52:55], v[92:95]
ds_read_b128 v[52:55], v18
v_mfma_f32_16x16x32_bf16 v[124:127], a[220:223], v[56:59], v[124:127]
buffer_load_dwordx4 v40, s[44:47], s73 offen offset:2048 lds
ds_read_b128 v[56:59], v18 offset:1024
v_mfma_f32_16x16x32_bf16 v[156:159], a[220:223], v[60:63], v[156:159]
ds_read_b128 v[60:63], v18 offset:2048
v_cvt_pk_bf16_f32 v47, v50, v51
v_mfma_f32_16x16x32_bf16 v[160:163], a[192:195], a[224:227], v[160:163]
s_mov_b32 s71, 524288
buffer_store_dwordx4 v[44:47], v38, s[32:35], s71 offen sc1
v_mfma_f32_16x16x32_bf16 v[192:195], a[192:195], a[228:231], v[192:195]
v_mfma_f32_16x16x32_bf16 v[224:227], a[192:195], a[232:235], v[224:227]
ds_read_b64_tr_b16 a[192:193], v15
v_accvgpr_read_b32 v44, a136
v_mfma_f32_16x16x32_bf16 v[164:167], a[196:199], a[224:227], v[164:167]
ds_read_b64_tr_b16 a[194:195], v15 offset:1024
v_accvgpr_read_b32 v45, a137
v_mfma_f32_16x16x32_bf16 v[196:199], a[196:199], a[228:231], v[196:199]
buffer_load_dwordx4 v41, s[44:47], s73 offen offset:3072 lds
v_accvgpr_read_b32 v46, a138
v_mfma_f32_16x16x32_bf16 v[228:231], a[196:199], a[232:235], v[228:231]
s_add_u32 m0, s56, 49408
ds_read_b64_tr_b16 a[196:197], v16
v_mfma_f32_16x16x32_bf16 v[168:171], a[200:203], a[224:227], v[168:171]
ds_read_b64_tr_b16 a[198:199], v16 offset:1024
v_accvgpr_read_b32 v47, a139
v_mfma_f32_16x16x32_bf16 v[200:203], a[200:203], a[228:231], v[200:203]
v_accvgpr_read_b32 v48, a140
v_mfma_f32_16x16x32_bf16 v[232:235], a[200:203], a[232:235], v[232:235]
ds_read_b64_tr_b16 a[200:201], v15 offset:64
v_accvgpr_read_b32 v49, a141
v_mfma_f32_16x16x32_bf16 v[172:175], a[204:207], a[224:227], v[172:175]
ds_read_b64_tr_b16 a[202:203], v15 offset:1088
v_mfma_f32_16x16x32_bf16 v[204:207], a[204:207], a[228:231], v[204:207]
buffer_load_dwordx4 v2, s[16:19], s74 offen lds
v_accvgpr_read_b32 v50, a142
v_mfma_f32_16x16x32_bf16 v[236:239], a[204:207], a[232:235], v[236:239]
ds_read_b64_tr_b16 a[204:205], v16 offset:64
v_accvgpr_read_b32 v51, a143
v_mfma_f32_16x16x32_bf16 v[176:179], a[208:211], a[224:227], v[176:179]
ds_read_b64_tr_b16 a[206:207], v16 offset:1088
v_mul_f32 v44, v44, v36
v_mfma_f32_16x16x32_bf16 v[208:211], a[208:211], a[228:231], v[208:211]
v_mfma_f32_16x16x32_bf16 v[240:243], a[208:211], a[232:235], v[240:243]
ds_read_b64_tr_b16 a[208:209], v15 offset:128
v_mul_f32 v45, v45, v36
v_mfma_f32_16x16x32_bf16 v[180:183], a[212:215], a[224:227], v[180:183]
ds_read_b64_tr_b16 a[210:211], v15 offset:1152
v_mul_f32 v46, v46, v36
v_mfma_f32_16x16x32_bf16 v[212:215], a[212:215], a[228:231], v[212:215]
buffer_load_dwordx4 v3, s[16:19], s74 offen offset:1024 lds
v_mul_f32 v47, v47, v36
v_mfma_f32_16x16x32_bf16 v[244:247], a[212:215], a[232:235], v[244:247]
ds_read_b64_tr_b16 a[212:213], v16 offset:128
v_mfma_f32_16x16x32_bf16 v[184:187], a[216:219], a[224:227], v[184:187]
ds_read_b64_tr_b16 a[214:215], v16 offset:1152
v_mul_f32 v48, v48, v36
v_mfma_f32_16x16x32_bf16 v[216:219], a[216:219], a[228:231], v[216:219]
v_mul_f32 v49, v49, v36
v_mfma_f32_16x16x32_bf16 v[248:251], a[216:219], a[232:235], v[248:251]
ds_read_b64_tr_b16 a[216:217], v15 offset:192
v_mfma_f32_16x16x32_bf16 v[188:191], a[220:223], a[224:227], v[188:191]
ds_read_b64_tr_b16 a[218:219], v15 offset:1216
v_mul_f32 v50, v50, v36
v_mfma_f32_16x16x32_bf16 v[220:223], a[220:223], a[228:231], v[220:223]
buffer_load_dwordx4 v4, s[16:19], s74 offen offset:2048 lds
v_mul_f32 v51, v51, v36
v_mfma_f32_16x16x32_bf16 v[252:255], a[220:223], a[232:235], v[252:255]
ds_read_b64_tr_b16 a[220:221], v16 offset:192
v_cvt_pk_bf16_f32 v44, v44, v45
s_waitcnt lgkmcnt(3)
v_mfma_f32_16x16x32_bf16 v[64:67], a[192:195], v[52:55], v[64:67]
ds_read_b64_tr_b16 a[222:223], v16 offset:1216
v_mfma_f32_16x16x32_bf16 v[96:99], a[192:195], v[56:59], v[96:99]
ds_read_b128 a[224:227], v18 offset:3072
v_cvt_pk_bf16_f32 v45, v46, v47
v_mfma_f32_16x16x32_bf16 v[128:131], a[192:195], v[60:63], v[128:131]
ds_read_b128 a[228:231], v18 offset:4096
v_cvt_pk_bf16_f32 v46, v48, v49
v_mfma_f32_16x16x32_bf16 v[68:71], a[196:199], v[52:55], v[68:71]
ds_read_b128 a[232:235], v18 offset:5120
v_cvt_pk_bf16_f32 v47, v50, v51
v_mfma_f32_16x16x32_bf16 v[100:103], a[196:199], v[56:59], v[100:103]
s_add_u32 s73, s73, 262144
v_mfma_f32_16x16x32_bf16 v[132:135], a[196:199], v[60:63], v[132:135]
s_add_u32 s74, s74, 64
s_mov_b32 s71, 524288
v_mfma_f32_16x16x32_bf16 v[72:75], a[200:203], v[52:55], v[72:75]
buffer_store_dwordx4 v[44:47], v38, s[32:35], s71 offen offset:1024 sc1
s_and_b32 s73, s73, 4194303
v_mfma_f32_16x16x32_bf16 v[104:107], a[200:203], v[56:59], v[104:107]
s_and_b32 s74, s74, 1023
v_accvgpr_read_b32 v44, a144
v_mfma_f32_16x16x32_bf16 v[136:139], a[200:203], v[60:63], v[136:139]
s_waitcnt vmcnt(9) lgkmcnt(0)
s_barrier
v_mfma_f32_16x16x32_bf16 v[76:79], a[204:207], v[52:55], v[76:79]
s_add_u32 m0, s57, 98304
v_accvgpr_read_b32 v45, a145
v_mfma_f32_16x16x32_bf16 v[108:111], a[204:207], v[56:59], v[108:111]
buffer_load_dwordx4 v5, s[44:47], s73 offen lds
v_accvgpr_read_b32 v46, a146
v_mfma_f32_16x16x32_bf16 v[140:143], a[204:207], v[60:63], v[140:143]
v_accvgpr_read_b32 v47, a147
v_mfma_f32_16x16x32_bf16 v[80:83], a[208:211], v[52:55], v[80:83]
v_mfma_f32_16x16x32_bf16 v[112:115], a[208:211], v[56:59], v[112:115]
v_accvgpr_read_b32 v48, a148
v_mfma_f32_16x16x32_bf16 v[144:147], a[208:211], v[60:63], v[144:147]
v_accvgpr_read_b32 v49, a149
v_mfma_f32_16x16x32_bf16 v[84:87], a[212:215], v[52:55], v[84:87]
v_accvgpr_read_b32 v50, a150
v_mfma_f32_16x16x32_bf16 v[116:119], a[212:215], v[56:59], v[116:119]
buffer_load_dwordx4 v39, s[44:47], s73 offen offset:1024 lds
v_mfma_f32_16x16x32_bf16 v[148:151], a[212:215], v[60:63], v[148:151]
v_accvgpr_read_b32 v51, a151
v_mfma_f32_16x16x32_bf16 v[88:91], a[216:219], v[52:55], v[88:91]
v_mul_f32 v44, v44, v36
v_mfma_f32_16x16x32_bf16 v[120:123], a[216:219], v[56:59], v[120:123]
v_mul_f32 v45, v45, v36
v_mfma_f32_16x16x32_bf16 v[152:155], a[216:219], v[60:63], v[152:155]
v_mfma_f32_16x16x32_bf16 v[92:95], a[220:223], v[52:55], v[92:95]
ds_read_b128 v[52:55], v18 offset:32768
v_mul_f32 v46, v46, v36
v_mfma_f32_16x16x32_bf16 v[124:127], a[220:223], v[56:59], v[124:127]
buffer_load_dwordx4 v40, s[44:47], s73 offen offset:2048 lds
ds_read_b128 v[56:59], v18 offset:33792
v_mfma_f32_16x16x32_bf16 v[156:159], a[220:223], v[60:63], v[156:159]
ds_read_b128 v[60:63], v18 offset:34816
v_mul_f32 v47, v47, v36
v_mfma_f32_16x16x32_bf16 v[160:163], a[192:195], a[224:227], v[160:163]
v_mul_f32 v48, v48, v36
v_mfma_f32_16x16x32_bf16 v[192:195], a[192:195], a[228:231], v[192:195]
v_mul_f32 v49, v49, v36
v_mfma_f32_16x16x32_bf16 v[224:227], a[192:195], a[232:235], v[224:227]
ds_read_b64_tr_b16 a[192:193], v11
v_mul_f32 v50, v50, v36
v_mfma_f32_16x16x32_bf16 v[164:167], a[196:199], a[224:227], v[164:167]
ds_read_b64_tr_b16 a[194:195], v11 offset:1024
v_mul_f32 v51, v51, v36
v_mfma_f32_16x16x32_bf16 v[196:199], a[196:199], a[228:231], v[196:199]
buffer_load_dwordx4 v41, s[44:47], s73 offen offset:3072 lds
v_mfma_f32_16x16x32_bf16 v[228:231], a[196:199], a[232:235], v[228:231]
s_add_u32 m0, s56, 114944
ds_read_b64_tr_b16 a[196:197], v12
v_mfma_f32_16x16x32_bf16 v[168:171], a[200:203], a[224:227], v[168:171]
ds_read_b64_tr_b16 a[198:199], v12 offset:1024
v_cvt_pk_bf16_f32 v44, v44, v45
v_mfma_f32_16x16x32_bf16 v[200:203], a[200:203], a[228:231], v[200:203]
v_cvt_pk_bf16_f32 v45, v46, v47
v_mfma_f32_16x16x32_bf16 v[232:235], a[200:203], a[232:235], v[232:235]
ds_read_b64_tr_b16 a[200:201], v11 offset:64
v_cvt_pk_bf16_f32 v46, v48, v49
v_mfma_f32_16x16x32_bf16 v[172:175], a[204:207], a[224:227], v[172:175]
ds_read_b64_tr_b16 a[202:203], v11 offset:1088
v_cvt_pk_bf16_f32 v47, v50, v51
v_mfma_f32_16x16x32_bf16 v[204:207], a[204:207], a[228:231], v[204:207]
buffer_load_dwordx4 v2, s[16:19], s74 offen lds
s_mov_b32 s71, 524288
v_mfma_f32_16x16x32_bf16 v[236:239], a[204:207], a[232:235], v[236:239]
buffer_store_dwordx4 v[44:47], v38, s[32:35], s71 offen offset:2048 sc1
ds_read_b64_tr_b16 a[204:205], v12 offset:64
v_mfma_f32_16x16x32_bf16 v[176:179], a[208:211], a[224:227], v[176:179]
ds_read_b64_tr_b16 a[206:207], v12 offset:1088
v_mfma_f32_16x16x32_bf16 v[208:211], a[208:211], a[228:231], v[208:211]
v_accvgpr_read_b32 v44, a152
v_mfma_f32_16x16x32_bf16 v[240:243], a[208:211], a[232:235], v[240:243]
ds_read_b64_tr_b16 a[208:209], v11 offset:128
v_accvgpr_read_b32 v45, a153
v_mfma_f32_16x16x32_bf16 v[180:183], a[212:215], a[224:227], v[180:183]
ds_read_b64_tr_b16 a[210:211], v11 offset:1152
v_accvgpr_read_b32 v46, a154
v_mfma_f32_16x16x32_bf16 v[212:215], a[212:215], a[228:231], v[212:215]
buffer_load_dwordx4 v3, s[16:19], s74 offen offset:1024 lds
v_mfma_f32_16x16x32_bf16 v[244:247], a[212:215], a[232:235], v[244:247]
ds_read_b64_tr_b16 a[212:213], v12 offset:128
v_accvgpr_read_b32 v47, a155
v_mfma_f32_16x16x32_bf16 v[184:187], a[216:219], a[224:227], v[184:187]
ds_read_b64_tr_b16 a[214:215], v12 offset:1152
v_accvgpr_read_b32 v48, a156
v_mfma_f32_16x16x32_bf16 v[216:219], a[216:219], a[228:231], v[216:219]
v_mfma_f32_16x16x32_bf16 v[248:251], a[216:219], a[232:235], v[248:251]
ds_read_b64_tr_b16 a[216:217], v11 offset:192
v_accvgpr_read_b32 v49, a157
v_mfma_f32_16x16x32_bf16 v[188:191], a[220:223], a[224:227], v[188:191]
ds_read_b64_tr_b16 a[218:219], v11 offset:1216
v_accvgpr_read_b32 v50, a158
v_mfma_f32_16x16x32_bf16 v[220:223], a[220:223], a[228:231], v[220:223]
buffer_load_dwordx4 v4, s[16:19], s74 offen offset:2048 lds
v_accvgpr_read_b32 v51, a159
v_mfma_f32_16x16x32_bf16 v[252:255], a[220:223], a[232:235], v[252:255]
ds_read_b64_tr_b16 a[220:221], v12 offset:192
s_waitcnt lgkmcnt(4)
v_mfma_f32_16x16x32_bf16 v[64:67], a[192:195], v[52:55], v[64:67]
ds_read_b64_tr_b16 a[222:223], v12 offset:1216
v_mul_f32 v44, v44, v36
v_mfma_f32_16x16x32_bf16 v[96:99], a[192:195], v[56:59], v[96:99]
ds_read_b128 a[224:227], v18 offset:35840
v_mul_f32 v45, v45, v36
v_mfma_f32_16x16x32_bf16 v[128:131], a[192:195], v[60:63], v[128:131]
ds_read_b128 a[228:231], v18 offset:36864
v_mul_f32 v46, v46, v36
v_mfma_f32_16x16x32_bf16 v[68:71], a[196:199], v[52:55], v[68:71]
ds_read_b128 a[232:235], v18 offset:37888
v_mfma_f32_16x16x32_bf16 v[100:103], a[196:199], v[56:59], v[100:103]
s_add_u32 s73, s73, 262144
v_mul_f32 v47, v47, v36
v_mfma_f32_16x16x32_bf16 v[132:135], a[196:199], v[60:63], v[132:135]
s_add_u32 s74, s74, 64
v_mul_f32 v48, v48, v36
v_mfma_f32_16x16x32_bf16 v[72:75], a[200:203], v[52:55], v[72:75]
s_and_b32 s73, s73, 4194303
v_mul_f32 v49, v49, v36
v_mfma_f32_16x16x32_bf16 v[104:107], a[200:203], v[56:59], v[104:107]
s_and_b32 s74, s74, 1023
v_mfma_f32_16x16x32_bf16 v[136:139], a[200:203], v[60:63], v[136:139]
s_waitcnt vmcnt(9) lgkmcnt(0)
s_barrier
v_mul_f32 v50, v50, v36
v_mfma_f32_16x16x32_bf16 v[76:79], a[204:207], v[52:55], v[76:79]
s_add_u32 m0, s57, 131072
v_mul_f32 v51, v51, v36
v_mfma_f32_16x16x32_bf16 v[108:111], a[204:207], v[56:59], v[108:111]
buffer_load_dwordx4 v5, s[44:47], s73 offen lds
v_cvt_pk_bf16_f32 v44, v44, v45
v_mfma_f32_16x16x32_bf16 v[140:143], a[204:207], v[60:63], v[140:143]
v_mfma_f32_16x16x32_bf16 v[80:83], a[208:211], v[52:55], v[80:83]
v_cvt_pk_bf16_f32 v45, v46, v47
v_mfma_f32_16x16x32_bf16 v[112:115], a[208:211], v[56:59], v[112:115]
v_cvt_pk_bf16_f32 v46, v48, v49
v_mfma_f32_16x16x32_bf16 v[144:147], a[208:211], v[60:63], v[144:147]
v_cvt_pk_bf16_f32 v47, v50, v51
v_mfma_f32_16x16x32_bf16 v[84:87], a[212:215], v[52:55], v[84:87]
v_mfma_f32_16x16x32_bf16 v[116:119], a[212:215], v[56:59], v[116:119]
buffer_load_dwordx4 v39, s[44:47], s73 offen offset:1024 lds
s_mov_b32 s71, 524288
v_mfma_f32_16x16x32_bf16 v[148:151], a[212:215], v[60:63], v[148:151]
buffer_store_dwordx4 v[44:47], v38, s[32:35], s71 offen offset:3072 sc1
v_mfma_f32_16x16x32_bf16 v[88:91], a[216:219], v[52:55], v[88:91]
s_nop 0
v_accvgpr_read_b32 v44, a160
v_mfma_f32_16x16x32_bf16 v[120:123], a[216:219], v[56:59], v[120:123]
v_mfma_f32_16x16x32_bf16 v[152:155], a[216:219], v[60:63], v[152:155]
v_accvgpr_read_b32 v45, a161
v_mfma_f32_16x16x32_bf16 v[92:95], a[220:223], v[52:55], v[92:95]
ds_read_b128 v[52:55], v17
v_accvgpr_read_b32 v46, a162
v_mfma_f32_16x16x32_bf16 v[124:127], a[220:223], v[56:59], v[124:127]
buffer_load_dwordx4 v40, s[44:47], s73 offen offset:2048 lds
ds_read_b128 v[56:59], v17 offset:1024
v_mfma_f32_16x16x32_bf16 v[156:159], a[220:223], v[60:63], v[156:159]
ds_read_b128 v[60:63], v17 offset:2048
v_accvgpr_read_b32 v47, a163
v_mfma_f32_16x16x32_bf16 v[160:163], a[192:195], a[224:227], v[160:163]
v_accvgpr_read_b32 v48, a164
v_mfma_f32_16x16x32_bf16 v[192:195], a[192:195], a[228:231], v[192:195]
v_accvgpr_read_b32 v49, a165
v_mfma_f32_16x16x32_bf16 v[224:227], a[192:195], a[232:235], v[224:227]
ds_read_b64_tr_b16 a[192:193], v13
v_accvgpr_read_b32 v50, a166
v_mfma_f32_16x16x32_bf16 v[164:167], a[196:199], a[224:227], v[164:167]
ds_read_b64_tr_b16 a[194:195], v13 offset:1024
v_mfma_f32_16x16x32_bf16 v[196:199], a[196:199], a[228:231], v[196:199]
buffer_load_dwordx4 v41, s[44:47], s73 offen offset:3072 lds
v_accvgpr_read_b32 v51, a167
v_mfma_f32_16x16x32_bf16 v[228:231], a[196:199], a[232:235], v[228:231]
s_add_u32 m0, s56, 147712
ds_read_b64_tr_b16 a[196:197], v14
v_mfma_f32_16x16x32_bf16 v[168:171], a[200:203], a[224:227], v[168:171]
ds_read_b64_tr_b16 a[198:199], v14 offset:1024
v_mul_f32 v44, v44, v37
v_mfma_f32_16x16x32_bf16 v[200:203], a[200:203], a[228:231], v[200:203]
v_mul_f32 v45, v45, v37
v_mfma_f32_16x16x32_bf16 v[232:235], a[200:203], a[232:235], v[232:235]
ds_read_b64_tr_b16 a[200:201], v13 offset:64
v_mul_f32 v46, v46, v37
v_mfma_f32_16x16x32_bf16 v[172:175], a[204:207], a[224:227], v[172:175]
ds_read_b64_tr_b16 a[202:203], v13 offset:1088
v_mul_f32 v47, v47, v37
v_mfma_f32_16x16x32_bf16 v[204:207], a[204:207], a[228:231], v[204:207]
buffer_load_dwordx4 v2, s[16:19], s74 offen lds
v_mul_f32 v48, v48, v37
v_mfma_f32_16x16x32_bf16 v[236:239], a[204:207], a[232:235], v[236:239]
ds_read_b64_tr_b16 a[204:205], v14 offset:64
v_mfma_f32_16x16x32_bf16 v[176:179], a[208:211], a[224:227], v[176:179]
ds_read_b64_tr_b16 a[206:207], v14 offset:1088
v_mul_f32 v49, v49, v37
v_mfma_f32_16x16x32_bf16 v[208:211], a[208:211], a[228:231], v[208:211]
v_mul_f32 v50, v50, v37
v_mfma_f32_16x16x32_bf16 v[240:243], a[208:211], a[232:235], v[240:243]
ds_read_b64_tr_b16 a[208:209], v13 offset:128
v_mul_f32 v51, v51, v37
v_mfma_f32_16x16x32_bf16 v[180:183], a[212:215], a[224:227], v[180:183]
ds_read_b64_tr_b16 a[210:211], v13 offset:1152
v_mfma_f32_16x16x32_bf16 v[212:215], a[212:215], a[228:231], v[212:215]
buffer_load_dwordx4 v3, s[16:19], s74 offen offset:1024 lds
v_cvt_pk_bf16_f32 v44, v44, v45
v_mfma_f32_16x16x32_bf16 v[244:247], a[212:215], a[232:235], v[244:247]
ds_read_b64_tr_b16 a[212:213], v14 offset:128
v_cvt_pk_bf16_f32 v45, v46, v47
v_mfma_f32_16x16x32_bf16 v[184:187], a[216:219], a[224:227], v[184:187]
ds_read_b64_tr_b16 a[214:215], v14 offset:1152
v_mfma_f32_16x16x32_bf16 v[216:219], a[216:219], a[228:231], v[216:219]
v_cvt_pk_bf16_f32 v46, v48, v49
v_mfma_f32_16x16x32_bf16 v[248:251], a[216:219], a[232:235], v[248:251]
ds_read_b64_tr_b16 a[216:217], v13 offset:192
v_cvt_pk_bf16_f32 v47, v50, v51
v_mfma_f32_16x16x32_bf16 v[188:191], a[220:223], a[224:227], v[188:191]
ds_read_b64_tr_b16 a[218:219], v13 offset:1216
s_mov_b32 s71, 655360
v_mfma_f32_16x16x32_bf16 v[220:223], a[220:223], a[228:231], v[220:223]
buffer_load_dwordx4 v4, s[16:19], s74 offen offset:2048 lds
v_mfma_f32_16x16x32_bf16 v[252:255], a[220:223], a[232:235], v[252:255]
buffer_store_dwordx4 v[44:47], v38, s[32:35], s71 offen sc1
ds_read_b64_tr_b16 a[220:221], v14 offset:192
s_waitcnt lgkmcnt(4)
v_mfma_f32_16x16x32_bf16 v[64:67], a[192:195], v[52:55], v[64:67]
ds_read_b64_tr_b16 a[222:223], v14 offset:1216
v_accvgpr_read_b32 v44, a168
v_mfma_f32_16x16x32_bf16 v[96:99], a[192:195], v[56:59], v[96:99]
ds_read_b128 a[224:227], v17 offset:3072
v_accvgpr_read_b32 v45, a169
v_mfma_f32_16x16x32_bf16 v[128:131], a[192:195], v[60:63], v[128:131]
ds_read_b128 a[228:231], v17 offset:4096
v_mfma_f32_16x16x32_bf16 v[68:71], a[196:199], v[52:55], v[68:71]
ds_read_b128 a[232:235], v17 offset:5120
v_accvgpr_read_b32 v46, a170
v_mfma_f32_16x16x32_bf16 v[100:103], a[196:199], v[56:59], v[100:103]
s_add_u32 s75, s75, 8192
v_accvgpr_read_b32 v47, a171
v_mfma_f32_16x16x32_bf16 v[132:135], a[196:199], v[60:63], v[132:135]
s_and_b32 s75, s75, 131071
v_accvgpr_read_b32 v48, a172
v_mfma_f32_16x16x32_bf16 v[72:75], a[200:203], v[52:55], v[72:75]
v_mfma_f32_16x16x32_bf16 v[104:107], a[200:203], v[56:59], v[104:107]
v_accvgpr_read_b32 v49, a173
v_mfma_f32_16x16x32_bf16 v[136:139], a[200:203], v[60:63], v[136:139]
s_waitcnt vmcnt(9) lgkmcnt(0)
s_barrier
v_accvgpr_read_b32 v50, a174
v_mfma_f32_16x16x32_bf16 v[76:79], a[204:207], v[52:55], v[76:79]
s_add_u32 m0, s77, 32768
v_accvgpr_read_b32 v51, a175
v_mfma_f32_16x16x32_bf16 v[108:111], a[204:207], v[56:59], v[108:111]
buffer_load_dwordx4 v6, s[36:39], s75 offen nt lds
v_mfma_f32_16x16x32_bf16 v[140:143], a[204:207], v[60:63], v[140:143]
v_mul_f32 v44, v44, v37
v_mfma_f32_16x16x32_bf16 v[80:83], a[208:211], v[52:55], v[80:83]
v_mul_f32 v45, v45, v37
v_mfma_f32_16x16x32_bf16 v[112:115], a[208:211], v[56:59], v[112:115]
buffer_load_dwordx4 v7, s[36:39], s75 offen offset:1024 nt lds
v_mul_f32 v46, v46, v37
v_mfma_f32_16x16x32_bf16 v[144:147], a[208:211], v[60:63], v[144:147]
v_mfma_f32_16x16x32_bf16 v[84:87], a[212:215], v[52:55], v[84:87]
v_mul_f32 v47, v47, v37
v_mfma_f32_16x16x32_bf16 v[116:119], a[212:215], v[56:59], v[116:119]
buffer_load_dwordx4 v8, s[36:39], s75 offen offset:2048 nt lds
v_mul_f32 v48, v48, v37
v_mfma_f32_16x16x32_bf16 v[148:151], a[212:215], v[60:63], v[148:151]
v_mul_f32 v49, v49, v37
v_mfma_f32_16x16x32_bf16 v[88:91], a[216:219], v[52:55], v[88:91]
v_mfma_f32_16x16x32_bf16 v[120:123], a[216:219], v[56:59], v[120:123]
buffer_load_dwordx4 v9, s[36:39], s75 offen offset:3072 nt lds
v_mul_f32 v50, v50, v37
v_mfma_f32_16x16x32_bf16 v[152:155], a[216:219], v[60:63], v[152:155]
s_add_u32 s75, s75, 8192
v_mul_f32 v51, v51, v37
v_mfma_f32_16x16x32_bf16 v[92:95], a[220:223], v[52:55], v[92:95]
s_and_b32 s75, s75, 131071
ds_read_b128 v[52:55], v18
v_mfma_f32_16x16x32_bf16 v[124:127], a[220:223], v[56:59], v[124:127]
s_add_u32 m0, s77, 49152
ds_read_b128 v[56:59], v18 offset:1024
v_mfma_f32_16x16x32_bf16 v[156:159], a[220:223], v[60:63], v[156:159]
buffer_load_dwordx4 v6, s[36:39], s75 offen nt lds
ds_read_b128 v[60:63], v18 offset:2048
v_mfma_f32_16x16x32_bf16 v[160:163], a[192:195], a[224:227], v[160:163]
v_cvt_pk_bf16_f32 v44, v44, v45
v_mfma_f32_16x16x32_bf16 v[192:195], a[192:195], a[228:231], v[192:195]
v_cvt_pk_bf16_f32 v45, v46, v47
v_mfma_f32_16x16x32_bf16 v[224:227], a[192:195], a[232:235], v[224:227]
buffer_load_dwordx4 v7, s[36:39], s75 offen offset:1024 nt lds
ds_read_b64_tr_b16 a[192:193], v15
v_mfma_f32_16x16x32_bf16 v[164:167], a[196:199], a[224:227], v[164:167]
ds_read_b64_tr_b16 a[194:195], v15 offset:1024
v_cvt_pk_bf16_f32 v46, v48, v49
v_mfma_f32_16x16x32_bf16 v[196:199], a[196:199], a[228:231], v[196:199]
v_cvt_pk_bf16_f32 v47, v50, v51
s_mov_b32 s71, 655360
v_mfma_f32_16x16x32_bf16 v[228:231], a[196:199], a[232:235], v[228:231]
buffer_load_dwordx4 v8, s[36:39], s75 offen offset:2048 nt lds
ds_read_b64_tr_b16 a[196:197], v16
v_mfma_f32_16x16x32_bf16 v[168:171], a[200:203], a[224:227], v[168:171]
buffer_store_dwordx4 v[44:47], v38, s[32:35], s71 offen offset:1024 sc1
ds_read_b64_tr_b16 a[198:199], v16 offset:1024
v_mfma_f32_16x16x32_bf16 v[200:203], a[200:203], a[228:231], v[200:203]
v_accvgpr_read_b32 v44, a176
v_mfma_f32_16x16x32_bf16 v[232:235], a[200:203], a[232:235], v[232:235]
buffer_load_dwordx4 v9, s[36:39], s75 offen offset:3072 nt lds
ds_read_b64_tr_b16 a[200:201], v15 offset:64
v_mfma_f32_16x16x32_bf16 v[172:175], a[204:207], a[224:227], v[172:175]
ds_read_b64_tr_b16 a[202:203], v15 offset:1088
v_accvgpr_read_b32 v45, a177
v_mfma_f32_16x16x32_bf16 v[204:207], a[204:207], a[228:231], v[204:207]
v_accvgpr_read_b32 v46, a178
v_mfma_f32_16x16x32_bf16 v[236:239], a[204:207], a[232:235], v[236:239]
ds_read_b64_tr_b16 a[204:205], v16 offset:64
v_accvgpr_read_b32 v47, a179
v_mfma_f32_16x16x32_bf16 v[176:179], a[208:211], a[224:227], v[176:179]
ds_read_b64_tr_b16 a[206:207], v16 offset:1088
v_accvgpr_read_b32 v48, a180
v_mfma_f32_16x16x32_bf16 v[208:211], a[208:211], a[228:231], v[208:211]
v_accvgpr_read_b32 v49, a181
v_mfma_f32_16x16x32_bf16 v[240:243], a[208:211], a[232:235], v[240:243]
ds_read_b64_tr_b16 a[208:209], v15 offset:128
v_accvgpr_read_b32 v50, a182
v_mfma_f32_16x16x32_bf16 v[180:183], a[212:215], a[224:227], v[180:183]
ds_read_b64_tr_b16 a[210:211], v15 offset:1152
v_accvgpr_read_b32 v51, a183
v_mfma_f32_16x16x32_bf16 v[212:215], a[212:215], a[228:231], v[212:215]
v_mul_f32 v44, v44, v37
v_mfma_f32_16x16x32_bf16 v[244:247], a[212:215], a[232:235], v[244:247]
ds_read_b64_tr_b16 a[212:213], v16 offset:128
v_mfma_f32_16x16x32_bf16 v[184:187], a[216:219], a[224:227], v[184:187]
ds_read_b64_tr_b16 a[214:215], v16 offset:1152
v_mul_f32 v45, v45, v37
v_mfma_f32_16x16x32_bf16 v[216:219], a[216:219], a[228:231], v[216:219]
v_mul_f32 v46, v46, v37
v_mfma_f32_16x16x32_bf16 v[248:251], a[216:219], a[232:235], v[248:251]
ds_read_b64_tr_b16 a[216:217], v15 offset:192
v_mul_f32 v47, v47, v37
v_mfma_f32_16x16x32_bf16 v[188:191], a[220:223], a[224:227], v[188:191]
ds_read_b64_tr_b16 a[218:219], v15 offset:1216
v_mfma_f32_16x16x32_bf16 v[220:223], a[220:223], a[228:231], v[220:223]
v_mul_f32 v48, v48, v37
v_mfma_f32_16x16x32_bf16 v[252:255], a[220:223], a[232:235], v[252:255]
ds_read_b64_tr_b16 a[220:221], v16 offset:192
v_mul_f32 v49, v49, v37
s_waitcnt lgkmcnt(4)
v_mfma_f32_16x16x32_bf16 v[64:67], a[192:195], v[52:55], v[64:67]
ds_read_b64_tr_b16 a[222:223], v16 offset:1216
v_mul_f32 v50, v50, v37
v_mfma_f32_16x16x32_bf16 v[96:99], a[192:195], v[56:59], v[96:99]
ds_read_b128 a[224:227], v18 offset:3072
v_mfma_f32_16x16x32_bf16 v[128:131], a[192:195], v[60:63], v[128:131]
ds_read_b128 a[228:231], v18 offset:4096
v_mul_f32 v51, v51, v37
v_mfma_f32_16x16x32_bf16 v[68:71], a[196:199], v[52:55], v[68:71]
ds_read_b128 a[232:235], v18 offset:5120
v_cvt_pk_bf16_f32 v44, v44, v45
v_mfma_f32_16x16x32_bf16 v[100:103], a[196:199], v[56:59], v[100:103]
s_add_u32 s76, s76, 8192
v_cvt_pk_bf16_f32 v45, v46, v47
v_mfma_f32_16x16x32_bf16 v[132:135], a[196:199], v[60:63], v[132:135]
s_and_b32 s76, s76, 131071
v_mfma_f32_16x16x32_bf16 v[72:75], a[200:203], v[52:55], v[72:75]
v_cvt_pk_bf16_f32 v46, v48, v49
v_mfma_f32_16x16x32_bf16 v[104:107], a[200:203], v[56:59], v[104:107]
v_cvt_pk_bf16_f32 v47, v50, v51
v_mfma_f32_16x16x32_bf16 v[136:139], a[200:203], v[60:63], v[136:139]
s_waitcnt vmcnt(10) lgkmcnt(0)
s_barrier
s_mov_b32 s71, 655360
v_mfma_f32_16x16x32_bf16 v[76:79], a[204:207], v[52:55], v[76:79]
s_add_u32 m0, s77, 98304
v_mfma_f32_16x16x32_bf16 v[108:111], a[204:207], v[56:59], v[108:111]
buffer_load_dwordx4 v10, s[40:43], s76 offen nt lds
buffer_store_dwordx4 v[44:47], v38, s[32:35], s71 offen offset:2048 sc1
v_mfma_f32_16x16x32_bf16 v[140:143], a[204:207], v[60:63], v[140:143]
s_nop 0
v_accvgpr_read_b32 v44, a184
v_mfma_f32_16x16x32_bf16 v[80:83], a[208:211], v[52:55], v[80:83]
v_accvgpr_read_b32 v45, a185
v_mfma_f32_16x16x32_bf16 v[112:115], a[208:211], v[56:59], v[112:115]
buffer_load_dwordx4 v19, s[40:43], s76 offen offset:1024 nt lds
v_mfma_f32_16x16x32_bf16 v[144:147], a[208:211], v[60:63], v[144:147]
v_accvgpr_read_b32 v46, a186
v_mfma_f32_16x16x32_bf16 v[84:87], a[212:215], v[52:55], v[84:87]
v_accvgpr_read_b32 v47, a187
v_mfma_f32_16x16x32_bf16 v[116:119], a[212:215], v[56:59], v[116:119]
buffer_load_dwordx4 v10, s[40:43], s76 offen offset:2048 nt lds
v_accvgpr_read_b32 v48, a188
v_mfma_f32_16x16x32_bf16 v[148:151], a[212:215], v[60:63], v[148:151]
v_mfma_f32_16x16x32_bf16 v[88:91], a[216:219], v[52:55], v[88:91]
v_accvgpr_read_b32 v49, a189
v_mfma_f32_16x16x32_bf16 v[120:123], a[216:219], v[56:59], v[120:123]
buffer_load_dwordx4 v19, s[40:43], s76 offen offset:3072 nt lds
v_accvgpr_read_b32 v50, a190
v_mfma_f32_16x16x32_bf16 v[152:155], a[216:219], v[60:63], v[152:155]
s_add_u32 s76, s76, 8192
v_accvgpr_read_b32 v51, a191
v_mfma_f32_16x16x32_bf16 v[92:95], a[220:223], v[52:55], v[92:95]
s_and_b32 s76, s76, 131071
ds_read_b128 v[52:55], v18 offset:32768
v_mfma_f32_16x16x32_bf16 v[124:127], a[220:223], v[56:59], v[124:127]
s_add_u32 m0, s77, 114688
ds_read_b128 v[56:59], v18 offset:33792
v_mfma_f32_16x16x32_bf16 v[156:159], a[220:223], v[60:63], v[156:159]
buffer_load_dwordx4 v10, s[40:43], s76 offen nt lds
ds_read_b128 v[60:63], v18 offset:34816
v_mfma_f32_16x16x32_bf16 v[160:163], a[192:195], a[224:227], v[160:163]
v_mul_f32 v44, v44, v37
v_mfma_f32_16x16x32_bf16 v[192:195], a[192:195], a[228:231], v[192:195]
v_mul_f32 v45, v45, v37
v_mfma_f32_16x16x32_bf16 v[224:227], a[192:195], a[232:235], v[224:227]
buffer_load_dwordx4 v19, s[40:43], s76 offen offset:1024 nt lds
ds_read_b64_tr_b16 a[192:193], v11
v_mfma_f32_16x16x32_bf16 v[164:167], a[196:199], a[224:227], v[164:167]
ds_read_b64_tr_b16 a[194:195], v11 offset:1024
v_mul_f32 v46, v46, v37
v_mfma_f32_16x16x32_bf16 v[196:199], a[196:199], a[228:231], v[196:199]
v_mul_f32 v47, v47, v37
v_mfma_f32_16x16x32_bf16 v[228:231], a[196:199], a[232:235], v[228:231]
buffer_load_dwordx4 v10, s[40:43], s76 offen offset:2048 nt lds
ds_read_b64_tr_b16 a[196:197], v12
v_mfma_f32_16x16x32_bf16 v[168:171], a[200:203], a[224:227], v[168:171]
ds_read_b64_tr_b16 a[198:199], v12 offset:1024
v_mul_f32 v48, v48, v37
v_mfma_f32_16x16x32_bf16 v[200:203], a[200:203], a[228:231], v[200:203]
v_mul_f32 v49, v49, v37
v_mfma_f32_16x16x32_bf16 v[232:235], a[200:203], a[232:235], v[232:235]
buffer_load_dwordx4 v19, s[40:43], s76 offen offset:3072 nt lds
ds_read_b64_tr_b16 a[200:201], v11 offset:64
v_mfma_f32_16x16x32_bf16 v[172:175], a[204:207], a[224:227], v[172:175]
ds_read_b64_tr_b16 a[202:203], v11 offset:1088
v_mul_f32 v50, v50, v37
v_mfma_f32_16x16x32_bf16 v[204:207], a[204:207], a[228:231], v[204:207]
v_mul_f32 v51, v51, v37
v_mfma_f32_16x16x32_bf16 v[236:239], a[204:207], a[232:235], v[236:239]
ds_read_b64_tr_b16 a[204:205], v12 offset:64
v_cvt_pk_bf16_f32 v44, v44, v45
v_mfma_f32_16x16x32_bf16 v[176:179], a[208:211], a[224:227], v[176:179]
ds_read_b64_tr_b16 a[206:207], v12 offset:1088
v_cvt_pk_bf16_f32 v45, v46, v47
v_mfma_f32_16x16x32_bf16 v[208:211], a[208:211], a[228:231], v[208:211]
v_cvt_pk_bf16_f32 v46, v48, v49
v_mfma_f32_16x16x32_bf16 v[240:243], a[208:211], a[232:235], v[240:243]
ds_read_b64_tr_b16 a[208:209], v11 offset:128
v_cvt_pk_bf16_f32 v47, v50, v51
v_mfma_f32_16x16x32_bf16 v[180:183], a[212:215], a[224:227], v[180:183]
ds_read_b64_tr_b16 a[210:211], v11 offset:1152
s_mov_b32 s71, 655360
v_mfma_f32_16x16x32_bf16 v[212:215], a[212:215], a[228:231], v[212:215]
buffer_store_dwordx4 v[44:47], v38, s[32:35], s71 offen offset:3072 sc1
v_mfma_f32_16x16x32_bf16 v[244:247], a[212:215], a[232:235], v[244:247]
ds_read_b64_tr_b16 a[212:213], v12 offset:128
v_mfma_f32_16x16x32_bf16 v[184:187], a[216:219], a[224:227], v[184:187]
ds_read_b64_tr_b16 a[214:215], v12 offset:1152
v_mfma_f32_16x16x32_bf16 v[216:219], a[216:219], a[228:231], v[216:219]
v_mfma_f32_16x16x32_bf16 v[248:251], a[216:219], a[232:235], v[248:251]
ds_read_b64_tr_b16 a[216:217], v11 offset:192
v_mfma_f32_16x16x32_bf16 v[188:191], a[220:223], a[224:227], v[188:191]
ds_read_b64_tr_b16 a[218:219], v11 offset:1216
v_mfma_f32_16x16x32_bf16 v[220:223], a[220:223], a[228:231], v[220:223]
v_mfma_f32_16x16x32_bf16 v[252:255], a[220:223], a[232:235], v[252:255]
ds_read_b64_tr_b16 a[220:221], v12 offset:192
s_waitcnt lgkmcnt(5)
v_mfma_f32_16x16x32_bf16 v[64:67], a[192:195], v[52:55], v[64:67]
ds_read_b64_tr_b16 a[222:223], v12 offset:1216
v_mfma_f32_16x16x32_bf16 v[68:71], a[196:199], v[52:55], v[68:71]
ds_read_b128 a[224:227], v18 offset:35840
v_mfma_f32_16x16x32_bf16 v[72:75], a[200:203], v[52:55], v[72:75]
ds_read_b128 a[228:231], v18 offset:36864
v_mfma_f32_16x16x32_bf16 v[76:79], a[204:207], v[52:55], v[76:79]
ds_read_b128 a[232:235], v18 offset:37888
v_mfma_f32_16x16x32_bf16 v[80:83], a[208:211], v[52:55], v[80:83]
v_xor_b32 v44, 128, v28
s_waitcnt lgkmcnt(5)
v_mfma_f32_16x16x32_bf16 v[84:87], a[212:215], v[52:55], v[84:87]
v_xor_b32 v45, 160, v28
v_mfma_f32_16x16x32_bf16 v[88:91], a[216:219], v[52:55], v[88:91]
v_xor_b32 v46, 192, v28
s_waitcnt lgkmcnt(3)
v_mfma_f32_16x16x32_bf16 v[92:95], a[220:223], v[52:55], v[92:95]
v_xor_b32 v47, 224, v28
v_mfma_f32_16x16x32_bf16 v[96:99], a[192:195], v[56:59], v[96:99]
s_waitcnt lgkmcnt(0)
s_barrier
v_mov_b32 v48, 0x3f803f80
v_mfma_f32_16x16x32_bf16 v[100:103], a[196:199], v[56:59], v[100:103]
v_mov_b32 v49, 0x3f803f80
v_mfma_f32_16x16x32_bf16 v[104:107], a[200:203], v[56:59], v[104:107]
v_mov_b32 v50, 0x3f803f80
v_mfma_f32_16x16x32_bf16 v[108:111], a[204:207], v[56:59], v[108:111]
v_mov_b32 v51, 0x3f803f80
v_mfma_f32_16x16x32_bf16 v[112:115], a[208:211], v[56:59], v[112:115]
v_mul_f32 v64, s66, v64
v_mul_f32 v65, s66, v65
v_mul_f32 v66, s66, v66
v_mfma_f32_16x16x32_bf16 v[116:119], a[212:215], v[56:59], v[116:119]
v_mul_f32 v67, s66, v67
v_mul_f32 v68, s66, v68
v_mul_f32 v69, s66, v69
v_mfma_f32_16x16x32_bf16 v[120:123], a[216:219], v[56:59], v[120:123]
v_mul_f32 v70, s66, v70
v_mul_f32 v71, s66, v71
v_cvt_pk_bf16_f32 v64, v64, v65
v_mfma_f32_16x16x32_bf16 v[124:127], a[220:223], v[56:59], v[124:127]
v_cvt_pk_bf16_f32 v65, v66, v67
v_cvt_pk_bf16_f32 v66, v68, v69
v_cvt_pk_bf16_f32 v67, v70, v71
v_mfma_f32_16x16x32_bf16 v[128:131], a[192:195], v[60:63], v[128:131]
v_mul_f32 v72, s66, v72
v_mul_f32 v73, s66, v73
v_mul_f32 v74, s66, v74
v_mfma_f32_16x16x32_bf16 v[132:135], a[196:199], v[60:63], v[132:135]
v_mul_f32 v75, s66, v75
v_mul_f32 v76, s66, v76
v_mul_f32 v77, s66, v77
v_mfma_f32_16x16x32_bf16 v[136:139], a[200:203], v[60:63], v[136:139]
v_mul_f32 v78, s66, v78
v_mul_f32 v79, s66, v79
v_cvt_pk_bf16_f32 v68, v72, v73
v_mfma_f32_16x16x32_bf16 v[140:143], a[204:207], v[60:63], v[140:143]
v_cvt_pk_bf16_f32 v69, v74, v75
v_cvt_pk_bf16_f32 v70, v76, v77
v_cvt_pk_bf16_f32 v71, v78, v79
v_mfma_f32_16x16x32_bf16 v[144:147], a[208:211], v[60:63], v[144:147]
v_mul_f32 v80, s66, v80
v_mul_f32 v81, s66, v81
v_mul_f32 v82, s66, v82
v_mfma_f32_16x16x32_bf16 v[148:151], a[212:215], v[60:63], v[148:151]
v_mul_f32 v83, s66, v83
v_mul_f32 v84, s66, v84
v_mul_f32 v85, s66, v85
v_mfma_f32_16x16x32_bf16 v[152:155], a[216:219], v[60:63], v[152:155]
v_mul_f32 v86, s66, v86
v_mul_f32 v87, s66, v87
v_cvt_pk_bf16_f32 v72, v80, v81
v_mfma_f32_16x16x32_bf16 v[156:159], a[220:223], v[60:63], v[156:159]
v_cvt_pk_bf16_f32 v73, v82, v83
v_cvt_pk_bf16_f32 v74, v84, v85
v_cvt_pk_bf16_f32 v75, v86, v87
v_mfma_f32_16x16x32_bf16 v[160:163], a[192:195], a[224:227], v[160:163]
v_mul_f32 v88, s66, v88
v_mul_f32 v89, s66, v89
v_mul_f32 v90, s66, v90
v_mfma_f32_16x16x32_bf16 v[164:167], a[196:199], a[224:227], v[164:167]
v_mul_f32 v91, s66, v91
v_mul_f32 v92, s66, v92
v_mul_f32 v93, s66, v93
v_mfma_f32_16x16x32_bf16 v[168:171], a[200:203], a[224:227], v[168:171]
v_mul_f32 v94, s66, v94
v_mul_f32 v95, s66, v95
v_cvt_pk_bf16_f32 v76, v88, v89
v_mfma_f32_16x16x32_bf16 v[172:175], a[204:207], a[224:227], v[172:175]
v_cvt_pk_bf16_f32 v77, v90, v91
v_cvt_pk_bf16_f32 v78, v92, v93
v_cvt_pk_bf16_f32 v79, v94, v95
v_mfma_f32_16x16x32_bf16 v[176:179], a[208:211], a[224:227], v[176:179]
v_mul_f32 v96, s66, v96
v_mul_f32 v97, s66, v97
v_mul_f32 v98, s66, v98
v_mfma_f32_16x16x32_bf16 v[180:183], a[212:215], a[224:227], v[180:183]
v_mul_f32 v99, s66, v99
v_mul_f32 v100, s66, v100
v_mul_f32 v101, s66, v101
v_mfma_f32_16x16x32_bf16 v[184:187], a[216:219], a[224:227], v[184:187]
v_mul_f32 v102, s66, v102
v_mul_f32 v103, s66, v103
v_cvt_pk_bf16_f32 v96, v96, v97
v_mfma_f32_16x16x32_bf16 v[188:191], a[220:223], a[224:227], v[188:191]
v_cvt_pk_bf16_f32 v97, v98, v99
v_cvt_pk_bf16_f32 v98, v100, v101
v_cvt_pk_bf16_f32 v99, v102, v103
v_mfma_f32_16x16x32_bf16 v[192:195], a[192:195], a[228:231], v[192:195]
v_mul_f32 v104, s66, v104
v_mul_f32 v105, s66, v105
v_mul_f32 v106, s66, v106
v_mfma_f32_16x16x32_bf16 v[196:199], a[196:199], a[228:231], v[196:199]
v_mul_f32 v107, s66, v107
v_mul_f32 v108, s66, v108
v_mul_f32 v109, s66, v109
v_mfma_f32_16x16x32_bf16 v[200:203], a[200:203], a[228:231], v[200:203]
v_mul_f32 v110, s66, v110
v_mul_f32 v111, s66, v111
v_cvt_pk_bf16_f32 v100, v104, v105
v_mfma_f32_16x16x32_bf16 v[204:207], a[204:207], a[228:231], v[204:207]
v_cvt_pk_bf16_f32 v101, v106, v107
v_cvt_pk_bf16_f32 v102, v108, v109
v_cvt_pk_bf16_f32 v103, v110, v111
v_mfma_f32_16x16x32_bf16 v[208:211], a[208:211], a[228:231], v[208:211]
v_mul_f32 v112, s66, v112
v_mul_f32 v113, s66, v113
v_mul_f32 v114, s66, v114
v_mfma_f32_16x16x32_bf16 v[212:215], a[212:215], a[228:231], v[212:215]
v_mul_f32 v115, s66, v115
v_mul_f32 v116, s66, v116
v_mul_f32 v117, s66, v117
v_mfma_f32_16x16x32_bf16 v[216:219], a[216:219], a[228:231], v[216:219]
v_mul_f32 v118, s66, v118
v_mul_f32 v119, s66, v119
v_cvt_pk_bf16_f32 v104, v112, v113
v_mfma_f32_16x16x32_bf16 v[220:223], a[220:223], a[228:231], v[220:223]
v_cvt_pk_bf16_f32 v105, v114, v115
v_cvt_pk_bf16_f32 v106, v116, v117
v_cvt_pk_bf16_f32 v107, v118, v119
v_mfma_f32_16x16x32_bf16 v[224:227], a[192:195], a[232:235], v[224:227]
ds_read_b64 a[192:193], v20
ds_read_b64 a[194:195], v21
v_mul_f32 v120, s66, v120
v_mul_f32 v121, s66, v121
v_mul_f32 v122, s66, v122
v_mfma_f32_16x16x32_bf16 v[228:231], a[196:199], a[232:235], v[228:231]
ds_read_b64 a[196:197], v22
ds_read_b64 a[198:199], v23
v_mul_f32 v123, s66, v123
v_mul_f32 v124, s66, v124
v_mul_f32 v125, s66, v125
v_mfma_f32_16x16x32_bf16 v[232:235], a[200:203], a[232:235], v[232:235]
ds_read_b64 a[200:201], v24
ds_read_b64 a[202:203], v25
v_mul_f32 v126, s66, v126
v_mul_f32 v127, s66, v127
v_cvt_pk_bf16_f32 v108, v120, v121
v_mfma_f32_16x16x32_bf16 v[236:239], a[204:207], a[232:235], v[236:239]
ds_read_b64 a[204:205], v26
ds_read_b64 a[206:207], v27
v_cvt_pk_bf16_f32 v109, v122, v123
v_cvt_pk_bf16_f32 v110, v124, v125
v_cvt_pk_bf16_f32 v111, v126, v127
v_mfma_f32_16x16x32_bf16 v[240:243], a[208:211], a[232:235], v[240:243]
ds_read_b64 a[208:209], v20 offset:4096
ds_read_b64 a[210:211], v21 offset:4096
v_mul_f32 v128, s66, v128
v_mul_f32 v129, s66, v129
v_mul_f32 v130, s66, v130
v_mul_f32 v131, s66, v131
v_mfma_f32_16x16x32_bf16 v[244:247], a[212:215], a[232:235], v[244:247]
ds_read_b64 a[212:213], v22 offset:4096
ds_read_b64 a[214:215], v23 offset:4096
v_mul_f32 v132, s66, v132
v_mul_f32 v133, s66, v133
v_mul_f32 v134, s66, v134
v_mul_f32 v135, s66, v135
v_mfma_f32_16x16x32_bf16 v[248:251], a[216:219], a[232:235], v[248:251]
ds_read_b64 a[216:217], v24 offset:4096
ds_read_b64 a[218:219], v25 offset:4096
v_cvt_pk_bf16_f32 v128, v128, v129
v_cvt_pk_bf16_f32 v129, v130, v131
v_cvt_pk_bf16_f32 v130, v132, v133
v_cvt_pk_bf16_f32 v131, v134, v135
v_mfma_f32_16x16x32_bf16 v[252:255], a[220:223], a[232:235], v[252:255]
ds_read_b64 a[220:221], v26 offset:4096
ds_read_b64 a[222:223], v27 offset:4096
v_mul_f32 v136, s66, v136
v_mul_f32 v137, s66, v137
v_mul_f32 v138, s66, v138
v_mul_f32 v139, s66, v139
s_waitcnt lgkmcnt(4)
v_mfma_f32_16x16x32_bf16 v[80:83], a[192:195], v[64:67], 0
v_mul_f32 v140, s66, v140
v_mul_f32 v141, s66, v141
v_mul_f32 v142, s66, v142
v_mul_f32 v143, s66, v143
v_mfma_f32_16x16x32_bf16 v[84:87], a[208:211], v[64:67], 0
v_cvt_pk_bf16_f32 v132, v136, v137
v_cvt_pk_bf16_f32 v133, v138, v139
v_cvt_pk_bf16_f32 v134, v140, v141
v_cvt_pk_bf16_f32 v135, v142, v143
v_mfma_f32_16x16x32_bf16 v[80:83], a[196:199], v[68:71], v[80:83]
v_mul_f32 v144, s66, v144
v_mul_f32 v145, s66, v145
v_mul_f32 v146, s66, v146
v_mul_f32 v147, s66, v147
v_mfma_f32_16x16x32_bf16 v[84:87], a[212:215], v[68:71], v[84:87]
v_mul_f32 v148, s66, v148
v_mul_f32 v149, s66, v149
v_mul_f32 v150, s66, v150
v_mul_f32 v151, s66, v151
v_mfma_f32_16x16x32_bf16 v[80:83], a[200:203], v[72:75], v[80:83]
v_cvt_pk_bf16_f32 v136, v144, v145
v_cvt_pk_bf16_f32 v137, v146, v147
v_cvt_pk_bf16_f32 v138, v148, v149
v_cvt_pk_bf16_f32 v139, v150, v151
s_waitcnt lgkmcnt(0)
v_mfma_f32_16x16x32_bf16 v[84:87], a[216:219], v[72:75], v[84:87]
v_mul_f32 v152, s66, v152
v_mul_f32 v153, s66, v153
v_mul_f32 v154, s66, v154
v_mul_f32 v155, s66, v155
v_mfma_f32_16x16x32_bf16 v[80:83], a[204:207], v[76:79], v[80:83]
v_mul_f32 v156, s66, v156
v_mul_f32 v157, s66, v157
v_mul_f32 v158, s66, v158
v_mul_f32 v159, s66, v159
v_mfma_f32_16x16x32_bf16 v[84:87], a[220:223], v[76:79], v[84:87]
v_cvt_pk_bf16_f32 v140, v152, v153
v_cvt_pk_bf16_f32 v141, v154, v155
v_cvt_pk_bf16_f32 v142, v156, v157
v_cvt_pk_bf16_f32 v143, v158, v159
v_mfma_f32_16x16x32_bf16 v[112:115], a[192:195], v[96:99], 0
v_mul_f32 v160, s66, v160
v_mul_f32 v161, s66, v161
ds_read_b64_tr_b16 a[224:225], v28
ds_read_b64_tr_b16 a[226:227], v28 offset:4096
v_mfma_f32_16x16x32_bf16 v[116:119], a[208:211], v[96:99], 0
v_mul_f32 v162, s66, v162
v_mul_f32 v163, s66, v163
ds_read_b64_tr_b16 a[228:229], v29
ds_read_b64_tr_b16 a[230:231], v29 offset:4096
v_mfma_f32_16x16x32_bf16 v[112:115], a[196:199], v[100:103], v[112:115]
v_mul_f32 v164, s66, v164
v_mul_f32 v165, s66, v165
ds_read_b64_tr_b16 a[232:233], v30
ds_read_b64_tr_b16 a[234:235], v30 offset:4096
v_mfma_f32_16x16x32_bf16 v[116:119], a[212:215], v[100:103], v[116:119]
v_mul_f32 v166, s66, v166
v_mul_f32 v167, s66, v167
ds_read_b64_tr_b16 a[236:237], v31
ds_read_b64_tr_b16 a[238:239], v31 offset:4096
v_mfma_f32_16x16x32_bf16 v[112:115], a[200:203], v[104:107], v[112:115]
v_cvt_pk_bf16_f32 v160, v160, v161
v_cvt_pk_bf16_f32 v161, v162, v163
ds_read_b64_tr_b16 a[240:241], v44
ds_read_b64_tr_b16 a[242:243], v44 offset:4096
v_mfma_f32_16x16x32_bf16 v[116:119], a[216:219], v[104:107], v[116:119]
v_cvt_pk_bf16_f32 v162, v164, v165
v_cvt_pk_bf16_f32 v163, v166, v167
ds_read_b64_tr_b16 a[244:245], v45
ds_read_b64_tr_b16 a[246:247], v45 offset:4096
v_mfma_f32_16x16x32_bf16 v[112:115], a[204:207], v[108:111], v[112:115]
v_mul_f32 v168, s66, v168
v_mul_f32 v169, s66, v169
ds_read_b64_tr_b16 a[248:249], v46
ds_read_b64_tr_b16 a[250:251], v46 offset:4096
v_mfma_f32_16x16x32_bf16 v[116:119], a[220:223], v[108:111], v[116:119]
v_mul_f32 v170, s66, v170
v_mul_f32 v171, s66, v171
ds_read_b64_tr_b16 a[252:253], v47
ds_read_b64_tr_b16 a[254:255], v47 offset:4096
v_mfma_f32_16x16x32_bf16 v[144:147], a[192:195], v[128:131], 0
v_mul_f32 v172, s66, v172
v_mul_f32 v173, s66, v173
v_mfma_f32_16x16x32_bf16 v[148:151], a[208:211], v[128:131], 0
v_mul_f32 v174, s66, v174
v_mul_f32 v175, s66, v175
v_mfma_f32_16x16x32_bf16 v[144:147], a[196:199], v[132:135], v[144:147]
v_cvt_pk_bf16_f32 v164, v168, v169
v_cvt_pk_bf16_f32 v165, v170, v171
v_mfma_f32_16x16x32_bf16 v[148:151], a[212:215], v[132:135], v[148:151]
v_cvt_pk_bf16_f32 v166, v172, v173
v_cvt_pk_bf16_f32 v167, v174, v175
v_mfma_f32_16x16x32_bf16 v[144:147], a[200:203], v[136:139], v[144:147]
v_mul_f32 v176, s66, v176
v_mul_f32 v177, s66, v177
v_mfma_f32_16x16x32_bf16 v[148:151], a[216:219], v[136:139], v[148:151]
v_mul_f32 v178, s66, v178
v_mul_f32 v179, s66, v179
v_exp_f32 v80, v80
v_exp_f32 v81, v81
v_exp_f32 v82, v82
v_cvt_pk_bf16_f32 v80, v80, v81
v_exp_f32 v83, v83
v_exp_f32 v84, v84
v_cvt_pk_bf16_f32 v81, v82, v83
v_exp_f32 v85, v85
v_exp_f32 v86, v86
v_cvt_pk_bf16_f32 v82, v84, v85
v_exp_f32 v87, v87
s_nop 0
v_cvt_pk_bf16_f32 v83, v86, v87
v_mfma_f32_16x16x32_bf16 v[144:147], a[204:207], v[140:143], v[144:147]
v_mul_f32 v180, s66, v180
v_mul_f32 v181, s66, v181
v_mfma_f32_16x16x32_bf16 v[148:151], a[220:223], v[140:143], v[148:151]
v_mul_f32 v182, s66, v182
v_mul_f32 v183, s66, v183
s_waitcnt lgkmcnt(0)
v_mfma_f32_16x16x32_bf16 a[0:3], a[224:227], v[80:83], 0
v_cvt_pk_bf16_f32 v168, v176, v177
v_cvt_pk_bf16_f32 v169, v178, v179
v_mfma_f32_16x16x32_bf16 a[4:7], a[228:231], v[80:83], 0
v_cvt_pk_bf16_f32 v170, v180, v181
v_cvt_pk_bf16_f32 v171, v182, v183
v_mfma_f32_16x16x32_bf16 a[8:11], a[232:235], v[80:83], 0
v_mul_f32 v184, s66, v184
v_mul_f32 v185, s66, v185
v_mfma_f32_16x16x32_bf16 a[12:15], a[236:239], v[80:83], 0
v_mul_f32 v186, s66, v186
v_mul_f32 v187, s66, v187
v_mfma_f32_16x16x32_bf16 a[16:19], a[240:243], v[80:83], 0
v_mul_f32 v188, s66, v188
v_mul_f32 v189, s66, v189
v_mfma_f32_16x16x32_bf16 a[20:23], a[244:247], v[80:83], 0
v_mul_f32 v190, s66, v190
v_mul_f32 v191, s66, v191
v_mfma_f32_16x16x32_bf16 a[24:27], a[248:251], v[80:83], 0
v_cvt_pk_bf16_f32 v172, v184, v185
v_cvt_pk_bf16_f32 v173, v186, v187
v_mfma_f32_16x16x32_bf16 a[28:31], a[252:255], v[80:83], 0
v_cvt_pk_bf16_f32 v174, v188, v189
v_cvt_pk_bf16_f32 v175, v190, v191
v_mfma_f32_16x16x32_bf16 v[88:91], v[48:51], v[80:83], 0
v_exp_f32 v112, v112
v_mfma_f32_16x16x32_bf16 v[80:83], a[192:195], v[160:163], 0
v_mul_f32 v192, s66, v192
v_mul_f32 v193, s66, v193
v_mul_f32 v194, s66, v194
v_mfma_f32_16x16x32_bf16 v[84:87], a[208:211], v[160:163], 0
v_mul_f32 v195, s66, v195
v_mul_f32 v196, s66, v196
v_mul_f32 v197, s66, v197
v_mfma_f32_16x16x32_bf16 v[80:83], a[196:199], v[164:167], v[80:83]
v_mul_f32 v198, s66, v198
v_mul_f32 v199, s66, v199
v_cvt_pk_bf16_f32 v192, v192, v193
v_mfma_f32_16x16x32_bf16 v[84:87], a[212:215], v[164:167], v[84:87]
v_cvt_pk_bf16_f32 v193, v194, v195
v_cvt_pk_bf16_f32 v194, v196, v197
v_cvt_pk_bf16_f32 v195, v198, v199
v_mfma_f32_16x16x32_bf16 v[80:83], a[200:203], v[168:171], v[80:83]
v_mul_f32 v200, s66, v200
v_mul_f32 v201, s66, v201
v_mul_f32 v202, s66, v202
v_mfma_f32_16x16x32_bf16 v[84:87], a[216:219], v[168:171], v[84:87]
v_mul_f32 v203, s66, v203
v_mul_f32 v204, s66, v204
v_mul_f32 v205, s66, v205
v_exp_f32 v113, v113
v_exp_f32 v114, v114
v_cvt_pk_bf16_f32 v112, v112, v113
v_exp_f32 v115, v115
v_exp_f32 v116, v116
v_cvt_pk_bf16_f32 v113, v114, v115
v_exp_f32 v117, v117
v_exp_f32 v118, v118
v_cvt_pk_bf16_f32 v114, v116, v117
v_exp_f32 v119, v119
s_nop 0
v_cvt_pk_bf16_f32 v115, v118, v119
v_mfma_f32_16x16x32_bf16 v[80:83], a[204:207], v[172:175], v[80:83]
v_mul_f32 v206, s66, v206
v_mul_f32 v207, s66, v207
v_cvt_pk_bf16_f32 v196, v200, v201
v_mfma_f32_16x16x32_bf16 v[84:87], a[220:223], v[172:175], v[84:87]
v_cvt_pk_bf16_f32 v197, v202, v203
v_cvt_pk_bf16_f32 v198, v204, v205
v_cvt_pk_bf16_f32 v199, v206, v207
v_mfma_f32_16x16x32_bf16 a[32:35], a[224:227], v[112:115], 0
v_mul_f32 v208, s66, v208
v_mul_f32 v209, s66, v209
v_mul_f32 v210, s66, v210
v_mfma_f32_16x16x32_bf16 a[36:39], a[228:231], v[112:115], 0
v_mul_f32 v211, s66, v211
v_mul_f32 v212, s66, v212
v_mul_f32 v213, s66, v213
v_mfma_f32_16x16x32_bf16 a[40:43], a[232:235], v[112:115], 0
v_mul_f32 v214, s66, v214
v_mul_f32 v215, s66, v215
v_cvt_pk_bf16_f32 v200, v208, v209
v_mfma_f32_16x16x32_bf16 a[44:47], a[236:239], v[112:115], 0
v_cvt_pk_bf16_f32 v201, v210, v211
v_cvt_pk_bf16_f32 v202, v212, v213
v_cvt_pk_bf16_f32 v203, v214, v215
v_mfma_f32_16x16x32_bf16 a[48:51], a[240:243], v[112:115], 0
v_mul_f32 v216, s66, v216
v_mul_f32 v217, s66, v217
v_mul_f32 v218, s66, v218
v_mfma_f32_16x16x32_bf16 a[52:55], a[244:247], v[112:115], 0
v_mul_f32 v219, s66, v219
v_mul_f32 v220, s66, v220
v_mul_f32 v221, s66, v221
v_mfma_f32_16x16x32_bf16 a[56:59], a[248:251], v[112:115], 0
v_mul_f32 v222, s66, v222
v_mul_f32 v223, s66, v223
v_cvt_pk_bf16_f32 v204, v216, v217
v_mfma_f32_16x16x32_bf16 a[60:63], a[252:255], v[112:115], 0
v_cvt_pk_bf16_f32 v205, v218, v219
v_cvt_pk_bf16_f32 v206, v220, v221
v_cvt_pk_bf16_f32 v207, v222, v223
v_mfma_f32_16x16x32_bf16 v[92:95], v[48:51], v[112:115], 0
v_exp_f32 v144, v144
v_mfma_f32_16x16x32_bf16 v[112:115], a[192:195], v[192:195], 0
v_mul_f32 v224, s66, v224
v_mul_f32 v225, s66, v225
v_mul_f32 v226, s66, v226
v_mfma_f32_16x16x32_bf16 v[116:119], a[208:211], v[192:195], 0
v_mul_f32 v227, s66, v227
v_mul_f32 v228, s66, v228
v_mul_f32 v229, s66, v229
v_mfma_f32_16x16x32_bf16 v[112:115], a[196:199], v[196:199], v[112:115]
v_mul_f32 v230, s66, v230
v_mul_f32 v231, s66, v231
v_cvt_pk_bf16_f32 v224, v224, v225
v_mfma_f32_16x16x32_bf16 v[116:119], a[212:215], v[196:199], v[116:119]
v_cvt_pk_bf16_f32 v225, v226, v227
v_cvt_pk_bf16_f32 v226, v228, v229
v_cvt_pk_bf16_f32 v227, v230, v231
v_mfma_f32_16x16x32_bf16 v[112:115], a[200:203], v[200:203], v[112:115]
v_mul_f32 v232, s66, v232
v_mul_f32 v233, s66, v233
v_mul_f32 v234, s66, v234
v_mfma_f32_16x16x32_bf16 v[116:119], a[216:219], v[200:203], v[116:119]
v_mul_f32 v235, s66, v235
v_mul_f32 v236, s66, v236
v_mul_f32 v237, s66, v237
v_exp_f32 v145, v145
v_exp_f32 v146, v146
v_cvt_pk_bf16_f32 v144, v144, v145
v_exp_f32 v147, v147
v_exp_f32 v148, v148
v_cvt_pk_bf16_f32 v145, v146, v147
v_exp_f32 v149, v149
v_exp_f32 v150, v150
v_cvt_pk_bf16_f32 v146, v148, v149
v_exp_f32 v151, v151
s_nop 0
v_cvt_pk_bf16_f32 v147, v150, v151
v_mfma_f32_16x16x32_bf16 v[112:115], a[204:207], v[204:207], v[112:115]
v_mul_f32 v238, s66, v238
v_mul_f32 v239, s66, v239
v_cvt_pk_bf16_f32 v228, v232, v233
v_mfma_f32_16x16x32_bf16 v[116:119], a[220:223], v[204:207], v[116:119]
v_cvt_pk_bf16_f32 v229, v234, v235
v_cvt_pk_bf16_f32 v230, v236, v237
v_cvt_pk_bf16_f32 v231, v238, v239
v_mfma_f32_16x16x32_bf16 a[64:67], a[224:227], v[144:147], 0
v_mul_f32 v240, s66, v240
v_mul_f32 v241, s66, v241
v_mul_f32 v242, s66, v242
s_barrier
v_mfma_f32_16x16x32_bf16 a[68:71], a[228:231], v[144:147], 0
v_mul_f32 v243, s66, v243
v_mul_f32 v244, s66, v244
v_mul_f32 v245, s66, v245
s_add_u32 s75, s75, 8192
v_mfma_f32_16x16x32_bf16 a[72:75], a[232:235], v[144:147], 0
v_mul_f32 v246, s66, v246
v_mul_f32 v247, s66, v247
v_cvt_pk_bf16_f32 v232, v240, v241
s_and_b32 s75, s75, 131071
v_mfma_f32_16x16x32_bf16 a[76:79], a[236:239], v[144:147], 0
s_add_u32 m0, s77, 0
v_cvt_pk_bf16_f32 v233, v242, v243
v_cvt_pk_bf16_f32 v234, v244, v245
v_cvt_pk_bf16_f32 v235, v246, v247
v_mfma_f32_16x16x32_bf16 a[80:83], a[240:243], v[144:147], 0
buffer_load_dwordx4 v6, s[36:39], s75 offen nt lds
v_mul_f32 v248, s66, v248
v_mul_f32 v249, s66, v249
v_mul_f32 v250, s66, v250
v_mfma_f32_16x16x32_bf16 a[84:87], a[244:247], v[144:147], 0
v_mul_f32 v251, s66, v251
v_mul_f32 v252, s66, v252
v_mul_f32 v253, s66, v253
v_mfma_f32_16x16x32_bf16 a[88:91], a[248:251], v[144:147], 0
v_mul_f32 v254, s66, v254
v_mul_f32 v255, s66, v255
v_cvt_pk_bf16_f32 v236, v248, v249
v_mfma_f32_16x16x32_bf16 a[92:95], a[252:255], v[144:147], 0
v_cvt_pk_bf16_f32 v237, v250, v251
v_cvt_pk_bf16_f32 v238, v252, v253
v_cvt_pk_bf16_f32 v239, v254, v255
v_mfma_f32_16x16x32_bf16 v[120:123], v[48:51], v[144:147], 0
v_exp_f32 v80, v80
v_mfma_f32_16x16x32_bf16 v[144:147], a[192:195], v[224:227], 0
buffer_load_dwordx4 v7, s[36:39], s75 offen offset:1024 nt lds
ds_read_b64 a[192:193], v20 offset:16384
ds_read_b64 a[194:195], v21 offset:16384
v_mfma_f32_16x16x32_bf16 v[148:151], a[208:211], v[224:227], 0
v_exp_f32 v81, v81
v_mfma_f32_16x16x32_bf16 v[144:147], a[196:199], v[228:231], v[144:147]
ds_read_b64 a[208:209], v20 offset:20480
ds_read_b64 a[210:211], v21 offset:20480
v_mfma_f32_16x16x32_bf16 v[148:151], a[212:215], v[228:231], v[148:151]
v_exp_f32 v82, v82
v_cvt_pk_bf16_f32 v80, v80, v81
v_mfma_f32_16x16x32_bf16 v[144:147], a[200:203], v[232:235], v[144:147]
ds_read_b64 a[196:197], v22 offset:16384
ds_read_b64 a[198:199], v23 offset:16384
v_mfma_f32_16x16x32_bf16 v[148:151], a[216:219], v[232:235], v[148:151]
buffer_load_dwordx4 v8, s[36:39], s75 offen offset:2048 nt lds
v_exp_f32 v83, v83
v_exp_f32 v84, v84
v_cvt_pk_bf16_f32 v81, v82, v83
v_exp_f32 v85, v85
v_exp_f32 v86, v86
v_cvt_pk_bf16_f32 v82, v84, v85
v_exp_f32 v87, v87
s_nop 0
v_cvt_pk_bf16_f32 v83, v86, v87
v_mfma_f32_16x16x32_bf16 v[144:147], a[204:207], v[236:239], v[144:147]
ds_read_b64 a[212:213], v22 offset:20480
ds_read_b64 a[214:215], v23 offset:20480
v_mfma_f32_16x16x32_bf16 v[148:151], a[220:223], v[236:239], v[148:151]
v_exp_f32 v112, v112
v_mfma_f32_16x16x32_bf16 a[96:99], a[224:227], v[80:83], 0
ds_read_b64 a[200:201], v24 offset:16384
ds_read_b64 a[202:203], v25 offset:16384
v_mfma_f32_16x16x32_bf16 a[100:103], a[228:231], v[80:83], 0
v_exp_f32 v113, v113
v_mfma_f32_16x16x32_bf16 a[104:107], a[232:235], v[80:83], 0
buffer_load_dwordx4 v9, s[36:39], s75 offen offset:3072 nt lds
ds_read_b64 a[216:217], v24 offset:20480
ds_read_b64 a[218:219], v25 offset:20480
v_mfma_f32_16x16x32_bf16 a[108:111], a[236:239], v[80:83], 0
s_add_u32 s76, s76, 8192
v_exp_f32 v114, v114
v_cvt_pk_bf16_f32 v112, v112, v113
v_mfma_f32_16x16x32_bf16 a[112:115], a[240:243], v[80:83], 0
ds_read_b64 a[204:205], v26 offset:16384
ds_read_b64 a[206:207], v27 offset:16384
s_and_b32 s76, s76, 131071
v_mfma_f32_16x16x32_bf16 a[116:119], a[244:247], v[80:83], 0
s_add_u32 m0, s77, 65536
v_exp_f32 v115, v115
v_mfma_f32_16x16x32_bf16 a[120:123], a[248:251], v[80:83], 0
ds_read_b64 a[220:221], v26 offset:20480
ds_read_b64 a[222:223], v27 offset:20480
v_mfma_f32_16x16x32_bf16 a[124:127], a[252:255], v[80:83], 0
buffer_load_dwordx4 v10, s[40:43], s76 offen nt lds
v_exp_f32 v116, v116
v_mfma_f32_16x16x32_bf16 v[124:127], v[48:51], v[80:83], 0
v_cvt_pk_bf16_f32 v113, v114, v115
v_exp_f32 v117, v117
s_waitcnt lgkmcnt(3)
v_mfma_f32_16x16x32_bf16 v[80:83], a[192:195], v[64:67], 0
v_exp_f32 v118, v118
v_cvt_pk_bf16_f32 v114, v116, v117
v_mfma_f32_16x16x32_bf16 v[84:87], a[208:211], v[64:67], 0
v_exp_f32 v144, v144
v_mfma_f32_16x16x32_bf16 v[80:83], a[196:199], v[68:71], v[80:83]
v_exp_f32 v119, v119
v_mfma_f32_16x16x32_bf16 v[84:87], a[212:215], v[68:71], v[84:87]
buffer_load_dwordx4 v19, s[40:43], s76 offen offset:1024 nt lds
v_exp_f32 v145, v145
v_mfma_f32_16x16x32_bf16 v[80:83], a[200:203], v[72:75], v[80:83]
v_cvt_pk_bf16_f32 v115, v118, v119
v_exp_f32 v146, v146
v_mfma_f32_16x16x32_bf16 v[84:87], a[216:219], v[72:75], v[84:87]
v_cvt_pk_bf16_f32 v144, v144, v145
s_waitcnt lgkmcnt(0)
v_mfma_f32_16x16x32_bf16 v[80:83], a[204:207], v[76:79], v[80:83]
v_mfma_f32_16x16x32_bf16 v[84:87], a[220:223], v[76:79], v[84:87]
v_exp_f32 v147, v147
v_mfma_f32_16x16x32_bf16 a[128:131], a[224:227], v[112:115], 0
buffer_load_dwordx4 v10, s[40:43], s76 offen offset:2048 nt lds
v_mfma_f32_16x16x32_bf16 a[132:135], a[228:231], v[112:115], 0
v_exp_f32 v148, v148
v_mfma_f32_16x16x32_bf16 a[136:139], a[232:235], v[112:115], 0
s_barrier
v_mfma_f32_16x16x32_bf16 a[140:143], a[236:239], v[112:115], 0
v_cvt_pk_bf16_f32 v145, v146, v147
v_mfma_f32_16x16x32_bf16 a[144:147], a[240:243], v[112:115], 0
v_mfma_f32_16x16x32_bf16 a[148:151], a[244:247], v[112:115], 0
buffer_load_dwordx4 v19, s[40:43], s76 offen offset:3072 nt lds
v_exp_f32 v149, v149
v_mfma_f32_16x16x32_bf16 a[152:155], a[248:251], v[112:115], 0
v_mfma_f32_16x16x32_bf16 a[156:159], a[252:255], v[112:115], 0
v_exp_f32 v150, v150
v_mfma_f32_16x16x32_bf16 v[152:155], v[48:51], v[112:115], 0
v_mfma_f32_16x16x32_bf16 v[112:115], a[192:195], v[96:99], 0
v_cvt_pk_bf16_f32 v146, v148, v149
v_exp_f32 v80, v80
v_mfma_f32_16x16x32_bf16 v[116:119], a[208:211], v[96:99], 0
v_exp_f32 v81, v81
v_mfma_f32_16x16x32_bf16 v[112:115], a[196:199], v[100:103], v[112:115]
v_exp_f32 v151, v151
v_mfma_f32_16x16x32_bf16 v[116:119], a[212:215], v[100:103], v[116:119]
v_exp_f32 v82, v82
v_mfma_f32_16x16x32_bf16 v[112:115], a[200:203], v[104:107], v[112:115]
v_cvt_pk_bf16_f32 v147, v150, v151
v_mfma_f32_16x16x32_bf16 v[116:119], a[216:219], v[104:107], v[116:119]
s_add_u32 s75, s75, 8192
v_cvt_pk_bf16_f32 v80, v80, v81
v_mfma_f32_16x16x32_bf16 v[112:115], a[204:207], v[108:111], v[112:115]
s_and_b32 s75, s75, 131071
v_mfma_f32_16x16x32_bf16 v[116:119], a[220:223], v[108:111], v[116:119]
s_add_u32 m0, s77, 16384
v_exp_f32 v83, v83
v_mfma_f32_16x16x32_bf16 a[160:163], a[224:227], v[144:147], 0
buffer_load_dwordx4 v6, s[36:39], s75 offen nt lds
ds_read_b64_tr_b16 a[224:225], v28 offset:16384
ds_read_b64_tr_b16 a[226:227], v28 offset:20480
v_mfma_f32_16x16x32_bf16 a[164:167], a[228:231], v[144:147], 0
v_exp_f32 v84, v84
v_mfma_f32_16x16x32_bf16 a[168:171], a[232:235], v[144:147], 0
ds_read_b64_tr_b16 a[228:229], v29 offset:16384
ds_read_b64_tr_b16 a[230:231], v29 offset:20480
v_mfma_f32_16x16x32_bf16 a[172:175], a[236:239], v[144:147], 0
v_cvt_pk_bf16_f32 v81, v82, v83
v_mfma_f32_16x16x32_bf16 a[176:179], a[240:243], v[144:147], 0
ds_read_b64_tr_b16 a[232:233], v30 offset:16384
ds_read_b64_tr_b16 a[234:235], v30 offset:20480
v_lshlrev_b32 v178, 7, v42
v_mfma_f32_16x16x32_bf16 a[180:183], a[244:247], v[144:147], 0
v_exp_f32 v85, v85
v_mfma_f32_16x16x32_bf16 a[184:187], a[248:251], v[144:147], 0
buffer_load_dword v178, v178, s[52:55], s0 offen
ds_read_b64_tr_b16 a[236:237], v31 offset:16384
ds_read_b64_tr_b16 a[238:239], v31 offset:20480
v_mfma_f32_16x16x32_bf16 a[188:191], a[252:255], v[144:147], 0
v_exp_f32 v86, v86
v_mfma_f32_16x16x32_bf16 v[156:159], v[48:51], v[144:147], 0
buffer_load_dwordx4 v7, s[36:39], s75 offen offset:1024 nt lds
ds_read_b64_tr_b16 a[240:241], v44 offset:16384
ds_read_b64_tr_b16 a[242:243], v44 offset:20480
v_mfma_f32_16x16x32_bf16 v[144:147], a[192:195], v[128:131], 0
v_cvt_pk_bf16_f32 v82, v84, v85
v_exp_f32 v112, v112
v_mfma_f32_16x16x32_bf16 v[148:151], a[208:211], v[128:131], 0
ds_read_b64_tr_b16 a[244:245], v45 offset:16384
ds_read_b64_tr_b16 a[246:247], v45 offset:20480
v_mfma_f32_16x16x32_bf16 v[144:147], a[196:199], v[132:135], v[144:147]
v_exp_f32 v87, v87
v_mfma_f32_16x16x32_bf16 v[148:151], a[212:215], v[132:135], v[148:151]
ds_read_b64_tr_b16 a[248:249], v46 offset:16384
ds_read_b64_tr_b16 a[250:251], v46 offset:20480
v_mfma_f32_16x16x32_bf16 v[144:147], a[200:203], v[136:139], v[144:147]
v_cvt_pk_bf16_f32 v83, v86, v87
v_exp_f32 v113, v113
v_mfma_f32_16x16x32_bf16 v[148:151], a[216:219], v[136:139], v[148:151]
ds_read_b64_tr_b16 a[252:253], v47 offset:16384
ds_read_b64_tr_b16 a[254:255], v47 offset:20480
v_mfma_f32_16x16x32_bf16 v[144:147], a[204:207], v[140:143], v[144:147]
v_exp_f32 v114, v114
v_cvt_pk_bf16_f32 v112, v112, v113
v_mfma_f32_16x16x32_bf16 v[148:151], a[220:223], v[140:143], v[148:151]
buffer_load_dwordx4 v8, s[36:39], s75 offen offset:2048 nt lds
v_exp_f32 v115, v115
s_waitcnt lgkmcnt(4)
v_mfma_f32_16x16x32_bf16 a[0:3], a[224:227], v[80:83], a[0:3]
v_mfma_f32_16x16x32_bf16 a[4:7], a[228:231], v[80:83], a[4:7]
v_exp_f32 v116, v116
v_mfma_f32_16x16x32_bf16 a[8:11], a[232:235], v[80:83], a[8:11]
v_mfma_f32_16x16x32_bf16 a[12:15], a[236:239], v[80:83], a[12:15]
v_cvt_pk_bf16_f32 v113, v114, v115
v_mfma_f32_16x16x32_bf16 a[16:19], a[240:243], v[80:83], a[16:19]
v_mfma_f32_16x16x32_bf16 a[20:23], a[244:247], v[80:83], a[20:23]
v_exp_f32 v117, v117
s_waitcnt lgkmcnt(0)
v_mfma_f32_16x16x32_bf16 a[24:27], a[248:251], v[80:83], a[24:27]
v_mfma_f32_16x16x32_bf16 a[28:31], a[252:255], v[80:83], a[28:31]
buffer_load_dwordx4 v9, s[36:39], s75 offen offset:3072 nt lds
v_exp_f32 v118, v118
v_mfma_f32_16x16x32_bf16 v[88:91], v[48:51], v[80:83], v[88:91]
v_mfma_f32_16x16x32_bf16 v[80:83], a[192:195], v[160:163], 0
v_cvt_pk_bf16_f32 v114, v116, v117
v_exp_f32 v144, v144
v_mfma_f32_16x16x32_bf16 v[84:87], a[208:211], v[160:163], 0
v_exp_f32 v145, v145
v_mfma_f32_16x16x32_bf16 v[80:83], a[196:199], v[164:167], v[80:83]
v_exp_f32 v119, v119
v_mfma_f32_16x16x32_bf16 v[84:87], a[212:215], v[164:167], v[84:87]
v_exp_f32 v146, v146
v_mfma_f32_16x16x32_bf16 v[80:83], a[200:203], v[168:171], v[80:83]
v_cvt_pk_bf16_f32 v115, v118, v119
v_mfma_f32_16x16x32_bf16 v[84:87], a[216:219], v[168:171], v[84:87]
v_cvt_pk_bf16_f32 v144, v144, v145
v_mfma_f32_16x16x32_bf16 v[80:83], a[204:207], v[172:175], v[80:83]
v_mfma_f32_16x16x32_bf16 v[84:87], a[220:223], v[172:175], v[84:87]
v_exp_f32 v147, v147
v_mfma_f32_16x16x32_bf16 a[32:35], a[224:227], v[112:115], a[32:35]
v_mov_b32 v181, 1
v_mfma_f32_16x16x32_bf16 a[36:39], a[228:231], v[112:115], a[36:39]
v_lshlrev_b32 v182, 16, v1
v_exp_f32 v148, v148
v_mfma_f32_16x16x32_bf16 a[40:43], a[232:235], v[112:115], a[40:43]
v_mfma_f32_16x16x32_bf16 a[44:47], a[236:239], v[112:115], a[44:47]
v_cvt_pk_bf16_f32 v145, v146, v147
v_mfma_f32_16x16x32_bf16 a[48:51], a[240:243], v[112:115], a[48:51]
v_mfma_f32_16x16x32_bf16 a[52:55], a[244:247], v[112:115], a[52:55]
v_exp_f32 v149, v149
v_mfma_f32_16x16x32_bf16 a[56:59], a[248:251], v[112:115], a[56:59]
v_mfma_f32_16x16x32_bf16 a[60:63], a[252:255], v[112:115], a[60:63]
v_exp_f32 v150, v150
v_mfma_f32_16x16x32_bf16 v[92:95], v[48:51], v[112:115], v[92:95]
v_mfma_f32_16x16x32_bf16 v[112:115], a[192:195], v[192:195], 0
v_cvt_pk_bf16_f32 v146, v148, v149
v_exp_f32 v80, v80
v_mfma_f32_16x16x32_bf16 v[116:119], a[208:211], v[192:195], 0
v_exp_f32 v81, v81
v_mfma_f32_16x16x32_bf16 v[112:115], a[196:199], v[196:199], v[112:115]
v_exp_f32 v151, v151
v_mfma_f32_16x16x32_bf16 v[116:119], a[212:215], v[196:199], v[116:119]
v_exp_f32 v82, v82
v_mfma_f32_16x16x32_bf16 v[112:115], a[200:203], v[200:203], v[112:115]
v_cvt_pk_bf16_f32 v147, v150, v151
v_mfma_f32_16x16x32_bf16 v[116:119], a[216:219], v[200:203], v[116:119]
v_cvt_pk_bf16_f32 v80, v80, v81
v_mfma_f32_16x16x32_bf16 v[112:115], a[204:207], v[204:207], v[112:115]
v_mfma_f32_16x16x32_bf16 v[116:119], a[220:223], v[204:207], v[116:119]
v_exp_f32 v83, v83
v_mfma_f32_16x16x32_bf16 a[64:67], a[224:227], v[144:147], a[64:67]
s_waitcnt vmcnt(28)
s_barrier
v_mfma_f32_16x16x32_bf16 a[68:71], a[228:231], v[144:147], a[68:71]
s_add_u32 s76, s76, 8192
v_exp_f32 v84, v84
v_mfma_f32_16x16x32_bf16 a[72:75], a[232:235], v[144:147], a[72:75]
s_and_b32 s76, s76, 131071
v_mfma_f32_16x16x32_bf16 a[76:79], a[236:239], v[144:147], a[76:79]
s_add_u32 m0, s77, 81920
v_cvt_pk_bf16_f32 v81, v82, v83
v_mfma_f32_16x16x32_bf16 a[80:83], a[240:243], v[144:147], a[80:83]
buffer_load_dwordx4 v10, s[40:43], s76 offen nt lds
v_mfma_f32_16x16x32_bf16 a[84:87], a[244:247], v[144:147], a[84:87]
v_exp_f32 v85, v85
v_mfma_f32_16x16x32_bf16 a[88:91], a[248:251], v[144:147], a[88:91]
v_mfma_f32_16x16x32_bf16 a[92:95], a[252:255], v[144:147], a[92:95]
v_exp_f32 v86, v86
v_mfma_f32_16x16x32_bf16 v[120:123], v[48:51], v[144:147], v[120:123]
v_mfma_f32_16x16x32_bf16 v[144:147], a[192:195], v[224:227], 0
ds_read_b64 a[192:193], v20 offset:32768
ds_read_b64 a[194:195], v21 offset:32768
v_cvt_pk_bf16_f32 v82, v84, v85
v_mfma_f32_16x16x32_bf16 v[148:151], a[208:211], v[224:227], 0
v_exp_f32 v112, v112
v_mfma_f32_16x16x32_bf16 v[144:147], a[196:199], v[228:231], v[144:147]
ds_read_b64 a[208:209], v20 offset:36864
ds_read_b64 a[210:211], v21 offset:36864
v_mfma_f32_16x16x32_bf16 v[148:151], a[212:215], v[228:231], v[148:151]
buffer_load_dwordx4 v19, s[40:43], s76 offen offset:1024 nt lds
v_exp_f32 v87, v87
v_mfma_f32_16x16x32_bf16 v[144:147], a[200:203], v[232:235], v[144:147]
ds_read_b64 a[196:197], v22 offset:32768
ds_read_b64 a[198:199], v23 offset:32768
v_cvt_pk_bf16_f32 v83, v86, v87
v_mfma_f32_16x16x32_bf16 v[148:151], a[216:219], v[232:235], v[148:151]
v_exp_f32 v113, v113
v_mfma_f32_16x16x32_bf16 v[144:147], a[204:207], v[236:239], v[144:147]
ds_read_b64 a[212:213], v22 offset:36864
ds_read_b64 a[214:215], v23 offset:36864
v_mfma_f32_16x16x32_bf16 v[148:151], a[220:223], v[236:239], v[148:151]
v_exp_f32 v114, v114
v_cvt_pk_bf16_f32 v112, v112, v113
v_mfma_f32_16x16x32_bf16 a[96:99], a[224:227], v[80:83], a[96:99]
ds_read_b64 a[200:201], v24 offset:32768
ds_read_b64 a[202:203], v25 offset:32768
v_mfma_f32_16x16x32_bf16 a[100:103], a[228:231], v[80:83], a[100:103]
v_exp_f32 v115, v115
v_mfma_f32_16x16x32_bf16 a[104:107], a[232:235], v[80:83], a[104:107]
ds_read_b64 a[216:217], v24 offset:36864
ds_read_b64 a[218:219], v25 offset:36864
v_mfma_f32_16x16x32_bf16 a[108:111], a[236:239], v[80:83], a[108:111]
buffer_load_dwordx4 v10, s[40:43], s76 offen offset:2048 nt lds
v_exp_f32 v116, v116
v_mfma_f32_16x16x32_bf16 a[112:115], a[240:243], v[80:83], a[112:115]
ds_read_b64 a[204:205], v26 offset:32768
ds_read_b64 a[206:207], v27 offset:32768
v_cvt_pk_bf16_f32 v113, v114, v115
v_mfma_f32_16x16x32_bf16 a[116:119], a[244:247], v[80:83], a[116:119]
v_exp_f32 v117, v117
v_mfma_f32_16x16x32_bf16 a[120:123], a[248:251], v[80:83], a[120:123]
ds_read_b64 a[220:221], v26 offset:36864
ds_read_b64 a[222:223], v27 offset:36864
v_mfma_f32_16x16x32_bf16 a[124:127], a[252:255], v[80:83], a[124:127]
v_exp_f32 v118, v118
v_mfma_f32_16x16x32_bf16 v[124:127], v[48:51], v[80:83], v[124:127]
s_waitcnt lgkmcnt(4)
v_mfma_f32_16x16x32_bf16 v[80:83], a[192:195], v[64:67], 0
v_cvt_pk_bf16_f32 v114, v116, v117
v_exp_f32 v144, v144
v_mfma_f32_16x16x32_bf16 v[84:87], a[208:211], v[64:67], 0
v_exp_f32 v145, v145
v_mfma_f32_16x16x32_bf16 v[80:83], a[196:199], v[68:71], v[80:83]
buffer_load_dwordx4 v19, s[40:43], s76 offen offset:3072 nt lds
v_exp_f32 v119, v119
v_mfma_f32_16x16x32_bf16 v[84:87], a[212:215], v[68:71], v[84:87]
v_exp_f32 v146, v146
v_mfma_f32_16x16x32_bf16 v[80:83], a[200:203], v[72:75], v[80:83]
v_cvt_pk_bf16_f32 v115, v118, v119
v_mfma_f32_16x16x32_bf16 v[84:87], a[216:219], v[72:75], v[84:87]
v_cvt_pk_bf16_f32 v144, v144, v145
s_waitcnt lgkmcnt(0)
v_mfma_f32_16x16x32_bf16 v[80:83], a[204:207], v[76:79], v[80:83]
v_mfma_f32_16x16x32_bf16 v[84:87], a[220:223], v[76:79], v[84:87]
v_exp_f32 v147, v147
v_mfma_f32_16x16x32_bf16 a[128:131], a[224:227], v[112:115], a[128:131]
v_mfma_f32_16x16x32_bf16 a[132:135], a[228:231], v[112:115], a[132:135]
v_exp_f32 v148, v148
v_mfma_f32_16x16x32_bf16 a[136:139], a[232:235], v[112:115], a[136:139]
s_waitcnt vmcnt(22)
s_barrier
v_mfma_f32_16x16x32_bf16 a[140:143], a[236:239], v[112:115], a[140:143]
s_add_u32 s75, s75, 8192
v_cvt_pk_bf16_f32 v145, v146, v147
v_mfma_f32_16x16x32_bf16 a[144:147], a[240:243], v[112:115], a[144:147]
s_and_b32 s75, s75, 131071
v_mfma_f32_16x16x32_bf16 a[148:151], a[244:247], v[112:115], a[148:151]
s_add_u32 m0, s77, 32768
v_exp_f32 v149, v149
v_mfma_f32_16x16x32_bf16 a[152:155], a[248:251], v[112:115], a[152:155]
buffer_load_dwordx4 v6, s[36:39], s75 offen nt lds
v_mfma_f32_16x16x32_bf16 a[156:159], a[252:255], v[112:115], a[156:159]
v_exp_f32 v150, v150
v_mfma_f32_16x16x32_bf16 v[152:155], v[48:51], v[112:115], v[152:155]
v_mfma_f32_16x16x32_bf16 v[112:115], a[192:195], v[96:99], 0
v_cvt_pk_bf16_f32 v146, v148, v149
v_exp_f32 v80, v80
v_mfma_f32_16x16x32_bf16 v[116:119], a[208:211], v[96:99], 0
v_exp_f32 v81, v81
v_mfma_f32_16x16x32_bf16 v[112:115], a[196:199], v[100:103], v[112:115]
v_exp_f32 v151, v151
v_mfma_f32_16x16x32_bf16 v[116:119], a[212:215], v[100:103], v[116:119]
v_exp_f32 v82, v82
v_mfma_f32_16x16x32_bf16 v[112:115], a[200:203], v[104:107], v[112:115]
v_cvt_pk_bf16_f32 v147, v150, v151
v_mfma_f32_16x16x32_bf16 v[116:119], a[216:219], v[104:107], v[116:119]
v_cvt_pk_bf16_f32 v80, v80, v81
v_mfma_f32_16x16x32_bf16 v[112:115], a[204:207], v[108:111], v[112:115]
v_mfma_f32_16x16x32_bf16 v[116:119], a[220:223], v[108:111], v[116:119]
v_exp_f32 v83, v83
v_mfma_f32_16x16x32_bf16 a[160:163], a[224:227], v[144:147], a[160:163]
ds_read_b64_tr_b16 a[224:225], v28 offset:32768
ds_read_b64_tr_b16 a[226:227], v28 offset:36864
v_mfma_f32_16x16x32_bf16 a[164:167], a[228:231], v[144:147], a[164:167]
buffer_load_dwordx4 v7, s[36:39], s75 offen offset:1024 nt lds
v_exp_f32 v84, v84
v_mfma_f32_16x16x32_bf16 a[168:171], a[232:235], v[144:147], a[168:171]
ds_read_b64_tr_b16 a[228:229], v29 offset:32768
ds_read_b64_tr_b16 a[230:231], v29 offset:36864
v_mfma_f32_16x16x32_bf16 a[172:175], a[236:239], v[144:147], a[172:175]
v_cvt_pk_bf16_f32 v81, v82, v83
v_mfma_f32_16x16x32_bf16 a[176:179], a[240:243], v[144:147], a[176:179]
ds_read_b64_tr_b16 a[232:233], v30 offset:32768
ds_read_b64_tr_b16 a[234:235], v30 offset:36864
v_mfma_f32_16x16x32_bf16 a[180:183], a[244:247], v[144:147], a[180:183]
v_exp_f32 v85, v85
v_mfma_f32_16x16x32_bf16 a[184:187], a[248:251], v[144:147], a[184:187]
ds_read_b64_tr_b16 a[236:237], v31 offset:32768
ds_read_b64_tr_b16 a[238:239], v31 offset:36864
v_mfma_f32_16x16x32_bf16 a[188:191], a[252:255], v[144:147], a[188:191]
v_exp_f32 v86, v86
v_mfma_f32_16x16x32_bf16 v[156:159], v[48:51], v[144:147], v[156:159]
ds_read_b64_tr_b16 a[240:241], v44 offset:32768
ds_read_b64_tr_b16 a[242:243], v44 offset:36864
v_mfma_f32_16x16x32_bf16 v[144:147], a[192:195], v[128:131], 0
v_cvt_pk_bf16_f32 v82, v84, v85
v_exp_f32 v112, v112
v_mfma_f32_16x16x32_bf16 v[148:151], a[208:211], v[128:131], 0
ds_read_b64_tr_b16 a[244:245], v45 offset:32768
ds_read_b64_tr_b16 a[246:247], v45 offset:36864
v_mfma_f32_16x16x32_bf16 v[144:147], a[196:199], v[132:135], v[144:147]
v_exp_f32 v87, v87
v_mfma_f32_16x16x32_bf16 v[148:151], a[212:215], v[132:135], v[148:151]
ds_read_b64_tr_b16 a[248:249], v46 offset:32768
ds_read_b64_tr_b16 a[250:251], v46 offset:36864
v_mfma_f32_16x16x32_bf16 v[144:147], a[200:203], v[136:139], v[144:147]
buffer_load_dwordx4 v8, s[36:39], s75 offen offset:2048 nt lds
v_cvt_pk_bf16_f32 v83, v86, v87
v_mfma_f32_16x16x32_bf16 v[148:151], a[216:219], v[136:139], v[148:151]
ds_read_b64_tr_b16 a[252:253], v47 offset:32768
ds_read_b64_tr_b16 a[254:255], v47 offset:36864
v_mfma_f32_16x16x32_bf16 v[144:147], a[204:207], v[140:143], v[144:147]
v_exp_f32 v113, v113
v_mfma_f32_16x16x32_bf16 v[148:151], a[220:223], v[140:143], v[148:151]
v_exp_f32 v114, v114
v_cvt_pk_bf16_f32 v112, v112, v113
s_waitcnt lgkmcnt(4)
v_mfma_f32_16x16x32_bf16 a[0:3], a[224:227], v[80:83], a[0:3]
v_exp_f32 v115, v115
v_mfma_f32_16x16x32_bf16 a[4:7], a[228:231], v[80:83], a[4:7]
v_exp_f32 v116, v116
v_mfma_f32_16x16x32_bf16 a[8:11], a[232:235], v[80:83], a[8:11]
v_mfma_f32_16x16x32_bf16 a[12:15], a[236:239], v[80:83], a[12:15]
v_cvt_pk_bf16_f32 v113, v114, v115
v_mfma_f32_16x16x32_bf16 a[16:19], a[240:243], v[80:83], a[16:19]
v_mfma_f32_16x16x32_bf16 a[20:23], a[244:247], v[80:83], a[20:23]
v_exp_f32 v117, v117
s_waitcnt lgkmcnt(0)
v_mfma_f32_16x16x32_bf16 a[24:27], a[248:251], v[80:83], a[24:27]
v_mfma_f32_16x16x32_bf16 a[28:31], a[252:255], v[80:83], a[28:31]
v_exp_f32 v118, v118
v_mfma_f32_16x16x32_bf16 v[88:91], v[48:51], v[80:83], v[88:91]
buffer_load_dwordx4 v9, s[36:39], s75 offen offset:3072 nt lds
v_mfma_f32_16x16x32_bf16 v[80:83], a[192:195], v[160:163], 0
v_cvt_pk_bf16_f32 v114, v116, v117
v_exp_f32 v144, v144
v_mfma_f32_16x16x32_bf16 v[84:87], a[208:211], v[160:163], 0
v_exp_f32 v145, v145
v_mfma_f32_16x16x32_bf16 v[80:83], a[196:199], v[164:167], v[80:83]
v_exp_f32 v119, v119
v_mfma_f32_16x16x32_bf16 v[84:87], a[212:215], v[164:167], v[84:87]
v_exp_f32 v146, v146
v_mfma_f32_16x16x32_bf16 v[80:83], a[200:203], v[168:171], v[80:83]
v_cvt_pk_bf16_f32 v115, v118, v119
v_mfma_f32_16x16x32_bf16 v[84:87], a[216:219], v[168:171], v[84:87]
v_cvt_pk_bf16_f32 v144, v144, v145
v_mfma_f32_16x16x32_bf16 v[80:83], a[204:207], v[172:175], v[80:83]
v_mfma_f32_16x16x32_bf16 v[84:87], a[220:223], v[172:175], v[84:87]
v_exp_f32 v147, v147
v_mfma_f32_16x16x32_bf16 a[32:35], a[224:227], v[112:115], a[32:35]
v_mfma_f32_16x16x32_bf16 a[36:39], a[228:231], v[112:115], a[36:39]
v_exp_f32 v148, v148
v_mfma_f32_16x16x32_bf16 a[40:43], a[232:235], v[112:115], a[40:43]
v_mfma_f32_16x16x32_bf16 a[44:47], a[236:239], v[112:115], a[44:47]
v_cvt_pk_bf16_f32 v145, v146, v147
v_mfma_f32_16x16x32_bf16 a[48:51], a[240:243], v[112:115], a[48:51]
v_mfma_f32_16x16x32_bf16 a[52:55], a[244:247], v[112:115], a[52:55]
v_exp_f32 v149, v149
v_mfma_f32_16x16x32_bf16 a[56:59], a[248:251], v[112:115], a[56:59]
v_mfma_f32_16x16x32_bf16 a[60:63], a[252:255], v[112:115], a[60:63]
v_exp_f32 v150, v150
v_mfma_f32_16x16x32_bf16 v[92:95], v[48:51], v[112:115], v[92:95]
v_mfma_f32_16x16x32_bf16 v[112:115], a[192:195], v[192:195], 0
v_cvt_pk_bf16_f32 v146, v148, v149
v_exp_f32 v80, v80
v_mfma_f32_16x16x32_bf16 v[116:119], a[208:211], v[192:195], 0
v_exp_f32 v81, v81
v_mfma_f32_16x16x32_bf16 v[112:115], a[196:199], v[196:199], v[112:115]
v_exp_f32 v151, v151
v_mfma_f32_16x16x32_bf16 v[116:119], a[212:215], v[196:199], v[116:119]
v_exp_f32 v82, v82
v_mfma_f32_16x16x32_bf16 v[112:115], a[200:203], v[200:203], v[112:115]
v_cvt_pk_bf16_f32 v147, v150, v151
v_mfma_f32_16x16x32_bf16 v[116:119], a[216:219], v[200:203], v[116:119]
v_cvt_pk_bf16_f32 v80, v80, v81
v_mfma_f32_16x16x32_bf16 v[112:115], a[204:207], v[204:207], v[112:115]
v_mfma_f32_16x16x32_bf16 v[116:119], a[220:223], v[204:207], v[116:119]
v_exp_f32 v83, v83
v_mfma_f32_16x16x32_bf16 a[64:67], a[224:227], v[144:147], a[64:67]
s_waitcnt vmcnt(21)
s_barrier
v_mfma_f32_16x16x32_bf16 a[68:71], a[228:231], v[144:147], a[68:71]
s_add_u32 s76, s76, 8192
v_exp_f32 v84, v84
v_mfma_f32_16x16x32_bf16 a[72:75], a[232:235], v[144:147], a[72:75]
s_and_b32 s76, s76, 131071
s_add_u32 s64, s15, 0
v_mfma_f32_16x16x32_bf16 a[76:79], a[236:239], v[144:147], a[76:79]
s_add_u32 m0, s77, 98304
buffer_atomic_add v181, v182, s[4:7], s64 offen sc1
v_cvt_pk_bf16_f32 v81, v82, v83
v_mfma_f32_16x16x32_bf16 a[80:83], a[240:243], v[144:147], a[80:83]
buffer_load_dwordx4 v10, s[40:43], s76 offen nt lds
v_mfma_f32_16x16x32_bf16 a[84:87], a[244:247], v[144:147], a[84:87]
v_exp_f32 v85, v85
v_mfma_f32_16x16x32_bf16 a[88:91], a[248:251], v[144:147], a[88:91]
v_mfma_f32_16x16x32_bf16 a[92:95], a[252:255], v[144:147], a[92:95]
v_exp_f32 v86, v86
v_mfma_f32_16x16x32_bf16 v[120:123], v[48:51], v[144:147], v[120:123]
v_mfma_f32_16x16x32_bf16 v[144:147], a[192:195], v[224:227], 0
ds_read_b64 a[192:193], v20 offset:49152
ds_read_b64 a[194:195], v21 offset:49152
v_cvt_pk_bf16_f32 v82, v84, v85
v_mfma_f32_16x16x32_bf16 v[148:151], a[208:211], v[224:227], 0
v_exp_f32 v112, v112
v_mfma_f32_16x16x32_bf16 v[144:147], a[196:199], v[228:231], v[144:147]
ds_read_b64 a[208:209], v20 offset:53248
ds_read_b64 a[210:211], v21 offset:53248
v_mfma_f32_16x16x32_bf16 v[148:151], a[212:215], v[228:231], v[148:151]
buffer_load_dwordx4 v19, s[40:43], s76 offen offset:1024 nt lds
v_exp_f32 v87, v87
v_mfma_f32_16x16x32_bf16 v[144:147], a[200:203], v[232:235], v[144:147]
ds_read_b64 a[196:197], v22 offset:49152
ds_read_b64 a[198:199], v23 offset:49152
v_cvt_pk_bf16_f32 v83, v86, v87
v_mfma_f32_16x16x32_bf16 v[148:151], a[216:219], v[232:235], v[148:151]
v_exp_f32 v113, v113
v_mfma_f32_16x16x32_bf16 v[144:147], a[204:207], v[236:239], v[144:147]
ds_read_b64 a[212:213], v22 offset:53248
ds_read_b64 a[214:215], v23 offset:53248
v_mfma_f32_16x16x32_bf16 v[148:151], a[220:223], v[236:239], v[148:151]
v_exp_f32 v114, v114
v_cvt_pk_bf16_f32 v112, v112, v113
v_mfma_f32_16x16x32_bf16 a[96:99], a[224:227], v[80:83], a[96:99]
ds_read_b64 a[200:201], v24 offset:49152
ds_read_b64 a[202:203], v25 offset:49152
v_mfma_f32_16x16x32_bf16 a[100:103], a[228:231], v[80:83], a[100:103]
v_exp_f32 v115, v115
v_mfma_f32_16x16x32_bf16 a[104:107], a[232:235], v[80:83], a[104:107]
ds_read_b64 a[216:217], v24 offset:53248
ds_read_b64 a[218:219], v25 offset:53248
v_mfma_f32_16x16x32_bf16 a[108:111], a[236:239], v[80:83], a[108:111]
buffer_load_dwordx4 v10, s[40:43], s76 offen offset:2048 nt lds
v_exp_f32 v116, v116
v_mfma_f32_16x16x32_bf16 a[112:115], a[240:243], v[80:83], a[112:115]
ds_read_b64 a[204:205], v26 offset:49152
ds_read_b64 a[206:207], v27 offset:49152
v_cvt_pk_bf16_f32 v113, v114, v115
v_mfma_f32_16x16x32_bf16 a[116:119], a[244:247], v[80:83], a[116:119]
v_exp_f32 v117, v117
v_mfma_f32_16x16x32_bf16 a[120:123], a[248:251], v[80:83], a[120:123]
ds_read_b64 a[220:221], v26 offset:53248
ds_read_b64 a[222:223], v27 offset:53248
v_mfma_f32_16x16x32_bf16 a[124:127], a[252:255], v[80:83], a[124:127]
v_exp_f32 v118, v118
v_mfma_f32_16x16x32_bf16 v[124:127], v[48:51], v[80:83], v[124:127]
s_waitcnt lgkmcnt(4)
v_mfma_f32_16x16x32_bf16 v[80:83], a[192:195], v[64:67], 0
v_cvt_pk_bf16_f32 v114, v116, v117
v_exp_f32 v144, v144
v_mfma_f32_16x16x32_bf16 v[84:87], a[208:211], v[64:67], 0
v_exp_f32 v145, v145
v_mfma_f32_16x16x32_bf16 v[80:83], a[196:199], v[68:71], v[80:83]
buffer_load_dwordx4 v19, s[40:43], s76 offen offset:3072 nt lds
v_exp_f32 v119, v119
v_mfma_f32_16x16x32_bf16 v[84:87], a[212:215], v[68:71], v[84:87]
v_exp_f32 v146, v146
v_mfma_f32_16x16x32_bf16 v[80:83], a[200:203], v[72:75], v[80:83]
v_cvt_pk_bf16_f32 v115, v118, v119
v_mfma_f32_16x16x32_bf16 v[84:87], a[216:219], v[72:75], v[84:87]
v_cvt_pk_bf16_f32 v144, v144, v145
s_waitcnt lgkmcnt(0)
v_mfma_f32_16x16x32_bf16 v[80:83], a[204:207], v[76:79], v[80:83]
v_mfma_f32_16x16x32_bf16 v[84:87], a[220:223], v[76:79], v[84:87]
v_exp_f32 v147, v147
v_mfma_f32_16x16x32_bf16 a[128:131], a[224:227], v[112:115], a[128:131]
v_mfma_f32_16x16x32_bf16 a[132:135], a[228:231], v[112:115], a[132:135]
v_exp_f32 v148, v148
v_mfma_f32_16x16x32_bf16 a[136:139], a[232:235], v[112:115], a[136:139]
s_barrier
v_mfma_f32_16x16x32_bf16 a[140:143], a[236:239], v[112:115], a[140:143]
s_add_u32 s75, s75, 8192
v_cvt_pk_bf16_f32 v145, v146, v147
v_mfma_f32_16x16x32_bf16 a[144:147], a[240:243], v[112:115], a[144:147]
s_and_b32 s75, s75, 131071
v_mfma_f32_16x16x32_bf16 a[148:151], a[244:247], v[112:115], a[148:151]
s_add_u32 m0, s77, 49152
v_exp_f32 v149, v149
v_mfma_f32_16x16x32_bf16 a[152:155], a[248:251], v[112:115], a[152:155]
buffer_load_dwordx4 v6, s[36:39], s75 offen nt lds
v_mfma_f32_16x16x32_bf16 a[156:159], a[252:255], v[112:115], a[156:159]
v_exp_f32 v150, v150
v_mfma_f32_16x16x32_bf16 v[152:155], v[48:51], v[112:115], v[152:155]
v_mfma_f32_16x16x32_bf16 v[112:115], a[192:195], v[96:99], 0
v_cvt_pk_bf16_f32 v146, v148, v149
v_exp_f32 v80, v80
v_mfma_f32_16x16x32_bf16 v[116:119], a[208:211], v[96:99], 0
v_exp_f32 v81, v81
v_mfma_f32_16x16x32_bf16 v[112:115], a[196:199], v[100:103], v[112:115]
v_exp_f32 v151, v151
v_mfma_f32_16x16x32_bf16 v[116:119], a[212:215], v[100:103], v[116:119]
v_exp_f32 v82, v82
v_mfma_f32_16x16x32_bf16 v[112:115], a[200:203], v[104:107], v[112:115]
v_cvt_pk_bf16_f32 v147, v150, v151
v_mfma_f32_16x16x32_bf16 v[116:119], a[216:219], v[104:107], v[116:119]
v_cvt_pk_bf16_f32 v80, v80, v81
v_mfma_f32_16x16x32_bf16 v[112:115], a[204:207], v[108:111], v[112:115]
v_mfma_f32_16x16x32_bf16 v[116:119], a[220:223], v[108:111], v[116:119]
v_exp_f32 v83, v83
v_mfma_f32_16x16x32_bf16 a[160:163], a[224:227], v[144:147], a[160:163]
ds_read_b64_tr_b16 a[224:225], v28 offset:49152
ds_read_b64_tr_b16 a[226:227], v28 offset:53248
v_mfma_f32_16x16x32_bf16 a[164:167], a[228:231], v[144:147], a[164:167]
buffer_load_dwordx4 v7, s[36:39], s75 offen offset:1024 nt lds
v_exp_f32 v84, v84
v_mfma_f32_16x16x32_bf16 a[168:171], a[232:235], v[144:147], a[168:171]
ds_read_b64_tr_b16 a[228:229], v29 offset:49152
ds_read_b64_tr_b16 a[230:231], v29 offset:53248
v_mfma_f32_16x16x32_bf16 a[172:175], a[236:239], v[144:147], a[172:175]
v_cvt_pk_bf16_f32 v81, v82, v83
v_mfma_f32_16x16x32_bf16 a[176:179], a[240:243], v[144:147], a[176:179]
ds_read_b64_tr_b16 a[232:233], v30 offset:49152
ds_read_b64_tr_b16 a[234:235], v30 offset:53248
v_mfma_f32_16x16x32_bf16 a[180:183], a[244:247], v[144:147], a[180:183]
v_exp_f32 v85, v85
v_mfma_f32_16x16x32_bf16 a[184:187], a[248:251], v[144:147], a[184:187]
ds_read_b64_tr_b16 a[236:237], v31 offset:49152
ds_read_b64_tr_b16 a[238:239], v31 offset:53248
v_mfma_f32_16x16x32_bf16 a[188:191], a[252:255], v[144:147], a[188:191]
v_exp_f32 v86, v86
v_mfma_f32_16x16x32_bf16 v[156:159], v[48:51], v[144:147], v[156:159]
ds_read_b64_tr_b16 a[240:241], v44 offset:49152
ds_read_b64_tr_b16 a[242:243], v44 offset:53248
v_mfma_f32_16x16x32_bf16 v[144:147], a[192:195], v[128:131], 0
v_cvt_pk_bf16_f32 v82, v84, v85
v_exp_f32 v112, v112
v_mfma_f32_16x16x32_bf16 v[148:151], a[208:211], v[128:131], 0
ds_read_b64_tr_b16 a[244:245], v45 offset:49152
ds_read_b64_tr_b16 a[246:247], v45 offset:53248
v_mfma_f32_16x16x32_bf16 v[144:147], a[196:199], v[132:135], v[144:147]
v_exp_f32 v87, v87
v_mfma_f32_16x16x32_bf16 v[148:151], a[212:215], v[132:135], v[148:151]
ds_read_b64_tr_b16 a[248:249], v46 offset:49152
ds_read_b64_tr_b16 a[250:251], v46 offset:53248
v_mfma_f32_16x16x32_bf16 v[144:147], a[200:203], v[136:139], v[144:147]
buffer_load_dwordx4 v8, s[36:39], s75 offen offset:2048 nt lds
v_cvt_pk_bf16_f32 v83, v86, v87
v_mfma_f32_16x16x32_bf16 v[148:151], a[216:219], v[136:139], v[148:151]
ds_read_b64_tr_b16 a[252:253], v47 offset:49152
ds_read_b64_tr_b16 a[254:255], v47 offset:53248
v_mfma_f32_16x16x32_bf16 v[144:147], a[204:207], v[140:143], v[144:147]
v_exp_f32 v113, v113
v_mfma_f32_16x16x32_bf16 v[148:151], a[220:223], v[140:143], v[148:151]
v_exp_f32 v114, v114
v_cvt_pk_bf16_f32 v112, v112, v113
s_waitcnt lgkmcnt(4)
v_mfma_f32_16x16x32_bf16 a[0:3], a[224:227], v[80:83], a[0:3]
v_exp_f32 v115, v115
v_mfma_f32_16x16x32_bf16 a[4:7], a[228:231], v[80:83], a[4:7]
v_exp_f32 v116, v116
v_mfma_f32_16x16x32_bf16 a[8:11], a[232:235], v[80:83], a[8:11]
v_mfma_f32_16x16x32_bf16 a[12:15], a[236:239], v[80:83], a[12:15]
v_cvt_pk_bf16_f32 v113, v114, v115
v_mfma_f32_16x16x32_bf16 a[16:19], a[240:243], v[80:83], a[16:19]
v_mfma_f32_16x16x32_bf16 a[20:23], a[244:247], v[80:83], a[20:23]
v_exp_f32 v117, v117
s_waitcnt lgkmcnt(0)
v_mfma_f32_16x16x32_bf16 a[24:27], a[248:251], v[80:83], a[24:27]
v_mfma_f32_16x16x32_bf16 a[28:31], a[252:255], v[80:83], a[28:31]
v_exp_f32 v118, v118
v_mfma_f32_16x16x32_bf16 v[88:91], v[48:51], v[80:83], v[88:91]
buffer_load_dwordx4 v9, s[36:39], s75 offen offset:3072 nt lds
v_mfma_f32_16x16x32_bf16 v[80:83], a[192:195], v[160:163], 0
v_cvt_pk_bf16_f32 v114, v116, v117
v_exp_f32 v144, v144
v_mfma_f32_16x16x32_bf16 v[84:87], a[208:211], v[160:163], 0
v_exp_f32 v145, v145
v_mfma_f32_16x16x32_bf16 v[80:83], a[196:199], v[164:167], v[80:83]
v_exp_f32 v119, v119
v_mfma_f32_16x16x32_bf16 v[84:87], a[212:215], v[164:167], v[84:87]
v_exp_f32 v146, v146
v_mfma_f32_16x16x32_bf16 v[80:83], a[200:203], v[168:171], v[80:83]
v_cvt_pk_bf16_f32 v115, v118, v119
v_mfma_f32_16x16x32_bf16 v[84:87], a[216:219], v[168:171], v[84:87]
v_cvt_pk_bf16_f32 v144, v144, v145
v_mfma_f32_16x16x32_bf16 v[80:83], a[204:207], v[172:175], v[80:83]
v_mfma_f32_16x16x32_bf16 v[84:87], a[220:223], v[172:175], v[84:87]
v_exp_f32 v147, v147
v_mfma_f32_16x16x32_bf16 a[32:35], a[224:227], v[112:115], a[32:35]
v_mfma_f32_16x16x32_bf16 a[36:39], a[228:231], v[112:115], a[36:39]
v_exp_f32 v148, v148
v_mfma_f32_16x16x32_bf16 a[40:43], a[232:235], v[112:115], a[40:43]
v_mfma_f32_16x16x32_bf16 a[44:47], a[236:239], v[112:115], a[44:47]
v_cvt_pk_bf16_f32 v145, v146, v147
v_mfma_f32_16x16x32_bf16 a[48:51], a[240:243], v[112:115], a[48:51]
v_mfma_f32_16x16x32_bf16 a[52:55], a[244:247], v[112:115], a[52:55]
v_exp_f32 v149, v149
v_mfma_f32_16x16x32_bf16 a[56:59], a[248:251], v[112:115], a[56:59]
v_mfma_f32_16x16x32_bf16 a[60:63], a[252:255], v[112:115], a[60:63]
v_exp_f32 v150, v150
v_mfma_f32_16x16x32_bf16 v[92:95], v[48:51], v[112:115], v[92:95]
v_mfma_f32_16x16x32_bf16 v[112:115], a[192:195], v[192:195], 0
v_cvt_pk_bf16_f32 v146, v148, v149
v_exp_f32 v80, v80
v_mfma_f32_16x16x32_bf16 v[116:119], a[208:211], v[192:195], 0
v_exp_f32 v81, v81
v_mfma_f32_16x16x32_bf16 v[112:115], a[196:199], v[196:199], v[112:115]
v_exp_f32 v151, v151
v_mfma_f32_16x16x32_bf16 v[116:119], a[212:215], v[196:199], v[116:119]
v_exp_f32 v82, v82
v_mfma_f32_16x16x32_bf16 v[112:115], a[200:203], v[200:203], v[112:115]
v_cvt_pk_bf16_f32 v147, v150, v151
v_mfma_f32_16x16x32_bf16 v[116:119], a[216:219], v[200:203], v[116:119]
v_cvt_pk_bf16_f32 v80, v80, v81
v_mfma_f32_16x16x32_bf16 v[112:115], a[204:207], v[204:207], v[112:115]
v_mfma_f32_16x16x32_bf16 v[116:119], a[220:223], v[204:207], v[116:119]
v_exp_f32 v83, v83
v_mfma_f32_16x16x32_bf16 a[64:67], a[224:227], v[144:147], a[64:67]
s_waitcnt vmcnt(26)
s_barrier
v_mfma_f32_16x16x32_bf16 a[68:71], a[228:231], v[144:147], a[68:71]
s_add_u32 s76, s76, 8192
v_exp_f32 v84, v84
v_mfma_f32_16x16x32_bf16 a[72:75], a[232:235], v[144:147], a[72:75]
s_and_b32 s76, s76, 131071
v_mfma_f32_16x16x32_bf16 a[76:79], a[236:239], v[144:147], a[76:79]
s_add_u32 m0, s77, 114688
v_cvt_pk_bf16_f32 v81, v82, v83
v_mfma_f32_16x16x32_bf16 a[80:83], a[240:243], v[144:147], a[80:83]
buffer_load_dwordx4 v10, s[40:43], s76 offen nt lds
v_mfma_f32_16x16x32_bf16 a[84:87], a[244:247], v[144:147], a[84:87]
v_exp_f32 v85, v85
v_mfma_f32_16x16x32_bf16 a[88:91], a[248:251], v[144:147], a[88:91]
v_mfma_f32_16x16x32_bf16 a[92:95], a[252:255], v[144:147], a[92:95]
v_exp_f32 v86, v86
v_mfma_f32_16x16x32_bf16 v[120:123], v[48:51], v[144:147], v[120:123]
v_mfma_f32_16x16x32_bf16 v[144:147], a[192:195], v[224:227], 0
ds_read_b64 a[192:193], v20
ds_read_b64 a[194:195], v21
v_cvt_pk_bf16_f32 v82, v84, v85
v_mfma_f32_16x16x32_bf16 v[148:151], a[208:211], v[224:227], 0
v_exp_f32 v112, v112
v_mfma_f32_16x16x32_bf16 v[144:147], a[196:199], v[228:231], v[144:147]
ds_read_b64 a[208:209], v20 offset:4096
ds_read_b64 a[210:211], v21 offset:4096
v_mfma_f32_16x16x32_bf16 v[148:151], a[212:215], v[228:231], v[148:151]
buffer_load_dwordx4 v19, s[40:43], s76 offen offset:1024 nt lds
v_exp_f32 v87, v87
v_mfma_f32_16x16x32_bf16 v[144:147], a[200:203], v[232:235], v[144:147]
ds_read_b64 a[196:197], v22
ds_read_b64 a[198:199], v23
v_cvt_pk_bf16_f32 v83, v86, v87
v_mfma_f32_16x16x32_bf16 v[148:151], a[216:219], v[232:235], v[148:151]
v_exp_f32 v113, v113
v_mfma_f32_16x16x32_bf16 v[144:147], a[204:207], v[236:239], v[144:147]
ds_read_b64 a[212:213], v22 offset:4096
ds_read_b64 a[214:215], v23 offset:4096
v_mfma_f32_16x16x32_bf16 v[148:151], a[220:223], v[236:239], v[148:151]
v_exp_f32 v114, v114
v_cvt_pk_bf16_f32 v112, v112, v113
v_mfma_f32_16x16x32_bf16 a[96:99], a[224:227], v[80:83], a[96:99]
ds_read_b64 a[200:201], v24
ds_read_b64 a[202:203], v25
v_mfma_f32_16x16x32_bf16 a[100:103], a[228:231], v[80:83], a[100:103]
v_exp_f32 v115, v115
v_mfma_f32_16x16x32_bf16 a[104:107], a[232:235], v[80:83], a[104:107]
ds_read_b64 a[216:217], v24 offset:4096
ds_read_b64 a[218:219], v25 offset:4096
v_mfma_f32_16x16x32_bf16 a[108:111], a[236:239], v[80:83], a[108:111]
buffer_load_dwordx4 v10, s[40:43], s76 offen offset:2048 nt lds
v_exp_f32 v116, v116
v_mfma_f32_16x16x32_bf16 a[112:115], a[240:243], v[80:83], a[112:115]
ds_read_b64 a[204:205], v26
ds_read_b64 a[206:207], v27
v_cvt_pk_bf16_f32 v113, v114, v115
v_mfma_f32_16x16x32_bf16 a[116:119], a[244:247], v[80:83], a[116:119]
v_exp_f32 v117, v117
v_mfma_f32_16x16x32_bf16 a[120:123], a[248:251], v[80:83], a[120:123]
ds_read_b64 a[220:221], v26 offset:4096
ds_read_b64 a[222:223], v27 offset:4096
v_mfma_f32_16x16x32_bf16 a[124:127], a[252:255], v[80:83], a[124:127]
v_exp_f32 v118, v118
v_mfma_f32_16x16x32_bf16 v[124:127], v[48:51], v[80:83], v[124:127]
s_waitcnt lgkmcnt(4)
v_mfma_f32_16x16x32_bf16 v[80:83], a[192:195], v[64:67], 0
v_cvt_pk_bf16_f32 v114, v116, v117
v_exp_f32 v144, v144
v_mfma_f32_16x16x32_bf16 v[84:87], a[208:211], v[64:67], 0
v_exp_f32 v145, v145
v_mfma_f32_16x16x32_bf16 v[80:83], a[196:199], v[68:71], v[80:83]
buffer_load_dwordx4 v19, s[40:43], s76 offen offset:3072 nt lds
v_exp_f32 v119, v119
v_mfma_f32_16x16x32_bf16 v[84:87], a[212:215], v[68:71], v[84:87]
v_exp_f32 v146, v146
v_mfma_f32_16x16x32_bf16 v[80:83], a[200:203], v[72:75], v[80:83]
v_cvt_pk_bf16_f32 v115, v118, v119
v_mfma_f32_16x16x32_bf16 v[84:87], a[216:219], v[72:75], v[84:87]
v_cvt_pk_bf16_f32 v144, v144, v145
s_waitcnt lgkmcnt(0)
v_mfma_f32_16x16x32_bf16 v[80:83], a[204:207], v[76:79], v[80:83]
v_mfma_f32_16x16x32_bf16 v[84:87], a[220:223], v[76:79], v[84:87]
v_exp_f32 v147, v147
v_mfma_f32_16x16x32_bf16 a[128:131], a[224:227], v[112:115], a[128:131]
v_mfma_f32_16x16x32_bf16 a[132:135], a[228:231], v[112:115], a[132:135]
v_exp_f32 v148, v148
v_mfma_f32_16x16x32_bf16 a[136:139], a[232:235], v[112:115], a[136:139]
s_waitcnt vmcnt(26)
s_barrier
v_mfma_f32_16x16x32_bf16 a[140:143], a[236:239], v[112:115], a[140:143]
s_add_u32 s75, s75, 8192
v_cvt_pk_bf16_f32 v145, v146, v147
v_mfma_f32_16x16x32_bf16 a[144:147], a[240:243], v[112:115], a[144:147]
s_and_b32 s75, s75, 131071
v_mfma_f32_16x16x32_bf16 a[148:151], a[244:247], v[112:115], a[148:151]
s_add_u32 m0, s77, 0
v_exp_f32 v149, v149
v_mfma_f32_16x16x32_bf16 a[152:155], a[248:251], v[112:115], a[152:155]
buffer_load_dwordx4 v6, s[36:39], s75 offen nt lds
v_mfma_f32_16x16x32_bf16 a[156:159], a[252:255], v[112:115], a[156:159]
v_exp_f32 v150, v150
v_mfma_f32_16x16x32_bf16 v[152:155], v[48:51], v[112:115], v[152:155]
v_mfma_f32_16x16x32_bf16 v[112:115], a[192:195], v[96:99], 0
v_lshlrev_b32 v11, 4, v1
v_cvt_pk_bf16_f32 v146, v148, v149
v_mfma_f32_16x16x32_bf16 v[116:119], a[208:211], v[96:99], 0
v_exp_f32 v80, v80
v_mfma_f32_16x16x32_bf16 v[112:115], a[196:199], v[100:103], v[112:115]
v_exp_f32 v151, v151
v_mfma_f32_16x16x32_bf16 v[116:119], a[212:215], v[100:103], v[116:119]
v_exp_f32 v81, v81
v_mfma_f32_16x16x32_bf16 v[112:115], a[200:203], v[104:107], v[112:115]
v_cvt_pk_bf16_f32 v147, v150, v151
v_exp_f32 v82, v82
v_mfma_f32_16x16x32_bf16 v[116:119], a[216:219], v[104:107], v[116:119]
v_cvt_pk_bf16_f32 v80, v80, v81
v_mfma_f32_16x16x32_bf16 v[112:115], a[204:207], v[108:111], v[112:115]
v_mfma_f32_16x16x32_bf16 v[116:119], a[220:223], v[108:111], v[116:119]
v_exp_f32 v83, v83
v_mfma_f32_16x16x32_bf16 a[160:163], a[224:227], v[144:147], a[160:163]
ds_read_b64_tr_b16 a[224:225], v28
ds_read_b64_tr_b16 a[226:227], v28 offset:4096
v_add_u32 v12, 131072, v11
v_mfma_f32_16x16x32_bf16 a[164:167], a[228:231], v[144:147], a[164:167]
buffer_load_dwordx4 v7, s[36:39], s75 offen offset:1024 nt lds
v_exp_f32 v84, v84
v_mfma_f32_16x16x32_bf16 a[168:171], a[232:235], v[144:147], a[168:171]
ds_read_b64_tr_b16 a[228:229], v29
ds_read_b64_tr_b16 a[230:231], v29 offset:4096
v_mfma_f32_16x16x32_bf16 a[172:175], a[236:239], v[144:147], a[172:175]
v_cvt_pk_bf16_f32 v81, v82, v83
v_mfma_f32_16x16x32_bf16 a[176:179], a[240:243], v[144:147], a[176:179]
ds_read_b64_tr_b16 a[232:233], v30
ds_read_b64_tr_b16 a[234:235], v30 offset:4096
v_mfma_f32_16x16x32_bf16 a[180:183], a[244:247], v[144:147], a[180:183]
v_exp_f32 v85, v85
v_mfma_f32_16x16x32_bf16 a[184:187], a[248:251], v[144:147], a[184:187]
ds_read_b64_tr_b16 a[236:237], v31
ds_read_b64_tr_b16 a[238:239], v31 offset:4096
v_mfma_f32_16x16x32_bf16 a[188:191], a[252:255], v[144:147], a[188:191]
v_exp_f32 v86, v86
v_mfma_f32_16x16x32_bf16 v[156:159], v[48:51], v[144:147], v[156:159]
ds_read_b64_tr_b16 a[240:241], v44
ds_read_b64_tr_b16 a[242:243], v44 offset:4096
v_mfma_f32_16x16x32_bf16 v[144:147], a[192:195], v[128:131], 0
v_add_u32 v13, 262144, v11
v_cvt_pk_bf16_f32 v82, v84, v85
v_mfma_f32_16x16x32_bf16 v[148:151], a[208:211], v[128:131], 0
ds_read_b64_tr_b16 a[244:245], v45
ds_read_b64_tr_b16 a[246:247], v45 offset:4096
v_mfma_f32_16x16x32_bf16 v[144:147], a[196:199], v[132:135], v[144:147]
v_exp_f32 v87, v87
v_mfma_f32_16x16x32_bf16 v[148:151], a[212:215], v[132:135], v[148:151]
ds_read_b64_tr_b16 a[248:249], v46
ds_read_b64_tr_b16 a[250:251], v46 offset:4096
v_mfma_f32_16x16x32_bf16 v[144:147], a[200:203], v[136:139], v[144:147]
buffer_load_dwordx4 v8, s[36:39], s75 offen offset:2048 nt lds
v_cvt_pk_bf16_f32 v83, v86, v87
v_mfma_f32_16x16x32_bf16 v[148:151], a[216:219], v[136:139], v[148:151]
ds_read_b64_tr_b16 a[252:253], v47
ds_read_b64_tr_b16 a[254:255], v47 offset:4096
v_mfma_f32_16x16x32_bf16 v[144:147], a[204:207], v[140:143], v[144:147]
v_exp_f32 v112, v112
v_mfma_f32_16x16x32_bf16 v[148:151], a[220:223], v[140:143], v[148:151]
v_exp_f32 v113, v113
s_waitcnt lgkmcnt(4)
v_mfma_f32_16x16x32_bf16 a[0:3], a[224:227], v[80:83], a[0:3]
v_exp_f32 v114, v114
v_cvt_pk_bf16_f32 v112, v112, v113
v_mfma_f32_16x16x32_bf16 a[4:7], a[228:231], v[80:83], a[4:7]
v_add_u32 v14, 393216, v11
v_exp_f32 v115, v115
v_mfma_f32_16x16x32_bf16 a[8:11], a[232:235], v[80:83], a[8:11]
v_exp_f32 v116, v116
v_mfma_f32_16x16x32_bf16 a[12:15], a[236:239], v[80:83], a[12:15]
v_cvt_pk_bf16_f32 v113, v114, v115
v_mfma_f32_16x16x32_bf16 a[16:19], a[240:243], v[80:83], a[16:19]
v_mfma_f32_16x16x32_bf16 a[20:23], a[244:247], v[80:83], a[20:23]
v_exp_f32 v117, v117
s_waitcnt lgkmcnt(0)
v_mfma_f32_16x16x32_bf16 a[24:27], a[248:251], v[80:83], a[24:27]
v_mfma_f32_16x16x32_bf16 a[28:31], a[252:255], v[80:83], a[28:31]
v_exp_f32 v118, v118
v_mfma_f32_16x16x32_bf16 v[88:91], v[48:51], v[80:83], v[88:91]
buffer_load_dwordx4 v9, s[36:39], s75 offen offset:3072 nt lds
v_mfma_f32_16x16x32_bf16 v[80:83], a[192:195], v[160:163], 0
v_add_u32 v15, 524288, v11
v_cvt_pk_bf16_f32 v114, v116, v117
v_mfma_f32_16x16x32_bf16 v[84:87], a[208:211], v[160:163], 0
v_exp_f32 v144, v144
v_mfma_f32_16x16x32_bf16 v[80:83], a[196:199], v[164:167], v[80:83]
v_exp_f32 v119, v119
v_mfma_f32_16x16x32_bf16 v[84:87], a[212:215], v[164:167], v[84:87]
v_exp_f32 v145, v145
v_mfma_f32_16x16x32_bf16 v[80:83], a[200:203], v[168:171], v[80:83]
v_cvt_pk_bf16_f32 v115, v118, v119
v_exp_f32 v146, v146
v_mfma_f32_16x16x32_bf16 v[84:87], a[216:219], v[168:171], v[84:87]
v_cvt_pk_bf16_f32 v144, v144, v145
v_mfma_f32_16x16x32_bf16 v[80:83], a[204:207], v[172:175], v[80:83]
v_mfma_f32_16x16x32_bf16 v[84:87], a[220:223], v[172:175], v[84:87]
v_exp_f32 v147, v147
v_mfma_f32_16x16x32_bf16 a[32:35], a[224:227], v[112:115], a[32:35]
v_mfma_f32_16x16x32_bf16 a[36:39], a[228:231], v[112:115], a[36:39]
v_add_u32 v16, 655360, v11
v_exp_f32 v148, v148
v_mfma_f32_16x16x32_bf16 a[40:43], a[232:235], v[112:115], a[40:43]
v_mfma_f32_16x16x32_bf16 a[44:47], a[236:239], v[112:115], a[44:47]
v_cvt_pk_bf16_f32 v145, v146, v147
v_mfma_f32_16x16x32_bf16 a[48:51], a[240:243], v[112:115], a[48:51]
v_mfma_f32_16x16x32_bf16 a[52:55], a[244:247], v[112:115], a[52:55]
v_exp_f32 v149, v149
v_mfma_f32_16x16x32_bf16 a[56:59], a[248:251], v[112:115], a[56:59]
v_mfma_f32_16x16x32_bf16 a[60:63], a[252:255], v[112:115], a[60:63]
v_exp_f32 v150, v150
v_mfma_f32_16x16x32_bf16 v[92:95], v[48:51], v[112:115], v[92:95]
v_mfma_f32_16x16x32_bf16 v[112:115], a[192:195], v[192:195], 0
v_cvt_pk_bf16_f32 v146, v148, v149
v_exp_f32 v80, v80
v_mfma_f32_16x16x32_bf16 v[116:119], a[208:211], v[192:195], 0
v_lshrrev_b32 v176, 4, v1
v_exp_f32 v81, v81
v_mfma_f32_16x16x32_bf16 v[112:115], a[196:199], v[196:199], v[112:115]
v_exp_f32 v151, v151
v_mfma_f32_16x16x32_bf16 v[116:119], a[212:215], v[196:199], v[116:119]
v_exp_f32 v82, v82
v_mfma_f32_16x16x32_bf16 v[112:115], a[200:203], v[200:203], v[112:115]
v_cvt_pk_bf16_f32 v147, v150, v151
v_mfma_f32_16x16x32_bf16 v[116:119], a[216:219], v[200:203], v[116:119]
v_cvt_pk_bf16_f32 v80, v80, v81
v_mfma_f32_16x16x32_bf16 v[112:115], a[204:207], v[204:207], v[112:115]
v_mfma_f32_16x16x32_bf16 v[116:119], a[220:223], v[204:207], v[116:119]
v_exp_f32 v83, v83
v_mfma_f32_16x16x32_bf16 a[64:67], a[224:227], v[144:147], a[64:67]
s_waitcnt vmcnt(25)
s_barrier
v_mfma_f32_16x16x32_bf16 a[68:71], a[228:231], v[144:147], a[68:71]
s_add_u32 s76, s76, 8192
v_exp_f32 v84, v84
v_mfma_f32_16x16x32_bf16 a[72:75], a[232:235], v[144:147], a[72:75]
s_and_b32 s76, s76, 131071
v_and_b32 v177, 15, v1
v_mfma_f32_16x16x32_bf16 a[76:79], a[236:239], v[144:147], a[76:79]
s_add_u32 m0, s77, 65536
v_cvt_pk_bf16_f32 v81, v82, v83
v_mfma_f32_16x16x32_bf16 a[80:83], a[240:243], v[144:147], a[80:83]
buffer_load_dwordx4 v10, s[40:43], s76 offen nt lds
v_mfma_f32_16x16x32_bf16 a[84:87], a[244:247], v[144:147], a[84:87]
v_exp_f32 v85, v85
v_mfma_f32_16x16x32_bf16 a[88:91], a[248:251], v[144:147], a[88:91]
v_mfma_f32_16x16x32_bf16 a[92:95], a[252:255], v[144:147], a[92:95]
v_exp_f32 v86, v86
v_mfma_f32_16x16x32_bf16 v[120:123], v[48:51], v[144:147], v[120:123]
v_mfma_f32_16x16x32_bf16 v[144:147], a[192:195], v[224:227], 0
ds_read_b64 a[192:193], v20 offset:16384
ds_read_b64 a[194:195], v21 offset:16384
v_cvt_pk_bf16_f32 v82, v84, v85
v_mfma_f32_16x16x32_bf16 v[148:151], a[208:211], v[224:227], 0
v_lshlrev_b32 v3, 2, v176
v_exp_f32 v112, v112
v_mfma_f32_16x16x32_bf16 v[144:147], a[196:199], v[228:231], v[144:147]
ds_read_b64 a[208:209], v20 offset:20480
ds_read_b64 a[210:211], v21 offset:20480
v_mfma_f32_16x16x32_bf16 v[148:151], a[212:215], v[228:231], v[148:151]
buffer_load_dwordx4 v19, s[40:43], s76 offen offset:1024 nt lds
v_exp_f32 v87, v87
v_mfma_f32_16x16x32_bf16 v[144:147], a[200:203], v[232:235], v[144:147]
ds_read_b64 a[196:197], v22 offset:16384
ds_read_b64 a[198:199], v23 offset:16384
v_cvt_pk_bf16_f32 v83, v86, v87
v_mfma_f32_16x16x32_bf16 v[148:151], a[216:219], v[232:235], v[148:151]
v_exp_f32 v113, v113
v_mfma_f32_16x16x32_bf16 v[144:147], a[204:207], v[236:239], v[144:147]
ds_read_b64 a[212:213], v22 offset:20480
ds_read_b64 a[214:215], v23 offset:20480
v_mfma_f32_16x16x32_bf16 v[148:151], a[220:223], v[236:239], v[148:151]
v_exp_f32 v114, v114
v_cvt_pk_bf16_f32 v112, v112, v113
v_mfma_f32_16x16x32_bf16 a[96:99], a[224:227], v[80:83], a[96:99]
ds_read_b64 a[200:201], v24 offset:16384
ds_read_b64 a[202:203], v25 offset:16384
v_mfma_f32_16x16x32_bf16 a[100:103], a[228:231], v[80:83], a[100:103]
v_exp_f32 v115, v115
v_mfma_f32_16x16x32_bf16 a[104:107], a[232:235], v[80:83], a[104:107]
ds_read_b64 a[216:217], v24 offset:20480
ds_read_b64 a[218:219], v25 offset:20480
v_xor_b32 v3, v3, v177
v_mfma_f32_16x16x32_bf16 a[108:111], a[236:239], v[80:83], a[108:111]
buffer_load_dwordx4 v10, s[40:43], s76 offen offset:2048 nt lds
v_exp_f32 v116, v116
v_mfma_f32_16x16x32_bf16 a[112:115], a[240:243], v[80:83], a[112:115]
ds_read_b64 a[204:205], v26 offset:16384
ds_read_b64 a[206:207], v27 offset:16384
v_cvt_pk_bf16_f32 v113, v114, v115
v_mfma_f32_16x16x32_bf16 a[116:119], a[244:247], v[80:83], a[116:119]
v_exp_f32 v117, v117
v_mfma_f32_16x16x32_bf16 a[120:123], a[248:251], v[80:83], a[120:123]
ds_read_b64 a[220:221], v26 offset:20480
ds_read_b64 a[222:223], v27 offset:20480
v_mfma_f32_16x16x32_bf16 a[124:127], a[252:255], v[80:83], a[124:127]
v_exp_f32 v118, v118
v_mfma_f32_16x16x32_bf16 v[124:127], v[48:51], v[80:83], v[124:127]
s_waitcnt lgkmcnt(4)
v_mfma_f32_16x16x32_bf16 v[80:83], a[192:195], v[64:67], 0
v_cvt_pk_bf16_f32 v114, v116, v117
v_exp_f32 v144, v144
v_mfma_f32_16x16x32_bf16 v[84:87], a[208:211], v[64:67], 0
v_exp_f32 v145, v145
v_mfma_f32_16x16x32_bf16 v[80:83], a[196:199], v[68:71], v[80:83]
buffer_load_dwordx4 v19, s[40:43], s76 offen offset:3072 nt lds
v_lshlrev_b32 v3, 4, v3
v_mfma_f32_16x16x32_bf16 v[84:87], a[212:215], v[68:71], v[84:87]
v_exp_f32 v119, v119
v_mfma_f32_16x16x32_bf16 v[80:83], a[200:203], v[72:75], v[80:83]
v_cvt_pk_bf16_f32 v115, v118, v119
v_exp_f32 v146, v146
v_mfma_f32_16x16x32_bf16 v[84:87], a[216:219], v[72:75], v[84:87]
v_cvt_pk_bf16_f32 v144, v144, v145
s_waitcnt lgkmcnt(0)
v_mfma_f32_16x16x32_bf16 v[80:83], a[204:207], v[76:79], v[80:83]
v_mfma_f32_16x16x32_bf16 v[84:87], a[220:223], v[76:79], v[84:87]
v_exp_f32 v147, v147
v_mfma_f32_16x16x32_bf16 a[128:131], a[224:227], v[112:115], a[128:131]
v_mfma_f32_16x16x32_bf16 a[132:135], a[228:231], v[112:115], a[132:135]
v_exp_f32 v148, v148
v_mfma_f32_16x16x32_bf16 a[136:139], a[232:235], v[112:115], a[136:139]
s_waitcnt vmcnt(25)
s_barrier
v_mfma_f32_16x16x32_bf16 a[140:143], a[236:239], v[112:115], a[140:143]
s_add_u32 s75, s75, 8192
v_lshlrev_b32 v2, 10, v176
v_cvt_pk_bf16_f32 v145, v146, v147
v_mfma_f32_16x16x32_bf16 a[144:147], a[240:243], v[112:115], a[144:147]
s_and_b32 s75, s75, 131071
v_mfma_f32_16x16x32_bf16 a[148:151], a[244:247], v[112:115], a[148:151]
s_add_u32 m0, s77, 16384
v_exp_f32 v149, v149
v_mfma_f32_16x16x32_bf16 a[152:155], a[248:251], v[112:115], a[152:155]
buffer_load_dwordx4 v6, s[36:39], s75 offen nt lds
v_mfma_f32_16x16x32_bf16 a[156:159], a[252:255], v[112:115], a[156:159]
v_exp_f32 v150, v150
v_mfma_f32_16x16x32_bf16 v[152:155], v[48:51], v[112:115], v[152:155]
v_mfma_f32_16x16x32_bf16 v[112:115], a[192:195], v[96:99], 0
v_cvt_pk_bf16_f32 v146, v148, v149
v_exp_f32 v80, v80
v_mfma_f32_16x16x32_bf16 v[116:119], a[208:211], v[96:99], 0
v_exp_f32 v81, v81
v_mfma_f32_16x16x32_bf16 v[112:115], a[196:199], v[100:103], v[112:115]
v_add_u32 v2, v2, v3
v_exp_f32 v151, v151
v_mfma_f32_16x16x32_bf16 v[116:119], a[212:215], v[100:103], v[116:119]
v_exp_f32 v82, v82
v_mfma_f32_16x16x32_bf16 v[112:115], a[200:203], v[104:107], v[112:115]
v_cvt_pk_bf16_f32 v147, v150, v151
v_mfma_f32_16x16x32_bf16 v[116:119], a[216:219], v[104:107], v[116:119]
v_cvt_pk_bf16_f32 v80, v80, v81
v_mfma_f32_16x16x32_bf16 v[112:115], a[204:207], v[108:111], v[112:115]
v_mfma_f32_16x16x32_bf16 v[116:119], a[220:223], v[108:111], v[116:119]
v_exp_f32 v83, v83
v_mfma_f32_16x16x32_bf16 a[160:163], a[224:227], v[144:147], a[160:163]
ds_read_b64_tr_b16 a[224:225], v28 offset:16384
ds_read_b64_tr_b16 a[226:227], v28 offset:20480
v_mfma_f32_16x16x32_bf16 a[164:167], a[228:231], v[144:147], a[164:167]
buffer_load_dwordx4 v7, s[36:39], s75 offen offset:1024 nt lds
v_exp_f32 v84, v84
v_mfma_f32_16x16x32_bf16 a[168:171], a[232:235], v[144:147], a[168:171]
ds_read_b64_tr_b16 a[228:229], v29 offset:16384
ds_read_b64_tr_b16 a[230:231], v29 offset:20480
v_mfma_f32_16x16x32_bf16 a[172:175], a[236:239], v[144:147], a[172:175]
v_add_u32 v3, 3040, v2
v_cvt_pk_bf16_f32 v81, v82, v83
v_mfma_f32_16x16x32_bf16 a[176:179], a[240:243], v[144:147], a[176:179]
ds_read_b64_tr_b16 a[232:233], v30 offset:16384
ds_read_b64_tr_b16 a[234:235], v30 offset:20480
v_mfma_f32_16x16x32_bf16 a[180:183], a[244:247], v[144:147], a[180:183]
v_exp_f32 v85, v85
v_mfma_f32_16x16x32_bf16 a[184:187], a[248:251], v[144:147], a[184:187]
ds_read_b64_tr_b16 a[236:237], v31 offset:16384
ds_read_b64_tr_b16 a[238:239], v31 offset:20480
v_mfma_f32_16x16x32_bf16 a[188:191], a[252:255], v[144:147], a[188:191]
v_exp_f32 v86, v86
v_mfma_f32_16x16x32_bf16 v[156:159], v[48:51], v[144:147], v[156:159]
ds_read_b64_tr_b16 a[240:241], v44 offset:16384
ds_read_b64_tr_b16 a[242:243], v44 offset:20480
v_mfma_f32_16x16x32_bf16 v[144:147], a[192:195], v[128:131], 0
v_cvt_pk_bf16_f32 v82, v84, v85
v_exp_f32 v112, v112
v_mfma_f32_16x16x32_bf16 v[148:151], a[208:211], v[128:131], 0
ds_read_b64_tr_b16 a[244:245], v45 offset:16384
ds_read_b64_tr_b16 a[246:247], v45 offset:20480
v_mfma_f32_16x16x32_bf16 v[144:147], a[196:199], v[132:135], v[144:147]
v_exp_f32 v87, v87
v_mfma_f32_16x16x32_bf16 v[148:151], a[212:215], v[132:135], v[148:151]
ds_read_b64_tr_b16 a[248:249], v46 offset:16384
ds_read_b64_tr_b16 a[250:251], v46 offset:20480
v_add_u32 v4, 6080, v2
v_mfma_f32_16x16x32_bf16 v[144:147], a[200:203], v[136:139], v[144:147]
buffer_load_dwordx4 v8, s[36:39], s75 offen offset:2048 nt lds
v_cvt_pk_bf16_f32 v83, v86, v87
v_mfma_f32_16x16x32_bf16 v[148:151], a[216:219], v[136:139], v[148:151]
ds_read_b64_tr_b16 a[252:253], v47 offset:16384
ds_read_b64_tr_b16 a[254:255], v47 offset:20480
v_mfma_f32_16x16x32_bf16 v[144:147], a[204:207], v[140:143], v[144:147]
v_exp_f32 v113, v113
v_mfma_f32_16x16x32_bf16 v[148:151], a[220:223], v[140:143], v[148:151]
v_exp_f32 v114, v114
v_cvt_pk_bf16_f32 v112, v112, v113
s_waitcnt lgkmcnt(4)
v_mfma_f32_16x16x32_bf16 a[0:3], a[224:227], v[80:83], a[0:3]
v_exp_f32 v115, v115
v_mfma_f32_16x16x32_bf16 a[4:7], a[228:231], v[80:83], a[4:7]
v_exp_f32 v116, v116
v_mfma_f32_16x16x32_bf16 a[8:11], a[232:235], v[80:83], a[8:11]
v_mfma_f32_16x16x32_bf16 a[12:15], a[236:239], v[80:83], a[12:15]
v_add_u32 v5, 9120, v2
v_cvt_pk_bf16_f32 v113, v114, v115
v_mfma_f32_16x16x32_bf16 a[16:19], a[240:243], v[80:83], a[16:19]
v_mfma_f32_16x16x32_bf16 a[20:23], a[244:247], v[80:83], a[20:23]
v_exp_f32 v117, v117
s_waitcnt lgkmcnt(0)
v_mfma_f32_16x16x32_bf16 a[24:27], a[248:251], v[80:83], a[24:27]
v_mfma_f32_16x16x32_bf16 a[28:31], a[252:255], v[80:83], a[28:31]
v_exp_f32 v118, v118
v_mfma_f32_16x16x32_bf16 v[88:91], v[48:51], v[80:83], v[88:91]
buffer_load_dwordx4 v9, s[36:39], s75 offen offset:3072 nt lds
v_mfma_f32_16x16x32_bf16 v[80:83], a[192:195], v[160:163], 0
v_cvt_pk_bf16_f32 v114, v116, v117
v_exp_f32 v144, v144
v_mfma_f32_16x16x32_bf16 v[84:87], a[208:211], v[160:163], 0
v_exp_f32 v145, v145
v_mfma_f32_16x16x32_bf16 v[80:83], a[196:199], v[164:167], v[80:83]
v_exp_f32 v119, v119
v_mfma_f32_16x16x32_bf16 v[84:87], a[212:215], v[164:167], v[84:87]
v_mul_u32_u24 v17, 1056, v176
v_exp_f32 v146, v146
v_mfma_f32_16x16x32_bf16 v[80:83], a[200:203], v[168:171], v[80:83]
v_cvt_pk_bf16_f32 v115, v118, v119
v_mfma_f32_16x16x32_bf16 v[84:87], a[216:219], v[168:171], v[84:87]
v_cvt_pk_bf16_f32 v144, v144, v145
v_mfma_f32_16x16x32_bf16 v[80:83], a[204:207], v[172:175], v[80:83]
v_mfma_f32_16x16x32_bf16 v[84:87], a[220:223], v[172:175], v[84:87]
v_exp_f32 v147, v147
v_mfma_f32_16x16x32_bf16 a[32:35], a[224:227], v[112:115], a[32:35]
v_mfma_f32_16x16x32_bf16 a[36:39], a[228:231], v[112:115], a[36:39]
v_exp_f32 v148, v148
v_mfma_f32_16x16x32_bf16 a[40:43], a[232:235], v[112:115], a[40:43]
v_mfma_f32_16x16x32_bf16 a[44:47], a[236:239], v[112:115], a[44:47]
v_cvt_pk_bf16_f32 v145, v146, v147
v_mfma_f32_16x16x32_bf16 a[48:51], a[240:243], v[112:115], a[48:51]
v_and_b32 v18, 3, v177
v_mfma_f32_16x16x32_bf16 a[52:55], a[244:247], v[112:115], a[52:55]
v_exp_f32 v149, v149
v_mfma_f32_16x16x32_bf16 a[56:59], a[248:251], v[112:115], a[56:59]
v_mfma_f32_16x16x32_bf16 a[60:63], a[252:255], v[112:115], a[60:63]
v_exp_f32 v150, v150
v_mfma_f32_16x16x32_bf16 v[92:95], v[48:51], v[112:115], v[92:95]
v_mfma_f32_16x16x32_bf16 v[112:115], a[192:195], v[192:195], 0
v_cvt_pk_bf16_f32 v146, v148, v149
v_exp_f32 v80, v80
v_mfma_f32_16x16x32_bf16 v[116:119], a[208:211], v[192:195], 0
v_exp_f32 v81, v81
v_mfma_f32_16x16x32_bf16 v[112:115], a[196:199], v[196:199], v[112:115]
v_exp_f32 v151, v151
v_mfma_f32_16x16x32_bf16 v[116:119], a[212:215], v[196:199], v[116:119]
v_exp_f32 v82, v82
v_mfma_f32_16x16x32_bf16 v[112:115], a[200:203], v[200:203], v[112:115]
v_lshlrev_b32 v18, 3, v18
v_cvt_pk_bf16_f32 v147, v150, v151
v_mfma_f32_16x16x32_bf16 v[116:119], a[216:219], v[200:203], v[116:119]
v_cvt_pk_bf16_f32 v80, v80, v81
v_mfma_f32_16x16x32_bf16 v[112:115], a[204:207], v[204:207], v[112:115]
v_mfma_f32_16x16x32_bf16 v[116:119], a[220:223], v[204:207], v[116:119]
v_exp_f32 v83, v83
v_mfma_f32_16x16x32_bf16 a[64:67], a[224:227], v[144:147], a[64:67]
s_waitcnt vmcnt(25)
s_barrier
v_mfma_f32_16x16x32_bf16 a[68:71], a[228:231], v[144:147], a[68:71]
s_add_u32 s76, s76, 8192
v_exp_f32 v84, v84
v_mfma_f32_16x16x32_bf16 a[72:75], a[232:235], v[144:147], a[72:75]
s_and_b32 s76, s76, 131071
v_mfma_f32_16x16x32_bf16 a[76:79], a[236:239], v[144:147], a[76:79]
s_add_u32 m0, s77, 81920
v_cvt_pk_bf16_f32 v81, v82, v83
v_mfma_f32_16x16x32_bf16 a[80:83], a[240:243], v[144:147], a[80:83]
buffer_load_dwordx4 v10, s[40:43], s76 offen nt lds
v_add_u32 v17, v17, v18
v_mfma_f32_16x16x32_bf16 a[84:87], a[244:247], v[144:147], a[84:87]
v_exp_f32 v85, v85
v_mfma_f32_16x16x32_bf16 a[88:91], a[248:251], v[144:147], a[88:91]
v_mfma_f32_16x16x32_bf16 a[92:95], a[252:255], v[144:147], a[92:95]
v_exp_f32 v86, v86
v_mfma_f32_16x16x32_bf16 v[120:123], v[48:51], v[144:147], v[120:123]
v_mfma_f32_16x16x32_bf16 v[144:147], a[192:195], v[224:227], 0
ds_read_b64 a[192:193], v20 offset:32768
ds_read_b64 a[194:195], v21 offset:32768
v_cvt_pk_bf16_f32 v82, v84, v85
v_mfma_f32_16x16x32_bf16 v[148:151], a[208:211], v[224:227], 0
v_exp_f32 v112, v112
v_mfma_f32_16x16x32_bf16 v[144:147], a[196:199], v[228:231], v[144:147]
ds_read_b64 a[208:209], v20 offset:36864
ds_read_b64 a[210:211], v21 offset:36864
v_mfma_f32_16x16x32_bf16 v[148:151], a[212:215], v[228:231], v[148:151]
buffer_load_dwordx4 v19, s[40:43], s76 offen offset:1024 nt lds
v_exp_f32 v87, v87
v_mfma_f32_16x16x32_bf16 v[144:147], a[200:203], v[232:235], v[144:147]
ds_read_b64 a[196:197], v22 offset:32768
ds_read_b64 a[198:199], v23 offset:32768
v_lshrrev_b32 v177, 2, v177
v_mfma_f32_16x16x32_bf16 v[148:151], a[216:219], v[232:235], v[148:151]
v_cvt_pk_bf16_f32 v83, v86, v87
v_exp_f32 v113, v113
v_mfma_f32_16x16x32_bf16 v[144:147], a[204:207], v[236:239], v[144:147]
ds_read_b64 a[212:213], v22 offset:36864
ds_read_b64 a[214:215], v23 offset:36864
v_mfma_f32_16x16x32_bf16 v[148:151], a[220:223], v[236:239], v[148:151]
v_exp_f32 v114, v114
v_cvt_pk_bf16_f32 v112, v112, v113
v_mfma_f32_16x16x32_bf16 a[96:99], a[224:227], v[80:83], a[96:99]
ds_read_b64 a[200:201], v24 offset:32768
ds_read_b64 a[202:203], v25 offset:32768
v_mfma_f32_16x16x32_bf16 a[100:103], a[228:231], v[80:83], a[100:103]
v_exp_f32 v115, v115
v_mfma_f32_16x16x32_bf16 a[104:107], a[232:235], v[80:83], a[104:107]
ds_read_b64 a[216:217], v24 offset:36864
ds_read_b64 a[218:219], v25 offset:36864
v_mfma_f32_16x16x32_bf16 a[108:111], a[236:239], v[80:83], a[108:111]
buffer_load_dwordx4 v10, s[40:43], s76 offen offset:2048 nt lds
v_exp_f32 v116, v116
v_mfma_f32_16x16x32_bf16 a[112:115], a[240:243], v[80:83], a[112:115]
ds_read_b64 a[204:205], v26 offset:32768
ds_read_b64 a[206:207], v27 offset:32768
v_cvt_pk_bf16_f32 v113, v114, v115
v_mfma_f32_16x16x32_bf16 a[116:119], a[244:247], v[80:83], a[116:119]
v_lshlrev_b32 v18, 8, v177
v_exp_f32 v117, v117
v_mfma_f32_16x16x32_bf16 a[120:123], a[248:251], v[80:83], a[120:123]
ds_read_b64 a[220:221], v26 offset:36864
ds_read_b64 a[222:223], v27 offset:36864
v_mfma_f32_16x16x32_bf16 a[124:127], a[252:255], v[80:83], a[124:127]
v_exp_f32 v118, v118
v_mfma_f32_16x16x32_bf16 v[124:127], v[48:51], v[80:83], v[124:127]
s_waitcnt lgkmcnt(4)
v_mfma_f32_16x16x32_bf16 v[80:83], a[192:195], v[64:67], 0
v_cvt_pk_bf16_f32 v114, v116, v117
v_exp_f32 v144, v144
v_mfma_f32_16x16x32_bf16 v[84:87], a[208:211], v[64:67], 0
v_exp_f32 v145, v145
v_mfma_f32_16x16x32_bf16 v[80:83], a[196:199], v[68:71], v[80:83]
buffer_load_dwordx4 v19, s[40:43], s76 offen offset:3072 nt lds
v_exp_f32 v119, v119
v_mfma_f32_16x16x32_bf16 v[84:87], a[212:215], v[68:71], v[84:87]
v_exp_f32 v146, v146
v_mfma_f32_16x16x32_bf16 v[80:83], a[200:203], v[72:75], v[80:83]
v_cvt_pk_bf16_f32 v115, v118, v119
v_mfma_f32_16x16x32_bf16 v[84:87], a[216:219], v[72:75], v[84:87]
v_add_u32 v17, v17, v18
v_cvt_pk_bf16_f32 v144, v144, v145
s_waitcnt lgkmcnt(0)
v_mfma_f32_16x16x32_bf16 v[80:83], a[204:207], v[76:79], v[80:83]
v_mfma_f32_16x16x32_bf16 v[84:87], a[220:223], v[76:79], v[84:87]
v_exp_f32 v147, v147
v_mfma_f32_16x16x32_bf16 a[128:131], a[224:227], v[112:115], a[128:131]
v_mfma_f32_16x16x32_bf16 a[132:135], a[228:231], v[112:115], a[132:135]
v_exp_f32 v148, v148
v_mfma_f32_16x16x32_bf16 a[136:139], a[232:235], v[112:115], a[136:139]
s_waitcnt vmcnt(24)
s_barrier
v_mfma_f32_16x16x32_bf16 a[140:143], a[236:239], v[112:115], a[140:143]
s_add_u32 s75, s75, 8192
v_cvt_pk_bf16_f32 v145, v146, v147
v_mfma_f32_16x16x32_bf16 a[144:147], a[240:243], v[112:115], a[144:147]
s_and_b32 s75, s75, 131071
v_mfma_f32_16x16x32_bf16 a[148:151], a[244:247], v[112:115], a[148:151]
s_add_u32 m0, s77, 32768
v_add_u32 v176, s78, v17
v_exp_f32 v149, v149
v_mfma_f32_16x16x32_bf16 a[152:155], a[248:251], v[112:115], a[152:155]
buffer_load_dwordx4 v6, s[36:39], s75 offen nt lds
v_mfma_f32_16x16x32_bf16 a[156:159], a[252:255], v[112:115], a[156:159]
v_exp_f32 v150, v150
v_mfma_f32_16x16x32_bf16 v[152:155], v[48:51], v[112:115], v[152:155]
v_mfma_f32_16x16x32_bf16 v[112:115], a[192:195], v[96:99], 0
v_cvt_pk_bf16_f32 v146, v148, v149
v_exp_f32 v80, v80
v_mfma_f32_16x16x32_bf16 v[116:119], a[208:211], v[96:99], 0
v_exp_f32 v81, v81
v_mfma_f32_16x16x32_bf16 v[112:115], a[196:199], v[100:103], v[112:115]
v_exp_f32 v151, v151
v_mfma_f32_16x16x32_bf16 v[116:119], a[212:215], v[100:103], v[116:119]
v_exp_f32 v82, v82
v_mfma_f32_16x16x32_bf16 v[112:115], a[200:203], v[104:107], v[112:115]
v_cvt_pk_bf16_f32 v147, v150, v151
v_mfma_f32_16x16x32_bf16 v[116:119], a[216:219], v[104:107], v[116:119]
s_add_u32 s58, s3, 0
v_cvt_pk_bf16_f32 v80, v80, v81
v_mfma_f32_16x16x32_bf16 v[112:115], a[204:207], v[108:111], v[112:115]
v_mfma_f32_16x16x32_bf16 v[116:119], a[220:223], v[108:111], v[116:119]
v_exp_f32 v83, v83
v_mfma_f32_16x16x32_bf16 a[160:163], a[224:227], v[144:147], a[160:163]
ds_read_b64_tr_b16 a[224:225], v28 offset:32768
ds_read_b64_tr_b16 a[226:227], v28 offset:36864
v_mfma_f32_16x16x32_bf16 a[164:167], a[228:231], v[144:147], a[164:167]
buffer_load_dwordx4 v7, s[36:39], s75 offen offset:1024 nt lds
v_exp_f32 v84, v84
v_mfma_f32_16x16x32_bf16 a[168:171], a[232:235], v[144:147], a[168:171]
ds_read_b64_tr_b16 a[228:229], v29 offset:32768
ds_read_b64_tr_b16 a[230:231], v29 offset:36864
v_mfma_f32_16x16x32_bf16 a[172:175], a[236:239], v[144:147], a[172:175]
v_cvt_pk_bf16_f32 v81, v82, v83
v_mfma_f32_16x16x32_bf16 a[176:179], a[240:243], v[144:147], a[176:179]
ds_read_b64_tr_b16 a[232:233], v30 offset:32768
ds_read_b64_tr_b16 a[234:235], v30 offset:36864
v_mfma_f32_16x16x32_bf16 a[180:183], a[244:247], v[144:147], a[180:183]
v_exp_f32 v85, v85
v_mfma_f32_16x16x32_bf16 a[184:187], a[248:251], v[144:147], a[184:187]
ds_read_b64_tr_b16 a[236:237], v31 offset:32768
ds_read_b64_tr_b16 a[238:239], v31 offset:36864
s_and_b32 s58, s58, 3
v_mfma_f32_16x16x32_bf16 a[188:191], a[252:255], v[144:147], a[188:191]
v_exp_f32 v86, v86
v_mfma_f32_16x16x32_bf16 v[156:159], v[48:51], v[144:147], v[156:159]
ds_read_b64_tr_b16 a[240:241], v44 offset:32768
ds_read_b64_tr_b16 a[242:243], v44 offset:36864
v_mfma_f32_16x16x32_bf16 v[144:147], a[192:195], v[128:131], 0
v_cvt_pk_bf16_f32 v82, v84, v85
v_exp_f32 v112, v112
v_mfma_f32_16x16x32_bf16 v[148:151], a[208:211], v[128:131], 0
ds_read_b64_tr_b16 a[244:245], v45 offset:32768
ds_read_b64_tr_b16 a[246:247], v45 offset:36864
v_mfma_f32_16x16x32_bf16 v[144:147], a[196:199], v[132:135], v[144:147]
v_exp_f32 v87, v87
v_mfma_f32_16x16x32_bf16 v[148:151], a[212:215], v[132:135], v[148:151]
ds_read_b64_tr_b16 a[248:249], v46 offset:32768
ds_read_b64_tr_b16 a[250:251], v46 offset:36864
v_mfma_f32_16x16x32_bf16 v[144:147], a[200:203], v[136:139], v[144:147]
buffer_load_dwordx4 v8, s[36:39], s75 offen offset:2048 nt lds
v_cvt_pk_bf16_f32 v83, v86, v87
v_mfma_f32_16x16x32_bf16 v[148:151], a[216:219], v[136:139], v[148:151]
ds_read_b64_tr_b16 a[252:253], v47 offset:32768
ds_read_b64_tr_b16 a[254:255], v47 offset:36864
v_xor_b32 v17, s58, v177
v_mfma_f32_16x16x32_bf16 v[144:147], a[204:207], v[140:143], v[144:147]
v_exp_f32 v113, v113
v_mfma_f32_16x16x32_bf16 v[148:151], a[220:223], v[140:143], v[148:151]
v_exp_f32 v114, v114
v_cvt_pk_bf16_f32 v112, v112, v113
s_waitcnt lgkmcnt(4)
v_mfma_f32_16x16x32_bf16 a[0:3], a[224:227], v[80:83], a[0:3]
v_exp_f32 v115, v115
v_mfma_f32_16x16x32_bf16 a[4:7], a[228:231], v[80:83], a[4:7]
v_exp_f32 v116, v116
v_mfma_f32_16x16x32_bf16 a[8:11], a[232:235], v[80:83], a[8:11]
v_mfma_f32_16x16x32_bf16 a[12:15], a[236:239], v[80:83], a[12:15]
v_cvt_pk_bf16_f32 v113, v114, v115
v_mfma_f32_16x16x32_bf16 a[16:19], a[240:243], v[80:83], a[16:19]
v_mfma_f32_16x16x32_bf16 a[20:23], a[244:247], v[80:83], a[20:23]
v_exp_f32 v117, v117
s_waitcnt lgkmcnt(0)
v_mfma_f32_16x16x32_bf16 a[24:27], a[248:251], v[80:83], a[24:27]
v_lshlrev_b32 v17, 6, v17
v_mfma_f32_16x16x32_bf16 a[28:31], a[252:255], v[80:83], a[28:31]
v_exp_f32 v118, v118
v_mfma_f32_16x16x32_bf16 v[88:91], v[48:51], v[80:83], v[88:91]
buffer_load_dwordx4 v9, s[36:39], s75 offen offset:3072 nt lds
v_mfma_f32_16x16x32_bf16 v[80:83], a[192:195], v[160:163], 0
v_cvt_pk_bf16_f32 v114, v116, v117
v_exp_f32 v144, v144
v_mfma_f32_16x16x32_bf16 v[84:87], a[208:211], v[160:163], 0
v_exp_f32 v145, v145
v_mfma_f32_16x16x32_bf16 v[80:83], a[196:199], v[164:167], v[80:83]
v_exp_f32 v119, v119
v_mfma_f32_16x16x32_bf16 v[84:87], a[212:215], v[164:167], v[84:87]
v_exp_f32 v146, v146
v_mfma_f32_16x16x32_bf16 v[80:83], a[200:203], v[168:171], v[80:83]
v_cvt_pk_bf16_f32 v115, v118, v119
v_mfma_f32_16x16x32_bf16 v[84:87], a[216:219], v[168:171], v[84:87]
v_cvt_pk_bf16_f32 v144, v144, v145
v_mfma_f32_16x16x32_bf16 v[80:83], a[204:207], v[172:175], v[80:83]
v_add_u32 v17, v17, v176
v_mfma_f32_16x16x32_bf16 v[84:87], a[220:223], v[172:175], v[84:87]
v_exp_f32 v147, v147
v_mfma_f32_16x16x32_bf16 a[32:35], a[224:227], v[112:115], a[32:35]
v_mfma_f32_16x16x32_bf16 a[36:39], a[228:231], v[112:115], a[36:39]
v_exp_f32 v148, v148
v_mfma_f32_16x16x32_bf16 a[40:43], a[232:235], v[112:115], a[40:43]
v_mfma_f32_16x16x32_bf16 a[44:47], a[236:239], v[112:115], a[44:47]
v_cvt_pk_bf16_f32 v145, v146, v147
v_mfma_f32_16x16x32_bf16 a[48:51], a[240:243], v[112:115], a[48:51]
v_mfma_f32_16x16x32_bf16 a[52:55], a[244:247], v[112:115], a[52:55]
v_exp_f32 v149, v149
v_mfma_f32_16x16x32_bf16 a[56:59], a[248:251], v[112:115], a[56:59]
v_mfma_f32_16x16x32_bf16 a[60:63], a[252:255], v[112:115], a[60:63]
s_add_u32 s58, s3, 1
v_exp_f32 v150, v150
v_mfma_f32_16x16x32_bf16 v[92:95], v[48:51], v[112:115], v[92:95]
v_mfma_f32_16x16x32_bf16 v[112:115], a[192:195], v[192:195], 0
v_cvt_pk_bf16_f32 v146, v148, v149
v_exp_f32 v80, v80
v_mfma_f32_16x16x32_bf16 v[116:119], a[208:211], v[192:195], 0
v_exp_f32 v81, v81
v_mfma_f32_16x16x32_bf16 v[112:115], a[196:199], v[196:199], v[112:115]
v_exp_f32 v151, v151
v_mfma_f32_16x16x32_bf16 v[116:119], a[212:215], v[196:199], v[116:119]
v_exp_f32 v82, v82
v_mfma_f32_16x16x32_bf16 v[112:115], a[200:203], v[200:203], v[112:115]
v_cvt_pk_bf16_f32 v147, v150, v151
v_mfma_f32_16x16x32_bf16 v[116:119], a[216:219], v[200:203], v[116:119]
v_cvt_pk_bf16_f32 v80, v80, v81
v_mfma_f32_16x16x32_bf16 v[112:115], a[204:207], v[204:207], v[112:115]
s_and_b32 s58, s58, 3
v_mfma_f32_16x16x32_bf16 v[116:119], a[220:223], v[204:207], v[116:119]
v_exp_f32 v83, v83
v_mfma_f32_16x16x32_bf16 a[64:67], a[224:227], v[144:147], a[64:67]
s_waitcnt vmcnt(24)
s_barrier
v_mfma_f32_16x16x32_bf16 a[68:71], a[228:231], v[144:147], a[68:71]
s_add_u32 s76, s76, 8192
v_exp_f32 v84, v84
v_mfma_f32_16x16x32_bf16 a[72:75], a[232:235], v[144:147], a[72:75]
s_and_b32 s76, s76, 131071
v_mfma_f32_16x16x32_bf16 a[76:79], a[236:239], v[144:147], a[76:79]
s_add_u32 m0, s77, 98304
v_cvt_pk_bf16_f32 v81, v82, v83
v_mfma_f32_16x16x32_bf16 a[80:83], a[240:243], v[144:147], a[80:83]
buffer_load_dwordx4 v10, s[40:43], s76 offen nt lds
v_mfma_f32_16x16x32_bf16 a[84:87], a[244:247], v[144:147], a[84:87]
v_exp_f32 v85, v85
v_mfma_f32_16x16x32_bf16 a[88:91], a[248:251], v[144:147], a[88:91]
v_mfma_f32_16x16x32_bf16 a[92:95], a[252:255], v[144:147], a[92:95]
v_xor_b32 v18, s58, v177
v_exp_f32 v86, v86
v_mfma_f32_16x16x32_bf16 v[120:123], v[48:51], v[144:147], v[120:123]
v_mfma_f32_16x16x32_bf16 v[144:147], a[192:195], v[224:227], 0
ds_read_b64 a[192:193], v20 offset:49152
ds_read_b64 a[194:195], v21 offset:49152
v_cvt_pk_bf16_f32 v82, v84, v85
v_mfma_f32_16x16x32_bf16 v[148:151], a[208:211], v[224:227], 0
v_exp_f32 v112, v112
v_mfma_f32_16x16x32_bf16 v[144:147], a[196:199], v[228:231], v[144:147]
ds_read_b64 a[208:209], v20 offset:53248
ds_read_b64 a[210:211], v21 offset:53248
v_mfma_f32_16x16x32_bf16 v[148:151], a[212:215], v[228:231], v[148:151]
buffer_load_dwordx4 v19, s[40:43], s76 offen offset:1024 nt lds
v_exp_f32 v87, v87
v_mfma_f32_16x16x32_bf16 v[144:147], a[200:203], v[232:235], v[144:147]
ds_read_b64 a[196:197], v22 offset:49152
ds_read_b64 a[198:199], v23 offset:49152
v_cvt_pk_bf16_f32 v83, v86, v87
v_mfma_f32_16x16x32_bf16 v[148:151], a[216:219], v[232:235], v[148:151]
v_exp_f32 v113, v113
v_mfma_f32_16x16x32_bf16 v[144:147], a[204:207], v[236:239], v[144:147]
ds_read_b64 a[212:213], v22 offset:53248
ds_read_b64 a[214:215], v23 offset:53248
v_mfma_f32_16x16x32_bf16 v[148:151], a[220:223], v[236:239], v[148:151]
v_lshlrev_b32 v18, 6, v18
v_exp_f32 v114, v114
v_mfma_f32_16x16x32_bf16 a[96:99], a[224:227], v[80:83], a[96:99]
ds_read_b64 a[200:201], v24 offset:49152
ds_read_b64 a[202:203], v25 offset:49152
v_cvt_pk_bf16_f32 v112, v112, v113
v_mfma_f32_16x16x32_bf16 a[100:103], a[228:231], v[80:83], a[100:103]
v_exp_f32 v115, v115
v_mfma_f32_16x16x32_bf16 a[104:107], a[232:235], v[80:83], a[104:107]
ds_read_b64 a[216:217], v24 offset:53248
ds_read_b64 a[218:219], v25 offset:53248
v_mfma_f32_16x16x32_bf16 a[108:111], a[236:239], v[80:83], a[108:111]
buffer_load_dwordx4 v10, s[40:43], s76 offen offset:2048 nt lds
v_exp_f32 v116, v116
v_mfma_f32_16x16x32_bf16 a[112:115], a[240:243], v[80:83], a[112:115]
ds_read_b64 a[204:205], v26 offset:49152
ds_read_b64 a[206:207], v27 offset:49152
v_cvt_pk_bf16_f32 v113, v114, v115
v_mfma_f32_16x16x32_bf16 a[116:119], a[244:247], v[80:83], a[116:119]
v_exp_f32 v117, v117
v_mfma_f32_16x16x32_bf16 a[120:123], a[248:251], v[80:83], a[120:123]
ds_read_b64 a[220:221], v26 offset:53248
ds_read_b64 a[222:223], v27 offset:53248
v_mfma_f32_16x16x32_bf16 a[124:127], a[252:255], v[80:83], a[124:127]
v_exp_f32 v118, v118
v_mfma_f32_16x16x32_bf16 v[124:127], v[48:51], v[80:83], v[124:127]
v_add_u32 v18, v18, v176
s_waitcnt lgkmcnt(4)
v_mfma_f32_16x16x32_bf16 v[80:83], a[192:195], v[64:67], 0
v_cvt_pk_bf16_f32 v114, v116, v117
v_exp_f32 v144, v144
v_mfma_f32_16x16x32_bf16 v[84:87], a[208:211], v[64:67], 0
v_exp_f32 v145, v145
v_mfma_f32_16x16x32_bf16 v[80:83], a[196:199], v[68:71], v[80:83]
buffer_load_dwordx4 v19, s[40:43], s76 offen offset:3072 nt lds
v_exp_f32 v119, v119
v_mfma_f32_16x16x32_bf16 v[84:87], a[212:215], v[68:71], v[84:87]
v_exp_f32 v146, v146
v_mfma_f32_16x16x32_bf16 v[80:83], a[200:203], v[72:75], v[80:83]
v_cvt_pk_bf16_f32 v115, v118, v119
v_mfma_f32_16x16x32_bf16 v[84:87], a[216:219], v[72:75], v[84:87]
v_cvt_pk_bf16_f32 v144, v144, v145
s_waitcnt lgkmcnt(0)
v_mfma_f32_16x16x32_bf16 v[80:83], a[204:207], v[76:79], v[80:83]
v_mfma_f32_16x16x32_bf16 v[84:87], a[220:223], v[76:79], v[84:87]
s_add_u32 s58, s3, 2
v_exp_f32 v147, v147
v_mfma_f32_16x16x32_bf16 a[128:131], a[224:227], v[112:115], a[128:131]
v_mfma_f32_16x16x32_bf16 a[132:135], a[228:231], v[112:115], a[132:135]
v_exp_f32 v148, v148
v_mfma_f32_16x16x32_bf16 a[136:139], a[232:235], v[112:115], a[136:139]
s_waitcnt vmcnt(24)
s_barrier
v_mfma_f32_16x16x32_bf16 a[140:143], a[236:239], v[112:115], a[140:143]
s_add_u32 s75, s75, 8192
v_cvt_pk_bf16_f32 v145, v146, v147
v_mfma_f32_16x16x32_bf16 a[144:147], a[240:243], v[112:115], a[144:147]
s_and_b32 s75, s75, 131071
v_mfma_f32_16x16x32_bf16 a[148:151], a[244:247], v[112:115], a[148:151]
s_add_u32 m0, s77, 49152
v_exp_f32 v149, v149
v_mfma_f32_16x16x32_bf16 a[152:155], a[248:251], v[112:115], a[152:155]
buffer_load_dwordx4 v6, s[36:39], s75 offen nt lds
v_mfma_f32_16x16x32_bf16 a[156:159], a[252:255], v[112:115], a[156:159]
v_exp_f32 v150, v150
v_mfma_f32_16x16x32_bf16 v[152:155], v[48:51], v[112:115], v[152:155]
s_and_b32 s58, s58, 3
v_mfma_f32_16x16x32_bf16 v[112:115], a[192:195], v[96:99], 0
v_cvt_pk_bf16_f32 v146, v148, v149
v_exp_f32 v80, v80
v_mfma_f32_16x16x32_bf16 v[116:119], a[208:211], v[96:99], 0
v_exp_f32 v81, v81
v_mfma_f32_16x16x32_bf16 v[112:115], a[196:199], v[100:103], v[112:115]
v_exp_f32 v151, v151
v_mfma_f32_16x16x32_bf16 v[116:119], a[212:215], v[100:103], v[116:119]
v_exp_f32 v82, v82
v_mfma_f32_16x16x32_bf16 v[112:115], a[200:203], v[104:107], v[112:115]
v_cvt_pk_bf16_f32 v147, v150, v151
v_mfma_f32_16x16x32_bf16 v[116:119], a[216:219], v[104:107], v[116:119]
v_cvt_pk_bf16_f32 v80, v80, v81
v_mfma_f32_16x16x32_bf16 v[112:115], a[204:207], v[108:111], v[112:115]
v_mfma_f32_16x16x32_bf16 v[116:119], a[220:223], v[108:111], v[116:119]
v_exp_f32 v83, v83
v_mfma_f32_16x16x32_bf16 a[160:163], a[224:227], v[144:147], a[160:163]
ds_read_b64_tr_b16 a[224:225], v28 offset:49152
ds_read_b64_tr_b16 a[226:227], v28 offset:53248
v_xor_b32 v39, s58, v177
v_mfma_f32_16x16x32_bf16 a[164:167], a[228:231], v[144:147], a[164:167]
buffer_load_dwordx4 v7, s[36:39], s75 offen offset:1024 nt lds
v_exp_f32 v84, v84
v_mfma_f32_16x16x32_bf16 a[168:171], a[232:235], v[144:147], a[168:171]
ds_read_b64_tr_b16 a[228:229], v29 offset:49152
ds_read_b64_tr_b16 a[230:231], v29 offset:53248
v_mfma_f32_16x16x32_bf16 a[172:175], a[236:239], v[144:147], a[172:175]
v_cvt_pk_bf16_f32 v81, v82, v83
v_mfma_f32_16x16x32_bf16 a[176:179], a[240:243], v[144:147], a[176:179]
ds_read_b64_tr_b16 a[232:233], v30 offset:49152
ds_read_b64_tr_b16 a[234:235], v30 offset:53248
v_mfma_f32_16x16x32_bf16 a[180:183], a[244:247], v[144:147], a[180:183]
v_exp_f32 v85, v85
v_mfma_f32_16x16x32_bf16 a[184:187], a[248:251], v[144:147], a[184:187]
ds_read_b64_tr_b16 a[236:237], v31 offset:49152
ds_read_b64_tr_b16 a[238:239], v31 offset:53248
v_mfma_f32_16x16x32_bf16 a[188:191], a[252:255], v[144:147], a[188:191]
v_exp_f32 v86, v86
v_mfma_f32_16x16x32_bf16 v[156:159], v[48:51], v[144:147], v[156:159]
ds_read_b64_tr_b16 a[240:241], v44 offset:49152
ds_read_b64_tr_b16 a[242:243], v44 offset:53248
v_lshlrev_b32 v39, 6, v39
v_mfma_f32_16x16x32_bf16 v[144:147], a[192:195], v[128:131], 0
v_cvt_pk_bf16_f32 v82, v84, v85
v_exp_f32 v112, v112
v_mfma_f32_16x16x32_bf16 v[148:151], a[208:211], v[128:131], 0
ds_read_b64_tr_b16 a[244:245], v45 offset:49152
ds_read_b64_tr_b16 a[246:247], v45 offset:53248
v_mfma_f32_16x16x32_bf16 v[144:147], a[196:199], v[132:135], v[144:147]
v_exp_f32 v87, v87
v_mfma_f32_16x16x32_bf16 v[148:151], a[212:215], v[132:135], v[148:151]
ds_read_b64_tr_b16 a[248:249], v46 offset:49152
ds_read_b64_tr_b16 a[250:251], v46 offset:53248
v_mfma_f32_16x16x32_bf16 v[144:147], a[200:203], v[136:139], v[144:147]
buffer_load_dwordx4 v8, s[36:39], s75 offen offset:2048 nt lds
v_cvt_pk_bf16_f32 v83, v86, v87
v_mfma_f32_16x16x32_bf16 v[148:151], a[216:219], v[136:139], v[148:151]
ds_read_b64_tr_b16 a[252:253], v47 offset:49152
ds_read_b64_tr_b16 a[254:255], v47 offset:53248
v_mfma_f32_16x16x32_bf16 v[144:147], a[204:207], v[140:143], v[144:147]
v_exp_f32 v113, v113
v_mfma_f32_16x16x32_bf16 v[148:151], a[220:223], v[140:143], v[148:151]
v_exp_f32 v114, v114
v_cvt_pk_bf16_f32 v112, v112, v113
s_waitcnt lgkmcnt(4)
v_mfma_f32_16x16x32_bf16 a[0:3], a[224:227], v[80:83], a[0:3]
v_add_u32 v39, v39, v176
v_exp_f32 v115, v115
v_mfma_f32_16x16x32_bf16 a[4:7], a[228:231], v[80:83], a[4:7]
v_exp_f32 v116, v116
v_mfma_f32_16x16x32_bf16 a[8:11], a[232:235], v[80:83], a[8:11]
v_mfma_f32_16x16x32_bf16 a[12:15], a[236:239], v[80:83], a[12:15]
v_cvt_pk_bf16_f32 v113, v114, v115
v_mfma_f32_16x16x32_bf16 a[16:19], a[240:243], v[80:83], a[16:19]
v_mfma_f32_16x16x32_bf16 a[20:23], a[244:247], v[80:83], a[20:23]
v_exp_f32 v117, v117
s_waitcnt lgkmcnt(0)
v_mfma_f32_16x16x32_bf16 a[24:27], a[248:251], v[80:83], a[24:27]
v_mfma_f32_16x16x32_bf16 a[28:31], a[252:255], v[80:83], a[28:31]
v_exp_f32 v118, v118
v_mfma_f32_16x16x32_bf16 v[88:91], v[48:51], v[80:83], v[88:91]
buffer_load_dwordx4 v9, s[36:39], s75 offen offset:3072 nt lds
v_mfma_f32_16x16x32_bf16 v[80:83], a[192:195], v[160:163], 0
s_add_u32 s58, s3, 3
v_cvt_pk_bf16_f32 v114, v116, v117
v_exp_f32 v144, v144
v_mfma_f32_16x16x32_bf16 v[84:87], a[208:211], v[160:163], 0
v_exp_f32 v145, v145
v_mfma_f32_16x16x32_bf16 v[80:83], a[196:199], v[164:167], v[80:83]
v_exp_f32 v119, v119
v_mfma_f32_16x16x32_bf16 v[84:87], a[212:215], v[164:167], v[84:87]
v_exp_f32 v146, v146
v_mfma_f32_16x16x32_bf16 v[80:83], a[200:203], v[168:171], v[80:83]
v_cvt_pk_bf16_f32 v115, v118, v119
v_mfma_f32_16x16x32_bf16 v[84:87], a[216:219], v[168:171], v[84:87]
v_cvt_pk_bf16_f32 v144, v144, v145
v_mfma_f32_16x16x32_bf16 v[80:83], a[204:207], v[172:175], v[80:83]
v_mfma_f32_16x16x32_bf16 v[84:87], a[220:223], v[172:175], v[84:87]
v_exp_f32 v147, v147
v_mfma_f32_16x16x32_bf16 a[32:35], a[224:227], v[112:115], a[32:35]
v_mfma_f32_16x16x32_bf16 a[36:39], a[228:231], v[112:115], a[36:39]
s_and_b32 s58, s58, 3
v_exp_f32 v148, v148
v_mfma_f32_16x16x32_bf16 a[40:43], a[232:235], v[112:115], a[40:43]
v_mfma_f32_16x16x32_bf16 a[44:47], a[236:239], v[112:115], a[44:47]
v_cvt_pk_bf16_f32 v145, v146, v147
v_mfma_f32_16x16x32_bf16 a[48:51], a[240:243], v[112:115], a[48:51]
v_mfma_f32_16x16x32_bf16 a[52:55], a[244:247], v[112:115], a[52:55]
v_exp_f32 v149, v149
v_mfma_f32_16x16x32_bf16 a[56:59], a[248:251], v[112:115], a[56:59]
v_mfma_f32_16x16x32_bf16 a[60:63], a[252:255], v[112:115], a[60:63]
v_exp_f32 v150, v150
v_mfma_f32_16x16x32_bf16 v[92:95], v[48:51], v[112:115], v[92:95]
v_mfma_f32_16x16x32_bf16 v[112:115], a[192:195], v[192:195], 0
v_xor_b32 v40, s58, v177
v_cvt_pk_bf16_f32 v146, v148, v149
v_mfma_f32_16x16x32_bf16 v[116:119], a[208:211], v[192:195], 0
v_exp_f32 v80, v80
v_mfma_f32_16x16x32_bf16 v[112:115], a[196:199], v[196:199], v[112:115]
v_exp_f32 v151, v151
v_mfma_f32_16x16x32_bf16 v[116:119], a[212:215], v[196:199], v[116:119]
v_exp_f32 v81, v81
v_mfma_f32_16x16x32_bf16 v[112:115], a[200:203], v[200:203], v[112:115]
v_cvt_pk_bf16_f32 v147, v150, v151
v_exp_f32 v82, v82
v_mfma_f32_16x16x32_bf16 v[116:119], a[216:219], v[200:203], v[116:119]
v_cvt_pk_bf16_f32 v80, v80, v81
v_mfma_f32_16x16x32_bf16 v[112:115], a[204:207], v[204:207], v[112:115]
v_mfma_f32_16x16x32_bf16 v[116:119], a[220:223], v[204:207], v[116:119]
v_exp_f32 v83, v83
v_mfma_f32_16x16x32_bf16 a[64:67], a[224:227], v[144:147], a[64:67]
s_waitcnt vmcnt(24)
s_barrier
v_mfma_f32_16x16x32_bf16 a[68:71], a[228:231], v[144:147], a[68:71]
s_add_u32 s76, s76, 8192
v_lshlrev_b32 v40, 6, v40
v_exp_f32 v84, v84
v_mfma_f32_16x16x32_bf16 a[72:75], a[232:235], v[144:147], a[72:75]
s_and_b32 s76, s76, 131071
v_mfma_f32_16x16x32_bf16 a[76:79], a[236:239], v[144:147], a[76:79]
s_add_u32 m0, s77, 114688
v_cvt_pk_bf16_f32 v81, v82, v83
v_mfma_f32_16x16x32_bf16 a[80:83], a[240:243], v[144:147], a[80:83]
buffer_load_dwordx4 v10, s[40:43], s76 offen nt lds
v_mfma_f32_16x16x32_bf16 a[84:87], a[244:247], v[144:147], a[84:87]
v_exp_f32 v85, v85
v_mfma_f32_16x16x32_bf16 a[88:91], a[248:251], v[144:147], a[88:91]
v_mfma_f32_16x16x32_bf16 a[92:95], a[252:255], v[144:147], a[92:95]
v_exp_f32 v86, v86
v_mfma_f32_16x16x32_bf16 v[120:123], v[48:51], v[144:147], v[120:123]
v_mfma_f32_16x16x32_bf16 v[144:147], a[192:195], v[224:227], 0
ds_read_b64 a[192:193], v20
ds_read_b64 a[194:195], v21
v_cvt_pk_bf16_f32 v82, v84, v85
v_mfma_f32_16x16x32_bf16 v[148:151], a[208:211], v[224:227], 0
v_add_u32 v40, v40, v176
v_exp_f32 v112, v112
v_mfma_f32_16x16x32_bf16 v[144:147], a[196:199], v[228:231], v[144:147]
ds_read_b64 a[208:209], v20 offset:4096
ds_read_b64 a[210:211], v21 offset:4096
v_mfma_f32_16x16x32_bf16 v[148:151], a[212:215], v[228:231], v[148:151]
buffer_load_dwordx4 v19, s[40:43], s76 offen offset:1024 nt lds
v_exp_f32 v87, v87
v_mfma_f32_16x16x32_bf16 v[144:147], a[200:203], v[232:235], v[144:147]
ds_read_b64 a[196:197], v22
ds_read_b64 a[198:199], v23
v_cvt_pk_bf16_f32 v83, v86, v87
v_mfma_f32_16x16x32_bf16 v[148:151], a[216:219], v[232:235], v[148:151]
v_exp_f32 v113, v113
v_mfma_f32_16x16x32_bf16 v[144:147], a[204:207], v[236:239], v[144:147]
ds_read_b64 a[212:213], v22 offset:4096
ds_read_b64 a[214:215], v23 offset:4096
v_mfma_f32_16x16x32_bf16 v[148:151], a[220:223], v[236:239], v[148:151]
v_exp_f32 v114, v114
v_cvt_pk_bf16_f32 v112, v112, v113
v_mfma_f32_16x16x32_bf16 a[96:99], a[224:227], v[80:83], a[96:99]
ds_read_b64 a[200:201], v24
ds_read_b64 a[202:203], v25
v_mfma_f32_16x16x32_bf16 a[100:103], a[228:231], v[80:83], a[100:103]
v_exp_f32 v115, v115
v_mfma_f32_16x16x32_bf16 a[104:107], a[232:235], v[80:83], a[104:107]
ds_read_b64 a[216:217], v24 offset:4096
ds_read_b64 a[218:219], v25 offset:4096
v_mfma_f32_16x16x32_bf16 a[108:111], a[236:239], v[80:83], a[108:111]
buffer_load_dwordx4 v10, s[40:43], s76 offen offset:2048 nt lds
v_exp_f32 v116, v116
v_mfma_f32_16x16x32_bf16 a[112:115], a[240:243], v[80:83], a[112:115]
ds_read_b64 a[204:205], v26
ds_read_b64 a[206:207], v27
v_cvt_pk_bf16_f32 v113, v114, v115
v_mfma_f32_16x16x32_bf16 a[116:119], a[244:247], v[80:83], a[116:119]
v_exp_f32 v117, v117
v_mfma_f32_16x16x32_bf16 a[120:123], a[248:251], v[80:83], a[120:123]
ds_read_b64 a[220:221], v26 offset:4096
ds_read_b64 a[222:223], v27 offset:4096
v_mfma_f32_16x16x32_bf16 a[124:127], a[252:255], v[80:83], a[124:127]
v_exp_f32 v118, v118
v_mfma_f32_16x16x32_bf16 v[124:127], v[48:51], v[80:83], v[124:127]
s_waitcnt lgkmcnt(4)
v_mfma_f32_16x16x32_bf16 v[80:83], a[192:195], v[64:67], 0
v_cvt_pk_bf16_f32 v114, v116, v117
v_exp_f32 v144, v144
v_mfma_f32_16x16x32_bf16 v[84:87], a[208:211], v[64:67], 0
v_exp_f32 v145, v145
v_mfma_f32_16x16x32_bf16 v[80:83], a[196:199], v[68:71], v[80:83]
buffer_load_dwordx4 v19, s[40:43], s76 offen offset:3072 nt lds
v_exp_f32 v119, v119
v_mfma_f32_16x16x32_bf16 v[84:87], a[212:215], v[68:71], v[84:87]
v_exp_f32 v146, v146
v_mfma_f32_16x16x32_bf16 v[80:83], a[200:203], v[72:75], v[80:83]
v_cvt_pk_bf16_f32 v115, v118, v119
v_mfma_f32_16x16x32_bf16 v[84:87], a[216:219], v[72:75], v[84:87]
v_cvt_pk_bf16_f32 v144, v144, v145
s_waitcnt lgkmcnt(0)
v_mfma_f32_16x16x32_bf16 v[80:83], a[204:207], v[76:79], v[80:83]
v_mfma_f32_16x16x32_bf16 v[84:87], a[220:223], v[76:79], v[84:87]
v_exp_f32 v147, v147
v_mfma_f32_16x16x32_bf16 a[128:131], a[224:227], v[112:115], a[128:131]
v_mfma_f32_16x16x32_bf16 a[132:135], a[228:231], v[112:115], a[132:135]
v_exp_f32 v148, v148
v_mfma_f32_16x16x32_bf16 a[136:139], a[232:235], v[112:115], a[136:139]
s_waitcnt vmcnt(24)
s_barrier
v_mfma_f32_16x16x32_bf16 a[140:143], a[236:239], v[112:115], a[140:143]
s_add_u32 s75, s75, 8192
v_cvt_pk_bf16_f32 v145, v146, v147
v_mfma_f32_16x16x32_bf16 a[144:147], a[240:243], v[112:115], a[144:147]
s_and_b32 s75, s75, 131071
v_mfma_f32_16x16x32_bf16 a[148:151], a[244:247], v[112:115], a[148:151]
s_add_u32 m0, s77, 0
v_exp_f32 v149, v149
v_mfma_f32_16x16x32_bf16 a[152:155], a[248:251], v[112:115], a[152:155]
buffer_load_dwordx4 v6, s[36:39], s75 offen nt lds
v_mfma_f32_16x16x32_bf16 a[156:159], a[252:255], v[112:115], a[156:159]
v_exp_f32 v150, v150
v_mfma_f32_16x16x32_bf16 v[152:155], v[48:51], v[112:115], v[152:155]
v_mfma_f32_16x16x32_bf16 v[112:115], a[192:195], v[96:99], 0
v_cvt_pk_bf16_f32 v146, v148, v149
v_exp_f32 v80, v80
v_mfma_f32_16x16x32_bf16 v[116:119], a[208:211], v[96:99], 0
v_exp_f32 v81, v81
v_mfma_f32_16x16x32_bf16 v[112:115], a[196:199], v[100:103], v[112:115]
v_exp_f32 v151, v151
v_mfma_f32_16x16x32_bf16 v[116:119], a[212:215], v[100:103], v[116:119]
v_exp_f32 v82, v82
v_mfma_f32_16x16x32_bf16 v[112:115], a[200:203], v[104:107], v[112:115]
v_cvt_pk_bf16_f32 v147, v150, v151
v_mfma_f32_16x16x32_bf16 v[116:119], a[216:219], v[104:107], v[116:119]
v_cvt_pk_bf16_f32 v80, v80, v81
v_mfma_f32_16x16x32_bf16 v[112:115], a[204:207], v[108:111], v[112:115]
v_mfma_f32_16x16x32_bf16 v[116:119], a[220:223], v[108:111], v[116:119]
v_exp_f32 v83, v83
v_mfma_f32_16x16x32_bf16 a[160:163], a[224:227], v[144:147], a[160:163]
ds_read_b64_tr_b16 a[224:225], v28
ds_read_b64_tr_b16 a[226:227], v28 offset:4096
v_mfma_f32_16x16x32_bf16 a[164:167], a[228:231], v[144:147], a[164:167]
buffer_load_dwordx4 v7, s[36:39], s75 offen offset:1024 nt lds
v_exp_f32 v84, v84
v_mfma_f32_16x16x32_bf16 a[168:171], a[232:235], v[144:147], a[168:171]
ds_read_b64_tr_b16 a[228:229], v29
ds_read_b64_tr_b16 a[230:231], v29 offset:4096
v_mfma_f32_16x16x32_bf16 a[172:175], a[236:239], v[144:147], a[172:175]
v_cvt_pk_bf16_f32 v81, v82, v83
v_mfma_f32_16x16x32_bf16 a[176:179], a[240:243], v[144:147], a[176:179]
ds_read_b64_tr_b16 a[232:233], v30
ds_read_b64_tr_b16 a[234:235], v30 offset:4096
v_mfma_f32_16x16x32_bf16 a[180:183], a[244:247], v[144:147], a[180:183]
v_exp_f32 v85, v85
v_mfma_f32_16x16x32_bf16 a[184:187], a[248:251], v[144:147], a[184:187]
ds_read_b64_tr_b16 a[236:237], v31
ds_read_b64_tr_b16 a[238:239], v31 offset:4096
v_mfma_f32_16x16x32_bf16 a[188:191], a[252:255], v[144:147], a[188:191]
v_exp_f32 v86, v86
v_mfma_f32_16x16x32_bf16 v[156:159], v[48:51], v[144:147], v[156:159]
ds_read_b64_tr_b16 a[240:241], v44
ds_read_b64_tr_b16 a[242:243], v44 offset:4096
v_mfma_f32_16x16x32_bf16 v[144:147], a[192:195], v[128:131], 0
v_cvt_pk_bf16_f32 v82, v84, v85
v_exp_f32 v112, v112
v_mfma_f32_16x16x32_bf16 v[148:151], a[208:211], v[128:131], 0
ds_read_b64_tr_b16 a[244:245], v45
ds_read_b64_tr_b16 a[246:247], v45 offset:4096
v_mfma_f32_16x16x32_bf16 v[144:147], a[196:199], v[132:135], v[144:147]
v_exp_f32 v87, v87
v_mfma_f32_16x16x32_bf16 v[148:151], a[212:215], v[132:135], v[148:151]
ds_read_b64_tr_b16 a[248:249], v46
ds_read_b64_tr_b16 a[250:251], v46 offset:4096
v_mfma_f32_16x16x32_bf16 v[144:147], a[200:203], v[136:139], v[144:147]
buffer_load_dwordx4 v8, s[36:39], s75 offen offset:2048 nt lds
v_cvt_pk_bf16_f32 v83, v86, v87
v_mfma_f32_16x16x32_bf16 v[148:151], a[216:219], v[136:139], v[148:151]
ds_read_b64_tr_b16 a[252:253], v47
ds_read_b64_tr_b16 a[254:255], v47 offset:4096
v_mfma_f32_16x16x32_bf16 v[144:147], a[204:207], v[140:143], v[144:147]
v_exp_f32 v113, v113
v_mfma_f32_16x16x32_bf16 v[148:151], a[220:223], v[140:143], v[148:151]
v_exp_f32 v114, v114
v_cvt_pk_bf16_f32 v112, v112, v113
s_waitcnt lgkmcnt(4)
v_mfma_f32_16x16x32_bf16 a[0:3], a[224:227], v[80:83], a[0:3]
v_exp_f32 v115, v115
v_mfma_f32_16x16x32_bf16 a[4:7], a[228:231], v[80:83], a[4:7]
v_exp_f32 v116, v116
v_mfma_f32_16x16x32_bf16 a[8:11], a[232:235], v[80:83], a[8:11]
v_mfma_f32_16x16x32_bf16 a[12:15], a[236:239], v[80:83], a[12:15]
v_cvt_pk_bf16_f32 v113, v114, v115
v_mfma_f32_16x16x32_bf16 a[16:19], a[240:243], v[80:83], a[16:19]
v_mfma_f32_16x16x32_bf16 a[20:23], a[244:247], v[80:83], a[20:23]
v_exp_f32 v117, v117
s_waitcnt lgkmcnt(0)
v_mfma_f32_16x16x32_bf16 a[24:27], a[248:251], v[80:83], a[24:27]
v_mfma_f32_16x16x32_bf16 a[28:31], a[252:255], v[80:83], a[28:31]
v_exp_f32 v118, v118
v_mfma_f32_16x16x32_bf16 v[88:91], v[48:51], v[80:83], v[88:91]
buffer_load_dwordx4 v9, s[36:39], s75 offen offset:3072 nt lds
v_mfma_f32_16x16x32_bf16 v[80:83], a[192:195], v[160:163], 0
v_cvt_pk_bf16_f32 v114, v116, v117
v_exp_f32 v144, v144
v_mfma_f32_16x16x32_bf16 v[84:87], a[208:211], v[160:163], 0
v_exp_f32 v145, v145
v_mfma_f32_16x16x32_bf16 v[80:83], a[196:199], v[164:167], v[80:83]
v_exp_f32 v119, v119
v_mfma_f32_16x16x32_bf16 v[84:87], a[212:215], v[164:167], v[84:87]
v_exp_f32 v146, v146
v_mfma_f32_16x16x32_bf16 v[80:83], a[200:203], v[168:171], v[80:83]
v_cvt_pk_bf16_f32 v115, v118, v119
v_mfma_f32_16x16x32_bf16 v[84:87], a[216:219], v[168:171], v[84:87]
v_cvt_pk_bf16_f32 v144, v144, v145
v_mfma_f32_16x16x32_bf16 v[80:83], a[204:207], v[172:175], v[80:83]
v_mfma_f32_16x16x32_bf16 v[84:87], a[220:223], v[172:175], v[84:87]
v_exp_f32 v147, v147
v_mfma_f32_16x16x32_bf16 a[32:35], a[224:227], v[112:115], a[32:35]
v_mfma_f32_16x16x32_bf16 a[36:39], a[228:231], v[112:115], a[36:39]
v_exp_f32 v148, v148
v_mfma_f32_16x16x32_bf16 a[40:43], a[232:235], v[112:115], a[40:43]
v_mfma_f32_16x16x32_bf16 a[44:47], a[236:239], v[112:115], a[44:47]
v_cvt_pk_bf16_f32 v145, v146, v147
v_mfma_f32_16x16x32_bf16 a[48:51], a[240:243], v[112:115], a[48:51]
v_mfma_f32_16x16x32_bf16 a[52:55], a[244:247], v[112:115], a[52:55]
v_exp_f32 v149, v149
v_mfma_f32_16x16x32_bf16 a[56:59], a[248:251], v[112:115], a[56:59]
v_mfma_f32_16x16x32_bf16 a[60:63], a[252:255], v[112:115], a[60:63]
v_exp_f32 v150, v150
v_mfma_f32_16x16x32_bf16 v[92:95], v[48:51], v[112:115], v[92:95]
v_mfma_f32_16x16x32_bf16 v[112:115], a[192:195], v[192:195], 0
v_cvt_pk_bf16_f32 v146, v148, v149
v_exp_f32 v80, v80
v_mfma_f32_16x16x32_bf16 v[116:119], a[208:211], v[192:195], 0
v_exp_f32 v81, v81
v_mfma_f32_16x16x32_bf16 v[112:115], a[196:199], v[196:199], v[112:115]
v_exp_f32 v151, v151
v_mfma_f32_16x16x32_bf16 v[116:119], a[212:215], v[196:199], v[116:119]
v_exp_f32 v82, v82
v_mfma_f32_16x16x32_bf16 v[112:115], a[200:203], v[200:203], v[112:115]
v_cvt_pk_bf16_f32 v147, v150, v151
v_mfma_f32_16x16x32_bf16 v[116:119], a[216:219], v[200:203], v[116:119]
v_cvt_pk_bf16_f32 v80, v80, v81
v_mfma_f32_16x16x32_bf16 v[112:115], a[204:207], v[204:207], v[112:115]
v_mfma_f32_16x16x32_bf16 v[116:119], a[220:223], v[204:207], v[116:119]
v_exp_f32 v83, v83
v_mfma_f32_16x16x32_bf16 a[64:67], a[224:227], v[144:147], a[64:67]
s_waitcnt vmcnt(24)
s_barrier
v_mfma_f32_16x16x32_bf16 a[68:71], a[228:231], v[144:147], a[68:71]
s_add_u32 s76, s76, 8192
v_exp_f32 v84, v84
v_mfma_f32_16x16x32_bf16 a[72:75], a[232:235], v[144:147], a[72:75]
s_and_b32 s76, s76, 131071
v_mfma_f32_16x16x32_bf16 a[76:79], a[236:239], v[144:147], a[76:79]
s_add_u32 m0, s77, 65536
v_cvt_pk_bf16_f32 v81, v82, v83
v_mfma_f32_16x16x32_bf16 a[80:83], a[240:243], v[144:147], a[80:83]
buffer_load_dwordx4 v10, s[40:43], s76 offen nt lds
v_mfma_f32_16x16x32_bf16 a[84:87], a[244:247], v[144:147], a[84:87]
v_exp_f32 v85, v85
v_mfma_f32_16x16x32_bf16 a[88:91], a[248:251], v[144:147], a[88:91]
v_mfma_f32_16x16x32_bf16 a[92:95], a[252:255], v[144:147], a[92:95]
v_exp_f32 v86, v86
v_mfma_f32_16x16x32_bf16 v[120:123], v[48:51], v[144:147], v[120:123]
v_mfma_f32_16x16x32_bf16 v[144:147], a[192:195], v[224:227], 0
ds_read_b64 a[192:193], v20 offset:16384
ds_read_b64 a[194:195], v21 offset:16384
v_cvt_pk_bf16_f32 v82, v84, v85
v_mfma_f32_16x16x32_bf16 v[148:151], a[208:211], v[224:227], 0
v_exp_f32 v112, v112
v_mfma_f32_16x16x32_bf16 v[144:147], a[196:199], v[228:231], v[144:147]
ds_read_b64 a[208:209], v20 offset:20480
ds_read_b64 a[210:211], v21 offset:20480
v_mfma_f32_16x16x32_bf16 v[148:151], a[212:215], v[228:231], v[148:151]
buffer_load_dwordx4 v19, s[40:43], s76 offen offset:1024 nt lds
v_exp_f32 v87, v87
v_mfma_f32_16x16x32_bf16 v[144:147], a[200:203], v[232:235], v[144:147]
ds_read_b64 a[196:197], v22 offset:16384
ds_read_b64 a[198:199], v23 offset:16384
v_cvt_pk_bf16_f32 v83, v86, v87
v_mfma_f32_16x16x32_bf16 v[148:151], a[216:219], v[232:235], v[148:151]
v_exp_f32 v113, v113
v_mfma_f32_16x16x32_bf16 v[144:147], a[204:207], v[236:239], v[144:147]
ds_read_b64 a[212:213], v22 offset:20480
ds_read_b64 a[214:215], v23 offset:20480
v_mfma_f32_16x16x32_bf16 v[148:151], a[220:223], v[236:239], v[148:151]
v_exp_f32 v114, v114
v_cvt_pk_bf16_f32 v112, v112, v113
v_mfma_f32_16x16x32_bf16 a[96:99], a[224:227], v[80:83], a[96:99]
ds_read_b64 a[200:201], v24 offset:16384
ds_read_b64 a[202:203], v25 offset:16384
v_mfma_f32_16x16x32_bf16 a[100:103], a[228:231], v[80:83], a[100:103]
v_exp_f32 v115, v115
v_mfma_f32_16x16x32_bf16 a[104:107], a[232:235], v[80:83], a[104:107]
ds_read_b64 a[216:217], v24 offset:20480
ds_read_b64 a[218:219], v25 offset:20480
v_mfma_f32_16x16x32_bf16 a[108:111], a[236:239], v[80:83], a[108:111]
buffer_load_dwordx4 v10, s[40:43], s76 offen offset:2048 nt lds
v_exp_f32 v116, v116
v_mfma_f32_16x16x32_bf16 a[112:115], a[240:243], v[80:83], a[112:115]
ds_read_b64 a[204:205], v26 offset:16384
ds_read_b64 a[206:207], v27 offset:16384
v_cvt_pk_bf16_f32 v113, v114, v115
v_mfma_f32_16x16x32_bf16 a[116:119], a[244:247], v[80:83], a[116:119]
v_exp_f32 v117, v117
v_mfma_f32_16x16x32_bf16 a[120:123], a[248:251], v[80:83], a[120:123]
ds_read_b64 a[220:221], v26 offset:20480
ds_read_b64 a[222:223], v27 offset:20480
v_mfma_f32_16x16x32_bf16 a[124:127], a[252:255], v[80:83], a[124:127]
v_exp_f32 v118, v118
v_mfma_f32_16x16x32_bf16 v[124:127], v[48:51], v[80:83], v[124:127]
s_waitcnt lgkmcnt(4)
v_mfma_f32_16x16x32_bf16 v[80:83], a[192:195], v[64:67], 0
v_cvt_pk_bf16_f32 v114, v116, v117
v_exp_f32 v144, v144
v_mfma_f32_16x16x32_bf16 v[84:87], a[208:211], v[64:67], 0
v_exp_f32 v145, v145
v_mfma_f32_16x16x32_bf16 v[80:83], a[196:199], v[68:71], v[80:83]
buffer_load_dwordx4 v19, s[40:43], s76 offen offset:3072 nt lds
v_exp_f32 v119, v119
v_mfma_f32_16x16x32_bf16 v[84:87], a[212:215], v[68:71], v[84:87]
v_exp_f32 v146, v146
v_mfma_f32_16x16x32_bf16 v[80:83], a[200:203], v[72:75], v[80:83]
v_cvt_pk_bf16_f32 v115, v118, v119
v_mfma_f32_16x16x32_bf16 v[84:87], a[216:219], v[72:75], v[84:87]
v_cvt_pk_bf16_f32 v144, v144, v145
s_waitcnt lgkmcnt(0)
v_mfma_f32_16x16x32_bf16 v[80:83], a[204:207], v[76:79], v[80:83]
v_mfma_f32_16x16x32_bf16 v[84:87], a[220:223], v[76:79], v[84:87]
v_exp_f32 v147, v147
v_mfma_f32_16x16x32_bf16 a[128:131], a[224:227], v[112:115], a[128:131]
v_mfma_f32_16x16x32_bf16 a[132:135], a[228:231], v[112:115], a[132:135]
v_exp_f32 v148, v148
v_mfma_f32_16x16x32_bf16 a[136:139], a[232:235], v[112:115], a[136:139]
s_waitcnt vmcnt(24)
s_barrier
v_mfma_f32_16x16x32_bf16 a[140:143], a[236:239], v[112:115], a[140:143]
s_add_u32 s75, s75, 8192
v_cvt_pk_bf16_f32 v145, v146, v147
v_mfma_f32_16x16x32_bf16 a[144:147], a[240:243], v[112:115], a[144:147]
s_and_b32 s75, s75, 131071
v_mfma_f32_16x16x32_bf16 a[148:151], a[244:247], v[112:115], a[148:151]
s_add_u32 m0, s77, 16384
v_exp_f32 v149, v149
v_mfma_f32_16x16x32_bf16 a[152:155], a[248:251], v[112:115], a[152:155]
buffer_load_dwordx4 v6, s[36:39], s75 offen nt lds
v_mfma_f32_16x16x32_bf16 a[156:159], a[252:255], v[112:115], a[156:159]
v_exp_f32 v150, v150
v_mfma_f32_16x16x32_bf16 v[152:155], v[48:51], v[112:115], v[152:155]
v_mfma_f32_16x16x32_bf16 v[112:115], a[192:195], v[96:99], 0
v_cvt_pk_bf16_f32 v146, v148, v149
v_exp_f32 v80, v80
v_mfma_f32_16x16x32_bf16 v[116:119], a[208:211], v[96:99], 0
v_exp_f32 v81, v81
v_mfma_f32_16x16x32_bf16 v[112:115], a[196:199], v[100:103], v[112:115]
v_exp_f32 v151, v151
v_mfma_f32_16x16x32_bf16 v[116:119], a[212:215], v[100:103], v[116:119]
v_exp_f32 v82, v82
v_mfma_f32_16x16x32_bf16 v[112:115], a[200:203], v[104:107], v[112:115]
v_cvt_pk_bf16_f32 v147, v150, v151
v_mfma_f32_16x16x32_bf16 v[116:119], a[216:219], v[104:107], v[116:119]
v_cvt_pk_bf16_f32 v80, v80, v81
v_mfma_f32_16x16x32_bf16 v[112:115], a[204:207], v[108:111], v[112:115]
v_mfma_f32_16x16x32_bf16 v[116:119], a[220:223], v[108:111], v[116:119]
v_exp_f32 v83, v83
v_mfma_f32_16x16x32_bf16 a[160:163], a[224:227], v[144:147], a[160:163]
ds_read_b64_tr_b16 a[224:225], v28 offset:16384
ds_read_b64_tr_b16 a[226:227], v28 offset:20480
v_mfma_f32_16x16x32_bf16 a[164:167], a[228:231], v[144:147], a[164:167]
buffer_load_dwordx4 v7, s[36:39], s75 offen offset:1024 nt lds
v_exp_f32 v84, v84
v_mfma_f32_16x16x32_bf16 a[168:171], a[232:235], v[144:147], a[168:171]
ds_read_b64_tr_b16 a[228:229], v29 offset:16384
ds_read_b64_tr_b16 a[230:231], v29 offset:20480
v_mfma_f32_16x16x32_bf16 a[172:175], a[236:239], v[144:147], a[172:175]
v_cvt_pk_bf16_f32 v81, v82, v83
v_mfma_f32_16x16x32_bf16 a[176:179], a[240:243], v[144:147], a[176:179]
ds_read_b64_tr_b16 a[232:233], v30 offset:16384
ds_read_b64_tr_b16 a[234:235], v30 offset:20480
v_mfma_f32_16x16x32_bf16 a[180:183], a[244:247], v[144:147], a[180:183]
v_exp_f32 v85, v85
v_mfma_f32_16x16x32_bf16 a[184:187], a[248:251], v[144:147], a[184:187]
ds_read_b64_tr_b16 a[236:237], v31 offset:16384
ds_read_b64_tr_b16 a[238:239], v31 offset:20480
v_mfma_f32_16x16x32_bf16 a[188:191], a[252:255], v[144:147], a[188:191]
v_exp_f32 v86, v86
v_mfma_f32_16x16x32_bf16 v[156:159], v[48:51], v[144:147], v[156:159]
ds_read_b64_tr_b16 a[240:241], v44 offset:16384
ds_read_b64_tr_b16 a[242:243], v44 offset:20480
v_mfma_f32_16x16x32_bf16 v[144:147], a[192:195], v[128:131], 0
v_cvt_pk_bf16_f32 v82, v84, v85
v_exp_f32 v112, v112
v_mfma_f32_16x16x32_bf16 v[148:151], a[208:211], v[128:131], 0
ds_read_b64_tr_b16 a[244:245], v45 offset:16384
ds_read_b64_tr_b16 a[246:247], v45 offset:20480
v_mfma_f32_16x16x32_bf16 v[144:147], a[196:199], v[132:135], v[144:147]
v_exp_f32 v87, v87
v_mfma_f32_16x16x32_bf16 v[148:151], a[212:215], v[132:135], v[148:151]
ds_read_b64_tr_b16 a[248:249], v46 offset:16384
ds_read_b64_tr_b16 a[250:251], v46 offset:20480
v_mfma_f32_16x16x32_bf16 v[144:147], a[200:203], v[136:139], v[144:147]
buffer_load_dwordx4 v8, s[36:39], s75 offen offset:2048 nt lds
v_cvt_pk_bf16_f32 v83, v86, v87
v_mfma_f32_16x16x32_bf16 v[148:151], a[216:219], v[136:139], v[148:151]
ds_read_b64_tr_b16 a[252:253], v47 offset:16384
ds_read_b64_tr_b16 a[254:255], v47 offset:20480
v_mfma_f32_16x16x32_bf16 v[144:147], a[204:207], v[140:143], v[144:147]
v_exp_f32 v113, v113
v_mfma_f32_16x16x32_bf16 v[148:151], a[220:223], v[140:143], v[148:151]
v_exp_f32 v114, v114
v_cvt_pk_bf16_f32 v112, v112, v113
s_waitcnt lgkmcnt(4)
v_mfma_f32_16x16x32_bf16 a[0:3], a[224:227], v[80:83], a[0:3]
v_exp_f32 v115, v115
v_mfma_f32_16x16x32_bf16 a[4:7], a[228:231], v[80:83], a[4:7]
v_exp_f32 v116, v116
v_mfma_f32_16x16x32_bf16 a[8:11], a[232:235], v[80:83], a[8:11]
v_mfma_f32_16x16x32_bf16 a[12:15], a[236:239], v[80:83], a[12:15]
v_cvt_pk_bf16_f32 v113, v114, v115
v_mfma_f32_16x16x32_bf16 a[16:19], a[240:243], v[80:83], a[16:19]
v_mfma_f32_16x16x32_bf16 a[20:23], a[244:247], v[80:83], a[20:23]
v_exp_f32 v117, v117
s_waitcnt lgkmcnt(0)
v_mfma_f32_16x16x32_bf16 a[24:27], a[248:251], v[80:83], a[24:27]
v_mfma_f32_16x16x32_bf16 a[28:31], a[252:255], v[80:83], a[28:31]
v_exp_f32 v118, v118
v_mfma_f32_16x16x32_bf16 v[88:91], v[48:51], v[80:83], v[88:91]
buffer_load_dwordx4 v9, s[36:39], s75 offen offset:3072 nt lds
v_mfma_f32_16x16x32_bf16 v[80:83], a[192:195], v[160:163], 0
v_cvt_pk_bf16_f32 v114, v116, v117
v_exp_f32 v144, v144
v_mfma_f32_16x16x32_bf16 v[84:87], a[208:211], v[160:163], 0
v_exp_f32 v145, v145
v_mfma_f32_16x16x32_bf16 v[80:83], a[196:199], v[164:167], v[80:83]
v_exp_f32 v119, v119
v_mfma_f32_16x16x32_bf16 v[84:87], a[212:215], v[164:167], v[84:87]
v_exp_f32 v146, v146
v_mfma_f32_16x16x32_bf16 v[80:83], a[200:203], v[168:171], v[80:83]
v_cvt_pk_bf16_f32 v115, v118, v119
v_mfma_f32_16x16x32_bf16 v[84:87], a[216:219], v[168:171], v[84:87]
v_cvt_pk_bf16_f32 v144, v144, v145
v_mfma_f32_16x16x32_bf16 v[80:83], a[204:207], v[172:175], v[80:83]
v_mfma_f32_16x16x32_bf16 v[84:87], a[220:223], v[172:175], v[84:87]
v_exp_f32 v147, v147
v_mfma_f32_16x16x32_bf16 a[32:35], a[224:227], v[112:115], a[32:35]
v_mfma_f32_16x16x32_bf16 a[36:39], a[228:231], v[112:115], a[36:39]
v_exp_f32 v148, v148
v_mfma_f32_16x16x32_bf16 a[40:43], a[232:235], v[112:115], a[40:43]
v_mfma_f32_16x16x32_bf16 a[44:47], a[236:239], v[112:115], a[44:47]
v_cvt_pk_bf16_f32 v145, v146, v147
v_mfma_f32_16x16x32_bf16 a[48:51], a[240:243], v[112:115], a[48:51]
v_mfma_f32_16x16x32_bf16 a[52:55], a[244:247], v[112:115], a[52:55]
v_exp_f32 v149, v149
v_mfma_f32_16x16x32_bf16 a[56:59], a[248:251], v[112:115], a[56:59]
v_mfma_f32_16x16x32_bf16 a[60:63], a[252:255], v[112:115], a[60:63]
v_exp_f32 v150, v150
v_mfma_f32_16x16x32_bf16 v[92:95], v[48:51], v[112:115], v[92:95]
v_mfma_f32_16x16x32_bf16 v[112:115], a[192:195], v[192:195], 0
v_cvt_pk_bf16_f32 v146, v148, v149
v_exp_f32 v80, v80
v_mfma_f32_16x16x32_bf16 v[116:119], a[208:211], v[192:195], 0
v_exp_f32 v81, v81
v_mfma_f32_16x16x32_bf16 v[112:115], a[196:199], v[196:199], v[112:115]
v_exp_f32 v151, v151
v_mfma_f32_16x16x32_bf16 v[116:119], a[212:215], v[196:199], v[116:119]
v_exp_f32 v82, v82
v_mfma_f32_16x16x32_bf16 v[112:115], a[200:203], v[200:203], v[112:115]
v_cvt_pk_bf16_f32 v147, v150, v151
v_mfma_f32_16x16x32_bf16 v[116:119], a[216:219], v[200:203], v[116:119]
v_cvt_pk_bf16_f32 v80, v80, v81
v_mfma_f32_16x16x32_bf16 v[112:115], a[204:207], v[204:207], v[112:115]
v_mfma_f32_16x16x32_bf16 v[116:119], a[220:223], v[204:207], v[116:119]
v_exp_f32 v83, v83
v_mfma_f32_16x16x32_bf16 a[64:67], a[224:227], v[144:147], a[64:67]
s_waitcnt vmcnt(24)
s_barrier
v_mfma_f32_16x16x32_bf16 a[68:71], a[228:231], v[144:147], a[68:71]
s_add_u32 s76, s76, 8192
v_exp_f32 v84, v84
v_mfma_f32_16x16x32_bf16 a[72:75], a[232:235], v[144:147], a[72:75]
s_and_b32 s76, s76, 131071
v_mfma_f32_16x16x32_bf16 a[76:79], a[236:239], v[144:147], a[76:79]
s_add_u32 m0, s77, 81920
v_cvt_pk_bf16_f32 v81, v82, v83
v_mfma_f32_16x16x32_bf16 a[80:83], a[240:243], v[144:147], a[80:83]
buffer_load_dwordx4 v10, s[40:43], s76 offen nt lds
v_mfma_f32_16x16x32_bf16 a[84:87], a[244:247], v[144:147], a[84:87]
v_exp_f32 v85, v85
v_mfma_f32_16x16x32_bf16 a[88:91], a[248:251], v[144:147], a[88:91]
v_mfma_f32_16x16x32_bf16 a[92:95], a[252:255], v[144:147], a[92:95]
v_exp_f32 v86, v86
v_mfma_f32_16x16x32_bf16 v[120:123], v[48:51], v[144:147], v[120:123]
v_mfma_f32_16x16x32_bf16 v[144:147], a[192:195], v[224:227], 0
ds_read_b64 a[192:193], v20 offset:32768
ds_read_b64 a[194:195], v21 offset:32768
v_cvt_pk_bf16_f32 v82, v84, v85
v_mfma_f32_16x16x32_bf16 v[148:151], a[208:211], v[224:227], 0
v_exp_f32 v112, v112
v_mfma_f32_16x16x32_bf16 v[144:147], a[196:199], v[228:231], v[144:147]
ds_read_b64 a[208:209], v20 offset:36864
ds_read_b64 a[210:211], v21 offset:36864
v_mfma_f32_16x16x32_bf16 v[148:151], a[212:215], v[228:231], v[148:151]
buffer_load_dwordx4 v19, s[40:43], s76 offen offset:1024 nt lds
v_exp_f32 v87, v87
v_mfma_f32_16x16x32_bf16 v[144:147], a[200:203], v[232:235], v[144:147]
ds_read_b64 a[196:197], v22 offset:32768
ds_read_b64 a[198:199], v23 offset:32768
v_cvt_pk_bf16_f32 v83, v86, v87
v_mfma_f32_16x16x32_bf16 v[148:151], a[216:219], v[232:235], v[148:151]
v_exp_f32 v113, v113
v_mfma_f32_16x16x32_bf16 v[144:147], a[204:207], v[236:239], v[144:147]
ds_read_b64 a[212:213], v22 offset:36864
ds_read_b64 a[214:215], v23 offset:36864
v_mfma_f32_16x16x32_bf16 v[148:151], a[220:223], v[236:239], v[148:151]
v_exp_f32 v114, v114
v_cvt_pk_bf16_f32 v112, v112, v113
v_mfma_f32_16x16x32_bf16 a[96:99], a[224:227], v[80:83], a[96:99]
ds_read_b64 a[200:201], v24 offset:32768
ds_read_b64 a[202:203], v25 offset:32768
v_mfma_f32_16x16x32_bf16 a[100:103], a[228:231], v[80:83], a[100:103]
v_exp_f32 v115, v115
v_mfma_f32_16x16x32_bf16 a[104:107], a[232:235], v[80:83], a[104:107]
ds_read_b64 a[216:217], v24 offset:36864
ds_read_b64 a[218:219], v25 offset:36864
v_mfma_f32_16x16x32_bf16 a[108:111], a[236:239], v[80:83], a[108:111]
buffer_load_dwordx4 v10, s[40:43], s76 offen offset:2048 nt lds
v_exp_f32 v116, v116
v_mfma_f32_16x16x32_bf16 a[112:115], a[240:243], v[80:83], a[112:115]
ds_read_b64 a[204:205], v26 offset:32768
ds_read_b64 a[206:207], v27 offset:32768
v_cvt_pk_bf16_f32 v113, v114, v115
v_mfma_f32_16x16x32_bf16 a[116:119], a[244:247], v[80:83], a[116:119]
v_exp_f32 v117, v117
v_mfma_f32_16x16x32_bf16 a[120:123], a[248:251], v[80:83], a[120:123]
ds_read_b64 a[220:221], v26 offset:36864
ds_read_b64 a[222:223], v27 offset:36864
v_mfma_f32_16x16x32_bf16 a[124:127], a[252:255], v[80:83], a[124:127]
v_exp_f32 v118, v118
v_mfma_f32_16x16x32_bf16 v[124:127], v[48:51], v[80:83], v[124:127]
s_waitcnt lgkmcnt(4)
v_mfma_f32_16x16x32_bf16 v[80:83], a[192:195], v[64:67], 0
v_cvt_pk_bf16_f32 v114, v116, v117
v_exp_f32 v144, v144
v_mfma_f32_16x16x32_bf16 v[84:87], a[208:211], v[64:67], 0
v_exp_f32 v145, v145
v_mfma_f32_16x16x32_bf16 v[80:83], a[196:199], v[68:71], v[80:83]
buffer_load_dwordx4 v19, s[40:43], s76 offen offset:3072 nt lds
v_exp_f32 v119, v119
v_mfma_f32_16x16x32_bf16 v[84:87], a[212:215], v[68:71], v[84:87]
v_exp_f32 v146, v146
v_mfma_f32_16x16x32_bf16 v[80:83], a[200:203], v[72:75], v[80:83]
v_cvt_pk_bf16_f32 v115, v118, v119
v_mfma_f32_16x16x32_bf16 v[84:87], a[216:219], v[72:75], v[84:87]
v_cvt_pk_bf16_f32 v144, v144, v145
s_waitcnt lgkmcnt(0)
v_mfma_f32_16x16x32_bf16 v[80:83], a[204:207], v[76:79], v[80:83]
v_mfma_f32_16x16x32_bf16 v[84:87], a[220:223], v[76:79], v[84:87]
v_exp_f32 v147, v147
v_mfma_f32_16x16x32_bf16 a[128:131], a[224:227], v[112:115], a[128:131]
v_mfma_f32_16x16x32_bf16 a[132:135], a[228:231], v[112:115], a[132:135]
v_exp_f32 v148, v148
v_mfma_f32_16x16x32_bf16 a[136:139], a[232:235], v[112:115], a[136:139]
s_waitcnt vmcnt(24)
s_barrier
v_mfma_f32_16x16x32_bf16 a[140:143], a[236:239], v[112:115], a[140:143]
s_add_u32 s75, s75, 8192
v_cvt_pk_bf16_f32 v145, v146, v147
v_mfma_f32_16x16x32_bf16 a[144:147], a[240:243], v[112:115], a[144:147]
s_and_b32 s75, s75, 131071
v_mfma_f32_16x16x32_bf16 a[148:151], a[244:247], v[112:115], a[148:151]
s_add_u32 m0, s77, 32768
v_exp_f32 v149, v149
v_mfma_f32_16x16x32_bf16 a[152:155], a[248:251], v[112:115], a[152:155]
buffer_load_dwordx4 v6, s[36:39], s75 offen nt lds
v_mfma_f32_16x16x32_bf16 a[156:159], a[252:255], v[112:115], a[156:159]
v_exp_f32 v150, v150
v_mfma_f32_16x16x32_bf16 v[152:155], v[48:51], v[112:115], v[152:155]
v_mfma_f32_16x16x32_bf16 v[112:115], a[192:195], v[96:99], 0
v_cvt_pk_bf16_f32 v146, v148, v149
v_exp_f32 v80, v80
v_mfma_f32_16x16x32_bf16 v[116:119], a[208:211], v[96:99], 0
v_exp_f32 v81, v81
v_mfma_f32_16x16x32_bf16 v[112:115], a[196:199], v[100:103], v[112:115]
v_exp_f32 v151, v151
v_mfma_f32_16x16x32_bf16 v[116:119], a[212:215], v[100:103], v[116:119]
v_exp_f32 v82, v82
v_mfma_f32_16x16x32_bf16 v[112:115], a[200:203], v[104:107], v[112:115]
v_cvt_pk_bf16_f32 v147, v150, v151
v_mfma_f32_16x16x32_bf16 v[116:119], a[216:219], v[104:107], v[116:119]
v_cvt_pk_bf16_f32 v80, v80, v81
v_mfma_f32_16x16x32_bf16 v[112:115], a[204:207], v[108:111], v[112:115]
v_mfma_f32_16x16x32_bf16 v[116:119], a[220:223], v[108:111], v[116:119]
v_exp_f32 v83, v83
v_mfma_f32_16x16x32_bf16 a[160:163], a[224:227], v[144:147], a[160:163]
ds_read_b64_tr_b16 a[224:225], v28 offset:32768
ds_read_b64_tr_b16 a[226:227], v28 offset:36864
v_mfma_f32_16x16x32_bf16 a[164:167], a[228:231], v[144:147], a[164:167]
buffer_load_dwordx4 v7, s[36:39], s75 offen offset:1024 nt lds
v_exp_f32 v84, v84
v_mfma_f32_16x16x32_bf16 a[168:171], a[232:235], v[144:147], a[168:171]
ds_read_b64_tr_b16 a[228:229], v29 offset:32768
ds_read_b64_tr_b16 a[230:231], v29 offset:36864
v_mfma_f32_16x16x32_bf16 a[172:175], a[236:239], v[144:147], a[172:175]
v_cvt_pk_bf16_f32 v81, v82, v83
v_mfma_f32_16x16x32_bf16 a[176:179], a[240:243], v[144:147], a[176:179]
ds_read_b64_tr_b16 a[232:233], v30 offset:32768
ds_read_b64_tr_b16 a[234:235], v30 offset:36864
v_lshlrev_b32 v179, 7, v42
v_mfma_f32_16x16x32_bf16 a[180:183], a[244:247], v[144:147], a[180:183]
v_exp_f32 v85, v85
v_mfma_f32_16x16x32_bf16 a[184:187], a[248:251], v[144:147], a[184:187]
buffer_load_dword v179, v179, s[52:55], s0 offen
ds_read_b64_tr_b16 a[236:237], v31 offset:32768
ds_read_b64_tr_b16 a[238:239], v31 offset:36864
v_mfma_f32_16x16x32_bf16 a[188:191], a[252:255], v[144:147], a[188:191]
v_exp_f32 v86, v86
v_mfma_f32_16x16x32_bf16 v[156:159], v[48:51], v[144:147], v[156:159]
ds_read_b64_tr_b16 a[240:241], v44 offset:32768
ds_read_b64_tr_b16 a[242:243], v44 offset:36864
v_mfma_f32_16x16x32_bf16 v[144:147], a[192:195], v[128:131], 0
v_cvt_pk_bf16_f32 v82, v84, v85
v_exp_f32 v112, v112
v_mfma_f32_16x16x32_bf16 v[148:151], a[208:211], v[128:131], 0
ds_read_b64_tr_b16 a[244:245], v45 offset:32768
ds_read_b64_tr_b16 a[246:247], v45 offset:36864
v_mfma_f32_16x16x32_bf16 v[144:147], a[196:199], v[132:135], v[144:147]
v_exp_f32 v87, v87
v_mfma_f32_16x16x32_bf16 v[148:151], a[212:215], v[132:135], v[148:151]
ds_read_b64_tr_b16 a[248:249], v46 offset:32768
ds_read_b64_tr_b16 a[250:251], v46 offset:36864
v_mfma_f32_16x16x32_bf16 v[144:147], a[200:203], v[136:139], v[144:147]
buffer_load_dwordx4 v8, s[36:39], s75 offen offset:2048 nt lds
v_cvt_pk_bf16_f32 v83, v86, v87
v_mfma_f32_16x16x32_bf16 v[148:151], a[216:219], v[136:139], v[148:151]
ds_read_b64_tr_b16 a[252:253], v47 offset:32768
ds_read_b64_tr_b16 a[254:255], v47 offset:36864
v_mfma_f32_16x16x32_bf16 v[144:147], a[204:207], v[140:143], v[144:147]
v_exp_f32 v113, v113
v_mfma_f32_16x16x32_bf16 v[148:151], a[220:223], v[140:143], v[148:151]
v_exp_f32 v114, v114
v_cvt_pk_bf16_f32 v112, v112, v113
s_waitcnt lgkmcnt(4)
v_mfma_f32_16x16x32_bf16 a[0:3], a[224:227], v[80:83], a[0:3]
v_exp_f32 v115, v115
v_mfma_f32_16x16x32_bf16 a[4:7], a[228:231], v[80:83], a[4:7]
v_exp_f32 v116, v116
v_mfma_f32_16x16x32_bf16 a[8:11], a[232:235], v[80:83], a[8:11]
v_mfma_f32_16x16x32_bf16 a[12:15], a[236:239], v[80:83], a[12:15]
v_cvt_pk_bf16_f32 v113, v114, v115
v_mfma_f32_16x16x32_bf16 a[16:19], a[240:243], v[80:83], a[16:19]
v_mfma_f32_16x16x32_bf16 a[20:23], a[244:247], v[80:83], a[20:23]
v_exp_f32 v117, v117
s_waitcnt lgkmcnt(0)
v_mfma_f32_16x16x32_bf16 a[24:27], a[248:251], v[80:83], a[24:27]
v_mfma_f32_16x16x32_bf16 a[28:31], a[252:255], v[80:83], a[28:31]
v_exp_f32 v118, v118
v_mfma_f32_16x16x32_bf16 v[88:91], v[48:51], v[80:83], v[88:91]
buffer_load_dwordx4 v9, s[36:39], s75 offen offset:3072 nt lds
v_mfma_f32_16x16x32_bf16 v[80:83], a[192:195], v[160:163], 0
v_cvt_pk_bf16_f32 v114, v116, v117
v_exp_f32 v144, v144
v_mfma_f32_16x16x32_bf16 v[84:87], a[208:211], v[160:163], 0
v_exp_f32 v145, v145
v_mfma_f32_16x16x32_bf16 v[80:83], a[196:199], v[164:167], v[80:83]
v_exp_f32 v119, v119
v_mfma_f32_16x16x32_bf16 v[84:87], a[212:215], v[164:167], v[84:87]
v_exp_f32 v146, v146
v_mfma_f32_16x16x32_bf16 v[80:83], a[200:203], v[168:171], v[80:83]
v_cvt_pk_bf16_f32 v115, v118, v119
v_mfma_f32_16x16x32_bf16 v[84:87], a[216:219], v[168:171], v[84:87]
v_cvt_pk_bf16_f32 v144, v144, v145
v_mfma_f32_16x16x32_bf16 v[80:83], a[204:207], v[172:175], v[80:83]
v_mfma_f32_16x16x32_bf16 v[84:87], a[220:223], v[172:175], v[84:87]
v_exp_f32 v147, v147
v_mfma_f32_16x16x32_bf16 a[32:35], a[224:227], v[112:115], a[32:35]
v_mfma_f32_16x16x32_bf16 a[36:39], a[228:231], v[112:115], a[36:39]
v_exp_f32 v148, v148
v_mfma_f32_16x16x32_bf16 a[40:43], a[232:235], v[112:115], a[40:43]
v_mfma_f32_16x16x32_bf16 a[44:47], a[236:239], v[112:115], a[44:47]
v_cvt_pk_bf16_f32 v145, v146, v147
v_mfma_f32_16x16x32_bf16 a[48:51], a[240:243], v[112:115], a[48:51]
v_mfma_f32_16x16x32_bf16 a[52:55], a[244:247], v[112:115], a[52:55]
v_exp_f32 v149, v149
v_mfma_f32_16x16x32_bf16 a[56:59], a[248:251], v[112:115], a[56:59]
v_mfma_f32_16x16x32_bf16 a[60:63], a[252:255], v[112:115], a[60:63]
v_exp_f32 v150, v150
v_mfma_f32_16x16x32_bf16 v[92:95], v[48:51], v[112:115], v[92:95]
v_mfma_f32_16x16x32_bf16 v[112:115], a[192:195], v[192:195], 0
v_cvt_pk_bf16_f32 v146, v148, v149
v_exp_f32 v80, v80
v_mfma_f32_16x16x32_bf16 v[116:119], a[208:211], v[192:195], 0
v_exp_f32 v81, v81
v_mfma_f32_16x16x32_bf16 v[112:115], a[196:199], v[196:199], v[112:115]
v_exp_f32 v151, v151
v_mfma_f32_16x16x32_bf16 v[116:119], a[212:215], v[196:199], v[116:119]
v_exp_f32 v82, v82
v_mfma_f32_16x16x32_bf16 v[112:115], a[200:203], v[200:203], v[112:115]
v_cvt_pk_bf16_f32 v147, v150, v151
v_mfma_f32_16x16x32_bf16 v[116:119], a[216:219], v[200:203], v[116:119]
v_cvt_pk_bf16_f32 v80, v80, v81
v_mfma_f32_16x16x32_bf16 v[112:115], a[204:207], v[204:207], v[112:115]
v_mfma_f32_16x16x32_bf16 v[116:119], a[220:223], v[204:207], v[116:119]
v_exp_f32 v83, v83
v_mfma_f32_16x16x32_bf16 a[64:67], a[224:227], v[144:147], a[64:67]
s_waitcnt vmcnt(25)
s_barrier
v_mfma_f32_16x16x32_bf16 a[68:71], a[228:231], v[144:147], a[68:71]
s_add_u32 s76, s76, 8192
v_exp_f32 v84, v84
v_mfma_f32_16x16x32_bf16 a[72:75], a[232:235], v[144:147], a[72:75]
s_and_b32 s76, s76, 131071
v_mfma_f32_16x16x32_bf16 a[76:79], a[236:239], v[144:147], a[76:79]
s_add_u32 m0, s77, 98304
v_cvt_pk_bf16_f32 v81, v82, v83
v_mfma_f32_16x16x32_bf16 a[80:83], a[240:243], v[144:147], a[80:83]
buffer_load_dwordx4 v10, s[40:43], s76 offen nt lds
v_mfma_f32_16x16x32_bf16 a[84:87], a[244:247], v[144:147], a[84:87]
v_exp_f32 v85, v85
v_mfma_f32_16x16x32_bf16 a[88:91], a[248:251], v[144:147], a[88:91]
v_mfma_f32_16x16x32_bf16 a[92:95], a[252:255], v[144:147], a[92:95]
v_exp_f32 v86, v86
v_mfma_f32_16x16x32_bf16 v[120:123], v[48:51], v[144:147], v[120:123]
v_mfma_f32_16x16x32_bf16 v[144:147], a[192:195], v[224:227], 0
ds_read_b64 a[192:193], v20 offset:49152
ds_read_b64 a[194:195], v21 offset:49152
v_cvt_pk_bf16_f32 v82, v84, v85
v_mfma_f32_16x16x32_bf16 v[148:151], a[208:211], v[224:227], 0
v_exp_f32 v112, v112
v_mfma_f32_16x16x32_bf16 v[144:147], a[196:199], v[228:231], v[144:147]
ds_read_b64 a[208:209], v20 offset:53248
ds_read_b64 a[210:211], v21 offset:53248
v_mfma_f32_16x16x32_bf16 v[148:151], a[212:215], v[228:231], v[148:151]
buffer_load_dwordx4 v19, s[40:43], s76 offen offset:1024 nt lds
v_exp_f32 v87, v87
v_mfma_f32_16x16x32_bf16 v[144:147], a[200:203], v[232:235], v[144:147]
ds_read_b64 a[196:197], v22 offset:49152
ds_read_b64 a[198:199], v23 offset:49152
v_cvt_pk_bf16_f32 v83, v86, v87
v_mfma_f32_16x16x32_bf16 v[148:151], a[216:219], v[232:235], v[148:151]
v_exp_f32 v113, v113
v_mfma_f32_16x16x32_bf16 v[144:147], a[204:207], v[236:239], v[144:147]
ds_read_b64 a[212:213], v22 offset:53248
ds_read_b64 a[214:215], v23 offset:53248
v_mfma_f32_16x16x32_bf16 v[148:151], a[220:223], v[236:239], v[148:151]
v_exp_f32 v114, v114
v_cvt_pk_bf16_f32 v112, v112, v113
v_mfma_f32_16x16x32_bf16 a[96:99], a[224:227], v[80:83], a[96:99]
ds_read_b64 a[200:201], v24 offset:49152
ds_read_b64 a[202:203], v25 offset:49152
v_mfma_f32_16x16x32_bf16 a[100:103], a[228:231], v[80:83], a[100:103]
v_exp_f32 v115, v115
v_mfma_f32_16x16x32_bf16 a[104:107], a[232:235], v[80:83], a[104:107]
ds_read_b64 a[216:217], v24 offset:53248
ds_read_b64 a[218:219], v25 offset:53248
v_mfma_f32_16x16x32_bf16 a[108:111], a[236:239], v[80:83], a[108:111]
buffer_load_dwordx4 v10, s[40:43], s76 offen offset:2048 nt lds
v_exp_f32 v116, v116
v_mfma_f32_16x16x32_bf16 a[112:115], a[240:243], v[80:83], a[112:115]
ds_read_b64 a[204:205], v26 offset:49152
ds_read_b64 a[206:207], v27 offset:49152
v_cvt_pk_bf16_f32 v113, v114, v115
v_mfma_f32_16x16x32_bf16 a[116:119], a[244:247], v[80:83], a[116:119]
v_exp_f32 v117, v117
v_mfma_f32_16x16x32_bf16 a[120:123], a[248:251], v[80:83], a[120:123]
ds_read_b64 a[220:221], v26 offset:53248
ds_read_b64 a[222:223], v27 offset:53248
v_mfma_f32_16x16x32_bf16 a[124:127], a[252:255], v[80:83], a[124:127]
v_exp_f32 v118, v118
v_mfma_f32_16x16x32_bf16 v[124:127], v[48:51], v[80:83], v[124:127]
s_waitcnt lgkmcnt(4)
v_mfma_f32_16x16x32_bf16 v[80:83], a[192:195], v[64:67], 0
v_cvt_pk_bf16_f32 v114, v116, v117
v_exp_f32 v144, v144
v_mfma_f32_16x16x32_bf16 v[84:87], a[208:211], v[64:67], 0
v_exp_f32 v145, v145
v_mfma_f32_16x16x32_bf16 v[80:83], a[196:199], v[68:71], v[80:83]
buffer_load_dwordx4 v19, s[40:43], s76 offen offset:3072 nt lds
v_exp_f32 v119, v119
v_mfma_f32_16x16x32_bf16 v[84:87], a[212:215], v[68:71], v[84:87]
v_exp_f32 v146, v146
v_mfma_f32_16x16x32_bf16 v[80:83], a[200:203], v[72:75], v[80:83]
v_cvt_pk_bf16_f32 v115, v118, v119
v_mfma_f32_16x16x32_bf16 v[84:87], a[216:219], v[72:75], v[84:87]
v_cvt_pk_bf16_f32 v144, v144, v145
s_waitcnt lgkmcnt(0)
v_mfma_f32_16x16x32_bf16 v[80:83], a[204:207], v[76:79], v[80:83]
v_mfma_f32_16x16x32_bf16 v[84:87], a[220:223], v[76:79], v[84:87]
v_exp_f32 v147, v147
v_mfma_f32_16x16x32_bf16 a[128:131], a[224:227], v[112:115], a[128:131]
v_mfma_f32_16x16x32_bf16 a[132:135], a[228:231], v[112:115], a[132:135]
v_exp_f32 v148, v148
v_mfma_f32_16x16x32_bf16 a[136:139], a[232:235], v[112:115], a[136:139]
s_waitcnt vmcnt(25)
s_barrier
v_mfma_f32_16x16x32_bf16 a[140:143], a[236:239], v[112:115], a[140:143]
s_add_u32 s75, s75, 8192
v_cvt_pk_bf16_f32 v145, v146, v147
v_mfma_f32_16x16x32_bf16 a[144:147], a[240:243], v[112:115], a[144:147]
s_and_b32 s75, s75, 131071
v_mfma_f32_16x16x32_bf16 a[148:151], a[244:247], v[112:115], a[148:151]
s_add_u32 m0, s77, 49152
v_exp_f32 v149, v149
v_mfma_f32_16x16x32_bf16 a[152:155], a[248:251], v[112:115], a[152:155]
buffer_load_dwordx4 v6, s[36:39], s75 offen nt lds
v_mfma_f32_16x16x32_bf16 a[156:159], a[252:255], v[112:115], a[156:159]
v_exp_f32 v150, v150
v_mfma_f32_16x16x32_bf16 v[152:155], v[48:51], v[112:115], v[152:155]
v_mfma_f32_16x16x32_bf16 v[112:115], a[192:195], v[96:99], 0
v_cvt_pk_bf16_f32 v146, v148, v149
v_exp_f32 v80, v80
v_mfma_f32_16x16x32_bf16 v[116:119], a[208:211], v[96:99], 0
v_exp_f32 v81, v81
v_mfma_f32_16x16x32_bf16 v[112:115], a[196:199], v[100:103], v[112:115]
v_exp_f32 v151, v151
v_mfma_f32_16x16x32_bf16 v[116:119], a[212:215], v[100:103], v[116:119]
v_exp_f32 v82, v82
v_mfma_f32_16x16x32_bf16 v[112:115], a[200:203], v[104:107], v[112:115]
v_cvt_pk_bf16_f32 v147, v150, v151
v_mfma_f32_16x16x32_bf16 v[116:119], a[216:219], v[104:107], v[116:119]
v_cvt_pk_bf16_f32 v80, v80, v81
v_mfma_f32_16x16x32_bf16 v[112:115], a[204:207], v[108:111], v[112:115]
v_mfma_f32_16x16x32_bf16 v[116:119], a[220:223], v[108:111], v[116:119]
v_exp_f32 v83, v83
v_mfma_f32_16x16x32_bf16 a[160:163], a[224:227], v[144:147], a[160:163]
ds_read_b64_tr_b16 a[224:225], v28 offset:49152
ds_read_b64_tr_b16 a[226:227], v28 offset:53248
v_mfma_f32_16x16x32_bf16 a[164:167], a[228:231], v[144:147], a[164:167]
buffer_load_dwordx4 v7, s[36:39], s75 offen offset:1024 nt lds
v_exp_f32 v84, v84
v_mfma_f32_16x16x32_bf16 a[168:171], a[232:235], v[144:147], a[168:171]
ds_read_b64_tr_b16 a[228:229], v29 offset:49152
ds_read_b64_tr_b16 a[230:231], v29 offset:53248
v_mfma_f32_16x16x32_bf16 a[172:175], a[236:239], v[144:147], a[172:175]
v_cvt_pk_bf16_f32 v81, v82, v83
v_mfma_f32_16x16x32_bf16 a[176:179], a[240:243], v[144:147], a[176:179]
ds_read_b64_tr_b16 a[232:233], v30 offset:49152
ds_read_b64_tr_b16 a[234:235], v30 offset:53248
v_mfma_f32_16x16x32_bf16 a[180:183], a[244:247], v[144:147], a[180:183]
v_exp_f32 v85, v85
v_mfma_f32_16x16x32_bf16 a[184:187], a[248:251], v[144:147], a[184:187]
ds_read_b64_tr_b16 a[236:237], v31 offset:49152
ds_read_b64_tr_b16 a[238:239], v31 offset:53248
v_mfma_f32_16x16x32_bf16 a[188:191], a[252:255], v[144:147], a[188:191]
v_exp_f32 v86, v86
v_mfma_f32_16x16x32_bf16 v[156:159], v[48:51], v[144:147], v[156:159]
ds_read_b64_tr_b16 a[240:241], v44 offset:49152
ds_read_b64_tr_b16 a[242:243], v44 offset:53248
v_mfma_f32_16x16x32_bf16 v[144:147], a[192:195], v[128:131], 0
v_cvt_pk_bf16_f32 v82, v84, v85
v_exp_f32 v112, v112
v_mfma_f32_16x16x32_bf16 v[148:151], a[208:211], v[128:131], 0
ds_read_b64_tr_b16 a[244:245], v45 offset:49152
ds_read_b64_tr_b16 a[246:247], v45 offset:53248
v_mfma_f32_16x16x32_bf16 v[144:147], a[196:199], v[132:135], v[144:147]
v_exp_f32 v87, v87
v_mfma_f32_16x16x32_bf16 v[148:151], a[212:215], v[132:135], v[148:151]
ds_read_b64_tr_b16 a[248:249], v46 offset:49152
ds_read_b64_tr_b16 a[250:251], v46 offset:53248
v_mfma_f32_16x16x32_bf16 v[144:147], a[200:203], v[136:139], v[144:147]
buffer_load_dwordx4 v8, s[36:39], s75 offen offset:2048 nt lds
v_cvt_pk_bf16_f32 v83, v86, v87
v_mfma_f32_16x16x32_bf16 v[148:151], a[216:219], v[136:139], v[148:151]
ds_read_b64_tr_b16 a[252:253], v47 offset:49152
ds_read_b64_tr_b16 a[254:255], v47 offset:53248
v_mfma_f32_16x16x32_bf16 v[144:147], a[204:207], v[140:143], v[144:147]
v_exp_f32 v113, v113
v_mfma_f32_16x16x32_bf16 v[148:151], a[220:223], v[140:143], v[148:151]
v_exp_f32 v114, v114
v_cvt_pk_bf16_f32 v112, v112, v113
s_waitcnt lgkmcnt(4)
v_mfma_f32_16x16x32_bf16 a[0:3], a[224:227], v[80:83], a[0:3]
v_exp_f32 v115, v115
v_mfma_f32_16x16x32_bf16 a[4:7], a[228:231], v[80:83], a[4:7]
v_exp_f32 v116, v116
v_mfma_f32_16x16x32_bf16 a[8:11], a[232:235], v[80:83], a[8:11]
v_mfma_f32_16x16x32_bf16 a[12:15], a[236:239], v[80:83], a[12:15]
v_cvt_pk_bf16_f32 v113, v114, v115
v_mfma_f32_16x16x32_bf16 a[16:19], a[240:243], v[80:83], a[16:19]
v_mfma_f32_16x16x32_bf16 a[20:23], a[244:247], v[80:83], a[20:23]
v_exp_f32 v117, v117
s_waitcnt lgkmcnt(0)
v_mfma_f32_16x16x32_bf16 a[24:27], a[248:251], v[80:83], a[24:27]
v_mfma_f32_16x16x32_bf16 a[28:31], a[252:255], v[80:83], a[28:31]
v_exp_f32 v118, v118
v_mfma_f32_16x16x32_bf16 v[88:91], v[48:51], v[80:83], v[88:91]
buffer_load_dwordx4 v9, s[36:39], s75 offen offset:3072 nt lds
v_mfma_f32_16x16x32_bf16 v[80:83], a[192:195], v[160:163], 0
v_cvt_pk_bf16_f32 v114, v116, v117
v_exp_f32 v144, v144
v_mfma_f32_16x16x32_bf16 v[84:87], a[208:211], v[160:163], 0
v_exp_f32 v145, v145
v_mfma_f32_16x16x32_bf16 v[80:83], a[196:199], v[164:167], v[80:83]
v_exp_f32 v119, v119
v_mfma_f32_16x16x32_bf16 v[84:87], a[212:215], v[164:167], v[84:87]
v_exp_f32 v146, v146
v_mfma_f32_16x16x32_bf16 v[80:83], a[200:203], v[168:171], v[80:83]
v_cvt_pk_bf16_f32 v115, v118, v119
v_mfma_f32_16x16x32_bf16 v[84:87], a[216:219], v[168:171], v[84:87]
v_cvt_pk_bf16_f32 v144, v144, v145
v_mfma_f32_16x16x32_bf16 v[80:83], a[204:207], v[172:175], v[80:83]
v_mfma_f32_16x16x32_bf16 v[84:87], a[220:223], v[172:175], v[84:87]
v_exp_f32 v147, v147
v_mfma_f32_16x16x32_bf16 a[32:35], a[224:227], v[112:115], a[32:35]
v_mfma_f32_16x16x32_bf16 a[36:39], a[228:231], v[112:115], a[36:39]
v_exp_f32 v148, v148
v_mfma_f32_16x16x32_bf16 a[40:43], a[232:235], v[112:115], a[40:43]
v_mfma_f32_16x16x32_bf16 a[44:47], a[236:239], v[112:115], a[44:47]
v_cvt_pk_bf16_f32 v145, v146, v147
v_mfma_f32_16x16x32_bf16 a[48:51], a[240:243], v[112:115], a[48:51]
v_mfma_f32_16x16x32_bf16 a[52:55], a[244:247], v[112:115], a[52:55]
v_exp_f32 v149, v149
v_mfma_f32_16x16x32_bf16 a[56:59], a[248:251], v[112:115], a[56:59]
v_mfma_f32_16x16x32_bf16 a[60:63], a[252:255], v[112:115], a[60:63]
v_exp_f32 v150, v150
v_mfma_f32_16x16x32_bf16 v[92:95], v[48:51], v[112:115], v[92:95]
v_mfma_f32_16x16x32_bf16 v[112:115], a[192:195], v[192:195], 0
v_cvt_pk_bf16_f32 v146, v148, v149
v_exp_f32 v80, v80
v_mfma_f32_16x16x32_bf16 v[116:119], a[208:211], v[192:195], 0
v_exp_f32 v81, v81
v_mfma_f32_16x16x32_bf16 v[112:115], a[196:199], v[196:199], v[112:115]
v_exp_f32 v151, v151
v_mfma_f32_16x16x32_bf16 v[116:119], a[212:215], v[196:199], v[116:119]
v_exp_f32 v82, v82
v_mfma_f32_16x16x32_bf16 v[112:115], a[200:203], v[200:203], v[112:115]
v_cvt_pk_bf16_f32 v147, v150, v151
v_mfma_f32_16x16x32_bf16 v[116:119], a[216:219], v[200:203], v[116:119]
v_cvt_pk_bf16_f32 v80, v80, v81
v_mfma_f32_16x16x32_bf16 v[112:115], a[204:207], v[204:207], v[112:115]
v_mfma_f32_16x16x32_bf16 v[116:119], a[220:223], v[204:207], v[116:119]
v_exp_f32 v83, v83
v_mfma_f32_16x16x32_bf16 a[64:67], a[224:227], v[144:147], a[64:67]
s_waitcnt vmcnt(25)
s_barrier
v_mfma_f32_16x16x32_bf16 a[68:71], a[228:231], v[144:147], a[68:71]
s_add_u32 s76, s76, 8192
v_exp_f32 v84, v84
v_mfma_f32_16x16x32_bf16 a[72:75], a[232:235], v[144:147], a[72:75]
s_and_b32 s76, s76, 131071
v_mfma_f32_16x16x32_bf16 a[76:79], a[236:239], v[144:147], a[76:79]
s_add_u32 m0, s77, 114688
v_cvt_pk_bf16_f32 v81, v82, v83
v_mfma_f32_16x16x32_bf16 a[80:83], a[240:243], v[144:147], a[80:83]
buffer_load_dwordx4 v10, s[40:43], s76 offen nt lds
v_mfma_f32_16x16x32_bf16 a[84:87], a[244:247], v[144:147], a[84:87]
v_exp_f32 v85, v85
v_mfma_f32_16x16x32_bf16 a[88:91], a[248:251], v[144:147], a[88:91]
v_mfma_f32_16x16x32_bf16 a[92:95], a[252:255], v[144:147], a[92:95]
v_exp_f32 v86, v86
v_mfma_f32_16x16x32_bf16 v[120:123], v[48:51], v[144:147], v[120:123]
v_mfma_f32_16x16x32_bf16 v[144:147], a[192:195], v[224:227], 0
ds_read_b64 a[192:193], v20
ds_read_b64 a[194:195], v21
v_cvt_pk_bf16_f32 v82, v84, v85
v_mfma_f32_16x16x32_bf16 v[148:151], a[208:211], v[224:227], 0
v_exp_f32 v112, v112
v_mfma_f32_16x16x32_bf16 v[144:147], a[196:199], v[228:231], v[144:147]
ds_read_b64 a[208:209], v20 offset:4096
ds_read_b64 a[210:211], v21 offset:4096
v_mfma_f32_16x16x32_bf16 v[148:151], a[212:215], v[228:231], v[148:151]
buffer_load_dwordx4 v19, s[40:43], s76 offen offset:1024 nt lds
v_exp_f32 v87, v87
v_mfma_f32_16x16x32_bf16 v[144:147], a[200:203], v[232:235], v[144:147]
ds_read_b64 a[196:197], v22
ds_read_b64 a[198:199], v23
v_cvt_pk_bf16_f32 v83, v86, v87
v_mfma_f32_16x16x32_bf16 v[148:151], a[216:219], v[232:235], v[148:151]
v_exp_f32 v113, v113
v_mfma_f32_16x16x32_bf16 v[144:147], a[204:207], v[236:239], v[144:147]
ds_read_b64 a[212:213], v22 offset:4096
ds_read_b64 a[214:215], v23 offset:4096
v_mfma_f32_16x16x32_bf16 v[148:151], a[220:223], v[236:239], v[148:151]
v_exp_f32 v114, v114
v_cvt_pk_bf16_f32 v112, v112, v113
v_mfma_f32_16x16x32_bf16 a[96:99], a[224:227], v[80:83], a[96:99]
ds_read_b64 a[200:201], v24
ds_read_b64 a[202:203], v25
v_mfma_f32_16x16x32_bf16 a[100:103], a[228:231], v[80:83], a[100:103]
v_exp_f32 v115, v115
v_mfma_f32_16x16x32_bf16 a[104:107], a[232:235], v[80:83], a[104:107]
ds_read_b64 a[216:217], v24 offset:4096
ds_read_b64 a[218:219], v25 offset:4096
s_add_u32 s65, s14, 0
v_mfma_f32_16x16x32_bf16 a[108:111], a[236:239], v[80:83], a[108:111]
buffer_load_dwordx4 v10, s[40:43], s76 offen offset:2048 nt lds
buffer_load_dword v183, v182, s[92:95], s65 offen sc1
v_mfma_f32_16x16x32_bf16 a[112:115], a[240:243], v[80:83], a[112:115]
ds_read_b64 a[204:205], v26
ds_read_b64 a[206:207], v27
v_mfma_f32_16x16x32_bf16 a[116:119], a[244:247], v[80:83], a[116:119]
v_exp_f32 v116, v116
v_cvt_pk_bf16_f32 v113, v114, v115
v_mfma_f32_16x16x32_bf16 a[120:123], a[248:251], v[80:83], a[120:123]
ds_read_b64 a[220:221], v26 offset:4096
ds_read_b64 a[222:223], v27 offset:4096
v_mfma_f32_16x16x32_bf16 a[124:127], a[252:255], v[80:83], a[124:127]
v_exp_f32 v117, v117
v_mfma_f32_16x16x32_bf16 v[124:127], v[48:51], v[80:83], v[124:127]
v_exp_f32 v118, v118
s_waitcnt lgkmcnt(4)
v_mfma_f32_16x16x32_bf16 v[80:83], a[192:195], v[64:67], 0
v_cvt_pk_bf16_f32 v114, v116, v117
v_exp_f32 v144, v144
v_mfma_f32_16x16x32_bf16 v[84:87], a[208:211], v[64:67], 0
v_exp_f32 v145, v145
v_mfma_f32_16x16x32_bf16 v[80:83], a[196:199], v[68:71], v[80:83]
buffer_load_dwordx4 v19, s[40:43], s76 offen offset:3072 nt lds
v_exp_f32 v119, v119
v_mfma_f32_16x16x32_bf16 v[84:87], a[212:215], v[68:71], v[84:87]
v_exp_f32 v146, v146
v_mfma_f32_16x16x32_bf16 v[80:83], a[200:203], v[72:75], v[80:83]
v_cvt_pk_bf16_f32 v115, v118, v119
v_mfma_f32_16x16x32_bf16 v[84:87], a[216:219], v[72:75], v[84:87]
v_cvt_pk_bf16_f32 v144, v144, v145
s_waitcnt lgkmcnt(0)
v_mfma_f32_16x16x32_bf16 v[80:83], a[204:207], v[76:79], v[80:83]
v_mfma_f32_16x16x32_bf16 v[84:87], a[220:223], v[76:79], v[84:87]
v_exp_f32 v147, v147
v_mfma_f32_16x16x32_bf16 a[128:131], a[224:227], v[112:115], a[128:131]
v_mfma_f32_16x16x32_bf16 a[132:135], a[228:231], v[112:115], a[132:135]
v_exp_f32 v148, v148
v_mfma_f32_16x16x32_bf16 a[136:139], a[232:235], v[112:115], a[136:139]
s_waitcnt vmcnt(26)
s_barrier
v_mfma_f32_16x16x32_bf16 a[140:143], a[236:239], v[112:115], a[140:143]
v_cvt_pk_bf16_f32 v145, v146, v147
v_mfma_f32_16x16x32_bf16 a[144:147], a[240:243], v[112:115], a[144:147]
v_mfma_f32_16x16x32_bf16 a[148:151], a[244:247], v[112:115], a[148:151]
v_exp_f32 v149, v149
v_mfma_f32_16x16x32_bf16 a[152:155], a[248:251], v[112:115], a[152:155]
v_mfma_f32_16x16x32_bf16 a[156:159], a[252:255], v[112:115], a[156:159]
v_exp_f32 v150, v150
v_mfma_f32_16x16x32_bf16 v[152:155], v[48:51], v[112:115], v[152:155]
v_mfma_f32_16x16x32_bf16 v[112:115], a[192:195], v[96:99], 0
v_cvt_pk_bf16_f32 v146, v148, v149
v_exp_f32 v80, v80
v_mfma_f32_16x16x32_bf16 v[116:119], a[208:211], v[96:99], 0
v_exp_f32 v81, v81
v_mfma_f32_16x16x32_bf16 v[112:115], a[196:199], v[100:103], v[112:115]
v_exp_f32 v151, v151
v_mfma_f32_16x16x32_bf16 v[116:119], a[212:215], v[100:103], v[116:119]
v_exp_f32 v82, v82
v_mfma_f32_16x16x32_bf16 v[112:115], a[200:203], v[104:107], v[112:115]
v_cvt_pk_bf16_f32 v147, v150, v151
v_mfma_f32_16x16x32_bf16 v[116:119], a[216:219], v[104:107], v[116:119]
v_cvt_pk_bf16_f32 v80, v80, v81
v_mfma_f32_16x16x32_bf16 v[112:115], a[204:207], v[108:111], v[112:115]
v_mfma_f32_16x16x32_bf16 v[116:119], a[220:223], v[108:111], v[116:119]
v_exp_f32 v83, v83
v_mfma_f32_16x16x32_bf16 a[160:163], a[224:227], v[144:147], a[160:163]
ds_read_b64_tr_b16 a[224:225], v28
ds_read_b64_tr_b16 a[226:227], v28 offset:4096
v_mfma_f32_16x16x32_bf16 a[164:167], a[228:231], v[144:147], a[164:167]
v_exp_f32 v84, v84
v_mfma_f32_16x16x32_bf16 a[168:171], a[232:235], v[144:147], a[168:171]
ds_read_b64_tr_b16 a[228:229], v29
ds_read_b64_tr_b16 a[230:231], v29 offset:4096
v_mfma_f32_16x16x32_bf16 a[172:175], a[236:239], v[144:147], a[172:175]
v_cvt_pk_bf16_f32 v81, v82, v83
v_mfma_f32_16x16x32_bf16 a[176:179], a[240:243], v[144:147], a[176:179]
ds_read_b64_tr_b16 a[232:233], v30
ds_read_b64_tr_b16 a[234:235], v30 offset:4096
v_mfma_f32_16x16x32_bf16 a[180:183], a[244:247], v[144:147], a[180:183]
v_exp_f32 v85, v85
v_mfma_f32_16x16x32_bf16 a[184:187], a[248:251], v[144:147], a[184:187]
ds_read_b64_tr_b16 a[236:237], v31
ds_read_b64_tr_b16 a[238:239], v31 offset:4096
v_mfma_f32_16x16x32_bf16 a[188:191], a[252:255], v[144:147], a[188:191]
v_exp_f32 v86, v86
v_mfma_f32_16x16x32_bf16 v[156:159], v[48:51], v[144:147], v[156:159]
ds_read_b64_tr_b16 a[240:241], v44
ds_read_b64_tr_b16 a[242:243], v44 offset:4096
v_mfma_f32_16x16x32_bf16 v[144:147], a[192:195], v[128:131], 0
v_cvt_pk_bf16_f32 v82, v84, v85
v_exp_f32 v112, v112
v_mfma_f32_16x16x32_bf16 v[148:151], a[208:211], v[128:131], 0
ds_read_b64_tr_b16 a[244:245], v45
ds_read_b64_tr_b16 a[246:247], v45 offset:4096
v_mfma_f32_16x16x32_bf16 v[144:147], a[196:199], v[132:135], v[144:147]
v_exp_f32 v87, v87
v_mfma_f32_16x16x32_bf16 v[148:151], a[212:215], v[132:135], v[148:151]
ds_read_b64_tr_b16 a[248:249], v46
ds_read_b64_tr_b16 a[250:251], v46 offset:4096
v_mfma_f32_16x16x32_bf16 v[144:147], a[200:203], v[136:139], v[144:147]
v_cvt_pk_bf16_f32 v83, v86, v87
v_exp_f32 v113, v113
v_mfma_f32_16x16x32_bf16 v[148:151], a[216:219], v[136:139], v[148:151]
ds_read_b64_tr_b16 a[252:253], v47
ds_read_b64_tr_b16 a[254:255], v47 offset:4096
v_mfma_f32_16x16x32_bf16 v[144:147], a[204:207], v[140:143], v[144:147]
v_exp_f32 v114, v114
v_cvt_pk_bf16_f32 v112, v112, v113
v_mfma_f32_16x16x32_bf16 v[148:151], a[220:223], v[140:143], v[148:151]
v_exp_f32 v115, v115
s_waitcnt lgkmcnt(4)
v_mfma_f32_16x16x32_bf16 a[0:3], a[224:227], v[80:83], a[0:3]
v_mfma_f32_16x16x32_bf16 a[4:7], a[228:231], v[80:83], a[4:7]
v_exp_f32 v116, v116
v_mfma_f32_16x16x32_bf16 a[8:11], a[232:235], v[80:83], a[8:11]
v_mfma_f32_16x16x32_bf16 a[12:15], a[236:239], v[80:83], a[12:15]
v_cvt_pk_bf16_f32 v113, v114, v115
v_mfma_f32_16x16x32_bf16 a[16:19], a[240:243], v[80:83], a[16:19]
v_mfma_f32_16x16x32_bf16 a[20:23], a[244:247], v[80:83], a[20:23]
v_exp_f32 v117, v117
s_waitcnt lgkmcnt(0)
v_mfma_f32_16x16x32_bf16 a[24:27], a[248:251], v[80:83], a[24:27]
v_mfma_f32_16x16x32_bf16 a[28:31], a[252:255], v[80:83], a[28:31]
v_exp_f32 v118, v118
v_mfma_f32_16x16x32_bf16 v[88:91], v[48:51], v[80:83], v[88:91]
v_mfma_f32_16x16x32_bf16 v[80:83], a[192:195], v[160:163], 0
v_cvt_pk_bf16_f32 v114, v116, v117
v_exp_f32 v144, v144
v_mfma_f32_16x16x32_bf16 v[84:87], a[208:211], v[160:163], 0
v_exp_f32 v145, v145
v_mfma_f32_16x16x32_bf16 v[80:83], a[196:199], v[164:167], v[80:83]
v_exp_f32 v119, v119
v_mfma_f32_16x16x32_bf16 v[84:87], a[212:215], v[164:167], v[84:87]
v_exp_f32 v146, v146
v_mfma_f32_16x16x32_bf16 v[80:83], a[200:203], v[168:171], v[80:83]
v_cvt_pk_bf16_f32 v115, v118, v119
v_mfma_f32_16x16x32_bf16 v[84:87], a[216:219], v[168:171], v[84:87]
v_cvt_pk_bf16_f32 v144, v144, v145
v_mfma_f32_16x16x32_bf16 v[80:83], a[204:207], v[172:175], v[80:83]
v_mfma_f32_16x16x32_bf16 v[84:87], a[220:223], v[172:175], v[84:87]
v_exp_f32 v147, v147
v_mfma_f32_16x16x32_bf16 a[32:35], a[224:227], v[112:115], a[32:35]
v_mfma_f32_16x16x32_bf16 a[36:39], a[228:231], v[112:115], a[36:39]
v_exp_f32 v148, v148
v_mfma_f32_16x16x32_bf16 a[40:43], a[232:235], v[112:115], a[40:43]
v_mfma_f32_16x16x32_bf16 a[44:47], a[236:239], v[112:115], a[44:47]
s_lshl_b32 s61, s3, 13
v_cvt_pk_bf16_f32 v145, v146, v147
v_mfma_f32_16x16x32_bf16 a[48:51], a[240:243], v[112:115], a[48:51]
buffer_load_dword v180, v42, s[8:11], s61 offen
v_mfma_f32_16x16x32_bf16 a[52:55], a[244:247], v[112:115], a[52:55]
v_exp_f32 v149, v149
v_mfma_f32_16x16x32_bf16 a[56:59], a[248:251], v[112:115], a[56:59]
v_mfma_f32_16x16x32_bf16 a[60:63], a[252:255], v[112:115], a[60:63]
v_exp_f32 v150, v150
v_mfma_f32_16x16x32_bf16 v[92:95], v[48:51], v[112:115], v[92:95]
v_mfma_f32_16x16x32_bf16 v[112:115], a[192:195], v[192:195], 0
v_cvt_pk_bf16_f32 v146, v148, v149
v_exp_f32 v80, v80
v_mfma_f32_16x16x32_bf16 v[116:119], a[208:211], v[192:195], 0
v_exp_f32 v81, v81
v_mfma_f32_16x16x32_bf16 v[112:115], a[196:199], v[196:199], v[112:115]
v_exp_f32 v151, v151
v_mfma_f32_16x16x32_bf16 v[116:119], a[212:215], v[196:199], v[116:119]
v_exp_f32 v82, v82
v_mfma_f32_16x16x32_bf16 v[112:115], a[200:203], v[200:203], v[112:115]
v_cvt_pk_bf16_f32 v147, v150, v151
v_mfma_f32_16x16x32_bf16 v[116:119], a[216:219], v[200:203], v[116:119]
v_cvt_pk_bf16_f32 v80, v80, v81
v_mfma_f32_16x16x32_bf16 v[112:115], a[204:207], v[204:207], v[112:115]
v_mfma_f32_16x16x32_bf16 v[116:119], a[220:223], v[204:207], v[116:119]
v_exp_f32 v83, v83
v_mfma_f32_16x16x32_bf16 a[64:67], a[224:227], v[144:147], a[64:67]
s_waitcnt vmcnt(23)
s_barrier
v_mfma_f32_16x16x32_bf16 a[68:71], a[228:231], v[144:147], a[68:71]
v_exp_f32 v84, v84
v_mfma_f32_16x16x32_bf16 a[72:75], a[232:235], v[144:147], a[72:75]
v_mfma_f32_16x16x32_bf16 a[76:79], a[236:239], v[144:147], a[76:79]
v_cvt_pk_bf16_f32 v81, v82, v83
v_mfma_f32_16x16x32_bf16 a[80:83], a[240:243], v[144:147], a[80:83]
v_mfma_f32_16x16x32_bf16 a[84:87], a[244:247], v[144:147], a[84:87]
v_exp_f32 v85, v85
v_mfma_f32_16x16x32_bf16 a[88:91], a[248:251], v[144:147], a[88:91]
v_mfma_f32_16x16x32_bf16 a[92:95], a[252:255], v[144:147], a[92:95]
v_exp_f32 v86, v86
v_mfma_f32_16x16x32_bf16 v[120:123], v[48:51], v[144:147], v[120:123]
v_mfma_f32_16x16x32_bf16 v[144:147], a[192:195], v[224:227], 0
ds_read_b64 a[192:193], v20 offset:16384
ds_read_b64 a[194:195], v21 offset:16384
v_cvt_pk_bf16_f32 v82, v84, v85
v_mfma_f32_16x16x32_bf16 v[148:151], a[208:211], v[224:227], 0
v_exp_f32 v112, v112
v_mfma_f32_16x16x32_bf16 v[144:147], a[196:199], v[228:231], v[144:147]
ds_read_b64 a[208:209], v20 offset:20480
ds_read_b64 a[210:211], v21 offset:20480
v_mfma_f32_16x16x32_bf16 v[148:151], a[212:215], v[228:231], v[148:151]
v_exp_f32 v87, v87
v_mfma_f32_16x16x32_bf16 v[144:147], a[200:203], v[232:235], v[144:147]
ds_read_b64 a[196:197], v22 offset:16384
ds_read_b64 a[198:199], v23 offset:16384
v_cvt_pk_bf16_f32 v83, v86, v87
v_mfma_f32_16x16x32_bf16 v[148:151], a[216:219], v[232:235], v[148:151]
v_exp_f32 v113, v113
v_mfma_f32_16x16x32_bf16 v[144:147], a[204:207], v[236:239], v[144:147]
ds_read_b64 a[212:213], v22 offset:20480
ds_read_b64 a[214:215], v23 offset:20480
v_mfma_f32_16x16x32_bf16 v[148:151], a[220:223], v[236:239], v[148:151]
v_exp_f32 v114, v114
v_cvt_pk_bf16_f32 v112, v112, v113
v_mfma_f32_16x16x32_bf16 a[96:99], a[224:227], v[80:83], a[96:99]
ds_read_b64 a[200:201], v24 offset:16384
ds_read_b64 a[202:203], v25 offset:16384
v_mfma_f32_16x16x32_bf16 a[100:103], a[228:231], v[80:83], a[100:103]
v_exp_f32 v115, v115
v_mfma_f32_16x16x32_bf16 a[104:107], a[232:235], v[80:83], a[104:107]
ds_read_b64 a[216:217], v24 offset:20480
ds_read_b64 a[218:219], v25 offset:20480
v_mfma_f32_16x16x32_bf16 a[108:111], a[236:239], v[80:83], a[108:111]
v_exp_f32 v116, v116
v_cvt_pk_bf16_f32 v113, v114, v115
v_mfma_f32_16x16x32_bf16 a[112:115], a[240:243], v[80:83], a[112:115]
ds_read_b64 a[204:205], v26 offset:16384
ds_read_b64 a[206:207], v27 offset:16384
v_mfma_f32_16x16x32_bf16 a[116:119], a[244:247], v[80:83], a[116:119]
v_exp_f32 v117, v117
v_mfma_f32_16x16x32_bf16 a[120:123], a[248:251], v[80:83], a[120:123]
ds_read_b64 a[220:221], v26 offset:20480
ds_read_b64 a[222:223], v27 offset:20480
v_mfma_f32_16x16x32_bf16 a[124:127], a[252:255], v[80:83], a[124:127]
v_exp_f32 v118, v118
v_mfma_f32_16x16x32_bf16 v[124:127], v[48:51], v[80:83], v[124:127]
s_waitcnt lgkmcnt(4)
v_mfma_f32_16x16x32_bf16 v[80:83], a[192:195], v[64:67], 0
v_cvt_pk_bf16_f32 v114, v116, v117
v_exp_f32 v144, v144
v_mfma_f32_16x16x32_bf16 v[84:87], a[208:211], v[64:67], 0
v_exp_f32 v145, v145
v_mfma_f32_16x16x32_bf16 v[80:83], a[196:199], v[68:71], v[80:83]
v_exp_f32 v119, v119
v_mfma_f32_16x16x32_bf16 v[84:87], a[212:215], v[68:71], v[84:87]
v_exp_f32 v146, v146
v_mfma_f32_16x16x32_bf16 v[80:83], a[200:203], v[72:75], v[80:83]
v_cvt_pk_bf16_f32 v115, v118, v119
v_mfma_f32_16x16x32_bf16 v[84:87], a[216:219], v[72:75], v[84:87]
v_cvt_pk_bf16_f32 v144, v144, v145
s_waitcnt lgkmcnt(0)
v_mfma_f32_16x16x32_bf16 v[80:83], a[204:207], v[76:79], v[80:83]
v_mfma_f32_16x16x32_bf16 v[84:87], a[220:223], v[76:79], v[84:87]
v_exp_f32 v147, v147
v_mfma_f32_16x16x32_bf16 a[128:131], a[224:227], v[112:115], a[128:131]
v_mfma_f32_16x16x32_bf16 a[132:135], a[228:231], v[112:115], a[132:135]
v_exp_f32 v148, v148
v_mfma_f32_16x16x32_bf16 a[136:139], a[232:235], v[112:115], a[136:139]
s_waitcnt vmcnt(19)
s_barrier
v_mfma_f32_16x16x32_bf16 a[140:143], a[236:239], v[112:115], a[140:143]
v_cvt_pk_bf16_f32 v145, v146, v147
v_mfma_f32_16x16x32_bf16 a[144:147], a[240:243], v[112:115], a[144:147]
v_mfma_f32_16x16x32_bf16 a[148:151], a[244:247], v[112:115], a[148:151]
v_exp_f32 v149, v149
v_mfma_f32_16x16x32_bf16 a[152:155], a[248:251], v[112:115], a[152:155]
v_mfma_f32_16x16x32_bf16 a[156:159], a[252:255], v[112:115], a[156:159]
v_exp_f32 v150, v150
v_mfma_f32_16x16x32_bf16 v[152:155], v[48:51], v[112:115], v[152:155]
v_mfma_f32_16x16x32_bf16 v[112:115], a[192:195], v[96:99], 0
v_cvt_pk_bf16_f32 v146, v148, v149
v_exp_f32 v80, v80
v_mfma_f32_16x16x32_bf16 v[116:119], a[208:211], v[96:99], 0
v_exp_f32 v81, v81
v_mfma_f32_16x16x32_bf16 v[112:115], a[196:199], v[100:103], v[112:115]
v_exp_f32 v151, v151
v_mfma_f32_16x16x32_bf16 v[116:119], a[212:215], v[100:103], v[116:119]
v_exp_f32 v82, v82
v_mfma_f32_16x16x32_bf16 v[112:115], a[200:203], v[104:107], v[112:115]
v_cvt_pk_bf16_f32 v147, v150, v151
v_mfma_f32_16x16x32_bf16 v[116:119], a[216:219], v[104:107], v[116:119]
v_cvt_pk_bf16_f32 v80, v80, v81
v_mfma_f32_16x16x32_bf16 v[112:115], a[204:207], v[108:111], v[112:115]
v_mfma_f32_16x16x32_bf16 v[116:119], a[220:223], v[108:111], v[116:119]
v_exp_f32 v83, v83
v_mfma_f32_16x16x32_bf16 a[160:163], a[224:227], v[144:147], a[160:163]
ds_read_b64_tr_b16 a[224:225], v28 offset:16384
ds_read_b64_tr_b16 a[226:227], v28 offset:20480
v_mfma_f32_16x16x32_bf16 a[164:167], a[228:231], v[144:147], a[164:167]
v_exp_f32 v84, v84
v_mfma_f32_16x16x32_bf16 a[168:171], a[232:235], v[144:147], a[168:171]
ds_read_b64_tr_b16 a[228:229], v29 offset:16384
ds_read_b64_tr_b16 a[230:231], v29 offset:20480
v_mfma_f32_16x16x32_bf16 a[172:175], a[236:239], v[144:147], a[172:175]
v_cvt_pk_bf16_f32 v81, v82, v83
v_mfma_f32_16x16x32_bf16 a[176:179], a[240:243], v[144:147], a[176:179]
ds_read_b64_tr_b16 a[232:233], v30 offset:16384
ds_read_b64_tr_b16 a[234:235], v30 offset:20480
v_mfma_f32_16x16x32_bf16 a[180:183], a[244:247], v[144:147], a[180:183]
v_exp_f32 v85, v85
v_mfma_f32_16x16x32_bf16 a[184:187], a[248:251], v[144:147], a[184:187]
ds_read_b64_tr_b16 a[236:237], v31 offset:16384
ds_read_b64_tr_b16 a[238:239], v31 offset:20480
v_mfma_f32_16x16x32_bf16 a[188:191], a[252:255], v[144:147], a[188:191]
v_exp_f32 v86, v86
v_mfma_f32_16x16x32_bf16 v[156:159], v[48:51], v[144:147], v[156:159]
ds_read_b64_tr_b16 a[240:241], v44 offset:16384
ds_read_b64_tr_b16 a[242:243], v44 offset:20480
v_mfma_f32_16x16x32_bf16 v[144:147], a[192:195], v[128:131], 0
v_cvt_pk_bf16_f32 v82, v84, v85
v_exp_f32 v112, v112
v_mfma_f32_16x16x32_bf16 v[148:151], a[208:211], v[128:131], 0
ds_read_b64_tr_b16 a[244:245], v45 offset:16384
ds_read_b64_tr_b16 a[246:247], v45 offset:20480
v_mfma_f32_16x16x32_bf16 v[144:147], a[196:199], v[132:135], v[144:147]
v_exp_f32 v87, v87
v_mfma_f32_16x16x32_bf16 v[148:151], a[212:215], v[132:135], v[148:151]
ds_read_b64_tr_b16 a[248:249], v46 offset:16384
ds_read_b64_tr_b16 a[250:251], v46 offset:20480
v_mfma_f32_16x16x32_bf16 v[144:147], a[200:203], v[136:139], v[144:147]
v_cvt_pk_bf16_f32 v83, v86, v87
v_exp_f32 v113, v113
v_mfma_f32_16x16x32_bf16 v[148:151], a[216:219], v[136:139], v[148:151]
ds_read_b64_tr_b16 a[252:253], v47 offset:16384
ds_read_b64_tr_b16 a[254:255], v47 offset:20480
v_mfma_f32_16x16x32_bf16 v[144:147], a[204:207], v[140:143], v[144:147]
v_exp_f32 v114, v114
v_cvt_pk_bf16_f32 v112, v112, v113
v_mfma_f32_16x16x32_bf16 v[148:151], a[220:223], v[140:143], v[148:151]
v_exp_f32 v115, v115
s_waitcnt lgkmcnt(4)
v_mfma_f32_16x16x32_bf16 a[0:3], a[224:227], v[80:83], a[0:3]
v_mfma_f32_16x16x32_bf16 a[4:7], a[228:231], v[80:83], a[4:7]
v_exp_f32 v116, v116
v_mfma_f32_16x16x32_bf16 a[8:11], a[232:235], v[80:83], a[8:11]
v_mfma_f32_16x16x32_bf16 a[12:15], a[236:239], v[80:83], a[12:15]
v_cvt_pk_bf16_f32 v113, v114, v115
v_mfma_f32_16x16x32_bf16 a[16:19], a[240:243], v[80:83], a[16:19]
v_mfma_f32_16x16x32_bf16 a[20:23], a[244:247], v[80:83], a[20:23]
v_exp_f32 v117, v117
s_waitcnt lgkmcnt(0)
v_mfma_f32_16x16x32_bf16 a[24:27], a[248:251], v[80:83], a[24:27]
v_mfma_f32_16x16x32_bf16 a[28:31], a[252:255], v[80:83], a[28:31]
v_exp_f32 v118, v118
v_mfma_f32_16x16x32_bf16 v[88:91], v[48:51], v[80:83], v[88:91]
v_mfma_f32_16x16x32_bf16 v[80:83], a[192:195], v[160:163], 0
v_cvt_pk_bf16_f32 v114, v116, v117
v_exp_f32 v144, v144
v_mfma_f32_16x16x32_bf16 v[84:87], a[208:211], v[160:163], 0
v_exp_f32 v145, v145
v_mfma_f32_16x16x32_bf16 v[80:83], a[196:199], v[164:167], v[80:83]
v_exp_f32 v119, v119
v_mfma_f32_16x16x32_bf16 v[84:87], a[212:215], v[164:167], v[84:87]
v_exp_f32 v146, v146
v_mfma_f32_16x16x32_bf16 v[80:83], a[200:203], v[168:171], v[80:83]
v_cvt_pk_bf16_f32 v115, v118, v119
v_mfma_f32_16x16x32_bf16 v[84:87], a[216:219], v[168:171], v[84:87]
v_cvt_pk_bf16_f32 v144, v144, v145
v_mfma_f32_16x16x32_bf16 v[80:83], a[204:207], v[172:175], v[80:83]
v_mfma_f32_16x16x32_bf16 v[84:87], a[220:223], v[172:175], v[84:87]
v_exp_f32 v147, v147
v_mfma_f32_16x16x32_bf16 a[32:35], a[224:227], v[112:115], a[32:35]
v_mfma_f32_16x16x32_bf16 a[36:39], a[228:231], v[112:115], a[36:39]
v_exp_f32 v148, v148
v_mfma_f32_16x16x32_bf16 a[40:43], a[232:235], v[112:115], a[40:43]
v_mfma_f32_16x16x32_bf16 a[44:47], a[236:239], v[112:115], a[44:47]
v_cvt_pk_bf16_f32 v145, v146, v147
v_mfma_f32_16x16x32_bf16 a[48:51], a[240:243], v[112:115], a[48:51]
s_waitcnt vmcnt(2)
v_readfirstlane_b32 s63, v183
s_nop 0
s_cmp_ge_u32 s63, 8
s_cbranch_scc0 L_concat_heads__mha_block_cached__gqa_block_cached__near_ridge_kernel_poll0_spin
L_concat_heads__mha_block_cached__gqa_block_cached__near_ridge_kernel_poll0_ok:
v_mfma_f32_16x16x32_bf16 a[52:55], a[244:247], v[112:115], a[52:55]
v_exp_f32 v149, v149
v_mfma_f32_16x16x32_bf16 a[56:59], a[248:251], v[112:115], a[56:59]
v_mfma_f32_16x16x32_bf16 a[60:63], a[252:255], v[112:115], a[60:63]
v_exp_f32 v150, v150
v_mfma_f32_16x16x32_bf16 v[92:95], v[48:51], v[112:115], v[92:95]
v_mfma_f32_16x16x32_bf16 v[112:115], a[192:195], v[192:195], 0
v_cvt_pk_bf16_f32 v146, v148, v149
v_exp_f32 v80, v80
v_mfma_f32_16x16x32_bf16 v[116:119], a[208:211], v[192:195], 0
v_exp_f32 v81, v81
v_mfma_f32_16x16x32_bf16 v[112:115], a[196:199], v[196:199], v[112:115]
v_exp_f32 v151, v151
v_mfma_f32_16x16x32_bf16 v[116:119], a[212:215], v[196:199], v[116:119]
v_exp_f32 v82, v82
v_mfma_f32_16x16x32_bf16 v[112:115], a[200:203], v[200:203], v[112:115]
v_cvt_pk_bf16_f32 v147, v150, v151
v_mfma_f32_16x16x32_bf16 v[116:119], a[216:219], v[200:203], v[116:119]
v_cvt_pk_bf16_f32 v80, v80, v81
v_mfma_f32_16x16x32_bf16 v[112:115], a[204:207], v[204:207], v[112:115]
v_mfma_f32_16x16x32_bf16 v[116:119], a[220:223], v[204:207], v[116:119]
v_exp_f32 v83, v83
v_mfma_f32_16x16x32_bf16 a[64:67], a[224:227], v[144:147], a[64:67]
s_barrier
v_mfma_f32_16x16x32_bf16 a[68:71], a[228:231], v[144:147], a[68:71]
v_exp_f32 v84, v84
v_mfma_f32_16x16x32_bf16 a[72:75], a[232:235], v[144:147], a[72:75]
v_mfma_f32_16x16x32_bf16 a[76:79], a[236:239], v[144:147], a[76:79]
v_cvt_pk_bf16_f32 v81, v82, v83
v_mfma_f32_16x16x32_bf16 a[80:83], a[240:243], v[144:147], a[80:83]
v_mfma_f32_16x16x32_bf16 a[84:87], a[244:247], v[144:147], a[84:87]
v_exp_f32 v85, v85
v_mfma_f32_16x16x32_bf16 a[88:91], a[248:251], v[144:147], a[88:91]
v_mfma_f32_16x16x32_bf16 a[92:95], a[252:255], v[144:147], a[92:95]
v_exp_f32 v86, v86
v_mfma_f32_16x16x32_bf16 v[120:123], v[48:51], v[144:147], v[120:123]
v_mfma_f32_16x16x32_bf16 v[144:147], a[192:195], v[224:227], 0
ds_read_b64 a[192:193], v20 offset:32768
ds_read_b64 a[194:195], v21 offset:32768
v_cvt_pk_bf16_f32 v82, v84, v85
v_mfma_f32_16x16x32_bf16 v[148:151], a[208:211], v[224:227], 0
v_exp_f32 v112, v112
v_mfma_f32_16x16x32_bf16 v[144:147], a[196:199], v[228:231], v[144:147]
ds_read_b64 a[208:209], v20 offset:36864
ds_read_b64 a[210:211], v21 offset:36864
v_mfma_f32_16x16x32_bf16 v[148:151], a[212:215], v[228:231], v[148:151]
v_exp_f32 v87, v87
v_mfma_f32_16x16x32_bf16 v[144:147], a[200:203], v[232:235], v[144:147]
ds_read_b64 a[196:197], v22 offset:32768
ds_read_b64 a[198:199], v23 offset:32768
v_cvt_pk_bf16_f32 v83, v86, v87
v_mfma_f32_16x16x32_bf16 v[148:151], a[216:219], v[232:235], v[148:151]
v_exp_f32 v113, v113
v_mfma_f32_16x16x32_bf16 v[144:147], a[204:207], v[236:239], v[144:147]
ds_read_b64 a[212:213], v22 offset:36864
ds_read_b64 a[214:215], v23 offset:36864
v_mfma_f32_16x16x32_bf16 v[148:151], a[220:223], v[236:239], v[148:151]
v_exp_f32 v114, v114
v_cvt_pk_bf16_f32 v112, v112, v113
v_mfma_f32_16x16x32_bf16 a[96:99], a[224:227], v[80:83], a[96:99]
ds_read_b64 a[200:201], v24 offset:32768
ds_read_b64 a[202:203], v25 offset:32768
v_mfma_f32_16x16x32_bf16 a[100:103], a[228:231], v[80:83], a[100:103]
v_exp_f32 v115, v115
v_mfma_f32_16x16x32_bf16 a[104:107], a[232:235], v[80:83], a[104:107]
ds_read_b64 a[216:217], v24 offset:36864
ds_read_b64 a[218:219], v25 offset:36864
v_mfma_f32_16x16x32_bf16 a[108:111], a[236:239], v[80:83], a[108:111]
v_exp_f32 v116, v116
v_cvt_pk_bf16_f32 v113, v114, v115
v_mfma_f32_16x16x32_bf16 a[112:115], a[240:243], v[80:83], a[112:115]
ds_read_b64 a[204:205], v26 offset:32768
ds_read_b64 a[206:207], v27 offset:32768
v_mfma_f32_16x16x32_bf16 a[116:119], a[244:247], v[80:83], a[116:119]
v_exp_f32 v117, v117
v_mfma_f32_16x16x32_bf16 a[120:123], a[248:251], v[80:83], a[120:123]
ds_read_b64 a[220:221], v26 offset:36864
ds_read_b64 a[222:223], v27 offset:36864
v_mfma_f32_16x16x32_bf16 a[124:127], a[252:255], v[80:83], a[124:127]
v_exp_f32 v118, v118
v_mfma_f32_16x16x32_bf16 v[124:127], v[48:51], v[80:83], v[124:127]
s_waitcnt lgkmcnt(4)
v_mfma_f32_16x16x32_bf16 v[80:83], a[192:195], v[64:67], 0
v_cvt_pk_bf16_f32 v114, v116, v117
v_exp_f32 v144, v144
v_mfma_f32_16x16x32_bf16 v[84:87], a[208:211], v[64:67], 0
v_exp_f32 v145, v145
v_mfma_f32_16x16x32_bf16 v[80:83], a[196:199], v[68:71], v[80:83]
v_exp_f32 v119, v119
v_mfma_f32_16x16x32_bf16 v[84:87], a[212:215], v[68:71], v[84:87]
v_exp_f32 v146, v146
v_mfma_f32_16x16x32_bf16 v[80:83], a[200:203], v[72:75], v[80:83]
v_cvt_pk_bf16_f32 v115, v118, v119
v_mfma_f32_16x16x32_bf16 v[84:87], a[216:219], v[72:75], v[84:87]
v_cvt_pk_bf16_f32 v144, v144, v145
s_waitcnt lgkmcnt(0)
v_mfma_f32_16x16x32_bf16 v[80:83], a[204:207], v[76:79], v[80:83]
v_mfma_f32_16x16x32_bf16 v[84:87], a[220:223], v[76:79], v[84:87]
v_exp_f32 v147, v147
v_mfma_f32_16x16x32_bf16 a[128:131], a[224:227], v[112:115], a[128:131]
v_mfma_f32_16x16x32_bf16 a[132:135], a[228:231], v[112:115], a[132:135]
v_exp_f32 v148, v148
v_mfma_f32_16x16x32_bf16 a[136:139], a[232:235], v[112:115], a[136:139]
s_barrier
v_mfma_f32_16x16x32_bf16 a[140:143], a[236:239], v[112:115], a[140:143]
v_cvt_pk_bf16_f32 v145, v146, v147
v_mfma_f32_16x16x32_bf16 a[144:147], a[240:243], v[112:115], a[144:147]
v_mfma_f32_16x16x32_bf16 a[148:151], a[244:247], v[112:115], a[148:151]
v_exp_f32 v149, v149
v_mfma_f32_16x16x32_bf16 a[152:155], a[248:251], v[112:115], a[152:155]
v_mfma_f32_16x16x32_bf16 a[156:159], a[252:255], v[112:115], a[156:159]
v_exp_f32 v150, v150
v_mfma_f32_16x16x32_bf16 v[152:155], v[48:51], v[112:115], v[152:155]
v_mfma_f32_16x16x32_bf16 v[112:115], a[192:195], v[96:99], 0
v_cvt_pk_bf16_f32 v146, v148, v149
v_exp_f32 v80, v80
v_mfma_f32_16x16x32_bf16 v[116:119], a[208:211], v[96:99], 0
v_exp_f32 v81, v81
v_mfma_f32_16x16x32_bf16 v[112:115], a[196:199], v[100:103], v[112:115]
v_exp_f32 v151, v151
v_mfma_f32_16x16x32_bf16 v[116:119], a[212:215], v[100:103], v[116:119]
v_exp_f32 v82, v82
v_mfma_f32_16x16x32_bf16 v[112:115], a[200:203], v[104:107], v[112:115]
v_cvt_pk_bf16_f32 v147, v150, v151
v_mfma_f32_16x16x32_bf16 v[116:119], a[216:219], v[104:107], v[116:119]
v_cvt_pk_bf16_f32 v80, v80, v81
v_mfma_f32_16x16x32_bf16 v[112:115], a[204:207], v[108:111], v[112:115]
v_mfma_f32_16x16x32_bf16 v[116:119], a[220:223], v[108:111], v[116:119]
v_exp_f32 v83, v83
v_mfma_f32_16x16x32_bf16 a[160:163], a[224:227], v[144:147], a[160:163]
ds_read_b64_tr_b16 a[224:225], v28 offset:32768
ds_read_b64_tr_b16 a[226:227], v28 offset:36864
v_mfma_f32_16x16x32_bf16 a[164:167], a[228:231], v[144:147], a[164:167]
v_exp_f32 v84, v84
v_mfma_f32_16x16x32_bf16 a[168:171], a[232:235], v[144:147], a[168:171]
ds_read_b64_tr_b16 a[228:229], v29 offset:32768
ds_read_b64_tr_b16 a[230:231], v29 offset:36864
v_mfma_f32_16x16x32_bf16 a[172:175], a[236:239], v[144:147], a[172:175]
v_cvt_pk_bf16_f32 v81, v82, v83
v_mfma_f32_16x16x32_bf16 a[176:179], a[240:243], v[144:147], a[176:179]
ds_read_b64_tr_b16 a[232:233], v30 offset:32768
ds_read_b64_tr_b16 a[234:235], v30 offset:36864
v_mfma_f32_16x16x32_bf16 a[180:183], a[244:247], v[144:147], a[180:183]
v_exp_f32 v85, v85
v_mfma_f32_16x16x32_bf16 a[184:187], a[248:251], v[144:147], a[184:187]
ds_read_b64_tr_b16 a[236:237], v31 offset:32768
ds_read_b64_tr_b16 a[238:239], v31 offset:36864
v_mfma_f32_16x16x32_bf16 a[188:191], a[252:255], v[144:147], a[188:191]
v_exp_f32 v86, v86
v_mfma_f32_16x16x32_bf16 v[156:159], v[48:51], v[144:147], v[156:159]
ds_read_b64_tr_b16 a[240:241], v44 offset:32768
ds_read_b64_tr_b16 a[242:243], v44 offset:36864
v_mfma_f32_16x16x32_bf16 v[144:147], a[192:195], v[128:131], 0
v_cvt_pk_bf16_f32 v82, v84, v85
v_exp_f32 v112, v112
v_mfma_f32_16x16x32_bf16 v[148:151], a[208:211], v[128:131], 0
ds_read_b64_tr_b16 a[244:245], v45 offset:32768
ds_read_b64_tr_b16 a[246:247], v45 offset:36864
v_mfma_f32_16x16x32_bf16 v[144:147], a[196:199], v[132:135], v[144:147]
v_exp_f32 v87, v87
v_mfma_f32_16x16x32_bf16 v[148:151], a[212:215], v[132:135], v[148:151]
ds_read_b64_tr_b16 a[248:249], v46 offset:32768
ds_read_b64_tr_b16 a[250:251], v46 offset:36864
v_mfma_f32_16x16x32_bf16 v[144:147], a[200:203], v[136:139], v[144:147]
v_cvt_pk_bf16_f32 v83, v86, v87
v_exp_f32 v113, v113
v_mfma_f32_16x16x32_bf16 v[148:151], a[216:219], v[136:139], v[148:151]
ds_read_b64_tr_b16 a[252:253], v47 offset:32768
ds_read_b64_tr_b16 a[254:255], v47 offset:36864
v_mfma_f32_16x16x32_bf16 v[144:147], a[204:207], v[140:143], v[144:147]
v_exp_f32 v114, v114
v_cvt_pk_bf16_f32 v112, v112, v113
v_mfma_f32_16x16x32_bf16 v[148:151], a[220:223], v[140:143], v[148:151]
v_exp_f32 v115, v115
s_waitcnt lgkmcnt(4)
v_mfma_f32_16x16x32_bf16 a[0:3], a[224:227], v[80:83], a[0:3]
v_mfma_f32_16x16x32_bf16 a[4:7], a[228:231], v[80:83], a[4:7]
v_exp_f32 v116, v116
v_mfma_f32_16x16x32_bf16 a[8:11], a[232:235], v[80:83], a[8:11]
v_mfma_f32_16x16x32_bf16 a[12:15], a[236:239], v[80:83], a[12:15]
v_cvt_pk_bf16_f32 v113, v114, v115
v_mfma_f32_16x16x32_bf16 a[16:19], a[240:243], v[80:83], a[16:19]
v_mfma_f32_16x16x32_bf16 a[20:23], a[244:247], v[80:83], a[20:23]
v_exp_f32 v117, v117
s_waitcnt lgkmcnt(0)
v_mfma_f32_16x16x32_bf16 a[24:27], a[248:251], v[80:83], a[24:27]
v_mfma_f32_16x16x32_bf16 a[28:31], a[252:255], v[80:83], a[28:31]
v_exp_f32 v118, v118
v_mfma_f32_16x16x32_bf16 v[88:91], v[48:51], v[80:83], v[88:91]
v_mfma_f32_16x16x32_bf16 v[80:83], a[192:195], v[160:163], 0
v_cvt_pk_bf16_f32 v114, v116, v117
v_exp_f32 v144, v144
v_mfma_f32_16x16x32_bf16 v[84:87], a[208:211], v[160:163], 0
v_exp_f32 v145, v145
v_mfma_f32_16x16x32_bf16 v[80:83], a[196:199], v[164:167], v[80:83]
v_exp_f32 v119, v119
v_mfma_f32_16x16x32_bf16 v[84:87], a[212:215], v[164:167], v[84:87]
v_exp_f32 v146, v146
v_mfma_f32_16x16x32_bf16 v[80:83], a[200:203], v[168:171], v[80:83]
v_cvt_pk_bf16_f32 v115, v118, v119
v_mfma_f32_16x16x32_bf16 v[84:87], a[216:219], v[168:171], v[84:87]
v_cvt_pk_bf16_f32 v144, v144, v145
v_mfma_f32_16x16x32_bf16 v[80:83], a[204:207], v[172:175], v[80:83]
v_mfma_f32_16x16x32_bf16 v[84:87], a[220:223], v[172:175], v[84:87]
v_exp_f32 v147, v147
v_mfma_f32_16x16x32_bf16 a[32:35], a[224:227], v[112:115], a[32:35]
v_mfma_f32_16x16x32_bf16 a[36:39], a[228:231], v[112:115], a[36:39]
v_exp_f32 v148, v148
v_mfma_f32_16x16x32_bf16 a[40:43], a[232:235], v[112:115], a[40:43]
v_mfma_f32_16x16x32_bf16 a[44:47], a[236:239], v[112:115], a[44:47]
v_cvt_pk_bf16_f32 v145, v146, v147
v_mfma_f32_16x16x32_bf16 a[48:51], a[240:243], v[112:115], a[48:51]
v_mfma_f32_16x16x32_bf16 a[52:55], a[244:247], v[112:115], a[52:55]
v_exp_f32 v149, v149
v_mfma_f32_16x16x32_bf16 a[56:59], a[248:251], v[112:115], a[56:59]
v_mfma_f32_16x16x32_bf16 a[60:63], a[252:255], v[112:115], a[60:63]
v_exp_f32 v150, v150
v_mfma_f32_16x16x32_bf16 v[92:95], v[48:51], v[112:115], v[92:95]
v_mfma_f32_16x16x32_bf16 v[112:115], a[192:195], v[192:195], 0
v_cvt_pk_bf16_f32 v146, v148, v149
v_exp_f32 v80, v80
v_mfma_f32_16x16x32_bf16 v[116:119], a[208:211], v[192:195], 0
v_exp_f32 v81, v81
v_mfma_f32_16x16x32_bf16 v[112:115], a[196:199], v[196:199], v[112:115]
v_exp_f32 v151, v151
v_mfma_f32_16x16x32_bf16 v[116:119], a[212:215], v[196:199], v[116:119]
v_exp_f32 v82, v82
v_mfma_f32_16x16x32_bf16 v[112:115], a[200:203], v[200:203], v[112:115]
v_cvt_pk_bf16_f32 v147, v150, v151
v_mfma_f32_16x16x32_bf16 v[116:119], a[216:219], v[200:203], v[116:119]
v_cvt_pk_bf16_f32 v80, v80, v81
v_mfma_f32_16x16x32_bf16 v[112:115], a[204:207], v[204:207], v[112:115]
v_mfma_f32_16x16x32_bf16 v[116:119], a[220:223], v[204:207], v[116:119]
v_exp_f32 v83, v83
v_mfma_f32_16x16x32_bf16 a[64:67], a[224:227], v[144:147], a[64:67]
s_barrier
v_mfma_f32_16x16x32_bf16 a[68:71], a[228:231], v[144:147], a[68:71]
v_exp_f32 v84, v84
v_mfma_f32_16x16x32_bf16 a[72:75], a[232:235], v[144:147], a[72:75]
v_mfma_f32_16x16x32_bf16 a[76:79], a[236:239], v[144:147], a[76:79]
v_cvt_pk_bf16_f32 v81, v82, v83
v_mfma_f32_16x16x32_bf16 a[80:83], a[240:243], v[144:147], a[80:83]
v_mfma_f32_16x16x32_bf16 a[84:87], a[244:247], v[144:147], a[84:87]
v_exp_f32 v85, v85
v_mfma_f32_16x16x32_bf16 a[88:91], a[248:251], v[144:147], a[88:91]
v_mfma_f32_16x16x32_bf16 a[92:95], a[252:255], v[144:147], a[92:95]
v_exp_f32 v86, v86
v_mfma_f32_16x16x32_bf16 v[120:123], v[48:51], v[144:147], v[120:123]
v_mfma_f32_16x16x32_bf16 v[144:147], a[192:195], v[224:227], 0
ds_read_b64 a[192:193], v20 offset:49152
ds_read_b64 a[194:195], v21 offset:49152
v_cvt_pk_bf16_f32 v82, v84, v85
v_mfma_f32_16x16x32_bf16 v[148:151], a[208:211], v[224:227], 0
v_exp_f32 v112, v112
v_mfma_f32_16x16x32_bf16 v[144:147], a[196:199], v[228:231], v[144:147]
ds_read_b64 a[208:209], v20 offset:53248
ds_read_b64 a[210:211], v21 offset:53248
v_mfma_f32_16x16x32_bf16 v[148:151], a[212:215], v[228:231], v[148:151]
v_exp_f32 v87, v87
v_mfma_f32_16x16x32_bf16 v[144:147], a[200:203], v[232:235], v[144:147]
ds_read_b64 a[196:197], v22 offset:49152
ds_read_b64 a[198:199], v23 offset:49152
v_cvt_pk_bf16_f32 v83, v86, v87
v_mfma_f32_16x16x32_bf16 v[148:151], a[216:219], v[232:235], v[148:151]
v_exp_f32 v113, v113
v_mfma_f32_16x16x32_bf16 v[144:147], a[204:207], v[236:239], v[144:147]
ds_read_b64 a[212:213], v22 offset:53248
ds_read_b64 a[214:215], v23 offset:53248
v_mfma_f32_16x16x32_bf16 v[148:151], a[220:223], v[236:239], v[148:151]
v_exp_f32 v114, v114
v_cvt_pk_bf16_f32 v112, v112, v113
v_mfma_f32_16x16x32_bf16 a[96:99], a[224:227], v[80:83], a[96:99]
ds_read_b64 a[200:201], v24 offset:49152
ds_read_b64 a[202:203], v25 offset:49152
v_mfma_f32_16x16x32_bf16 a[100:103], a[228:231], v[80:83], a[100:103]
v_exp_f32 v115, v115
v_mfma_f32_16x16x32_bf16 a[104:107], a[232:235], v[80:83], a[104:107]
ds_read_b64 a[216:217], v24 offset:53248
ds_read_b64 a[218:219], v25 offset:53248
v_mfma_f32_16x16x32_bf16 a[108:111], a[236:239], v[80:83], a[108:111]
v_exp_f32 v116, v116
v_cvt_pk_bf16_f32 v113, v114, v115
v_mfma_f32_16x16x32_bf16 a[112:115], a[240:243], v[80:83], a[112:115]
ds_read_b64 a[204:205], v26 offset:49152
ds_read_b64 a[206:207], v27 offset:49152
v_mfma_f32_16x16x32_bf16 a[116:119], a[244:247], v[80:83], a[116:119]
v_exp_f32 v117, v117
v_mfma_f32_16x16x32_bf16 a[120:123], a[248:251], v[80:83], a[120:123]
ds_read_b64 a[220:221], v26 offset:53248
ds_read_b64 a[222:223], v27 offset:53248
v_mfma_f32_16x16x32_bf16 a[124:127], a[252:255], v[80:83], a[124:127]
v_exp_f32 v118, v118
v_mfma_f32_16x16x32_bf16 v[124:127], v[48:51], v[80:83], v[124:127]
s_waitcnt lgkmcnt(4)
v_mfma_f32_16x16x32_bf16 v[80:83], a[192:195], v[64:67], 0
v_cvt_pk_bf16_f32 v114, v116, v117
v_exp_f32 v144, v144
v_mfma_f32_16x16x32_bf16 v[84:87], a[208:211], v[64:67], 0
v_exp_f32 v145, v145
v_mfma_f32_16x16x32_bf16 v[80:83], a[196:199], v[68:71], v[80:83]
v_exp_f32 v119, v119
v_mfma_f32_16x16x32_bf16 v[84:87], a[212:215], v[68:71], v[84:87]
v_exp_f32 v146, v146
v_mfma_f32_16x16x32_bf16 v[80:83], a[200:203], v[72:75], v[80:83]
v_cvt_pk_bf16_f32 v115, v118, v119
v_mfma_f32_16x16x32_bf16 v[84:87], a[216:219], v[72:75], v[84:87]
v_cvt_pk_bf16_f32 v144, v144, v145
s_waitcnt lgkmcnt(0)
v_mfma_f32_16x16x32_bf16 v[80:83], a[204:207], v[76:79], v[80:83]
v_mfma_f32_16x16x32_bf16 v[84:87], a[220:223], v[76:79], v[84:87]
v_exp_f32 v147, v147
v_mfma_f32_16x16x32_bf16 a[128:131], a[224:227], v[112:115], a[128:131]
v_mfma_f32_16x16x32_bf16 a[132:135], a[228:231], v[112:115], a[132:135]
v_exp_f32 v148, v148
v_mfma_f32_16x16x32_bf16 a[136:139], a[232:235], v[112:115], a[136:139]
s_waitcnt vmcnt(1)
s_barrier
v_mfma_f32_16x16x32_bf16 a[140:143], a[236:239], v[112:115], a[140:143]
v_cvt_pk_bf16_f32 v145, v146, v147
v_mfma_f32_16x16x32_bf16 a[144:147], a[240:243], v[112:115], a[144:147]
v_mfma_f32_16x16x32_bf16 a[148:151], a[244:247], v[112:115], a[148:151]
v_exp_f32 v149, v149
v_mfma_f32_16x16x32_bf16 a[152:155], a[248:251], v[112:115], a[152:155]
v_mfma_f32_16x16x32_bf16 a[156:159], a[252:255], v[112:115], a[156:159]
v_exp_f32 v150, v150
v_mfma_f32_16x16x32_bf16 v[152:155], v[48:51], v[112:115], v[152:155]
v_mfma_f32_16x16x32_bf16 v[112:115], a[192:195], v[96:99], 0
v_cvt_pk_bf16_f32 v146, v148, v149
v_exp_f32 v80, v80
v_mfma_f32_16x16x32_bf16 v[116:119], a[208:211], v[96:99], 0
v_exp_f32 v81, v81
v_mfma_f32_16x16x32_bf16 v[112:115], a[196:199], v[100:103], v[112:115]
v_exp_f32 v151, v151
v_mfma_f32_16x16x32_bf16 v[116:119], a[212:215], v[100:103], v[116:119]
v_exp_f32 v82, v82
v_mfma_f32_16x16x32_bf16 v[112:115], a[200:203], v[104:107], v[112:115]
v_cvt_pk_bf16_f32 v147, v150, v151
v_mfma_f32_16x16x32_bf16 v[116:119], a[216:219], v[104:107], v[116:119]
v_cvt_pk_bf16_f32 v80, v80, v81
v_mfma_f32_16x16x32_bf16 v[112:115], a[204:207], v[108:111], v[112:115]
v_mfma_f32_16x16x32_bf16 v[116:119], a[220:223], v[108:111], v[116:119]
v_exp_f32 v83, v83
v_mfma_f32_16x16x32_bf16 a[160:163], a[224:227], v[144:147], a[160:163]
ds_read_b64_tr_b16 a[224:225], v28 offset:49152
ds_read_b64_tr_b16 a[226:227], v28 offset:53248
v_mfma_f32_16x16x32_bf16 a[164:167], a[228:231], v[144:147], a[164:167]
v_exp_f32 v84, v84
v_mfma_f32_16x16x32_bf16 a[168:171], a[232:235], v[144:147], a[168:171]
ds_read_b64_tr_b16 a[228:229], v29 offset:49152
ds_read_b64_tr_b16 a[230:231], v29 offset:53248
v_mfma_f32_16x16x32_bf16 a[172:175], a[236:239], v[144:147], a[172:175]
v_cvt_pk_bf16_f32 v81, v82, v83
v_mfma_f32_16x16x32_bf16 a[176:179], a[240:243], v[144:147], a[176:179]
ds_read_b64_tr_b16 a[232:233], v30 offset:49152
ds_read_b64_tr_b16 a[234:235], v30 offset:53248
v_mfma_f32_16x16x32_bf16 a[180:183], a[244:247], v[144:147], a[180:183]
v_exp_f32 v85, v85
v_mfma_f32_16x16x32_bf16 a[184:187], a[248:251], v[144:147], a[184:187]
ds_read_b64_tr_b16 a[236:237], v31 offset:49152
ds_read_b64_tr_b16 a[238:239], v31 offset:53248
v_mfma_f32_16x16x32_bf16 a[188:191], a[252:255], v[144:147], a[188:191]
v_exp_f32 v86, v86
v_mfma_f32_16x16x32_bf16 v[156:159], v[48:51], v[144:147], v[156:159]
ds_read_b64_tr_b16 a[240:241], v44 offset:49152
ds_read_b64_tr_b16 a[242:243], v44 offset:53248
v_mfma_f32_16x16x32_bf16 v[144:147], a[192:195], v[128:131], 0
v_cvt_pk_bf16_f32 v82, v84, v85
v_exp_f32 v112, v112
v_mfma_f32_16x16x32_bf16 v[148:151], a[208:211], v[128:131], 0
ds_read_b64_tr_b16 a[244:245], v45 offset:49152
ds_read_b64_tr_b16 a[246:247], v45 offset:53248
v_mfma_f32_16x16x32_bf16 v[144:147], a[196:199], v[132:135], v[144:147]
v_exp_f32 v87, v87
v_mfma_f32_16x16x32_bf16 v[148:151], a[212:215], v[132:135], v[148:151]
ds_read_b64_tr_b16 a[248:249], v46 offset:49152
ds_read_b64_tr_b16 a[250:251], v46 offset:53248
v_mfma_f32_16x16x32_bf16 v[144:147], a[200:203], v[136:139], v[144:147]
v_cvt_pk_bf16_f32 v83, v86, v87
v_exp_f32 v113, v113
v_mfma_f32_16x16x32_bf16 v[148:151], a[216:219], v[136:139], v[148:151]
ds_read_b64_tr_b16 a[252:253], v47 offset:49152
ds_read_b64_tr_b16 a[254:255], v47 offset:53248
v_mfma_f32_16x16x32_bf16 v[144:147], a[204:207], v[140:143], v[144:147]
v_exp_f32 v114, v114
v_cvt_pk_bf16_f32 v112, v112, v113
v_mfma_f32_16x16x32_bf16 v[148:151], a[220:223], v[140:143], v[148:151]
v_exp_f32 v115, v115
s_waitcnt lgkmcnt(4)
v_mfma_f32_16x16x32_bf16 a[0:3], a[224:227], v[80:83], a[0:3]
v_mfma_f32_16x16x32_bf16 a[4:7], a[228:231], v[80:83], a[4:7]
v_exp_f32 v116, v116
v_mfma_f32_16x16x32_bf16 a[8:11], a[232:235], v[80:83], a[8:11]
v_mfma_f32_16x16x32_bf16 a[12:15], a[236:239], v[80:83], a[12:15]
v_cvt_pk_bf16_f32 v113, v114, v115
v_mfma_f32_16x16x32_bf16 a[16:19], a[240:243], v[80:83], a[16:19]
v_mfma_f32_16x16x32_bf16 a[20:23], a[244:247], v[80:83], a[20:23]
v_exp_f32 v117, v117
s_waitcnt lgkmcnt(0)
v_mfma_f32_16x16x32_bf16 a[24:27], a[248:251], v[80:83], a[24:27]
v_mfma_f32_16x16x32_bf16 a[28:31], a[252:255], v[80:83], a[28:31]
v_exp_f32 v118, v118
v_mfma_f32_16x16x32_bf16 v[88:91], v[48:51], v[80:83], v[88:91]
v_mfma_f32_16x16x32_bf16 v[80:83], a[192:195], v[160:163], 0
v_cvt_pk_bf16_f32 v114, v116, v117
v_exp_f32 v144, v144
v_mfma_f32_16x16x32_bf16 v[84:87], a[208:211], v[160:163], 0
v_exp_f32 v145, v145
v_mfma_f32_16x16x32_bf16 v[80:83], a[196:199], v[164:167], v[80:83]
v_exp_f32 v119, v119
v_mfma_f32_16x16x32_bf16 v[84:87], a[212:215], v[164:167], v[84:87]
v_exp_f32 v146, v146
v_mfma_f32_16x16x32_bf16 v[80:83], a[200:203], v[168:171], v[80:83]
v_cvt_pk_bf16_f32 v115, v118, v119
v_mfma_f32_16x16x32_bf16 v[84:87], a[216:219], v[168:171], v[84:87]
v_cvt_pk_bf16_f32 v144, v144, v145
v_mfma_f32_16x16x32_bf16 v[80:83], a[204:207], v[172:175], v[80:83]
v_mfma_f32_16x16x32_bf16 v[84:87], a[220:223], v[172:175], v[84:87]
v_exp_f32 v147, v147
v_mfma_f32_16x16x32_bf16 a[32:35], a[224:227], v[112:115], a[32:35]
v_mfma_f32_16x16x32_bf16 a[36:39], a[228:231], v[112:115], a[36:39]
v_exp_f32 v148, v148
v_mfma_f32_16x16x32_bf16 a[40:43], a[232:235], v[112:115], a[40:43]
v_mfma_f32_16x16x32_bf16 a[44:47], a[236:239], v[112:115], a[44:47]
v_cvt_pk_bf16_f32 v145, v146, v147
v_mfma_f32_16x16x32_bf16 a[48:51], a[240:243], v[112:115], a[48:51]
v_mfma_f32_16x16x32_bf16 a[52:55], a[244:247], v[112:115], a[52:55]
v_exp_f32 v149, v149
v_mfma_f32_16x16x32_bf16 a[56:59], a[248:251], v[112:115], a[56:59]
v_mfma_f32_16x16x32_bf16 a[60:63], a[252:255], v[112:115], a[60:63]
v_exp_f32 v150, v150
v_mfma_f32_16x16x32_bf16 v[92:95], v[48:51], v[112:115], v[92:95]
v_mfma_f32_16x16x32_bf16 v[112:115], a[192:195], v[192:195], 0
v_cvt_pk_bf16_f32 v146, v148, v149
v_exp_f32 v80, v80
v_mfma_f32_16x16x32_bf16 v[116:119], a[208:211], v[192:195], 0
v_exp_f32 v81, v81
v_mfma_f32_16x16x32_bf16 v[112:115], a[196:199], v[196:199], v[112:115]
v_exp_f32 v151, v151
v_mfma_f32_16x16x32_bf16 v[116:119], a[212:215], v[196:199], v[116:119]
v_exp_f32 v82, v82
v_mfma_f32_16x16x32_bf16 v[112:115], a[200:203], v[200:203], v[112:115]
v_cvt_pk_bf16_f32 v147, v150, v151
v_mfma_f32_16x16x32_bf16 v[116:119], a[216:219], v[200:203], v[116:119]
v_cvt_pk_bf16_f32 v80, v80, v81
v_mfma_f32_16x16x32_bf16 v[112:115], a[204:207], v[204:207], v[112:115]
v_mfma_f32_16x16x32_bf16 v[116:119], a[220:223], v[204:207], v[116:119]
v_exp_f32 v83, v83
v_mfma_f32_16x16x32_bf16 a[64:67], a[224:227], v[144:147], a[64:67]
s_barrier
v_mfma_f32_16x16x32_bf16 a[68:71], a[228:231], v[144:147], a[68:71]
s_add_u32 s70, s70, 1024
v_exp_f32 v84, v84
v_mfma_f32_16x16x32_bf16 a[72:75], a[232:235], v[144:147], a[72:75]
s_and_b32 s70, s70, 16383
v_mfma_f32_16x16x32_bf16 a[76:79], a[236:239], v[144:147], a[76:79]
s_lshl_b32 s97, s70, 5
v_cvt_pk_bf16_f32 v81, v82, v83
v_mfma_f32_16x16x32_bf16 a[80:83], a[240:243], v[144:147], a[80:83]
s_add_u32 s97, s97, s96
v_mfma_f32_16x16x32_bf16 a[84:87], a[244:247], v[144:147], a[84:87]
s_add_u32 m0, s78, 0
v_exp_f32 v85, v85
v_mfma_f32_16x16x32_bf16 a[88:91], a[248:251], v[144:147], a[88:91]
buffer_load_dwordx4 v2, s[84:87], s97 offen lds
v_mfma_f32_16x16x32_bf16 a[92:95], a[252:255], v[144:147], a[92:95]
v_exp_f32 v86, v86
v_mfma_f32_16x16x32_bf16 v[120:123], v[48:51], v[144:147], v[120:123]
v_mfma_f32_16x16x32_bf16 v[144:147], a[192:195], v[224:227], 0
v_cvt_pk_bf16_f32 v82, v84, v85
v_exp_f32 v112, v112
v_mfma_f32_16x16x32_bf16 v[148:151], a[208:211], v[224:227], 0
buffer_load_dwordx4 v3, s[84:87], s97 offen offset:1056 lds
v_exp_f32 v113, v113
v_mfma_f32_16x16x32_bf16 v[144:147], a[196:199], v[228:231], v[144:147]
v_exp_f32 v87, v87
v_mfma_f32_16x16x32_bf16 v[148:151], a[212:215], v[228:231], v[148:151]
v_exp_f32 v114, v114
v_mfma_f32_16x16x32_bf16 v[144:147], a[200:203], v[232:235], v[144:147]
v_cvt_pk_bf16_f32 v83, v86, v87
v_cvt_pk_bf16_f32 v112, v112, v113
v_mfma_f32_16x16x32_bf16 v[148:151], a[216:219], v[232:235], v[148:151]
buffer_load_dwordx4 v4, s[84:87], s97 offen offset:2112 lds
v_exp_f32 v115, v115
v_mfma_f32_16x16x32_bf16 v[144:147], a[204:207], v[236:239], v[144:147]
v_mfma_f32_16x16x32_bf16 v[148:151], a[220:223], v[236:239], v[148:151]
v_exp_f32 v116, v116
v_mfma_f32_16x16x32_bf16 a[96:99], a[224:227], v[80:83], a[96:99]
v_cvt_pk_bf16_f32 v113, v114, v115
v_mfma_f32_16x16x32_bf16 a[100:103], a[228:231], v[80:83], a[100:103]
buffer_load_dwordx4 v5, s[84:87], s97 offen offset:3168 lds
v_exp_f32 v117, v117
v_mfma_f32_16x16x32_bf16 a[104:107], a[232:235], v[80:83], a[104:107]
s_add_u32 s98, s97, 16384
v_mfma_f32_16x16x32_bf16 a[108:111], a[236:239], v[80:83], a[108:111]
s_add_u32 m0, s78, 4224
v_exp_f32 v118, v118
v_mfma_f32_16x16x32_bf16 a[112:115], a[240:243], v[80:83], a[112:115]
v_cvt_pk_bf16_f32 v114, v116, v117
v_exp_f32 v144, v144
v_mfma_f32_16x16x32_bf16 a[116:119], a[244:247], v[80:83], a[116:119]
buffer_load_dwordx4 v2, s[84:87], s98 offen lds
v_exp_f32 v145, v145
v_mfma_f32_16x16x32_bf16 a[120:123], a[248:251], v[80:83], a[120:123]
v_exp_f32 v119, v119
v_mfma_f32_16x16x32_bf16 a[124:127], a[252:255], v[80:83], a[124:127]
v_cvt_pk_bf16_f32 v115, v118, v119
v_exp_f32 v146, v146
v_mfma_f32_16x16x32_bf16 v[124:127], v[48:51], v[80:83], v[124:127]
v_cvt_pk_bf16_f32 v144, v144, v145
v_exp_f32 v147, v147
v_mfma_f32_16x16x32_bf16 a[128:131], a[224:227], v[112:115], a[128:131]
buffer_load_dwordx4 v3, s[84:87], s98 offen offset:1056 lds
v_exp_f32 v148, v148
v_mfma_f32_16x16x32_bf16 a[132:135], a[228:231], v[112:115], a[132:135]
v_mfma_f32_16x16x32_bf16 a[136:139], a[232:235], v[112:115], a[136:139]
v_cvt_pk_bf16_f32 v145, v146, v147
v_mfma_f32_16x16x32_bf16 a[140:143], a[236:239], v[112:115], a[140:143]
v_exp_f32 v149, v149
v_mfma_f32_16x16x32_bf16 a[144:147], a[240:243], v[112:115], a[144:147]
buffer_load_dwordx4 v4, s[84:87], s98 offen offset:2112 lds
v_exp_f32 v150, v150
v_mfma_f32_16x16x32_bf16 a[148:151], a[244:247], v[112:115], a[148:151]
v_cvt_pk_bf16_f32 v146, v148, v149
v_mfma_f32_16x16x32_bf16 a[152:155], a[248:251], v[112:115], a[152:155]
v_exp_f32 v151, v151
v_mfma_f32_16x16x32_bf16 a[156:159], a[252:255], v[112:115], a[156:159]
v_cvt_pk_bf16_f32 v147, v150, v151
v_mfma_f32_16x16x32_bf16 v[152:155], v[48:51], v[112:115], v[152:155]
buffer_load_dwordx4 v5, s[84:87], s98 offen offset:3168 lds
v_mfma_f32_16x16x32_bf16 a[160:163], a[224:227], v[144:147], a[160:163]
v_mfma_f32_16x16x32_bf16 a[164:167], a[228:231], v[144:147], a[164:167]
v_mfma_f32_16x16x32_bf16 a[168:171], a[232:235], v[144:147], a[168:171]
v_rcp_f32 v32, v88
v_mfma_f32_16x16x32_bf16 a[172:175], a[236:239], v[144:147], a[172:175]
v_rcp_f32 v33, v92
v_mfma_f32_16x16x32_bf16 a[176:179], a[240:243], v[144:147], a[176:179]
v_rcp_f32 v34, v120
v_mfma_f32_16x16x32_bf16 a[180:183], a[244:247], v[144:147], a[180:183]
v_rcp_f32 v35, v124
v_mfma_f32_16x16x32_bf16 a[184:187], a[248:251], v[144:147], a[184:187]
v_rcp_f32 v36, v152
v_mfma_f32_16x16x32_bf16 a[188:191], a[252:255], v[144:147], a[188:191]
v_mfma_f32_16x16x32_bf16 v[156:159], v[48:51], v[144:147], v[156:159]
s_nop 7
v_rcp_f32 v37, v156
v_min3_f32 v240, v88, v92, v120
v_max3_f32 v241, v88, v92, v120
v_add_f32 v242, v88, v92
v_min3_f32 v240, v240, v124, v152
v_max3_f32 v241, v241, v124, v152
v_add_f32 v242, v242, v120
v_min_f32 v240, v240, v156
v_max_f32 v241, v241, v156
v_add_f32 v242, v242, v124
v_add_f32 v242, v242, v152
s_mov_b32 s58, 0x33800000
v_add_f32 v242, v242, v156
s_mov_b32 s59, 0x4e800000
v_cmp_ge_f32 s[60:61], v240, s58
v_cmp_le_f32 s[62:63], v241, s59
v_cmp_o_f32 vcc, v242, v242
s_and_b64 s[60:61], s[60:61], s[62:63]
s_and_b64 s[60:61], s[60:61], vcc
s_cmp_eq_u64 s[60:61], -1
s_cbranch_scc0 L_concat_heads__mha_block_cached__gqa_block_cached__near_ridge_kernel_slow1
L_concat_heads__mha_block_cached__gqa_block_cached__near_ridge_kernel_back1:
v_mov_b32 v48, 1
v_lshlrev_b32 v50, 16, v1
v_accvgpr_read_b32 v44, a0
v_accvgpr_read_b32 v45, a1
v_accvgpr_read_b32 v46, a2
v_accvgpr_read_b32 v47, a3
v_accvgpr_read_b32 v41, a4
v_accvgpr_read_b32 v19, a5
v_accvgpr_read_b32 v10, a6
v_accvgpr_read_b32 v6, a7
v_mul_f32 v44, v44, v32
v_mul_f32 v45, v45, v32
v_mul_f32 v46, v46, v32
v_mul_f32 v47, v47, v32
v_mul_f32 v41, v41, v32
s_add_u32 s99, s70, s79
buffer_load_dwordx4 v[112:115], v11, s[80:83], s99 offen sc1
v_mul_f32 v19, v19, v32
v_mul_f32 v10, v10, v32
v_mul_f32 v6, v6, v32
v_cvt_pk_bf16_f32 v184, v44, v45
v_cvt_pk_bf16_f32 v185, v46, v47
v_cvt_pk_bf16_f32 v186, v41, v19
v_cvt_pk_bf16_f32 v187, v10, v6
v_accvgpr_read_b32 v160, a8
v_accvgpr_read_b32 v161, a9
v_accvgpr_read_b32 v162, a10
v_accvgpr_read_b32 v163, a11
v_accvgpr_read_b32 v164, a12
v_accvgpr_read_b32 v165, a13
v_accvgpr_read_b32 v166, a14
v_accvgpr_read_b32 v167, a15
buffer_load_dwordx4 v[116:119], v12, s[80:83], s99 offen sc1
v_mul_f32 v160, v160, v32
v_mul_f32 v161, v161, v32
v_mul_f32 v162, v162, v32
v_mul_f32 v163, v163, v32
v_mul_f32 v164, v164, v32
v_mul_f32 v165, v165, v32
v_mul_f32 v166, v166, v32
v_mul_f32 v167, v167, v32
v_cvt_pk_bf16_f32 v188, v160, v161
v_cvt_pk_bf16_f32 v189, v162, v163
v_cvt_pk_bf16_f32 v190, v164, v165
v_cvt_pk_bf16_f32 v191, v166, v167
v_accvgpr_read_b32 v44, a16
v_accvgpr_read_b32 v45, a17
v_accvgpr_read_b32 v46, a18
buffer_load_dwordx4 v[120:123], v13, s[80:83], s99 offen sc1
v_accvgpr_read_b32 v47, a19
v_accvgpr_read_b32 v41, a20
v_accvgpr_read_b32 v19, a21
v_accvgpr_read_b32 v10, a22
v_accvgpr_read_b32 v6, a23
v_mul_f32 v44, v44, v32
v_mul_f32 v45, v45, v32
v_mul_f32 v46, v46, v32
v_mul_f32 v47, v47, v32
v_mul_f32 v41, v41, v32
v_mul_f32 v19, v19, v32
v_mul_f32 v10, v10, v32
v_mul_f32 v6, v6, v32
v_cvt_pk_bf16_f32 v192, v44, v45
v_cvt_pk_bf16_f32 v193, v46, v47
buffer_load_dwordx4 v[124:127], v14, s[80:83], s99 offen sc1
v_cvt_pk_bf16_f32 v194, v41, v19
v_cvt_pk_bf16_f32 v195, v10, v6
v_accvgpr_read_b32 v160, a24
v_accvgpr_read_b32 v161, a25
v_accvgpr_read_b32 v162, a26
v_accvgpr_read_b32 v163, a27
v_accvgpr_read_b32 v164, a28
v_accvgpr_read_b32 v165, a29
v_accvgpr_read_b32 v166, a30
v_accvgpr_read_b32 v167, a31
v_mul_f32 v160, v160, v32
v_mul_f32 v161, v161, v32
v_mul_f32 v162, v162, v32
v_mul_f32 v163, v163, v32
v_mul_f32 v164, v164, v32
buffer_load_dwordx4 v[128:131], v15, s[80:83], s99 offen sc1
v_mul_f32 v165, v165, v32
v_mul_f32 v166, v166, v32
v_mul_f32 v167, v167, v32
v_cvt_pk_bf16_f32 v196, v160, v161
v_cvt_pk_bf16_f32 v197, v162, v163
v_cvt_pk_bf16_f32 v198, v164, v165
v_cvt_pk_bf16_f32 v199, v166, v167
v_accvgpr_read_b32 v44, a32
v_accvgpr_read_b32 v45, a33
v_accvgpr_read_b32 v46, a34
v_accvgpr_read_b32 v47, a35
v_accvgpr_read_b32 v41, a36
v_accvgpr_read_b32 v19, a37
v_accvgpr_read_b32 v10, a38
v_accvgpr_read_b32 v6, a39
buffer_load_dwordx4 v[132:135], v16, s[80:83], s99 offen sc1
v_mul_f32 v44, v44, v33
v_mul_f32 v45, v45, v33
v_mul_f32 v46, v46, v33
v_mul_f32 v47, v47, v33
v_mul_f32 v41, v41, v33
v_mul_f32 v19, v19, v33
v_mul_f32 v10, v10, v33
v_mul_f32 v6, v6, v33
v_cvt_pk_bf16_f32 v200, v44, v45
v_cvt_pk_bf16_f32 v201, v46, v47
v_cvt_pk_bf16_f32 v202, v41, v19
v_cvt_pk_bf16_f32 v203, v10, v6
v_accvgpr_read_b32 v160, a40
v_accvgpr_read_b32 v161, a41
v_accvgpr_read_b32 v162, a42
s_add_u32 s70, s70, 1024
s_and_b32 s70, s70, 16383
s_lshl_b32 s97, s70, 5
s_add_u32 s97, s97, s96
s_add_u32 m0, s78, 8448
s_nop 0
buffer_load_dwordx4 v2, s[84:87], s97 offen lds
v_accvgpr_read_b32 v163, a43
v_accvgpr_read_b32 v164, a44
v_accvgpr_read_b32 v165, a45
v_accvgpr_read_b32 v166, a46
v_accvgpr_read_b32 v167, a47
v_mul_f32 v160, v160, v33
v_mul_f32 v161, v161, v33
v_mul_f32 v162, v162, v33
v_mul_f32 v163, v163, v33
v_mul_f32 v164, v164, v33
v_mul_f32 v165, v165, v33
v_mul_f32 v166, v166, v33
v_mul_f32 v167, v167, v33
v_cvt_pk_bf16_f32 v204, v160, v161
v_cvt_pk_bf16_f32 v205, v162, v163
buffer_load_dwordx4 v3, s[84:87], s97 offen offset:1056 lds
v_cvt_pk_bf16_f32 v206, v164, v165
v_cvt_pk_bf16_f32 v207, v166, v167
v_accvgpr_read_b32 v44, a48
v_accvgpr_read_b32 v45, a49
v_accvgpr_read_b32 v46, a50
v_accvgpr_read_b32 v47, a51
v_accvgpr_read_b32 v41, a52
v_accvgpr_read_b32 v19, a53
v_accvgpr_read_b32 v10, a54
v_accvgpr_read_b32 v6, a55
v_mul_f32 v44, v44, v33
v_mul_f32 v45, v45, v33
v_mul_f32 v46, v46, v33
v_mul_f32 v47, v47, v33
v_mul_f32 v41, v41, v33
buffer_load_dwordx4 v4, s[84:87], s97 offen offset:2112 lds
v_mul_f32 v19, v19, v33
v_mul_f32 v10, v10, v33
v_mul_f32 v6, v6, v33
v_cvt_pk_bf16_f32 v208, v44, v45
v_cvt_pk_bf16_f32 v209, v46, v47
v_cvt_pk_bf16_f32 v210, v41, v19
v_cvt_pk_bf16_f32 v211, v10, v6
v_accvgpr_read_b32 v160, a56
v_accvgpr_read_b32 v161, a57
v_accvgpr_read_b32 v162, a58
v_accvgpr_read_b32 v163, a59
v_accvgpr_read_b32 v164, a60
v_accvgpr_read_b32 v165, a61
v_accvgpr_read_b32 v166, a62
v_accvgpr_read_b32 v167, a63
buffer_load_dwordx4 v5, s[84:87], s97 offen offset:3168 lds
v_mul_f32 v160, v160, v33
v_mul_f32 v161, v161, v33
v_mul_f32 v162, v162, v33
v_mul_f32 v163, v163, v33
v_mul_f32 v164, v164, v33
v_mul_f32 v165, v165, v33
v_mul_f32 v166, v166, v33
v_mul_f32 v167, v167, v33
v_cvt_pk_bf16_f32 v212, v160, v161
v_cvt_pk_bf16_f32 v213, v162, v163
v_cvt_pk_bf16_f32 v214, v164, v165
v_cvt_pk_bf16_f32 v215, v166, v167
v_accvgpr_read_b32 v44, a64
v_accvgpr_read_b32 v45, a65
v_accvgpr_read_b32 v46, a66
s_add_u32 s98, s97, 16384
s_add_u32 m0, s78, 12672
s_nop 0
buffer_load_dwordx4 v2, s[84:87], s98 offen lds
v_accvgpr_read_b32 v47, a67
v_accvgpr_read_b32 v41, a68
v_accvgpr_read_b32 v19, a69
v_accvgpr_read_b32 v10, a70
v_accvgpr_read_b32 v6, a71
v_mul_f32 v44, v44, v34
v_mul_f32 v45, v45, v34
v_mul_f32 v46, v46, v34
v_mul_f32 v47, v47, v34
v_mul_f32 v41, v41, v34
v_mul_f32 v19, v19, v34
v_mul_f32 v10, v10, v34
v_mul_f32 v6, v6, v34
v_cvt_pk_bf16_f32 v216, v44, v45
v_cvt_pk_bf16_f32 v217, v46, v47
buffer_load_dwordx4 v3, s[84:87], s98 offen offset:1056 lds
v_cvt_pk_bf16_f32 v218, v41, v19
v_cvt_pk_bf16_f32 v219, v10, v6
v_accvgpr_read_b32 v160, a72
v_accvgpr_read_b32 v161, a73
v_accvgpr_read_b32 v162, a74
v_accvgpr_read_b32 v163, a75
v_accvgpr_read_b32 v164, a76
v_accvgpr_read_b32 v165, a77
v_accvgpr_read_b32 v166, a78
v_accvgpr_read_b32 v167, a79
v_mul_f32 v160, v160, v34
v_mul_f32 v161, v161, v34
v_mul_f32 v162, v162, v34
v_mul_f32 v163, v163, v34
v_mul_f32 v164, v164, v34
buffer_load_dwordx4 v4, s[84:87], s98 offen offset:2112 lds
v_mul_f32 v165, v165, v34
v_mul_f32 v166, v166, v34
v_mul_f32 v167, v167, v34
v_cvt_pk_bf16_f32 v220, v160, v161
v_cvt_pk_bf16_f32 v221, v162, v163
v_cvt_pk_bf16_f32 v222, v164, v165
v_cvt_pk_bf16_f32 v223, v166, v167
v_accvgpr_read_b32 v44, a80
v_accvgpr_read_b32 v45, a81
v_accvgpr_read_b32 v46, a82
v_accvgpr_read_b32 v47, a83
v_accvgpr_read_b32 v41, a84
v_accvgpr_read_b32 v19, a85
v_accvgpr_read_b32 v10, a86
v_accvgpr_read_b32 v6, a87
buffer_load_dwordx4 v5, s[84:87], s98 offen offset:3168 lds
v_mul_f32 v44, v44, v34
v_mul_f32 v45, v45, v34
v_mul_f32 v46, v46, v34
v_mul_f32 v47, v47, v34
v_mul_f32 v41, v41, v34
v_mul_f32 v19, v19, v34
v_mul_f32 v10, v10, v34
v_mul_f32 v6, v6, v34
v_cvt_pk_bf16_f32 v224, v44, v45
v_cvt_pk_bf16_f32 v225, v46, v47
v_cvt_pk_bf16_f32 v226, v41, v19
v_cvt_pk_bf16_f32 v227, v10, v6
v_accvgpr_read_b32 v160, a88
v_accvgpr_read_b32 v161, a89
v_accvgpr_read_b32 v162, a90
s_add_u32 s99, s70, s79
buffer_load_dwordx4 v[136:139], v11, s[80:83], s99 offen sc1
v_accvgpr_read_b32 v163, a91
v_accvgpr_read_b32 v164, a92
v_accvgpr_read_b32 v165, a93
v_accvgpr_read_b32 v166, a94
v_accvgpr_read_b32 v167, a95
v_mul_f32 v160, v160, v34
v_mul_f32 v161, v161, v34
v_mul_f32 v162, v162, v34
v_mul_f32 v163, v163, v34
v_mul_f32 v164, v164, v34
v_mul_f32 v165, v165, v34
v_mul_f32 v166, v166, v34
v_mul_f32 v167, v167, v34
v_cvt_pk_bf16_f32 v228, v160, v161
v_cvt_pk_bf16_f32 v229, v162, v163
buffer_load_dwordx4 v[140:143], v12, s[80:83], s99 offen sc1
v_cvt_pk_bf16_f32 v230, v164, v165
v_cvt_pk_bf16_f32 v231, v166, v167
v_accvgpr_read_b32 v44, a96
v_accvgpr_read_b32 v45, a97
v_accvgpr_read_b32 v46, a98
v_accvgpr_read_b32 v47, a99
v_accvgpr_read_b32 v41, a100
v_accvgpr_read_b32 v19, a101
v_accvgpr_read_b32 v10, a102
v_accvgpr_read_b32 v6, a103
v_mul_f32 v44, v44, v35
v_mul_f32 v45, v45, v35
v_mul_f32 v46, v46, v35
v_mul_f32 v47, v47, v35
v_mul_f32 v41, v41, v35
buffer_load_dwordx4 v[144:147], v13, s[80:83], s99 offen sc1
v_mul_f32 v19, v19, v35
v_mul_f32 v10, v10, v35
v_mul_f32 v6, v6, v35
v_cvt_pk_bf16_f32 v232, v44, v45
v_cvt_pk_bf16_f32 v233, v46, v47
v_cvt_pk_bf16_f32 v234, v41, v19
v_cvt_pk_bf16_f32 v235, v10, v6
v_accvgpr_read_b32 v160, a104
v_accvgpr_read_b32 v161, a105
v_accvgpr_read_b32 v162, a106
v_accvgpr_read_b32 v163, a107
v_accvgpr_read_b32 v164, a108
v_accvgpr_read_b32 v165, a109
v_accvgpr_read_b32 v166, a110
v_accvgpr_read_b32 v167, a111
buffer_load_dwordx4 v[148:151], v14, s[80:83], s99 offen sc1
v_mul_f32 v160, v160, v35
v_mul_f32 v161, v161, v35
v_mul_f32 v162, v162, v35
v_mul_f32 v163, v163, v35
v_mul_f32 v164, v164, v35
v_mul_f32 v165, v165, v35
v_mul_f32 v166, v166, v35
v_mul_f32 v167, v167, v35
v_cvt_pk_bf16_f32 v236, v160, v161
v_cvt_pk_bf16_f32 v237, v162, v163
v_cvt_pk_bf16_f32 v238, v164, v165
v_cvt_pk_bf16_f32 v239, v166, v167
v_accvgpr_read_b32 v44, a112
v_accvgpr_read_b32 v45, a113
v_accvgpr_read_b32 v46, a114
buffer_load_dwordx4 v[152:155], v15, s[80:83], s99 offen sc1
v_accvgpr_read_b32 v47, a115
v_accvgpr_read_b32 v41, a116
v_accvgpr_read_b32 v19, a117
v_accvgpr_read_b32 v10, a118
v_accvgpr_read_b32 v6, a119
v_mul_f32 v44, v44, v35
v_mul_f32 v45, v45, v35
v_mul_f32 v46, v46, v35
v_mul_f32 v47, v47, v35
v_mul_f32 v41, v41, v35
v_mul_f32 v19, v19, v35
v_mul_f32 v10, v10, v35
v_mul_f32 v6, v6, v35
v_cvt_pk_bf16_f32 v240, v44, v45
v_cvt_pk_bf16_f32 v241, v46, v47
buffer_load_dwordx4 v[156:159], v16, s[80:83], s99 offen sc1
v_cvt_pk_bf16_f32 v242, v41, v19
v_cvt_pk_bf16_f32 v243, v10, v6
v_accvgpr_read_b32 v160, a120
v_accvgpr_read_b32 v161, a121
v_accvgpr_read_b32 v162, a122
v_accvgpr_read_b32 v163, a123
v_accvgpr_read_b32 v164, a124
v_accvgpr_read_b32 v165, a125
v_accvgpr_read_b32 v166, a126
v_accvgpr_read_b32 v167, a127
v_mul_f32 v160, v160, v35
v_mul_f32 v161, v161, v35
v_mul_f32 v162, v162, v35
v_mul_f32 v163, v163, v35
v_mul_f32 v164, v164, v35
s_add_u32 s70, s70, 1024
s_and_b32 s70, s70, 16383
s_lshl_b32 s97, s70, 5
s_add_u32 s97, s97, s96
s_add_u32 m0, s78, 16896
s_nop 0
buffer_load_dwordx4 v2, s[84:87], s97 offen lds
v_mul_f32 v165, v165, v35
v_mul_f32 v166, v166, v35
v_mul_f32 v167, v167, v35
v_cvt_pk_bf16_f32 v244, v160, v161
v_cvt_pk_bf16_f32 v245, v162, v163
v_cvt_pk_bf16_f32 v246, v164, v165
v_cvt_pk_bf16_f32 v247, v166, v167
v_accvgpr_read_b32 v44, a128
v_accvgpr_read_b32 v45, a129
v_accvgpr_read_b32 v46, a130
v_accvgpr_read_b32 v47, a131
v_accvgpr_read_b32 v41, a132
v_accvgpr_read_b32 v19, a133
v_accvgpr_read_b32 v10, a134
v_accvgpr_read_b32 v6, a135
buffer_load_dwordx4 v3, s[84:87], s97 offen offset:1056 lds
v_mul_f32 v44, v44, v36
v_mul_f32 v45, v45, v36
v_mul_f32 v46, v46, v36
v_mul_f32 v47, v47, v36
v_mul_f32 v41, v41, v36
v_mul_f32 v19, v19, v36
v_mul_f32 v10, v10, v36
v_mul_f32 v6, v6, v36
v_cvt_pk_bf16_f32 v248, v44, v45
v_cvt_pk_bf16_f32 v249, v46, v47
v_cvt_pk_bf16_f32 v250, v41, v19
v_cvt_pk_bf16_f32 v251, v10, v6
v_accvgpr_read_b32 v160, a136
v_accvgpr_read_b32 v161, a137
v_accvgpr_read_b32 v162, a138
buffer_load_dwordx4 v4, s[84:87], s97 offen offset:2112 lds
v_accvgpr_read_b32 v163, a139
v_accvgpr_read_b32 v164, a140
v_accvgpr_read_b32 v165, a141
v_accvgpr_read_b32 v166, a142
v_accvgpr_read_b32 v167, a143
v_mul_f32 v160, v160, v36
v_mul_f32 v161, v161, v36
v_mul_f32 v162, v162, v36
v_mul_f32 v163, v163, v36
v_mul_f32 v164, v164, v36
v_mul_f32 v165, v165, v36
v_mul_f32 v166, v166, v36
v_mul_f32 v167, v167, v36
v_cvt_pk_bf16_f32 v252, v160, v161
v_cvt_pk_bf16_f32 v253, v162, v163
buffer_load_dwordx4 v5, s[84:87], s97 offen offset:3168 lds
v_cvt_pk_bf16_f32 v254, v164, v165
v_cvt_pk_bf16_f32 v255, v166, v167
v_accvgpr_read_b32 v44, a144
v_accvgpr_read_b32 v45, a145
v_accvgpr_read_b32 v46, a146
v_accvgpr_read_b32 v47, a147
v_accvgpr_read_b32 v41, a148
v_accvgpr_read_b32 v19, a149
v_accvgpr_read_b32 v10, a150
v_accvgpr_read_b32 v6, a151
v_mul_f32 v44, v44, v36
v_mul_f32 v45, v45, v36
v_mul_f32 v46, v46, v36
v_mul_f32 v47, v47, v36
v_mul_f32 v41, v41, v36
s_add_u32 s98, s97, 16384
s_add_u32 m0, s78, 21120
s_nop 0
buffer_load_dwordx4 v2, s[84:87], s98 offen lds
v_mul_f32 v19, v19, v36
v_mul_f32 v10, v10, v36
v_mul_f32 v6, v6, v36
v_cvt_pk_bf16_f32 v52, v44, v45
v_cvt_pk_bf16_f32 v53, v46, v47
v_cvt_pk_bf16_f32 v54, v41, v19
v_cvt_pk_bf16_f32 v55, v10, v6
v_accvgpr_read_b32 v160, a152
v_accvgpr_read_b32 v161, a153
v_accvgpr_read_b32 v162, a154
v_accvgpr_read_b32 v163, a155
v_accvgpr_read_b32 v164, a156
v_accvgpr_read_b32 v165, a157
v_accvgpr_read_b32 v166, a158
v_accvgpr_read_b32 v167, a159
buffer_load_dwordx4 v3, s[84:87], s98 offen offset:1056 lds
v_mul_f32 v160, v160, v36
v_mul_f32 v161, v161, v36
v_mul_f32 v162, v162, v36
v_mul_f32 v163, v163, v36
v_mul_f32 v164, v164, v36
v_mul_f32 v165, v165, v36
v_mul_f32 v166, v166, v36
v_mul_f32 v167, v167, v36
v_cvt_pk_bf16_f32 v56, v160, v161
v_cvt_pk_bf16_f32 v57, v162, v163
v_cvt_pk_bf16_f32 v58, v164, v165
v_cvt_pk_bf16_f32 v59, v166, v167
v_accvgpr_read_b32 v44, a160
v_accvgpr_read_b32 v45, a161
v_accvgpr_read_b32 v46, a162
buffer_load_dwordx4 v4, s[84:87], s98 offen offset:2112 lds
v_accvgpr_read_b32 v47, a163
v_accvgpr_read_b32 v41, a164
v_accvgpr_read_b32 v19, a165
v_accvgpr_read_b32 v10, a166
v_accvgpr_read_b32 v6, a167
v_mul_f32 v44, v44, v37
v_mul_f32 v45, v45, v37
v_mul_f32 v46, v46, v37
v_mul_f32 v47, v47, v37
v_mul_f32 v41, v41, v37
v_mul_f32 v19, v19, v37
v_mul_f32 v10, v10, v37
v_mul_f32 v6, v6, v37
v_cvt_pk_bf16_f32 v60, v44, v45
v_cvt_pk_bf16_f32 v61, v46, v47
buffer_load_dwordx4 v5, s[84:87], s98 offen offset:3168 lds
v_cvt_pk_bf16_f32 v62, v41, v19
v_cvt_pk_bf16_f32 v63, v10, v6
v_accvgpr_read_b32 v160, a168
v_accvgpr_read_b32 v161, a169
v_accvgpr_read_b32 v162, a170
v_accvgpr_read_b32 v163, a171
v_accvgpr_read_b32 v164, a172
v_accvgpr_read_b32 v165, a173
v_accvgpr_read_b32 v166, a174
v_accvgpr_read_b32 v167, a175
v_mul_f32 v160, v160, v37
v_mul_f32 v161, v161, v37
v_mul_f32 v162, v162, v37
v_mul_f32 v163, v163, v37
v_mul_f32 v164, v164, v37
v_mul_f32 v165, v165, v37
v_mul_f32 v166, v166, v37
v_mul_f32 v167, v167, v37
v_cvt_pk_bf16_f32 v20, v160, v161
v_cvt_pk_bf16_f32 v21, v162, v163
v_cvt_pk_bf16_f32 v22, v164, v165
v_cvt_pk_bf16_f32 v23, v166, v167
v_accvgpr_read_b32 v44, a176
v_accvgpr_read_b32 v45, a177
v_accvgpr_read_b32 v46, a178
v_accvgpr_read_b32 v47, a179
v_accvgpr_read_b32 v41, a180
v_accvgpr_read_b32 v19, a181
v_accvgpr_read_b32 v10, a182
v_accvgpr_read_b32 v6, a183
v_mul_f32 v44, v44, v37
v_mul_f32 v45, v45, v37
v_mul_f32 v46, v46, v37
v_mul_f32 v47, v47, v37
v_mul_f32 v41, v41, v37
v_mul_f32 v19, v19, v37
v_mul_f32 v10, v10, v37
v_mul_f32 v6, v6, v37
v_cvt_pk_bf16_f32 v24, v44, v45
v_cvt_pk_bf16_f32 v25, v46, v47
v_cvt_pk_bf16_f32 v26, v41, v19
v_cvt_pk_bf16_f32 v27, v10, v6
v_accvgpr_read_b32 v160, a184
v_accvgpr_read_b32 v161, a185
v_accvgpr_read_b32 v162, a186
v_accvgpr_read_b32 v163, a187
v_accvgpr_read_b32 v164, a188
v_accvgpr_read_b32 v165, a189
v_accvgpr_read_b32 v166, a190
v_accvgpr_read_b32 v167, a191
v_mul_f32 v160, v160, v37
v_mul_f32 v161, v161, v37
v_mul_f32 v162, v162, v37
v_mul_f32 v163, v163, v37
v_mul_f32 v164, v164, v37
v_mul_f32 v165, v165, v37
v_mul_f32 v166, v166, v37
v_mul_f32 v167, v167, v37
v_cvt_pk_bf16_f32 v28, v160, v161
v_cvt_pk_bf16_f32 v29, v162, v163
v_cvt_pk_bf16_f32 v30, v164, v165
v_cvt_pk_bf16_f32 v31, v166, v167
s_waitcnt vmcnt(28)
ds_read_b64_tr_b16 a[192:193], v17
ds_read_b64_tr_b16 a[194:195], v17 offset:4224
ds_read_b64_tr_b16 a[196:197], v17 offset:32
ds_read_b64_tr_b16 a[198:199], v17 offset:4256
ds_read_b64_tr_b16 a[200:201], v18
ds_read_b64_tr_b16 a[202:203], v18 offset:4224
ds_read_b64_tr_b16 a[204:205], v18 offset:32
ds_read_b64_tr_b16 a[206:207], v18 offset:4256
ds_read_b64_tr_b16 a[208:209], v39
ds_read_b64_tr_b16 a[210:211], v39 offset:4224
ds_read_b64_tr_b16 a[212:213], v39 offset:32
ds_read_b64_tr_b16 a[214:215], v39 offset:4256
ds_read_b64_tr_b16 a[216:217], v40
ds_read_b64_tr_b16 a[218:219], v40 offset:4224
ds_read_b64_tr_b16 a[220:221], v40 offset:32
ds_read_b64_tr_b16 a[222:223], v40 offset:4256
s_waitcnt vmcnt(27) lgkmcnt(14)
v_mfma_f32_16x16x32_bf16 v[64:67], a[192:195], v[112:115], 0
s_waitcnt vmcnt(26)
v_mfma_f32_16x16x32_bf16 v[68:71], a[192:195], v[116:119], 0
s_add_u32 s99, s70, s79
s_waitcnt vmcnt(25)
v_mfma_f32_16x16x32_bf16 v[72:75], a[192:195], v[120:123], 0
buffer_load_dwordx4 v[160:163], v11, s[80:83], s99 offen sc1
s_mov_b32 s71, 0
s_waitcnt vmcnt(25)
v_mfma_f32_16x16x32_bf16 v[76:79], a[192:195], v[124:127], 0
buffer_store_dwordx4 v[184:187], v38, s[48:51], s71 offen sc1
s_waitcnt vmcnt(25)
v_mfma_f32_16x16x32_bf16 v[80:83], a[192:195], v[128:131], 0
s_waitcnt vmcnt(24)
v_mfma_f32_16x16x32_bf16 v[84:87], a[192:195], v[132:135], 0
buffer_load_dwordx4 v[164:167], v12, s[80:83], s99 offen sc1
s_waitcnt vmcnt(17)
ds_read_b64_tr_b16 a[192:193], v17 offset:8448
s_waitcnt lgkmcnt(1)
v_mfma_f32_16x16x32_bf16 v[88:91], a[196:199], v[112:115], 0
ds_read_b64_tr_b16 a[194:195], v17 offset:12672
v_mfma_f32_16x16x32_bf16 v[92:95], a[196:199], v[116:119], 0
v_mfma_f32_16x16x32_bf16 v[96:99], a[196:199], v[120:123], 0
buffer_load_dwordx4 v[168:171], v13, s[80:83], s99 offen sc1
v_mfma_f32_16x16x32_bf16 v[100:103], a[196:199], v[124:127], 0
s_mov_b32 s71, 0
v_mfma_f32_16x16x32_bf16 v[104:107], a[196:199], v[128:131], 0
buffer_store_dwordx4 v[188:191], v38, s[48:51], s71 offen offset:1024 sc1
v_mfma_f32_16x16x32_bf16 v[108:111], a[196:199], v[132:135], 0
buffer_load_dwordx4 v[172:175], v14, s[80:83], s99 offen sc1
ds_read_b64_tr_b16 a[196:197], v17 offset:8480
v_mfma_f32_16x16x32_bf16 a[0:3], a[200:203], v[112:115], 0
ds_read_b64_tr_b16 a[198:199], v17 offset:12704
v_mfma_f32_16x16x32_bf16 a[4:7], a[200:203], v[116:119], 0
v_mfma_f32_16x16x32_bf16 a[8:11], a[200:203], v[120:123], 0
buffer_load_dwordx4 v[176:179], v15, s[80:83], s99 offen sc1
v_mfma_f32_16x16x32_bf16 a[12:15], a[200:203], v[124:127], 0
v_mfma_f32_16x16x32_bf16 a[16:19], a[200:203], v[128:131], 0
v_mfma_f32_16x16x32_bf16 a[20:23], a[200:203], v[132:135], 0
buffer_load_dwordx4 v[180:183], v16, s[80:83], s99 offen sc1
s_mov_b32 s71, 0
ds_read_b64_tr_b16 a[200:201], v18 offset:8448
v_mfma_f32_16x16x32_bf16 a[24:27], a[204:207], v[112:115], 0
buffer_store_dwordx4 v[192:195], v38, s[48:51], s71 offen offset:2048 sc1
s_add_u32 s70, s70, 1024
ds_read_b64_tr_b16 a[202:203], v18 offset:12672
v_mfma_f32_16x16x32_bf16 a[28:31], a[204:207], v[116:119], 0
s_and_b32 s70, s70, 16383
v_mfma_f32_16x16x32_bf16 a[32:35], a[204:207], v[120:123], 0
s_lshl_b32 s97, s70, 5
v_mfma_f32_16x16x32_bf16 a[36:39], a[204:207], v[124:127], 0
s_add_u32 s97, s97, s96
v_mfma_f32_16x16x32_bf16 a[40:43], a[204:207], v[128:131], 0
s_add_u32 m0, s78, 25344
v_mfma_f32_16x16x32_bf16 a[44:47], a[204:207], v[132:135], 0
buffer_load_dwordx4 v2, s[84:87], s97 offen lds
ds_read_b64_tr_b16 a[204:205], v18 offset:8480
v_mfma_f32_16x16x32_bf16 a[48:51], a[208:211], v[112:115], 0
ds_read_b64_tr_b16 a[206:207], v18 offset:12704
v_mfma_f32_16x16x32_bf16 a[52:55], a[208:211], v[116:119], 0
s_mov_b32 s71, 0
v_mfma_f32_16x16x32_bf16 a[56:59], a[208:211], v[120:123], 0
buffer_load_dwordx4 v3, s[84:87], s97 offen offset:1056 lds
buffer_store_dwordx4 v[196:199], v38, s[48:51], s71 offen offset:3072 sc1
v_mfma_f32_16x16x32_bf16 a[60:63], a[208:211], v[124:127], 0
v_mfma_f32_16x16x32_bf16 a[64:67], a[208:211], v[128:131], 0
v_mfma_f32_16x16x32_bf16 a[68:71], a[208:211], v[132:135], 0
buffer_load_dwordx4 v4, s[84:87], s97 offen offset:2112 lds
ds_read_b64_tr_b16 a[208:209], v39 offset:8448
v_mfma_f32_16x16x32_bf16 a[72:75], a[212:215], v[112:115], 0
ds_read_b64_tr_b16 a[210:211], v39 offset:12672
v_mfma_f32_16x16x32_bf16 a[76:79], a[212:215], v[116:119], 0
v_mfma_f32_16x16x32_bf16 a[80:83], a[212:215], v[120:123], 0
buffer_load_dwordx4 v5, s[84:87], s97 offen offset:3168 lds
s_mov_b32 s71, 131072
v_mfma_f32_16x16x32_bf16 a[84:87], a[212:215], v[124:127], 0
buffer_store_dwordx4 v[200:203], v38, s[48:51], s71 offen sc1
s_add_u32 s98, s97, 16384
v_mfma_f32_16x16x32_bf16 a[88:91], a[212:215], v[128:131], 0
s_add_u32 m0, s78, 29568
v_mfma_f32_16x16x32_bf16 a[92:95], a[212:215], v[132:135], 0
buffer_load_dwordx4 v2, s[84:87], s98 offen lds
ds_read_b64_tr_b16 a[212:213], v39 offset:8480
v_mfma_f32_16x16x32_bf16 a[96:99], a[216:219], v[112:115], 0
ds_read_b64_tr_b16 a[214:215], v39 offset:12704
v_mfma_f32_16x16x32_bf16 a[100:103], a[216:219], v[116:119], 0
v_mfma_f32_16x16x32_bf16 a[104:107], a[216:219], v[120:123], 0
buffer_load_dwordx4 v3, s[84:87], s98 offen offset:1056 lds
v_mfma_f32_16x16x32_bf16 a[108:111], a[216:219], v[124:127], 0
v_mfma_f32_16x16x32_bf16 a[112:115], a[216:219], v[128:131], 0
s_mov_b32 s71, 131072
v_mfma_f32_16x16x32_bf16 a[116:119], a[216:219], v[132:135], 0
buffer_load_dwordx4 v4, s[84:87], s98 offen offset:2112 lds
buffer_store_dwordx4 v[204:207], v38, s[48:51], s71 offen offset:1024 sc1
ds_read_b64_tr_b16 a[216:217], v40 offset:8448
v_mfma_f32_16x16x32_bf16 a[120:123], a[220:223], v[112:115], 0
ds_read_b64_tr_b16 a[218:219], v40 offset:12672
v_mfma_f32_16x16x32_bf16 a[124:127], a[220:223], v[116:119], 0
v_mfma_f32_16x16x32_bf16 a[128:131], a[220:223], v[120:123], 0
buffer_load_dwordx4 v5, s[84:87], s98 offen offset:3168 lds
v_mfma_f32_16x16x32_bf16 a[132:135], a[220:223], v[124:127], 0
v_mfma_f32_16x16x32_bf16 a[136:139], a[220:223], v[128:131], 0
v_mfma_f32_16x16x32_bf16 a[140:143], a[220:223], v[132:135], 0
ds_read_b64_tr_b16 a[220:221], v40 offset:8480
s_waitcnt vmcnt(33) lgkmcnt(3)
v_mfma_f32_16x16x32_bf16 v[64:67], a[192:195], v[136:139], v[64:67]
ds_read_b64_tr_b16 a[222:223], v40 offset:12704
s_waitcnt vmcnt(32)
v_mfma_f32_16x16x32_bf16 v[68:71], a[192:195], v[140:143], v[68:71]
s_add_u32 s99, s70, s79
s_waitcnt vmcnt(31)
v_mfma_f32_16x16x32_bf16 v[72:75], a[192:195], v[144:147], v[72:75]
buffer_load_dwordx4 v[112:115], v11, s[80:83], s99 offen sc1
s_mov_b32 s71, 131072
s_waitcnt vmcnt(31)
v_mfma_f32_16x16x32_bf16 v[76:79], a[192:195], v[148:151], v[76:79]
buffer_store_dwordx4 v[208:211], v38, s[48:51], s71 offen offset:2048 sc1
s_waitcnt vmcnt(31)
v_mfma_f32_16x16x32_bf16 v[80:83], a[192:195], v[152:155], v[80:83]
s_waitcnt vmcnt(30)
v_mfma_f32_16x16x32_bf16 v[84:87], a[192:195], v[156:159], v[84:87]
buffer_load_dwordx4 v[116:119], v12, s[80:83], s99 offen sc1
s_waitcnt vmcnt(23)
ds_read_b64_tr_b16 a[192:193], v17 offset:16896
v_mfma_f32_16x16x32_bf16 v[88:91], a[196:199], v[136:139], v[88:91]
ds_read_b64_tr_b16 a[194:195], v17 offset:21120
v_mfma_f32_16x16x32_bf16 v[92:95], a[196:199], v[140:143], v[92:95]
v_mfma_f32_16x16x32_bf16 v[96:99], a[196:199], v[144:147], v[96:99]
buffer_load_dwordx4 v[120:123], v13, s[80:83], s99 offen sc1
v_mfma_f32_16x16x32_bf16 v[100:103], a[196:199], v[148:151], v[100:103]
s_mov_b32 s71, 131072
v_mfma_f32_16x16x32_bf16 v[104:107], a[196:199], v[152:155], v[104:107]
buffer_store_dwordx4 v[212:215], v38, s[48:51], s71 offen offset:3072 sc1
v_mfma_f32_16x16x32_bf16 v[108:111], a[196:199], v[156:159], v[108:111]
buffer_load_dwordx4 v[124:127], v14, s[80:83], s99 offen sc1
ds_read_b64_tr_b16 a[196:197], v17 offset:16928
v_mfma_f32_16x16x32_bf16 a[0:3], a[200:203], v[136:139], a[0:3]
ds_read_b64_tr_b16 a[198:199], v17 offset:21152
v_mfma_f32_16x16x32_bf16 a[4:7], a[200:203], v[140:143], a[4:7]
v_mfma_f32_16x16x32_bf16 a[8:11], a[200:203], v[144:147], a[8:11]
buffer_load_dwordx4 v[128:131], v15, s[80:83], s99 offen sc1
v_mfma_f32_16x16x32_bf16 a[12:15], a[200:203], v[148:151], a[12:15]
v_mfma_f32_16x16x32_bf16 a[16:19], a[200:203], v[152:155], a[16:19]
v_mfma_f32_16x16x32_bf16 a[20:23], a[200:203], v[156:159], a[20:23]
buffer_load_dwordx4 v[132:135], v16, s[80:83], s99 offen sc1
s_mov_b32 s71, 262144
ds_read_b64_tr_b16 a[200:201], v18 offset:16896
v_mfma_f32_16x16x32_bf16 a[24:27], a[204:207], v[136:139], a[24:27]
buffer_store_dwordx4 v[216:219], v38, s[48:51], s71 offen sc1
s_add_u32 s70, s70, 1024
ds_read_b64_tr_b16 a[202:203], v18 offset:21120
v_mfma_f32_16x16x32_bf16 a[28:31], a[204:207], v[140:143], a[28:31]
s_and_b32 s70, s70, 16383
v_mfma_f32_16x16x32_bf16 a[32:35], a[204:207], v[144:147], a[32:35]
s_lshl_b32 s97, s70, 5
v_mfma_f32_16x16x32_bf16 a[36:39], a[204:207], v[148:151], a[36:39]
s_add_u32 s97, s97, s96
v_mfma_f32_16x16x32_bf16 a[40:43], a[204:207], v[152:155], a[40:43]
s_add_u32 m0, s78, 0
v_mfma_f32_16x16x32_bf16 a[44:47], a[204:207], v[156:159], a[44:47]
buffer_load_dwordx4 v2, s[84:87], s97 offen lds
ds_read_b64_tr_b16 a[204:205], v18 offset:16928
v_mfma_f32_16x16x32_bf16 a[48:51], a[208:211], v[136:139], a[48:51]
ds_read_b64_tr_b16 a[206:207], v18 offset:21152
v_mfma_f32_16x16x32_bf16 a[52:55], a[208:211], v[140:143], a[52:55]
s_mov_b32 s71, 262144
v_mfma_f32_16x16x32_bf16 a[56:59], a[208:211], v[144:147], a[56:59]
buffer_load_dwordx4 v3, s[84:87], s97 offen offset:1056 lds
buffer_store_dwordx4 v[220:223], v38, s[48:51], s71 offen offset:1024 sc1
v_mfma_f32_16x16x32_bf16 a[60:63], a[208:211], v[148:151], a[60:63]
v_mfma_f32_16x16x32_bf16 a[64:67], a[208:211], v[152:155], a[64:67]
v_mfma_f32_16x16x32_bf16 a[68:71], a[208:211], v[156:159], a[68:71]
buffer_load_dwordx4 v4, s[84:87], s97 offen offset:2112 lds
ds_read_b64_tr_b16 a[208:209], v39 offset:16896
v_mfma_f32_16x16x32_bf16 a[72:75], a[212:215], v[136:139], a[72:75]
ds_read_b64_tr_b16 a[210:211], v39 offset:21120
v_mfma_f32_16x16x32_bf16 a[76:79], a[212:215], v[140:143], a[76:79]
v_mfma_f32_16x16x32_bf16 a[80:83], a[212:215], v[144:147], a[80:83]
buffer_load_dwordx4 v5, s[84:87], s97 offen offset:3168 lds
s_mov_b32 s71, 262144
v_mfma_f32_16x16x32_bf16 a[84:87], a[212:215], v[148:151], a[84:87]
buffer_store_dwordx4 v[224:227], v38, s[48:51], s71 offen offset:2048 sc1
s_add_u32 s98, s97, 16384
v_mfma_f32_16x16x32_bf16 a[88:91], a[212:215], v[152:155], a[88:91]
s_add_u32 m0, s78, 4224
v_mfma_f32_16x16x32_bf16 a[92:95], a[212:215], v[156:159], a[92:95]
buffer_load_dwordx4 v2, s[84:87], s98 offen lds
ds_read_b64_tr_b16 a[212:213], v39 offset:16928
s_waitcnt lgkmcnt(2)
v_mfma_f32_16x16x32_bf16 a[96:99], a[216:219], v[136:139], a[96:99]
ds_read_b64_tr_b16 a[214:215], v39 offset:21152
v_mfma_f32_16x16x32_bf16 a[100:103], a[216:219], v[140:143], a[100:103]
v_mfma_f32_16x16x32_bf16 a[104:107], a[216:219], v[144:147], a[104:107]
buffer_load_dwordx4 v3, s[84:87], s98 offen offset:1056 lds
v_mfma_f32_16x16x32_bf16 a[108:111], a[216:219], v[148:151], a[108:111]
v_mfma_f32_16x16x32_bf16 a[112:115], a[216:219], v[152:155], a[112:115]
s_mov_b32 s71, 262144
v_mfma_f32_16x16x32_bf16 a[116:119], a[216:219], v[156:159], a[116:119]
buffer_load_dwordx4 v4, s[84:87], s98 offen offset:2112 lds
buffer_store_dwordx4 v[228:231], v38, s[48:51], s71 offen offset:3072 sc1
ds_read_b64_tr_b16 a[216:217], v40 offset:16896
v_mfma_f32_16x16x32_bf16 a[120:123], a[220:223], v[136:139], a[120:123]
ds_read_b64_tr_b16 a[218:219], v40 offset:21120
v_mfma_f32_16x16x32_bf16 a[124:127], a[220:223], v[140:143], a[124:127]
v_mfma_f32_16x16x32_bf16 a[128:131], a[220:223], v[144:147], a[128:131]
buffer_load_dwordx4 v5, s[84:87], s98 offen offset:3168 lds
v_mfma_f32_16x16x32_bf16 a[132:135], a[220:223], v[148:151], a[132:135]
v_mfma_f32_16x16x32_bf16 a[136:139], a[220:223], v[152:155], a[136:139]
v_mfma_f32_16x16x32_bf16 a[140:143], a[220:223], v[156:159], a[140:143]
ds_read_b64_tr_b16 a[220:221], v40 offset:16928
s_waitcnt vmcnt(39)
v_mfma_f32_16x16x32_bf16 v[64:67], a[192:195], v[160:163], v[64:67]
ds_read_b64_tr_b16 a[222:223], v40 offset:21152
s_waitcnt vmcnt(37)
v_mfma_f32_16x16x32_bf16 v[68:71], a[192:195], v[164:167], v[68:71]
s_add_u32 s99, s70, s79
s_waitcnt vmcnt(36)
v_mfma_f32_16x16x32_bf16 v[72:75], a[192:195], v[168:171], v[72:75]
buffer_load_dwordx4 v[136:139], v11, s[80:83], s99 offen sc1
s_mov_b32 s71, 393216
s_waitcnt vmcnt(35)
v_mfma_f32_16x16x32_bf16 v[76:79], a[192:195], v[172:175], v[76:79]
buffer_store_dwordx4 v[232:235], v38, s[48:51], s71 offen sc1
s_waitcnt vmcnt(35)
v_mfma_f32_16x16x32_bf16 v[80:83], a[192:195], v[176:179], v[80:83]
s_waitcnt vmcnt(34)
v_mfma_f32_16x16x32_bf16 v[84:87], a[192:195], v[180:183], v[84:87]
buffer_load_dwordx4 v[140:143], v12, s[80:83], s99 offen sc1
s_waitcnt vmcnt(23)
ds_read_b64_tr_b16 a[192:193], v17 offset:25344
v_mfma_f32_16x16x32_bf16 v[88:91], a[196:199], v[160:163], v[88:91]
ds_read_b64_tr_b16 a[194:195], v17 offset:29568
v_mfma_f32_16x16x32_bf16 v[92:95], a[196:199], v[164:167], v[92:95]
v_mfma_f32_16x16x32_bf16 v[96:99], a[196:199], v[168:171], v[96:99]
buffer_load_dwordx4 v[144:147], v13, s[80:83], s99 offen sc1
v_mfma_f32_16x16x32_bf16 v[100:103], a[196:199], v[172:175], v[100:103]
s_mov_b32 s71, 393216
v_mfma_f32_16x16x32_bf16 v[104:107], a[196:199], v[176:179], v[104:107]
buffer_store_dwordx4 v[236:239], v38, s[48:51], s71 offen offset:1024 sc1
v_mfma_f32_16x16x32_bf16 v[108:111], a[196:199], v[180:183], v[108:111]
buffer_load_dwordx4 v[148:151], v14, s[80:83], s99 offen sc1
ds_read_b64_tr_b16 a[196:197], v17 offset:25376
v_mfma_f32_16x16x32_bf16 a[0:3], a[200:203], v[160:163], a[0:3]
ds_read_b64_tr_b16 a[198:199], v17 offset:29600
v_mfma_f32_16x16x32_bf16 a[4:7], a[200:203], v[164:167], a[4:7]
v_mfma_f32_16x16x32_bf16 a[8:11], a[200:203], v[168:171], a[8:11]
buffer_load_dwordx4 v[152:155], v15, s[80:83], s99 offen sc1
v_mfma_f32_16x16x32_bf16 a[12:15], a[200:203], v[172:175], a[12:15]
v_mfma_f32_16x16x32_bf16 a[16:19], a[200:203], v[176:179], a[16:19]
v_mfma_f32_16x16x32_bf16 a[20:23], a[200:203], v[180:183], a[20:23]
buffer_load_dwordx4 v[156:159], v16, s[80:83], s99 offen sc1
s_mov_b32 s71, 393216
ds_read_b64_tr_b16 a[200:201], v18 offset:25344
v_mfma_f32_16x16x32_bf16 a[24:27], a[204:207], v[160:163], a[24:27]
buffer_store_dwordx4 v[240:243], v38, s[48:51], s71 offen offset:2048 sc1
s_add_u32 s70, s70, 1024
ds_read_b64_tr_b16 a[202:203], v18 offset:29568
v_mfma_f32_16x16x32_bf16 a[28:31], a[204:207], v[164:167], a[28:31]
s_and_b32 s70, s70, 16383
v_mfma_f32_16x16x32_bf16 a[32:35], a[204:207], v[168:171], a[32:35]
s_lshl_b32 s97, s70, 5
v_mfma_f32_16x16x32_bf16 a[36:39], a[204:207], v[172:175], a[36:39]
s_add_u32 s97, s97, s96
v_mfma_f32_16x16x32_bf16 a[40:43], a[204:207], v[176:179], a[40:43]
s_add_u32 m0, s78, 8448
v_mfma_f32_16x16x32_bf16 a[44:47], a[204:207], v[180:183], a[44:47]
buffer_load_dwordx4 v2, s[84:87], s97 offen lds
ds_read_b64_tr_b16 a[204:205], v18 offset:25376
s_waitcnt lgkmcnt(2)
v_mfma_f32_16x16x32_bf16 a[48:51], a[208:211], v[160:163], a[48:51]
ds_read_b64_tr_b16 a[206:207], v18 offset:29600
v_mfma_f32_16x16x32_bf16 a[52:55], a[208:211], v[164:167], a[52:55]
s_mov_b32 s71, 393216
v_mfma_f32_16x16x32_bf16 a[56:59], a[208:211], v[168:171], a[56:59]
buffer_load_dwordx4 v3, s[84:87], s97 offen offset:1056 lds
buffer_store_dwordx4 v[244:247], v38, s[48:51], s71 offen offset:3072 sc1
v_mfma_f32_16x16x32_bf16 a[60:63], a[208:211], v[172:175], a[60:63]
v_mfma_f32_16x16x32_bf16 a[64:67], a[208:211], v[176:179], a[64:67]
v_mfma_f32_16x16x32_bf16 a[68:71], a[208:211], v[180:183], a[68:71]
buffer_load_dwordx4 v4, s[84:87], s97 offen offset:2112 lds
ds_read_b64_tr_b16 a[208:209], v39 offset:25344
v_mfma_f32_16x16x32_bf16 a[72:75], a[212:215], v[160:163], a[72:75]
ds_read_b64_tr_b16 a[210:211], v39 offset:29568
v_mfma_f32_16x16x32_bf16 a[76:79], a[212:215], v[164:167], a[76:79]
v_mfma_f32_16x16x32_bf16 a[80:83], a[212:215], v[168:171], a[80:83]
buffer_load_dwordx4 v5, s[84:87], s97 offen offset:3168 lds
s_mov_b32 s71, 524288
v_mfma_f32_16x16x32_bf16 a[84:87], a[212:215], v[172:175], a[84:87]
buffer_store_dwordx4 v[248:251], v38, s[48:51], s71 offen sc1
s_add_u32 s98, s97, 16384
v_mfma_f32_16x16x32_bf16 a[88:91], a[212:215], v[176:179], a[88:91]
s_add_u32 m0, s78, 12672
v_mfma_f32_16x16x32_bf16 a[92:95], a[212:215], v[180:183], a[92:95]
buffer_load_dwordx4 v2, s[84:87], s98 offen lds
ds_read_b64_tr_b16 a[212:213], v39 offset:25376
v_mfma_f32_16x16x32_bf16 a[96:99], a[216:219], v[160:163], a[96:99]
ds_read_b64_tr_b16 a[214:215], v39 offset:29600
v_mfma_f32_16x16x32_bf16 a[100:103], a[216:219], v[164:167], a[100:103]
v_mfma_f32_16x16x32_bf16 a[104:107], a[216:219], v[168:171], a[104:107]
buffer_load_dwordx4 v3, s[84:87], s98 offen offset:1056 lds
v_mfma_f32_16x16x32_bf16 a[108:111], a[216:219], v[172:175], a[108:111]
v_mfma_f32_16x16x32_bf16 a[112:115], a[216:219], v[176:179], a[112:115]
s_mov_b32 s71, 524288
v_mfma_f32_16x16x32_bf16 a[116:119], a[216:219], v[180:183], a[116:119]
buffer_load_dwordx4 v4, s[84:87], s98 offen offset:2112 lds
buffer_store_dwordx4 v[252:255], v38, s[48:51], s71 offen offset:1024 sc1
ds_read_b64_tr_b16 a[216:217], v40 offset:25344
v_mfma_f32_16x16x32_bf16 a[120:123], a[220:223], v[160:163], a[120:123]
ds_read_b64_tr_b16 a[218:219], v40 offset:29568
v_mfma_f32_16x16x32_bf16 a[124:127], a[220:223], v[164:167], a[124:127]
v_mfma_f32_16x16x32_bf16 a[128:131], a[220:223], v[168:171], a[128:131]
buffer_load_dwordx4 v5, s[84:87], s98 offen offset:3168 lds
v_mfma_f32_16x16x32_bf16 a[132:135], a[220:223], v[172:175], a[132:135]
v_mfma_f32_16x16x32_bf16 a[136:139], a[220:223], v[176:179], a[136:139]
v_mfma_f32_16x16x32_bf16 a[140:143], a[220:223], v[180:183], a[140:143]
ds_read_b64_tr_b16 a[220:221], v40 offset:25376
s_waitcnt vmcnt(39)
v_mfma_f32_16x16x32_bf16 v[64:67], a[192:195], v[112:115], v[64:67]
ds_read_b64_tr_b16 a[222:223], v40 offset:29600
s_waitcnt vmcnt(37)
v_mfma_f32_16x16x32_bf16 v[68:71], a[192:195], v[116:119], v[68:71]
s_add_u32 s99, s70, s79
s_waitcnt vmcnt(36)
v_mfma_f32_16x16x32_bf16 v[72:75], a[192:195], v[120:123], v[72:75]
buffer_load_dwordx4 v[160:163], v11, s[80:83], s99 offen sc1
s_mov_b32 s71, 524288
s_waitcnt vmcnt(35)
v_mfma_f32_16x16x32_bf16 v[76:79], a[192:195], v[124:127], v[76:79]
buffer_store_dwordx4 v[52:55], v38, s[48:51], s71 offen offset:2048 sc1
s_waitcnt vmcnt(35)
v_mfma_f32_16x16x32_bf16 v[80:83], a[192:195], v[128:131], v[80:83]
s_waitcnt vmcnt(34)
v_mfma_f32_16x16x32_bf16 v[84:87], a[192:195], v[132:135], v[84:87]
buffer_load_dwordx4 v[164:167], v12, s[80:83], s99 offen sc1
s_waitcnt vmcnt(23)
ds_read_b64_tr_b16 a[192:193], v17
v_mfma_f32_16x16x32_bf16 v[88:91], a[196:199], v[112:115], v[88:91]
ds_read_b64_tr_b16 a[194:195], v17 offset:4224
v_mfma_f32_16x16x32_bf16 v[92:95], a[196:199], v[116:119], v[92:95]
v_mfma_f32_16x16x32_bf16 v[96:99], a[196:199], v[120:123], v[96:99]
buffer_load_dwordx4 v[168:171], v13, s[80:83], s99 offen sc1
v_mfma_f32_16x16x32_bf16 v[100:103], a[196:199], v[124:127], v[100:103]
s_mov_b32 s71, 524288
v_mfma_f32_16x16x32_bf16 v[104:107], a[196:199], v[128:131], v[104:107]
buffer_store_dwordx4 v[56:59], v38, s[48:51], s71 offen offset:3072 sc1
v_mfma_f32_16x16x32_bf16 v[108:111], a[196:199], v[132:135], v[108:111]
buffer_load_dwordx4 v[172:175], v14, s[80:83], s99 offen sc1
ds_read_b64_tr_b16 a[196:197], v17 offset:32
s_waitcnt lgkmcnt(3)
v_mfma_f32_16x16x32_bf16 a[0:3], a[200:203], v[112:115], a[0:3]
ds_read_b64_tr_b16 a[198:199], v17 offset:4256
v_mfma_f32_16x16x32_bf16 a[4:7], a[200:203], v[116:119], a[4:7]
v_mfma_f32_16x16x32_bf16 a[8:11], a[200:203], v[120:123], a[8:11]
buffer_load_dwordx4 v[176:179], v15, s[80:83], s99 offen sc1
v_mfma_f32_16x16x32_bf16 a[12:15], a[200:203], v[124:127], a[12:15]
v_mfma_f32_16x16x32_bf16 a[16:19], a[200:203], v[128:131], a[16:19]
v_mfma_f32_16x16x32_bf16 a[20:23], a[200:203], v[132:135], a[20:23]
buffer_load_dwordx4 v[180:183], v16, s[80:83], s99 offen sc1
s_mov_b32 s71, 655360
ds_read_b64_tr_b16 a[200:201], v18
v_mfma_f32_16x16x32_bf16 a[24:27], a[204:207], v[112:115], a[24:27]
buffer_store_dwordx4 v[60:63], v38, s[48:51], s71 offen sc1
s_add_u32 s70, s70, 1024
ds_read_b64_tr_b16 a[202:203], v18 offset:4224
v_mfma_f32_16x16x32_bf16 a[28:31], a[204:207], v[116:119], a[28:31]
s_and_b32 s70, s70, 16383
v_mfma_f32_16x16x32_bf16 a[32:35], a[204:207], v[120:123], a[32:35]
s_lshl_b32 s97, s70, 5
v_mfma_f32_16x16x32_bf16 a[36:39], a[204:207], v[124:127], a[36:39]
s_add_u32 s97, s97, s96
v_mfma_f32_16x16x32_bf16 a[40:43], a[204:207], v[128:131], a[40:43]
s_add_u32 m0, s78, 16896
v_mfma_f32_16x16x32_bf16 a[44:47], a[204:207], v[132:135], a[44:47]
buffer_load_dwordx4 v2, s[84:87], s97 offen lds
ds_read_b64_tr_b16 a[204:205], v18 offset:32
v_mfma_f32_16x16x32_bf16 a[48:51], a[208:211], v[112:115], a[48:51]
ds_read_b64_tr_b16 a[206:207], v18 offset:4256
v_mfma_f32_16x16x32_bf16 a[52:55], a[208:211], v[116:119], a[52:55]
s_mov_b32 s71, 655360
v_mfma_f32_16x16x32_bf16 a[56:59], a[208:211], v[120:123], a[56:59]
buffer_load_dwordx4 v3, s[84:87], s97 offen offset:1056 lds
buffer_store_dwordx4 v[20:23], v38, s[48:51], s71 offen offset:1024 sc1
v_mfma_f32_16x16x32_bf16 a[60:63], a[208:211], v[124:127], a[60:63]
v_mfma_f32_16x16x32_bf16 a[64:67], a[208:211], v[128:131], a[64:67]
v_mfma_f32_16x16x32_bf16 a[68:71], a[208:211], v[132:135], a[68:71]
buffer_load_dwordx4 v4, s[84:87], s97 offen offset:2112 lds
ds_read_b64_tr_b16 a[208:209], v39
v_mfma_f32_16x16x32_bf16 a[72:75], a[212:215], v[112:115], a[72:75]
ds_read_b64_tr_b16 a[210:211], v39 offset:4224
v_mfma_f32_16x16x32_bf16 a[76:79], a[212:215], v[116:119], a[76:79]
v_mfma_f32_16x16x32_bf16 a[80:83], a[212:215], v[120:123], a[80:83]
buffer_load_dwordx4 v5, s[84:87], s97 offen offset:3168 lds
s_mov_b32 s71, 655360
v_mfma_f32_16x16x32_bf16 a[84:87], a[212:215], v[124:127], a[84:87]
buffer_store_dwordx4 v[24:27], v38, s[48:51], s71 offen offset:2048 sc1
s_add_u32 s98, s97, 16384
v_mfma_f32_16x16x32_bf16 a[88:91], a[212:215], v[128:131], a[88:91]
s_add_u32 m0, s78, 21120
v_mfma_f32_16x16x32_bf16 a[92:95], a[212:215], v[132:135], a[92:95]
buffer_load_dwordx4 v2, s[84:87], s98 offen lds
ds_read_b64_tr_b16 a[212:213], v39 offset:32
v_mfma_f32_16x16x32_bf16 a[96:99], a[216:219], v[112:115], a[96:99]
ds_read_b64_tr_b16 a[214:215], v39 offset:4256
v_mfma_f32_16x16x32_bf16 a[100:103], a[216:219], v[116:119], a[100:103]
v_mfma_f32_16x16x32_bf16 a[104:107], a[216:219], v[120:123], a[104:107]
buffer_load_dwordx4 v3, s[84:87], s98 offen offset:1056 lds
v_mfma_f32_16x16x32_bf16 a[108:111], a[216:219], v[124:127], a[108:111]
v_mfma_f32_16x16x32_bf16 a[112:115], a[216:219], v[128:131], a[112:115]
s_mov_b32 s71, 655360
v_mfma_f32_16x16x32_bf16 a[116:119], a[216:219], v[132:135], a[116:119]
buffer_load_dwordx4 v4, s[84:87], s98 offen offset:2112 lds
buffer_store_dwordx4 v[28:31], v38, s[48:51], s71 offen offset:3072 sc1
ds_read_b64_tr_b16 a[216:217], v40
v_mfma_f32_16x16x32_bf16 a[120:123], a[220:223], v[112:115], a[120:123]
ds_read_b64_tr_b16 a[218:219], v40 offset:4224
v_mfma_f32_16x16x32_bf16 a[124:127], a[220:223], v[116:119], a[124:127]
v_mfma_f32_16x16x32_bf16 a[128:131], a[220:223], v[120:123], a[128:131]
buffer_load_dwordx4 v5, s[84:87], s98 offen offset:3168 lds
v_mfma_f32_16x16x32_bf16 a[132:135], a[220:223], v[124:127], a[132:135]
v_mfma_f32_16x16x32_bf16 a[136:139], a[220:223], v[128:131], a[136:139]
v_mfma_f32_16x16x32_bf16 a[140:143], a[220:223], v[132:135], a[140:143]
ds_read_b64_tr_b16 a[220:221], v40 offset:32
s_waitcnt vmcnt(39) lgkmcnt(3)
v_mfma_f32_16x16x32_bf16 v[64:67], a[192:195], v[136:139], v[64:67]
ds_read_b64_tr_b16 a[222:223], v40 offset:4256
s_waitcnt vmcnt(37)
v_mfma_f32_16x16x32_bf16 v[68:71], a[192:195], v[140:143], v[68:71]
s_add_u32 s99, s70, s79
s_waitcnt vmcnt(36)
v_mfma_f32_16x16x32_bf16 v[72:75], a[192:195], v[144:147], v[72:75]
buffer_load_dwordx4 v[112:115], v11, s[80:83], s99 offen sc1
s_waitcnt vmcnt(35)
v_mfma_f32_16x16x32_bf16 v[76:79], a[192:195], v[148:151], v[76:79]
s_waitcnt vmcnt(34)
v_mfma_f32_16x16x32_bf16 v[80:83], a[192:195], v[152:155], v[80:83]
s_waitcnt vmcnt(33)
v_mfma_f32_16x16x32_bf16 v[84:87], a[192:195], v[156:159], v[84:87]
buffer_load_dwordx4 v[116:119], v12, s[80:83], s99 offen sc1
s_waitcnt vmcnt(22)
ds_read_b64_tr_b16 a[192:193], v17 offset:8448
v_mfma_f32_16x16x32_bf16 v[88:91], a[196:199], v[136:139], v[88:91]
ds_read_b64_tr_b16 a[194:195], v17 offset:12672
v_mfma_f32_16x16x32_bf16 v[92:95], a[196:199], v[140:143], v[92:95]
v_mfma_f32_16x16x32_bf16 v[96:99], a[196:199], v[144:147], v[96:99]
buffer_load_dwordx4 v[120:123], v13, s[80:83], s99 offen sc1
v_mfma_f32_16x16x32_bf16 v[100:103], a[196:199], v[148:151], v[100:103]
v_mfma_f32_16x16x32_bf16 v[104:107], a[196:199], v[152:155], v[104:107]
v_mfma_f32_16x16x32_bf16 v[108:111], a[196:199], v[156:159], v[108:111]
buffer_load_dwordx4 v[124:127], v14, s[80:83], s99 offen sc1
ds_read_b64_tr_b16 a[196:197], v17 offset:8480
v_mfma_f32_16x16x32_bf16 a[0:3], a[200:203], v[136:139], a[0:3]
ds_read_b64_tr_b16 a[198:199], v17 offset:12704
v_mfma_f32_16x16x32_bf16 a[4:7], a[200:203], v[140:143], a[4:7]
v_mfma_f32_16x16x32_bf16 a[8:11], a[200:203], v[144:147], a[8:11]
buffer_load_dwordx4 v[128:131], v15, s[80:83], s99 offen sc1
v_mfma_f32_16x16x32_bf16 a[12:15], a[200:203], v[148:151], a[12:15]
v_mfma_f32_16x16x32_bf16 a[16:19], a[200:203], v[152:155], a[16:19]
v_mfma_f32_16x16x32_bf16 a[20:23], a[200:203], v[156:159], a[20:23]
buffer_load_dwordx4 v[132:135], v16, s[80:83], s99 offen sc1
ds_read_b64_tr_b16 a[200:201], v18 offset:8448
v_mfma_f32_16x16x32_bf16 a[24:27], a[204:207], v[136:139], a[24:27]
s_add_u32 s70, s70, 1024
ds_read_b64_tr_b16 a[202:203], v18 offset:12672
v_mfma_f32_16x16x32_bf16 a[28:31], a[204:207], v[140:143], a[28:31]
s_and_b32 s70, s70, 16383
v_mfma_f32_16x16x32_bf16 a[32:35], a[204:207], v[144:147], a[32:35]
s_lshl_b32 s97, s70, 5
v_mfma_f32_16x16x32_bf16 a[36:39], a[204:207], v[148:151], a[36:39]
s_add_u32 s97, s97, s96
v_mfma_f32_16x16x32_bf16 a[40:43], a[204:207], v[152:155], a[40:43]
s_add_u32 m0, s78, 25344
v_mfma_f32_16x16x32_bf16 a[44:47], a[204:207], v[156:159], a[44:47]
buffer_load_dwordx4 v2, s[84:87], s97 offen lds
ds_read_b64_tr_b16 a[204:205], v18 offset:8480
v_mfma_f32_16x16x32_bf16 a[48:51], a[208:211], v[136:139], a[48:51]
ds_read_b64_tr_b16 a[206:207], v18 offset:12704
v_mfma_f32_16x16x32_bf16 a[52:55], a[208:211], v[140:143], a[52:55]
v_mfma_f32_16x16x32_bf16 a[56:59], a[208:211], v[144:147], a[56:59]
buffer_load_dwordx4 v3, s[84:87], s97 offen offset:1056 lds
v_mfma_f32_16x16x32_bf16 a[60:63], a[208:211], v[148:151], a[60:63]
v_mfma_f32_16x16x32_bf16 a[64:67], a[208:211], v[152:155], a[64:67]
v_mfma_f32_16x16x32_bf16 a[68:71], a[208:211], v[156:159], a[68:71]
buffer_load_dwordx4 v4, s[84:87], s97 offen offset:2112 lds
ds_read_b64_tr_b16 a[208:209], v39 offset:8448
v_mfma_f32_16x16x32_bf16 a[72:75], a[212:215], v[136:139], a[72:75]
ds_read_b64_tr_b16 a[210:211], v39 offset:12672
v_mfma_f32_16x16x32_bf16 a[76:79], a[212:215], v[140:143], a[76:79]
v_mfma_f32_16x16x32_bf16 a[80:83], a[212:215], v[144:147], a[80:83]
buffer_load_dwordx4 v5, s[84:87], s97 offen offset:3168 lds
v_mfma_f32_16x16x32_bf16 a[84:87], a[212:215], v[148:151], a[84:87]
s_add_u32 s98, s97, 16384
v_mfma_f32_16x16x32_bf16 a[88:91], a[212:215], v[152:155], a[88:91]
s_add_u32 m0, s78, 29568
v_mfma_f32_16x16x32_bf16 a[92:95], a[212:215], v[156:159], a[92:95]
buffer_load_dwordx4 v2, s[84:87], s98 offen lds
ds_read_b64_tr_b16 a[212:213], v39 offset:8480
s_waitcnt lgkmcnt(3)
v_mfma_f32_16x16x32_bf16 a[96:99], a[216:219], v[136:139], a[96:99]
ds_read_b64_tr_b16 a[214:215], v39 offset:12704
v_mfma_f32_16x16x32_bf16 a[100:103], a[216:219], v[140:143], a[100:103]
v_mfma_f32_16x16x32_bf16 a[104:107], a[216:219], v[144:147], a[104:107]
buffer_load_dwordx4 v3, s[84:87], s98 offen offset:1056 lds
v_mfma_f32_16x16x32_bf16 a[108:111], a[216:219], v[148:151], a[108:111]
v_mfma_f32_16x16x32_bf16 a[112:115], a[216:219], v[152:155], a[112:115]
v_mfma_f32_16x16x32_bf16 a[116:119], a[216:219], v[156:159], a[116:119]
buffer_load_dwordx4 v4, s[84:87], s98 offen offset:2112 lds
ds_read_b64_tr_b16 a[216:217], v40 offset:8448
v_mfma_f32_16x16x32_bf16 a[120:123], a[220:223], v[136:139], a[120:123]
ds_read_b64_tr_b16 a[218:219], v40 offset:12672
v_mfma_f32_16x16x32_bf16 a[124:127], a[220:223], v[140:143], a[124:127]
v_mfma_f32_16x16x32_bf16 a[128:131], a[220:223], v[144:147], a[128:131]
buffer_load_dwordx4 v5, s[84:87], s98 offen offset:3168 lds
v_mfma_f32_16x16x32_bf16 a[132:135], a[220:223], v[148:151], a[132:135]
v_mfma_f32_16x16x32_bf16 a[136:139], a[220:223], v[152:155], a[136:139]
v_mfma_f32_16x16x32_bf16 a[140:143], a[220:223], v[156:159], a[140:143]
ds_read_b64_tr_b16 a[220:221], v40 offset:8480
s_waitcnt vmcnt(33)
v_mfma_f32_16x16x32_bf16 v[64:67], a[192:195], v[160:163], v[64:67]
ds_read_b64_tr_b16 a[222:223], v40 offset:12704
s_waitcnt vmcnt(31)
v_mfma_f32_16x16x32_bf16 v[68:71], a[192:195], v[164:167], v[68:71]
s_add_u32 s99, s70, s79
s_waitcnt vmcnt(30)
v_mfma_f32_16x16x32_bf16 v[72:75], a[192:195], v[168:171], v[72:75]
buffer_load_dwordx4 v[136:139], v11, s[80:83], s99 offen sc1
s_waitcnt vmcnt(29)
v_mfma_f32_16x16x32_bf16 v[76:79], a[192:195], v[172:175], v[76:79]
s_waitcnt vmcnt(28)
v_mfma_f32_16x16x32_bf16 v[80:83], a[192:195], v[176:179], v[80:83]
s_waitcnt vmcnt(27)
v_mfma_f32_16x16x32_bf16 v[84:87], a[192:195], v[180:183], v[84:87]
buffer_load_dwordx4 v[140:143], v12, s[80:83], s99 offen sc1
s_waitcnt vmcnt(16)
ds_read_b64_tr_b16 a[192:193], v17 offset:16896
v_mfma_f32_16x16x32_bf16 v[88:91], a[196:199], v[160:163], v[88:91]
ds_read_b64_tr_b16 a[194:195], v17 offset:21120
v_mfma_f32_16x16x32_bf16 v[92:95], a[196:199], v[164:167], v[92:95]
v_mfma_f32_16x16x32_bf16 v[96:99], a[196:199], v[168:171], v[96:99]
buffer_load_dwordx4 v[144:147], v13, s[80:83], s99 offen sc1
v_mfma_f32_16x16x32_bf16 v[100:103], a[196:199], v[172:175], v[100:103]
v_mfma_f32_16x16x32_bf16 v[104:107], a[196:199], v[176:179], v[104:107]
v_mfma_f32_16x16x32_bf16 v[108:111], a[196:199], v[180:183], v[108:111]
buffer_load_dwordx4 v[148:151], v14, s[80:83], s99 offen sc1
ds_read_b64_tr_b16 a[196:197], v17 offset:16928
v_mfma_f32_16x16x32_bf16 a[0:3], a[200:203], v[160:163], a[0:3]
ds_read_b64_tr_b16 a[198:199], v17 offset:21152
v_mfma_f32_16x16x32_bf16 a[4:7], a[200:203], v[164:167], a[4:7]
v_mfma_f32_16x16x32_bf16 a[8:11], a[200:203], v[168:171], a[8:11]
buffer_load_dwordx4 v[152:155], v15, s[80:83], s99 offen sc1
v_mfma_f32_16x16x32_bf16 a[12:15], a[200:203], v[172:175], a[12:15]
v_mfma_f32_16x16x32_bf16 a[16:19], a[200:203], v[176:179], a[16:19]
v_mfma_f32_16x16x32_bf16 a[20:23], a[200:203], v[180:183], a[20:23]
buffer_load_dwordx4 v[156:159], v16, s[80:83], s99 offen sc1
ds_read_b64_tr_b16 a[200:201], v18 offset:16896
v_mfma_f32_16x16x32_bf16 a[24:27], a[204:207], v[160:163], a[24:27]
s_add_u32 s70, s70, 1024
ds_read_b64_tr_b16 a[202:203], v18 offset:21120
v_mfma_f32_16x16x32_bf16 a[28:31], a[204:207], v[164:167], a[28:31]
s_and_b32 s70, s70, 16383
v_mfma_f32_16x16x32_bf16 a[32:35], a[204:207], v[168:171], a[32:35]
s_lshl_b32 s97, s70, 5
v_mfma_f32_16x16x32_bf16 a[36:39], a[204:207], v[172:175], a[36:39]
s_add_u32 s97, s97, s96
v_mfma_f32_16x16x32_bf16 a[40:43], a[204:207], v[176:179], a[40:43]
s_add_u32 m0, s78, 0
v_mfma_f32_16x16x32_bf16 a[44:47], a[204:207], v[180:183], a[44:47]
buffer_load_dwordx4 v2, s[84:87], s97 offen lds
ds_read_b64_tr_b16 a[204:205], v18 offset:16928
s_waitcnt lgkmcnt(2)
v_mfma_f32_16x16x32_bf16 a[48:51], a[208:211], v[160:163], a[48:51]
ds_read_b64_tr_b16 a[206:207], v18 offset:21152
v_mfma_f32_16x16x32_bf16 a[52:55], a[208:211], v[164:167], a[52:55]
v_mfma_f32_16x16x32_bf16 a[56:59], a[208:211], v[168:171], a[56:59]
buffer_load_dwordx4 v3, s[84:87], s97 offen offset:1056 lds
v_mfma_f32_16x16x32_bf16 a[60:63], a[208:211], v[172:175], a[60:63]
v_mfma_f32_16x16x32_bf16 a[64:67], a[208:211], v[176:179], a[64:67]
v_mfma_f32_16x16x32_bf16 a[68:71], a[208:211], v[180:183], a[68:71]
buffer_load_dwordx4 v4, s[84:87], s97 offen offset:2112 lds
ds_read_b64_tr_b16 a[208:209], v39 offset:16896
v_mfma_f32_16x16x32_bf16 a[72:75], a[212:215], v[160:163], a[72:75]
ds_read_b64_tr_b16 a[210:211], v39 offset:21120
v_mfma_f32_16x16x32_bf16 a[76:79], a[212:215], v[164:167], a[76:79]
v_mfma_f32_16x16x32_bf16 a[80:83], a[212:215], v[168:171], a[80:83]
buffer_load_dwordx4 v5, s[84:87], s97 offen offset:3168 lds
v_mfma_f32_16x16x32_bf16 a[84:87], a[212:215], v[172:175], a[84:87]
s_add_u32 s98, s97, 16384
v_mfma_f32_16x16x32_bf16 a[88:91], a[212:215], v[176:179], a[88:91]
s_add_u32 m0, s78, 4224
v_mfma_f32_16x16x32_bf16 a[92:95], a[212:215], v[180:183], a[92:95]
buffer_load_dwordx4 v2, s[84:87], s98 offen lds
ds_read_b64_tr_b16 a[212:213], v39 offset:16928
v_mfma_f32_16x16x32_bf16 a[96:99], a[216:219], v[160:163], a[96:99]
ds_read_b64_tr_b16 a[214:215], v39 offset:21152
v_mfma_f32_16x16x32_bf16 a[100:103], a[216:219], v[164:167], a[100:103]
v_mfma_f32_16x16x32_bf16 a[104:107], a[216:219], v[168:171], a[104:107]
buffer_load_dwordx4 v3, s[84:87], s98 offen offset:1056 lds
v_mfma_f32_16x16x32_bf16 a[108:111], a[216:219], v[172:175], a[108:111]
v_mfma_f32_16x16x32_bf16 a[112:115], a[216:219], v[176:179], a[112:115]
v_mfma_f32_16x16x32_bf16 a[116:119], a[216:219], v[180:183], a[116:119]
buffer_load_dwordx4 v4, s[84:87], s98 offen offset:2112 lds
ds_read_b64_tr_b16 a[216:217], v40 offset:16896
v_mfma_f32_16x16x32_bf16 a[120:123], a[220:223], v[160:163], a[120:123]
ds_read_b64_tr_b16 a[218:219], v40 offset:21120
v_mfma_f32_16x16x32_bf16 a[124:127], a[220:223], v[164:167], a[124:127]
v_mfma_f32_16x16x32_bf16 a[128:131], a[220:223], v[168:171], a[128:131]
buffer_load_dwordx4 v5, s[84:87], s98 offen offset:3168 lds
s_barrier
v_mfma_f32_16x16x32_bf16 a[132:135], a[220:223], v[172:175], a[132:135]
s_add_u32 s64, s15, 4
buffer_atomic_add v48, v50, s[4:7], s64 offen sc1
v_mfma_f32_16x16x32_bf16 a[136:139], a[220:223], v[176:179], a[136:139]
v_mfma_f32_16x16x32_bf16 a[140:143], a[220:223], v[180:183], a[140:143]
ds_read_b64_tr_b16 a[220:221], v40 offset:16928
s_waitcnt vmcnt(28)
v_mfma_f32_16x16x32_bf16 v[64:67], a[192:195], v[112:115], v[64:67]
ds_read_b64_tr_b16 a[222:223], v40 offset:21152
s_waitcnt vmcnt(27)
v_mfma_f32_16x16x32_bf16 v[68:71], a[192:195], v[116:119], v[68:71]
s_add_u32 s99, s70, s79
s_waitcnt vmcnt(26)
v_mfma_f32_16x16x32_bf16 v[72:75], a[192:195], v[120:123], v[72:75]
buffer_load_dwordx4 v[160:163], v11, s[80:83], s99 offen sc1
s_waitcnt vmcnt(26)
v_mfma_f32_16x16x32_bf16 v[76:79], a[192:195], v[124:127], v[76:79]
s_waitcnt vmcnt(25)
v_mfma_f32_16x16x32_bf16 v[80:83], a[192:195], v[128:131], v[80:83]
s_waitcnt vmcnt(24)
v_mfma_f32_16x16x32_bf16 v[84:87], a[192:195], v[132:135], v[84:87]
buffer_load_dwordx4 v[164:167], v12, s[80:83], s99 offen sc1
s_waitcnt vmcnt(17)
ds_read_b64_tr_b16 a[192:193], v17 offset:25344
v_mfma_f32_16x16x32_bf16 v[88:91], a[196:199], v[112:115], v[88:91]
ds_read_b64_tr_b16 a[194:195], v17 offset:29568
v_mfma_f32_16x16x32_bf16 v[92:95], a[196:199], v[116:119], v[92:95]
v_mfma_f32_16x16x32_bf16 v[96:99], a[196:199], v[120:123], v[96:99]
buffer_load_dwordx4 v[168:171], v13, s[80:83], s99 offen sc1
v_mfma_f32_16x16x32_bf16 v[100:103], a[196:199], v[124:127], v[100:103]
v_mfma_f32_16x16x32_bf16 v[104:107], a[196:199], v[128:131], v[104:107]
v_mfma_f32_16x16x32_bf16 v[108:111], a[196:199], v[132:135], v[108:111]
buffer_load_dwordx4 v[172:175], v14, s[80:83], s99 offen sc1
ds_read_b64_tr_b16 a[196:197], v17 offset:25376
s_waitcnt lgkmcnt(3)
v_mfma_f32_16x16x32_bf16 a[0:3], a[200:203], v[112:115], a[0:3]
ds_read_b64_tr_b16 a[198:199], v17 offset:29600
v_mfma_f32_16x16x32_bf16 a[4:7], a[200:203], v[116:119], a[4:7]
v_mfma_f32_16x16x32_bf16 a[8:11], a[200:203], v[120:123], a[8:11]
buffer_load_dwordx4 v[176:179], v15, s[80:83], s99 offen sc1
v_mfma_f32_16x16x32_bf16 a[12:15], a[200:203], v[124:127], a[12:15]
v_mfma_f32_16x16x32_bf16 a[16:19], a[200:203], v[128:131], a[16:19]
v_mfma_f32_16x16x32_bf16 a[20:23], a[200:203], v[132:135], a[20:23]
buffer_load_dwordx4 v[180:183], v16, s[80:83], s99 offen sc1
ds_read_b64_tr_b16 a[200:201], v18 offset:25344
v_mfma_f32_16x16x32_bf16 a[24:27], a[204:207], v[112:115], a[24:27]
s_add_u32 s70, s70, 1024
ds_read_b64_tr_b16 a[202:203], v18 offset:29568
v_mfma_f32_16x16x32_bf16 a[28:31], a[204:207], v[116:119], a[28:31]
s_and_b32 s70, s70, 16383
v_mfma_f32_16x16x32_bf16 a[32:35], a[204:207], v[120:123], a[32:35]
s_lshl_b32 s97, s70, 5
v_mfma_f32_16x16x32_bf16 a[36:39], a[204:207], v[124:127], a[36:39]
s_add_u32 s97, s97, s96
v_mfma_f32_16x16x32_bf16 a[40:43], a[204:207], v[128:131], a[40:43]
s_add_u32 m0, s78, 8448
v_mfma_f32_16x16x32_bf16 a[44:47], a[204:207], v[132:135], a[44:47]
buffer_load_dwordx4 v2, s[84:87], s97 offen lds
ds_read_b64_tr_b16 a[204:205], v18 offset:25376
v_mfma_f32_16x16x32_bf16 a[48:51], a[208:211], v[112:115], a[48:51]
ds_read_b64_tr_b16 a[206:207], v18 offset:29600
v_mfma_f32_16x16x32_bf16 a[52:55], a[208:211], v[116:119], a[52:55]
v_mfma_f32_16x16x32_bf16 a[56:59], a[208:211], v[120:123], a[56:59]
buffer_load_dwordx4 v3, s[84:87], s97 offen offset:1056 lds
v_mfma_f32_16x16x32_bf16 a[60:63], a[208:211], v[124:127], a[60:63]
v_mfma_f32_16x16x32_bf16 a[64:67], a[208:211], v[128:131], a[64:67]
v_mfma_f32_16x16x32_bf16 a[68:71], a[208:211], v[132:135], a[68:71]
buffer_load_dwordx4 v4, s[84:87], s97 offen offset:2112 lds
ds_read_b64_tr_b16 a[208:209], v39 offset:25344
v_mfma_f32_16x16x32_bf16 a[72:75], a[212:215], v[112:115], a[72:75]
ds_read_b64_tr_b16 a[210:211], v39 offset:29568
v_mfma_f32_16x16x32_bf16 a[76:79], a[212:215], v[116:119], a[76:79]
v_mfma_f32_16x16x32_bf16 a[80:83], a[212:215], v[120:123], a[80:83]
buffer_load_dwordx4 v5, s[84:87], s97 offen offset:3168 lds
v_mfma_f32_16x16x32_bf16 a[84:87], a[212:215], v[124:127], a[84:87]
s_add_u32 s98, s97, 16384
v_mfma_f32_16x16x32_bf16 a[88:91], a[212:215], v[128:131], a[88:91]
s_add_u32 m0, s78, 12672
v_mfma_f32_16x16x32_bf16 a[92:95], a[212:215], v[132:135], a[92:95]
buffer_load_dwordx4 v2, s[84:87], s98 offen lds
ds_read_b64_tr_b16 a[212:213], v39 offset:25376
v_mfma_f32_16x16x32_bf16 a[96:99], a[216:219], v[112:115], a[96:99]
ds_read_b64_tr_b16 a[214:215], v39 offset:29600
v_mfma_f32_16x16x32_bf16 a[100:103], a[216:219], v[116:119], a[100:103]
v_mfma_f32_16x16x32_bf16 a[104:107], a[216:219], v[120:123], a[104:107]
buffer_load_dwordx4 v3, s[84:87], s98 offen offset:1056 lds
v_mfma_f32_16x16x32_bf16 a[108:111], a[216:219], v[124:127], a[108:111]
v_mfma_f32_16x16x32_bf16 a[112:115], a[216:219], v[128:131], a[112:115]
v_mfma_f32_16x16x32_bf16 a[116:119], a[216:219], v[132:135], a[116:119]
buffer_load_dwordx4 v4, s[84:87], s98 offen offset:2112 lds
ds_read_b64_tr_b16 a[216:217], v40 offset:25344
v_mfma_f32_16x16x32_bf16 a[120:123], a[220:223], v[112:115], a[120:123]
ds_read_b64_tr_b16 a[218:219], v40 offset:29568
v_mfma_f32_16x16x32_bf16 a[124:127], a[220:223], v[116:119], a[124:127]
v_mfma_f32_16x16x32_bf16 a[128:131], a[220:223], v[120:123], a[128:131]
buffer_load_dwordx4 v5, s[84:87], s98 offen offset:3168 lds
v_mfma_f32_16x16x32_bf16 a[132:135], a[220:223], v[124:127], a[132:135]
v_mfma_f32_16x16x32_bf16 a[136:139], a[220:223], v[128:131], a[136:139]
v_mfma_f32_16x16x32_bf16 a[140:143], a[220:223], v[132:135], a[140:143]
ds_read_b64_tr_b16 a[220:221], v40 offset:25376
s_waitcnt vmcnt(28) lgkmcnt(3)
v_mfma_f32_16x16x32_bf16 v[64:67], a[192:195], v[136:139], v[64:67]
ds_read_b64_tr_b16 a[222:223], v40 offset:29600
s_waitcnt vmcnt(27)
v_mfma_f32_16x16x32_bf16 v[68:71], a[192:195], v[140:143], v[68:71]
s_add_u32 s99, s70, s79
s_waitcnt vmcnt(26)
v_mfma_f32_16x16x32_bf16 v[72:75], a[192:195], v[144:147], v[72:75]
buffer_load_dwordx4 v[112:115], v11, s[80:83], s99 offen sc1
s_waitcnt vmcnt(26)
v_mfma_f32_16x16x32_bf16 v[76:79], a[192:195], v[148:151], v[76:79]
s_waitcnt vmcnt(25)
v_mfma_f32_16x16x32_bf16 v[80:83], a[192:195], v[152:155], v[80:83]
s_waitcnt vmcnt(24)
v_mfma_f32_16x16x32_bf16 v[84:87], a[192:195], v[156:159], v[84:87]
buffer_load_dwordx4 v[116:119], v12, s[80:83], s99 offen sc1
s_waitcnt vmcnt(17)
ds_read_b64_tr_b16 a[192:193], v17
v_mfma_f32_16x16x32_bf16 v[88:91], a[196:199], v[136:139], v[88:91]
ds_read_b64_tr_b16 a[194:195], v17 offset:4224
v_mfma_f32_16x16x32_bf16 v[92:95], a[196:199], v[140:143], v[92:95]
v_mfma_f32_16x16x32_bf16 v[96:99], a[196:199], v[144:147], v[96:99]
buffer_load_dwordx4 v[120:123], v13, s[80:83], s99 offen sc1
v_mfma_f32_16x16x32_bf16 v[100:103], a[196:199], v[148:151], v[100:103]
v_mfma_f32_16x16x32_bf16 v[104:107], a[196:199], v[152:155], v[104:107]
v_mfma_f32_16x16x32_bf16 v[108:111], a[196:199], v[156:159], v[108:111]
buffer_load_dwordx4 v[124:127], v14, s[80:83], s99 offen sc1
ds_read_b64_tr_b16 a[196:197], v17 offset:32
v_mfma_f32_16x16x32_bf16 a[0:3], a[200:203], v[136:139], a[0:3]
ds_read_b64_tr_b16 a[198:199], v17 offset:4256
v_mfma_f32_16x16x32_bf16 a[4:7], a[200:203], v[140:143], a[4:7]
v_mfma_f32_16x16x32_bf16 a[8:11], a[200:203], v[144:147], a[8:11]
buffer_load_dwordx4 v[128:131], v15, s[80:83], s99 offen sc1
v_mfma_f32_16x16x32_bf16 a[12:15], a[200:203], v[148:151], a[12:15]
v_mfma_f32_16x16x32_bf16 a[16:19], a[200:203], v[152:155], a[16:19]
v_mfma_f32_16x16x32_bf16 a[20:23], a[200:203], v[156:159], a[20:23]
buffer_load_dwordx4 v[132:135], v16, s[80:83], s99 offen sc1
ds_read_b64_tr_b16 a[200:201], v18
v_mfma_f32_16x16x32_bf16 a[24:27], a[204:207], v[136:139], a[24:27]
s_add_u32 s70, s70, 1024
ds_read_b64_tr_b16 a[202:203], v18 offset:4224
v_mfma_f32_16x16x32_bf16 a[28:31], a[204:207], v[140:143], a[28:31]
s_and_b32 s70, s70, 16383
v_mfma_f32_16x16x32_bf16 a[32:35], a[204:207], v[144:147], a[32:35]
s_lshl_b32 s97, s70, 5
v_mfma_f32_16x16x32_bf16 a[36:39], a[204:207], v[148:151], a[36:39]
s_add_u32 s97, s97, s96
v_mfma_f32_16x16x32_bf16 a[40:43], a[204:207], v[152:155], a[40:43]
s_add_u32 m0, s78, 16896
v_mfma_f32_16x16x32_bf16 a[44:47], a[204:207], v[156:159], a[44:47]
buffer_load_dwordx4 v2, s[84:87], s97 offen lds
ds_read_b64_tr_b16 a[204:205], v18 offset:32
v_mfma_f32_16x16x32_bf16 a[48:51], a[208:211], v[136:139], a[48:51]
ds_read_b64_tr_b16 a[206:207], v18 offset:4256
v_mfma_f32_16x16x32_bf16 a[52:55], a[208:211], v[140:143], a[52:55]
v_mfma_f32_16x16x32_bf16 a[56:59], a[208:211], v[144:147], a[56:59]
buffer_load_dwordx4 v3, s[84:87], s97 offen offset:1056 lds
v_mfma_f32_16x16x32_bf16 a[60:63], a[208:211], v[148:151], a[60:63]
v_mfma_f32_16x16x32_bf16 a[64:67], a[208:211], v[152:155], a[64:67]
v_mfma_f32_16x16x32_bf16 a[68:71], a[208:211], v[156:159], a[68:71]
buffer_load_dwordx4 v4, s[84:87], s97 offen offset:2112 lds
ds_read_b64_tr_b16 a[208:209], v39
v_mfma_f32_16x16x32_bf16 a[72:75], a[212:215], v[136:139], a[72:75]
ds_read_b64_tr_b16 a[210:211], v39 offset:4224
v_mfma_f32_16x16x32_bf16 a[76:79], a[212:215], v[140:143], a[76:79]
v_mfma_f32_16x16x32_bf16 a[80:83], a[212:215], v[144:147], a[80:83]
buffer_load_dwordx4 v5, s[84:87], s97 offen offset:3168 lds
v_mfma_f32_16x16x32_bf16 a[84:87], a[212:215], v[148:151], a[84:87]
s_add_u32 s98, s97, 16384
v_mfma_f32_16x16x32_bf16 a[88:91], a[212:215], v[152:155], a[88:91]
s_add_u32 m0, s78, 21120
v_mfma_f32_16x16x32_bf16 a[92:95], a[212:215], v[156:159], a[92:95]
buffer_load_dwordx4 v2, s[84:87], s98 offen lds
ds_read_b64_tr_b16 a[212:213], v39 offset:32
s_waitcnt lgkmcnt(3)
v_mfma_f32_16x16x32_bf16 a[96:99], a[216:219], v[136:139], a[96:99]
ds_read_b64_tr_b16 a[214:215], v39 offset:4256
v_mfma_f32_16x16x32_bf16 a[100:103], a[216:219], v[140:143], a[100:103]
v_mfma_f32_16x16x32_bf16 a[104:107], a[216:219], v[144:147], a[104:107]
buffer_load_dwordx4 v3, s[84:87], s98 offen offset:1056 lds
v_mfma_f32_16x16x32_bf16 a[108:111], a[216:219], v[148:151], a[108:111]
v_mfma_f32_16x16x32_bf16 a[112:115], a[216:219], v[152:155], a[112:115]
v_mfma_f32_16x16x32_bf16 a[116:119], a[216:219], v[156:159], a[116:119]
buffer_load_dwordx4 v4, s[84:87], s98 offen offset:2112 lds
ds_read_b64_tr_b16 a[216:217], v40
v_mfma_f32_16x16x32_bf16 a[120:123], a[220:223], v[136:139], a[120:123]
ds_read_b64_tr_b16 a[218:219], v40 offset:4224
v_mfma_f32_16x16x32_bf16 a[124:127], a[220:223], v[140:143], a[124:127]
v_mfma_f32_16x16x32_bf16 a[128:131], a[220:223], v[144:147], a[128:131]
buffer_load_dwordx4 v5, s[84:87], s98 offen offset:3168 lds
v_mfma_f32_16x16x32_bf16 a[132:135], a[220:223], v[148:151], a[132:135]
v_mfma_f32_16x16x32_bf16 a[136:139], a[220:223], v[152:155], a[136:139]
v_mfma_f32_16x16x32_bf16 a[140:143], a[220:223], v[156:159], a[140:143]
ds_read_b64_tr_b16 a[220:221], v40 offset:32
s_waitcnt vmcnt(27)
v_mfma_f32_16x16x32_bf16 v[64:67], a[192:195], v[160:163], v[64:67]
ds_read_b64_tr_b16 a[222:223], v40 offset:4256
s_waitcnt vmcnt(26)
v_mfma_f32_16x16x32_bf16 v[68:71], a[192:195], v[164:167], v[68:71]
s_add_u32 s99, s70, s79
s_waitcnt vmcnt(25)
v_mfma_f32_16x16x32_bf16 v[72:75], a[192:195], v[168:171], v[72:75]
buffer_load_dwordx4 v[136:139], v11, s[80:83], s99 offen sc1
s_waitcnt vmcnt(25)
v_mfma_f32_16x16x32_bf16 v[76:79], a[192:195], v[172:175], v[76:79]
s_waitcnt vmcnt(24)
v_mfma_f32_16x16x32_bf16 v[80:83], a[192:195], v[176:179], v[80:83]
s_waitcnt vmcnt(23)
v_mfma_f32_16x16x32_bf16 v[84:87], a[192:195], v[180:183], v[84:87]
buffer_load_dwordx4 v[140:143], v12, s[80:83], s99 offen sc1
s_waitcnt vmcnt(16)
ds_read_b64_tr_b16 a[192:193], v17 offset:8448
v_mfma_f32_16x16x32_bf16 v[88:91], a[196:199], v[160:163], v[88:91]
ds_read_b64_tr_b16 a[194:195], v17 offset:12672
v_mfma_f32_16x16x32_bf16 v[92:95], a[196:199], v[164:167], v[92:95]
v_mfma_f32_16x16x32_bf16 v[96:99], a[196:199], v[168:171], v[96:99]
buffer_load_dwordx4 v[144:147], v13, s[80:83], s99 offen sc1
v_mfma_f32_16x16x32_bf16 v[100:103], a[196:199], v[172:175], v[100:103]
v_mfma_f32_16x16x32_bf16 v[104:107], a[196:199], v[176:179], v[104:107]
v_mfma_f32_16x16x32_bf16 v[108:111], a[196:199], v[180:183], v[108:111]
buffer_load_dwordx4 v[148:151], v14, s[80:83], s99 offen sc1
ds_read_b64_tr_b16 a[196:197], v17 offset:8480
v_mfma_f32_16x16x32_bf16 a[0:3], a[200:203], v[160:163], a[0:3]
ds_read_b64_tr_b16 a[198:199], v17 offset:12704
v_mfma_f32_16x16x32_bf16 a[4:7], a[200:203], v[164:167], a[4:7]
v_mfma_f32_16x16x32_bf16 a[8:11], a[200:203], v[168:171], a[8:11]
buffer_load_dwordx4 v[152:155], v15, s[80:83], s99 offen sc1
v_mfma_f32_16x16x32_bf16 a[12:15], a[200:203], v[172:175], a[12:15]
v_mfma_f32_16x16x32_bf16 a[16:19], a[200:203], v[176:179], a[16:19]
v_mfma_f32_16x16x32_bf16 a[20:23], a[200:203], v[180:183], a[20:23]
buffer_load_dwordx4 v[156:159], v16, s[80:83], s99 offen sc1
ds_read_b64_tr_b16 a[200:201], v18 offset:8448
v_mfma_f32_16x16x32_bf16 a[24:27], a[204:207], v[160:163], a[24:27]
s_add_u32 s70, s70, 1024
ds_read_b64_tr_b16 a[202:203], v18 offset:12672
v_mfma_f32_16x16x32_bf16 a[28:31], a[204:207], v[164:167], a[28:31]
s_and_b32 s70, s70, 16383
v_mfma_f32_16x16x32_bf16 a[32:35], a[204:207], v[168:171], a[32:35]
s_lshl_b32 s97, s70, 5
v_mfma_f32_16x16x32_bf16 a[36:39], a[204:207], v[172:175], a[36:39]
s_add_u32 s97, s97, s96
v_mfma_f32_16x16x32_bf16 a[40:43], a[204:207], v[176:179], a[40:43]
s_add_u32 m0, s78, 25344
v_mfma_f32_16x16x32_bf16 a[44:47], a[204:207], v[180:183], a[44:47]
buffer_load_dwordx4 v2, s[84:87], s97 offen lds
ds_read_b64_tr_b16 a[204:205], v18 offset:8480
s_waitcnt lgkmcnt(2)
v_mfma_f32_16x16x32_bf16 a[48:51], a[208:211], v[160:163], a[48:51]
ds_read_b64_tr_b16 a[206:207], v18 offset:12704
v_mfma_f32_16x16x32_bf16 a[52:55], a[208:211], v[164:167], a[52:55]
v_mfma_f32_16x16x32_bf16 a[56:59], a[208:211], v[168:171], a[56:59]
buffer_load_dwordx4 v3, s[84:87], s97 offen offset:1056 lds
v_mfma_f32_16x16x32_bf16 a[60:63], a[208:211], v[172:175], a[60:63]
v_mfma_f32_16x16x32_bf16 a[64:67], a[208:211], v[176:179], a[64:67]
v_mfma_f32_16x16x32_bf16 a[68:71], a[208:211], v[180:183], a[68:71]
buffer_load_dwordx4 v4, s[84:87], s97 offen offset:2112 lds
ds_read_b64_tr_b16 a[208:209], v39 offset:8448
v_mfma_f32_16x16x32_bf16 a[72:75], a[212:215], v[160:163], a[72:75]
ds_read_b64_tr_b16 a[210:211], v39 offset:12672
v_mfma_f32_16x16x32_bf16 a[76:79], a[212:215], v[164:167], a[76:79]
v_mfma_f32_16x16x32_bf16 a[80:83], a[212:215], v[168:171], a[80:83]
buffer_load_dwordx4 v5, s[84:87], s97 offen offset:3168 lds
v_mfma_f32_16x16x32_bf16 a[84:87], a[212:215], v[172:175], a[84:87]
s_add_u32 s98, s97, 16384
v_mfma_f32_16x16x32_bf16 a[88:91], a[212:215], v[176:179], a[88:91]
s_add_u32 m0, s78, 29568
v_mfma_f32_16x16x32_bf16 a[92:95], a[212:215], v[180:183], a[92:95]
buffer_load_dwordx4 v2, s[84:87], s98 offen lds
ds_read_b64_tr_b16 a[212:213], v39 offset:8480
v_mfma_f32_16x16x32_bf16 a[96:99], a[216:219], v[160:163], a[96:99]
ds_read_b64_tr_b16 a[214:215], v39 offset:12704
v_mfma_f32_16x16x32_bf16 a[100:103], a[216:219], v[164:167], a[100:103]
v_mfma_f32_16x16x32_bf16 a[104:107], a[216:219], v[168:171], a[104:107]
buffer_load_dwordx4 v3, s[84:87], s98 offen offset:1056 lds
v_mfma_f32_16x16x32_bf16 a[108:111], a[216:219], v[172:175], a[108:111]
v_mfma_f32_16x16x32_bf16 a[112:115], a[216:219], v[176:179], a[112:115]
v_mfma_f32_16x16x32_bf16 a[116:119], a[216:219], v[180:183], a[116:119]
buffer_load_dwordx4 v4, s[84:87], s98 offen offset:2112 lds
ds_read_b64_tr_b16 a[216:217], v40 offset:8448
v_mfma_f32_16x16x32_bf16 a[120:123], a[220:223], v[160:163], a[120:123]
ds_read_b64_tr_b16 a[218:219], v40 offset:12672
v_mfma_f32_16x16x32_bf16 a[124:127], a[220:223], v[164:167], a[124:127]
v_mfma_f32_16x16x32_bf16 a[128:131], a[220:223], v[168:171], a[128:131]
buffer_load_dwordx4 v5, s[84:87], s98 offen offset:3168 lds
v_mfma_f32_16x16x32_bf16 a[132:135], a[220:223], v[172:175], a[132:135]
v_mfma_f32_16x16x32_bf16 a[136:139], a[220:223], v[176:179], a[136:139]
v_mfma_f32_16x16x32_bf16 a[140:143], a[220:223], v[180:183], a[140:143]
ds_read_b64_tr_b16 a[220:221], v40 offset:8480
s_waitcnt vmcnt(27)
v_mfma_f32_16x16x32_bf16 v[64:67], a[192:195], v[112:115], v[64:67]
ds_read_b64_tr_b16 a[222:223], v40 offset:12704
s_waitcnt vmcnt(26)
v_mfma_f32_16x16x32_bf16 v[68:71], a[192:195], v[116:119], v[68:71]
s_add_u32 s99, s70, s79
s_waitcnt vmcnt(25)
v_mfma_f32_16x16x32_bf16 v[72:75], a[192:195], v[120:123], v[72:75]
buffer_load_dwordx4 v[160:163], v11, s[80:83], s99 offen sc1
s_waitcnt vmcnt(25)
v_mfma_f32_16x16x32_bf16 v[76:79], a[192:195], v[124:127], v[76:79]
s_waitcnt vmcnt(24)
v_mfma_f32_16x16x32_bf16 v[80:83], a[192:195], v[128:131], v[80:83]
s_waitcnt vmcnt(23)
v_mfma_f32_16x16x32_bf16 v[84:87], a[192:195], v[132:135], v[84:87]
buffer_load_dwordx4 v[164:167], v12, s[80:83], s99 offen sc1
s_waitcnt vmcnt(16)
ds_read_b64_tr_b16 a[192:193], v17 offset:16896
v_mfma_f32_16x16x32_bf16 v[88:91], a[196:199], v[112:115], v[88:91]
ds_read_b64_tr_b16 a[194:195], v17 offset:21120
v_mfma_f32_16x16x32_bf16 v[92:95], a[196:199], v[116:119], v[92:95]
v_mfma_f32_16x16x32_bf16 v[96:99], a[196:199], v[120:123], v[96:99]
buffer_load_dwordx4 v[168:171], v13, s[80:83], s99 offen sc1
v_mfma_f32_16x16x32_bf16 v[100:103], a[196:199], v[124:127], v[100:103]
v_mfma_f32_16x16x32_bf16 v[104:107], a[196:199], v[128:131], v[104:107]
v_mfma_f32_16x16x32_bf16 v[108:111], a[196:199], v[132:135], v[108:111]
buffer_load_dwordx4 v[172:175], v14, s[80:83], s99 offen sc1
ds_read_b64_tr_b16 a[196:197], v17 offset:16928
s_waitcnt lgkmcnt(3)
v_mfma_f32_16x16x32_bf16 a[0:3], a[200:203], v[112:115], a[0:3]
ds_read_b64_tr_b16 a[198:199], v17 offset:21152
v_mfma_f32_16x16x32_bf16 a[4:7], a[200:203], v[116:119], a[4:7]
v_mfma_f32_16x16x32_bf16 a[8:11], a[200:203], v[120:123], a[8:11]
buffer_load_dwordx4 v[176:179], v15, s[80:83], s99 offen sc1
v_mfma_f32_16x16x32_bf16 a[12:15], a[200:203], v[124:127], a[12:15]
v_mfma_f32_16x16x32_bf16 a[16:19], a[200:203], v[128:131], a[16:19]
v_mfma_f32_16x16x32_bf16 a[20:23], a[200:203], v[132:135], a[20:23]
buffer_load_dwordx4 v[180:183], v16, s[80:83], s99 offen sc1
ds_read_b64_tr_b16 a[200:201], v18 offset:16896
v_mfma_f32_16x16x32_bf16 a[24:27], a[204:207], v[112:115], a[24:27]
s_add_u32 s70, s70, 1024
ds_read_b64_tr_b16 a[202:203], v18 offset:21120
v_mfma_f32_16x16x32_bf16 a[28:31], a[204:207], v[116:119], a[28:31]
s_and_b32 s70, s70, 16383
v_mfma_f32_16x16x32_bf16 a[32:35], a[204:207], v[120:123], a[32:35]
s_lshl_b32 s97, s70, 5
v_mfma_f32_16x16x32_bf16 a[36:39], a[204:207], v[124:127], a[36:39]
s_add_u32 s97, s97, s96
v_mfma_f32_16x16x32_bf16 a[40:43], a[204:207], v[128:131], a[40:43]
s_add_u32 m0, s78, 0
v_mfma_f32_16x16x32_bf16 a[44:47], a[204:207], v[132:135], a[44:47]
buffer_load_dwordx4 v2, s[84:87], s97 offen lds
ds_read_b64_tr_b16 a[204:205], v18 offset:16928
v_mfma_f32_16x16x32_bf16 a[48:51], a[208:211], v[112:115], a[48:51]
ds_read_b64_tr_b16 a[206:207], v18 offset:21152
v_mfma_f32_16x16x32_bf16 a[52:55], a[208:211], v[116:119], a[52:55]
v_mfma_f32_16x16x32_bf16 a[56:59], a[208:211], v[120:123], a[56:59]
buffer_load_dwordx4 v3, s[84:87], s97 offen offset:1056 lds
v_mfma_f32_16x16x32_bf16 a[60:63], a[208:211], v[124:127], a[60:63]
v_mfma_f32_16x16x32_bf16 a[64:67], a[208:211], v[128:131], a[64:67]
v_mfma_f32_16x16x32_bf16 a[68:71], a[208:211], v[132:135], a[68:71]
buffer_load_dwordx4 v4, s[84:87], s97 offen offset:2112 lds
ds_read_b64_tr_b16 a[208:209], v39 offset:16896
v_mfma_f32_16x16x32_bf16 a[72:75], a[212:215], v[112:115], a[72:75]
ds_read_b64_tr_b16 a[210:211], v39 offset:21120
v_mfma_f32_16x16x32_bf16 a[76:79], a[212:215], v[116:119], a[76:79]
v_mfma_f32_16x16x32_bf16 a[80:83], a[212:215], v[120:123], a[80:83]
buffer_load_dwordx4 v5, s[84:87], s97 offen offset:3168 lds
v_mfma_f32_16x16x32_bf16 a[84:87], a[212:215], v[124:127], a[84:87]
s_add_u32 s98, s97, 16384
v_mfma_f32_16x16x32_bf16 a[88:91], a[212:215], v[128:131], a[88:91]
s_add_u32 m0, s78, 4224
v_mfma_f32_16x16x32_bf16 a[92:95], a[212:215], v[132:135], a[92:95]
buffer_load_dwordx4 v2, s[84:87], s98 offen lds
ds_read_b64_tr_b16 a[212:213], v39 offset:16928
v_mfma_f32_16x16x32_bf16 a[96:99], a[216:219], v[112:115], a[96:99]
ds_read_b64_tr_b16 a[214:215], v39 offset:21152
v_mfma_f32_16x16x32_bf16 a[100:103], a[216:219], v[116:119], a[100:103]
v_mfma_f32_16x16x32_bf16 a[104:107], a[216:219], v[120:123], a[104:107]
buffer_load_dwordx4 v3, s[84:87], s98 offen offset:1056 lds
v_mfma_f32_16x16x32_bf16 a[108:111], a[216:219], v[124:127], a[108:111]
v_mfma_f32_16x16x32_bf16 a[112:115], a[216:219], v[128:131], a[112:115]
v_mfma_f32_16x16x32_bf16 a[116:119], a[216:219], v[132:135], a[116:119]
buffer_load_dwordx4 v4, s[84:87], s98 offen offset:2112 lds
ds_read_b64_tr_b16 a[216:217], v40 offset:16896
v_mfma_f32_16x16x32_bf16 a[120:123], a[220:223], v[112:115], a[120:123]
ds_read_b64_tr_b16 a[218:219], v40 offset:21120
v_mfma_f32_16x16x32_bf16 a[124:127], a[220:223], v[116:119], a[124:127]
v_mfma_f32_16x16x32_bf16 a[128:131], a[220:223], v[120:123], a[128:131]
buffer_load_dwordx4 v5, s[84:87], s98 offen offset:3168 lds
v_mfma_f32_16x16x32_bf16 a[132:135], a[220:223], v[124:127], a[132:135]
v_mfma_f32_16x16x32_bf16 a[136:139], a[220:223], v[128:131], a[136:139]
v_mfma_f32_16x16x32_bf16 a[140:143], a[220:223], v[132:135], a[140:143]
ds_read_b64_tr_b16 a[220:221], v40 offset:16928
s_waitcnt vmcnt(27) lgkmcnt(3)
v_mfma_f32_16x16x32_bf16 v[64:67], a[192:195], v[136:139], v[64:67]
ds_read_b64_tr_b16 a[222:223], v40 offset:21152
s_waitcnt vmcnt(26)
v_mfma_f32_16x16x32_bf16 v[68:71], a[192:195], v[140:143], v[68:71]
s_add_u32 s99, s70, s79
s_waitcnt vmcnt(25)
v_mfma_f32_16x16x32_bf16 v[72:75], a[192:195], v[144:147], v[72:75]
buffer_load_dwordx4 v[112:115], v11, s[80:83], s99 offen sc1
s_waitcnt vmcnt(25)
v_mfma_f32_16x16x32_bf16 v[76:79], a[192:195], v[148:151], v[76:79]
s_waitcnt vmcnt(24)
v_mfma_f32_16x16x32_bf16 v[80:83], a[192:195], v[152:155], v[80:83]
s_waitcnt vmcnt(23)
v_mfma_f32_16x16x32_bf16 v[84:87], a[192:195], v[156:159], v[84:87]
buffer_load_dwordx4 v[116:119], v12, s[80:83], s99 offen sc1
s_waitcnt vmcnt(16)
ds_read_b64_tr_b16 a[192:193], v17 offset:25344
v_mfma_f32_16x16x32_bf16 v[88:91], a[196:199], v[136:139], v[88:91]
ds_read_b64_tr_b16 a[194:195], v17 offset:29568
v_mfma_f32_16x16x32_bf16 v[92:95], a[196:199], v[140:143], v[92:95]
v_mfma_f32_16x16x32_bf16 v[96:99], a[196:199], v[144:147], v[96:99]
buffer_load_dwordx4 v[120:123], v13, s[80:83], s99 offen sc1
v_mfma_f32_16x16x32_bf16 v[100:103], a[196:199], v[148:151], v[100:103]
v_mfma_f32_16x16x32_bf16 v[104:107], a[196:199], v[152:155], v[104:107]
v_mfma_f32_16x16x32_bf16 v[108:111], a[196:199], v[156:159], v[108:111]
buffer_load_dwordx4 v[124:127], v14, s[80:83], s99 offen sc1
ds_read_b64_tr_b16 a[196:197], v17 offset:25376
v_mfma_f32_16x16x32_bf16 a[0:3], a[200:203], v[136:139], a[0:3]
ds_read_b64_tr_b16 a[198:199], v17 offset:29600
v_mfma_f32_16x16x32_bf16 a[4:7], a[200:203], v[140:143], a[4:7]
v_mfma_f32_16x16x32_bf16 a[8:11], a[200:203], v[144:147], a[8:11]
buffer_load_dwordx4 v[128:131], v15, s[80:83], s99 offen sc1
v_mfma_f32_16x16x32_bf16 a[12:15], a[200:203], v[148:151], a[12:15]
v_mfma_f32_16x16x32_bf16 a[16:19], a[200:203], v[152:155], a[16:19]
v_mfma_f32_16x16x32_bf16 a[20:23], a[200:203], v[156:159], a[20:23]
buffer_load_dwordx4 v[132:135], v16, s[80:83], s99 offen sc1
ds_read_b64_tr_b16 a[200:201], v18 offset:25344
v_mfma_f32_16x16x32_bf16 a[24:27], a[204:207], v[136:139], a[24:27]
s_add_u32 s70, s70, 1024
ds_read_b64_tr_b16 a[202:203], v18 offset:29568
v_mfma_f32_16x16x32_bf16 a[28:31], a[204:207], v[140:143], a[28:31]
s_and_b32 s70, s70, 16383
v_mfma_f32_16x16x32_bf16 a[32:35], a[204:207], v[144:147], a[32:35]
s_lshl_b32 s97, s70, 5
v_mfma_f32_16x16x32_bf16 a[36:39], a[204:207], v[148:151], a[36:39]
s_add_u32 s97, s97, s96
v_mfma_f32_16x16x32_bf16 a[40:43], a[204:207], v[152:155], a[40:43]
s_add_u32 m0, s78, 8448
v_mfma_f32_16x16x32_bf16 a[44:47], a[204:207], v[156:159], a[44:47]
buffer_load_dwordx4 v2, s[84:87], s97 offen lds
ds_read_b64_tr_b16 a[204:205], v18 offset:25376
v_mfma_f32_16x16x32_bf16 a[48:51], a[208:211], v[136:139], a[48:51]
ds_read_b64_tr_b16 a[206:207], v18 offset:29600
v_mfma_f32_16x16x32_bf16 a[52:55], a[208:211], v[140:143], a[52:55]
v_mfma_f32_16x16x32_bf16 a[56:59], a[208:211], v[144:147], a[56:59]
buffer_load_dwordx4 v3, s[84:87], s97 offen offset:1056 lds
v_mfma_f32_16x16x32_bf16 a[60:63], a[208:211], v[148:151], a[60:63]
v_mfma_f32_16x16x32_bf16 a[64:67], a[208:211], v[152:155], a[64:67]
v_mfma_f32_16x16x32_bf16 a[68:71], a[208:211], v[156:159], a[68:71]
buffer_load_dwordx4 v4, s[84:87], s97 offen offset:2112 lds
ds_read_b64_tr_b16 a[208:209], v39 offset:25344
v_mfma_f32_16x16x32_bf16 a[72:75], a[212:215], v[136:139], a[72:75]
ds_read_b64_tr_b16 a[210:211], v39 offset:29568
v_mfma_f32_16x16x32_bf16 a[76:79], a[212:215], v[140:143], a[76:79]
v_mfma_f32_16x16x32_bf16 a[80:83], a[212:215], v[144:147], a[80:83]
buffer_load_dwordx4 v5, s[84:87], s97 offen offset:3168 lds
v_mfma_f32_16x16x32_bf16 a[84:87], a[212:215], v[148:151], a[84:87]
s_add_u32 s98, s97, 16384
v_mfma_f32_16x16x32_bf16 a[88:91], a[212:215], v[152:155], a[88:91]
s_add_u32 m0, s78, 12672
v_mfma_f32_16x16x32_bf16 a[92:95], a[212:215], v[156:159], a[92:95]
buffer_load_dwordx4 v2, s[84:87], s98 offen lds
ds_read_b64_tr_b16 a[212:213], v39 offset:25376
s_waitcnt lgkmcnt(3)
v_mfma_f32_16x16x32_bf16 a[96:99], a[216:219], v[136:139], a[96:99]
ds_read_b64_tr_b16 a[214:215], v39 offset:29600
v_mfma_f32_16x16x32_bf16 a[100:103], a[216:219], v[140:143], a[100:103]
v_mfma_f32_16x16x32_bf16 a[104:107], a[216:219], v[144:147], a[104:107]
buffer_load_dwordx4 v3, s[84:87], s98 offen offset:1056 lds
v_mfma_f32_16x16x32_bf16 a[108:111], a[216:219], v[148:151], a[108:111]
v_mfma_f32_16x16x32_bf16 a[112:115], a[216:219], v[152:155], a[112:115]
v_mfma_f32_16x16x32_bf16 a[116:119], a[216:219], v[156:159], a[116:119]
buffer_load_dwordx4 v4, s[84:87], s98 offen offset:2112 lds
ds_read_b64_tr_b16 a[216:217], v40 offset:25344
v_mfma_f32_16x16x32_bf16 a[120:123], a[220:223], v[136:139], a[120:123]
ds_read_b64_tr_b16 a[218:219], v40 offset:29568
v_mfma_f32_16x16x32_bf16 a[124:127], a[220:223], v[140:143], a[124:127]
v_mfma_f32_16x16x32_bf16 a[128:131], a[220:223], v[144:147], a[128:131]
buffer_load_dwordx4 v5, s[84:87], s98 offen offset:3168 lds
v_mfma_f32_16x16x32_bf16 a[132:135], a[220:223], v[148:151], a[132:135]
v_mfma_f32_16x16x32_bf16 a[136:139], a[220:223], v[152:155], a[136:139]
v_mfma_f32_16x16x32_bf16 a[140:143], a[220:223], v[156:159], a[140:143]
ds_read_b64_tr_b16 a[220:221], v40 offset:25376
s_waitcnt vmcnt(27)
v_mfma_f32_16x16x32_bf16 v[64:67], a[192:195], v[160:163], v[64:67]
ds_read_b64_tr_b16 a[222:223], v40 offset:29600
s_waitcnt vmcnt(26)
v_mfma_f32_16x16x32_bf16 v[68:71], a[192:195], v[164:167], v[68:71]
s_add_u32 s99, s70, s79
s_waitcnt vmcnt(25)
v_mfma_f32_16x16x32_bf16 v[72:75], a[192:195], v[168:171], v[72:75]
buffer_load_dwordx4 v[136:139], v11, s[80:83], s99 offen sc1
s_waitcnt vmcnt(25)
v_mfma_f32_16x16x32_bf16 v[76:79], a[192:195], v[172:175], v[76:79]
s_waitcnt vmcnt(24)
v_mfma_f32_16x16x32_bf16 v[80:83], a[192:195], v[176:179], v[80:83]
s_waitcnt vmcnt(23)
v_mfma_f32_16x16x32_bf16 v[84:87], a[192:195], v[180:183], v[84:87]
buffer_load_dwordx4 v[140:143], v12, s[80:83], s99 offen sc1
s_waitcnt vmcnt(16)
ds_read_b64_tr_b16 a[192:193], v17
v_mfma_f32_16x16x32_bf16 v[88:91], a[196:199], v[160:163], v[88:91]
ds_read_b64_tr_b16 a[194:195], v17 offset:4224
v_mfma_f32_16x16x32_bf16 v[92:95], a[196:199], v[164:167], v[92:95]
v_mfma_f32_16x16x32_bf16 v[96:99], a[196:199], v[168:171], v[96:99]
buffer_load_dwordx4 v[144:147], v13, s[80:83], s99 offen sc1
v_mfma_f32_16x16x32_bf16 v[100:103], a[196:199], v[172:175], v[100:103]
v_mfma_f32_16x16x32_bf16 v[104:107], a[196:199], v[176:179], v[104:107]
v_mfma_f32_16x16x32_bf16 v[108:111], a[196:199], v[180:183], v[108:111]
buffer_load_dwordx4 v[148:151], v14, s[80:83], s99 offen sc1
ds_read_b64_tr_b16 a[196:197], v17 offset:32
v_mfma_f32_16x16x32_bf16 a[0:3], a[200:203], v[160:163], a[0:3]
ds_read_b64_tr_b16 a[198:199], v17 offset:4256
v_mfma_f32_16x16x32_bf16 a[4:7], a[200:203], v[164:167], a[4:7]
v_mfma_f32_16x16x32_bf16 a[8:11], a[200:203], v[168:171], a[8:11]
buffer_load_dwordx4 v[152:155], v15, s[80:83], s99 offen sc1
v_mfma_f32_16x16x32_bf16 a[12:15], a[200:203], v[172:175], a[12:15]
v_mfma_f32_16x16x32_bf16 a[16:19], a[200:203], v[176:179], a[16:19]
v_mfma_f32_16x16x32_bf16 a[20:23], a[200:203], v[180:183], a[20:23]
buffer_load_dwordx4 v[156:159], v16, s[80:83], s99 offen sc1
ds_read_b64_tr_b16 a[200:201], v18
v_mfma_f32_16x16x32_bf16 a[24:27], a[204:207], v[160:163], a[24:27]
s_add_u32 s70, s70, 1024
ds_read_b64_tr_b16 a[202:203], v18 offset:4224
v_mfma_f32_16x16x32_bf16 a[28:31], a[204:207], v[164:167], a[28:31]
s_and_b32 s70, s70, 16383
v_mfma_f32_16x16x32_bf16 a[32:35], a[204:207], v[168:171], a[32:35]
s_lshl_b32 s97, s70, 5
v_mfma_f32_16x16x32_bf16 a[36:39], a[204:207], v[172:175], a[36:39]
s_add_u32 s97, s97, s96
v_mfma_f32_16x16x32_bf16 a[40:43], a[204:207], v[176:179], a[40:43]
s_add_u32 m0, s78, 16896
v_mfma_f32_16x16x32_bf16 a[44:47], a[204:207], v[180:183], a[44:47]
buffer_load_dwordx4 v2, s[84:87], s97 offen lds
ds_read_b64_tr_b16 a[204:205], v18 offset:32
s_waitcnt lgkmcnt(2)
v_mfma_f32_16x16x32_bf16 a[48:51], a[208:211], v[160:163], a[48:51]
ds_read_b64_tr_b16 a[206:207], v18 offset:4256
v_mfma_f32_16x16x32_bf16 a[52:55], a[208:211], v[164:167], a[52:55]
v_mfma_f32_16x16x32_bf16 a[56:59], a[208:211], v[168:171], a[56:59]
buffer_load_dwordx4 v3, s[84:87], s97 offen offset:1056 lds
v_mfma_f32_16x16x32_bf16 a[60:63], a[208:211], v[172:175], a[60:63]
v_mfma_f32_16x16x32_bf16 a[64:67], a[208:211], v[176:179], a[64:67]
v_mfma_f32_16x16x32_bf16 a[68:71], a[208:211], v[180:183], a[68:71]
buffer_load_dwordx4 v4, s[84:87], s97 offen offset:2112 lds
ds_read_b64_tr_b16 a[208:209], v39
v_mfma_f32_16x16x32_bf16 a[72:75], a[212:215], v[160:163], a[72:75]
ds_read_b64_tr_b16 a[210:211], v39 offset:4224
v_mfma_f32_16x16x32_bf16 a[76:79], a[212:215], v[164:167], a[76:79]
v_mfma_f32_16x16x32_bf16 a[80:83], a[212:215], v[168:171], a[80:83]
buffer_load_dwordx4 v5, s[84:87], s97 offen offset:3168 lds
v_mfma_f32_16x16x32_bf16 a[84:87], a[212:215], v[172:175], a[84:87]
s_add_u32 s98, s97, 16384
v_mfma_f32_16x16x32_bf16 a[88:91], a[212:215], v[176:179], a[88:91]
s_add_u32 m0, s78, 21120
v_mfma_f32_16x16x32_bf16 a[92:95], a[212:215], v[180:183], a[92:95]
buffer_load_dwordx4 v2, s[84:87], s98 offen lds
ds_read_b64_tr_b16 a[212:213], v39 offset:32
v_mfma_f32_16x16x32_bf16 a[96:99], a[216:219], v[160:163], a[96:99]
ds_read_b64_tr_b16 a[214:215], v39 offset:4256
v_mfma_f32_16x16x32_bf16 a[100:103], a[216:219], v[164:167], a[100:103]
v_mfma_f32_16x16x32_bf16 a[104:107], a[216:219], v[168:171], a[104:107]
buffer_load_dwordx4 v3, s[84:87], s98 offen offset:1056 lds
v_mfma_f32_16x16x32_bf16 a[108:111], a[216:219], v[172:175], a[108:111]
v_mfma_f32_16x16x32_bf16 a[112:115], a[216:219], v[176:179], a[112:115]
v_mfma_f32_16x16x32_bf16 a[116:119], a[216:219], v[180:183], a[116:119]
buffer_load_dwordx4 v4, s[84:87], s98 offen offset:2112 lds
ds_read_b64_tr_b16 a[216:217], v40
v_mfma_f32_16x16x32_bf16 a[120:123], a[220:223], v[160:163], a[120:123]
ds_read_b64_tr_b16 a[218:219], v40 offset:4224
v_mfma_f32_16x16x32_bf16 a[124:127], a[220:223], v[164:167], a[124:127]
v_mfma_f32_16x16x32_bf16 a[128:131], a[220:223], v[168:171], a[128:131]
buffer_load_dwordx4 v5, s[84:87], s98 offen offset:3168 lds
v_mfma_f32_16x16x32_bf16 a[132:135], a[220:223], v[172:175], a[132:135]
v_mfma_f32_16x16x32_bf16 a[136:139], a[220:223], v[176:179], a[136:139]
s_add_u32 s65, s14, 4
buffer_load_dword v49, v50, s[92:95], s65 offen sc1
v_mfma_f32_16x16x32_bf16 a[140:143], a[220:223], v[180:183], a[140:143]
ds_read_b64_tr_b16 a[220:221], v40 offset:32
s_waitcnt vmcnt(28)
v_mfma_f32_16x16x32_bf16 v[64:67], a[192:195], v[112:115], v[64:67]
ds_read_b64_tr_b16 a[222:223], v40 offset:4256
s_waitcnt vmcnt(27)
v_mfma_f32_16x16x32_bf16 v[68:71], a[192:195], v[116:119], v[68:71]
s_add_u32 s99, s70, s79
s_waitcnt vmcnt(26)
v_mfma_f32_16x16x32_bf16 v[72:75], a[192:195], v[120:123], v[72:75]
buffer_load_dwordx4 v[160:163], v11, s[80:83], s99 offen sc1
s_waitcnt vmcnt(26)
v_mfma_f32_16x16x32_bf16 v[76:79], a[192:195], v[124:127], v[76:79]
s_waitcnt vmcnt(25)
v_mfma_f32_16x16x32_bf16 v[80:83], a[192:195], v[128:131], v[80:83]
s_waitcnt vmcnt(24)
v_mfma_f32_16x16x32_bf16 v[84:87], a[192:195], v[132:135], v[84:87]
buffer_load_dwordx4 v[164:167], v12, s[80:83], s99 offen sc1
s_waitcnt vmcnt(17)
ds_read_b64_tr_b16 a[192:193], v17 offset:8448
v_mfma_f32_16x16x32_bf16 v[88:91], a[196:199], v[112:115], v[88:91]
ds_read_b64_tr_b16 a[194:195], v17 offset:12672
v_mfma_f32_16x16x32_bf16 v[92:95], a[196:199], v[116:119], v[92:95]
v_mfma_f32_16x16x32_bf16 v[96:99], a[196:199], v[120:123], v[96:99]
buffer_load_dwordx4 v[168:171], v13, s[80:83], s99 offen sc1
v_mfma_f32_16x16x32_bf16 v[100:103], a[196:199], v[124:127], v[100:103]
v_mfma_f32_16x16x32_bf16 v[104:107], a[196:199], v[128:131], v[104:107]
v_mfma_f32_16x16x32_bf16 v[108:111], a[196:199], v[132:135], v[108:111]
buffer_load_dwordx4 v[172:175], v14, s[80:83], s99 offen sc1
ds_read_b64_tr_b16 a[196:197], v17 offset:8480
s_waitcnt lgkmcnt(3)
v_mfma_f32_16x16x32_bf16 a[0:3], a[200:203], v[112:115], a[0:3]
ds_read_b64_tr_b16 a[198:199], v17 offset:12704
v_mfma_f32_16x16x32_bf16 a[4:7], a[200:203], v[116:119], a[4:7]
v_mfma_f32_16x16x32_bf16 a[8:11], a[200:203], v[120:123], a[8:11]
buffer_load_dwordx4 v[176:179], v15, s[80:83], s99 offen sc1
v_mfma_f32_16x16x32_bf16 a[12:15], a[200:203], v[124:127], a[12:15]
v_mfma_f32_16x16x32_bf16 a[16:19], a[200:203], v[128:131], a[16:19]
v_mfma_f32_16x16x32_bf16 a[20:23], a[200:203], v[132:135], a[20:23]
buffer_load_dwordx4 v[180:183], v16, s[80:83], s99 offen sc1
ds_read_b64_tr_b16 a[200:201], v18 offset:8448
v_mfma_f32_16x16x32_bf16 a[24:27], a[204:207], v[112:115], a[24:27]
s_add_u32 s70, s70, 1024
ds_read_b64_tr_b16 a[202:203], v18 offset:12672
v_mfma_f32_16x16x32_bf16 a[28:31], a[204:207], v[116:119], a[28:31]
s_and_b32 s70, s70, 16383
v_mfma_f32_16x16x32_bf16 a[32:35], a[204:207], v[120:123], a[32:35]
s_lshl_b32 s97, s70, 5
v_mfma_f32_16x16x32_bf16 a[36:39], a[204:207], v[124:127], a[36:39]
s_add_u32 s97, s97, s96
v_mfma_f32_16x16x32_bf16 a[40:43], a[204:207], v[128:131], a[40:43]
s_add_u32 m0, s78, 25344
v_mfma_f32_16x16x32_bf16 a[44:47], a[204:207], v[132:135], a[44:47]
buffer_load_dwordx4 v2, s[84:87], s97 offen lds
ds_read_b64_tr_b16 a[204:205], v18 offset:8480
v_mfma_f32_16x16x32_bf16 a[48:51], a[208:211], v[112:115], a[48:51]
ds_read_b64_tr_b16 a[206:207], v18 offset:12704
v_mfma_f32_16x16x32_bf16 a[52:55], a[208:211], v[116:119], a[52:55]
v_mfma_f32_16x16x32_bf16 a[56:59], a[208:211], v[120:123], a[56:59]
buffer_load_dwordx4 v3, s[84:87], s97 offen offset:1056 lds
v_mfma_f32_16x16x32_bf16 a[60:63], a[208:211], v[124:127], a[60:63]
v_mfma_f32_16x16x32_bf16 a[64:67], a[208:211], v[128:131], a[64:67]
v_mfma_f32_16x16x32_bf16 a[68:71], a[208:211], v[132:135], a[68:71]
buffer_load_dwordx4 v4, s[84:87], s97 offen offset:2112 lds
ds_read_b64_tr_b16 a[208:209], v39 offset:8448
v_mfma_f32_16x16x32_bf16 a[72:75], a[212:215], v[112:115], a[72:75]
ds_read_b64_tr_b16 a[210:211], v39 offset:12672
v_mfma_f32_16x16x32_bf16 a[76:79], a[212:215], v[116:119], a[76:79]
v_mfma_f32_16x16x32_bf16 a[80:83], a[212:215], v[120:123], a[80:83]
buffer_load_dwordx4 v5, s[84:87], s97 offen offset:3168 lds
v_mfma_f32_16x16x32_bf16 a[84:87], a[212:215], v[124:127], a[84:87]
s_add_u32 s98, s97, 16384
v_mfma_f32_16x16x32_bf16 a[88:91], a[212:215], v[128:131], a[88:91]
s_add_u32 m0, s78, 29568
v_mfma_f32_16x16x32_bf16 a[92:95], a[212:215], v[132:135], a[92:95]
buffer_load_dwordx4 v2, s[84:87], s98 offen lds
ds_read_b64_tr_b16 a[212:213], v39 offset:8480
v_mfma_f32_16x16x32_bf16 a[96:99], a[216:219], v[112:115], a[96:99]
ds_read_b64_tr_b16 a[214:215], v39 offset:12704
v_mfma_f32_16x16x32_bf16 a[100:103], a[216:219], v[116:119], a[100:103]
v_mfma_f32_16x16x32_bf16 a[104:107], a[216:219], v[120:123], a[104:107]
buffer_load_dwordx4 v3, s[84:87], s98 offen offset:1056 lds
v_mfma_f32_16x16x32_bf16 a[108:111], a[216:219], v[124:127], a[108:111]
v_mfma_f32_16x16x32_bf16 a[112:115], a[216:219], v[128:131], a[112:115]
v_mfma_f32_16x16x32_bf16 a[116:119], a[216:219], v[132:135], a[116:119]
buffer_load_dwordx4 v4, s[84:87], s98 offen offset:2112 lds
ds_read_b64_tr_b16 a[216:217], v40 offset:8448
v_mfma_f32_16x16x32_bf16 a[120:123], a[220:223], v[112:115], a[120:123]
ds_read_b64_tr_b16 a[218:219], v40 offset:12672
v_mfma_f32_16x16x32_bf16 a[124:127], a[220:223], v[116:119], a[124:127]
v_mfma_f32_16x16x32_bf16 a[128:131], a[220:223], v[120:123], a[128:131]
buffer_load_dwordx4 v5, s[84:87], s98 offen offset:3168 lds
v_mfma_f32_16x16x32_bf16 a[132:135], a[220:223], v[124:127], a[132:135]
v_mfma_f32_16x16x32_bf16 a[136:139], a[220:223], v[128:131], a[136:139]
v_mfma_f32_16x16x32_bf16 a[140:143], a[220:223], v[132:135], a[140:143]
ds_read_b64_tr_b16 a[220:221], v40 offset:8480
s_waitcnt vmcnt(28) lgkmcnt(3)
v_mfma_f32_16x16x32_bf16 v[64:67], a[192:195], v[136:139], v[64:67]
ds_read_b64_tr_b16 a[222:223], v40 offset:12704
s_waitcnt vmcnt(27)
v_mfma_f32_16x16x32_bf16 v[68:71], a[192:195], v[140:143], v[68:71]
s_add_u32 s99, s70, s79
s_waitcnt vmcnt(26)
v_mfma_f32_16x16x32_bf16 v[72:75], a[192:195], v[144:147], v[72:75]
buffer_load_dwordx4 v[112:115], v11, s[80:83], s99 offen sc1
s_waitcnt vmcnt(26)
v_mfma_f32_16x16x32_bf16 v[76:79], a[192:195], v[148:151], v[76:79]
s_waitcnt vmcnt(25)
v_mfma_f32_16x16x32_bf16 v[80:83], a[192:195], v[152:155], v[80:83]
s_waitcnt vmcnt(24)
v_mfma_f32_16x16x32_bf16 v[84:87], a[192:195], v[156:159], v[84:87]
buffer_load_dwordx4 v[116:119], v12, s[80:83], s99 offen sc1
s_waitcnt vmcnt(17)
ds_read_b64_tr_b16 a[192:193], v17 offset:16896
v_mfma_f32_16x16x32_bf16 v[88:91], a[196:199], v[136:139], v[88:91]
ds_read_b64_tr_b16 a[194:195], v17 offset:21120
v_mfma_f32_16x16x32_bf16 v[92:95], a[196:199], v[140:143], v[92:95]
v_mfma_f32_16x16x32_bf16 v[96:99], a[196:199], v[144:147], v[96:99]
buffer_load_dwordx4 v[120:123], v13, s[80:83], s99 offen sc1
v_mfma_f32_16x16x32_bf16 v[100:103], a[196:199], v[148:151], v[100:103]
v_mfma_f32_16x16x32_bf16 v[104:107], a[196:199], v[152:155], v[104:107]
v_mfma_f32_16x16x32_bf16 v[108:111], a[196:199], v[156:159], v[108:111]
buffer_load_dwordx4 v[124:127], v14, s[80:83], s99 offen sc1
ds_read_b64_tr_b16 a[196:197], v17 offset:16928
v_mfma_f32_16x16x32_bf16 a[0:3], a[200:203], v[136:139], a[0:3]
ds_read_b64_tr_b16 a[198:199], v17 offset:21152
v_mfma_f32_16x16x32_bf16 a[4:7], a[200:203], v[140:143], a[4:7]
v_mfma_f32_16x16x32_bf16 a[8:11], a[200:203], v[144:147], a[8:11]
buffer_load_dwordx4 v[128:131], v15, s[80:83], s99 offen sc1
v_mfma_f32_16x16x32_bf16 a[12:15], a[200:203], v[148:151], a[12:15]
v_mfma_f32_16x16x32_bf16 a[16:19], a[200:203], v[152:155], a[16:19]
v_mfma_f32_16x16x32_bf16 a[20:23], a[200:203], v[156:159], a[20:23]
buffer_load_dwordx4 v[132:135], v16, s[80:83], s99 offen sc1
ds_read_b64_tr_b16 a[200:201], v18 offset:16896
v_mfma_f32_16x16x32_bf16 a[24:27], a[204:207], v[136:139], a[24:27]
s_add_u32 s96, s96, 2097152
ds_read_b64_tr_b16 a[202:203], v18 offset:21120
v_mfma_f32_16x16x32_bf16 a[28:31], a[204:207], v[140:143], a[28:31]
s_add_u32 s70, s70, 1024
v_mfma_f32_16x16x32_bf16 a[32:35], a[204:207], v[144:147], a[32:35]
s_and_b32 s70, s70, 16383
v_mfma_f32_16x16x32_bf16 a[36:39], a[204:207], v[148:151], a[36:39]
s_lshl_b32 s97, s70, 5
v_mfma_f32_16x16x32_bf16 a[40:43], a[204:207], v[152:155], a[40:43]
s_add_u32 s97, s97, s96
v_mfma_f32_16x16x32_bf16 a[44:47], a[204:207], v[156:159], a[44:47]
s_add_u32 m0, s78, 0
ds_read_b64_tr_b16 a[204:205], v18 offset:16928
v_mfma_f32_16x16x32_bf16 a[48:51], a[208:211], v[136:139], a[48:51]
buffer_load_dwordx4 v2, s[84:87], s97 offen lds
ds_read_b64_tr_b16 a[206:207], v18 offset:21152
v_mfma_f32_16x16x32_bf16 a[52:55], a[208:211], v[140:143], a[52:55]
v_mfma_f32_16x16x32_bf16 a[56:59], a[208:211], v[144:147], a[56:59]
v_mfma_f32_16x16x32_bf16 a[60:63], a[208:211], v[148:151], a[60:63]
buffer_load_dwordx4 v3, s[84:87], s97 offen offset:1056 lds
v_mfma_f32_16x16x32_bf16 a[64:67], a[208:211], v[152:155], a[64:67]
v_mfma_f32_16x16x32_bf16 a[68:71], a[208:211], v[156:159], a[68:71]
ds_read_b64_tr_b16 a[208:209], v39 offset:16896
v_mfma_f32_16x16x32_bf16 a[72:75], a[212:215], v[136:139], a[72:75]
buffer_load_dwordx4 v4, s[84:87], s97 offen offset:2112 lds
ds_read_b64_tr_b16 a[210:211], v39 offset:21120
v_mfma_f32_16x16x32_bf16 a[76:79], a[212:215], v[140:143], a[76:79]
v_mfma_f32_16x16x32_bf16 a[80:83], a[212:215], v[144:147], a[80:83]
v_mfma_f32_16x16x32_bf16 a[84:87], a[212:215], v[148:151], a[84:87]
buffer_load_dwordx4 v5, s[84:87], s97 offen offset:3168 lds
v_mfma_f32_16x16x32_bf16 a[88:91], a[212:215], v[152:155], a[88:91]
s_add_u32 s98, s97, 16384
v_mfma_f32_16x16x32_bf16 a[92:95], a[212:215], v[156:159], a[92:95]
s_add_u32 m0, s78, 4224
ds_read_b64_tr_b16 a[212:213], v39 offset:16928
s_waitcnt lgkmcnt(3)
v_mfma_f32_16x16x32_bf16 a[96:99], a[216:219], v[136:139], a[96:99]
buffer_load_dwordx4 v2, s[84:87], s98 offen lds
ds_read_b64_tr_b16 a[214:215], v39 offset:21152
v_mfma_f32_16x16x32_bf16 a[100:103], a[216:219], v[140:143], a[100:103]
v_mfma_f32_16x16x32_bf16 a[104:107], a[216:219], v[144:147], a[104:107]
v_mfma_f32_16x16x32_bf16 a[108:111], a[216:219], v[148:151], a[108:111]
buffer_load_dwordx4 v3, s[84:87], s98 offen offset:1056 lds
v_mfma_f32_16x16x32_bf16 a[112:115], a[216:219], v[152:155], a[112:115]
v_mfma_f32_16x16x32_bf16 a[116:119], a[216:219], v[156:159], a[116:119]
ds_read_b64_tr_b16 a[216:217], v40 offset:16896
v_mfma_f32_16x16x32_bf16 a[120:123], a[220:223], v[136:139], a[120:123]
buffer_load_dwordx4 v4, s[84:87], s98 offen offset:2112 lds
ds_read_b64_tr_b16 a[218:219], v40 offset:21120
v_mfma_f32_16x16x32_bf16 a[124:127], a[220:223], v[140:143], a[124:127]
v_mfma_f32_16x16x32_bf16 a[128:131], a[220:223], v[144:147], a[128:131]
v_mfma_f32_16x16x32_bf16 a[132:135], a[220:223], v[148:151], a[132:135]
buffer_load_dwordx4 v5, s[84:87], s98 offen offset:3168 lds
v_mfma_f32_16x16x32_bf16 a[136:139], a[220:223], v[152:155], a[136:139]
s_waitcnt vmcnt(28)
v_readfirstlane_b32 s63, v49
s_nop 0
s_cmp_ge_u32 s63, 8
s_cbranch_scc0 L_concat_heads__mha_block_cached__gqa_block_cached__near_ridge_kernel_poll1_spin
L_concat_heads__mha_block_cached__gqa_block_cached__near_ridge_kernel_poll1_ok:
v_mfma_f32_16x16x32_bf16 a[140:143], a[220:223], v[156:159], a[140:143]
ds_read_b64_tr_b16 a[220:221], v40 offset:16928
s_waitcnt vmcnt(27)
v_mfma_f32_16x16x32_bf16 v[64:67], a[192:195], v[160:163], v[64:67]
ds_read_b64_tr_b16 a[222:223], v40 offset:21152
s_waitcnt vmcnt(26)
v_mfma_f32_16x16x32_bf16 v[68:71], a[192:195], v[164:167], v[68:71]
s_add_u32 s79, s79, 65536
s_waitcnt vmcnt(25)
v_mfma_f32_16x16x32_bf16 v[72:75], a[192:195], v[168:171], v[72:75]
s_add_u32 s99, s70, s79
s_waitcnt vmcnt(24)
v_mfma_f32_16x16x32_bf16 v[76:79], a[192:195], v[172:175], v[76:79]
buffer_load_dwordx4 v[136:139], v11, s[80:83], s99 offen sc1
s_waitcnt vmcnt(24)
v_mfma_f32_16x16x32_bf16 v[80:83], a[192:195], v[176:179], v[80:83]
s_waitcnt vmcnt(23)
v_mfma_f32_16x16x32_bf16 v[84:87], a[192:195], v[180:183], v[84:87]
s_waitcnt vmcnt(15)
ds_read_b64_tr_b16 a[192:193], v17 offset:25344
v_mfma_f32_16x16x32_bf16 v[88:91], a[196:199], v[160:163], v[88:91]
buffer_load_dwordx4 v[140:143], v12, s[80:83], s99 offen sc1
ds_read_b64_tr_b16 a[194:195], v17 offset:29568
v_mfma_f32_16x16x32_bf16 v[92:95], a[196:199], v[164:167], v[92:95]
v_mfma_f32_16x16x32_bf16 v[96:99], a[196:199], v[168:171], v[96:99]
v_mfma_f32_16x16x32_bf16 v[100:103], a[196:199], v[172:175], v[100:103]
buffer_load_dwordx4 v[144:147], v13, s[80:83], s99 offen sc1
v_mfma_f32_16x16x32_bf16 v[104:107], a[196:199], v[176:179], v[104:107]
v_mfma_f32_16x16x32_bf16 v[108:111], a[196:199], v[180:183], v[108:111]
ds_read_b64_tr_b16 a[196:197], v17 offset:25376
v_mfma_f32_16x16x32_bf16 a[0:3], a[200:203], v[160:163], a[0:3]
buffer_load_dwordx4 v[148:151], v14, s[80:83], s99 offen sc1
ds_read_b64_tr_b16 a[198:199], v17 offset:29600
v_mfma_f32_16x16x32_bf16 a[4:7], a[200:203], v[164:167], a[4:7]
v_mfma_f32_16x16x32_bf16 a[8:11], a[200:203], v[168:171], a[8:11]
v_mfma_f32_16x16x32_bf16 a[12:15], a[200:203], v[172:175], a[12:15]
buffer_load_dwordx4 v[152:155], v15, s[80:83], s99 offen sc1
v_mfma_f32_16x16x32_bf16 a[16:19], a[200:203], v[176:179], a[16:19]
v_mfma_f32_16x16x32_bf16 a[20:23], a[200:203], v[180:183], a[20:23]
ds_read_b64_tr_b16 a[200:201], v18 offset:25344
v_mfma_f32_16x16x32_bf16 a[24:27], a[204:207], v[160:163], a[24:27]
buffer_load_dwordx4 v[156:159], v16, s[80:83], s99 offen sc1
ds_read_b64_tr_b16 a[202:203], v18 offset:29568
v_mfma_f32_16x16x32_bf16 a[28:31], a[204:207], v[164:167], a[28:31]
s_add_u32 s70, s70, 1024
v_mfma_f32_16x16x32_bf16 a[32:35], a[204:207], v[168:171], a[32:35]
s_and_b32 s70, s70, 16383
v_mfma_f32_16x16x32_bf16 a[36:39], a[204:207], v[172:175], a[36:39]
s_lshl_b32 s97, s70, 5
v_mfma_f32_16x16x32_bf16 a[40:43], a[204:207], v[176:179], a[40:43]
s_add_u32 s97, s97, s96
v_mfma_f32_16x16x32_bf16 a[44:47], a[204:207], v[180:183], a[44:47]
s_add_u32 m0, s78, 8448
ds_read_b64_tr_b16 a[204:205], v18 offset:25376
s_waitcnt lgkmcnt(2)
v_mfma_f32_16x16x32_bf16 a[48:51], a[208:211], v[160:163], a[48:51]
buffer_load_dwordx4 v2, s[84:87], s97 offen lds
ds_read_b64_tr_b16 a[206:207], v18 offset:29600
v_mfma_f32_16x16x32_bf16 a[52:55], a[208:211], v[164:167], a[52:55]
v_mfma_f32_16x16x32_bf16 a[56:59], a[208:211], v[168:171], a[56:59]
v_mfma_f32_16x16x32_bf16 a[60:63], a[208:211], v[172:175], a[60:63]
buffer_load_dwordx4 v3, s[84:87], s97 offen offset:1056 lds
v_mfma_f32_16x16x32_bf16 a[64:67], a[208:211], v[176:179], a[64:67]
v_mfma_f32_16x16x32_bf16 a[68:71], a[208:211], v[180:183], a[68:71]
ds_read_b64_tr_b16 a[208:209], v39 offset:25344
v_mfma_f32_16x16x32_bf16 a[72:75], a[212:215], v[160:163], a[72:75]
buffer_load_dwordx4 v4, s[84:87], s97 offen offset:2112 lds
ds_read_b64_tr_b16 a[210:211], v39 offset:29568
v_mfma_f32_16x16x32_bf16 a[76:79], a[212:215], v[164:167], a[76:79]
v_mfma_f32_16x16x32_bf16 a[80:83], a[212:215], v[168:171], a[80:83]
v_mfma_f32_16x16x32_bf16 a[84:87], a[212:215], v[172:175], a[84:87]
buffer_load_dwordx4 v5, s[84:87], s97 offen offset:3168 lds
v_mfma_f32_16x16x32_bf16 a[88:91], a[212:215], v[176:179], a[88:91]
s_add_u32 s98, s97, 16384
v_mfma_f32_16x16x32_bf16 a[92:95], a[212:215], v[180:183], a[92:95]
s_add_u32 m0, s78, 12672
ds_read_b64_tr_b16 a[212:213], v39 offset:25376
v_mfma_f32_16x16x32_bf16 a[96:99], a[216:219], v[160:163], a[96:99]
buffer_load_dwordx4 v2, s[84:87], s98 offen lds
ds_read_b64_tr_b16 a[214:215], v39 offset:29600
v_mfma_f32_16x16x32_bf16 a[100:103], a[216:219], v[164:167], a[100:103]
v_mfma_f32_16x16x32_bf16 a[104:107], a[216:219], v[168:171], a[104:107]
v_mfma_f32_16x16x32_bf16 a[108:111], a[216:219], v[172:175], a[108:111]
buffer_load_dwordx4 v3, s[84:87], s98 offen offset:1056 lds
v_mfma_f32_16x16x32_bf16 a[112:115], a[216:219], v[176:179], a[112:115]
v_mfma_f32_16x16x32_bf16 a[116:119], a[216:219], v[180:183], a[116:119]
ds_read_b64_tr_b16 a[216:217], v40 offset:25344
v_mfma_f32_16x16x32_bf16 a[120:123], a[220:223], v[160:163], a[120:123]
buffer_load_dwordx4 v4, s[84:87], s98 offen offset:2112 lds
ds_read_b64_tr_b16 a[218:219], v40 offset:29568
v_mfma_f32_16x16x32_bf16 a[124:127], a[220:223], v[164:167], a[124:127]
v_mfma_f32_16x16x32_bf16 a[128:131], a[220:223], v[168:171], a[128:131]
v_mfma_f32_16x16x32_bf16 a[132:135], a[220:223], v[172:175], a[132:135]
buffer_load_dwordx4 v5, s[84:87], s98 offen offset:3168 lds
v_mfma_f32_16x16x32_bf16 a[136:139], a[220:223], v[176:179], a[136:139]
v_mfma_f32_16x16x32_bf16 a[140:143], a[220:223], v[180:183], a[140:143]
ds_read_b64_tr_b16 a[220:221], v40 offset:25376
s_waitcnt vmcnt(27)
v_mfma_f32_16x16x32_bf16 v[64:67], a[192:195], v[112:115], v[64:67]
ds_read_b64_tr_b16 a[222:223], v40 offset:29600
s_waitcnt vmcnt(26)
v_mfma_f32_16x16x32_bf16 v[68:71], a[192:195], v[116:119], v[68:71]
s_add_u32 s99, s70, s79
s_waitcnt vmcnt(25)
v_mfma_f32_16x16x32_bf16 v[72:75], a[192:195], v[120:123], v[72:75]
buffer_load_dwordx4 v[160:163], v11, s[80:83], s99 offen sc1
s_waitcnt vmcnt(25)
v_mfma_f32_16x16x32_bf16 v[76:79], a[192:195], v[124:127], v[76:79]
s_waitcnt vmcnt(24)
v_mfma_f32_16x16x32_bf16 v[80:83], a[192:195], v[128:131], v[80:83]
s_waitcnt vmcnt(23)
v_mfma_f32_16x16x32_bf16 v[84:87], a[192:195], v[132:135], v[84:87]
buffer_load_dwordx4 v[164:167], v12, s[80:83], s99 offen sc1
s_waitcnt vmcnt(16)
ds_read_b64_tr_b16 a[192:193], v17
v_mfma_f32_16x16x32_bf16 v[88:91], a[196:199], v[112:115], v[88:91]
ds_read_b64_tr_b16 a[194:195], v17 offset:4224
v_mfma_f32_16x16x32_bf16 v[92:95], a[196:199], v[116:119], v[92:95]
v_mfma_f32_16x16x32_bf16 v[96:99], a[196:199], v[120:123], v[96:99]
buffer_load_dwordx4 v[168:171], v13, s[80:83], s99 offen sc1
v_mfma_f32_16x16x32_bf16 v[100:103], a[196:199], v[124:127], v[100:103]
v_mfma_f32_16x16x32_bf16 v[104:107], a[196:199], v[128:131], v[104:107]
v_mfma_f32_16x16x32_bf16 v[108:111], a[196:199], v[132:135], v[108:111]
buffer_load_dwordx4 v[172:175], v14, s[80:83], s99 offen sc1
ds_read_b64_tr_b16 a[196:197], v17 offset:32
s_waitcnt lgkmcnt(3)
v_mfma_f32_16x16x32_bf16 a[0:3], a[200:203], v[112:115], a[0:3]
ds_read_b64_tr_b16 a[198:199], v17 offset:4256
v_mfma_f32_16x16x32_bf16 a[4:7], a[200:203], v[116:119], a[4:7]
v_mfma_f32_16x16x32_bf16 a[8:11], a[200:203], v[120:123], a[8:11]
buffer_load_dwordx4 v[176:179], v15, s[80:83], s99 offen sc1
v_mfma_f32_16x16x32_bf16 a[12:15], a[200:203], v[124:127], a[12:15]
v_mfma_f32_16x16x32_bf16 a[16:19], a[200:203], v[128:131], a[16:19]
v_mfma_f32_16x16x32_bf16 a[20:23], a[200:203], v[132:135], a[20:23]
buffer_load_dwordx4 v[180:183], v16, s[80:83], s99 offen sc1
ds_read_b64_tr_b16 a[200:201], v18
v_mfma_f32_16x16x32_bf16 a[24:27], a[204:207], v[112:115], a[24:27]
s_add_u32 s70, s70, 1024
ds_read_b64_tr_b16 a[202:203], v18 offset:4224
v_mfma_f32_16x16x32_bf16 a[28:31], a[204:207], v[116:119], a[28:31]
s_and_b32 s70, s70, 16383
v_mfma_f32_16x16x32_bf16 a[32:35], a[204:207], v[120:123], a[32:35]
s_lshl_b32 s97, s70, 5
v_mfma_f32_16x16x32_bf16 a[36:39], a[204:207], v[124:127], a[36:39]
s_add_u32 s97, s97, s96
v_mfma_f32_16x16x32_bf16 a[40:43], a[204:207], v[128:131], a[40:43]
s_add_u32 m0, s78, 16896
v_mfma_f32_16x16x32_bf16 a[44:47], a[204:207], v[132:135], a[44:47]
buffer_load_dwordx4 v2, s[84:87], s97 offen lds
ds_read_b64_tr_b16 a[204:205], v18 offset:32
v_mfma_f32_16x16x32_bf16 a[48:51], a[208:211], v[112:115], a[48:51]
ds_read_b64_tr_b16 a[206:207], v18 offset:4256
v_mfma_f32_16x16x32_bf16 a[52:55], a[208:211], v[116:119], a[52:55]
v_mfma_f32_16x16x32_bf16 a[56:59], a[208:211], v[120:123], a[56:59]
buffer_load_dwordx4 v3, s[84:87], s97 offen offset:1056 lds
v_mfma_f32_16x16x32_bf16 a[60:63], a[208:211], v[124:127], a[60:63]
v_mfma_f32_16x16x32_bf16 a[64:67], a[208:211], v[128:131], a[64:67]
v_mfma_f32_16x16x32_bf16 a[68:71], a[208:211], v[132:135], a[68:71]
buffer_load_dwordx4 v4, s[84:87], s97 offen offset:2112 lds
ds_read_b64_tr_b16 a[208:209], v39
v_mfma_f32_16x16x32_bf16 a[72:75], a[212:215], v[112:115], a[72:75]
ds_read_b64_tr_b16 a[210:211], v39 offset:4224
v_mfma_f32_16x16x32_bf16 a[76:79], a[212:215], v[116:119], a[76:79]
v_mfma_f32_16x16x32_bf16 a[80:83], a[212:215], v[120:123], a[80:83]
buffer_load_dwordx4 v5, s[84:87], s97 offen offset:3168 lds
v_mfma_f32_16x16x32_bf16 a[84:87], a[212:215], v[124:127], a[84:87]
s_add_u32 s98, s97, 16384
v_mfma_f32_16x16x32_bf16 a[88:91], a[212:215], v[128:131], a[88:91]
s_add_u32 m0, s78, 21120
v_mfma_f32_16x16x32_bf16 a[92:95], a[212:215], v[132:135], a[92:95]
buffer_load_dwordx4 v2, s[84:87], s98 offen lds
ds_read_b64_tr_b16 a[212:213], v39 offset:32
v_mfma_f32_16x16x32_bf16 a[96:99], a[216:219], v[112:115], a[96:99]
ds_read_b64_tr_b16 a[214:215], v39 offset:4256
v_mfma_f32_16x16x32_bf16 a[100:103], a[216:219], v[116:119], a[100:103]
v_mfma_f32_16x16x32_bf16 a[104:107], a[216:219], v[120:123], a[104:107]
buffer_load_dwordx4 v3, s[84:87], s98 offen offset:1056 lds
v_mfma_f32_16x16x32_bf16 a[108:111], a[216:219], v[124:127], a[108:111]
v_mfma_f32_16x16x32_bf16 a[112:115], a[216:219], v[128:131], a[112:115]
v_mfma_f32_16x16x32_bf16 a[116:119], a[216:219], v[132:135], a[116:119]
buffer_load_dwordx4 v4, s[84:87], s98 offen offset:2112 lds
ds_read_b64_tr_b16 a[216:217], v40
v_mfma_f32_16x16x32_bf16 a[120:123], a[220:223], v[112:115], a[120:123]
ds_read_b64_tr_b16 a[218:219], v40 offset:4224
v_mfma_f32_16x16x32_bf16 a[124:127], a[220:223], v[116:119], a[124:127]
v_mfma_f32_16x16x32_bf16 a[128:131], a[220:223], v[120:123], a[128:131]
buffer_load_dwordx4 v5, s[84:87], s98 offen offset:3168 lds
v_mfma_f32_16x16x32_bf16 a[132:135], a[220:223], v[124:127], a[132:135]
v_mfma_f32_16x16x32_bf16 a[136:139], a[220:223], v[128:131], a[136:139]
v_mfma_f32_16x16x32_bf16 a[140:143], a[220:223], v[132:135], a[140:143]
ds_read_b64_tr_b16 a[220:221], v40 offset:32
s_waitcnt vmcnt(27) lgkmcnt(3)
v_mfma_f32_16x16x32_bf16 v[64:67], a[192:195], v[136:139], v[64:67]
ds_read_b64_tr_b16 a[222:223], v40 offset:4256
s_waitcnt vmcnt(26)
v_mfma_f32_16x16x32_bf16 v[68:71], a[192:195], v[140:143], v[68:71]
s_add_u32 s99, s70, s79
s_waitcnt vmcnt(25)
v_mfma_f32_16x16x32_bf16 v[72:75], a[192:195], v[144:147], v[72:75]
buffer_load_dwordx4 v[112:115], v11, s[80:83], s99 offen sc1
s_waitcnt vmcnt(25)
v_mfma_f32_16x16x32_bf16 v[76:79], a[192:195], v[148:151], v[76:79]
s_waitcnt vmcnt(24)
v_mfma_f32_16x16x32_bf16 v[80:83], a[192:195], v[152:155], v[80:83]
s_waitcnt vmcnt(23)
v_mfma_f32_16x16x32_bf16 v[84:87], a[192:195], v[156:159], v[84:87]
buffer_load_dwordx4 v[116:119], v12, s[80:83], s99 offen sc1
s_waitcnt vmcnt(16)
ds_read_b64_tr_b16 a[192:193], v17 offset:8448
v_mfma_f32_16x16x32_bf16 v[88:91], a[196:199], v[136:139], v[88:91]
ds_read_b64_tr_b16 a[194:195], v17 offset:12672
v_mfma_f32_16x16x32_bf16 v[92:95], a[196:199], v[140:143], v[92:95]
v_mfma_f32_16x16x32_bf16 v[96:99], a[196:199], v[144:147], v[96:99]
buffer_load_dwordx4 v[120:123], v13, s[80:83], s99 offen sc1
v_mfma_f32_16x16x32_bf16 v[100:103], a[196:199], v[148:151], v[100:103]
v_mfma_f32_16x16x32_bf16 v[104:107], a[196:199], v[152:155], v[104:107]
v_mfma_f32_16x16x32_bf16 v[108:111], a[196:199], v[156:159], v[108:111]
buffer_load_dwordx4 v[124:127], v14, s[80:83], s99 offen sc1
ds_read_b64_tr_b16 a[196:197], v17 offset:8480
v_mfma_f32_16x16x32_bf16 a[0:3], a[200:203], v[136:139], a[0:3]
ds_read_b64_tr_b16 a[198:199], v17 offset:12704
v_mfma_f32_16x16x32_bf16 a[4:7], a[200:203], v[140:143], a[4:7]
v_mfma_f32_16x16x32_bf16 a[8:11], a[200:203], v[144:147], a[8:11]
buffer_load_dwordx4 v[128:131], v15, s[80:83], s99 offen sc1
v_mfma_f32_16x16x32_bf16 a[12:15], a[200:203], v[148:151], a[12:15]
v_mfma_f32_16x16x32_bf16 a[16:19], a[200:203], v[152:155], a[16:19]
v_mfma_f32_16x16x32_bf16 a[20:23], a[200:203], v[156:159], a[20:23]
buffer_load_dwordx4 v[132:135], v16, s[80:83], s99 offen sc1
ds_read_b64_tr_b16 a[200:201], v18 offset:8448
v_mfma_f32_16x16x32_bf16 a[24:27], a[204:207], v[136:139], a[24:27]
s_add_u32 s70, s70, 1024
ds_read_b64_tr_b16 a[202:203], v18 offset:12672
v_mfma_f32_16x16x32_bf16 a[28:31], a[204:207], v[140:143], a[28:31]
s_and_b32 s70, s70, 16383
v_mfma_f32_16x16x32_bf16 a[32:35], a[204:207], v[144:147], a[32:35]
s_lshl_b32 s97, s70, 5
v_mfma_f32_16x16x32_bf16 a[36:39], a[204:207], v[148:151], a[36:39]
s_add_u32 s97, s97, s96
v_mfma_f32_16x16x32_bf16 a[40:43], a[204:207], v[152:155], a[40:43]
s_add_u32 m0, s78, 25344
v_mfma_f32_16x16x32_bf16 a[44:47], a[204:207], v[156:159], a[44:47]
buffer_load_dwordx4 v2, s[84:87], s97 offen lds
ds_read_b64_tr_b16 a[204:205], v18 offset:8480
v_mfma_f32_16x16x32_bf16 a[48:51], a[208:211], v[136:139], a[48:51]
ds_read_b64_tr_b16 a[206:207], v18 offset:12704
v_mfma_f32_16x16x32_bf16 a[52:55], a[208:211], v[140:143], a[52:55]
v_mfma_f32_16x16x32_bf16 a[56:59], a[208:211], v[144:147], a[56:59]
buffer_load_dwordx4 v3, s[84:87], s97 offen offset:1056 lds
v_mfma_f32_16x16x32_bf16 a[60:63], a[208:211], v[148:151], a[60:63]
v_mfma_f32_16x16x32_bf16 a[64:67], a[208:211], v[152:155], a[64:67]
v_mfma_f32_16x16x32_bf16 a[68:71], a[208:211], v[156:159], a[68:71]
buffer_load_dwordx4 v4, s[84:87], s97 offen offset:2112 lds
ds_read_b64_tr_b16 a[208:209], v39 offset:8448
v_mfma_f32_16x16x32_bf16 a[72:75], a[212:215], v[136:139], a[72:75]
ds_read_b64_tr_b16 a[210:211], v39 offset:12672
v_mfma_f32_16x16x32_bf16 a[76:79], a[212:215], v[140:143], a[76:79]
v_mfma_f32_16x16x32_bf16 a[80:83], a[212:215], v[144:147], a[80:83]
buffer_load_dwordx4 v5, s[84:87], s97 offen offset:3168 lds
v_mfma_f32_16x16x32_bf16 a[84:87], a[212:215], v[148:151], a[84:87]
s_add_u32 s98, s97, 16384
v_mfma_f32_16x16x32_bf16 a[88:91], a[212:215], v[152:155], a[88:91]
s_add_u32 m0, s78, 29568
v_mfma_f32_16x16x32_bf16 a[92:95], a[212:215], v[156:159], a[92:95]
buffer_load_dwordx4 v2, s[84:87], s98 offen lds
ds_read_b64_tr_b16 a[212:213], v39 offset:8480
s_waitcnt lgkmcnt(3)
v_mfma_f32_16x16x32_bf16 a[96:99], a[216:219], v[136:139], a[96:99]
ds_read_b64_tr_b16 a[214:215], v39 offset:12704
v_mfma_f32_16x16x32_bf16 a[100:103], a[216:219], v[140:143], a[100:103]
v_mfma_f32_16x16x32_bf16 a[104:107], a[216:219], v[144:147], a[104:107]
buffer_load_dwordx4 v3, s[84:87], s98 offen offset:1056 lds
v_mfma_f32_16x16x32_bf16 a[108:111], a[216:219], v[148:151], a[108:111]
v_mfma_f32_16x16x32_bf16 a[112:115], a[216:219], v[152:155], a[112:115]
v_mfma_f32_16x16x32_bf16 a[116:119], a[216:219], v[156:159], a[116:119]
buffer_load_dwordx4 v4, s[84:87], s98 offen offset:2112 lds
ds_read_b64_tr_b16 a[216:217], v40 offset:8448
v_mfma_f32_16x16x32_bf16 a[120:123], a[220:223], v[136:139], a[120:123]
ds_read_b64_tr_b16 a[218:219], v40 offset:12672
v_mfma_f32_16x16x32_bf16 a[124:127], a[220:223], v[140:143], a[124:127]
v_mfma_f32_16x16x32_bf16 a[128:131], a[220:223], v[144:147], a[128:131]
buffer_load_dwordx4 v5, s[84:87], s98 offen offset:3168 lds
v_mfma_f32_16x16x32_bf16 a[132:135], a[220:223], v[148:151], a[132:135]
v_mfma_f32_16x16x32_bf16 a[136:139], a[220:223], v[152:155], a[136:139]
v_mfma_f32_16x16x32_bf16 a[140:143], a[220:223], v[156:159], a[140:143]
ds_read_b64_tr_b16 a[220:221], v40 offset:8480
s_waitcnt vmcnt(27)
v_mfma_f32_16x16x32_bf16 v[64:67], a[192:195], v[160:163], v[64:67]
ds_read_b64_tr_b16 a[222:223], v40 offset:12704
s_waitcnt vmcnt(26)
v_mfma_f32_16x16x32_bf16 v[68:71], a[192:195], v[164:167], v[68:71]
s_add_u32 s99, s70, s79
s_waitcnt vmcnt(25)
v_mfma_f32_16x16x32_bf16 v[72:75], a[192:195], v[168:171], v[72:75]
buffer_load_dwordx4 v[136:139], v11, s[80:83], s99 offen sc1
s_waitcnt vmcnt(25)
v_mfma_f32_16x16x32_bf16 v[76:79], a[192:195], v[172:175], v[76:79]
s_waitcnt vmcnt(24)
v_mfma_f32_16x16x32_bf16 v[80:83], a[192:195], v[176:179], v[80:83]
s_waitcnt vmcnt(23)
v_mfma_f32_16x16x32_bf16 v[84:87], a[192:195], v[180:183], v[84:87]
buffer_load_dwordx4 v[140:143], v12, s[80:83], s99 offen sc1
s_waitcnt vmcnt(16)
ds_read_b64_tr_b16 a[192:193], v17 offset:16896
v_mfma_f32_16x16x32_bf16 v[88:91], a[196:199], v[160:163], v[88:91]
ds_read_b64_tr_b16 a[194:195], v17 offset:21120
v_mfma_f32_16x16x32_bf16 v[92:95], a[196:199], v[164:167], v[92:95]
v_mfma_f32_16x16x32_bf16 v[96:99], a[196:199], v[168:171], v[96:99]
buffer_load_dwordx4 v[144:147], v13, s[80:83], s99 offen sc1
v_mfma_f32_16x16x32_bf16 v[100:103], a[196:199], v[172:175], v[100:103]
v_mfma_f32_16x16x32_bf16 v[104:107], a[196:199], v[176:179], v[104:107]
v_mfma_f32_16x16x32_bf16 v[108:111], a[196:199], v[180:183], v[108:111]
buffer_load_dwordx4 v[148:151], v14, s[80:83], s99 offen sc1
ds_read_b64_tr_b16 a[196:197], v17 offset:16928
v_mfma_f32_16x16x32_bf16 a[0:3], a[200:203], v[160:163], a[0:3]
ds_read_b64_tr_b16 a[198:199], v17 offset:21152
v_mfma_f32_16x16x32_bf16 a[4:7], a[200:203], v[164:167], a[4:7]
v_mfma_f32_16x16x32_bf16 a[8:11], a[200:203], v[168:171], a[8:11]
buffer_load_dwordx4 v[152:155], v15, s[80:83], s99 offen sc1
v_mfma_f32_16x16x32_bf16 a[12:15], a[200:203], v[172:175], a[12:15]
v_mfma_f32_16x16x32_bf16 a[16:19], a[200:203], v[176:179], a[16:19]
v_mfma_f32_16x16x32_bf16 a[20:23], a[200:203], v[180:183], a[20:23]
buffer_load_dwordx4 v[156:159], v16, s[80:83], s99 offen sc1
ds_read_b64_tr_b16 a[200:201], v18 offset:16896
v_mfma_f32_16x16x32_bf16 a[24:27], a[204:207], v[160:163], a[24:27]
s_add_u32 s70, s70, 1024
ds_read_b64_tr_b16 a[202:203], v18 offset:21120
v_mfma_f32_16x16x32_bf16 a[28:31], a[204:207], v[164:167], a[28:31]
s_and_b32 s70, s70, 16383
v_mfma_f32_16x16x32_bf16 a[32:35], a[204:207], v[168:171], a[32:35]
s_lshl_b32 s97, s70, 5
v_mfma_f32_16x16x32_bf16 a[36:39], a[204:207], v[172:175], a[36:39]
s_add_u32 s97, s97, s96
v_mfma_f32_16x16x32_bf16 a[40:43], a[204:207], v[176:179], a[40:43]
s_add_u32 m0, s78, 0
v_mfma_f32_16x16x32_bf16 a[44:47], a[204:207], v[180:183], a[44:47]
buffer_load_dwordx4 v2, s[84:87], s97 offen lds
ds_read_b64_tr_b16 a[204:205], v18 offset:16928
s_waitcnt lgkmcnt(2)
v_mfma_f32_16x16x32_bf16 a[48:51], a[208:211], v[160:163], a[48:51]
ds_read_b64_tr_b16 a[206:207], v18 offset:21152
v_mfma_f32_16x16x32_bf16 a[52:55], a[208:211], v[164:167], a[52:55]
v_mfma_f32_16x16x32_bf16 a[56:59], a[208:211], v[168:171], a[56:59]
buffer_load_dwordx4 v3, s[84:87], s97 offen offset:1056 lds
v_mfma_f32_16x16x32_bf16 a[60:63], a[208:211], v[172:175], a[60:63]
v_mfma_f32_16x16x32_bf16 a[64:67], a[208:211], v[176:179], a[64:67]
v_mfma_f32_16x16x32_bf16 a[68:71], a[208:211], v[180:183], a[68:71]
buffer_load_dwordx4 v4, s[84:87], s97 offen offset:2112 lds
ds_read_b64_tr_b16 a[208:209], v39 offset:16896
v_mfma_f32_16x16x32_bf16 a[72:75], a[212:215], v[160:163], a[72:75]
ds_read_b64_tr_b16 a[210:211], v39 offset:21120
v_mfma_f32_16x16x32_bf16 a[76:79], a[212:215], v[164:167], a[76:79]
v_mfma_f32_16x16x32_bf16 a[80:83], a[212:215], v[168:171], a[80:83]
buffer_load_dwordx4 v5, s[84:87], s97 offen offset:3168 lds
v_mfma_f32_16x16x32_bf16 a[84:87], a[212:215], v[172:175], a[84:87]
s_add_u32 s98, s97, 16384
v_mfma_f32_16x16x32_bf16 a[88:91], a[212:215], v[176:179], a[88:91]
s_add_u32 m0, s78, 4224
v_mfma_f32_16x16x32_bf16 a[92:95], a[212:215], v[180:183], a[92:95]
buffer_load_dwordx4 v2, s[84:87], s98 offen lds
ds_read_b64_tr_b16 a[212:213], v39 offset:16928
v_mfma_f32_16x16x32_bf16 a[96:99], a[216:219], v[160:163], a[96:99]
ds_read_b64_tr_b16 a[214:215], v39 offset:21152
v_mfma_f32_16x16x32_bf16 a[100:103], a[216:219], v[164:167], a[100:103]
v_mfma_f32_16x16x32_bf16 a[104:107], a[216:219], v[168:171], a[104:107]
buffer_load_dwordx4 v3, s[84:87], s98 offen offset:1056 lds
v_mfma_f32_16x16x32_bf16 a[108:111], a[216:219], v[172:175], a[108:111]
v_mfma_f32_16x16x32_bf16 a[112:115], a[216:219], v[176:179], a[112:115]
v_mfma_f32_16x16x32_bf16 a[116:119], a[216:219], v[180:183], a[116:119]
buffer_load_dwordx4 v4, s[84:87], s98 offen offset:2112 lds
ds_read_b64_tr_b16 a[216:217], v40 offset:16896
v_mfma_f32_16x16x32_bf16 a[120:123], a[220:223], v[160:163], a[120:123]
ds_read_b64_tr_b16 a[218:219], v40 offset:21120
v_mfma_f32_16x16x32_bf16 a[124:127], a[220:223], v[164:167], a[124:127]
v_mfma_f32_16x16x32_bf16 a[128:131], a[220:223], v[168:171], a[128:131]
buffer_load_dwordx4 v5, s[84:87], s98 offen offset:3168 lds
v_mfma_f32_16x16x32_bf16 a[132:135], a[220:223], v[172:175], a[132:135]
v_mfma_f32_16x16x32_bf16 a[136:139], a[220:223], v[176:179], a[136:139]
v_mfma_f32_16x16x32_bf16 a[140:143], a[220:223], v[180:183], a[140:143]
ds_read_b64_tr_b16 a[220:221], v40 offset:16928
s_waitcnt vmcnt(27)
v_mfma_f32_16x16x32_bf16 v[64:67], a[192:195], v[112:115], v[64:67]
ds_read_b64_tr_b16 a[222:223], v40 offset:21152
s_waitcnt vmcnt(26)
v_mfma_f32_16x16x32_bf16 v[68:71], a[192:195], v[116:119], v[68:71]
s_add_u32 s99, s70, s79
s_waitcnt vmcnt(25)
v_mfma_f32_16x16x32_bf16 v[72:75], a[192:195], v[120:123], v[72:75]
buffer_load_dwordx4 v[160:163], v11, s[80:83], s99 offen sc1
s_waitcnt vmcnt(25)
v_mfma_f32_16x16x32_bf16 v[76:79], a[192:195], v[124:127], v[76:79]
s_waitcnt vmcnt(24)
v_mfma_f32_16x16x32_bf16 v[80:83], a[192:195], v[128:131], v[80:83]
s_waitcnt vmcnt(23)
v_mfma_f32_16x16x32_bf16 v[84:87], a[192:195], v[132:135], v[84:87]
buffer_load_dwordx4 v[164:167], v12, s[80:83], s99 offen sc1
s_waitcnt vmcnt(16)
ds_read_b64_tr_b16 a[192:193], v17 offset:25344
v_mfma_f32_16x16x32_bf16 v[88:91], a[196:199], v[112:115], v[88:91]
ds_read_b64_tr_b16 a[194:195], v17 offset:29568
v_mfma_f32_16x16x32_bf16 v[92:95], a[196:199], v[116:119], v[92:95]
v_mfma_f32_16x16x32_bf16 v[96:99], a[196:199], v[120:123], v[96:99]
buffer_load_dwordx4 v[168:171], v13, s[80:83], s99 offen sc1
v_mfma_f32_16x16x32_bf16 v[100:103], a[196:199], v[124:127], v[100:103]
v_mfma_f32_16x16x32_bf16 v[104:107], a[196:199], v[128:131], v[104:107]
v_mfma_f32_16x16x32_bf16 v[108:111], a[196:199], v[132:135], v[108:111]
buffer_load_dwordx4 v[172:175], v14, s[80:83], s99 offen sc1
ds_read_b64_tr_b16 a[196:197], v17 offset:25376
s_waitcnt lgkmcnt(3)
v_mfma_f32_16x16x32_bf16 a[0:3], a[200:203], v[112:115], a[0:3]
ds_read_b64_tr_b16 a[198:199], v17 offset:29600
v_mfma_f32_16x16x32_bf16 a[4:7], a[200:203], v[116:119], a[4:7]
v_mfma_f32_16x16x32_bf16 a[8:11], a[200:203], v[120:123], a[8:11]
buffer_load_dwordx4 v[176:179], v15, s[80:83], s99 offen sc1
v_mfma_f32_16x16x32_bf16 a[12:15], a[200:203], v[124:127], a[12:15]
v_mfma_f32_16x16x32_bf16 a[16:19], a[200:203], v[128:131], a[16:19]
v_mfma_f32_16x16x32_bf16 a[20:23], a[200:203], v[132:135], a[20:23]
buffer_load_dwordx4 v[180:183], v16, s[80:83], s99 offen sc1
ds_read_b64_tr_b16 a[200:201], v18 offset:25344
v_mfma_f32_16x16x32_bf16 a[24:27], a[204:207], v[112:115], a[24:27]
s_add_u32 s70, s70, 1024
ds_read_b64_tr_b16 a[202:203], v18 offset:29568
v_mfma_f32_16x16x32_bf16 a[28:31], a[204:207], v[116:119], a[28:31]
s_and_b32 s70, s70, 16383
v_mfma_f32_16x16x32_bf16 a[32:35], a[204:207], v[120:123], a[32:35]
s_lshl_b32 s97, s70, 5
v_mfma_f32_16x16x32_bf16 a[36:39], a[204:207], v[124:127], a[36:39]
s_add_u32 s97, s97, s96
v_mfma_f32_16x16x32_bf16 a[40:43], a[204:207], v[128:131], a[40:43]
s_add_u32 m0, s78, 8448
v_mfma_f32_16x16x32_bf16 a[44:47], a[204:207], v[132:135], a[44:47]
buffer_load_dwordx4 v2, s[84:87], s97 offen lds
ds_read_b64_tr_b16 a[204:205], v18 offset:25376
v_mfma_f32_16x16x32_bf16 a[48:51], a[208:211], v[112:115], a[48:51]
ds_read_b64_tr_b16 a[206:207], v18 offset:29600
v_mfma_f32_16x16x32_bf16 a[52:55], a[208:211], v[116:119], a[52:55]
v_mfma_f32_16x16x32_bf16 a[56:59], a[208:211], v[120:123], a[56:59]
buffer_load_dwordx4 v3, s[84:87], s97 offen offset:1056 lds
v_mfma_f32_16x16x32_bf16 a[60:63], a[208:211], v[124:127], a[60:63]
v_mfma_f32_16x16x32_bf16 a[64:67], a[208:211], v[128:131], a[64:67]
v_mfma_f32_16x16x32_bf16 a[68:71], a[208:211], v[132:135], a[68:71]
buffer_load_dwordx4 v4, s[84:87], s97 offen offset:2112 lds
ds_read_b64_tr_b16 a[208:209], v39 offset:25344
v_mfma_f32_16x16x32_bf16 a[72:75], a[212:215], v[112:115], a[72:75]
ds_read_b64_tr_b16 a[210:211], v39 offset:29568
v_mfma_f32_16x16x32_bf16 a[76:79], a[212:215], v[116:119], a[76:79]
v_mfma_f32_16x16x32_bf16 a[80:83], a[212:215], v[120:123], a[80:83]
buffer_load_dwordx4 v5, s[84:87], s97 offen offset:3168 lds
v_mfma_f32_16x16x32_bf16 a[84:87], a[212:215], v[124:127], a[84:87]
s_add_u32 s98, s97, 16384
v_mfma_f32_16x16x32_bf16 a[88:91], a[212:215], v[128:131], a[88:91]
s_add_u32 m0, s78, 12672
v_mfma_f32_16x16x32_bf16 a[92:95], a[212:215], v[132:135], a[92:95]
buffer_load_dwordx4 v2, s[84:87], s98 offen lds
ds_read_b64_tr_b16 a[212:213], v39 offset:25376
v_mfma_f32_16x16x32_bf16 a[96:99], a[216:219], v[112:115], a[96:99]
ds_read_b64_tr_b16 a[214:215], v39 offset:29600
v_mfma_f32_16x16x32_bf16 a[100:103], a[216:219], v[116:119], a[100:103]
v_mfma_f32_16x16x32_bf16 a[104:107], a[216:219], v[120:123], a[104:107]
buffer_load_dwordx4 v3, s[84:87], s98 offen offset:1056 lds
v_mfma_f32_16x16x32_bf16 a[108:111], a[216:219], v[124:127], a[108:111]
v_mfma_f32_16x16x32_bf16 a[112:115], a[216:219], v[128:131], a[112:115]
v_mfma_f32_16x16x32_bf16 a[116:119], a[216:219], v[132:135], a[116:119]
buffer_load_dwordx4 v4, s[84:87], s98 offen offset:2112 lds
ds_read_b64_tr_b16 a[216:217], v40 offset:25344
v_mfma_f32_16x16x32_bf16 a[120:123], a[220:223], v[112:115], a[120:123]
ds_read_b64_tr_b16 a[218:219], v40 offset:29568
v_mfma_f32_16x16x32_bf16 a[124:127], a[220:223], v[116:119], a[124:127]
v_mfma_f32_16x16x32_bf16 a[128:131], a[220:223], v[120:123], a[128:131]
buffer_load_dwordx4 v5, s[84:87], s98 offen offset:3168 lds
v_mfma_f32_16x16x32_bf16 a[132:135], a[220:223], v[124:127], a[132:135]
v_mfma_f32_16x16x32_bf16 a[136:139], a[220:223], v[128:131], a[136:139]
v_mfma_f32_16x16x32_bf16 a[140:143], a[220:223], v[132:135], a[140:143]
ds_read_b64_tr_b16 a[220:221], v40 offset:25376
s_waitcnt vmcnt(27) lgkmcnt(3)
v_mfma_f32_16x16x32_bf16 v[64:67], a[192:195], v[136:139], v[64:67]
ds_read_b64_tr_b16 a[222:223], v40 offset:29600
s_waitcnt vmcnt(26)
v_mfma_f32_16x16x32_bf16 v[68:71], a[192:195], v[140:143], v[68:71]
s_add_u32 s99, s70, s79
s_waitcnt vmcnt(25)
v_mfma_f32_16x16x32_bf16 v[72:75], a[192:195], v[144:147], v[72:75]
buffer_load_dwordx4 v[112:115], v11, s[80:83], s99 offen sc1
s_waitcnt vmcnt(25)
v_mfma_f32_16x16x32_bf16 v[76:79], a[192:195], v[148:151], v[76:79]
s_waitcnt vmcnt(24)
v_mfma_f32_16x16x32_bf16 v[80:83], a[192:195], v[152:155], v[80:83]
s_waitcnt vmcnt(23)
v_mfma_f32_16x16x32_bf16 v[84:87], a[192:195], v[156:159], v[84:87]
buffer_load_dwordx4 v[116:119], v12, s[80:83], s99 offen sc1
s_waitcnt vmcnt(16)
ds_read_b64_tr_b16 a[192:193], v17
v_mfma_f32_16x16x32_bf16 v[88:91], a[196:199], v[136:139], v[88:91]
ds_read_b64_tr_b16 a[194:195], v17 offset:4224
v_mfma_f32_16x16x32_bf16 v[92:95], a[196:199], v[140:143], v[92:95]
v_mfma_f32_16x16x32_bf16 v[96:99], a[196:199], v[144:147], v[96:99]
buffer_load_dwordx4 v[120:123], v13, s[80:83], s99 offen sc1
v_mfma_f32_16x16x32_bf16 v[100:103], a[196:199], v[148:151], v[100:103]
v_mfma_f32_16x16x32_bf16 v[104:107], a[196:199], v[152:155], v[104:107]
v_mfma_f32_16x16x32_bf16 v[108:111], a[196:199], v[156:159], v[108:111]
buffer_load_dwordx4 v[124:127], v14, s[80:83], s99 offen sc1
ds_read_b64_tr_b16 a[196:197], v17 offset:32
v_mfma_f32_16x16x32_bf16 a[0:3], a[200:203], v[136:139], a[0:3]
ds_read_b64_tr_b16 a[198:199], v17 offset:4256
v_mfma_f32_16x16x32_bf16 a[4:7], a[200:203], v[140:143], a[4:7]
v_mfma_f32_16x16x32_bf16 a[8:11], a[200:203], v[144:147], a[8:11]
buffer_load_dwordx4 v[128:131], v15, s[80:83], s99 offen sc1
v_mfma_f32_16x16x32_bf16 a[12:15], a[200:203], v[148:151], a[12:15]
v_mfma_f32_16x16x32_bf16 a[16:19], a[200:203], v[152:155], a[16:19]
v_mfma_f32_16x16x32_bf16 a[20:23], a[200:203], v[156:159], a[20:23]
buffer_load_dwordx4 v[132:135], v16, s[80:83], s99 offen sc1
ds_read_b64_tr_b16 a[200:201], v18
v_mfma_f32_16x16x32_bf16 a[24:27], a[204:207], v[136:139], a[24:27]
s_add_u32 s70, s70, 1024
ds_read_b64_tr_b16 a[202:203], v18 offset:4224
v_mfma_f32_16x16x32_bf16 a[28:31], a[204:207], v[140:143], a[28:31]
s_and_b32 s70, s70, 16383
v_mfma_f32_16x16x32_bf16 a[32:35], a[204:207], v[144:147], a[32:35]
s_lshl_b32 s97, s70, 5
v_mfma_f32_16x16x32_bf16 a[36:39], a[204:207], v[148:151], a[36:39]
s_add_u32 s97, s97, s96
v_mfma_f32_16x16x32_bf16 a[40:43], a[204:207], v[152:155], a[40:43]
s_add_u32 m0, s78, 16896
v_mfma_f32_16x16x32_bf16 a[44:47], a[204:207], v[156:159], a[44:47]
buffer_load_dwordx4 v2, s[84:87], s97 offen lds
ds_read_b64_tr_b16 a[204:205], v18 offset:32
v_mfma_f32_16x16x32_bf16 a[48:51], a[208:211], v[136:139], a[48:51]
ds_read_b64_tr_b16 a[206:207], v18 offset:4256
v_mfma_f32_16x16x32_bf16 a[52:55], a[208:211], v[140:143], a[52:55]
v_mfma_f32_16x16x32_bf16 a[56:59], a[208:211], v[144:147], a[56:59]
buffer_load_dwordx4 v3, s[84:87], s97 offen offset:1056 lds
v_mfma_f32_16x16x32_bf16 a[60:63], a[208:211], v[148:151], a[60:63]
v_mfma_f32_16x16x32_bf16 a[64:67], a[208:211], v[152:155], a[64:67]
v_mfma_f32_16x16x32_bf16 a[68:71], a[208:211], v[156:159], a[68:71]
buffer_load_dwordx4 v4, s[84:87], s97 offen offset:2112 lds
ds_read_b64_tr_b16 a[208:209], v39
v_mfma_f32_16x16x32_bf16 a[72:75], a[212:215], v[136:139], a[72:75]
ds_read_b64_tr_b16 a[210:211], v39 offset:4224
v_mfma_f32_16x16x32_bf16 a[76:79], a[212:215], v[140:143], a[76:79]
v_mfma_f32_16x16x32_bf16 a[80:83], a[212:215], v[144:147], a[80:83]
buffer_load_dwordx4 v5, s[84:87], s97 offen offset:3168 lds
v_mfma_f32_16x16x32_bf16 a[84:87], a[212:215], v[148:151], a[84:87]
s_add_u32 s98, s97, 16384
v_mfma_f32_16x16x32_bf16 a[88:91], a[212:215], v[152:155], a[88:91]
s_add_u32 m0, s78, 21120
v_mfma_f32_16x16x32_bf16 a[92:95], a[212:215], v[156:159], a[92:95]
buffer_load_dwordx4 v2, s[84:87], s98 offen lds
ds_read_b64_tr_b16 a[212:213], v39 offset:32
s_waitcnt lgkmcnt(3)
v_mfma_f32_16x16x32_bf16 a[96:99], a[216:219], v[136:139], a[96:99]
ds_read_b64_tr_b16 a[214:215], v39 offset:4256
v_mfma_f32_16x16x32_bf16 a[100:103], a[216:219], v[140:143], a[100:103]
v_mfma_f32_16x16x32_bf16 a[104:107], a[216:219], v[144:147], a[104:107]
buffer_load_dwordx4 v3, s[84:87], s98 offen offset:1056 lds
v_mfma_f32_16x16x32_bf16 a[108:111], a[216:219], v[148:151], a[108:111]
v_mfma_f32_16x16x32_bf16 a[112:115], a[216:219], v[152:155], a[112:115]
v_mfma_f32_16x16x32_bf16 a[116:119], a[216:219], v[156:159], a[116:119]
buffer_load_dwordx4 v4, s[84:87], s98 offen offset:2112 lds
ds_read_b64_tr_b16 a[216:217], v40
v_mfma_f32_16x16x32_bf16 a[120:123], a[220:223], v[136:139], a[120:123]
ds_read_b64_tr_b16 a[218:219], v40 offset:4224
v_mfma_f32_16x16x32_bf16 a[124:127], a[220:223], v[140:143], a[124:127]
v_mfma_f32_16x16x32_bf16 a[128:131], a[220:223], v[144:147], a[128:131]
buffer_load_dwordx4 v5, s[84:87], s98 offen offset:3168 lds
v_mfma_f32_16x16x32_bf16 a[132:135], a[220:223], v[148:151], a[132:135]
v_mfma_f32_16x16x32_bf16 a[136:139], a[220:223], v[152:155], a[136:139]
v_mfma_f32_16x16x32_bf16 a[140:143], a[220:223], v[156:159], a[140:143]
ds_read_b64_tr_b16 a[220:221], v40 offset:32
s_waitcnt vmcnt(27)
v_mfma_f32_16x16x32_bf16 v[64:67], a[192:195], v[160:163], v[64:67]
ds_read_b64_tr_b16 a[222:223], v40 offset:4256
s_waitcnt vmcnt(26)
v_mfma_f32_16x16x32_bf16 v[68:71], a[192:195], v[164:167], v[68:71]
s_add_u32 s99, s70, s79
s_waitcnt vmcnt(25)
v_mfma_f32_16x16x32_bf16 v[72:75], a[192:195], v[168:171], v[72:75]
buffer_load_dwordx4 v[136:139], v11, s[80:83], s99 offen sc1
s_waitcnt vmcnt(25)
v_mfma_f32_16x16x32_bf16 v[76:79], a[192:195], v[172:175], v[76:79]
s_waitcnt vmcnt(24)
v_mfma_f32_16x16x32_bf16 v[80:83], a[192:195], v[176:179], v[80:83]
s_waitcnt vmcnt(23)
v_mfma_f32_16x16x32_bf16 v[84:87], a[192:195], v[180:183], v[84:87]
buffer_load_dwordx4 v[140:143], v12, s[80:83], s99 offen sc1
s_waitcnt vmcnt(16)
ds_read_b64_tr_b16 a[192:193], v17 offset:8448
v_mfma_f32_16x16x32_bf16 v[88:91], a[196:199], v[160:163], v[88:91]
ds_read_b64_tr_b16 a[194:195], v17 offset:12672
v_mfma_f32_16x16x32_bf16 v[92:95], a[196:199], v[164:167], v[92:95]
v_mfma_f32_16x16x32_bf16 v[96:99], a[196:199], v[168:171], v[96:99]
buffer_load_dwordx4 v[144:147], v13, s[80:83], s99 offen sc1
v_mfma_f32_16x16x32_bf16 v[100:103], a[196:199], v[172:175], v[100:103]
v_mfma_f32_16x16x32_bf16 v[104:107], a[196:199], v[176:179], v[104:107]
v_mfma_f32_16x16x32_bf16 v[108:111], a[196:199], v[180:183], v[108:111]
buffer_load_dwordx4 v[148:151], v14, s[80:83], s99 offen sc1
ds_read_b64_tr_b16 a[196:197], v17 offset:8480
v_mfma_f32_16x16x32_bf16 a[0:3], a[200:203], v[160:163], a[0:3]
ds_read_b64_tr_b16 a[198:199], v17 offset:12704
v_mfma_f32_16x16x32_bf16 a[4:7], a[200:203], v[164:167], a[4:7]
v_mfma_f32_16x16x32_bf16 a[8:11], a[200:203], v[168:171], a[8:11]
buffer_load_dwordx4 v[152:155], v15, s[80:83], s99 offen sc1
v_mfma_f32_16x16x32_bf16 a[12:15], a[200:203], v[172:175], a[12:15]
v_mfma_f32_16x16x32_bf16 a[16:19], a[200:203], v[176:179], a[16:19]
v_mfma_f32_16x16x32_bf16 a[20:23], a[200:203], v[180:183], a[20:23]
buffer_load_dwordx4 v[156:159], v16, s[80:83], s99 offen sc1
ds_read_b64_tr_b16 a[200:201], v18 offset:8448
v_mfma_f32_16x16x32_bf16 a[24:27], a[204:207], v[160:163], a[24:27]
s_add_u32 s70, s70, 1024
ds_read_b64_tr_b16 a[202:203], v18 offset:12672
v_mfma_f32_16x16x32_bf16 a[28:31], a[204:207], v[164:167], a[28:31]
s_and_b32 s70, s70, 16383
v_mfma_f32_16x16x32_bf16 a[32:35], a[204:207], v[168:171], a[32:35]
s_lshl_b32 s97, s70, 5
v_mfma_f32_16x16x32_bf16 a[36:39], a[204:207], v[172:175], a[36:39]
s_add_u32 s97, s97, s96
v_mfma_f32_16x16x32_bf16 a[40:43], a[204:207], v[176:179], a[40:43]
s_add_u32 m0, s78, 25344
v_mfma_f32_16x16x32_bf16 a[44:47], a[204:207], v[180:183], a[44:47]
buffer_load_dwordx4 v2, s[84:87], s97 offen lds
ds_read_b64_tr_b16 a[204:205], v18 offset:8480
s_waitcnt lgkmcnt(2)
v_mfma_f32_16x16x32_bf16 a[48:51], a[208:211], v[160:163], a[48:51]
ds_read_b64_tr_b16 a[206:207], v18 offset:12704
v_mfma_f32_16x16x32_bf16 a[52:55], a[208:211], v[164:167], a[52:55]
v_mfma_f32_16x16x32_bf16 a[56:59], a[208:211], v[168:171], a[56:59]
buffer_load_dwordx4 v3, s[84:87], s97 offen offset:1056 lds
v_mfma_f32_16x16x32_bf16 a[60:63], a[208:211], v[172:175], a[60:63]
v_mfma_f32_16x16x32_bf16 a[64:67], a[208:211], v[176:179], a[64:67]
v_mfma_f32_16x16x32_bf16 a[68:71], a[208:211], v[180:183], a[68:71]
buffer_load_dwordx4 v4, s[84:87], s97 offen offset:2112 lds
ds_read_b64_tr_b16 a[208:209], v39 offset:8448
v_mfma_f32_16x16x32_bf16 a[72:75], a[212:215], v[160:163], a[72:75]
ds_read_b64_tr_b16 a[210:211], v39 offset:12672
v_mfma_f32_16x16x32_bf16 a[76:79], a[212:215], v[164:167], a[76:79]
v_mfma_f32_16x16x32_bf16 a[80:83], a[212:215], v[168:171], a[80:83]
buffer_load_dwordx4 v5, s[84:87], s97 offen offset:3168 lds
v_mfma_f32_16x16x32_bf16 a[84:87], a[212:215], v[172:175], a[84:87]
s_add_u32 s98, s97, 16384
v_mfma_f32_16x16x32_bf16 a[88:91], a[212:215], v[176:179], a[88:91]
s_add_u32 m0, s78, 29568
v_mfma_f32_16x16x32_bf16 a[92:95], a[212:215], v[180:183], a[92:95]
buffer_load_dwordx4 v2, s[84:87], s98 offen lds
ds_read_b64_tr_b16 a[212:213], v39 offset:8480
v_mfma_f32_16x16x32_bf16 a[96:99], a[216:219], v[160:163], a[96:99]
ds_read_b64_tr_b16 a[214:215], v39 offset:12704
v_mfma_f32_16x16x32_bf16 a[100:103], a[216:219], v[164:167], a[100:103]
v_mfma_f32_16x16x32_bf16 a[104:107], a[216:219], v[168:171], a[104:107]
buffer_load_dwordx4 v3, s[84:87], s98 offen offset:1056 lds
v_mfma_f32_16x16x32_bf16 a[108:111], a[216:219], v[172:175], a[108:111]
v_mfma_f32_16x16x32_bf16 a[112:115], a[216:219], v[176:179], a[112:115]
v_mfma_f32_16x16x32_bf16 a[116:119], a[216:219], v[180:183], a[116:119]
buffer_load_dwordx4 v4, s[84:87], s98 offen offset:2112 lds
ds_read_b64_tr_b16 a[216:217], v40 offset:8448
v_mfma_f32_16x16x32_bf16 a[120:123], a[220:223], v[160:163], a[120:123]
ds_read_b64_tr_b16 a[218:219], v40 offset:12672
v_mfma_f32_16x16x32_bf16 a[124:127], a[220:223], v[164:167], a[124:127]
v_mfma_f32_16x16x32_bf16 a[128:131], a[220:223], v[168:171], a[128:131]
buffer_load_dwordx4 v5, s[84:87], s98 offen offset:3168 lds
v_mfma_f32_16x16x32_bf16 a[132:135], a[220:223], v[172:175], a[132:135]
v_mfma_f32_16x16x32_bf16 a[136:139], a[220:223], v[176:179], a[136:139]
v_mfma_f32_16x16x32_bf16 a[140:143], a[220:223], v[180:183], a[140:143]
ds_read_b64_tr_b16 a[220:221], v40 offset:8480
s_waitcnt vmcnt(27)
v_mfma_f32_16x16x32_bf16 v[64:67], a[192:195], v[112:115], v[64:67]
ds_read_b64_tr_b16 a[222:223], v40 offset:12704
s_waitcnt vmcnt(26)
v_mfma_f32_16x16x32_bf16 v[68:71], a[192:195], v[116:119], v[68:71]
s_add_u32 s99, s70, s79
s_waitcnt vmcnt(25)
v_mfma_f32_16x16x32_bf16 v[72:75], a[192:195], v[120:123], v[72:75]
buffer_load_dwordx4 v[160:163], v11, s[80:83], s99 offen sc1
s_waitcnt vmcnt(25)
v_mfma_f32_16x16x32_bf16 v[76:79], a[192:195], v[124:127], v[76:79]
s_waitcnt vmcnt(24)
v_mfma_f32_16x16x32_bf16 v[80:83], a[192:195], v[128:131], v[80:83]
s_waitcnt vmcnt(23)
v_mfma_f32_16x16x32_bf16 v[84:87], a[192:195], v[132:135], v[84:87]
buffer_load_dwordx4 v[164:167], v12, s[80:83], s99 offen sc1
s_waitcnt vmcnt(16)
ds_read_b64_tr_b16 a[192:193], v17 offset:16896
v_mfma_f32_16x16x32_bf16 v[88:91], a[196:199], v[112:115], v[88:91]
ds_read_b64_tr_b16 a[194:195], v17 offset:21120
v_mfma_f32_16x16x32_bf16 v[92:95], a[196:199], v[116:119], v[92:95]
v_mfma_f32_16x16x32_bf16 v[96:99], a[196:199], v[120:123], v[96:99]
buffer_load_dwordx4 v[168:171], v13, s[80:83], s99 offen sc1
v_mfma_f32_16x16x32_bf16 v[100:103], a[196:199], v[124:127], v[100:103]
v_mfma_f32_16x16x32_bf16 v[104:107], a[196:199], v[128:131], v[104:107]
v_mfma_f32_16x16x32_bf16 v[108:111], a[196:199], v[132:135], v[108:111]
buffer_load_dwordx4 v[172:175], v14, s[80:83], s99 offen sc1
ds_read_b64_tr_b16 a[196:197], v17 offset:16928
s_waitcnt lgkmcnt(3)
v_mfma_f32_16x16x32_bf16 a[0:3], a[200:203], v[112:115], a[0:3]
ds_read_b64_tr_b16 a[198:199], v17 offset:21152
v_mfma_f32_16x16x32_bf16 a[4:7], a[200:203], v[116:119], a[4:7]
v_mfma_f32_16x16x32_bf16 a[8:11], a[200:203], v[120:123], a[8:11]
buffer_load_dwordx4 v[176:179], v15, s[80:83], s99 offen sc1
v_mfma_f32_16x16x32_bf16 a[12:15], a[200:203], v[124:127], a[12:15]
v_mfma_f32_16x16x32_bf16 a[16:19], a[200:203], v[128:131], a[16:19]
v_mfma_f32_16x16x32_bf16 a[20:23], a[200:203], v[132:135], a[20:23]
buffer_load_dwordx4 v[180:183], v16, s[80:83], s99 offen sc1
ds_read_b64_tr_b16 a[200:201], v18 offset:16896
v_mfma_f32_16x16x32_bf16 a[24:27], a[204:207], v[112:115], a[24:27]
s_add_u32 s70, s70, 1024
ds_read_b64_tr_b16 a[202:203], v18 offset:21120
v_mfma_f32_16x16x32_bf16 a[28:31], a[204:207], v[116:119], a[28:31]
s_and_b32 s70, s70, 16383
v_mfma_f32_16x16x32_bf16 a[32:35], a[204:207], v[120:123], a[32:35]
s_lshl_b32 s97, s70, 5
v_mfma_f32_16x16x32_bf16 a[36:39], a[204:207], v[124:127], a[36:39]
s_add_u32 s97, s97, s96
v_mfma_f32_16x16x32_bf16 a[40:43], a[204:207], v[128:131], a[40:43]
s_add_u32 m0, s78, 0
v_mfma_f32_16x16x32_bf16 a[44:47], a[204:207], v[132:135], a[44:47]
buffer_load_dwordx4 v2, s[84:87], s97 offen lds
ds_read_b64_tr_b16 a[204:205], v18 offset:16928
v_mfma_f32_16x16x32_bf16 a[48:51], a[208:211], v[112:115], a[48:51]
ds_read_b64_tr_b16 a[206:207], v18 offset:21152
v_mfma_f32_16x16x32_bf16 a[52:55], a[208:211], v[116:119], a[52:55]
v_mfma_f32_16x16x32_bf16 a[56:59], a[208:211], v[120:123], a[56:59]
buffer_load_dwordx4 v3, s[84:87], s97 offen offset:1056 lds
v_mfma_f32_16x16x32_bf16 a[60:63], a[208:211], v[124:127], a[60:63]
v_mfma_f32_16x16x32_bf16 a[64:67], a[208:211], v[128:131], a[64:67]
v_mfma_f32_16x16x32_bf16 a[68:71], a[208:211], v[132:135], a[68:71]
buffer_load_dwordx4 v4, s[84:87], s97 offen offset:2112 lds
ds_read_b64_tr_b16 a[208:209], v39 offset:16896
v_mfma_f32_16x16x32_bf16 a[72:75], a[212:215], v[112:115], a[72:75]
ds_read_b64_tr_b16 a[210:211], v39 offset:21120
v_mfma_f32_16x16x32_bf16 a[76:79], a[212:215], v[116:119], a[76:79]
v_mfma_f32_16x16x32_bf16 a[80:83], a[212:215], v[120:123], a[80:83]
buffer_load_dwordx4 v5, s[84:87], s97 offen offset:3168 lds
v_mfma_f32_16x16x32_bf16 a[84:87], a[212:215], v[124:127], a[84:87]
s_add_u32 s98, s97, 16384
v_mfma_f32_16x16x32_bf16 a[88:91], a[212:215], v[128:131], a[88:91]
s_add_u32 m0, s78, 4224
v_mfma_f32_16x16x32_bf16 a[92:95], a[212:215], v[132:135], a[92:95]
buffer_load_dwordx4 v2, s[84:87], s98 offen lds
ds_read_b64_tr_b16 a[212:213], v39 offset:16928
v_mfma_f32_16x16x32_bf16 a[96:99], a[216:219], v[112:115], a[96:99]
ds_read_b64_tr_b16 a[214:215], v39 offset:21152
v_mfma_f32_16x16x32_bf16 a[100:103], a[216:219], v[116:119], a[100:103]
v_mfma_f32_16x16x32_bf16 a[104:107], a[216:219], v[120:123], a[104:107]
buffer_load_dwordx4 v3, s[84:87], s98 offen offset:1056 lds
v_mfma_f32_16x16x32_bf16 a[108:111], a[216:219], v[124:127], a[108:111]
v_mfma_f32_16x16x32_bf16 a[112:115], a[216:219], v[128:131], a[112:115]
v_mfma_f32_16x16x32_bf16 a[116:119], a[216:219], v[132:135], a[116:119]
buffer_load_dwordx4 v4, s[84:87], s98 offen offset:2112 lds
ds_read_b64_tr_b16 a[216:217], v40 offset:16896
v_mfma_f32_16x16x32_bf16 a[120:123], a[220:223], v[112:115], a[120:123]
ds_read_b64_tr_b16 a[218:219], v40 offset:21120
v_mfma_f32_16x16x32_bf16 a[124:127], a[220:223], v[116:119], a[124:127]
v_mfma_f32_16x16x32_bf16 a[128:131], a[220:223], v[120:123], a[128:131]
buffer_load_dwordx4 v5, s[84:87], s98 offen offset:3168 lds
v_mfma_f32_16x16x32_bf16 a[132:135], a[220:223], v[124:127], a[132:135]
v_mfma_f32_16x16x32_bf16 a[136:139], a[220:223], v[128:131], a[136:139]
v_mfma_f32_16x16x32_bf16 a[140:143], a[220:223], v[132:135], a[140:143]
ds_read_b64_tr_b16 a[220:221], v40 offset:16928
s_waitcnt vmcnt(27) lgkmcnt(3)
v_mfma_f32_16x16x32_bf16 v[64:67], a[192:195], v[136:139], v[64:67]
ds_read_b64_tr_b16 a[222:223], v40 offset:21152
s_waitcnt vmcnt(26)
v_mfma_f32_16x16x32_bf16 v[68:71], a[192:195], v[140:143], v[68:71]
s_add_u32 s99, s70, s79
s_waitcnt vmcnt(25)
v_mfma_f32_16x16x32_bf16 v[72:75], a[192:195], v[144:147], v[72:75]
buffer_load_dwordx4 v[112:115], v11, s[80:83], s99 offen sc1
s_waitcnt vmcnt(25)
v_mfma_f32_16x16x32_bf16 v[76:79], a[192:195], v[148:151], v[76:79]
s_waitcnt vmcnt(24)
v_mfma_f32_16x16x32_bf16 v[80:83], a[192:195], v[152:155], v[80:83]
s_waitcnt vmcnt(23)
v_mfma_f32_16x16x32_bf16 v[84:87], a[192:195], v[156:159], v[84:87]
buffer_load_dwordx4 v[116:119], v12, s[80:83], s99 offen sc1
s_waitcnt vmcnt(16)
ds_read_b64_tr_b16 a[192:193], v17 offset:25344
v_mfma_f32_16x16x32_bf16 v[88:91], a[196:199], v[136:139], v[88:91]
ds_read_b64_tr_b16 a[194:195], v17 offset:29568
v_mfma_f32_16x16x32_bf16 v[92:95], a[196:199], v[140:143], v[92:95]
v_mfma_f32_16x16x32_bf16 v[96:99], a[196:199], v[144:147], v[96:99]
buffer_load_dwordx4 v[120:123], v13, s[80:83], s99 offen sc1
v_mfma_f32_16x16x32_bf16 v[100:103], a[196:199], v[148:151], v[100:103]
v_mfma_f32_16x16x32_bf16 v[104:107], a[196:199], v[152:155], v[104:107]
v_mfma_f32_16x16x32_bf16 v[108:111], a[196:199], v[156:159], v[108:111]
buffer_load_dwordx4 v[124:127], v14, s[80:83], s99 offen sc1
ds_read_b64_tr_b16 a[196:197], v17 offset:25376
v_mfma_f32_16x16x32_bf16 a[0:3], a[200:203], v[136:139], a[0:3]
ds_read_b64_tr_b16 a[198:199], v17 offset:29600
v_mfma_f32_16x16x32_bf16 a[4:7], a[200:203], v[140:143], a[4:7]
v_mfma_f32_16x16x32_bf16 a[8:11], a[200:203], v[144:147], a[8:11]
buffer_load_dwordx4 v[128:131], v15, s[80:83], s99 offen sc1
v_mfma_f32_16x16x32_bf16 a[12:15], a[200:203], v[148:151], a[12:15]
v_mfma_f32_16x16x32_bf16 a[16:19], a[200:203], v[152:155], a[16:19]
v_mfma_f32_16x16x32_bf16 a[20:23], a[200:203], v[156:159], a[20:23]
buffer_load_dwordx4 v[132:135], v16, s[80:83], s99 offen sc1
ds_read_b64_tr_b16 a[200:201], v18 offset:25344
v_mfma_f32_16x16x32_bf16 a[24:27], a[204:207], v[136:139], a[24:27]
s_add_u32 s70, s70, 1024
ds_read_b64_tr_b16 a[202:203], v18 offset:29568
v_mfma_f32_16x16x32_bf16 a[28:31], a[204:207], v[140:143], a[28:31]
s_and_b32 s70, s70, 16383
v_mfma_f32_16x16x32_bf16 a[32:35], a[204:207], v[144:147], a[32:35]
s_lshl_b32 s97, s70, 5
v_mfma_f32_16x16x32_bf16 a[36:39], a[204:207], v[148:151], a[36:39]
s_add_u32 s97, s97, s96
v_mfma_f32_16x16x32_bf16 a[40:43], a[204:207], v[152:155], a[40:43]
s_add_u32 m0, s78, 8448
v_mfma_f32_16x16x32_bf16 a[44:47], a[204:207], v[156:159], a[44:47]
buffer_load_dwordx4 v2, s[84:87], s97 offen lds
ds_read_b64_tr_b16 a[204:205], v18 offset:25376
v_mfma_f32_16x16x32_bf16 a[48:51], a[208:211], v[136:139], a[48:51]
ds_read_b64_tr_b16 a[206:207], v18 offset:29600
v_mfma_f32_16x16x32_bf16 a[52:55], a[208:211], v[140:143], a[52:55]
v_mfma_f32_16x16x32_bf16 a[56:59], a[208:211], v[144:147], a[56:59]
buffer_load_dwordx4 v3, s[84:87], s97 offen offset:1056 lds
v_mfma_f32_16x16x32_bf16 a[60:63], a[208:211], v[148:151], a[60:63]
v_mfma_f32_16x16x32_bf16 a[64:67], a[208:211], v[152:155], a[64:67]
v_mfma_f32_16x16x32_bf16 a[68:71], a[208:211], v[156:159], a[68:71]
buffer_load_dwordx4 v4, s[84:87], s97 offen offset:2112 lds
ds_read_b64_tr_b16 a[208:209], v39 offset:25344
v_mfma_f32_16x16x32_bf16 a[72:75], a[212:215], v[136:139], a[72:75]
ds_read_b64_tr_b16 a[210:211], v39 offset:29568
v_mfma_f32_16x16x32_bf16 a[76:79], a[212:215], v[140:143], a[76:79]
v_mfma_f32_16x16x32_bf16 a[80:83], a[212:215], v[144:147], a[80:83]
buffer_load_dwordx4 v5, s[84:87], s97 offen offset:3168 lds
v_mfma_f32_16x16x32_bf16 a[84:87], a[212:215], v[148:151], a[84:87]
s_add_u32 s98, s97, 16384
v_mfma_f32_16x16x32_bf16 a[88:91], a[212:215], v[152:155], a[88:91]
s_add_u32 m0, s78, 12672
v_mfma_f32_16x16x32_bf16 a[92:95], a[212:215], v[156:159], a[92:95]
buffer_load_dwordx4 v2, s[84:87], s98 offen lds
ds_read_b64_tr_b16 a[212:213], v39 offset:25376
s_waitcnt lgkmcnt(3)
v_mfma_f32_16x16x32_bf16 a[96:99], a[216:219], v[136:139], a[96:99]
ds_read_b64_tr_b16 a[214:215], v39 offset:29600
v_mfma_f32_16x16x32_bf16 a[100:103], a[216:219], v[140:143], a[100:103]
v_mfma_f32_16x16x32_bf16 a[104:107], a[216:219], v[144:147], a[104:107]
buffer_load_dwordx4 v3, s[84:87], s98 offen offset:1056 lds
v_mfma_f32_16x16x32_bf16 a[108:111], a[216:219], v[148:151], a[108:111]
v_mfma_f32_16x16x32_bf16 a[112:115], a[216:219], v[152:155], a[112:115]
v_mfma_f32_16x16x32_bf16 a[116:119], a[216:219], v[156:159], a[116:119]
buffer_load_dwordx4 v4, s[84:87], s98 offen offset:2112 lds
ds_read_b64_tr_b16 a[216:217], v40 offset:25344
v_mfma_f32_16x16x32_bf16 a[120:123], a[220:223], v[136:139], a[120:123]
ds_read_b64_tr_b16 a[218:219], v40 offset:29568
v_mfma_f32_16x16x32_bf16 a[124:127], a[220:223], v[140:143], a[124:127]
v_mfma_f32_16x16x32_bf16 a[128:131], a[220:223], v[144:147], a[128:131]
buffer_load_dwordx4 v5, s[84:87], s98 offen offset:3168 lds
v_mfma_f32_16x16x32_bf16 a[132:135], a[220:223], v[148:151], a[132:135]
v_mfma_f32_16x16x32_bf16 a[136:139], a[220:223], v[152:155], a[136:139]
v_mfma_f32_16x16x32_bf16 a[140:143], a[220:223], v[156:159], a[140:143]
ds_read_b64_tr_b16 a[220:221], v40 offset:25376
s_waitcnt vmcnt(27)
v_mfma_f32_16x16x32_bf16 v[64:67], a[192:195], v[160:163], v[64:67]
ds_read_b64_tr_b16 a[222:223], v40 offset:29600
s_waitcnt vmcnt(26)
v_mfma_f32_16x16x32_bf16 v[68:71], a[192:195], v[164:167], v[68:71]
s_add_u32 s99, s70, s79
s_waitcnt vmcnt(25)
v_mfma_f32_16x16x32_bf16 v[72:75], a[192:195], v[168:171], v[72:75]
buffer_load_dwordx4 v[136:139], v11, s[80:83], s99 offen sc1
s_waitcnt vmcnt(25)
v_mfma_f32_16x16x32_bf16 v[76:79], a[192:195], v[172:175], v[76:79]
s_waitcnt vmcnt(24)
v_mfma_f32_16x16x32_bf16 v[80:83], a[192:195], v[176:179], v[80:83]
s_waitcnt vmcnt(23)
v_mfma_f32_16x16x32_bf16 v[84:87], a[192:195], v[180:183], v[84:87]
buffer_load_dwordx4 v[140:143], v12, s[80:83], s99 offen sc1
s_waitcnt vmcnt(16)
ds_read_b64_tr_b16 a[192:193], v17
v_mfma_f32_16x16x32_bf16 v[88:91], a[196:199], v[160:163], v[88:91]
ds_read_b64_tr_b16 a[194:195], v17 offset:4224
v_mfma_f32_16x16x32_bf16 v[92:95], a[196:199], v[164:167], v[92:95]
v_mfma_f32_16x16x32_bf16 v[96:99], a[196:199], v[168:171], v[96:99]
buffer_load_dwordx4 v[144:147], v13, s[80:83], s99 offen sc1
v_mfma_f32_16x16x32_bf16 v[100:103], a[196:199], v[172:175], v[100:103]
v_mfma_f32_16x16x32_bf16 v[104:107], a[196:199], v[176:179], v[104:107]
v_mfma_f32_16x16x32_bf16 v[108:111], a[196:199], v[180:183], v[108:111]
buffer_load_dwordx4 v[148:151], v14, s[80:83], s99 offen sc1
ds_read_b64_tr_b16 a[196:197], v17 offset:32
v_mfma_f32_16x16x32_bf16 a[0:3], a[200:203], v[160:163], a[0:3]
ds_read_b64_tr_b16 a[198:199], v17 offset:4256
v_mfma_f32_16x16x32_bf16 a[4:7], a[200:203], v[164:167], a[4:7]
v_mfma_f32_16x16x32_bf16 a[8:11], a[200:203], v[168:171], a[8:11]
buffer_load_dwordx4 v[152:155], v15, s[80:83], s99 offen sc1
v_mfma_f32_16x16x32_bf16 a[12:15], a[200:203], v[172:175], a[12:15]
v_mfma_f32_16x16x32_bf16 a[16:19], a[200:203], v[176:179], a[16:19]
v_mfma_f32_16x16x32_bf16 a[20:23], a[200:203], v[180:183], a[20:23]
buffer_load_dwordx4 v[156:159], v16, s[80:83], s99 offen sc1
ds_read_b64_tr_b16 a[200:201], v18
v_mfma_f32_16x16x32_bf16 a[24:27], a[204:207], v[160:163], a[24:27]
s_add_u32 s70, s70, 1024
ds_read_b64_tr_b16 a[202:203], v18 offset:4224
v_mfma_f32_16x16x32_bf16 a[28:31], a[204:207], v[164:167], a[28:31]
s_and_b32 s70, s70, 16383
v_mfma_f32_16x16x32_bf16 a[32:35], a[204:207], v[168:171], a[32:35]
s_lshl_b32 s97, s70, 5
v_mfma_f32_16x16x32_bf16 a[36:39], a[204:207], v[172:175], a[36:39]
s_add_u32 s97, s97, s96
v_mfma_f32_16x16x32_bf16 a[40:43], a[204:207], v[176:179], a[40:43]
s_add_u32 m0, s78, 16896
v_mfma_f32_16x16x32_bf16 a[44:47], a[204:207], v[180:183], a[44:47]
buffer_load_dwordx4 v2, s[84:87], s97 offen lds
ds_read_b64_tr_b16 a[204:205], v18 offset:32
s_waitcnt lgkmcnt(2)
v_mfma_f32_16x16x32_bf16 a[48:51], a[208:211], v[160:163], a[48:51]
ds_read_b64_tr_b16 a[206:207], v18 offset:4256
v_mfma_f32_16x16x32_bf16 a[52:55], a[208:211], v[164:167], a[52:55]
v_mfma_f32_16x16x32_bf16 a[56:59], a[208:211], v[168:171], a[56:59]
buffer_load_dwordx4 v3, s[84:87], s97 offen offset:1056 lds
v_mfma_f32_16x16x32_bf16 a[60:63], a[208:211], v[172:175], a[60:63]
v_mfma_f32_16x16x32_bf16 a[64:67], a[208:211], v[176:179], a[64:67]
v_mfma_f32_16x16x32_bf16 a[68:71], a[208:211], v[180:183], a[68:71]
buffer_load_dwordx4 v4, s[84:87], s97 offen offset:2112 lds
ds_read_b64_tr_b16 a[208:209], v39
v_mfma_f32_16x16x32_bf16 a[72:75], a[212:215], v[160:163], a[72:75]
ds_read_b64_tr_b16 a[210:211], v39 offset:4224
v_mfma_f32_16x16x32_bf16 a[76:79], a[212:215], v[164:167], a[76:79]
v_mfma_f32_16x16x32_bf16 a[80:83], a[212:215], v[168:171], a[80:83]
buffer_load_dwordx4 v5, s[84:87], s97 offen offset:3168 lds
v_mfma_f32_16x16x32_bf16 a[84:87], a[212:215], v[172:175], a[84:87]
s_add_u32 s98, s97, 16384
v_mfma_f32_16x16x32_bf16 a[88:91], a[212:215], v[176:179], a[88:91]
s_add_u32 m0, s78, 21120
v_mfma_f32_16x16x32_bf16 a[92:95], a[212:215], v[180:183], a[92:95]
buffer_load_dwordx4 v2, s[84:87], s98 offen lds
ds_read_b64_tr_b16 a[212:213], v39 offset:32
v_mfma_f32_16x16x32_bf16 a[96:99], a[216:219], v[160:163], a[96:99]
ds_read_b64_tr_b16 a[214:215], v39 offset:4256
v_mfma_f32_16x16x32_bf16 a[100:103], a[216:219], v[164:167], a[100:103]
v_mfma_f32_16x16x32_bf16 a[104:107], a[216:219], v[168:171], a[104:107]
buffer_load_dwordx4 v3, s[84:87], s98 offen offset:1056 lds
v_mfma_f32_16x16x32_bf16 a[108:111], a[216:219], v[172:175], a[108:111]
v_mfma_f32_16x16x32_bf16 a[112:115], a[216:219], v[176:179], a[112:115]
v_mfma_f32_16x16x32_bf16 a[116:119], a[216:219], v[180:183], a[116:119]
buffer_load_dwordx4 v4, s[84:87], s98 offen offset:2112 lds
ds_read_b64_tr_b16 a[216:217], v40
v_mfma_f32_16x16x32_bf16 a[120:123], a[220:223], v[160:163], a[120:123]
ds_read_b64_tr_b16 a[218:219], v40 offset:4224
v_mfma_f32_16x16x32_bf16 a[124:127], a[220:223], v[164:167], a[124:127]
v_mfma_f32_16x16x32_bf16 a[128:131], a[220:223], v[168:171], a[128:131]
buffer_load_dwordx4 v5, s[84:87], s98 offen offset:3168 lds
v_mfma_f32_16x16x32_bf16 a[132:135], a[220:223], v[172:175], a[132:135]
v_mfma_f32_16x16x32_bf16 a[136:139], a[220:223], v[176:179], a[136:139]
v_mfma_f32_16x16x32_bf16 a[140:143], a[220:223], v[180:183], a[140:143]
ds_read_b64_tr_b16 a[220:221], v40 offset:32
s_waitcnt vmcnt(27)
v_mfma_f32_16x16x32_bf16 v[64:67], a[192:195], v[112:115], v[64:67]
ds_read_b64_tr_b16 a[222:223], v40 offset:4256
s_waitcnt vmcnt(26)
v_mfma_f32_16x16x32_bf16 v[68:71], a[192:195], v[116:119], v[68:71]
s_add_u32 s99, s70, s79
s_waitcnt vmcnt(25)
v_mfma_f32_16x16x32_bf16 v[72:75], a[192:195], v[120:123], v[72:75]
buffer_load_dwordx4 v[160:163], v11, s[80:83], s99 offen sc1
s_waitcnt vmcnt(25)
v_mfma_f32_16x16x32_bf16 v[76:79], a[192:195], v[124:127], v[76:79]
s_waitcnt vmcnt(24)
v_mfma_f32_16x16x32_bf16 v[80:83], a[192:195], v[128:131], v[80:83]
s_waitcnt vmcnt(23)
v_mfma_f32_16x16x32_bf16 v[84:87], a[192:195], v[132:135], v[84:87]
buffer_load_dwordx4 v[164:167], v12, s[80:83], s99 offen sc1
s_waitcnt vmcnt(16)
ds_read_b64_tr_b16 a[192:193], v17 offset:8448
v_mfma_f32_16x16x32_bf16 v[88:91], a[196:199], v[112:115], v[88:91]
ds_read_b64_tr_b16 a[194:195], v17 offset:12672
v_mfma_f32_16x16x32_bf16 v[92:95], a[196:199], v[116:119], v[92:95]
v_mfma_f32_16x16x32_bf16 v[96:99], a[196:199], v[120:123], v[96:99]
buffer_load_dwordx4 v[168:171], v13, s[80:83], s99 offen sc1
v_mfma_f32_16x16x32_bf16 v[100:103], a[196:199], v[124:127], v[100:103]
v_mfma_f32_16x16x32_bf16 v[104:107], a[196:199], v[128:131], v[104:107]
v_mfma_f32_16x16x32_bf16 v[108:111], a[196:199], v[132:135], v[108:111]
buffer_load_dwordx4 v[172:175], v14, s[80:83], s99 offen sc1
ds_read_b64_tr_b16 a[196:197], v17 offset:8480
s_waitcnt lgkmcnt(3)
v_mfma_f32_16x16x32_bf16 a[0:3], a[200:203], v[112:115], a[0:3]
ds_read_b64_tr_b16 a[198:199], v17 offset:12704
v_mfma_f32_16x16x32_bf16 a[4:7], a[200:203], v[116:119], a[4:7]
v_mfma_f32_16x16x32_bf16 a[8:11], a[200:203], v[120:123], a[8:11]
buffer_load_dwordx4 v[176:179], v15, s[80:83], s99 offen sc1
v_mfma_f32_16x16x32_bf16 a[12:15], a[200:203], v[124:127], a[12:15]
v_mfma_f32_16x16x32_bf16 a[16:19], a[200:203], v[128:131], a[16:19]
v_mfma_f32_16x16x32_bf16 a[20:23], a[200:203], v[132:135], a[20:23]
buffer_load_dwordx4 v[180:183], v16, s[80:83], s99 offen sc1
ds_read_b64_tr_b16 a[200:201], v18 offset:8448
v_mfma_f32_16x16x32_bf16 a[24:27], a[204:207], v[112:115], a[24:27]
s_add_u32 s70, s70, 1024
ds_read_b64_tr_b16 a[202:203], v18 offset:12672
v_mfma_f32_16x16x32_bf16 a[28:31], a[204:207], v[116:119], a[28:31]
s_and_b32 s70, s70, 16383
v_mfma_f32_16x16x32_bf16 a[32:35], a[204:207], v[120:123], a[32:35]
s_lshl_b32 s97, s70, 5
v_mfma_f32_16x16x32_bf16 a[36:39], a[204:207], v[124:127], a[36:39]
s_add_u32 s97, s97, s96
v_mfma_f32_16x16x32_bf16 a[40:43], a[204:207], v[128:131], a[40:43]
s_add_u32 m0, s78, 25344
v_mfma_f32_16x16x32_bf16 a[44:47], a[204:207], v[132:135], a[44:47]
buffer_load_dwordx4 v2, s[84:87], s97 offen lds
ds_read_b64_tr_b16 a[204:205], v18 offset:8480
v_mfma_f32_16x16x32_bf16 a[48:51], a[208:211], v[112:115], a[48:51]
ds_read_b64_tr_b16 a[206:207], v18 offset:12704
v_mfma_f32_16x16x32_bf16 a[52:55], a[208:211], v[116:119], a[52:55]
v_mfma_f32_16x16x32_bf16 a[56:59], a[208:211], v[120:123], a[56:59]
buffer_load_dwordx4 v3, s[84:87], s97 offen offset:1056 lds
v_mfma_f32_16x16x32_bf16 a[60:63], a[208:211], v[124:127], a[60:63]
v_mfma_f32_16x16x32_bf16 a[64:67], a[208:211], v[128:131], a[64:67]
v_mfma_f32_16x16x32_bf16 a[68:71], a[208:211], v[132:135], a[68:71]
buffer_load_dwordx4 v4, s[84:87], s97 offen offset:2112 lds
ds_read_b64_tr_b16 a[208:209], v39 offset:8448
v_mfma_f32_16x16x32_bf16 a[72:75], a[212:215], v[112:115], a[72:75]
ds_read_b64_tr_b16 a[210:211], v39 offset:12672
v_mfma_f32_16x16x32_bf16 a[76:79], a[212:215], v[116:119], a[76:79]
v_mfma_f32_16x16x32_bf16 a[80:83], a[212:215], v[120:123], a[80:83]
buffer_load_dwordx4 v5, s[84:87], s97 offen offset:3168 lds
v_mfma_f32_16x16x32_bf16 a[84:87], a[212:215], v[124:127], a[84:87]
s_add_u32 s98, s97, 16384
v_mfma_f32_16x16x32_bf16 a[88:91], a[212:215], v[128:131], a[88:91]
s_add_u32 m0, s78, 29568
v_mfma_f32_16x16x32_bf16 a[92:95], a[212:215], v[132:135], a[92:95]
buffer_load_dwordx4 v2, s[84:87], s98 offen lds
ds_read_b64_tr_b16 a[212:213], v39 offset:8480
v_mfma_f32_16x16x32_bf16 a[96:99], a[216:219], v[112:115], a[96:99]
ds_read_b64_tr_b16 a[214:215], v39 offset:12704
v_mfma_f32_16x16x32_bf16 a[100:103], a[216:219], v[116:119], a[100:103]
v_mfma_f32_16x16x32_bf16 a[104:107], a[216:219], v[120:123], a[104:107]
buffer_load_dwordx4 v3, s[84:87], s98 offen offset:1056 lds
v_mfma_f32_16x16x32_bf16 a[108:111], a[216:219], v[124:127], a[108:111]
v_mfma_f32_16x16x32_bf16 a[112:115], a[216:219], v[128:131], a[112:115]
v_mfma_f32_16x16x32_bf16 a[116:119], a[216:219], v[132:135], a[116:119]
buffer_load_dwordx4 v4, s[84:87], s98 offen offset:2112 lds
ds_read_b64_tr_b16 a[216:217], v40 offset:8448
v_mfma_f32_16x16x32_bf16 a[120:123], a[220:223], v[112:115], a[120:123]
ds_read_b64_tr_b16 a[218:219], v40 offset:12672
v_mfma_f32_16x16x32_bf16 a[124:127], a[220:223], v[116:119], a[124:127]
v_mfma_f32_16x16x32_bf16 a[128:131], a[220:223], v[120:123], a[128:131]
buffer_load_dwordx4 v5, s[84:87], s98 offen offset:3168 lds
v_mfma_f32_16x16x32_bf16 a[132:135], a[220:223], v[124:127], a[132:135]
v_mfma_f32_16x16x32_bf16 a[136:139], a[220:223], v[128:131], a[136:139]
v_mfma_f32_16x16x32_bf16 a[140:143], a[220:223], v[132:135], a[140:143]
ds_read_b64_tr_b16 a[220:221], v40 offset:8480
s_waitcnt vmcnt(27) lgkmcnt(3)
v_mfma_f32_16x16x32_bf16 v[64:67], a[192:195], v[136:139], v[64:67]
ds_read_b64_tr_b16 a[222:223], v40 offset:12704
s_waitcnt vmcnt(26)
v_mfma_f32_16x16x32_bf16 v[68:71], a[192:195], v[140:143], v[68:71]
s_add_u32 s99, s70, s79
s_waitcnt vmcnt(25)
v_mfma_f32_16x16x32_bf16 v[72:75], a[192:195], v[144:147], v[72:75]
buffer_load_dwordx4 v[112:115], v11, s[80:83], s99 offen sc1
s_waitcnt vmcnt(25)
v_mfma_f32_16x16x32_bf16 v[76:79], a[192:195], v[148:151], v[76:79]
s_waitcnt vmcnt(24)
v_mfma_f32_16x16x32_bf16 v[80:83], a[192:195], v[152:155], v[80:83]
s_waitcnt vmcnt(23)
v_mfma_f32_16x16x32_bf16 v[84:87], a[192:195], v[156:159], v[84:87]
buffer_load_dwordx4 v[116:119], v12, s[80:83], s99 offen sc1
s_waitcnt vmcnt(16)
ds_read_b64_tr_b16 a[192:193], v17 offset:16896
v_mfma_f32_16x16x32_bf16 v[88:91], a[196:199], v[136:139], v[88:91]
ds_read_b64_tr_b16 a[194:195], v17 offset:21120
v_mfma_f32_16x16x32_bf16 v[92:95], a[196:199], v[140:143], v[92:95]
v_mfma_f32_16x16x32_bf16 v[96:99], a[196:199], v[144:147], v[96:99]
buffer_load_dwordx4 v[120:123], v13, s[80:83], s99 offen sc1
v_mfma_f32_16x16x32_bf16 v[100:103], a[196:199], v[148:151], v[100:103]
v_mfma_f32_16x16x32_bf16 v[104:107], a[196:199], v[152:155], v[104:107]
v_mfma_f32_16x16x32_bf16 v[108:111], a[196:199], v[156:159], v[108:111]
buffer_load_dwordx4 v[124:127], v14, s[80:83], s99 offen sc1
ds_read_b64_tr_b16 a[196:197], v17 offset:16928
v_mfma_f32_16x16x32_bf16 a[0:3], a[200:203], v[136:139], a[0:3]
ds_read_b64_tr_b16 a[198:199], v17 offset:21152
v_mfma_f32_16x16x32_bf16 a[4:7], a[200:203], v[140:143], a[4:7]
v_mfma_f32_16x16x32_bf16 a[8:11], a[200:203], v[144:147], a[8:11]
buffer_load_dwordx4 v[128:131], v15, s[80:83], s99 offen sc1
v_mfma_f32_16x16x32_bf16 a[12:15], a[200:203], v[148:151], a[12:15]
v_mfma_f32_16x16x32_bf16 a[16:19], a[200:203], v[152:155], a[16:19]
v_mfma_f32_16x16x32_bf16 a[20:23], a[200:203], v[156:159], a[20:23]
buffer_load_dwordx4 v[132:135], v16, s[80:83], s99 offen sc1
ds_read_b64_tr_b16 a[200:201], v18 offset:16896
v_mfma_f32_16x16x32_bf16 a[24:27], a[204:207], v[136:139], a[24:27]
s_add_u32 s70, s70, 1024
ds_read_b64_tr_b16 a[202:203], v18 offset:21120
v_mfma_f32_16x16x32_bf16 a[28:31], a[204:207], v[140:143], a[28:31]
s_and_b32 s70, s70, 16383
v_mfma_f32_16x16x32_bf16 a[32:35], a[204:207], v[144:147], a[32:35]
s_lshl_b32 s97, s70, 5
v_mfma_f32_16x16x32_bf16 a[36:39], a[204:207], v[148:151], a[36:39]
s_add_u32 s97, s97, s96
v_mfma_f32_16x16x32_bf16 a[40:43], a[204:207], v[152:155], a[40:43]
s_add_u32 m0, s78, 0
v_mfma_f32_16x16x32_bf16 a[44:47], a[204:207], v[156:159], a[44:47]
buffer_load_dwordx4 v2, s[84:87], s97 offen lds
ds_read_b64_tr_b16 a[204:205], v18 offset:16928
v_mfma_f32_16x16x32_bf16 a[48:51], a[208:211], v[136:139], a[48:51]
ds_read_b64_tr_b16 a[206:207], v18 offset:21152
v_mfma_f32_16x16x32_bf16 a[52:55], a[208:211], v[140:143], a[52:55]
v_mfma_f32_16x16x32_bf16 a[56:59], a[208:211], v[144:147], a[56:59]
buffer_load_dwordx4 v3, s[84:87], s97 offen offset:1056 lds
v_mfma_f32_16x16x32_bf16 a[60:63], a[208:211], v[148:151], a[60:63]
v_mfma_f32_16x16x32_bf16 a[64:67], a[208:211], v[152:155], a[64:67]
v_mfma_f32_16x16x32_bf16 a[68:71], a[208:211], v[156:159], a[68:71]
buffer_load_dwordx4 v4, s[84:87], s97 offen offset:2112 lds
ds_read_b64_tr_b16 a[208:209], v39 offset:16896
v_mfma_f32_16x16x32_bf16 a[72:75], a[212:215], v[136:139], a[72:75]
ds_read_b64_tr_b16 a[210:211], v39 offset:21120
v_mfma_f32_16x16x32_bf16 a[76:79], a[212:215], v[140:143], a[76:79]
v_mfma_f32_16x16x32_bf16 a[80:83], a[212:215], v[144:147], a[80:83]
buffer_load_dwordx4 v5, s[84:87], s97 offen offset:3168 lds
v_mfma_f32_16x16x32_bf16 a[84:87], a[212:215], v[148:151], a[84:87]
s_add_u32 s98, s97, 16384
v_mfma_f32_16x16x32_bf16 a[88:91], a[212:215], v[152:155], a[88:91]
s_add_u32 m0, s78, 4224
v_mfma_f32_16x16x32_bf16 a[92:95], a[212:215], v[156:159], a[92:95]
buffer_load_dwordx4 v2, s[84:87], s98 offen lds
ds_read_b64_tr_b16 a[212:213], v39 offset:16928
s_waitcnt lgkmcnt(3)
v_mfma_f32_16x16x32_bf16 a[96:99], a[216:219], v[136:139], a[96:99]
ds_read_b64_tr_b16 a[214:215], v39 offset:21152
v_mfma_f32_16x16x32_bf16 a[100:103], a[216:219], v[140:143], a[100:103]
v_mfma_f32_16x16x32_bf16 a[104:107], a[216:219], v[144:147], a[104:107]
buffer_load_dwordx4 v3, s[84:87], s98 offen offset:1056 lds
v_mfma_f32_16x16x32_bf16 a[108:111], a[216:219], v[148:151], a[108:111]
v_mfma_f32_16x16x32_bf16 a[112:115], a[216:219], v[152:155], a[112:115]
v_mfma_f32_16x16x32_bf16 a[116:119], a[216:219], v[156:159], a[116:119]
buffer_load_dwordx4 v4, s[84:87], s98 offen offset:2112 lds
ds_read_b64_tr_b16 a[216:217], v40 offset:16896
v_mfma_f32_16x16x32_bf16 a[120:123], a[220:223], v[136:139], a[120:123]
ds_read_b64_tr_b16 a[218:219], v40 offset:21120
v_mfma_f32_16x16x32_bf16 a[124:127], a[220:223], v[140:143], a[124:127]
v_mfma_f32_16x16x32_bf16 a[128:131], a[220:223], v[144:147], a[128:131]
buffer_load_dwordx4 v5, s[84:87], s98 offen offset:3168 lds
v_mfma_f32_16x16x32_bf16 a[132:135], a[220:223], v[148:151], a[132:135]
v_mfma_f32_16x16x32_bf16 a[136:139], a[220:223], v[152:155], a[136:139]
v_mfma_f32_16x16x32_bf16 a[140:143], a[220:223], v[156:159], a[140:143]
ds_read_b64_tr_b16 a[220:221], v40 offset:16928
s_waitcnt vmcnt(27)
v_mfma_f32_16x16x32_bf16 v[64:67], a[192:195], v[160:163], v[64:67]
ds_read_b64_tr_b16 a[222:223], v40 offset:21152
s_waitcnt vmcnt(26)
v_mfma_f32_16x16x32_bf16 v[68:71], a[192:195], v[164:167], v[68:71]
s_add_u32 s99, s70, s79
s_waitcnt vmcnt(25)
v_mfma_f32_16x16x32_bf16 v[72:75], a[192:195], v[168:171], v[72:75]
buffer_load_dwordx4 v[136:139], v11, s[80:83], s99 offen sc1
s_waitcnt vmcnt(25)
v_mfma_f32_16x16x32_bf16 v[76:79], a[192:195], v[172:175], v[76:79]
s_waitcnt vmcnt(24)
v_mfma_f32_16x16x32_bf16 v[80:83], a[192:195], v[176:179], v[80:83]
s_waitcnt vmcnt(23)
v_mfma_f32_16x16x32_bf16 v[84:87], a[192:195], v[180:183], v[84:87]
buffer_load_dwordx4 v[140:143], v12, s[80:83], s99 offen sc1
s_waitcnt vmcnt(16)
ds_read_b64_tr_b16 a[192:193], v17 offset:25344
v_mfma_f32_16x16x32_bf16 v[88:91], a[196:199], v[160:163], v[88:91]
ds_read_b64_tr_b16 a[194:195], v17 offset:29568
v_mfma_f32_16x16x32_bf16 v[92:95], a[196:199], v[164:167], v[92:95]
v_mfma_f32_16x16x32_bf16 v[96:99], a[196:199], v[168:171], v[96:99]
buffer_load_dwordx4 v[144:147], v13, s[80:83], s99 offen sc1
v_mfma_f32_16x16x32_bf16 v[100:103], a[196:199], v[172:175], v[100:103]
v_mfma_f32_16x16x32_bf16 v[104:107], a[196:199], v[176:179], v[104:107]
v_mfma_f32_16x16x32_bf16 v[108:111], a[196:199], v[180:183], v[108:111]
buffer_load_dwordx4 v[148:151], v14, s[80:83], s99 offen sc1
ds_read_b64_tr_b16 a[196:197], v17 offset:25376
v_mfma_f32_16x16x32_bf16 a[0:3], a[200:203], v[160:163], a[0:3]
ds_read_b64_tr_b16 a[198:199], v17 offset:29600
v_mfma_f32_16x16x32_bf16 a[4:7], a[200:203], v[164:167], a[4:7]
v_mfma_f32_16x16x32_bf16 a[8:11], a[200:203], v[168:171], a[8:11]
buffer_load_dwordx4 v[152:155], v15, s[80:83], s99 offen sc1
v_mfma_f32_16x16x32_bf16 a[12:15], a[200:203], v[172:175], a[12:15]
v_mfma_f32_16x16x32_bf16 a[16:19], a[200:203], v[176:179], a[16:19]
v_mfma_f32_16x16x32_bf16 a[20:23], a[200:203], v[180:183], a[20:23]
buffer_load_dwordx4 v[156:159], v16, s[80:83], s99 offen sc1
ds_read_b64_tr_b16 a[200:201], v18 offset:25344
v_mfma_f32_16x16x32_bf16 a[24:27], a[204:207], v[160:163], a[24:27]
s_add_u32 s70, s70, 1024
ds_read_b64_tr_b16 a[202:203], v18 offset:29568
v_mfma_f32_16x16x32_bf16 a[28:31], a[204:207], v[164:167], a[28:31]
s_and_b32 s70, s70, 16383
v_mfma_f32_16x16x32_bf16 a[32:35], a[204:207], v[168:171], a[32:35]
s_lshl_b32 s97, s70, 5
v_mfma_f32_16x16x32_bf16 a[36:39], a[204:207], v[172:175], a[36:39]
s_add_u32 s97, s97, s96
v_mfma_f32_16x16x32_bf16 a[40:43], a[204:207], v[176:179], a[40:43]
s_add_u32 m0, s78, 8448
v_mfma_f32_16x16x32_bf16 a[44:47], a[204:207], v[180:183], a[44:47]
buffer_load_dwordx4 v2, s[84:87], s97 offen lds
ds_read_b64_tr_b16 a[204:205], v18 offset:25376
s_waitcnt lgkmcnt(2)
v_mfma_f32_16x16x32_bf16 a[48:51], a[208:211], v[160:163], a[48:51]
ds_read_b64_tr_b16 a[206:207], v18 offset:29600
v_mfma_f32_16x16x32_bf16 a[52:55], a[208:211], v[164:167], a[52:55]
v_mfma_f32_16x16x32_bf16 a[56:59], a[208:211], v[168:171], a[56:59]
buffer_load_dwordx4 v3, s[84:87], s97 offen offset:1056 lds
v_mfma_f32_16x16x32_bf16 a[60:63], a[208:211], v[172:175], a[60:63]
v_mfma_f32_16x16x32_bf16 a[64:67], a[208:211], v[176:179], a[64:67]
v_mfma_f32_16x16x32_bf16 a[68:71], a[208:211], v[180:183], a[68:71]
buffer_load_dwordx4 v4, s[84:87], s97 offen offset:2112 lds
ds_read_b64_tr_b16 a[208:209], v39 offset:25344
v_mfma_f32_16x16x32_bf16 a[72:75], a[212:215], v[160:163], a[72:75]
ds_read_b64_tr_b16 a[210:211], v39 offset:29568
v_mfma_f32_16x16x32_bf16 a[76:79], a[212:215], v[164:167], a[76:79]
v_mfma_f32_16x16x32_bf16 a[80:83], a[212:215], v[168:171], a[80:83]
buffer_load_dwordx4 v5, s[84:87], s97 offen offset:3168 lds
v_mfma_f32_16x16x32_bf16 a[84:87], a[212:215], v[172:175], a[84:87]
s_add_u32 s98, s97, 16384
v_mfma_f32_16x16x32_bf16 a[88:91], a[212:215], v[176:179], a[88:91]
s_add_u32 m0, s78, 12672
v_mfma_f32_16x16x32_bf16 a[92:95], a[212:215], v[180:183], a[92:95]
buffer_load_dwordx4 v2, s[84:87], s98 offen lds
ds_read_b64_tr_b16 a[212:213], v39 offset:25376
v_mfma_f32_16x16x32_bf16 a[96:99], a[216:219], v[160:163], a[96:99]
ds_read_b64_tr_b16 a[214:215], v39 offset:29600
v_mfma_f32_16x16x32_bf16 a[100:103], a[216:219], v[164:167], a[100:103]
v_mfma_f32_16x16x32_bf16 a[104:107], a[216:219], v[168:171], a[104:107]
buffer_load_dwordx4 v3, s[84:87], s98 offen offset:1056 lds
v_mfma_f32_16x16x32_bf16 a[108:111], a[216:219], v[172:175], a[108:111]
v_mfma_f32_16x16x32_bf16 a[112:115], a[216:219], v[176:179], a[112:115]
v_mfma_f32_16x16x32_bf16 a[116:119], a[216:219], v[180:183], a[116:119]
buffer_load_dwordx4 v4, s[84:87], s98 offen offset:2112 lds
ds_read_b64_tr_b16 a[216:217], v40 offset:25344
v_mfma_f32_16x16x32_bf16 a[120:123], a[220:223], v[160:163], a[120:123]
ds_read_b64_tr_b16 a[218:219], v40 offset:29568
v_mfma_f32_16x16x32_bf16 a[124:127], a[220:223], v[164:167], a[124:127]
v_mfma_f32_16x16x32_bf16 a[128:131], a[220:223], v[168:171], a[128:131]
buffer_load_dwordx4 v5, s[84:87], s98 offen offset:3168 lds
v_mfma_f32_16x16x32_bf16 a[132:135], a[220:223], v[172:175], a[132:135]
v_mfma_f32_16x16x32_bf16 a[136:139], a[220:223], v[176:179], a[136:139]
v_mfma_f32_16x16x32_bf16 a[140:143], a[220:223], v[180:183], a[140:143]
ds_read_b64_tr_b16 a[220:221], v40 offset:25376
s_waitcnt vmcnt(27)
v_mfma_f32_16x16x32_bf16 v[64:67], a[192:195], v[112:115], v[64:67]
ds_read_b64_tr_b16 a[222:223], v40 offset:29600
s_waitcnt vmcnt(26)
v_mfma_f32_16x16x32_bf16 v[68:71], a[192:195], v[116:119], v[68:71]
s_add_u32 s99, s70, s79
s_waitcnt vmcnt(25)
v_mfma_f32_16x16x32_bf16 v[72:75], a[192:195], v[120:123], v[72:75]
buffer_load_dwordx4 v[160:163], v11, s[80:83], s99 offen sc1
s_waitcnt vmcnt(25)
v_mfma_f32_16x16x32_bf16 v[76:79], a[192:195], v[124:127], v[76:79]
s_waitcnt vmcnt(24)
v_mfma_f32_16x16x32_bf16 v[80:83], a[192:195], v[128:131], v[80:83]
s_waitcnt vmcnt(23)
v_mfma_f32_16x16x32_bf16 v[84:87], a[192:195], v[132:135], v[84:87]
buffer_load_dwordx4 v[164:167], v12, s[80:83], s99 offen sc1
s_waitcnt vmcnt(16)
ds_read_b64_tr_b16 a[192:193], v17
v_mfma_f32_16x16x32_bf16 v[88:91], a[196:199], v[112:115], v[88:91]
ds_read_b64_tr_b16 a[194:195], v17 offset:4224
v_mfma_f32_16x16x32_bf16 v[92:95], a[196:199], v[116:119], v[92:95]
v_mfma_f32_16x16x32_bf16 v[96:99], a[196:199], v[120:123], v[96:99]
buffer_load_dwordx4 v[168:171], v13, s[80:83], s99 offen sc1
v_mfma_f32_16x16x32_bf16 v[100:103], a[196:199], v[124:127], v[100:103]
v_mfma_f32_16x16x32_bf16 v[104:107], a[196:199], v[128:131], v[104:107]
v_mfma_f32_16x16x32_bf16 v[108:111], a[196:199], v[132:135], v[108:111]
buffer_load_dwordx4 v[172:175], v14, s[80:83], s99 offen sc1
ds_read_b64_tr_b16 a[196:197], v17 offset:32
s_waitcnt lgkmcnt(3)
v_mfma_f32_16x16x32_bf16 a[0:3], a[200:203], v[112:115], a[0:3]
ds_read_b64_tr_b16 a[198:199], v17 offset:4256
v_mfma_f32_16x16x32_bf16 a[4:7], a[200:203], v[116:119], a[4:7]
v_mfma_f32_16x16x32_bf16 a[8:11], a[200:203], v[120:123], a[8:11]
buffer_load_dwordx4 v[176:179], v15, s[80:83], s99 offen sc1
v_mfma_f32_16x16x32_bf16 a[12:15], a[200:203], v[124:127], a[12:15]
v_mfma_f32_16x16x32_bf16 a[16:19], a[200:203], v[128:131], a[16:19]
v_mfma_f32_16x16x32_bf16 a[20:23], a[200:203], v[132:135], a[20:23]
buffer_load_dwordx4 v[180:183], v16, s[80:83], s99 offen sc1
ds_read_b64_tr_b16 a[200:201], v18
v_mfma_f32_16x16x32_bf16 a[24:27], a[204:207], v[112:115], a[24:27]
s_add_u32 s70, s70, 1024
ds_read_b64_tr_b16 a[202:203], v18 offset:4224
v_mfma_f32_16x16x32_bf16 a[28:31], a[204:207], v[116:119], a[28:31]
s_and_b32 s70, s70, 16383
v_mfma_f32_16x16x32_bf16 a[32:35], a[204:207], v[120:123], a[32:35]
s_lshl_b32 s97, s70, 5
v_mfma_f32_16x16x32_bf16 a[36:39], a[204:207], v[124:127], a[36:39]
s_add_u32 s97, s97, s96
v_mfma_f32_16x16x32_bf16 a[40:43], a[204:207], v[128:131], a[40:43]
s_add_u32 m0, s78, 16896
v_mfma_f32_16x16x32_bf16 a[44:47], a[204:207], v[132:135], a[44:47]
buffer_load_dwordx4 v2, s[84:87], s97 offen lds
ds_read_b64_tr_b16 a[204:205], v18 offset:32
v_mfma_f32_16x16x32_bf16 a[48:51], a[208:211], v[112:115], a[48:51]
ds_read_b64_tr_b16 a[206:207], v18 offset:4256
v_mfma_f32_16x16x32_bf16 a[52:55], a[208:211], v[116:119], a[52:55]
v_mfma_f32_16x16x32_bf16 a[56:59], a[208:211], v[120:123], a[56:59]
buffer_load_dwordx4 v3, s[84:87], s97 offen offset:1056 lds
v_mfma_f32_16x16x32_bf16 a[60:63], a[208:211], v[124:127], a[60:63]
v_mfma_f32_16x16x32_bf16 a[64:67], a[208:211], v[128:131], a[64:67]
v_mfma_f32_16x16x32_bf16 a[68:71], a[208:211], v[132:135], a[68:71]
buffer_load_dwordx4 v4, s[84:87], s97 offen offset:2112 lds
ds_read_b64_tr_b16 a[208:209], v39
v_mfma_f32_16x16x32_bf16 a[72:75], a[212:215], v[112:115], a[72:75]
ds_read_b64_tr_b16 a[210:211], v39 offset:4224
v_mfma_f32_16x16x32_bf16 a[76:79], a[212:215], v[116:119], a[76:79]
v_mfma_f32_16x16x32_bf16 a[80:83], a[212:215], v[120:123], a[80:83]
buffer_load_dwordx4 v5, s[84:87], s97 offen offset:3168 lds
v_mfma_f32_16x16x32_bf16 a[84:87], a[212:215], v[124:127], a[84:87]
s_add_u32 s98, s97, 16384
v_mfma_f32_16x16x32_bf16 a[88:91], a[212:215], v[128:131], a[88:91]
s_add_u32 m0, s78, 21120
v_mfma_f32_16x16x32_bf16 a[92:95], a[212:215], v[132:135], a[92:95]
buffer_load_dwordx4 v2, s[84:87], s98 offen lds
ds_read_b64_tr_b16 a[212:213], v39 offset:32
v_mfma_f32_16x16x32_bf16 a[96:99], a[216:219], v[112:115], a[96:99]
ds_read_b64_tr_b16 a[214:215], v39 offset:4256
v_mfma_f32_16x16x32_bf16 a[100:103], a[216:219], v[116:119], a[100:103]
v_mfma_f32_16x16x32_bf16 a[104:107], a[216:219], v[120:123], a[104:107]
buffer_load_dwordx4 v3, s[84:87], s98 offen offset:1056 lds
v_mfma_f32_16x16x32_bf16 a[108:111], a[216:219], v[124:127], a[108:111]
v_mfma_f32_16x16x32_bf16 a[112:115], a[216:219], v[128:131], a[112:115]
v_mfma_f32_16x16x32_bf16 a[116:119], a[216:219], v[132:135], a[116:119]
buffer_load_dwordx4 v4, s[84:87], s98 offen offset:2112 lds
ds_read_b64_tr_b16 a[216:217], v40
v_mfma_f32_16x16x32_bf16 a[120:123], a[220:223], v[112:115], a[120:123]
ds_read_b64_tr_b16 a[218:219], v40 offset:4224
v_mfma_f32_16x16x32_bf16 a[124:127], a[220:223], v[116:119], a[124:127]
v_mfma_f32_16x16x32_bf16 a[128:131], a[220:223], v[120:123], a[128:131]
buffer_load_dwordx4 v5, s[84:87], s98 offen offset:3168 lds
v_mfma_f32_16x16x32_bf16 a[132:135], a[220:223], v[124:127], a[132:135]
v_mfma_f32_16x16x32_bf16 a[136:139], a[220:223], v[128:131], a[136:139]
v_mfma_f32_16x16x32_bf16 a[140:143], a[220:223], v[132:135], a[140:143]
ds_read_b64_tr_b16 a[220:221], v40 offset:32
s_waitcnt vmcnt(27) lgkmcnt(3)
v_mfma_f32_16x16x32_bf16 v[64:67], a[192:195], v[136:139], v[64:67]
ds_read_b64_tr_b16 a[222:223], v40 offset:4256
s_waitcnt vmcnt(26)
v_mfma_f32_16x16x32_bf16 v[68:71], a[192:195], v[140:143], v[68:71]
s_add_u32 s99, s70, s79
s_waitcnt vmcnt(25)
v_mfma_f32_16x16x32_bf16 v[72:75], a[192:195], v[144:147], v[72:75]
buffer_load_dwordx4 v[112:115], v11, s[80:83], s99 offen sc1
s_waitcnt vmcnt(25)
v_mfma_f32_16x16x32_bf16 v[76:79], a[192:195], v[148:151], v[76:79]
s_waitcnt vmcnt(24)
v_mfma_f32_16x16x32_bf16 v[80:83], a[192:195], v[152:155], v[80:83]
s_waitcnt vmcnt(23)
v_mfma_f32_16x16x32_bf16 v[84:87], a[192:195], v[156:159], v[84:87]
buffer_load_dwordx4 v[116:119], v12, s[80:83], s99 offen sc1
s_waitcnt vmcnt(16)
ds_read_b64_tr_b16 a[192:193], v17 offset:8448
v_mfma_f32_16x16x32_bf16 v[88:91], a[196:199], v[136:139], v[88:91]
ds_read_b64_tr_b16 a[194:195], v17 offset:12672
v_mfma_f32_16x16x32_bf16 v[92:95], a[196:199], v[140:143], v[92:95]
v_mfma_f32_16x16x32_bf16 v[96:99], a[196:199], v[144:147], v[96:99]
buffer_load_dwordx4 v[120:123], v13, s[80:83], s99 offen sc1
v_mfma_f32_16x16x32_bf16 v[100:103], a[196:199], v[148:151], v[100:103]
v_mfma_f32_16x16x32_bf16 v[104:107], a[196:199], v[152:155], v[104:107]
v_mfma_f32_16x16x32_bf16 v[108:111], a[196:199], v[156:159], v[108:111]
buffer_load_dwordx4 v[124:127], v14, s[80:83], s99 offen sc1
ds_read_b64_tr_b16 a[196:197], v17 offset:8480
v_mfma_f32_16x16x32_bf16 a[0:3], a[200:203], v[136:139], a[0:3]
ds_read_b64_tr_b16 a[198:199], v17 offset:12704
v_mfma_f32_16x16x32_bf16 a[4:7], a[200:203], v[140:143], a[4:7]
v_mfma_f32_16x16x32_bf16 a[8:11], a[200:203], v[144:147], a[8:11]
buffer_load_dwordx4 v[128:131], v15, s[80:83], s99 offen sc1
v_mfma_f32_16x16x32_bf16 a[12:15], a[200:203], v[148:151], a[12:15]
v_mfma_f32_16x16x32_bf16 a[16:19], a[200:203], v[152:155], a[16:19]
v_mfma_f32_16x16x32_bf16 a[20:23], a[200:203], v[156:159], a[20:23]
buffer_load_dwordx4 v[132:135], v16, s[80:83], s99 offen sc1
ds_read_b64_tr_b16 a[200:201], v18 offset:8448
v_mfma_f32_16x16x32_bf16 a[24:27], a[204:207], v[136:139], a[24:27]
s_add_u32 s70, s70, 1024
ds_read_b64_tr_b16 a[202:203], v18 offset:12672
v_mfma_f32_16x16x32_bf16 a[28:31], a[204:207], v[140:143], a[28:31]
s_and_b32 s70, s70, 16383
v_mfma_f32_16x16x32_bf16 a[32:35], a[204:207], v[144:147], a[32:35]
s_lshl_b32 s97, s70, 5
v_mfma_f32_16x16x32_bf16 a[36:39], a[204:207], v[148:151], a[36:39]
s_add_u32 s97, s97, s96
v_mfma_f32_16x16x32_bf16 a[40:43], a[204:207], v[152:155], a[40:43]
s_add_u32 m0, s78, 25344
v_mfma_f32_16x16x32_bf16 a[44:47], a[204:207], v[156:159], a[44:47]
buffer_load_dwordx4 v2, s[84:87], s97 offen lds
ds_read_b64_tr_b16 a[204:205], v18 offset:8480
v_mfma_f32_16x16x32_bf16 a[48:51], a[208:211], v[136:139], a[48:51]
ds_read_b64_tr_b16 a[206:207], v18 offset:12704
v_mfma_f32_16x16x32_bf16 a[52:55], a[208:211], v[140:143], a[52:55]
v_mfma_f32_16x16x32_bf16 a[56:59], a[208:211], v[144:147], a[56:59]
buffer_load_dwordx4 v3, s[84:87], s97 offen offset:1056 lds
v_mfma_f32_16x16x32_bf16 a[60:63], a[208:211], v[148:151], a[60:63]
v_mfma_f32_16x16x32_bf16 a[64:67], a[208:211], v[152:155], a[64:67]
v_mfma_f32_16x16x32_bf16 a[68:71], a[208:211], v[156:159], a[68:71]
buffer_load_dwordx4 v4, s[84:87], s97 offen offset:2112 lds
ds_read_b64_tr_b16 a[208:209], v39 offset:8448
v_mfma_f32_16x16x32_bf16 a[72:75], a[212:215], v[136:139], a[72:75]
ds_read_b64_tr_b16 a[210:211], v39 offset:12672
v_mfma_f32_16x16x32_bf16 a[76:79], a[212:215], v[140:143], a[76:79]
v_mfma_f32_16x16x32_bf16 a[80:83], a[212:215], v[144:147], a[80:83]
buffer_load_dwordx4 v5, s[84:87], s97 offen offset:3168 lds
v_mfma_f32_16x16x32_bf16 a[84:87], a[212:215], v[148:151], a[84:87]
s_add_u32 s98, s97, 16384
v_mfma_f32_16x16x32_bf16 a[88:91], a[212:215], v[152:155], a[88:91]
s_add_u32 m0, s78, 29568
v_mfma_f32_16x16x32_bf16 a[92:95], a[212:215], v[156:159], a[92:95]
buffer_load_dwordx4 v2, s[84:87], s98 offen lds
ds_read_b64_tr_b16 a[212:213], v39 offset:8480
s_waitcnt lgkmcnt(3)
v_mfma_f32_16x16x32_bf16 a[96:99], a[216:219], v[136:139], a[96:99]
ds_read_b64_tr_b16 a[214:215], v39 offset:12704
v_mfma_f32_16x16x32_bf16 a[100:103], a[216:219], v[140:143], a[100:103]
v_mfma_f32_16x16x32_bf16 a[104:107], a[216:219], v[144:147], a[104:107]
buffer_load_dwordx4 v3, s[84:87], s98 offen offset:1056 lds
v_mfma_f32_16x16x32_bf16 a[108:111], a[216:219], v[148:151], a[108:111]
v_mfma_f32_16x16x32_bf16 a[112:115], a[216:219], v[152:155], a[112:115]
v_mfma_f32_16x16x32_bf16 a[116:119], a[216:219], v[156:159], a[116:119]
buffer_load_dwordx4 v4, s[84:87], s98 offen offset:2112 lds
ds_read_b64_tr_b16 a[216:217], v40 offset:8448
v_mfma_f32_16x16x32_bf16 a[120:123], a[220:223], v[136:139], a[120:123]
ds_read_b64_tr_b16 a[218:219], v40 offset:12672
v_mfma_f32_16x16x32_bf16 a[124:127], a[220:223], v[140:143], a[124:127]
v_mfma_f32_16x16x32_bf16 a[128:131], a[220:223], v[144:147], a[128:131]
buffer_load_dwordx4 v5, s[84:87], s98 offen offset:3168 lds
v_mfma_f32_16x16x32_bf16 a[132:135], a[220:223], v[148:151], a[132:135]
v_mfma_f32_16x16x32_bf16 a[136:139], a[220:223], v[152:155], a[136:139]
v_mfma_f32_16x16x32_bf16 a[140:143], a[220:223], v[156:159], a[140:143]
ds_read_b64_tr_b16 a[220:221], v40 offset:8480
s_waitcnt vmcnt(27)
v_mfma_f32_16x16x32_bf16 v[64:67], a[192:195], v[160:163], v[64:67]
ds_read_b64_tr_b16 a[222:223], v40 offset:12704
s_waitcnt vmcnt(26)
v_mfma_f32_16x16x32_bf16 v[68:71], a[192:195], v[164:167], v[68:71]
s_add_u32 s99, s70, s79
s_waitcnt vmcnt(25)
v_mfma_f32_16x16x32_bf16 v[72:75], a[192:195], v[168:171], v[72:75]
buffer_load_dwordx4 v[136:139], v11, s[80:83], s99 offen sc1
s_waitcnt vmcnt(25)
v_mfma_f32_16x16x32_bf16 v[76:79], a[192:195], v[172:175], v[76:79]
s_waitcnt vmcnt(24)
v_mfma_f32_16x16x32_bf16 v[80:83], a[192:195], v[176:179], v[80:83]
s_waitcnt vmcnt(23)
v_mfma_f32_16x16x32_bf16 v[84:87], a[192:195], v[180:183], v[84:87]
buffer_load_dwordx4 v[140:143], v12, s[80:83], s99 offen sc1
s_waitcnt vmcnt(16)
ds_read_b64_tr_b16 a[192:193], v17 offset:16896
v_mfma_f32_16x16x32_bf16 v[88:91], a[196:199], v[160:163], v[88:91]
ds_read_b64_tr_b16 a[194:195], v17 offset:21120
v_mfma_f32_16x16x32_bf16 v[92:95], a[196:199], v[164:167], v[92:95]
v_mfma_f32_16x16x32_bf16 v[96:99], a[196:199], v[168:171], v[96:99]
buffer_load_dwordx4 v[144:147], v13, s[80:83], s99 offen sc1
v_mfma_f32_16x16x32_bf16 v[100:103], a[196:199], v[172:175], v[100:103]
v_mfma_f32_16x16x32_bf16 v[104:107], a[196:199], v[176:179], v[104:107]
v_mfma_f32_16x16x32_bf16 v[108:111], a[196:199], v[180:183], v[108:111]
buffer_load_dwordx4 v[148:151], v14, s[80:83], s99 offen sc1
ds_read_b64_tr_b16 a[196:197], v17 offset:16928
v_mfma_f32_16x16x32_bf16 a[0:3], a[200:203], v[160:163], a[0:3]
ds_read_b64_tr_b16 a[198:199], v17 offset:21152
v_mfma_f32_16x16x32_bf16 a[4:7], a[200:203], v[164:167], a[4:7]
v_mfma_f32_16x16x32_bf16 a[8:11], a[200:203], v[168:171], a[8:11]
buffer_load_dwordx4 v[152:155], v15, s[80:83], s99 offen sc1
v_mfma_f32_16x16x32_bf16 a[12:15], a[200:203], v[172:175], a[12:15]
v_mfma_f32_16x16x32_bf16 a[16:19], a[200:203], v[176:179], a[16:19]
v_mfma_f32_16x16x32_bf16 a[20:23], a[200:203], v[180:183], a[20:23]
buffer_load_dwordx4 v[156:159], v16, s[80:83], s99 offen sc1
ds_read_b64_tr_b16 a[200:201], v18 offset:16896
v_mfma_f32_16x16x32_bf16 a[24:27], a[204:207], v[160:163], a[24:27]
ds_read_b64_tr_b16 a[202:203], v18 offset:21120
v_mfma_f32_16x16x32_bf16 a[28:31], a[204:207], v[164:167], a[28:31]
v_mfma_f32_16x16x32_bf16 a[32:35], a[204:207], v[168:171], a[32:35]
v_mfma_f32_16x16x32_bf16 a[36:39], a[204:207], v[172:175], a[36:39]
v_mfma_f32_16x16x32_bf16 a[40:43], a[204:207], v[176:179], a[40:43]
v_mfma_f32_16x16x32_bf16 a[44:47], a[204:207], v[180:183], a[44:47]
ds_read_b64_tr_b16 a[204:205], v18 offset:16928
s_waitcnt lgkmcnt(3)
v_mfma_f32_16x16x32_bf16 a[48:51], a[208:211], v[160:163], a[48:51]
ds_read_b64_tr_b16 a[206:207], v18 offset:21152
v_mfma_f32_16x16x32_bf16 a[52:55], a[208:211], v[164:167], a[52:55]
v_mfma_f32_16x16x32_bf16 a[56:59], a[208:211], v[168:171], a[56:59]
v_mfma_f32_16x16x32_bf16 a[60:63], a[208:211], v[172:175], a[60:63]
v_mfma_f32_16x16x32_bf16 a[64:67], a[208:211], v[176:179], a[64:67]
v_mfma_f32_16x16x32_bf16 a[68:71], a[208:211], v[180:183], a[68:71]
ds_read_b64_tr_b16 a[208:209], v39 offset:16896
v_mfma_f32_16x16x32_bf16 a[72:75], a[212:215], v[160:163], a[72:75]
ds_read_b64_tr_b16 a[210:211], v39 offset:21120
v_mfma_f32_16x16x32_bf16 a[76:79], a[212:215], v[164:167], a[76:79]
v_mfma_f32_16x16x32_bf16 a[80:83], a[212:215], v[168:171], a[80:83]
v_mfma_f32_16x16x32_bf16 a[84:87], a[212:215], v[172:175], a[84:87]
v_mfma_f32_16x16x32_bf16 a[88:91], a[212:215], v[176:179], a[88:91]
v_mfma_f32_16x16x32_bf16 a[92:95], a[212:215], v[180:183], a[92:95]
ds_read_b64_tr_b16 a[212:213], v39 offset:16928
v_mfma_f32_16x16x32_bf16 a[96:99], a[216:219], v[160:163], a[96:99]
ds_read_b64_tr_b16 a[214:215], v39 offset:21152
v_mfma_f32_16x16x32_bf16 a[100:103], a[216:219], v[164:167], a[100:103]
v_mfma_f32_16x16x32_bf16 a[104:107], a[216:219], v[168:171], a[104:107]
v_mfma_f32_16x16x32_bf16 a[108:111], a[216:219], v[172:175], a[108:111]
v_mfma_f32_16x16x32_bf16 a[112:115], a[216:219], v[176:179], a[112:115]
v_mfma_f32_16x16x32_bf16 a[116:119], a[216:219], v[180:183], a[116:119]
ds_read_b64_tr_b16 a[216:217], v40 offset:16896
v_mfma_f32_16x16x32_bf16 a[120:123], a[220:223], v[160:163], a[120:123]
ds_read_b64_tr_b16 a[218:219], v40 offset:21120
v_mfma_f32_16x16x32_bf16 a[124:127], a[220:223], v[164:167], a[124:127]
v_mfma_f32_16x16x32_bf16 a[128:131], a[220:223], v[168:171], a[128:131]
v_mfma_f32_16x16x32_bf16 a[132:135], a[220:223], v[172:175], a[132:135]
v_mfma_f32_16x16x32_bf16 a[136:139], a[220:223], v[176:179], a[136:139]
v_mfma_f32_16x16x32_bf16 a[140:143], a[220:223], v[180:183], a[140:143]
ds_read_b64_tr_b16 a[220:221], v40 offset:16928
s_waitcnt vmcnt(19)
v_mfma_f32_16x16x32_bf16 v[64:67], a[192:195], v[112:115], v[64:67]
ds_read_b64_tr_b16 a[222:223], v40 offset:21152
s_waitcnt vmcnt(18)
v_mfma_f32_16x16x32_bf16 v[68:71], a[192:195], v[116:119], v[68:71]
s_waitcnt vmcnt(17)
v_mfma_f32_16x16x32_bf16 v[72:75], a[192:195], v[120:123], v[72:75]
v_lshlrev_b32 v28, 4, v1
s_waitcnt vmcnt(16)
v_mfma_f32_16x16x32_bf16 v[76:79], a[192:195], v[124:127], v[76:79]
s_waitcnt vmcnt(15)
v_mfma_f32_16x16x32_bf16 v[80:83], a[192:195], v[128:131], v[80:83]
v_add_u32 v24, s78, v28
s_waitcnt vmcnt(14)
v_mfma_f32_16x16x32_bf16 v[84:87], a[192:195], v[132:135], v[84:87]
s_waitcnt vmcnt(6)
ds_read_b64_tr_b16 a[192:193], v17 offset:25344
v_mfma_f32_16x16x32_bf16 v[88:91], a[196:199], v[112:115], v[88:91]
s_mul_i32 s58, s3, 3072
ds_read_b64_tr_b16 a[194:195], v17 offset:29568
v_mfma_f32_16x16x32_bf16 v[92:95], a[196:199], v[116:119], v[92:95]
v_mfma_f32_16x16x32_bf16 v[96:99], a[196:199], v[120:123], v[96:99]
s_add_u32 s58, s58, 135168
v_mfma_f32_16x16x32_bf16 v[100:103], a[196:199], v[124:127], v[100:103]
v_mfma_f32_16x16x32_bf16 v[104:107], a[196:199], v[128:131], v[104:107]
v_add_u32 v25, s58, v28
v_mfma_f32_16x16x32_bf16 v[108:111], a[196:199], v[132:135], v[108:111]
ds_read_b64_tr_b16 a[196:197], v17 offset:25376
s_waitcnt lgkmcnt(3)
v_mfma_f32_16x16x32_bf16 a[0:3], a[200:203], v[112:115], a[0:3]
s_sub_u32 s58, s3, 1
ds_read_b64_tr_b16 a[198:199], v17 offset:29600
v_mfma_f32_16x16x32_bf16 a[4:7], a[200:203], v[116:119], a[4:7]
v_mfma_f32_16x16x32_bf16 a[8:11], a[200:203], v[120:123], a[8:11]
s_and_b32 s58, s58, 3
v_mfma_f32_16x16x32_bf16 a[12:15], a[200:203], v[124:127], a[12:15]
v_mfma_f32_16x16x32_bf16 a[16:19], a[200:203], v[128:131], a[16:19]
s_mul_i32 s59, s58, 33792
v_mfma_f32_16x16x32_bf16 a[20:23], a[200:203], v[132:135], a[20:23]
ds_read_b64_tr_b16 a[200:201], v18 offset:25344
v_mfma_f32_16x16x32_bf16 a[24:27], a[204:207], v[112:115], a[24:27]
v_add_u32 v26, s59, v28
ds_read_b64_tr_b16 a[202:203], v18 offset:29568
v_mfma_f32_16x16x32_bf16 a[28:31], a[204:207], v[116:119], a[28:31]
v_mfma_f32_16x16x32_bf16 a[32:35], a[204:207], v[120:123], a[32:35]
s_sub_u32 s58, s3, 2
v_mfma_f32_16x16x32_bf16 a[36:39], a[204:207], v[124:127], a[36:39]
v_mfma_f32_16x16x32_bf16 a[40:43], a[204:207], v[128:131], a[40:43]
s_and_b32 s58, s58, 3
v_mfma_f32_16x16x32_bf16 a[44:47], a[204:207], v[132:135], a[44:47]
ds_read_b64_tr_b16 a[204:205], v18 offset:25376
v_mfma_f32_16x16x32_bf16 a[48:51], a[208:211], v[112:115], a[48:51]
s_mul_i32 s59, s58, 33792
ds_read_b64_tr_b16 a[206:207], v18 offset:29600
v_mfma_f32_16x16x32_bf16 a[52:55], a[208:211], v[116:119], a[52:55]
v_mfma_f32_16x16x32_bf16 a[56:59], a[208:211], v[120:123], a[56:59]
v_add_u32 v27, s59, v28
v_mfma_f32_16x16x32_bf16 a[60:63], a[208:211], v[124:127], a[60:63]
v_mfma_f32_16x16x32_bf16 a[64:67], a[208:211], v[128:131], a[64:67]
s_sub_u32 s58, s3, 3
v_mfma_f32_16x16x32_bf16 a[68:71], a[208:211], v[132:135], a[68:71]
ds_read_b64_tr_b16 a[208:209], v39 offset:25344
v_mfma_f32_16x16x32_bf16 a[72:75], a[212:215], v[112:115], a[72:75]
s_and_b32 s58, s58, 3
ds_read_b64_tr_b16 a[210:211], v39 offset:29568
v_mfma_f32_16x16x32_bf16 a[76:79], a[212:215], v[116:119], a[76:79]
v_mfma_f32_16x16x32_bf16 a[80:83], a[212:215], v[120:123], a[80:83]
s_mul_i32 s59, s58, 33792
v_mfma_f32_16x16x32_bf16 a[84:87], a[212:215], v[124:127], a[84:87]
v_mfma_f32_16x16x32_bf16 a[88:91], a[212:215], v[128:131], a[88:91]
v_add_u32 v29, s59, v28
v_mfma_f32_16x16x32_bf16 a[92:95], a[212:215], v[132:135], a[92:95]
ds_read_b64_tr_b16 a[212:213], v39 offset:25376
v_mfma_f32_16x16x32_bf16 a[96:99], a[216:219], v[112:115], a[96:99]
s_mul_i32 s58, s58, 3072
ds_read_b64_tr_b16 a[214:215], v39 offset:29600
v_mfma_f32_16x16x32_bf16 a[100:103], a[216:219], v[116:119], a[100:103]
v_mfma_f32_16x16x32_bf16 a[104:107], a[216:219], v[120:123], a[104:107]
s_add_u32 s58, s58, 135168
v_mfma_f32_16x16x32_bf16 a[108:111], a[216:219], v[124:127], a[108:111]
v_mfma_f32_16x16x32_bf16 a[112:115], a[216:219], v[128:131], a[112:115]
v_add_u32 v31, s58, v28
v_mfma_f32_16x16x32_bf16 a[116:119], a[216:219], v[132:135], a[116:119]
ds_read_b64_tr_b16 a[216:217], v40 offset:25344
v_mfma_f32_16x16x32_bf16 a[120:123], a[220:223], v[112:115], a[120:123]
ds_read_b64_tr_b16 a[218:219], v40 offset:29568
v_mfma_f32_16x16x32_bf16 a[124:127], a[220:223], v[116:119], a[124:127]
v_mfma_f32_16x16x32_bf16 a[128:131], a[220:223], v[120:123], a[128:131]
v_mfma_f32_16x16x32_bf16 a[132:135], a[220:223], v[124:127], a[132:135]
v_mfma_f32_16x16x32_bf16 a[136:139], a[220:223], v[128:131], a[136:139]
v_mfma_f32_16x16x32_bf16 a[140:143], a[220:223], v[132:135], a[140:143]
ds_read_b64_tr_b16 a[220:221], v40 offset:25376
s_waitcnt vmcnt(5) lgkmcnt(3)
v_mfma_f32_16x16x32_bf16 a[0:3], a[200:203], v[136:139], a[0:3]
ds_read_b64_tr_b16 a[222:223], v40 offset:29600
s_waitcnt vmcnt(4)
v_mfma_f32_16x16x32_bf16 a[4:7], a[200:203], v[140:143], a[4:7]
s_waitcnt vmcnt(3)
v_mfma_f32_16x16x32_bf16 a[8:11], a[200:203], v[144:147], a[8:11]
s_waitcnt vmcnt(2)
v_mfma_f32_16x16x32_bf16 a[12:15], a[200:203], v[148:151], a[12:15]
s_waitcnt vmcnt(1)
v_mfma_f32_16x16x32_bf16 a[16:19], a[200:203], v[152:155], a[16:19]
s_waitcnt vmcnt(0)
v_mfma_f32_16x16x32_bf16 a[20:23], a[200:203], v[156:159], a[20:23]
v_mfma_f32_16x16x32_bf16 a[24:27], a[204:207], v[136:139], a[24:27]
v_mfma_f32_16x16x32_bf16 a[28:31], a[204:207], v[140:143], a[28:31]
v_mfma_f32_16x16x32_bf16 a[32:35], a[204:207], v[144:147], a[32:35]
v_mfma_f32_16x16x32_bf16 a[36:39], a[204:207], v[148:151], a[36:39]
v_mfma_f32_16x16x32_bf16 a[40:43], a[204:207], v[152:155], a[40:43]
ds_write_b128 v24, a[0:3]
v_mfma_f32_16x16x32_bf16 a[44:47], a[204:207], v[156:159], a[44:47]
ds_write_b128 v24, a[4:7] offset:1024
v_mfma_f32_16x16x32_bf16 a[48:51], a[208:211], v[136:139], a[48:51]
ds_write_b128 v24, a[8:11] offset:2048
v_mfma_f32_16x16x32_bf16 a[52:55], a[208:211], v[140:143], a[52:55]
ds_write_b128 v24, a[12:15] offset:3072
v_mfma_f32_16x16x32_bf16 a[56:59], a[208:211], v[144:147], a[56:59]
ds_write_b128 v24, a[16:19] offset:4096
v_mfma_f32_16x16x32_bf16 a[60:63], a[208:211], v[148:151], a[60:63]
ds_write_b128 v24, a[20:23] offset:5120
v_mfma_f32_16x16x32_bf16 a[64:67], a[208:211], v[152:155], a[64:67]
ds_write_b128 v24, a[24:27] offset:6144
v_mfma_f32_16x16x32_bf16 a[68:71], a[208:211], v[156:159], a[68:71]
ds_write_b128 v24, a[28:31] offset:7168
v_mfma_f32_16x16x32_bf16 a[72:75], a[212:215], v[136:139], a[72:75]
ds_write_b128 v24, a[32:35] offset:8192
v_mfma_f32_16x16x32_bf16 a[76:79], a[212:215], v[140:143], a[76:79]
ds_write_b128 v24, a[36:39] offset:9216
v_mfma_f32_16x16x32_bf16 a[80:83], a[212:215], v[144:147], a[80:83]
ds_write_b128 v24, a[40:43] offset:10240
v_mfma_f32_16x16x32_bf16 a[84:87], a[212:215], v[148:151], a[84:87]
ds_write_b128 v24, a[44:47] offset:11264
v_mfma_f32_16x16x32_bf16 a[88:91], a[212:215], v[152:155], a[88:91]
ds_write_b128 v24, a[48:51] offset:12288
v_mfma_f32_16x16x32_bf16 a[92:95], a[212:215], v[156:159], a[92:95]
ds_write_b128 v24, a[52:55] offset:13312
s_waitcnt lgkmcnt(7)
v_mfma_f32_16x16x32_bf16 a[96:99], a[216:219], v[136:139], a[96:99]
ds_write_b128 v24, a[56:59] offset:14336
v_mfma_f32_16x16x32_bf16 a[100:103], a[216:219], v[140:143], a[100:103]
ds_write_b128 v24, a[60:63] offset:15360
v_mfma_f32_16x16x32_bf16 a[104:107], a[216:219], v[144:147], a[104:107]
ds_write_b128 v24, a[64:67] offset:16384
v_mfma_f32_16x16x32_bf16 a[108:111], a[216:219], v[148:151], a[108:111]
ds_write_b128 v24, a[68:71] offset:17408
v_mfma_f32_16x16x32_bf16 a[112:115], a[216:219], v[152:155], a[112:115]
ds_write_b128 v24, a[72:75] offset:18432
v_mfma_f32_16x16x32_bf16 a[116:119], a[216:219], v[156:159], a[116:119]
ds_write_b128 v24, a[76:79] offset:19456
v_mfma_f32_16x16x32_bf16 a[120:123], a[220:223], v[136:139], a[120:123]
ds_write_b128 v24, a[80:83] offset:20480
v_mfma_f32_16x16x32_bf16 a[124:127], a[220:223], v[140:143], a[124:127]
ds_write_b128 v24, a[84:87] offset:21504
v_mfma_f32_16x16x32_bf16 a[128:131], a[220:223], v[144:147], a[128:131]
ds_write_b128 v24, a[88:91] offset:22528
v_mfma_f32_16x16x32_bf16 a[132:135], a[220:223], v[148:151], a[132:135]
ds_write_b128 v24, a[92:95] offset:23552
v_mfma_f32_16x16x32_bf16 a[136:139], a[220:223], v[152:155], a[136:139]
ds_write_b128 v24, a[96:99] offset:24576
v_mfma_f32_16x16x32_bf16 a[140:143], a[220:223], v[156:159], a[140:143]
ds_write_b128 v24, a[100:103] offset:25600
v_mfma_f32_16x16x32_bf16 v[64:67], a[192:195], v[136:139], v[64:67]
ds_write_b128 v24, a[104:107] offset:26624
v_mfma_f32_16x16x32_bf16 v[68:71], a[192:195], v[140:143], v[68:71]
ds_write_b128 v24, a[108:111] offset:27648
v_mfma_f32_16x16x32_bf16 v[72:75], a[192:195], v[144:147], v[72:75]
ds_write_b128 v24, a[112:115] offset:28672
v_mfma_f32_16x16x32_bf16 v[76:79], a[192:195], v[148:151], v[76:79]
ds_write_b128 v24, a[116:119] offset:29696
v_mfma_f32_16x16x32_bf16 v[80:83], a[192:195], v[152:155], v[80:83]
ds_write_b128 v24, a[120:123] offset:30720
v_mfma_f32_16x16x32_bf16 v[84:87], a[192:195], v[156:159], v[84:87]
ds_write_b128 v24, a[124:127] offset:31744
v_mfma_f32_16x16x32_bf16 v[88:91], a[196:199], v[136:139], v[88:91]
ds_write_b128 v24, a[128:131] offset:32768
v_mfma_f32_16x16x32_bf16 v[92:95], a[196:199], v[140:143], v[92:95]
ds_write_b128 v25, a[132:135]
v_mfma_f32_16x16x32_bf16 v[96:99], a[196:199], v[144:147], v[96:99]
ds_write_b128 v25, a[136:139] offset:1024
v_mfma_f32_16x16x32_bf16 v[100:103], a[196:199], v[148:151], v[100:103]
ds_write_b128 v25, a[140:143] offset:2048
v_mfma_f32_16x16x32_bf16 v[104:107], a[196:199], v[152:155], v[104:107]
v_mfma_f32_16x16x32_bf16 v[108:111], a[196:199], v[156:159], v[108:111]
s_waitcnt lgkmcnt(0)
s_barrier
ds_read_b128 v[112:115], v26
ds_read_b128 v[116:119], v26 offset:1024
ds_read_b128 v[120:123], v26 offset:2048
ds_read_b128 v[124:127], v26 offset:3072
ds_read_b128 v[128:131], v26 offset:4096
ds_read_b128 v[132:135], v26 offset:5120
ds_read_b128 v[136:139], v26 offset:6144
ds_read_b128 v[140:143], v26 offset:7168
ds_read_b128 v[144:147], v26 offset:8192
ds_read_b128 v[148:151], v26 offset:9216
ds_read_b128 v[152:155], v26 offset:10240
ds_read_b128 v[156:159], v26 offset:11264
ds_read_b128 v[160:163], v27 offset:12288
ds_read_b128 v[164:167], v27 offset:13312
ds_read_b128 v[168:171], v27 offset:14336
ds_read_b128 v[172:175], v27 offset:15360
ds_read_b128 v[176:179], v27 offset:16384
ds_read_b128 v[180:183], v27 offset:17408
ds_read_b128 v[184:187], v27 offset:18432
ds_read_b128 v[188:191], v27 offset:19456
ds_read_b128 v[192:195], v27 offset:20480
ds_read_b128 v[196:199], v27 offset:21504
ds_read_b128 v[200:203], v27 offset:22528
ds_read_b128 v[204:207], v27 offset:23552
v_and_b32 v28, 15, v1
v_lshlrev_b32 v28, 11, v28
v_lshrrev_b32 v24, 4, v1
v_lshlrev_b32 v24, 4, v24
v_add_u32 v28, v28, v24
s_lshl_b32 s58, s3, 6
v_add_u32 v30, s58, v28
s_waitcnt lgkmcnt(7)
v_add_f32 v64, v64, v112
v_add_f32 v65, v65, v113
v_add_f32 v66, v66, v114
v_add_f32 v67, v67, v115
v_add_f32 v68, v68, v116
v_add_f32 v69, v69, v117
v_add_f32 v70, v70, v118
v_add_f32 v71, v71, v119
v_add_f32 v72, v72, v120
v_add_f32 v73, v73, v121
v_add_f32 v74, v74, v122
v_add_f32 v75, v75, v123
v_add_f32 v76, v76, v124
v_add_f32 v77, v77, v125
v_add_f32 v78, v78, v126
v_add_f32 v79, v79, v127
v_add_f32 v80, v80, v128
v_add_f32 v81, v81, v129
v_add_f32 v82, v82, v130
v_add_f32 v83, v83, v131
v_add_f32 v84, v84, v132
v_add_f32 v85, v85, v133
v_add_f32 v86, v86, v134
v_add_f32 v87, v87, v135
v_add_f32 v88, v88, v136
v_add_f32 v89, v89, v137
v_add_f32 v90, v90, v138
v_add_f32 v91, v91, v139
v_add_f32 v92, v92, v140
v_add_f32 v93, v93, v141
v_add_f32 v94, v94, v142
v_add_f32 v95, v95, v143
v_add_f32 v96, v96, v144
v_add_f32 v97, v97, v145
v_add_f32 v98, v98, v146
v_add_f32 v99, v99, v147
v_add_f32 v100, v100, v148
v_add_f32 v101, v101, v149
v_add_f32 v102, v102, v150
v_add_f32 v103, v103, v151
v_add_f32 v104, v104, v152
v_add_f32 v105, v105, v153
v_add_f32 v106, v106, v154
v_add_f32 v107, v107, v155
v_add_f32 v108, v108, v156
v_add_f32 v109, v109, v157
v_add_f32 v110, v110, v158
v_add_f32 v111, v111, v159
ds_read_b128 v[112:115], v29 offset:24576
ds_read_b128 v[116:119], v29 offset:25600
ds_read_b128 v[120:123], v29 offset:26624
ds_read_b128 v[124:127], v29 offset:27648
ds_read_b128 v[128:131], v29 offset:28672
ds_read_b128 v[132:135], v29 offset:29696
ds_read_b128 v[136:139], v29 offset:30720
ds_read_b128 v[140:143], v29 offset:31744
ds_read_b128 v[144:147], v29 offset:32768
ds_read_b128 v[148:151], v31
ds_read_b128 v[152:155], v31 offset:1024
ds_read_b128 v[156:159], v31 offset:2048
v_add_f32 v64, v64, v160
v_add_f32 v65, v65, v161
v_add_f32 v66, v66, v162
v_add_f32 v67, v67, v163
v_add_f32 v68, v68, v164
v_add_f32 v69, v69, v165
v_add_f32 v70, v70, v166
v_add_f32 v71, v71, v167
v_add_f32 v72, v72, v168
v_add_f32 v73, v73, v169
v_add_f32 v74, v74, v170
v_add_f32 v75, v75, v171
v_add_f32 v76, v76, v172
v_add_f32 v77, v77, v173
v_add_f32 v78, v78, v174
v_add_f32 v79, v79, v175
v_add_f32 v80, v80, v176
v_add_f32 v81, v81, v177
v_add_f32 v82, v82, v178
v_add_f32 v83, v83, v179
s_waitcnt lgkmcnt(0)
v_add_f32 v84, v84, v180
v_add_f32 v85, v85, v181
v_add_f32 v86, v86, v182
v_add_f32 v87, v87, v183
v_add_f32 v88, v88, v184
v_add_f32 v89, v89, v185
v_add_f32 v90, v90, v186
v_add_f32 v91, v91, v187
v_add_f32 v92, v92, v188
v_add_f32 v93, v93, v189
v_add_f32 v94, v94, v190
v_add_f32 v95, v95, v191
v_add_f32 v96, v96, v192
v_add_f32 v97, v97, v193
v_add_f32 v98, v98, v194
v_add_f32 v99, v99, v195
v_add_f32 v100, v100, v196
v_add_f32 v101, v101, v197
v_add_f32 v102, v102, v198
v_add_f32 v103, v103, v199
v_add_f32 v104, v104, v200
v_add_f32 v105, v105, v201
v_add_f32 v106, v106, v202
v_add_f32 v107, v107, v203
v_add_f32 v108, v108, v204
v_add_f32 v109, v109, v205
v_add_f32 v110, v110, v206
v_add_f32 v111, v111, v207
v_add_f32 v64, v64, v112
v_add_f32 v65, v65, v113
v_add_f32 v66, v66, v114
v_add_f32 v67, v67, v115
v_add_f32 v68, v68, v116
v_add_f32 v69, v69, v117
v_add_f32 v70, v70, v118
v_add_f32 v71, v71, v119
v_add_f32 v72, v72, v120
v_add_f32 v73, v73, v121
v_add_f32 v74, v74, v122
v_add_f32 v75, v75, v123
v_add_f32 v76, v76, v124
v_add_f32 v77, v77, v125
v_add_f32 v78, v78, v126
v_add_f32 v79, v79, v127
v_add_f32 v80, v80, v128
v_add_f32 v81, v81, v129
v_add_f32 v82, v82, v130
v_add_f32 v83, v83, v131
v_add_f32 v84, v84, v132
v_add_f32 v85, v85, v133
v_add_f32 v86, v86, v134
v_add_f32 v87, v87, v135
v_add_f32 v88, v88, v136
v_add_f32 v89, v89, v137
v_add_f32 v90, v90, v138
v_add_f32 v91, v91, v139
v_add_f32 v92, v92, v140
v_add_f32 v93, v93, v141
v_add_f32 v94, v94, v142
v_add_f32 v95, v95, v143
v_add_f32 v96, v96, v144
v_add_f32 v97, v97, v145
v_add_f32 v98, v98, v146
v_add_f32 v99, v99, v147
v_add_f32 v100, v100, v148
v_add_f32 v101, v101, v149
v_add_f32 v102, v102, v150
v_add_f32 v103, v103, v151
v_add_f32 v104, v104, v152
v_add_f32 v105, v105, v153
v_add_f32 v106, v106, v154
v_add_f32 v107, v107, v155
v_add_f32 v108, v108, v156
v_add_f32 v109, v109, v157
v_add_f32 v110, v110, v158
v_add_f32 v111, v111, v159
v_cvt_pk_bf16_f32 v208, v64, v65
v_cvt_pk_bf16_f32 v209, v66, v67
v_cvt_pk_bf16_f32 v210, v88, v89
v_cvt_pk_bf16_f32 v211, v90, v91
v_cvt_pk_bf16_f32 v212, v68, v69
v_cvt_pk_bf16_f32 v213, v70, v71
v_cvt_pk_bf16_f32 v214, v92, v93
v_cvt_pk_bf16_f32 v215, v94, v95
v_cvt_pk_bf16_f32 v216, v72, v73
v_cvt_pk_bf16_f32 v217, v74, v75
v_cvt_pk_bf16_f32 v218, v96, v97
v_cvt_pk_bf16_f32 v219, v98, v99
v_cvt_pk_bf16_f32 v220, v76, v77
v_cvt_pk_bf16_f32 v221, v78, v79
v_cvt_pk_bf16_f32 v222, v100, v101
v_cvt_pk_bf16_f32 v223, v102, v103
v_cvt_pk_bf16_f32 v224, v80, v81
v_cvt_pk_bf16_f32 v225, v82, v83
v_cvt_pk_bf16_f32 v226, v104, v105
v_cvt_pk_bf16_f32 v227, v106, v107
v_cvt_pk_bf16_f32 v228, v84, v85
v_cvt_pk_bf16_f32 v229, v86, v87
v_cvt_pk_bf16_f32 v230, v108, v109
v_cvt_pk_bf16_f32 v231, v110, v111
v_permlane32_swap_b32 v208, v210
v_permlane32_swap_b32 v209, v211
v_permlane32_swap_b32 v212, v214
v_permlane32_swap_b32 v213, v215
v_permlane32_swap_b32 v216, v218
v_permlane32_swap_b32 v217, v219
v_permlane32_swap_b32 v220, v222
v_permlane32_swap_b32 v221, v223
v_permlane32_swap_b32 v224, v226
v_permlane32_swap_b32 v225, v227
v_permlane32_swap_b32 v228, v230
v_permlane32_swap_b32 v229, v231
v_permlane16_swap_b32 v208, v210
v_permlane16_swap_b32 v209, v211
v_permlane16_swap_b32 v212, v214
v_permlane16_swap_b32 v213, v215
v_permlane16_swap_b32 v216, v218
v_permlane16_swap_b32 v217, v219
v_permlane16_swap_b32 v220, v222
v_permlane16_swap_b32 v221, v223
v_permlane16_swap_b32 v224, v226
v_permlane16_swap_b32 v225, v227
v_permlane16_swap_b32 v228, v230
v_permlane16_swap_b32 v229, v231
s_mov_b32 s59, 0
buffer_store_dwordx4 v[208:211], v30, s[88:91], s59 offen sc1 nt
s_mov_b32 s59, 32768
buffer_store_dwordx4 v[212:215], v30, s[88:91], s59 offen sc1 nt
s_mov_b32 s59, 65536
buffer_store_dwordx4 v[216:219], v30, s[88:91], s59 offen sc1 nt
s_mov_b32 s59, 98304
buffer_store_dwordx4 v[220:223], v30, s[88:91], s59 offen sc1 nt
s_mov_b32 s59, 131072
buffer_store_dwordx4 v[224:227], v30, s[88:91], s59 offen sc1 nt
s_mov_b32 s59, 163840
buffer_store_dwordx4 v[228:231], v30, s[88:91], s59 offen sc1 nt
L_concat_heads__mha_block_cached__gqa_block_cached__near_ridge_kernel_end:
    s_endpgm
L_concat_heads__mha_block_cached__gqa_block_cached__near_ridge_kernel_codeend:
L_concat_heads__mha_block_cached__gqa_block_cached__near_ridge_kernel_slow0:
    s_waitcnt vmcnt(0) lgkmcnt(0)
    s_nop 15
    s_nop 15
    v_and_b32 v254, 15, v1
    v_lshrrev_b32 v255, 4, v1
    v_lshlrev_b32 v86, 8, v254
    v_lshlrev_b32 v248, 3, v255
    v_add_u32 v86, v86, v248
    v_add_u32 v87, 0x1000, v86
    v_lshlrev_b32 v94, 10, v255
    v_lshlrev_b32 v248, 1, v254
    v_add_u32 v94, v94, v248
    v_add_u32 v95, 0x1000, v94
    v_mov_b32 v80, 0xff800000
    v_mov_b32 v81, 0xff800000
    v_mov_b32 v82, 0xff800000
    v_mov_b32 v83, 0xff800000
    v_mov_b32 v84, 0xff800000
    v_mov_b32 v85, 0xff800000
    s_mov_b32 s58, 0
L_concat_heads__mha_block_cached__gqa_block_cached__near_ridge_kernel_slow0_p1:
    buffer_load_dwordx2 v[112:113], v86, s[24:27], s58 offen offset:0
    buffer_load_dwordx2 v[114:115], v86, s[24:27], s58 offen offset:32
    buffer_load_dwordx2 v[116:117], v86, s[24:27], s58 offen offset:64
    buffer_load_dwordx2 v[118:119], v86, s[24:27], s58 offen offset:96
    buffer_load_dwordx2 v[120:121], v86, s[24:27], s58 offen offset:128
    buffer_load_dwordx2 v[122:123], v86, s[24:27], s58 offen offset:160
    buffer_load_dwordx2 v[124:125], v86, s[24:27], s58 offen offset:192
    buffer_load_dwordx2 v[126:127], v86, s[24:27], s58 offen offset:224
    buffer_load_dwordx2 v[144:145], v87, s[24:27], s58 offen offset:0
    buffer_load_dwordx2 v[146:147], v87, s[24:27], s58 offen offset:32
    buffer_load_dwordx2 v[148:149], v87, s[24:27], s58 offen offset:64
    buffer_load_dwordx2 v[150:151], v87, s[24:27], s58 offen offset:96
    buffer_load_dwordx2 v[152:153], v87, s[24:27], s58 offen offset:128
    buffer_load_dwordx2 v[154:155], v87, s[24:27], s58 offen offset:160
    buffer_load_dwordx2 v[156:157], v87, s[24:27], s58 offen offset:192
    buffer_load_dwordx2 v[158:159], v87, s[24:27], s58 offen offset:224
    s_waitcnt vmcnt(0)
    v_mfma_f32_16x16x32_bf16 v[240:243], v[112:115], v[64:67], 0
    v_mfma_f32_16x16x32_bf16 v[240:243], v[116:119], v[68:71], v[240:243]
    v_mfma_f32_16x16x32_bf16 v[240:243], v[120:123], v[72:75], v[240:243]
    v_mfma_f32_16x16x32_bf16 v[240:243], v[124:127], v[76:79], v[240:243]
    v_mfma_f32_16x16x32_bf16 v[244:247], v[144:147], v[64:67], 0
    v_mfma_f32_16x16x32_bf16 v[244:247], v[148:151], v[68:71], v[244:247]
    v_mfma_f32_16x16x32_bf16 v[244:247], v[152:155], v[72:75], v[244:247]
    v_mfma_f32_16x16x32_bf16 v[244:247], v[156:159], v[76:79], v[244:247]
    s_nop 15
    s_nop 15
    v_max3_f32 v80, v240, v241, v80
    v_max3_f32 v80, v242, v243, v80
    v_max3_f32 v80, v244, v245, v80
    v_max3_f32 v80, v246, v247, v80
    s_nop 7
    v_mfma_f32_16x16x32_bf16 v[240:243], v[112:115], v[96:99], 0
    v_mfma_f32_16x16x32_bf16 v[240:243], v[116:119], v[100:103], v[240:243]
    v_mfma_f32_16x16x32_bf16 v[240:243], v[120:123], v[104:107], v[240:243]
    v_mfma_f32_16x16x32_bf16 v[240:243], v[124:127], v[108:111], v[240:243]
    v_mfma_f32_16x16x32_bf16 v[244:247], v[144:147], v[96:99], 0
    v_mfma_f32_16x16x32_bf16 v[244:247], v[148:151], v[100:103], v[244:247]
    v_mfma_f32_16x16x32_bf16 v[244:247], v[152:155], v[104:107], v[244:247]
    v_mfma_f32_16x16x32_bf16 v[244:247], v[156:159], v[108:111], v[244:247]
    s_nop 15
    s_nop 15
    v_max3_f32 v81, v240, v241, v81
    v_max3_f32 v81, v242, v243, v81
    v_max3_f32 v81, v244, v245, v81
    v_max3_f32 v81, v246, v247, v81
    s_nop 7
    v_mfma_f32_16x16x32_bf16 v[240:243], v[112:115], v[128:131], 0
    v_mfma_f32_16x16x32_bf16 v[240:243], v[116:119], v[132:135], v[240:243]
    v_mfma_f32_16x16x32_bf16 v[240:243], v[120:123], v[136:139], v[240:243]
    v_mfma_f32_16x16x32_bf16 v[240:243], v[124:127], v[140:143], v[240:243]
    v_mfma_f32_16x16x32_bf16 v[244:247], v[144:147], v[128:131], 0
    v_mfma_f32_16x16x32_bf16 v[244:247], v[148:151], v[132:135], v[244:247]
    v_mfma_f32_16x16x32_bf16 v[244:247], v[152:155], v[136:139], v[244:247]
    v_mfma_f32_16x16x32_bf16 v[244:247], v[156:159], v[140:143], v[244:247]
    s_nop 15
    s_nop 15
    v_max3_f32 v82, v240, v241, v82
    v_max3_f32 v82, v242, v243, v82
    v_max3_f32 v82, v244, v245, v82
    v_max3_f32 v82, v246, v247, v82
    s_nop 7
    v_mfma_f32_16x16x32_bf16 v[240:243], v[112:115], v[160:163], 0
    v_mfma_f32_16x16x32_bf16 v[240:243], v[116:119], v[164:167], v[240:243]
    v_mfma_f32_16x16x32_bf16 v[240:243], v[120:123], v[168:171], v[240:243]
    v_mfma_f32_16x16x32_bf16 v[240:243], v[124:127], v[172:175], v[240:243]
    v_mfma_f32_16x16x32_bf16 v[244:247], v[144:147], v[160:163], 0
    v_mfma_f32_16x16x32_bf16 v[244:247], v[148:151], v[164:167], v[244:247]
    v_mfma_f32_16x16x32_bf16 v[244:247], v[152:155], v[168:171], v[244:247]
    v_mfma_f32_16x16x32_bf16 v[244:247], v[156:159], v[172:175], v[244:247]
    s_nop 15
    s_nop 15
    v_max3_f32 v83, v240, v241, v83
    v_max3_f32 v83, v242, v243, v83
    v_max3_f32 v83, v244, v245, v83
    v_max3_f32 v83, v246, v247, v83
    s_nop 7
    v_mfma_f32_16x16x32_bf16 v[240:243], v[112:115], v[192:195], 0
    v_mfma_f32_16x16x32_bf16 v[240:243], v[116:119], v[196:199], v[240:243]
    v_mfma_f32_16x16x32_bf16 v[240:243], v[120:123], v[200:203], v[240:243]
    v_mfma_f32_16x16x32_bf16 v[240:243], v[124:127], v[204:207], v[240:243]
    v_mfma_f32_16x16x32_bf16 v[244:247], v[144:147], v[192:195], 0
    v_mfma_f32_16x16x32_bf16 v[244:247], v[148:151], v[196:199], v[244:247]
    v_mfma_f32_16x16x32_bf16 v[244:247], v[152:155], v[200:203], v[244:247]
    v_mfma_f32_16x16x32_bf16 v[244:247], v[156:159], v[204:207], v[244:247]
    s_nop 15
    s_nop 15
    v_max3_f32 v84, v240, v241, v84
    v_max3_f32 v84, v242, v243, v84
    v_max3_f32 v84, v244, v245, v84
    v_max3_f32 v84, v246, v247, v84
    s_nop 7
    v_mfma_f32_16x16x32_bf16 v[240:243], v[112:115], v[224:227], 0
    v_mfma_f32_16x16x32_bf16 v[240:243], v[116:119], v[228:231], v[240:243]
    v_mfma_f32_16x16x32_bf16 v[240:243], v[120:123], v[232:235], v[240:243]
    v_mfma_f32_16x16x32_bf16 v[240:243], v[124:127], v[236:239], v[240:243]
    v_mfma_f32_16x16x32_bf16 v[244:247], v[144:147], v[224:227], 0
    v_mfma_f32_16x16x32_bf16 v[244:247], v[148:151], v[228:231], v[244:247]
    v_mfma_f32_16x16x32_bf16 v[244:247], v[152:155], v[232:235], v[244:247]
    v_mfma_f32_16x16x32_bf16 v[244:247], v[156:159], v[236:239], v[244:247]
    s_nop 15
    s_nop 15
    v_max3_f32 v85, v240, v241, v85
    v_max3_f32 v85, v242, v243, v85
    v_max3_f32 v85, v244, v245, v85
    v_max3_f32 v85, v246, v247, v85
    s_nop 7
    s_add_u32 s58, s58, 0x2000
    s_cmp_lt_u32 s58, 0x20000
    s_cbranch_scc1 L_concat_heads__mha_block_cached__gqa_block_cached__near_ridge_kernel_slow0_p1
    v_mov_b32 v248, v80
    s_nop 1
    v_permlane32_swap_b32 v80, v248
    s_nop 1
    v_max_f32 v80, v80, v248
    v_mov_b32 v248, v80
    s_nop 1
    v_permlane16_swap_b32 v80, v248
    s_nop 1
    v_max_f32 v80, v80, v248
    v_mov_b32 v248, v81
    s_nop 1
    v_permlane32_swap_b32 v81, v248
    s_nop 1
    v_max_f32 v81, v81, v248
    v_mov_b32 v248, v81
    s_nop 1
    v_permlane16_swap_b32 v81, v248
    s_nop 1
    v_max_f32 v81, v81, v248
    v_mov_b32 v248, v82
    s_nop 1
    v_permlane32_swap_b32 v82, v248
    s_nop 1
    v_max_f32 v82, v82, v248
    v_mov_b32 v248, v82
    s_nop 1
    v_permlane16_swap_b32 v82, v248
    s_nop 1
    v_max_f32 v82, v82, v248
    v_mov_b32 v248, v83
    s_nop 1
    v_permlane32_swap_b32 v83, v248
    s_nop 1
    v_max_f32 v83, v83, v248
    v_mov_b32 v248, v83
    s_nop 1
    v_permlane16_swap_b32 v83, v248
    s_nop 1
    v_max_f32 v83, v83, v248
    v_mov_b32 v248, v84
    s_nop 1
    v_permlane32_swap_b32 v84, v248
    s_nop 1
    v_max_f32 v84, v84, v248
    v_mov_b32 v248, v84
    s_nop 1
    v_permlane16_swap_b32 v84, v248
    s_nop 1
    v_max_f32 v84, v84, v248
    v_mov_b32 v248, v85
    s_nop 1
    v_permlane32_swap_b32 v85, v248
    s_nop 1
    v_max_f32 v85, v85, v248
    v_mov_b32 v248, v85
    s_nop 1
    v_permlane16_swap_b32 v85, v248
    s_nop 1
    v_max_f32 v85, v85, v248
    v_accvgpr_write_b32 a0, 0
    v_accvgpr_write_b32 a1, 0
    v_accvgpr_write_b32 a2, 0
    v_accvgpr_write_b32 a3, 0
    v_accvgpr_write_b32 a4, 0
    v_accvgpr_write_b32 a5, 0
    v_accvgpr_write_b32 a6, 0
    v_accvgpr_write_b32 a7, 0
    v_accvgpr_write_b32 a8, 0
    v_accvgpr_write_b32 a9, 0
    v_accvgpr_write_b32 a10, 0
    v_accvgpr_write_b32 a11, 0
    v_accvgpr_write_b32 a12, 0
    v_accvgpr_write_b32 a13, 0
    v_accvgpr_write_b32 a14, 0
    v_accvgpr_write_b32 a15, 0
    v_accvgpr_write_b32 a16, 0
    v_accvgpr_write_b32 a17, 0
    v_accvgpr_write_b32 a18, 0
    v_accvgpr_write_b32 a19, 0
    v_accvgpr_write_b32 a20, 0
    v_accvgpr_write_b32 a21, 0
    v_accvgpr_write_b32 a22, 0
    v_accvgpr_write_b32 a23, 0
    v_accvgpr_write_b32 a24, 0
    v_accvgpr_write_b32 a25, 0
    v_accvgpr_write_b32 a26, 0
    v_accvgpr_write_b32 a27, 0
    v_accvgpr_write_b32 a28, 0
    v_accvgpr_write_b32 a29, 0
    v_accvgpr_write_b32 a30, 0
    v_accvgpr_write_b32 a31, 0
    v_accvgpr_write_b32 a32, 0
    v_accvgpr_write_b32 a33, 0
    v_accvgpr_write_b32 a34, 0
    v_accvgpr_write_b32 a35, 0
    v_accvgpr_write_b32 a36, 0
    v_accvgpr_write_b32 a37, 0
    v_accvgpr_write_b32 a38, 0
    v_accvgpr_write_b32 a39, 0
    v_accvgpr_write_b32 a40, 0
    v_accvgpr_write_b32 a41, 0
    v_accvgpr_write_b32 a42, 0
    v_accvgpr_write_b32 a43, 0
    v_accvgpr_write_b32 a44, 0
    v_accvgpr_write_b32 a45, 0
    v_accvgpr_write_b32 a46, 0
    v_accvgpr_write_b32 a47, 0
    v_accvgpr_write_b32 a48, 0
    v_accvgpr_write_b32 a49, 0
    v_accvgpr_write_b32 a50, 0
    v_accvgpr_write_b32 a51, 0
    v_accvgpr_write_b32 a52, 0
    v_accvgpr_write_b32 a53, 0
    v_accvgpr_write_b32 a54, 0
    v_accvgpr_write_b32 a55, 0
    v_accvgpr_write_b32 a56, 0
    v_accvgpr_write_b32 a57, 0
    v_accvgpr_write_b32 a58, 0
    v_accvgpr_write_b32 a59, 0
    v_accvgpr_write_b32 a60, 0
    v_accvgpr_write_b32 a61, 0
    v_accvgpr_write_b32 a62, 0
    v_accvgpr_write_b32 a63, 0
    v_accvgpr_write_b32 a64, 0
    v_accvgpr_write_b32 a65, 0
    v_accvgpr_write_b32 a66, 0
    v_accvgpr_write_b32 a67, 0
    v_accvgpr_write_b32 a68, 0
    v_accvgpr_write_b32 a69, 0
    v_accvgpr_write_b32 a70, 0
    v_accvgpr_write_b32 a71, 0
    v_accvgpr_write_b32 a72, 0
    v_accvgpr_write_b32 a73, 0
    v_accvgpr_write_b32 a74, 0
    v_accvgpr_write_b32 a75, 0
    v_accvgpr_write_b32 a76, 0
    v_accvgpr_write_b32 a77, 0
    v_accvgpr_write_b32 a78, 0
    v_accvgpr_write_b32 a79, 0
    v_accvgpr_write_b32 a80, 0
    v_accvgpr_write_b32 a81, 0
    v_accvgpr_write_b32 a82, 0
    v_accvgpr_write_b32 a83, 0
    v_accvgpr_write_b32 a84, 0
    v_accvgpr_write_b32 a85, 0
    v_accvgpr_write_b32 a86, 0
    v_accvgpr_write_b32 a87, 0
    v_accvgpr_write_b32 a88, 0
    v_accvgpr_write_b32 a89, 0
    v_accvgpr_write_b32 a90, 0
    v_accvgpr_write_b32 a91, 0
    v_accvgpr_write_b32 a92, 0
    v_accvgpr_write_b32 a93, 0
    v_accvgpr_write_b32 a94, 0
    v_accvgpr_write_b32 a95, 0
    v_accvgpr_write_b32 a96, 0
    v_accvgpr_write_b32 a97, 0
    v_accvgpr_write_b32 a98, 0
    v_accvgpr_write_b32 a99, 0
    v_accvgpr_write_b32 a100, 0
    v_accvgpr_write_b32 a101, 0
    v_accvgpr_write_b32 a102, 0
    v_accvgpr_write_b32 a103, 0
    v_accvgpr_write_b32 a104, 0
    v_accvgpr_write_b32 a105, 0
    v_accvgpr_write_b32 a106, 0
    v_accvgpr_write_b32 a107, 0
    v_accvgpr_write_b32 a108, 0
    v_accvgpr_write_b32 a109, 0
    v_accvgpr_write_b32 a110, 0
    v_accvgpr_write_b32 a111, 0
    v_accvgpr_write_b32 a112, 0
    v_accvgpr_write_b32 a113, 0
    v_accvgpr_write_b32 a114, 0
    v_accvgpr_write_b32 a115, 0
    v_accvgpr_write_b32 a116, 0
    v_accvgpr_write_b32 a117, 0
    v_accvgpr_write_b32 a118, 0
    v_accvgpr_write_b32 a119, 0
    v_accvgpr_write_b32 a120, 0
    v_accvgpr_write_b32 a121, 0
    v_accvgpr_write_b32 a122, 0
    v_accvgpr_write_b32 a123, 0
    v_accvgpr_write_b32 a124, 0
    v_accvgpr_write_b32 a125, 0
    v_accvgpr_write_b32 a126, 0
    v_accvgpr_write_b32 a127, 0
    v_accvgpr_write_b32 a128, 0
    v_accvgpr_write_b32 a129, 0
    v_accvgpr_write_b32 a130, 0
    v_accvgpr_write_b32 a131, 0
    v_accvgpr_write_b32 a132, 0
    v_accvgpr_write_b32 a133, 0
    v_accvgpr_write_b32 a134, 0
    v_accvgpr_write_b32 a135, 0
    v_accvgpr_write_b32 a136, 0
    v_accvgpr_write_b32 a137, 0
    v_accvgpr_write_b32 a138, 0
    v_accvgpr_write_b32 a139, 0
    v_accvgpr_write_b32 a140, 0
    v_accvgpr_write_b32 a141, 0
    v_accvgpr_write_b32 a142, 0
    v_accvgpr_write_b32 a143, 0
    v_accvgpr_write_b32 a144, 0
    v_accvgpr_write_b32 a145, 0
    v_accvgpr_write_b32 a146, 0
    v_accvgpr_write_b32 a147, 0
    v_accvgpr_write_b32 a148, 0
    v_accvgpr_write_b32 a149, 0
    v_accvgpr_write_b32 a150, 0
    v_accvgpr_write_b32 a151, 0
    v_accvgpr_write_b32 a152, 0
    v_accvgpr_write_b32 a153, 0
    v_accvgpr_write_b32 a154, 0
    v_accvgpr_write_b32 a155, 0
    v_accvgpr_write_b32 a156, 0
    v_accvgpr_write_b32 a157, 0
    v_accvgpr_write_b32 a158, 0
    v_accvgpr_write_b32 a159, 0
    v_accvgpr_write_b32 a160, 0
    v_accvgpr_write_b32 a161, 0
    v_accvgpr_write_b32 a162, 0
    v_accvgpr_write_b32 a163, 0
    v_accvgpr_write_b32 a164, 0
    v_accvgpr_write_b32 a165, 0
    v_accvgpr_write_b32 a166, 0
    v_accvgpr_write_b32 a167, 0
    v_accvgpr_write_b32 a168, 0
    v_accvgpr_write_b32 a169, 0
    v_accvgpr_write_b32 a170, 0
    v_accvgpr_write_b32 a171, 0
    v_accvgpr_write_b32 a172, 0
    v_accvgpr_write_b32 a173, 0
    v_accvgpr_write_b32 a174, 0
    v_accvgpr_write_b32 a175, 0
    v_accvgpr_write_b32 a176, 0
    v_accvgpr_write_b32 a177, 0
    v_accvgpr_write_b32 a178, 0
    v_accvgpr_write_b32 a179, 0
    v_accvgpr_write_b32 a180, 0
    v_accvgpr_write_b32 a181, 0
    v_accvgpr_write_b32 a182, 0
    v_accvgpr_write_b32 a183, 0
    v_accvgpr_write_b32 a184, 0
    v_accvgpr_write_b32 a185, 0
    v_accvgpr_write_b32 a186, 0
    v_accvgpr_write_b32 a187, 0
    v_accvgpr_write_b32 a188, 0
    v_accvgpr_write_b32 a189, 0
    v_accvgpr_write_b32 a190, 0
    v_accvgpr_write_b32 a191, 0
    v_mov_b32 v88, 0
    v_mov_b32 v89, 0
    v_mov_b32 v90, 0
    v_mov_b32 v91, 0
    v_mov_b32 v92, 0
    v_mov_b32 v93, 0
    s_mov_b32 s58, 0
L_concat_heads__mha_block_cached__gqa_block_cached__near_ridge_kernel_slow0_p2:
    buffer_load_dwordx2 v[112:113], v86, s[24:27], s58 offen offset:0
    buffer_load_dwordx2 v[114:115], v86, s[24:27], s58 offen offset:32
    buffer_load_dwordx2 v[116:117], v86, s[24:27], s58 offen offset:64
    buffer_load_dwordx2 v[118:119], v86, s[24:27], s58 offen offset:96
    buffer_load_dwordx2 v[120:121], v86, s[24:27], s58 offen offset:128
    buffer_load_dwordx2 v[122:123], v86, s[24:27], s58 offen offset:160
    buffer_load_dwordx2 v[124:125], v86, s[24:27], s58 offen offset:192
    buffer_load_dwordx2 v[126:127], v86, s[24:27], s58 offen offset:224
    buffer_load_dwordx2 v[144:145], v87, s[24:27], s58 offen offset:0
    buffer_load_dwordx2 v[146:147], v87, s[24:27], s58 offen offset:32
    buffer_load_dwordx2 v[148:149], v87, s[24:27], s58 offen offset:64
    buffer_load_dwordx2 v[150:151], v87, s[24:27], s58 offen offset:96
    buffer_load_dwordx2 v[152:153], v87, s[24:27], s58 offen offset:128
    buffer_load_dwordx2 v[154:155], v87, s[24:27], s58 offen offset:160
    buffer_load_dwordx2 v[156:157], v87, s[24:27], s58 offen offset:192
    buffer_load_dwordx2 v[158:159], v87, s[24:27], s58 offen offset:224
    buffer_load_ushort v240, v94, s[28:31], s58 offen offset:0
    buffer_load_ushort v241, v94, s[28:31], s58 offen offset:256
    buffer_load_ushort v242, v94, s[28:31], s58 offen offset:512
    buffer_load_ushort v243, v94, s[28:31], s58 offen offset:768
    buffer_load_ushort v244, v95, s[28:31], s58 offen offset:0
    buffer_load_ushort v245, v95, s[28:31], s58 offen offset:256
    buffer_load_ushort v246, v95, s[28:31], s58 offen offset:512
    buffer_load_ushort v247, v95, s[28:31], s58 offen offset:768
    buffer_load_ushort v248, v94, s[28:31], s58 offen offset:32
    buffer_load_ushort v249, v94, s[28:31], s58 offen offset:288
    buffer_load_ushort v250, v94, s[28:31], s58 offen offset:544
    buffer_load_ushort v251, v94, s[28:31], s58 offen offset:800
    buffer_load_ushort v252, v95, s[28:31], s58 offen offset:32
    buffer_load_ushort v253, v95, s[28:31], s58 offen offset:288
    buffer_load_ushort v254, v95, s[28:31], s58 offen offset:544
    buffer_load_ushort v255, v95, s[28:31], s58 offen offset:800
    s_waitcnt vmcnt(0)
    v_lshl_or_b32 v176, v241, 16, v240
    v_lshl_or_b32 v177, v243, 16, v242
    v_lshl_or_b32 v178, v245, 16, v244
    v_lshl_or_b32 v179, v247, 16, v246
    v_lshl_or_b32 v180, v249, 16, v248
    v_lshl_or_b32 v181, v251, 16, v250
    v_lshl_or_b32 v182, v253, 16, v252
    v_lshl_or_b32 v183, v255, 16, v254
    buffer_load_ushort v240, v94, s[28:31], s58 offen offset:64
    buffer_load_ushort v241, v94, s[28:31], s58 offen offset:320
    buffer_load_ushort v242, v94, s[28:31], s58 offen offset:576
    buffer_load_ushort v243, v94, s[28:31], s58 offen offset:832
    buffer_load_ushort v244, v95, s[28:31], s58 offen offset:64
    buffer_load_ushort v245, v95, s[28:31], s58 offen offset:320
    buffer_load_ushort v246, v95, s[28:31], s58 offen offset:576
    buffer_load_ushort v247, v95, s[28:31], s58 offen offset:832
    buffer_load_ushort v248, v94, s[28:31], s58 offen offset:96
    buffer_load_ushort v249, v94, s[28:31], s58 offen offset:352
    buffer_load_ushort v250, v94, s[28:31], s58 offen offset:608
    buffer_load_ushort v251, v94, s[28:31], s58 offen offset:864
    buffer_load_ushort v252, v95, s[28:31], s58 offen offset:96
    buffer_load_ushort v253, v95, s[28:31], s58 offen offset:352
    buffer_load_ushort v254, v95, s[28:31], s58 offen offset:608
    buffer_load_ushort v255, v95, s[28:31], s58 offen offset:864
    s_waitcnt vmcnt(0)
    v_lshl_or_b32 v184, v241, 16, v240
    v_lshl_or_b32 v185, v243, 16, v242
    v_lshl_or_b32 v186, v245, 16, v244
    v_lshl_or_b32 v187, v247, 16, v246
    v_lshl_or_b32 v188, v249, 16, v248
    v_lshl_or_b32 v189, v251, 16, v250
    v_lshl_or_b32 v190, v253, 16, v252
    v_lshl_or_b32 v191, v255, 16, v254
    buffer_load_ushort v240, v94, s[28:31], s58 offen offset:128
    buffer_load_ushort v241, v94, s[28:31], s58 offen offset:384
    buffer_load_ushort v242, v94, s[28:31], s58 offen offset:640
    buffer_load_ushort v243, v94, s[28:31], s58 offen offset:896
    buffer_load_ushort v244, v95, s[28:31], s58 offen offset:128
    buffer_load_ushort v245, v95, s[28:31], s58 offen offset:384
    buffer_load_ushort v246, v95, s[28:31], s58 offen offset:640
    buffer_load_ushort v247, v95, s[28:31], s58 offen offset:896
    buffer_load_ushort v248, v94, s[28:31], s58 offen offset:160
    buffer_load_ushort v249, v94, s[28:31], s58 offen offset:416
    buffer_load_ushort v250, v94, s[28:31], s58 offen offset:672
    buffer_load_ushort v251, v94, s[28:31], s58 offen offset:928
    buffer_load_ushort v252, v95, s[28:31], s58 offen offset:160
    buffer_load_ushort v253, v95, s[28:31], s58 offen offset:416
    buffer_load_ushort v254, v95, s[28:31], s58 offen offset:672
    buffer_load_ushort v255, v95, s[28:31], s58 offen offset:928
    s_waitcnt vmcnt(0)
    v_lshl_or_b32 v208, v241, 16, v240
    v_lshl_or_b32 v209, v243, 16, v242
    v_lshl_or_b32 v210, v245, 16, v244
    v_lshl_or_b32 v211, v247, 16, v246
    v_lshl_or_b32 v212, v249, 16, v248
    v_lshl_or_b32 v213, v251, 16, v250
    v_lshl_or_b32 v214, v253, 16, v252
    v_lshl_or_b32 v215, v255, 16, v254
    buffer_load_ushort v240, v94, s[28:31], s58 offen offset:192
    buffer_load_ushort v241, v94, s[28:31], s58 offen offset:448
    buffer_load_ushort v242, v94, s[28:31], s58 offen offset:704
    buffer_load_ushort v243, v94, s[28:31], s58 offen offset:960
    buffer_load_ushort v244, v95, s[28:31], s58 offen offset:192
    buffer_load_ushort v245, v95, s[28:31], s58 offen offset:448
    buffer_load_ushort v246, v95, s[28:31], s58 offen offset:704
    buffer_load_ushort v247, v95, s[28:31], s58 offen offset:960
    buffer_load_ushort v248, v94, s[28:31], s58 offen offset:224
    buffer_load_ushort v249, v94, s[28:31], s58 offen offset:480
    buffer_load_ushort v250, v94, s[28:31], s58 offen offset:736
    buffer_load_ushort v251, v94, s[28:31], s58 offen offset:992
    buffer_load_ushort v252, v95, s[28:31], s58 offen offset:224
    buffer_load_ushort v253, v95, s[28:31], s58 offen offset:480
    buffer_load_ushort v254, v95, s[28:31], s58 offen offset:736
    buffer_load_ushort v255, v95, s[28:31], s58 offen offset:992
    s_waitcnt vmcnt(0)
    v_lshl_or_b32 v216, v241, 16, v240
    v_lshl_or_b32 v217, v243, 16, v242
    v_lshl_or_b32 v218, v245, 16, v244
    v_lshl_or_b32 v219, v247, 16, v246
    v_lshl_or_b32 v220, v249, 16, v248
    v_lshl_or_b32 v221, v251, 16, v250
    v_lshl_or_b32 v222, v253, 16, v252
    v_lshl_or_b32 v223, v255, 16, v254
    s_nop 7
    v_mfma_f32_16x16x32_bf16 v[240:243], v[112:115], v[64:67], 0
    v_mfma_f32_16x16x32_bf16 v[240:243], v[116:119], v[68:71], v[240:243]
    v_mfma_f32_16x16x32_bf16 v[240:243], v[120:123], v[72:75], v[240:243]
    v_mfma_f32_16x16x32_bf16 v[240:243], v[124:127], v[76:79], v[240:243]
    v_mfma_f32_16x16x32_bf16 v[244:247], v[144:147], v[64:67], 0
    v_mfma_f32_16x16x32_bf16 v[244:247], v[148:151], v[68:71], v[244:247]
    v_mfma_f32_16x16x32_bf16 v[244:247], v[152:155], v[72:75], v[244:247]
    v_mfma_f32_16x16x32_bf16 v[244:247], v[156:159], v[76:79], v[244:247]
    s_nop 15
    s_nop 15
    v_sub_f32 v240, v240, v80
    v_sub_f32 v241, v241, v80
    v_sub_f32 v242, v242, v80
    v_sub_f32 v243, v243, v80
    v_sub_f32 v244, v244, v80
    v_sub_f32 v245, v245, v80
    v_sub_f32 v246, v246, v80
    v_sub_f32 v247, v247, v80
    v_exp_f32 v240, v240
    v_exp_f32 v241, v241
    v_exp_f32 v242, v242
    v_exp_f32 v243, v243
    v_exp_f32 v244, v244
    v_exp_f32 v245, v245
    v_exp_f32 v246, v246
    v_exp_f32 v247, v247
    s_nop 1
    v_add_f32 v88, v88, v240
    v_add_f32 v88, v88, v241
    v_add_f32 v88, v88, v242
    v_add_f32 v88, v88, v243
    v_add_f32 v88, v88, v244
    v_add_f32 v88, v88, v245
    v_add_f32 v88, v88, v246
    v_add_f32 v88, v88, v247
    v_cvt_pk_bf16_f32 v240, v240, v241
    v_cvt_pk_bf16_f32 v241, v242, v243
    v_cvt_pk_bf16_f32 v242, v244, v245
    v_cvt_pk_bf16_f32 v243, v246, v247
    s_nop 3
    v_mfma_f32_16x16x32_bf16 a[0:3], v[176:179], v[240:243], a[0:3]
    v_mfma_f32_16x16x32_bf16 a[4:7], v[180:183], v[240:243], a[4:7]
    v_mfma_f32_16x16x32_bf16 a[8:11], v[184:187], v[240:243], a[8:11]
    v_mfma_f32_16x16x32_bf16 a[12:15], v[188:191], v[240:243], a[12:15]
    v_mfma_f32_16x16x32_bf16 a[16:19], v[208:211], v[240:243], a[16:19]
    v_mfma_f32_16x16x32_bf16 a[20:23], v[212:215], v[240:243], a[20:23]
    v_mfma_f32_16x16x32_bf16 a[24:27], v[216:219], v[240:243], a[24:27]
    v_mfma_f32_16x16x32_bf16 a[28:31], v[220:223], v[240:243], a[28:31]
    s_nop 15
    s_nop 15
    v_mfma_f32_16x16x32_bf16 v[240:243], v[112:115], v[96:99], 0
    v_mfma_f32_16x16x32_bf16 v[240:243], v[116:119], v[100:103], v[240:243]
    v_mfma_f32_16x16x32_bf16 v[240:243], v[120:123], v[104:107], v[240:243]
    v_mfma_f32_16x16x32_bf16 v[240:243], v[124:127], v[108:111], v[240:243]
    v_mfma_f32_16x16x32_bf16 v[244:247], v[144:147], v[96:99], 0
    v_mfma_f32_16x16x32_bf16 v[244:247], v[148:151], v[100:103], v[244:247]
    v_mfma_f32_16x16x32_bf16 v[244:247], v[152:155], v[104:107], v[244:247]
    v_mfma_f32_16x16x32_bf16 v[244:247], v[156:159], v[108:111], v[244:247]
    s_nop 15
    s_nop 15
    v_sub_f32 v240, v240, v81
    v_sub_f32 v241, v241, v81
    v_sub_f32 v242, v242, v81
    v_sub_f32 v243, v243, v81
    v_sub_f32 v244, v244, v81
    v_sub_f32 v245, v245, v81
    v_sub_f32 v246, v246, v81
    v_sub_f32 v247, v247, v81
    v_exp_f32 v240, v240
    v_exp_f32 v241, v241
    v_exp_f32 v242, v242
    v_exp_f32 v243, v243
    v_exp_f32 v244, v244
    v_exp_f32 v245, v245
    v_exp_f32 v246, v246
    v_exp_f32 v247, v247
    s_nop 1
    v_add_f32 v89, v89, v240
    v_add_f32 v89, v89, v241
    v_add_f32 v89, v89, v242
    v_add_f32 v89, v89, v243
    v_add_f32 v89, v89, v244
    v_add_f32 v89, v89, v245
    v_add_f32 v89, v89, v246
    v_add_f32 v89, v89, v247
    v_cvt_pk_bf16_f32 v240, v240, v241
    v_cvt_pk_bf16_f32 v241, v242, v243
    v_cvt_pk_bf16_f32 v242, v244, v245
    v_cvt_pk_bf16_f32 v243, v246, v247
    s_nop 3
    v_mfma_f32_16x16x32_bf16 a[32:35], v[176:179], v[240:243], a[32:35]
    v_mfma_f32_16x16x32_bf16 a[36:39], v[180:183], v[240:243], a[36:39]
    v_mfma_f32_16x16x32_bf16 a[40:43], v[184:187], v[240:243], a[40:43]
    v_mfma_f32_16x16x32_bf16 a[44:47], v[188:191], v[240:243], a[44:47]
    v_mfma_f32_16x16x32_bf16 a[48:51], v[208:211], v[240:243], a[48:51]
    v_mfma_f32_16x16x32_bf16 a[52:55], v[212:215], v[240:243], a[52:55]
    v_mfma_f32_16x16x32_bf16 a[56:59], v[216:219], v[240:243], a[56:59]
    v_mfma_f32_16x16x32_bf16 a[60:63], v[220:223], v[240:243], a[60:63]
    s_nop 15
    s_nop 15
    v_mfma_f32_16x16x32_bf16 v[240:243], v[112:115], v[128:131], 0
    v_mfma_f32_16x16x32_bf16 v[240:243], v[116:119], v[132:135], v[240:243]
    v_mfma_f32_16x16x32_bf16 v[240:243], v[120:123], v[136:139], v[240:243]
    v_mfma_f32_16x16x32_bf16 v[240:243], v[124:127], v[140:143], v[240:243]
    v_mfma_f32_16x16x32_bf16 v[244:247], v[144:147], v[128:131], 0
    v_mfma_f32_16x16x32_bf16 v[244:247], v[148:151], v[132:135], v[244:247]
    v_mfma_f32_16x16x32_bf16 v[244:247], v[152:155], v[136:139], v[244:247]
    v_mfma_f32_16x16x32_bf16 v[244:247], v[156:159], v[140:143], v[244:247]
    s_nop 15
    s_nop 15
    v_sub_f32 v240, v240, v82
    v_sub_f32 v241, v241, v82
    v_sub_f32 v242, v242, v82
    v_sub_f32 v243, v243, v82
    v_sub_f32 v244, v244, v82
    v_sub_f32 v245, v245, v82
    v_sub_f32 v246, v246, v82
    v_sub_f32 v247, v247, v82
    v_exp_f32 v240, v240
    v_exp_f32 v241, v241
    v_exp_f32 v242, v242
    v_exp_f32 v243, v243
    v_exp_f32 v244, v244
    v_exp_f32 v245, v245
    v_exp_f32 v246, v246
    v_exp_f32 v247, v247
    s_nop 1
    v_add_f32 v90, v90, v240
    v_add_f32 v90, v90, v241
    v_add_f32 v90, v90, v242
    v_add_f32 v90, v90, v243
    v_add_f32 v90, v90, v244
    v_add_f32 v90, v90, v245
    v_add_f32 v90, v90, v246
    v_add_f32 v90, v90, v247
    v_cvt_pk_bf16_f32 v240, v240, v241
    v_cvt_pk_bf16_f32 v241, v242, v243
    v_cvt_pk_bf16_f32 v242, v244, v245
    v_cvt_pk_bf16_f32 v243, v246, v247
    s_nop 3
    v_mfma_f32_16x16x32_bf16 a[64:67], v[176:179], v[240:243], a[64:67]
    v_mfma_f32_16x16x32_bf16 a[68:71], v[180:183], v[240:243], a[68:71]
    v_mfma_f32_16x16x32_bf16 a[72:75], v[184:187], v[240:243], a[72:75]
    v_mfma_f32_16x16x32_bf16 a[76:79], v[188:191], v[240:243], a[76:79]
    v_mfma_f32_16x16x32_bf16 a[80:83], v[208:211], v[240:243], a[80:83]
    v_mfma_f32_16x16x32_bf16 a[84:87], v[212:215], v[240:243], a[84:87]
    v_mfma_f32_16x16x32_bf16 a[88:91], v[216:219], v[240:243], a[88:91]
    v_mfma_f32_16x16x32_bf16 a[92:95], v[220:223], v[240:243], a[92:95]
    s_nop 15
    s_nop 15
    v_mfma_f32_16x16x32_bf16 v[240:243], v[112:115], v[160:163], 0
    v_mfma_f32_16x16x32_bf16 v[240:243], v[116:119], v[164:167], v[240:243]
    v_mfma_f32_16x16x32_bf16 v[240:243], v[120:123], v[168:171], v[240:243]
    v_mfma_f32_16x16x32_bf16 v[240:243], v[124:127], v[172:175], v[240:243]
    v_mfma_f32_16x16x32_bf16 v[244:247], v[144:147], v[160:163], 0
    v_mfma_f32_16x16x32_bf16 v[244:247], v[148:151], v[164:167], v[244:247]
    v_mfma_f32_16x16x32_bf16 v[244:247], v[152:155], v[168:171], v[244:247]
    v_mfma_f32_16x16x32_bf16 v[244:247], v[156:159], v[172:175], v[244:247]
    s_nop 15
    s_nop 15
    v_sub_f32 v240, v240, v83
    v_sub_f32 v241, v241, v83
    v_sub_f32 v242, v242, v83
    v_sub_f32 v243, v243, v83
    v_sub_f32 v244, v244, v83
    v_sub_f32 v245, v245, v83
    v_sub_f32 v246, v246, v83
    v_sub_f32 v247, v247, v83
    v_exp_f32 v240, v240
    v_exp_f32 v241, v241
    v_exp_f32 v242, v242
    v_exp_f32 v243, v243
    v_exp_f32 v244, v244
    v_exp_f32 v245, v245
    v_exp_f32 v246, v246
    v_exp_f32 v247, v247
    s_nop 1
    v_add_f32 v91, v91, v240
    v_add_f32 v91, v91, v241
    v_add_f32 v91, v91, v242
    v_add_f32 v91, v91, v243
    v_add_f32 v91, v91, v244
    v_add_f32 v91, v91, v245
    v_add_f32 v91, v91, v246
    v_add_f32 v91, v91, v247
    v_cvt_pk_bf16_f32 v240, v240, v241
    v_cvt_pk_bf16_f32 v241, v242, v243
    v_cvt_pk_bf16_f32 v242, v244, v245
    v_cvt_pk_bf16_f32 v243, v246, v247
    s_nop 3
    v_mfma_f32_16x16x32_bf16 a[96:99], v[176:179], v[240:243], a[96:99]
    v_mfma_f32_16x16x32_bf16 a[100:103], v[180:183], v[240:243], a[100:103]
    v_mfma_f32_16x16x32_bf16 a[104:107], v[184:187], v[240:243], a[104:107]
    v_mfma_f32_16x16x32_bf16 a[108:111], v[188:191], v[240:243], a[108:111]
    v_mfma_f32_16x16x32_bf16 a[112:115], v[208:211], v[240:243], a[112:115]
    v_mfma_f32_16x16x32_bf16 a[116:119], v[212:215], v[240:243], a[116:119]
    v_mfma_f32_16x16x32_bf16 a[120:123], v[216:219], v[240:243], a[120:123]
    v_mfma_f32_16x16x32_bf16 a[124:127], v[220:223], v[240:243], a[124:127]
    s_nop 15
    s_nop 15
    v_mfma_f32_16x16x32_bf16 v[240:243], v[112:115], v[192:195], 0
    v_mfma_f32_16x16x32_bf16 v[240:243], v[116:119], v[196:199], v[240:243]
    v_mfma_f32_16x16x32_bf16 v[240:243], v[120:123], v[200:203], v[240:243]
    v_mfma_f32_16x16x32_bf16 v[240:243], v[124:127], v[204:207], v[240:243]
    v_mfma_f32_16x16x32_bf16 v[244:247], v[144:147], v[192:195], 0
    v_mfma_f32_16x16x32_bf16 v[244:247], v[148:151], v[196:199], v[244:247]
    v_mfma_f32_16x16x32_bf16 v[244:247], v[152:155], v[200:203], v[244:247]
    v_mfma_f32_16x16x32_bf16 v[244:247], v[156:159], v[204:207], v[244:247]
    s_nop 15
    s_nop 15
    v_sub_f32 v240, v240, v84
    v_sub_f32 v241, v241, v84
    v_sub_f32 v242, v242, v84
    v_sub_f32 v243, v243, v84
    v_sub_f32 v244, v244, v84
    v_sub_f32 v245, v245, v84
    v_sub_f32 v246, v246, v84
    v_sub_f32 v247, v247, v84
    v_exp_f32 v240, v240
    v_exp_f32 v241, v241
    v_exp_f32 v242, v242
    v_exp_f32 v243, v243
    v_exp_f32 v244, v244
    v_exp_f32 v245, v245
    v_exp_f32 v246, v246
    v_exp_f32 v247, v247
    s_nop 1
    v_add_f32 v92, v92, v240
    v_add_f32 v92, v92, v241
    v_add_f32 v92, v92, v242
    v_add_f32 v92, v92, v243
    v_add_f32 v92, v92, v244
    v_add_f32 v92, v92, v245
    v_add_f32 v92, v92, v246
    v_add_f32 v92, v92, v247
    v_cvt_pk_bf16_f32 v240, v240, v241
    v_cvt_pk_bf16_f32 v241, v242, v243
    v_cvt_pk_bf16_f32 v242, v244, v245
    v_cvt_pk_bf16_f32 v243, v246, v247
    s_nop 3
    v_mfma_f32_16x16x32_bf16 a[128:131], v[176:179], v[240:243], a[128:131]
    v_mfma_f32_16x16x32_bf16 a[132:135], v[180:183], v[240:243], a[132:135]
    v_mfma_f32_16x16x32_bf16 a[136:139], v[184:187], v[240:243], a[136:139]
    v_mfma_f32_16x16x32_bf16 a[140:143], v[188:191], v[240:243], a[140:143]
    v_mfma_f32_16x16x32_bf16 a[144:147], v[208:211], v[240:243], a[144:147]
    v_mfma_f32_16x16x32_bf16 a[148:151], v[212:215], v[240:243], a[148:151]
    v_mfma_f32_16x16x32_bf16 a[152:155], v[216:219], v[240:243], a[152:155]
    v_mfma_f32_16x16x32_bf16 a[156:159], v[220:223], v[240:243], a[156:159]
    s_nop 15
    s_nop 15
    v_mfma_f32_16x16x32_bf16 v[240:243], v[112:115], v[224:227], 0
    v_mfma_f32_16x16x32_bf16 v[240:243], v[116:119], v[228:231], v[240:243]
    v_mfma_f32_16x16x32_bf16 v[240:243], v[120:123], v[232:235], v[240:243]
    v_mfma_f32_16x16x32_bf16 v[240:243], v[124:127], v[236:239], v[240:243]
    v_mfma_f32_16x16x32_bf16 v[244:247], v[144:147], v[224:227], 0
    v_mfma_f32_16x16x32_bf16 v[244:247], v[148:151], v[228:231], v[244:247]
    v_mfma_f32_16x16x32_bf16 v[244:247], v[152:155], v[232:235], v[244:247]
    v_mfma_f32_16x16x32_bf16 v[244:247], v[156:159], v[236:239], v[244:247]
    s_nop 15
    s_nop 15
    v_sub_f32 v240, v240, v85
    v_sub_f32 v241, v241, v85
    v_sub_f32 v242, v242, v85
    v_sub_f32 v243, v243, v85
    v_sub_f32 v244, v244, v85
    v_sub_f32 v245, v245, v85
    v_sub_f32 v246, v246, v85
    v_sub_f32 v247, v247, v85
    v_exp_f32 v240, v240
    v_exp_f32 v241, v241
    v_exp_f32 v242, v242
    v_exp_f32 v243, v243
    v_exp_f32 v244, v244
    v_exp_f32 v245, v245
    v_exp_f32 v246, v246
    v_exp_f32 v247, v247
    s_nop 1
    v_add_f32 v93, v93, v240
    v_add_f32 v93, v93, v241
    v_add_f32 v93, v93, v242
    v_add_f32 v93, v93, v243
    v_add_f32 v93, v93, v244
    v_add_f32 v93, v93, v245
    v_add_f32 v93, v93, v246
    v_add_f32 v93, v93, v247
    v_cvt_pk_bf16_f32 v240, v240, v241
    v_cvt_pk_bf16_f32 v241, v242, v243
    v_cvt_pk_bf16_f32 v242, v244, v245
    v_cvt_pk_bf16_f32 v243, v246, v247
    s_nop 3
    v_mfma_f32_16x16x32_bf16 a[160:163], v[176:179], v[240:243], a[160:163]
    v_mfma_f32_16x16x32_bf16 a[164:167], v[180:183], v[240:243], a[164:167]
    v_mfma_f32_16x16x32_bf16 a[168:171], v[184:187], v[240:243], a[168:171]
    v_mfma_f32_16x16x32_bf16 a[172:175], v[188:191], v[240:243], a[172:175]
    v_mfma_f32_16x16x32_bf16 a[176:179], v[208:211], v[240:243], a[176:179]
    v_mfma_f32_16x16x32_bf16 a[180:183], v[212:215], v[240:243], a[180:183]
    v_mfma_f32_16x16x32_bf16 a[184:187], v[216:219], v[240:243], a[184:187]
    v_mfma_f32_16x16x32_bf16 a[188:191], v[220:223], v[240:243], a[188:191]
    s_nop 15
    s_nop 15
    s_add_u32 s58, s58, 0x2000
    s_cmp_lt_u32 s58, 0x20000
    s_cbranch_scc1 L_concat_heads__mha_block_cached__gqa_block_cached__near_ridge_kernel_slow0_p2
    v_mov_b32 v248, v88
    s_nop 1
    v_permlane32_swap_b32 v88, v248
    s_nop 1
    v_add_f32 v88, v88, v248
    v_mov_b32 v248, v88
    s_nop 1
    v_permlane16_swap_b32 v88, v248
    s_nop 1
    v_add_f32 v88, v88, v248
    s_nop 0
    v_rcp_f32 v32, v88
    v_mov_b32 v248, v89
    s_nop 1
    v_permlane32_swap_b32 v89, v248
    s_nop 1
    v_add_f32 v89, v89, v248
    v_mov_b32 v248, v89
    s_nop 1
    v_permlane16_swap_b32 v89, v248
    s_nop 1
    v_add_f32 v89, v89, v248
    s_nop 0
    v_rcp_f32 v33, v89
    v_mov_b32 v248, v90
    s_nop 1
    v_permlane32_swap_b32 v90, v248
    s_nop 1
    v_add_f32 v90, v90, v248
    v_mov_b32 v248, v90
    s_nop 1
    v_permlane16_swap_b32 v90, v248
    s_nop 1
    v_add_f32 v90, v90, v248
    s_nop 0
    v_rcp_f32 v34, v90
    v_mov_b32 v248, v91
    s_nop 1
    v_permlane32_swap_b32 v91, v248
    s_nop 1
    v_add_f32 v91, v91, v248
    v_mov_b32 v248, v91
    s_nop 1
    v_permlane16_swap_b32 v91, v248
    s_nop 1
    v_add_f32 v91, v91, v248
    s_nop 0
    v_rcp_f32 v35, v91
    v_mov_b32 v248, v92
    s_nop 1
    v_permlane32_swap_b32 v92, v248
    s_nop 1
    v_add_f32 v92, v92, v248
    v_mov_b32 v248, v92
    s_nop 1
    v_permlane16_swap_b32 v92, v248
    s_nop 1
    v_add_f32 v92, v92, v248
    s_nop 0
    v_rcp_f32 v36, v92
    v_mov_b32 v248, v93
    s_nop 1
    v_permlane32_swap_b32 v93, v248
    s_nop 1
    v_add_f32 v93, v93, v248
    v_mov_b32 v248, v93
    s_nop 1
    v_permlane16_swap_b32 v93, v248
    s_nop 1
    v_add_f32 v93, v93, v248
    s_nop 0
    v_rcp_f32 v37, v93
    s_nop 15
    s_nop 15
    s_waitcnt vmcnt(0)
    s_nop 7
    s_branch L_concat_heads__mha_block_cached__gqa_block_cached__near_ridge_kernel_back0
L_concat_heads__mha_block_cached__gqa_block_cached__near_ridge_kernel_poll0_spin:
    s_mov_b32 s62, 0x40000
L_concat_heads__mha_block_cached__gqa_block_cached__near_ridge_kernel_poll0_loop:
    s_sleep 4
    buffer_load_dword v183, v182, s[92:95], s65 offen sc1
    s_waitcnt vmcnt(0)
    v_readfirstlane_b32 s63, v183
    s_nop 1
    s_cmp_ge_u32 s63, 8
    s_cbranch_scc1 L_concat_heads__mha_block_cached__gqa_block_cached__near_ridge_kernel_poll0_ok
    s_sub_u32 s62, s62, 1
    s_cmp_lg_u32 s62, 0
    s_cbranch_scc1 L_concat_heads__mha_block_cached__gqa_block_cached__near_ridge_kernel_poll0_loop
    s_branch L_concat_heads__mha_block_cached__gqa_block_cached__near_ridge_kernel_poll0_ok
L_concat_heads__mha_block_cached__gqa_block_cached__near_ridge_kernel_slow1:
    s_waitcnt vmcnt(0) lgkmcnt(0)
    s_nop 15
    s_nop 15
    v_and_b32 v254, 15, v1
    v_lshrrev_b32 v255, 4, v1
    v_lshlrev_b32 v86, 8, v254
    v_lshlrev_b32 v248, 3, v255
    v_add_u32 v86, v86, v248
    v_add_u32 v87, 0x1000, v86
    v_lshlrev_b32 v94, 10, v255
    v_lshlrev_b32 v248, 1, v254
    v_add_u32 v94, v94, v248
    v_add_u32 v95, 0x1000, v94
    v_mov_b32 v80, 0xff800000
    v_mov_b32 v81, 0xff800000
    v_mov_b32 v82, 0xff800000
    v_mov_b32 v83, 0xff800000
    v_mov_b32 v84, 0xff800000
    v_mov_b32 v85, 0xff800000
    s_mov_b32 s58, 0
L_concat_heads__mha_block_cached__gqa_block_cached__near_ridge_kernel_slow1_p1:
    buffer_load_dwordx2 v[112:113], v86, s[36:39], s58 offen offset:0
    buffer_load_dwordx2 v[114:115], v86, s[36:39], s58 offen offset:32
    buffer_load_dwordx2 v[116:117], v86, s[36:39], s58 offen offset:64
    buffer_load_dwordx2 v[118:119], v86, s[36:39], s58 offen offset:96
    buffer_load_dwordx2 v[120:121], v86, s[36:39], s58 offen offset:128
    buffer_load_dwordx2 v[122:123], v86, s[36:39], s58 offen offset:160
    buffer_load_dwordx2 v[124:125], v86, s[36:39], s58 offen offset:192
    buffer_load_dwordx2 v[126:127], v86, s[36:39], s58 offen offset:224
    buffer_load_dwordx2 v[144:145], v87, s[36:39], s58 offen offset:0
    buffer_load_dwordx2 v[146:147], v87, s[36:39], s58 offen offset:32
    buffer_load_dwordx2 v[148:149], v87, s[36:39], s58 offen offset:64
    buffer_load_dwordx2 v[150:151], v87, s[36:39], s58 offen offset:96
    buffer_load_dwordx2 v[152:153], v87, s[36:39], s58 offen offset:128
    buffer_load_dwordx2 v[154:155], v87, s[36:39], s58 offen offset:160
    buffer_load_dwordx2 v[156:157], v87, s[36:39], s58 offen offset:192
    buffer_load_dwordx2 v[158:159], v87, s[36:39], s58 offen offset:224
    s_waitcnt vmcnt(0)
    v_mfma_f32_16x16x32_bf16 v[240:243], v[112:115], v[64:67], 0
    v_mfma_f32_16x16x32_bf16 v[240:243], v[116:119], v[68:71], v[240:243]
    v_mfma_f32_16x16x32_bf16 v[240:243], v[120:123], v[72:75], v[240:243]
    v_mfma_f32_16x16x32_bf16 v[240:243], v[124:127], v[76:79], v[240:243]
    v_mfma_f32_16x16x32_bf16 v[244:247], v[144:147], v[64:67], 0
    v_mfma_f32_16x16x32_bf16 v[244:247], v[148:151], v[68:71], v[244:247]
    v_mfma_f32_16x16x32_bf16 v[244:247], v[152:155], v[72:75], v[244:247]
    v_mfma_f32_16x16x32_bf16 v[244:247], v[156:159], v[76:79], v[244:247]
    s_nop 15
    s_nop 15
    v_max3_f32 v80, v240, v241, v80
    v_max3_f32 v80, v242, v243, v80
    v_max3_f32 v80, v244, v245, v80
    v_max3_f32 v80, v246, v247, v80
    s_nop 7
    v_mfma_f32_16x16x32_bf16 v[240:243], v[112:115], v[96:99], 0
    v_mfma_f32_16x16x32_bf16 v[240:243], v[116:119], v[100:103], v[240:243]
    v_mfma_f32_16x16x32_bf16 v[240:243], v[120:123], v[104:107], v[240:243]
    v_mfma_f32_16x16x32_bf16 v[240:243], v[124:127], v[108:111], v[240:243]
    v_mfma_f32_16x16x32_bf16 v[244:247], v[144:147], v[96:99], 0
    v_mfma_f32_16x16x32_bf16 v[244:247], v[148:151], v[100:103], v[244:247]
    v_mfma_f32_16x16x32_bf16 v[244:247], v[152:155], v[104:107], v[244:247]
    v_mfma_f32_16x16x32_bf16 v[244:247], v[156:159], v[108:111], v[244:247]
    s_nop 15
    s_nop 15
    v_max3_f32 v81, v240, v241, v81
    v_max3_f32 v81, v242, v243, v81
    v_max3_f32 v81, v244, v245, v81
    v_max3_f32 v81, v246, v247, v81
    s_nop 7
    v_mfma_f32_16x16x32_bf16 v[240:243], v[112:115], v[128:131], 0
    v_mfma_f32_16x16x32_bf16 v[240:243], v[116:119], v[132:135], v[240:243]
    v_mfma_f32_16x16x32_bf16 v[240:243], v[120:123], v[136:139], v[240:243]
    v_mfma_f32_16x16x32_bf16 v[240:243], v[124:127], v[140:143], v[240:243]
    v_mfma_f32_16x16x32_bf16 v[244:247], v[144:147], v[128:131], 0
    v_mfma_f32_16x16x32_bf16 v[244:247], v[148:151], v[132:135], v[244:247]
    v_mfma_f32_16x16x32_bf16 v[244:247], v[152:155], v[136:139], v[244:247]
    v_mfma_f32_16x16x32_bf16 v[244:247], v[156:159], v[140:143], v[244:247]
    s_nop 15
    s_nop 15
    v_max3_f32 v82, v240, v241, v82
    v_max3_f32 v82, v242, v243, v82
    v_max3_f32 v82, v244, v245, v82
    v_max3_f32 v82, v246, v247, v82
    s_nop 7
    v_mfma_f32_16x16x32_bf16 v[240:243], v[112:115], v[160:163], 0
    v_mfma_f32_16x16x32_bf16 v[240:243], v[116:119], v[164:167], v[240:243]
    v_mfma_f32_16x16x32_bf16 v[240:243], v[120:123], v[168:171], v[240:243]
    v_mfma_f32_16x16x32_bf16 v[240:243], v[124:127], v[172:175], v[240:243]
    v_mfma_f32_16x16x32_bf16 v[244:247], v[144:147], v[160:163], 0
    v_mfma_f32_16x16x32_bf16 v[244:247], v[148:151], v[164:167], v[244:247]
    v_mfma_f32_16x16x32_bf16 v[244:247], v[152:155], v[168:171], v[244:247]
    v_mfma_f32_16x16x32_bf16 v[244:247], v[156:159], v[172:175], v[244:247]
    s_nop 15
    s_nop 15
    v_max3_f32 v83, v240, v241, v83
    v_max3_f32 v83, v242, v243, v83
    v_max3_f32 v83, v244, v245, v83
    v_max3_f32 v83, v246, v247, v83
    s_nop 7
    v_mfma_f32_16x16x32_bf16 v[240:243], v[112:115], v[192:195], 0
    v_mfma_f32_16x16x32_bf16 v[240:243], v[116:119], v[196:199], v[240:243]
    v_mfma_f32_16x16x32_bf16 v[240:243], v[120:123], v[200:203], v[240:243]
    v_mfma_f32_16x16x32_bf16 v[240:243], v[124:127], v[204:207], v[240:243]
    v_mfma_f32_16x16x32_bf16 v[244:247], v[144:147], v[192:195], 0
    v_mfma_f32_16x16x32_bf16 v[244:247], v[148:151], v[196:199], v[244:247]
    v_mfma_f32_16x16x32_bf16 v[244:247], v[152:155], v[200:203], v[244:247]
    v_mfma_f32_16x16x32_bf16 v[244:247], v[156:159], v[204:207], v[244:247]
    s_nop 15
    s_nop 15
    v_max3_f32 v84, v240, v241, v84
    v_max3_f32 v84, v242, v243, v84
    v_max3_f32 v84, v244, v245, v84
    v_max3_f32 v84, v246, v247, v84
    s_nop 7
    v_mfma_f32_16x16x32_bf16 v[240:243], v[112:115], v[224:227], 0
    v_mfma_f32_16x16x32_bf16 v[240:243], v[116:119], v[228:231], v[240:243]
    v_mfma_f32_16x16x32_bf16 v[240:243], v[120:123], v[232:235], v[240:243]
    v_mfma_f32_16x16x32_bf16 v[240:243], v[124:127], v[236:239], v[240:243]
    v_mfma_f32_16x16x32_bf16 v[244:247], v[144:147], v[224:227], 0
    v_mfma_f32_16x16x32_bf16 v[244:247], v[148:151], v[228:231], v[244:247]
    v_mfma_f32_16x16x32_bf16 v[244:247], v[152:155], v[232:235], v[244:247]
    v_mfma_f32_16x16x32_bf16 v[244:247], v[156:159], v[236:239], v[244:247]
    s_nop 15
    s_nop 15
    v_max3_f32 v85, v240, v241, v85
    v_max3_f32 v85, v242, v243, v85
    v_max3_f32 v85, v244, v245, v85
    v_max3_f32 v85, v246, v247, v85
    s_nop 7
    s_add_u32 s58, s58, 0x2000
    s_cmp_lt_u32 s58, 0x20000
    s_cbranch_scc1 L_concat_heads__mha_block_cached__gqa_block_cached__near_ridge_kernel_slow1_p1
    v_mov_b32 v248, v80
    s_nop 1
    v_permlane32_swap_b32 v80, v248
    s_nop 1
    v_max_f32 v80, v80, v248
    v_mov_b32 v248, v80
    s_nop 1
    v_permlane16_swap_b32 v80, v248
    s_nop 1
    v_max_f32 v80, v80, v248
    v_mov_b32 v248, v81
    s_nop 1
    v_permlane32_swap_b32 v81, v248
    s_nop 1
    v_max_f32 v81, v81, v248
    v_mov_b32 v248, v81
    s_nop 1
    v_permlane16_swap_b32 v81, v248
    s_nop 1
    v_max_f32 v81, v81, v248
    v_mov_b32 v248, v82
    s_nop 1
    v_permlane32_swap_b32 v82, v248
    s_nop 1
    v_max_f32 v82, v82, v248
    v_mov_b32 v248, v82
    s_nop 1
    v_permlane16_swap_b32 v82, v248
    s_nop 1
    v_max_f32 v82, v82, v248
    v_mov_b32 v248, v83
    s_nop 1
    v_permlane32_swap_b32 v83, v248
    s_nop 1
    v_max_f32 v83, v83, v248
    v_mov_b32 v248, v83
    s_nop 1
    v_permlane16_swap_b32 v83, v248
    s_nop 1
    v_max_f32 v83, v83, v248
    v_mov_b32 v248, v84
    s_nop 1
    v_permlane32_swap_b32 v84, v248
    s_nop 1
    v_max_f32 v84, v84, v248
    v_mov_b32 v248, v84
    s_nop 1
    v_permlane16_swap_b32 v84, v248
    s_nop 1
    v_max_f32 v84, v84, v248
    v_mov_b32 v248, v85
    s_nop 1
    v_permlane32_swap_b32 v85, v248
    s_nop 1
    v_max_f32 v85, v85, v248
    v_mov_b32 v248, v85
    s_nop 1
    v_permlane16_swap_b32 v85, v248
    s_nop 1
    v_max_f32 v85, v85, v248
    v_accvgpr_write_b32 a0, 0
    v_accvgpr_write_b32 a1, 0
    v_accvgpr_write_b32 a2, 0
    v_accvgpr_write_b32 a3, 0
    v_accvgpr_write_b32 a4, 0
    v_accvgpr_write_b32 a5, 0
    v_accvgpr_write_b32 a6, 0
    v_accvgpr_write_b32 a7, 0
    v_accvgpr_write_b32 a8, 0
    v_accvgpr_write_b32 a9, 0
    v_accvgpr_write_b32 a10, 0
    v_accvgpr_write_b32 a11, 0
    v_accvgpr_write_b32 a12, 0
    v_accvgpr_write_b32 a13, 0
    v_accvgpr_write_b32 a14, 0
    v_accvgpr_write_b32 a15, 0
    v_accvgpr_write_b32 a16, 0
    v_accvgpr_write_b32 a17, 0
    v_accvgpr_write_b32 a18, 0
    v_accvgpr_write_b32 a19, 0
    v_accvgpr_write_b32 a20, 0
    v_accvgpr_write_b32 a21, 0
    v_accvgpr_write_b32 a22, 0
    v_accvgpr_write_b32 a23, 0
    v_accvgpr_write_b32 a24, 0
    v_accvgpr_write_b32 a25, 0
    v_accvgpr_write_b32 a26, 0
    v_accvgpr_write_b32 a27, 0
    v_accvgpr_write_b32 a28, 0
    v_accvgpr_write_b32 a29, 0
    v_accvgpr_write_b32 a30, 0
    v_accvgpr_write_b32 a31, 0
    v_accvgpr_write_b32 a32, 0
    v_accvgpr_write_b32 a33, 0
    v_accvgpr_write_b32 a34, 0
    v_accvgpr_write_b32 a35, 0
    v_accvgpr_write_b32 a36, 0
    v_accvgpr_write_b32 a37, 0
    v_accvgpr_write_b32 a38, 0
    v_accvgpr_write_b32 a39, 0
    v_accvgpr_write_b32 a40, 0
    v_accvgpr_write_b32 a41, 0
    v_accvgpr_write_b32 a42, 0
    v_accvgpr_write_b32 a43, 0
    v_accvgpr_write_b32 a44, 0
    v_accvgpr_write_b32 a45, 0
    v_accvgpr_write_b32 a46, 0
    v_accvgpr_write_b32 a47, 0
    v_accvgpr_write_b32 a48, 0
    v_accvgpr_write_b32 a49, 0
    v_accvgpr_write_b32 a50, 0
    v_accvgpr_write_b32 a51, 0
    v_accvgpr_write_b32 a52, 0
    v_accvgpr_write_b32 a53, 0
    v_accvgpr_write_b32 a54, 0
    v_accvgpr_write_b32 a55, 0
    v_accvgpr_write_b32 a56, 0
    v_accvgpr_write_b32 a57, 0
    v_accvgpr_write_b32 a58, 0
    v_accvgpr_write_b32 a59, 0
    v_accvgpr_write_b32 a60, 0
    v_accvgpr_write_b32 a61, 0
    v_accvgpr_write_b32 a62, 0
    v_accvgpr_write_b32 a63, 0
    v_accvgpr_write_b32 a64, 0
    v_accvgpr_write_b32 a65, 0
    v_accvgpr_write_b32 a66, 0
    v_accvgpr_write_b32 a67, 0
    v_accvgpr_write_b32 a68, 0
    v_accvgpr_write_b32 a69, 0
    v_accvgpr_write_b32 a70, 0
    v_accvgpr_write_b32 a71, 0
    v_accvgpr_write_b32 a72, 0
    v_accvgpr_write_b32 a73, 0
    v_accvgpr_write_b32 a74, 0
    v_accvgpr_write_b32 a75, 0
    v_accvgpr_write_b32 a76, 0
    v_accvgpr_write_b32 a77, 0
    v_accvgpr_write_b32 a78, 0
    v_accvgpr_write_b32 a79, 0
    v_accvgpr_write_b32 a80, 0
    v_accvgpr_write_b32 a81, 0
    v_accvgpr_write_b32 a82, 0
    v_accvgpr_write_b32 a83, 0
    v_accvgpr_write_b32 a84, 0
    v_accvgpr_write_b32 a85, 0
    v_accvgpr_write_b32 a86, 0
    v_accvgpr_write_b32 a87, 0
    v_accvgpr_write_b32 a88, 0
    v_accvgpr_write_b32 a89, 0
    v_accvgpr_write_b32 a90, 0
    v_accvgpr_write_b32 a91, 0
    v_accvgpr_write_b32 a92, 0
    v_accvgpr_write_b32 a93, 0
    v_accvgpr_write_b32 a94, 0
    v_accvgpr_write_b32 a95, 0
    v_accvgpr_write_b32 a96, 0
    v_accvgpr_write_b32 a97, 0
    v_accvgpr_write_b32 a98, 0
    v_accvgpr_write_b32 a99, 0
    v_accvgpr_write_b32 a100, 0
    v_accvgpr_write_b32 a101, 0
    v_accvgpr_write_b32 a102, 0
    v_accvgpr_write_b32 a103, 0
    v_accvgpr_write_b32 a104, 0
    v_accvgpr_write_b32 a105, 0
    v_accvgpr_write_b32 a106, 0
    v_accvgpr_write_b32 a107, 0
    v_accvgpr_write_b32 a108, 0
    v_accvgpr_write_b32 a109, 0
    v_accvgpr_write_b32 a110, 0
    v_accvgpr_write_b32 a111, 0
    v_accvgpr_write_b32 a112, 0
    v_accvgpr_write_b32 a113, 0
    v_accvgpr_write_b32 a114, 0
    v_accvgpr_write_b32 a115, 0
    v_accvgpr_write_b32 a116, 0
    v_accvgpr_write_b32 a117, 0
    v_accvgpr_write_b32 a118, 0
    v_accvgpr_write_b32 a119, 0
    v_accvgpr_write_b32 a120, 0
    v_accvgpr_write_b32 a121, 0
    v_accvgpr_write_b32 a122, 0
    v_accvgpr_write_b32 a123, 0
    v_accvgpr_write_b32 a124, 0
    v_accvgpr_write_b32 a125, 0
    v_accvgpr_write_b32 a126, 0
    v_accvgpr_write_b32 a127, 0
    v_accvgpr_write_b32 a128, 0
    v_accvgpr_write_b32 a129, 0
    v_accvgpr_write_b32 a130, 0
    v_accvgpr_write_b32 a131, 0
    v_accvgpr_write_b32 a132, 0
    v_accvgpr_write_b32 a133, 0
    v_accvgpr_write_b32 a134, 0
    v_accvgpr_write_b32 a135, 0
    v_accvgpr_write_b32 a136, 0
    v_accvgpr_write_b32 a137, 0
    v_accvgpr_write_b32 a138, 0
    v_accvgpr_write_b32 a139, 0
    v_accvgpr_write_b32 a140, 0
    v_accvgpr_write_b32 a141, 0
    v_accvgpr_write_b32 a142, 0
    v_accvgpr_write_b32 a143, 0
    v_accvgpr_write_b32 a144, 0
    v_accvgpr_write_b32 a145, 0
    v_accvgpr_write_b32 a146, 0
    v_accvgpr_write_b32 a147, 0
    v_accvgpr_write_b32 a148, 0
    v_accvgpr_write_b32 a149, 0
    v_accvgpr_write_b32 a150, 0
    v_accvgpr_write_b32 a151, 0
    v_accvgpr_write_b32 a152, 0
    v_accvgpr_write_b32 a153, 0
    v_accvgpr_write_b32 a154, 0
    v_accvgpr_write_b32 a155, 0
    v_accvgpr_write_b32 a156, 0
    v_accvgpr_write_b32 a157, 0
    v_accvgpr_write_b32 a158, 0
    v_accvgpr_write_b32 a159, 0
    v_accvgpr_write_b32 a160, 0
    v_accvgpr_write_b32 a161, 0
    v_accvgpr_write_b32 a162, 0
    v_accvgpr_write_b32 a163, 0
    v_accvgpr_write_b32 a164, 0
    v_accvgpr_write_b32 a165, 0
    v_accvgpr_write_b32 a166, 0
    v_accvgpr_write_b32 a167, 0
    v_accvgpr_write_b32 a168, 0
    v_accvgpr_write_b32 a169, 0
    v_accvgpr_write_b32 a170, 0
    v_accvgpr_write_b32 a171, 0
    v_accvgpr_write_b32 a172, 0
    v_accvgpr_write_b32 a173, 0
    v_accvgpr_write_b32 a174, 0
    v_accvgpr_write_b32 a175, 0
    v_accvgpr_write_b32 a176, 0
    v_accvgpr_write_b32 a177, 0
    v_accvgpr_write_b32 a178, 0
    v_accvgpr_write_b32 a179, 0
    v_accvgpr_write_b32 a180, 0
    v_accvgpr_write_b32 a181, 0
    v_accvgpr_write_b32 a182, 0
    v_accvgpr_write_b32 a183, 0
    v_accvgpr_write_b32 a184, 0
    v_accvgpr_write_b32 a185, 0
    v_accvgpr_write_b32 a186, 0
    v_accvgpr_write_b32 a187, 0
    v_accvgpr_write_b32 a188, 0
    v_accvgpr_write_b32 a189, 0
    v_accvgpr_write_b32 a190, 0
    v_accvgpr_write_b32 a191, 0
    v_mov_b32 v88, 0
    v_mov_b32 v89, 0
    v_mov_b32 v90, 0
    v_mov_b32 v91, 0
    v_mov_b32 v92, 0
    v_mov_b32 v93, 0
    s_mov_b32 s58, 0
L_concat_heads__mha_block_cached__gqa_block_cached__near_ridge_kernel_slow1_p2:
    buffer_load_dwordx2 v[112:113], v86, s[36:39], s58 offen offset:0
    buffer_load_dwordx2 v[114:115], v86, s[36:39], s58 offen offset:32
    buffer_load_dwordx2 v[116:117], v86, s[36:39], s58 offen offset:64
    buffer_load_dwordx2 v[118:119], v86, s[36:39], s58 offen offset:96
    buffer_load_dwordx2 v[120:121], v86, s[36:39], s58 offen offset:128
    buffer_load_dwordx2 v[122:123], v86, s[36:39], s58 offen offset:160
    buffer_load_dwordx2 v[124:125], v86, s[36:39], s58 offen offset:192
    buffer_load_dwordx2 v[126:127], v86, s[36:39], s58 offen offset:224
    buffer_load_dwordx2 v[144:145], v87, s[36:39], s58 offen offset:0
    buffer_load_dwordx2 v[146:147], v87, s[36:39], s58 offen offset:32
    buffer_load_dwordx2 v[148:149], v87, s[36:39], s58 offen offset:64
    buffer_load_dwordx2 v[150:151], v87, s[36:39], s58 offen offset:96
    buffer_load_dwordx2 v[152:153], v87, s[36:39], s58 offen offset:128
    buffer_load_dwordx2 v[154:155], v87, s[36:39], s58 offen offset:160
    buffer_load_dwordx2 v[156:157], v87, s[36:39], s58 offen offset:192
    buffer_load_dwordx2 v[158:159], v87, s[36:39], s58 offen offset:224
    buffer_load_ushort v240, v94, s[40:43], s58 offen offset:0
    buffer_load_ushort v241, v94, s[40:43], s58 offen offset:256
    buffer_load_ushort v242, v94, s[40:43], s58 offen offset:512
    buffer_load_ushort v243, v94, s[40:43], s58 offen offset:768
    buffer_load_ushort v244, v95, s[40:43], s58 offen offset:0
    buffer_load_ushort v245, v95, s[40:43], s58 offen offset:256
    buffer_load_ushort v246, v95, s[40:43], s58 offen offset:512
    buffer_load_ushort v247, v95, s[40:43], s58 offen offset:768
    buffer_load_ushort v248, v94, s[40:43], s58 offen offset:32
    buffer_load_ushort v249, v94, s[40:43], s58 offen offset:288
    buffer_load_ushort v250, v94, s[40:43], s58 offen offset:544
    buffer_load_ushort v251, v94, s[40:43], s58 offen offset:800
    buffer_load_ushort v252, v95, s[40:43], s58 offen offset:32
    buffer_load_ushort v253, v95, s[40:43], s58 offen offset:288
    buffer_load_ushort v254, v95, s[40:43], s58 offen offset:544
    buffer_load_ushort v255, v95, s[40:43], s58 offen offset:800
    s_waitcnt vmcnt(0)
    v_lshl_or_b32 v176, v241, 16, v240
    v_lshl_or_b32 v177, v243, 16, v242
    v_lshl_or_b32 v178, v245, 16, v244
    v_lshl_or_b32 v179, v247, 16, v246
    v_lshl_or_b32 v180, v249, 16, v248
    v_lshl_or_b32 v181, v251, 16, v250
    v_lshl_or_b32 v182, v253, 16, v252
    v_lshl_or_b32 v183, v255, 16, v254
    buffer_load_ushort v240, v94, s[40:43], s58 offen offset:64
    buffer_load_ushort v241, v94, s[40:43], s58 offen offset:320
    buffer_load_ushort v242, v94, s[40:43], s58 offen offset:576
    buffer_load_ushort v243, v94, s[40:43], s58 offen offset:832
    buffer_load_ushort v244, v95, s[40:43], s58 offen offset:64
    buffer_load_ushort v245, v95, s[40:43], s58 offen offset:320
    buffer_load_ushort v246, v95, s[40:43], s58 offen offset:576
    buffer_load_ushort v247, v95, s[40:43], s58 offen offset:832
    buffer_load_ushort v248, v94, s[40:43], s58 offen offset:96
    buffer_load_ushort v249, v94, s[40:43], s58 offen offset:352
    buffer_load_ushort v250, v94, s[40:43], s58 offen offset:608
    buffer_load_ushort v251, v94, s[40:43], s58 offen offset:864
    buffer_load_ushort v252, v95, s[40:43], s58 offen offset:96
    buffer_load_ushort v253, v95, s[40:43], s58 offen offset:352
    buffer_load_ushort v254, v95, s[40:43], s58 offen offset:608
    buffer_load_ushort v255, v95, s[40:43], s58 offen offset:864
    s_waitcnt vmcnt(0)
    v_lshl_or_b32 v184, v241, 16, v240
    v_lshl_or_b32 v185, v243, 16, v242
    v_lshl_or_b32 v186, v245, 16, v244
    v_lshl_or_b32 v187, v247, 16, v246
    v_lshl_or_b32 v188, v249, 16, v248
    v_lshl_or_b32 v189, v251, 16, v250
    v_lshl_or_b32 v190, v253, 16, v252
    v_lshl_or_b32 v191, v255, 16, v254
    buffer_load_ushort v240, v94, s[40:43], s58 offen offset:128
    buffer_load_ushort v241, v94, s[40:43], s58 offen offset:384
    buffer_load_ushort v242, v94, s[40:43], s58 offen offset:640
    buffer_load_ushort v243, v94, s[40:43], s58 offen offset:896
    buffer_load_ushort v244, v95, s[40:43], s58 offen offset:128
    buffer_load_ushort v245, v95, s[40:43], s58 offen offset:384
    buffer_load_ushort v246, v95, s[40:43], s58 offen offset:640
    buffer_load_ushort v247, v95, s[40:43], s58 offen offset:896
    buffer_load_ushort v248, v94, s[40:43], s58 offen offset:160
    buffer_load_ushort v249, v94, s[40:43], s58 offen offset:416
    buffer_load_ushort v250, v94, s[40:43], s58 offen offset:672
    buffer_load_ushort v251, v94, s[40:43], s58 offen offset:928
    buffer_load_ushort v252, v95, s[40:43], s58 offen offset:160
    buffer_load_ushort v253, v95, s[40:43], s58 offen offset:416
    buffer_load_ushort v254, v95, s[40:43], s58 offen offset:672
    buffer_load_ushort v255, v95, s[40:43], s58 offen offset:928
    s_waitcnt vmcnt(0)
    v_lshl_or_b32 v208, v241, 16, v240
    v_lshl_or_b32 v209, v243, 16, v242
    v_lshl_or_b32 v210, v245, 16, v244
    v_lshl_or_b32 v211, v247, 16, v246
    v_lshl_or_b32 v212, v249, 16, v248
    v_lshl_or_b32 v213, v251, 16, v250
    v_lshl_or_b32 v214, v253, 16, v252
    v_lshl_or_b32 v215, v255, 16, v254
    buffer_load_ushort v240, v94, s[40:43], s58 offen offset:192
    buffer_load_ushort v241, v94, s[40:43], s58 offen offset:448
    buffer_load_ushort v242, v94, s[40:43], s58 offen offset:704
    buffer_load_ushort v243, v94, s[40:43], s58 offen offset:960
    buffer_load_ushort v244, v95, s[40:43], s58 offen offset:192
    buffer_load_ushort v245, v95, s[40:43], s58 offen offset:448
    buffer_load_ushort v246, v95, s[40:43], s58 offen offset:704
    buffer_load_ushort v247, v95, s[40:43], s58 offen offset:960
    buffer_load_ushort v248, v94, s[40:43], s58 offen offset:224
    buffer_load_ushort v249, v94, s[40:43], s58 offen offset:480
    buffer_load_ushort v250, v94, s[40:43], s58 offen offset:736
    buffer_load_ushort v251, v94, s[40:43], s58 offen offset:992
    buffer_load_ushort v252, v95, s[40:43], s58 offen offset:224
    buffer_load_ushort v253, v95, s[40:43], s58 offen offset:480
    buffer_load_ushort v254, v95, s[40:43], s58 offen offset:736
    buffer_load_ushort v255, v95, s[40:43], s58 offen offset:992
    s_waitcnt vmcnt(0)
    v_lshl_or_b32 v216, v241, 16, v240
    v_lshl_or_b32 v217, v243, 16, v242
    v_lshl_or_b32 v218, v245, 16, v244
    v_lshl_or_b32 v219, v247, 16, v246
    v_lshl_or_b32 v220, v249, 16, v248
    v_lshl_or_b32 v221, v251, 16, v250
    v_lshl_or_b32 v222, v253, 16, v252
    v_lshl_or_b32 v223, v255, 16, v254
    s_nop 7
    v_mfma_f32_16x16x32_bf16 v[240:243], v[112:115], v[64:67], 0
    v_mfma_f32_16x16x32_bf16 v[240:243], v[116:119], v[68:71], v[240:243]
    v_mfma_f32_16x16x32_bf16 v[240:243], v[120:123], v[72:75], v[240:243]
    v_mfma_f32_16x16x32_bf16 v[240:243], v[124:127], v[76:79], v[240:243]
    v_mfma_f32_16x16x32_bf16 v[244:247], v[144:147], v[64:67], 0
    v_mfma_f32_16x16x32_bf16 v[244:247], v[148:151], v[68:71], v[244:247]
    v_mfma_f32_16x16x32_bf16 v[244:247], v[152:155], v[72:75], v[244:247]
    v_mfma_f32_16x16x32_bf16 v[244:247], v[156:159], v[76:79], v[244:247]
    s_nop 15
    s_nop 15
    v_sub_f32 v240, v240, v80
    v_sub_f32 v241, v241, v80
    v_sub_f32 v242, v242, v80
    v_sub_f32 v243, v243, v80
    v_sub_f32 v244, v244, v80
    v_sub_f32 v245, v245, v80
    v_sub_f32 v246, v246, v80
    v_sub_f32 v247, v247, v80
    v_exp_f32 v240, v240
    v_exp_f32 v241, v241
    v_exp_f32 v242, v242
    v_exp_f32 v243, v243
    v_exp_f32 v244, v244
    v_exp_f32 v245, v245
    v_exp_f32 v246, v246
    v_exp_f32 v247, v247
    s_nop 1
    v_add_f32 v88, v88, v240
    v_add_f32 v88, v88, v241
    v_add_f32 v88, v88, v242
    v_add_f32 v88, v88, v243
    v_add_f32 v88, v88, v244
    v_add_f32 v88, v88, v245
    v_add_f32 v88, v88, v246
    v_add_f32 v88, v88, v247
    v_cvt_pk_bf16_f32 v240, v240, v241
    v_cvt_pk_bf16_f32 v241, v242, v243
    v_cvt_pk_bf16_f32 v242, v244, v245
    v_cvt_pk_bf16_f32 v243, v246, v247
    s_nop 3
    v_mfma_f32_16x16x32_bf16 a[0:3], v[176:179], v[240:243], a[0:3]
    v_mfma_f32_16x16x32_bf16 a[4:7], v[180:183], v[240:243], a[4:7]
    v_mfma_f32_16x16x32_bf16 a[8:11], v[184:187], v[240:243], a[8:11]
    v_mfma_f32_16x16x32_bf16 a[12:15], v[188:191], v[240:243], a[12:15]
    v_mfma_f32_16x16x32_bf16 a[16:19], v[208:211], v[240:243], a[16:19]
    v_mfma_f32_16x16x32_bf16 a[20:23], v[212:215], v[240:243], a[20:23]
    v_mfma_f32_16x16x32_bf16 a[24:27], v[216:219], v[240:243], a[24:27]
    v_mfma_f32_16x16x32_bf16 a[28:31], v[220:223], v[240:243], a[28:31]
    s_nop 15
    s_nop 15
    v_mfma_f32_16x16x32_bf16 v[240:243], v[112:115], v[96:99], 0
    v_mfma_f32_16x16x32_bf16 v[240:243], v[116:119], v[100:103], v[240:243]
    v_mfma_f32_16x16x32_bf16 v[240:243], v[120:123], v[104:107], v[240:243]
    v_mfma_f32_16x16x32_bf16 v[240:243], v[124:127], v[108:111], v[240:243]
    v_mfma_f32_16x16x32_bf16 v[244:247], v[144:147], v[96:99], 0
    v_mfma_f32_16x16x32_bf16 v[244:247], v[148:151], v[100:103], v[244:247]
    v_mfma_f32_16x16x32_bf16 v[244:247], v[152:155], v[104:107], v[244:247]
    v_mfma_f32_16x16x32_bf16 v[244:247], v[156:159], v[108:111], v[244:247]
    s_nop 15
    s_nop 15
    v_sub_f32 v240, v240, v81
    v_sub_f32 v241, v241, v81
    v_sub_f32 v242, v242, v81
    v_sub_f32 v243, v243, v81
    v_sub_f32 v244, v244, v81
    v_sub_f32 v245, v245, v81
    v_sub_f32 v246, v246, v81
    v_sub_f32 v247, v247, v81
    v_exp_f32 v240, v240
    v_exp_f32 v241, v241
    v_exp_f32 v242, v242
    v_exp_f32 v243, v243
    v_exp_f32 v244, v244
    v_exp_f32 v245, v245
    v_exp_f32 v246, v246
    v_exp_f32 v247, v247
    s_nop 1
    v_add_f32 v89, v89, v240
    v_add_f32 v89, v89, v241
    v_add_f32 v89, v89, v242
    v_add_f32 v89, v89, v243
    v_add_f32 v89, v89, v244
    v_add_f32 v89, v89, v245
    v_add_f32 v89, v89, v246
    v_add_f32 v89, v89, v247
    v_cvt_pk_bf16_f32 v240, v240, v241
    v_cvt_pk_bf16_f32 v241, v242, v243
    v_cvt_pk_bf16_f32 v242, v244, v245
    v_cvt_pk_bf16_f32 v243, v246, v247
    s_nop 3
    v_mfma_f32_16x16x32_bf16 a[32:35], v[176:179], v[240:243], a[32:35]
    v_mfma_f32_16x16x32_bf16 a[36:39], v[180:183], v[240:243], a[36:39]
    v_mfma_f32_16x16x32_bf16 a[40:43], v[184:187], v[240:243], a[40:43]
    v_mfma_f32_16x16x32_bf16 a[44:47], v[188:191], v[240:243], a[44:47]
    v_mfma_f32_16x16x32_bf16 a[48:51], v[208:211], v[240:243], a[48:51]
    v_mfma_f32_16x16x32_bf16 a[52:55], v[212:215], v[240:243], a[52:55]
    v_mfma_f32_16x16x32_bf16 a[56:59], v[216:219], v[240:243], a[56:59]
    v_mfma_f32_16x16x32_bf16 a[60:63], v[220:223], v[240:243], a[60:63]
    s_nop 15
    s_nop 15
    v_mfma_f32_16x16x32_bf16 v[240:243], v[112:115], v[128:131], 0
    v_mfma_f32_16x16x32_bf16 v[240:243], v[116:119], v[132:135], v[240:243]
    v_mfma_f32_16x16x32_bf16 v[240:243], v[120:123], v[136:139], v[240:243]
    v_mfma_f32_16x16x32_bf16 v[240:243], v[124:127], v[140:143], v[240:243]
    v_mfma_f32_16x16x32_bf16 v[244:247], v[144:147], v[128:131], 0
    v_mfma_f32_16x16x32_bf16 v[244:247], v[148:151], v[132:135], v[244:247]
    v_mfma_f32_16x16x32_bf16 v[244:247], v[152:155], v[136:139], v[244:247]
    v_mfma_f32_16x16x32_bf16 v[244:247], v[156:159], v[140:143], v[244:247]
    s_nop 15
    s_nop 15
    v_sub_f32 v240, v240, v82
    v_sub_f32 v241, v241, v82
    v_sub_f32 v242, v242, v82
    v_sub_f32 v243, v243, v82
    v_sub_f32 v244, v244, v82
    v_sub_f32 v245, v245, v82
    v_sub_f32 v246, v246, v82
    v_sub_f32 v247, v247, v82
    v_exp_f32 v240, v240
    v_exp_f32 v241, v241
    v_exp_f32 v242, v242
    v_exp_f32 v243, v243
    v_exp_f32 v244, v244
    v_exp_f32 v245, v245
    v_exp_f32 v246, v246
    v_exp_f32 v247, v247
    s_nop 1
    v_add_f32 v90, v90, v240
    v_add_f32 v90, v90, v241
    v_add_f32 v90, v90, v242
    v_add_f32 v90, v90, v243
    v_add_f32 v90, v90, v244
    v_add_f32 v90, v90, v245
    v_add_f32 v90, v90, v246
    v_add_f32 v90, v90, v247
    v_cvt_pk_bf16_f32 v240, v240, v241
    v_cvt_pk_bf16_f32 v241, v242, v243
    v_cvt_pk_bf16_f32 v242, v244, v245
    v_cvt_pk_bf16_f32 v243, v246, v247
    s_nop 3
    v_mfma_f32_16x16x32_bf16 a[64:67], v[176:179], v[240:243], a[64:67]
    v_mfma_f32_16x16x32_bf16 a[68:71], v[180:183], v[240:243], a[68:71]
    v_mfma_f32_16x16x32_bf16 a[72:75], v[184:187], v[240:243], a[72:75]
    v_mfma_f32_16x16x32_bf16 a[76:79], v[188:191], v[240:243], a[76:79]
    v_mfma_f32_16x16x32_bf16 a[80:83], v[208:211], v[240:243], a[80:83]
    v_mfma_f32_16x16x32_bf16 a[84:87], v[212:215], v[240:243], a[84:87]
    v_mfma_f32_16x16x32_bf16 a[88:91], v[216:219], v[240:243], a[88:91]
    v_mfma_f32_16x16x32_bf16 a[92:95], v[220:223], v[240:243], a[92:95]
    s_nop 15
    s_nop 15
    v_mfma_f32_16x16x32_bf16 v[240:243], v[112:115], v[160:163], 0
    v_mfma_f32_16x16x32_bf16 v[240:243], v[116:119], v[164:167], v[240:243]
    v_mfma_f32_16x16x32_bf16 v[240:243], v[120:123], v[168:171], v[240:243]
    v_mfma_f32_16x16x32_bf16 v[240:243], v[124:127], v[172:175], v[240:243]
    v_mfma_f32_16x16x32_bf16 v[244:247], v[144:147], v[160:163], 0
    v_mfma_f32_16x16x32_bf16 v[244:247], v[148:151], v[164:167], v[244:247]
    v_mfma_f32_16x16x32_bf16 v[244:247], v[152:155], v[168:171], v[244:247]
    v_mfma_f32_16x16x32_bf16 v[244:247], v[156:159], v[172:175], v[244:247]
    s_nop 15
    s_nop 15
    v_sub_f32 v240, v240, v83
    v_sub_f32 v241, v241, v83
    v_sub_f32 v242, v242, v83
    v_sub_f32 v243, v243, v83
    v_sub_f32 v244, v244, v83
    v_sub_f32 v245, v245, v83
    v_sub_f32 v246, v246, v83
    v_sub_f32 v247, v247, v83
    v_exp_f32 v240, v240
    v_exp_f32 v241, v241
    v_exp_f32 v242, v242
    v_exp_f32 v243, v243
    v_exp_f32 v244, v244
    v_exp_f32 v245, v245
    v_exp_f32 v246, v246
    v_exp_f32 v247, v247
    s_nop 1
    v_add_f32 v91, v91, v240
    v_add_f32 v91, v91, v241
    v_add_f32 v91, v91, v242
    v_add_f32 v91, v91, v243
    v_add_f32 v91, v91, v244
    v_add_f32 v91, v91, v245
    v_add_f32 v91, v91, v246
    v_add_f32 v91, v91, v247
    v_cvt_pk_bf16_f32 v240, v240, v241
    v_cvt_pk_bf16_f32 v241, v242, v243
    v_cvt_pk_bf16_f32 v242, v244, v245
    v_cvt_pk_bf16_f32 v243, v246, v247
    s_nop 3
    v_mfma_f32_16x16x32_bf16 a[96:99], v[176:179], v[240:243], a[96:99]
    v_mfma_f32_16x16x32_bf16 a[100:103], v[180:183], v[240:243], a[100:103]
    v_mfma_f32_16x16x32_bf16 a[104:107], v[184:187], v[240:243], a[104:107]
    v_mfma_f32_16x16x32_bf16 a[108:111], v[188:191], v[240:243], a[108:111]
    v_mfma_f32_16x16x32_bf16 a[112:115], v[208:211], v[240:243], a[112:115]
    v_mfma_f32_16x16x32_bf16 a[116:119], v[212:215], v[240:243], a[116:119]
    v_mfma_f32_16x16x32_bf16 a[120:123], v[216:219], v[240:243], a[120:123]
    v_mfma_f32_16x16x32_bf16 a[124:127], v[220:223], v[240:243], a[124:127]
    s_nop 15
    s_nop 15
    v_mfma_f32_16x16x32_bf16 v[240:243], v[112:115], v[192:195], 0
    v_mfma_f32_16x16x32_bf16 v[240:243], v[116:119], v[196:199], v[240:243]
    v_mfma_f32_16x16x32_bf16 v[240:243], v[120:123], v[200:203], v[240:243]
    v_mfma_f32_16x16x32_bf16 v[240:243], v[124:127], v[204:207], v[240:243]
    v_mfma_f32_16x16x32_bf16 v[244:247], v[144:147], v[192:195], 0
    v_mfma_f32_16x16x32_bf16 v[244:247], v[148:151], v[196:199], v[244:247]
    v_mfma_f32_16x16x32_bf16 v[244:247], v[152:155], v[200:203], v[244:247]
    v_mfma_f32_16x16x32_bf16 v[244:247], v[156:159], v[204:207], v[244:247]
    s_nop 15
    s_nop 15
    v_sub_f32 v240, v240, v84
    v_sub_f32 v241, v241, v84
    v_sub_f32 v242, v242, v84
    v_sub_f32 v243, v243, v84
    v_sub_f32 v244, v244, v84
    v_sub_f32 v245, v245, v84
    v_sub_f32 v246, v246, v84
    v_sub_f32 v247, v247, v84
    v_exp_f32 v240, v240
    v_exp_f32 v241, v241
    v_exp_f32 v242, v242
    v_exp_f32 v243, v243
    v_exp_f32 v244, v244
    v_exp_f32 v245, v245
    v_exp_f32 v246, v246
    v_exp_f32 v247, v247
    s_nop 1
    v_add_f32 v92, v92, v240
    v_add_f32 v92, v92, v241
    v_add_f32 v92, v92, v242
    v_add_f32 v92, v92, v243
    v_add_f32 v92, v92, v244
    v_add_f32 v92, v92, v245
    v_add_f32 v92, v92, v246
    v_add_f32 v92, v92, v247
    v_cvt_pk_bf16_f32 v240, v240, v241
    v_cvt_pk_bf16_f32 v241, v242, v243
    v_cvt_pk_bf16_f32 v242, v244, v245
    v_cvt_pk_bf16_f32 v243, v246, v247
    s_nop 3
    v_mfma_f32_16x16x32_bf16 a[128:131], v[176:179], v[240:243], a[128:131]
    v_mfma_f32_16x16x32_bf16 a[132:135], v[180:183], v[240:243], a[132:135]
    v_mfma_f32_16x16x32_bf16 a[136:139], v[184:187], v[240:243], a[136:139]
    v_mfma_f32_16x16x32_bf16 a[140:143], v[188:191], v[240:243], a[140:143]
    v_mfma_f32_16x16x32_bf16 a[144:147], v[208:211], v[240:243], a[144:147]
    v_mfma_f32_16x16x32_bf16 a[148:151], v[212:215], v[240:243], a[148:151]
    v_mfma_f32_16x16x32_bf16 a[152:155], v[216:219], v[240:243], a[152:155]
    v_mfma_f32_16x16x32_bf16 a[156:159], v[220:223], v[240:243], a[156:159]
    s_nop 15
    s_nop 15
    v_mfma_f32_16x16x32_bf16 v[240:243], v[112:115], v[224:227], 0
    v_mfma_f32_16x16x32_bf16 v[240:243], v[116:119], v[228:231], v[240:243]
    v_mfma_f32_16x16x32_bf16 v[240:243], v[120:123], v[232:235], v[240:243]
    v_mfma_f32_16x16x32_bf16 v[240:243], v[124:127], v[236:239], v[240:243]
    v_mfma_f32_16x16x32_bf16 v[244:247], v[144:147], v[224:227], 0
    v_mfma_f32_16x16x32_bf16 v[244:247], v[148:151], v[228:231], v[244:247]
    v_mfma_f32_16x16x32_bf16 v[244:247], v[152:155], v[232:235], v[244:247]
    v_mfma_f32_16x16x32_bf16 v[244:247], v[156:159], v[236:239], v[244:247]
    s_nop 15
    s_nop 15
    v_sub_f32 v240, v240, v85
    v_sub_f32 v241, v241, v85
    v_sub_f32 v242, v242, v85
    v_sub_f32 v243, v243, v85
    v_sub_f32 v244, v244, v85
    v_sub_f32 v245, v245, v85
    v_sub_f32 v246, v246, v85
    v_sub_f32 v247, v247, v85
    v_exp_f32 v240, v240
    v_exp_f32 v241, v241
    v_exp_f32 v242, v242
    v_exp_f32 v243, v243
    v_exp_f32 v244, v244
    v_exp_f32 v245, v245
    v_exp_f32 v246, v246
    v_exp_f32 v247, v247
    s_nop 1
    v_add_f32 v93, v93, v240
    v_add_f32 v93, v93, v241
    v_add_f32 v93, v93, v242
    v_add_f32 v93, v93, v243
    v_add_f32 v93, v93, v244
    v_add_f32 v93, v93, v245
    v_add_f32 v93, v93, v246
    v_add_f32 v93, v93, v247
    v_cvt_pk_bf16_f32 v240, v240, v241
    v_cvt_pk_bf16_f32 v241, v242, v243
    v_cvt_pk_bf16_f32 v242, v244, v245
    v_cvt_pk_bf16_f32 v243, v246, v247
    s_nop 3
    v_mfma_f32_16x16x32_bf16 a[160:163], v[176:179], v[240:243], a[160:163]
    v_mfma_f32_16x16x32_bf16 a[164:167], v[180:183], v[240:243], a[164:167]
    v_mfma_f32_16x16x32_bf16 a[168:171], v[184:187], v[240:243], a[168:171]
    v_mfma_f32_16x16x32_bf16 a[172:175], v[188:191], v[240:243], a[172:175]
    v_mfma_f32_16x16x32_bf16 a[176:179], v[208:211], v[240:243], a[176:179]
    v_mfma_f32_16x16x32_bf16 a[180:183], v[212:215], v[240:243], a[180:183]
    v_mfma_f32_16x16x32_bf16 a[184:187], v[216:219], v[240:243], a[184:187]
    v_mfma_f32_16x16x32_bf16 a[188:191], v[220:223], v[240:243], a[188:191]
    s_nop 15
    s_nop 15
    s_add_u32 s58, s58, 0x2000
    s_cmp_lt_u32 s58, 0x20000
    s_cbranch_scc1 L_concat_heads__mha_block_cached__gqa_block_cached__near_ridge_kernel_slow1_p2
    v_mov_b32 v248, v88
    s_nop 1
    v_permlane32_swap_b32 v88, v248
    s_nop 1
    v_add_f32 v88, v88, v248
    v_mov_b32 v248, v88
    s_nop 1
    v_permlane16_swap_b32 v88, v248
    s_nop 1
    v_add_f32 v88, v88, v248
    s_nop 0
    v_rcp_f32 v32, v88
    v_mov_b32 v248, v89
    s_nop 1
    v_permlane32_swap_b32 v89, v248
    s_nop 1
    v_add_f32 v89, v89, v248
    v_mov_b32 v248, v89
    s_nop 1
    v_permlane16_swap_b32 v89, v248
    s_nop 1
    v_add_f32 v89, v89, v248
    s_nop 0
    v_rcp_f32 v33, v89
    v_mov_b32 v248, v90
    s_nop 1
    v_permlane32_swap_b32 v90, v248
    s_nop 1
    v_add_f32 v90, v90, v248
    v_mov_b32 v248, v90
    s_nop 1
    v_permlane16_swap_b32 v90, v248
    s_nop 1
    v_add_f32 v90, v90, v248
    s_nop 0
    v_rcp_f32 v34, v90
    v_mov_b32 v248, v91
    s_nop 1
    v_permlane32_swap_b32 v91, v248
    s_nop 1
    v_add_f32 v91, v91, v248
    v_mov_b32 v248, v91
    s_nop 1
    v_permlane16_swap_b32 v91, v248
    s_nop 1
    v_add_f32 v91, v91, v248
    s_nop 0
    v_rcp_f32 v35, v91
    v_mov_b32 v248, v92
    s_nop 1
    v_permlane32_swap_b32 v92, v248
    s_nop 1
    v_add_f32 v92, v92, v248
    v_mov_b32 v248, v92
    s_nop 1
    v_permlane16_swap_b32 v92, v248
    s_nop 1
    v_add_f32 v92, v92, v248
    s_nop 0
    v_rcp_f32 v36, v92
    v_mov_b32 v248, v93
    s_nop 1
    v_permlane32_swap_b32 v93, v248
    s_nop 1
    v_add_f32 v93, v93, v248
    v_mov_b32 v248, v93
    s_nop 1
    v_permlane16_swap_b32 v93, v248
    s_nop 1
    v_add_f32 v93, v93, v248
    s_nop 0
    v_rcp_f32 v37, v93
    s_nop 15
    s_nop 15
    s_waitcnt vmcnt(0)
    s_nop 7
    s_branch L_concat_heads__mha_block_cached__gqa_block_cached__near_ridge_kernel_back1
L_concat_heads__mha_block_cached__gqa_block_cached__near_ridge_kernel_poll1_spin:
    s_mov_b32 s62, 0x40000
L_concat_heads__mha_block_cached__gqa_block_cached__near_ridge_kernel_poll1_loop:
    s_sleep 4
    buffer_load_dword v49, v50, s[92:95], s65 offen sc1
    s_waitcnt vmcnt(0)
    v_readfirstlane_b32 s63, v49
    s_nop 1
    s_cmp_ge_u32 s63, 8
    s_cbranch_scc1 L_concat_heads__mha_block_cached__gqa_block_cached__near_ridge_kernel_poll1_ok
    s_sub_u32 s62, s62, 1
    s_cmp_lg_u32 s62, 0
    s_cbranch_scc1 L_concat_heads__mha_block_cached__gqa_block_cached__near_ridge_kernel_poll1_loop
    s_branch L_concat_heads__mha_block_cached__gqa_block_cached__near_ridge_kernel_poll1_ok
.section .rodata,"a"
.p2align 6
.amdhsa_kernel concat_heads__mha_block_cached__gqa_block_cached__near_ridge_kernel
  .amdhsa_next_free_vgpr 512
  .amdhsa_next_free_sgpr 102
  .amdhsa_accum_offset 256
  .amdhsa_group_segment_fixed_size 0
  .amdhsa_kernarg_size 104
  .amdhsa_user_sgpr_count 2
  .amdhsa_user_sgpr_kernarg_segment_ptr 1
  .amdhsa_system_sgpr_workgroup_id_x 1
.end_amdhsa_kernel
```
